```python
import torch

def _softmax(x, axis=-1):
    return torch.softmax(x, dim=axis)
def _gelu(x):
    return torch.nn.functional.gelu(x, approximate="tanh")
def _silu(x):
    return torch.nn.functional.silu(x)
def _sigmoid(x):
    return torch.sigmoid(x)
def _layernorm(x, axis=-1, eps=1e-5):
    m = x.mean(dim=axis, keepdim=True)
    v = x.var(dim=axis, keepdim=True, unbiased=False)
    return (x - m) / torch.sqrt(v + eps)
def _scatter_add(tgt, idx, src, axis=0):
    return tgt.clone().index_add_(axis, idx, src)
def _segment_sum(src, seg, n):
    out = torch.zeros((n,) + src.shape[1:], dtype=src.dtype)
    return out.index_add_(0, seg, src)
def _pad(x, pw):
    flat = tuple(v for pair in reversed(pw) for v in pair)
    return torch.nn.functional.pad(x, flat)

kernel_name = 'standalone__kv_cache_quant_int4_int2_kv_with_per_channel_or_per_token_scales__decode'

def setup_inputs():

    _w = (lambda a: (lambda t: t.to(torch.bfloat16) if t.is_floating_point() else t)(torch.as_tensor(a)))
    B = 1
    Sq = 1
    Skv = 32768
    Hq = 32
    Hkv = 32
    Dh = 192
    bits = 4
    G = 64
    if G <= 0 or G >= Skv:
        G = max(1, Skv // 2)
    Skv = (Skv // G) * G
    ngk = Skv // G
    qmax = (1 << bits) - 1
    return {
        "q": _w((lambda *s: torch.randn(*s, dtype=torch.bfloat16) * 1.6)(B, Hq, Sq, Dh)),
        "qk": _w(torch.randint(0, qmax + 1, (B, Hkv, Skv, Dh)).to(torch.int32)),
        "qv": _w(torch.randint(0, qmax + 1, (B, Hkv, Skv, Dh)).to(torch.int32)),
        "k_scales": _w(torch.abs((lambda *s: torch.randn(*s, dtype=torch.bfloat16) * 1.6)(B, Hkv, ngk, Dh)) * 0.05 + 0.02),
        "k_zeros": _w((lambda *s: torch.randn(*s, dtype=torch.bfloat16) * 1.6)(B, Hkv, ngk, Dh) + float(qmax) / 2.0),
        "v_scales": _w(torch.abs((lambda *s: torch.randn(*s, dtype=torch.bfloat16) * 0.05)(B, Hkv, Skv, 1)) * 0.05 + 0.02),
        "v_zeros": _w((lambda *s: torch.randn(*s, dtype=torch.bfloat16) * 0.05)(B, Hkv, Skv, 1) + float(qmax) / 2.0),
    }

def reference(q, qk, qv, k_scales, k_zeros, v_scales, v_zeros):
    B, Hq, Sq, Dh = q.shape
    Hkv, Skv = qk.shape[1], qk.shape[2]
    ngk = k_scales.shape[2]
    G = Skv // ngk
    ks = (lambda x, n, axis: torch.repeat_interleave(x, n, dim=axis))(k_scales, G, axis=2)
    kz = (lambda x, n, axis: torch.repeat_interleave(x, n, dim=axis))(k_zeros, G, axis=2)
    k = ((lambda x, dt: x.to(dt))(qk, q.dtype) - kz) * ks
    v = ((lambda x, dt: x.to(dt))(qv, q.dtype) - v_zeros) * v_scales
    rep = Hq // Hkv
    if rep > 1:
        k = (lambda x, n, axis: torch.repeat_interleave(x, n, dim=axis))(k, rep, axis=1)
        v = (lambda x, n, axis: torch.repeat_interleave(x, n, dim=axis))(v, rep, axis=1)
    scale = float(Dh) ** -0.5
    logits = torch.einsum("bhqd,bhkd->bhqk", q, k) * scale
    p = _softmax(logits, axis=-1)
    o = torch.einsum("bhqk,bhkd->bhqd", p, v)
    return o
```

```asm
; @launch grid=(256,1,1) block=(1024,1,1) lds=16384
.amdgcn_target "amdgcn-amd-amdhsa--gfx950"
.text
.globl standalone__kv_cache_quant_int4_int2_kv_with_per_channel_or_per_token_scales__decode_kernel
.p2align 8
.type standalone__kv_cache_quant_int4_int2_kv_with_per_channel_or_per_token_scales__decode_kernel,@function
standalone__kv_cache_quant_int4_int2_kv_with_per_channel_or_per_token_scales__decode_kernel:
    s_cmp_ge_u32 s2, 256
    s_cbranch_scc1 L_end
    s_load_dwordx16 s[4:19], s[0:1], 0
    s_load_dwordx4 s[20:23], s[0:1], 64
    v_lshrrev_b32 v113, 6, v0
    v_and_b32 v0, 63, v0
    v_readfirstlane_b32 s58, v113
    v_and_b32 v114, 15, v0
    v_lshrrev_b32 v113, 4, v0
    v_mul_u32_u24 v1, 768, v113
    v_lshl_add_u32 v1, v114, 4, v1
    v_lshlrev_b32 v2, 3, v114
    v_bfrev_b32 v3, v114
    v_lshrrev_b32 v3, 28, v3
    v_lshl_add_u32 v3, v3, 2, v113
    v_lshlrev_b32 v3, 1, v3
    s_lshr_b32 s56, s2, 3
    s_and_b32 s57, s2, 7
    s_mul_i32 s59, s57, 16
    s_add_u32 s59, s59, s58
    s_mul_i32 s59, s59, 4
    s_lshl_b32 s80, s56, 9
    s_add_u32 s59, s59, s80
    s_mul_i32 s60, s59, 49152
    s_mov_b32 s61, s60
    s_mul_i32 s62, s59, 384
    s_lshl_b32 s63, s59, 7
    s_mul_i32 s80, s56, 384
    s_mov_b32 s66, 0xcccccccc
    s_mov_b32 s67, 0xcccccccc
    s_mov_b32 s68, 0xaaaaaaaa
    s_mov_b32 s69, 0xaaaaaaaa
    s_waitcnt lgkmcnt(0)
    s_mov_b32 s24, s6
    s_and_b32 s25, s7, 0xffff
    s_mov_b32 s26, 805306368
    s_mov_b32 s27, 0x00020000
    s_mov_b32 s32, s10
    s_and_b32 s33, s11, 0xffff
    s_mov_b32 s34, 6291456
    s_mov_b32 s35, 0x00020000
    s_mov_b32 s36, s12
    s_and_b32 s37, s13, 0xffff
    s_mov_b32 s38, 6291456
    s_mov_b32 s39, 0x00020000
    s_mov_b32 s48, s4
    s_and_b32 s49, s5, 0xffff
    s_mov_b32 s50, 12288
    s_mov_b32 s51, 0x00020000
    buffer_load_dwordx2 v[88:89], v2, s[48:51], s80 offen offset:0
    buffer_load_dwordx2 v[90:91], v2, s[48:51], s80 offen offset:128
    buffer_load_dwordx2 v[92:93], v2, s[48:51], s80 offen offset:256
    buffer_load_dwordx2 v[76:77], v2, s[32:35], s62 offen offset:0
    buffer_load_dwordx2 v[78:79], v2, s[32:35], s62 offen offset:128
    buffer_load_dwordx2 v[80:81], v2, s[32:35], s62 offen offset:256
    buffer_load_dwordx2 v[82:83], v2, s[36:39], s62 offen offset:0
    buffer_load_dwordx2 v[84:85], v2, s[36:39], s62 offen offset:128
    buffer_load_dwordx2 v[86:87], v2, s[36:39], s62 offen offset:256
    s_add_u32 s62, s62, 384
    buffer_load_dwordx4 v[4:7], v1, s[24:27], s60 offen offset:0
    buffer_load_dwordx4 v[8:11], v1, s[24:27], s60 offen offset:256
    buffer_load_dwordx4 v[12:15], v1, s[24:27], s60 offen offset:512
    s_mov_b32 s28, s8
    s_and_b32 s29, s9, 0xffff
    s_mov_b32 s30, 805306368
    s_mov_b32 s31, 0x00020000
    s_mov_b32 s40, s14
    s_and_b32 s41, s15, 0xffff
    s_mov_b32 s42, 2097152
    s_mov_b32 s43, 0x00020000
    s_mov_b32 s44, s16
    s_and_b32 s45, s17, 0xffff
    s_mov_b32 s46, 2097152
    s_mov_b32 s47, 0x00020000
    buffer_load_dwordx4 v[16:19], v1, s[24:27], s60 offen offset:3072
    buffer_load_dwordx4 v[20:23], v1, s[24:27], s60 offen offset:3328
    buffer_load_dwordx4 v[24:27], v1, s[24:27], s60 offen offset:3584
    s_add_u32 s60, s60, 6144
    buffer_load_dwordx4 v[28:31], v1, s[24:27], s60 offen offset:0
    buffer_load_dwordx4 v[32:35], v1, s[24:27], s60 offen offset:256
    buffer_load_dwordx4 v[36:39], v1, s[24:27], s60 offen offset:512
    buffer_load_dwordx4 v[40:43], v1, s[24:27], s60 offen offset:3072
    buffer_load_dwordx4 v[44:47], v1, s[24:27], s60 offen offset:3328
    buffer_load_dwordx4 v[48:51], v1, s[24:27], s60 offen offset:3584
    s_add_u32 s60, s60, 6144
    s_mov_b32 s52, s22
    s_and_b32 s53, s23, 0xffff
    s_mov_b32 s54, 262144
    s_mov_b32 s55, 0x00020000
    s_mov_b32 s72, s18
    s_and_b32 s73, s19, 0xffff
    s_mov_b32 s74, 12288
    s_mov_b32 s75, 0x00020000
    s_mov_b32 s76, s20
    s_and_b32 s77, s21, 0xffff
    s_mov_b32 s78, 256
    s_mov_b32 s79, 0x00020000
    s_mov_b32 s80, 0x3dd53b95
    v_mov_b32 v101, 0xf149f2ca
    v_mov_b32 v102, 0
    v_mov_b32 v103, 0
    s_waitcnt vmcnt(18)
    v_lshlrev_b32 v52, 16, v88
    v_and_b32 v53, 0xffff0000, v88
    v_lshlrev_b32 v54, 16, v89
    v_and_b32 v55, 0xffff0000, v89
    v_lshlrev_b32 v56, 16, v90
    v_and_b32 v57, 0xffff0000, v90
    v_lshlrev_b32 v58, 16, v91
    v_and_b32 v59, 0xffff0000, v91
    v_lshlrev_b32 v60, 16, v92
    v_and_b32 v61, 0xffff0000, v92
    v_lshlrev_b32 v62, 16, v93
    v_and_b32 v63, 0xffff0000, v93
    v_mul_f32 v52, s80, v52
    v_mul_f32 v53, s80, v53
    v_mul_f32 v54, s80, v54
    v_mul_f32 v55, s80, v55
    v_mul_f32 v56, s80, v56
    v_mul_f32 v57, s80, v57
    v_mul_f32 v58, s80, v58
    v_mul_f32 v59, s80, v59
    v_mul_f32 v60, s80, v60
    v_mul_f32 v61, s80, v61
    v_mul_f32 v62, s80, v62
    v_mul_f32 v63, s80, v63
    v_mov_b32 v88, 0
    v_mov_b32 v89, 0
    v_mov_b32 v90, 0
    v_mov_b32 v91, 0
    v_mov_b32 v92, 0
    v_mov_b32 v93, 0
    v_mov_b32 v94, 0
    v_mov_b32 v95, 0
    v_mov_b32 v96, 0
    v_mov_b32 v97, 0
    v_mov_b32 v98, 0
    v_mov_b32 v99, 0
    s_mov_b32 s64, 3
    s_nop 0
L_loop:
    s_waitcnt vmcnt(9)
    v_lshlrev_b32 v113, 16, v76
    v_and_b32 v114, 0xffff0000, v76
    v_mul_f32 v64, v113, v52
    v_mul_f32 v65, v114, v53
    v_lshlrev_b32 v113, 16, v82
    v_and_b32 v114, 0xffff0000, v82
    v_mul_f32 v100, v64, v113
    v_fmac_f32 v100, v65, v114
    v_lshlrev_b32 v113, 16, v77
    v_and_b32 v114, 0xffff0000, v77
    v_mul_f32 v66, v113, v54
    v_mul_f32 v67, v114, v55
    v_lshlrev_b32 v113, 16, v83
    v_and_b32 v114, 0xffff0000, v83
    v_fmac_f32 v100, v66, v113
    v_fmac_f32 v100, v67, v114
    v_lshlrev_b32 v113, 16, v78
    v_and_b32 v114, 0xffff0000, v78
    v_mul_f32 v68, v113, v56
    v_mul_f32 v69, v114, v57
    v_lshlrev_b32 v113, 16, v84
    v_and_b32 v114, 0xffff0000, v84
    v_fmac_f32 v100, v68, v113
    v_fmac_f32 v100, v69, v114
    v_lshlrev_b32 v113, 16, v79
    v_and_b32 v114, 0xffff0000, v79
    v_mul_f32 v70, v113, v58
    v_mul_f32 v71, v114, v59
    v_lshlrev_b32 v113, 16, v85
    v_and_b32 v114, 0xffff0000, v85
    v_fmac_f32 v100, v70, v113
    v_fmac_f32 v100, v71, v114
    v_lshlrev_b32 v113, 16, v80
    v_and_b32 v114, 0xffff0000, v80
    v_mul_f32 v72, v113, v60
    v_mul_f32 v73, v114, v61
    v_lshlrev_b32 v113, 16, v86
    v_and_b32 v114, 0xffff0000, v86
    v_fmac_f32 v100, v72, v113
    v_fmac_f32 v100, v73, v114
    v_lshlrev_b32 v113, 16, v81
    v_and_b32 v114, 0xffff0000, v81
    v_mul_f32 v74, v113, v62
    v_mul_f32 v75, v114, v63
    v_lshlrev_b32 v113, 16, v87
    v_and_b32 v114, 0xffff0000, v87
    v_fmac_f32 v100, v74, v113
    v_fmac_f32 v100, v75, v114
    v_cvt_f32_i32 v4, v4
    v_cvt_f32_i32 v5, v5
    v_cvt_f32_i32 v6, v6
    v_cvt_f32_i32 v7, v7
    v_cvt_f32_i32 v8, v8
    v_cvt_f32_i32 v9, v9
    v_cvt_f32_i32 v10, v10
    v_cvt_f32_i32 v11, v11
    v_cvt_f32_i32 v12, v12
    v_cvt_f32_i32 v13, v13
    v_cvt_f32_i32 v14, v14
    v_cvt_f32_i32 v15, v15
    v_fma_f32 v107, v64, v4, -v100
    v_fmac_f32 v107, v65, v5
    v_fmac_f32 v107, v66, v6
    v_fmac_f32 v107, v67, v7
    v_fmac_f32 v107, v68, v8
    v_fmac_f32 v107, v69, v9
    v_fmac_f32 v107, v70, v10
    v_fmac_f32 v107, v71, v11
    v_fmac_f32 v107, v72, v12
    v_fmac_f32 v107, v73, v13
    v_fmac_f32 v107, v74, v14
    v_fmac_f32 v107, v75, v15
    buffer_load_dwordx4 v[4:7], v1, s[24:27], s60 offen offset:0
    buffer_load_dwordx4 v[8:11], v1, s[24:27], s60 offen offset:256
    buffer_load_dwordx4 v[12:15], v1, s[24:27], s60 offen offset:512
    v_add_f32_dpp v108, v107, v107 row_ror:8 row_mask:0xf bank_mask:0x3
    s_waitcnt vmcnt(9)
    v_cvt_f32_i32 v16, v16
    v_cvt_f32_i32 v17, v17
    v_cvt_f32_i32 v18, v18
    v_cvt_f32_i32 v19, v19
    v_cvt_f32_i32 v20, v20
    v_cvt_f32_i32 v21, v21
    v_cvt_f32_i32 v22, v22
    v_cvt_f32_i32 v23, v23
    v_cvt_f32_i32 v24, v24
    v_cvt_f32_i32 v25, v25
    v_cvt_f32_i32 v26, v26
    v_cvt_f32_i32 v27, v27
    v_fma_f32 v107, v64, v16, -v100
    v_fmac_f32 v107, v65, v17
    v_fmac_f32 v107, v66, v18
    v_fmac_f32 v107, v67, v19
    v_fmac_f32 v107, v68, v20
    v_fmac_f32 v107, v69, v21
    v_fmac_f32 v107, v70, v22
    v_fmac_f32 v107, v71, v23
    v_fmac_f32 v107, v72, v24
    v_fmac_f32 v107, v73, v25
    v_fmac_f32 v107, v74, v26
    v_fmac_f32 v107, v75, v27
    buffer_load_dwordx4 v[16:19], v1, s[24:27], s60 offen offset:3072
    buffer_load_dwordx4 v[20:23], v1, s[24:27], s60 offen offset:3328
    buffer_load_dwordx4 v[24:27], v1, s[24:27], s60 offen offset:3584
    s_add_u32 s60, s60, 6144
    v_add_f32_dpp v108, v107, v107 row_ror:8 row_mask:0xf bank_mask:0xc
    s_nop 1
    v_add_f32_dpp v109, v108, v108 row_shl:4 row_mask:0xf bank_mask:0x5
    s_waitcnt vmcnt(9)
    v_cvt_f32_i32 v28, v28
    v_cvt_f32_i32 v29, v29
    v_cvt_f32_i32 v30, v30
    v_cvt_f32_i32 v31, v31
    v_cvt_f32_i32 v32, v32
    v_cvt_f32_i32 v33, v33
    v_cvt_f32_i32 v34, v34
    v_cvt_f32_i32 v35, v35
    v_cvt_f32_i32 v36, v36
    v_cvt_f32_i32 v37, v37
    v_cvt_f32_i32 v38, v38
    v_cvt_f32_i32 v39, v39
    v_fma_f32 v107, v64, v28, -v100
    v_fmac_f32 v107, v65, v29
    v_fmac_f32 v107, v66, v30
    v_fmac_f32 v107, v67, v31
    v_fmac_f32 v107, v68, v32
    v_fmac_f32 v107, v69, v33
    v_fmac_f32 v107, v70, v34
    v_fmac_f32 v107, v71, v35
    v_fmac_f32 v107, v72, v36
    v_fmac_f32 v107, v73, v37
    v_fmac_f32 v107, v74, v38
    v_fmac_f32 v107, v75, v39
    buffer_load_dwordx4 v[28:31], v1, s[24:27], s60 offen offset:0
    buffer_load_dwordx4 v[32:35], v1, s[24:27], s60 offen offset:256
    buffer_load_dwordx4 v[36:39], v1, s[24:27], s60 offen offset:512
    v_add_f32_dpp v108, v107, v107 row_ror:8 row_mask:0xf bank_mask:0x3
    s_waitcnt vmcnt(9)
    v_cvt_f32_i32 v40, v40
    v_cvt_f32_i32 v41, v41
    v_cvt_f32_i32 v42, v42
    v_cvt_f32_i32 v43, v43
    v_cvt_f32_i32 v44, v44
    v_cvt_f32_i32 v45, v45
    v_cvt_f32_i32 v46, v46
    v_cvt_f32_i32 v47, v47
    v_cvt_f32_i32 v48, v48
    v_cvt_f32_i32 v49, v49
    v_cvt_f32_i32 v50, v50
    v_cvt_f32_i32 v51, v51
    v_fma_f32 v107, v64, v40, -v100
    v_fmac_f32 v107, v65, v41
    v_fmac_f32 v107, v66, v42
    v_fmac_f32 v107, v67, v43
    v_fmac_f32 v107, v68, v44
    v_fmac_f32 v107, v69, v45
    v_fmac_f32 v107, v70, v46
    v_fmac_f32 v107, v71, v47
    v_fmac_f32 v107, v72, v48
    v_fmac_f32 v107, v73, v49
    v_fmac_f32 v107, v74, v50
    v_fmac_f32 v107, v75, v51
    buffer_load_dwordx4 v[40:43], v1, s[24:27], s60 offen offset:3072
    buffer_load_dwordx4 v[44:47], v1, s[24:27], s60 offen offset:3328
    buffer_load_dwordx4 v[48:51], v1, s[24:27], s60 offen offset:3584
    s_add_u32 s60, s60, 6144
    v_add_f32_dpp v108, v107, v107 row_ror:8 row_mask:0xf bank_mask:0xc
    s_nop 1
    v_add_f32_dpp v109, v108, v108 row_shr:4 row_mask:0xf bank_mask:0xa
    s_nop 1
    v_add_f32_dpp v110, v109, v109 quad_perm:[2,3,0,1] row_mask:0xf bank_mask:0xf
    s_waitcnt vmcnt(9)
    v_cvt_f32_i32 v4, v4
    v_cvt_f32_i32 v5, v5
    v_cvt_f32_i32 v6, v6
    v_cvt_f32_i32 v7, v7
    v_cvt_f32_i32 v8, v8
    v_cvt_f32_i32 v9, v9
    v_cvt_f32_i32 v10, v10
    v_cvt_f32_i32 v11, v11
    v_cvt_f32_i32 v12, v12
    v_cvt_f32_i32 v13, v13
    v_cvt_f32_i32 v14, v14
    v_cvt_f32_i32 v15, v15
    v_fma_f32 v107, v64, v4, -v100
    v_fmac_f32 v107, v65, v5
    v_fmac_f32 v107, v66, v6
    v_fmac_f32 v107, v67, v7
    v_fmac_f32 v107, v68, v8
    v_fmac_f32 v107, v69, v9
    v_fmac_f32 v107, v70, v10
    v_fmac_f32 v107, v71, v11
    v_fmac_f32 v107, v72, v12
    v_fmac_f32 v107, v73, v13
    v_fmac_f32 v107, v74, v14
    v_fmac_f32 v107, v75, v15
    buffer_load_dwordx4 v[4:7], v1, s[24:27], s60 offen offset:0
    buffer_load_dwordx4 v[8:11], v1, s[24:27], s60 offen offset:256
    buffer_load_dwordx4 v[12:15], v1, s[24:27], s60 offen offset:512
    v_add_f32_dpp v108, v107, v107 row_ror:8 row_mask:0xf bank_mask:0x3
    s_waitcnt vmcnt(9)
    v_cvt_f32_i32 v16, v16
    v_cvt_f32_i32 v17, v17
    v_cvt_f32_i32 v18, v18
    v_cvt_f32_i32 v19, v19
    v_cvt_f32_i32 v20, v20
    v_cvt_f32_i32 v21, v21
    v_cvt_f32_i32 v22, v22
    v_cvt_f32_i32 v23, v23
    v_cvt_f32_i32 v24, v24
    v_cvt_f32_i32 v25, v25
    v_cvt_f32_i32 v26, v26
    v_cvt_f32_i32 v27, v27
    v_fma_f32 v107, v64, v16, -v100
    v_fmac_f32 v107, v65, v17
    v_fmac_f32 v107, v66, v18
    v_fmac_f32 v107, v67, v19
    v_fmac_f32 v107, v68, v20
    v_fmac_f32 v107, v69, v21
    v_fmac_f32 v107, v70, v22
    v_fmac_f32 v107, v71, v23
    v_fmac_f32 v107, v72, v24
    v_fmac_f32 v107, v73, v25
    v_fmac_f32 v107, v74, v26
    v_fmac_f32 v107, v75, v27
    buffer_load_dwordx4 v[16:19], v1, s[24:27], s60 offen offset:3072
    buffer_load_dwordx4 v[20:23], v1, s[24:27], s60 offen offset:3328
    buffer_load_dwordx4 v[24:27], v1, s[24:27], s60 offen offset:3584
    s_add_u32 s60, s60, 6144
    v_add_f32_dpp v108, v107, v107 row_ror:8 row_mask:0xf bank_mask:0xc
    s_nop 1
    v_add_f32_dpp v109, v108, v108 row_shl:4 row_mask:0xf bank_mask:0x5
    s_waitcnt vmcnt(9)
    v_cvt_f32_i32 v28, v28
    v_cvt_f32_i32 v29, v29
    v_cvt_f32_i32 v30, v30
    v_cvt_f32_i32 v31, v31
    v_cvt_f32_i32 v32, v32
    v_cvt_f32_i32 v33, v33
    v_cvt_f32_i32 v34, v34
    v_cvt_f32_i32 v35, v35
    v_cvt_f32_i32 v36, v36
    v_cvt_f32_i32 v37, v37
    v_cvt_f32_i32 v38, v38
    v_cvt_f32_i32 v39, v39
    v_fma_f32 v107, v64, v28, -v100
    v_fmac_f32 v107, v65, v29
    v_fmac_f32 v107, v66, v30
    v_fmac_f32 v107, v67, v31
    v_fmac_f32 v107, v68, v32
    v_fmac_f32 v107, v69, v33
    v_fmac_f32 v107, v70, v34
    v_fmac_f32 v107, v71, v35
    v_fmac_f32 v107, v72, v36
    v_fmac_f32 v107, v73, v37
    v_fmac_f32 v107, v74, v38
    v_fmac_f32 v107, v75, v39
    buffer_load_dwordx4 v[28:31], v1, s[24:27], s60 offen offset:0
    buffer_load_dwordx4 v[32:35], v1, s[24:27], s60 offen offset:256
    buffer_load_dwordx4 v[36:39], v1, s[24:27], s60 offen offset:512
    v_add_f32_dpp v108, v107, v107 row_ror:8 row_mask:0xf bank_mask:0x3
    s_waitcnt vmcnt(9)
    v_cvt_f32_i32 v40, v40
    v_cvt_f32_i32 v41, v41
    v_cvt_f32_i32 v42, v42
    v_cvt_f32_i32 v43, v43
    v_cvt_f32_i32 v44, v44
    v_cvt_f32_i32 v45, v45
    v_cvt_f32_i32 v46, v46
    v_cvt_f32_i32 v47, v47
    v_cvt_f32_i32 v48, v48
    v_cvt_f32_i32 v49, v49
    v_cvt_f32_i32 v50, v50
    v_cvt_f32_i32 v51, v51
    v_fma_f32 v107, v64, v40, -v100
    v_fmac_f32 v107, v65, v41
    v_fmac_f32 v107, v66, v42
    v_fmac_f32 v107, v67, v43
    v_fmac_f32 v107, v68, v44
    v_fmac_f32 v107, v69, v45
    v_fmac_f32 v107, v70, v46
    v_fmac_f32 v107, v71, v47
    v_fmac_f32 v107, v72, v48
    v_fmac_f32 v107, v73, v49
    v_fmac_f32 v107, v74, v50
    v_fmac_f32 v107, v75, v51
    buffer_load_dwordx4 v[40:43], v1, s[24:27], s60 offen offset:3072
    buffer_load_dwordx4 v[44:47], v1, s[24:27], s60 offen offset:3328
    buffer_load_dwordx4 v[48:51], v1, s[24:27], s60 offen offset:3584
    s_add_u32 s60, s60, 6144
    v_add_f32_dpp v108, v107, v107 row_ror:8 row_mask:0xf bank_mask:0xc
    s_nop 1
    v_add_f32_dpp v109, v108, v108 row_shr:4 row_mask:0xf bank_mask:0xa
    s_nop 1
    v_add_f32_dpp v111, v109, v109 quad_perm:[2,3,0,1] row_mask:0xf bank_mask:0xf
    v_cndmask_b32 v111, v110, v111, s[66:67]
    s_nop 1
    v_add_f32_dpp v112, v111, v111 quad_perm:[1,0,3,2] row_mask:0xf bank_mask:0xf
    s_waitcnt vmcnt(9)
    v_cvt_f32_i32 v4, v4
    v_cvt_f32_i32 v5, v5
    v_cvt_f32_i32 v6, v6
    v_cvt_f32_i32 v7, v7
    v_cvt_f32_i32 v8, v8
    v_cvt_f32_i32 v9, v9
    v_cvt_f32_i32 v10, v10
    v_cvt_f32_i32 v11, v11
    v_cvt_f32_i32 v12, v12
    v_cvt_f32_i32 v13, v13
    v_cvt_f32_i32 v14, v14
    v_cvt_f32_i32 v15, v15
    v_fma_f32 v107, v64, v4, -v100
    v_fmac_f32 v107, v65, v5
    v_fmac_f32 v107, v66, v6
    v_fmac_f32 v107, v67, v7
    v_fmac_f32 v107, v68, v8
    v_fmac_f32 v107, v69, v9
    v_fmac_f32 v107, v70, v10
    v_fmac_f32 v107, v71, v11
    v_fmac_f32 v107, v72, v12
    v_fmac_f32 v107, v73, v13
    v_fmac_f32 v107, v74, v14
    v_fmac_f32 v107, v75, v15
    buffer_load_dwordx4 v[4:7], v1, s[24:27], s60 offen offset:0
    buffer_load_dwordx4 v[8:11], v1, s[24:27], s60 offen offset:256
    buffer_load_dwordx4 v[12:15], v1, s[24:27], s60 offen offset:512
    v_add_f32_dpp v108, v107, v107 row_ror:8 row_mask:0xf bank_mask:0x3
    s_waitcnt vmcnt(9)
    v_cvt_f32_i32 v16, v16
    v_cvt_f32_i32 v17, v17
    v_cvt_f32_i32 v18, v18
    v_cvt_f32_i32 v19, v19
    v_cvt_f32_i32 v20, v20
    v_cvt_f32_i32 v21, v21
    v_cvt_f32_i32 v22, v22
    v_cvt_f32_i32 v23, v23
    v_cvt_f32_i32 v24, v24
    v_cvt_f32_i32 v25, v25
    v_cvt_f32_i32 v26, v26
    v_cvt_f32_i32 v27, v27
    v_fma_f32 v107, v64, v16, -v100
    v_fmac_f32 v107, v65, v17
    v_fmac_f32 v107, v66, v18
    v_fmac_f32 v107, v67, v19
    v_fmac_f32 v107, v68, v20
    v_fmac_f32 v107, v69, v21
    v_fmac_f32 v107, v70, v22
    v_fmac_f32 v107, v71, v23
    v_fmac_f32 v107, v72, v24
    v_fmac_f32 v107, v73, v25
    v_fmac_f32 v107, v74, v26
    v_fmac_f32 v107, v75, v27
    buffer_load_dwordx4 v[16:19], v1, s[24:27], s60 offen offset:3072
    buffer_load_dwordx4 v[20:23], v1, s[24:27], s60 offen offset:3328
    buffer_load_dwordx4 v[24:27], v1, s[24:27], s60 offen offset:3584
    s_add_u32 s60, s60, 6144
    v_add_f32_dpp v108, v107, v107 row_ror:8 row_mask:0xf bank_mask:0xc
    s_nop 1
    v_add_f32_dpp v109, v108, v108 row_shl:4 row_mask:0xf bank_mask:0x5
    s_waitcnt vmcnt(9)
    v_cvt_f32_i32 v28, v28
    v_cvt_f32_i32 v29, v29
    v_cvt_f32_i32 v30, v30
    v_cvt_f32_i32 v31, v31
    v_cvt_f32_i32 v32, v32
    v_cvt_f32_i32 v33, v33
    v_cvt_f32_i32 v34, v34
    v_cvt_f32_i32 v35, v35
    v_cvt_f32_i32 v36, v36
    v_cvt_f32_i32 v37, v37
    v_cvt_f32_i32 v38, v38
    v_cvt_f32_i32 v39, v39
    v_fma_f32 v107, v64, v28, -v100
    v_fmac_f32 v107, v65, v29
    v_fmac_f32 v107, v66, v30
    v_fmac_f32 v107, v67, v31
    v_fmac_f32 v107, v68, v32
    v_fmac_f32 v107, v69, v33
    v_fmac_f32 v107, v70, v34
    v_fmac_f32 v107, v71, v35
    v_fmac_f32 v107, v72, v36
    v_fmac_f32 v107, v73, v37
    v_fmac_f32 v107, v74, v38
    v_fmac_f32 v107, v75, v39
    buffer_load_dwordx4 v[28:31], v1, s[24:27], s60 offen offset:0
    buffer_load_dwordx4 v[32:35], v1, s[24:27], s60 offen offset:256
    buffer_load_dwordx4 v[36:39], v1, s[24:27], s60 offen offset:512
    v_add_f32_dpp v108, v107, v107 row_ror:8 row_mask:0xf bank_mask:0x3
    s_waitcnt vmcnt(9)
    v_cvt_f32_i32 v40, v40
    v_cvt_f32_i32 v41, v41
    v_cvt_f32_i32 v42, v42
    v_cvt_f32_i32 v43, v43
    v_cvt_f32_i32 v44, v44
    v_cvt_f32_i32 v45, v45
    v_cvt_f32_i32 v46, v46
    v_cvt_f32_i32 v47, v47
    v_cvt_f32_i32 v48, v48
    v_cvt_f32_i32 v49, v49
    v_cvt_f32_i32 v50, v50
    v_cvt_f32_i32 v51, v51
    v_fma_f32 v107, v64, v40, -v100
    v_fmac_f32 v107, v65, v41
    v_fmac_f32 v107, v66, v42
    v_fmac_f32 v107, v67, v43
    v_fmac_f32 v107, v68, v44
    v_fmac_f32 v107, v69, v45
    v_fmac_f32 v107, v70, v46
    v_fmac_f32 v107, v71, v47
    v_fmac_f32 v107, v72, v48
    v_fmac_f32 v107, v73, v49
    v_fmac_f32 v107, v74, v50
    v_fmac_f32 v107, v75, v51
    buffer_load_dwordx4 v[40:43], v1, s[24:27], s60 offen offset:3072
    buffer_load_dwordx4 v[44:47], v1, s[24:27], s60 offen offset:3328
    buffer_load_dwordx4 v[48:51], v1, s[24:27], s60 offen offset:3584
    s_add_u32 s60, s60, 6144
    v_add_f32_dpp v108, v107, v107 row_ror:8 row_mask:0xf bank_mask:0xc
    s_nop 1
    v_add_f32_dpp v109, v108, v108 row_shr:4 row_mask:0xf bank_mask:0xa
    s_nop 1
    v_add_f32_dpp v110, v109, v109 quad_perm:[2,3,0,1] row_mask:0xf bank_mask:0xf
    s_waitcnt vmcnt(9)
    v_cvt_f32_i32 v4, v4
    v_cvt_f32_i32 v5, v5
    v_cvt_f32_i32 v6, v6
    v_cvt_f32_i32 v7, v7
    v_cvt_f32_i32 v8, v8
    v_cvt_f32_i32 v9, v9
    v_cvt_f32_i32 v10, v10
    v_cvt_f32_i32 v11, v11
    v_cvt_f32_i32 v12, v12
    v_cvt_f32_i32 v13, v13
    v_cvt_f32_i32 v14, v14
    v_cvt_f32_i32 v15, v15
    v_fma_f32 v107, v64, v4, -v100
    v_fmac_f32 v107, v65, v5
    v_fmac_f32 v107, v66, v6
    v_fmac_f32 v107, v67, v7
    v_fmac_f32 v107, v68, v8
    v_fmac_f32 v107, v69, v9
    v_fmac_f32 v107, v70, v10
    v_fmac_f32 v107, v71, v11
    v_fmac_f32 v107, v72, v12
    v_fmac_f32 v107, v73, v13
    v_fmac_f32 v107, v74, v14
    v_fmac_f32 v107, v75, v15
    buffer_load_ushort v104, v3, s[40:43], s63 offen
    buffer_load_ushort v105, v3, s[44:47], s63 offen
    s_add_u32 s63, s63, 128
    buffer_load_dwordx4 v[4:7], v1, s[28:31], s61 offen offset:0
    buffer_load_dwordx4 v[8:11], v1, s[28:31], s61 offen offset:256
    buffer_load_dwordx4 v[12:15], v1, s[28:31], s61 offen offset:512
    v_add_f32_dpp v108, v107, v107 row_ror:8 row_mask:0xf bank_mask:0x3
    s_waitcnt vmcnt(11)
    v_cvt_f32_i32 v16, v16
    v_cvt_f32_i32 v17, v17
    v_cvt_f32_i32 v18, v18
    v_cvt_f32_i32 v19, v19
    v_cvt_f32_i32 v20, v20
    v_cvt_f32_i32 v21, v21
    v_cvt_f32_i32 v22, v22
    v_cvt_f32_i32 v23, v23
    v_cvt_f32_i32 v24, v24
    v_cvt_f32_i32 v25, v25
    v_cvt_f32_i32 v26, v26
    v_cvt_f32_i32 v27, v27
    v_fma_f32 v107, v64, v16, -v100
    v_fmac_f32 v107, v65, v17
    v_fmac_f32 v107, v66, v18
    v_fmac_f32 v107, v67, v19
    v_fmac_f32 v107, v68, v20
    v_fmac_f32 v107, v69, v21
    v_fmac_f32 v107, v70, v22
    v_fmac_f32 v107, v71, v23
    v_fmac_f32 v107, v72, v24
    v_fmac_f32 v107, v73, v25
    v_fmac_f32 v107, v74, v26
    v_fmac_f32 v107, v75, v27
    buffer_load_dwordx4 v[16:19], v1, s[28:31], s61 offen offset:3072
    buffer_load_dwordx4 v[20:23], v1, s[28:31], s61 offen offset:3328
    buffer_load_dwordx4 v[24:27], v1, s[28:31], s61 offen offset:3584
    s_add_u32 s61, s61, 6144
    v_add_f32_dpp v108, v107, v107 row_ror:8 row_mask:0xf bank_mask:0xc
    s_nop 1
    v_add_f32_dpp v109, v108, v108 row_shl:4 row_mask:0xf bank_mask:0x5
    s_waitcnt vmcnt(11)
    v_cvt_f32_i32 v28, v28
    v_cvt_f32_i32 v29, v29
    v_cvt_f32_i32 v30, v30
    v_cvt_f32_i32 v31, v31
    v_cvt_f32_i32 v32, v32
    v_cvt_f32_i32 v33, v33
    v_cvt_f32_i32 v34, v34
    v_cvt_f32_i32 v35, v35
    v_cvt_f32_i32 v36, v36
    v_cvt_f32_i32 v37, v37
    v_cvt_f32_i32 v38, v38
    v_cvt_f32_i32 v39, v39
    v_fma_f32 v107, v64, v28, -v100
    v_fmac_f32 v107, v65, v29
    v_fmac_f32 v107, v66, v30
    v_fmac_f32 v107, v67, v31
    v_fmac_f32 v107, v68, v32
    v_fmac_f32 v107, v69, v33
    v_fmac_f32 v107, v70, v34
    v_fmac_f32 v107, v71, v35
    v_fmac_f32 v107, v72, v36
    v_fmac_f32 v107, v73, v37
    v_fmac_f32 v107, v74, v38
    v_fmac_f32 v107, v75, v39
    buffer_load_dwordx4 v[28:31], v1, s[28:31], s61 offen offset:0
    buffer_load_dwordx4 v[32:35], v1, s[28:31], s61 offen offset:256
    buffer_load_dwordx4 v[36:39], v1, s[28:31], s61 offen offset:512
    v_add_f32_dpp v108, v107, v107 row_ror:8 row_mask:0xf bank_mask:0x3
    s_waitcnt vmcnt(11)
    v_cvt_f32_i32 v40, v40
    v_cvt_f32_i32 v41, v41
    v_cvt_f32_i32 v42, v42
    v_cvt_f32_i32 v43, v43
    v_cvt_f32_i32 v44, v44
    v_cvt_f32_i32 v45, v45
    v_cvt_f32_i32 v46, v46
    v_cvt_f32_i32 v47, v47
    v_cvt_f32_i32 v48, v48
    v_cvt_f32_i32 v49, v49
    v_cvt_f32_i32 v50, v50
    v_cvt_f32_i32 v51, v51
    v_fma_f32 v107, v64, v40, -v100
    v_fmac_f32 v107, v65, v41
    v_fmac_f32 v107, v66, v42
    v_fmac_f32 v107, v67, v43
    v_fmac_f32 v107, v68, v44
    v_fmac_f32 v107, v69, v45
    v_fmac_f32 v107, v70, v46
    v_fmac_f32 v107, v71, v47
    v_fmac_f32 v107, v72, v48
    v_fmac_f32 v107, v73, v49
    v_fmac_f32 v107, v74, v50
    v_fmac_f32 v107, v75, v51
    buffer_load_dwordx4 v[40:43], v1, s[28:31], s61 offen offset:3072
    buffer_load_dwordx4 v[44:47], v1, s[28:31], s61 offen offset:3328
    buffer_load_dwordx4 v[48:51], v1, s[28:31], s61 offen offset:3584
    s_add_u32 s61, s61, 6144
    v_add_f32_dpp v108, v107, v107 row_ror:8 row_mask:0xf bank_mask:0xc
    s_nop 1
    v_add_f32_dpp v109, v108, v108 row_shr:4 row_mask:0xf bank_mask:0xa
    s_nop 1
    v_add_f32_dpp v111, v109, v109 quad_perm:[2,3,0,1] row_mask:0xf bank_mask:0xf
    v_cndmask_b32 v111, v110, v111, s[66:67]
    s_nop 1
    v_add_f32_dpp v110, v111, v111 quad_perm:[1,0,3,2] row_mask:0xf bank_mask:0xf
    v_cndmask_b32 v112, v112, v110, s[68:69]
    s_nop 1
    s_waitcnt vmcnt(9)
    v_max_f32_dpp v113, v112, v112 row_ror:8 row_mask:0xf bank_mask:0xf
    v_lshlrev_b32 v104, 16, v104
    v_lshlrev_b32 v105, 16, v105
    v_max_f32_dpp v113, v113, v113 row_ror:4 row_mask:0xf bank_mask:0xf
    s_nop 1
    v_max_f32_dpp v113, v113, v113 row_ror:2 row_mask:0xf bank_mask:0xf
    s_nop 1
    v_max_f32_dpp v113, v113, v113 row_ror:1 row_mask:0xf bank_mask:0xf
    v_max_f32 v113, v113, v101
    v_sub_f32 v114, v101, v113
    v_sub_f32 v106, v112, v113
    v_exp_f32 v114, v114
    v_exp_f32 v106, v106
    v_mov_b32 v101, v113
    v_fma_f32 v102, v102, v114, v106
    v_mul_f32 v106, v106, v104
    v_mul_f32 v103, v103, v114
    v_fmac_f32 v103, v106, v105
    v_mul_f32 v88, v88, v114
    v_mul_f32 v89, v89, v114
    v_mul_f32 v90, v90, v114
    v_mul_f32 v91, v91, v114
    v_mul_f32 v92, v92, v114
    v_mul_f32 v93, v93, v114
    v_mul_f32 v94, v94, v114
    v_mul_f32 v95, v95, v114
    v_mul_f32 v96, v96, v114
    v_mul_f32 v97, v97, v114
    v_mul_f32 v98, v98, v114
    v_mul_f32 v99, v99, v114
    v_cvt_f32_i32 v4, v4
    v_cvt_f32_i32 v5, v5
    v_cvt_f32_i32 v6, v6
    v_cvt_f32_i32 v7, v7
    v_cvt_f32_i32 v8, v8
    v_cvt_f32_i32 v9, v9
    v_cvt_f32_i32 v10, v10
    v_cvt_f32_i32 v11, v11
    v_cvt_f32_i32 v12, v12
    v_cvt_f32_i32 v13, v13
    v_cvt_f32_i32 v14, v14
    v_cvt_f32_i32 v15, v15
    v_fmac_f32_dpp v88, v106, v4 row_newbcast:0 row_mask:0xf bank_mask:0xf
    v_fmac_f32_dpp v89, v106, v5 row_newbcast:0 row_mask:0xf bank_mask:0xf
    v_fmac_f32_dpp v90, v106, v6 row_newbcast:0 row_mask:0xf bank_mask:0xf
    v_fmac_f32_dpp v91, v106, v7 row_newbcast:0 row_mask:0xf bank_mask:0xf
    v_fmac_f32_dpp v92, v106, v8 row_newbcast:0 row_mask:0xf bank_mask:0xf
    v_fmac_f32_dpp v93, v106, v9 row_newbcast:0 row_mask:0xf bank_mask:0xf
    v_fmac_f32_dpp v94, v106, v10 row_newbcast:0 row_mask:0xf bank_mask:0xf
    v_fmac_f32_dpp v95, v106, v11 row_newbcast:0 row_mask:0xf bank_mask:0xf
    v_fmac_f32_dpp v96, v106, v12 row_newbcast:0 row_mask:0xf bank_mask:0xf
    v_fmac_f32_dpp v97, v106, v13 row_newbcast:0 row_mask:0xf bank_mask:0xf
    v_fmac_f32_dpp v98, v106, v14 row_newbcast:0 row_mask:0xf bank_mask:0xf
    v_fmac_f32_dpp v99, v106, v15 row_newbcast:0 row_mask:0xf bank_mask:0xf
    buffer_load_dwordx4 v[4:7], v1, s[28:31], s61 offen offset:0
    buffer_load_dwordx4 v[8:11], v1, s[28:31], s61 offen offset:256
    buffer_load_dwordx4 v[12:15], v1, s[28:31], s61 offen offset:512
    s_waitcnt vmcnt(9)
    v_cvt_f32_i32 v16, v16
    v_cvt_f32_i32 v17, v17
    v_cvt_f32_i32 v18, v18
    v_cvt_f32_i32 v19, v19
    v_cvt_f32_i32 v20, v20
    v_cvt_f32_i32 v21, v21
    v_cvt_f32_i32 v22, v22
    v_cvt_f32_i32 v23, v23
    v_cvt_f32_i32 v24, v24
    v_cvt_f32_i32 v25, v25
    v_cvt_f32_i32 v26, v26
    v_cvt_f32_i32 v27, v27
    v_fmac_f32_dpp v88, v106, v16 row_newbcast:8 row_mask:0xf bank_mask:0xf
    v_fmac_f32_dpp v89, v106, v17 row_newbcast:8 row_mask:0xf bank_mask:0xf
    v_fmac_f32_dpp v90, v106, v18 row_newbcast:8 row_mask:0xf bank_mask:0xf
    v_fmac_f32_dpp v91, v106, v19 row_newbcast:8 row_mask:0xf bank_mask:0xf
    v_fmac_f32_dpp v92, v106, v20 row_newbcast:8 row_mask:0xf bank_mask:0xf
    v_fmac_f32_dpp v93, v106, v21 row_newbcast:8 row_mask:0xf bank_mask:0xf
    v_fmac_f32_dpp v94, v106, v22 row_newbcast:8 row_mask:0xf bank_mask:0xf
    v_fmac_f32_dpp v95, v106, v23 row_newbcast:8 row_mask:0xf bank_mask:0xf
    v_fmac_f32_dpp v96, v106, v24 row_newbcast:8 row_mask:0xf bank_mask:0xf
    v_fmac_f32_dpp v97, v106, v25 row_newbcast:8 row_mask:0xf bank_mask:0xf
    v_fmac_f32_dpp v98, v106, v26 row_newbcast:8 row_mask:0xf bank_mask:0xf
    v_fmac_f32_dpp v99, v106, v27 row_newbcast:8 row_mask:0xf bank_mask:0xf
    buffer_load_dwordx4 v[16:19], v1, s[28:31], s61 offen offset:3072
    buffer_load_dwordx4 v[20:23], v1, s[28:31], s61 offen offset:3328
    buffer_load_dwordx4 v[24:27], v1, s[28:31], s61 offen offset:3584
    s_add_u32 s61, s61, 6144
    s_waitcnt vmcnt(9)
    v_cvt_f32_i32 v28, v28
    v_cvt_f32_i32 v29, v29
    v_cvt_f32_i32 v30, v30
    v_cvt_f32_i32 v31, v31
    v_cvt_f32_i32 v32, v32
    v_cvt_f32_i32 v33, v33
    v_cvt_f32_i32 v34, v34
    v_cvt_f32_i32 v35, v35
    v_cvt_f32_i32 v36, v36
    v_cvt_f32_i32 v37, v37
    v_cvt_f32_i32 v38, v38
    v_cvt_f32_i32 v39, v39
    v_fmac_f32_dpp v88, v106, v28 row_newbcast:4 row_mask:0xf bank_mask:0xf
    v_fmac_f32_dpp v89, v106, v29 row_newbcast:4 row_mask:0xf bank_mask:0xf
    v_fmac_f32_dpp v90, v106, v30 row_newbcast:4 row_mask:0xf bank_mask:0xf
    v_fmac_f32_dpp v91, v106, v31 row_newbcast:4 row_mask:0xf bank_mask:0xf
    v_fmac_f32_dpp v92, v106, v32 row_newbcast:4 row_mask:0xf bank_mask:0xf
    v_fmac_f32_dpp v93, v106, v33 row_newbcast:4 row_mask:0xf bank_mask:0xf
    v_fmac_f32_dpp v94, v106, v34 row_newbcast:4 row_mask:0xf bank_mask:0xf
    v_fmac_f32_dpp v95, v106, v35 row_newbcast:4 row_mask:0xf bank_mask:0xf
    v_fmac_f32_dpp v96, v106, v36 row_newbcast:4 row_mask:0xf bank_mask:0xf
    v_fmac_f32_dpp v97, v106, v37 row_newbcast:4 row_mask:0xf bank_mask:0xf
    v_fmac_f32_dpp v98, v106, v38 row_newbcast:4 row_mask:0xf bank_mask:0xf
    v_fmac_f32_dpp v99, v106, v39 row_newbcast:4 row_mask:0xf bank_mask:0xf
    buffer_load_dwordx4 v[28:31], v1, s[28:31], s61 offen offset:0
    buffer_load_dwordx4 v[32:35], v1, s[28:31], s61 offen offset:256
    buffer_load_dwordx4 v[36:39], v1, s[28:31], s61 offen offset:512
    s_waitcnt vmcnt(9)
    v_cvt_f32_i32 v40, v40
    v_cvt_f32_i32 v41, v41
    v_cvt_f32_i32 v42, v42
    v_cvt_f32_i32 v43, v43
    v_cvt_f32_i32 v44, v44
    v_cvt_f32_i32 v45, v45
    v_cvt_f32_i32 v46, v46
    v_cvt_f32_i32 v47, v47
    v_cvt_f32_i32 v48, v48
    v_cvt_f32_i32 v49, v49
    v_cvt_f32_i32 v50, v50
    v_cvt_f32_i32 v51, v51
    v_fmac_f32_dpp v88, v106, v40 row_newbcast:12 row_mask:0xf bank_mask:0xf
    v_fmac_f32_dpp v89, v106, v41 row_newbcast:12 row_mask:0xf bank_mask:0xf
    v_fmac_f32_dpp v90, v106, v42 row_newbcast:12 row_mask:0xf bank_mask:0xf
    v_fmac_f32_dpp v91, v106, v43 row_newbcast:12 row_mask:0xf bank_mask:0xf
    v_fmac_f32_dpp v92, v106, v44 row_newbcast:12 row_mask:0xf bank_mask:0xf
    v_fmac_f32_dpp v93, v106, v45 row_newbcast:12 row_mask:0xf bank_mask:0xf
    v_fmac_f32_dpp v94, v106, v46 row_newbcast:12 row_mask:0xf bank_mask:0xf
    v_fmac_f32_dpp v95, v106, v47 row_newbcast:12 row_mask:0xf bank_mask:0xf
    v_fmac_f32_dpp v96, v106, v48 row_newbcast:12 row_mask:0xf bank_mask:0xf
    v_fmac_f32_dpp v97, v106, v49 row_newbcast:12 row_mask:0xf bank_mask:0xf
    v_fmac_f32_dpp v98, v106, v50 row_newbcast:12 row_mask:0xf bank_mask:0xf
    v_fmac_f32_dpp v99, v106, v51 row_newbcast:12 row_mask:0xf bank_mask:0xf
    buffer_load_dwordx4 v[40:43], v1, s[28:31], s61 offen offset:3072
    buffer_load_dwordx4 v[44:47], v1, s[28:31], s61 offen offset:3328
    buffer_load_dwordx4 v[48:51], v1, s[28:31], s61 offen offset:3584
    s_add_u32 s61, s61, 6144
    s_waitcnt vmcnt(9)
    v_cvt_f32_i32 v4, v4
    v_cvt_f32_i32 v5, v5
    v_cvt_f32_i32 v6, v6
    v_cvt_f32_i32 v7, v7
    v_cvt_f32_i32 v8, v8
    v_cvt_f32_i32 v9, v9
    v_cvt_f32_i32 v10, v10
    v_cvt_f32_i32 v11, v11
    v_cvt_f32_i32 v12, v12
    v_cvt_f32_i32 v13, v13
    v_cvt_f32_i32 v14, v14
    v_cvt_f32_i32 v15, v15
    v_fmac_f32_dpp v88, v106, v4 row_newbcast:2 row_mask:0xf bank_mask:0xf
    v_fmac_f32_dpp v89, v106, v5 row_newbcast:2 row_mask:0xf bank_mask:0xf
    v_fmac_f32_dpp v90, v106, v6 row_newbcast:2 row_mask:0xf bank_mask:0xf
    v_fmac_f32_dpp v91, v106, v7 row_newbcast:2 row_mask:0xf bank_mask:0xf
    v_fmac_f32_dpp v92, v106, v8 row_newbcast:2 row_mask:0xf bank_mask:0xf
    v_fmac_f32_dpp v93, v106, v9 row_newbcast:2 row_mask:0xf bank_mask:0xf
    v_fmac_f32_dpp v94, v106, v10 row_newbcast:2 row_mask:0xf bank_mask:0xf
    v_fmac_f32_dpp v95, v106, v11 row_newbcast:2 row_mask:0xf bank_mask:0xf
    v_fmac_f32_dpp v96, v106, v12 row_newbcast:2 row_mask:0xf bank_mask:0xf
    v_fmac_f32_dpp v97, v106, v13 row_newbcast:2 row_mask:0xf bank_mask:0xf
    v_fmac_f32_dpp v98, v106, v14 row_newbcast:2 row_mask:0xf bank_mask:0xf
    v_fmac_f32_dpp v99, v106, v15 row_newbcast:2 row_mask:0xf bank_mask:0xf
    buffer_load_dwordx4 v[4:7], v1, s[28:31], s61 offen offset:0
    buffer_load_dwordx4 v[8:11], v1, s[28:31], s61 offen offset:256
    buffer_load_dwordx4 v[12:15], v1, s[28:31], s61 offen offset:512
    s_waitcnt vmcnt(9)
    v_cvt_f32_i32 v16, v16
    v_cvt_f32_i32 v17, v17
    v_cvt_f32_i32 v18, v18
    v_cvt_f32_i32 v19, v19
    v_cvt_f32_i32 v20, v20
    v_cvt_f32_i32 v21, v21
    v_cvt_f32_i32 v22, v22
    v_cvt_f32_i32 v23, v23
    v_cvt_f32_i32 v24, v24
    v_cvt_f32_i32 v25, v25
    v_cvt_f32_i32 v26, v26
    v_cvt_f32_i32 v27, v27
    v_fmac_f32_dpp v88, v106, v16 row_newbcast:10 row_mask:0xf bank_mask:0xf
    v_fmac_f32_dpp v89, v106, v17 row_newbcast:10 row_mask:0xf bank_mask:0xf
    v_fmac_f32_dpp v90, v106, v18 row_newbcast:10 row_mask:0xf bank_mask:0xf
    v_fmac_f32_dpp v91, v106, v19 row_newbcast:10 row_mask:0xf bank_mask:0xf
    v_fmac_f32_dpp v92, v106, v20 row_newbcast:10 row_mask:0xf bank_mask:0xf
    v_fmac_f32_dpp v93, v106, v21 row_newbcast:10 row_mask:0xf bank_mask:0xf
    v_fmac_f32_dpp v94, v106, v22 row_newbcast:10 row_mask:0xf bank_mask:0xf
    v_fmac_f32_dpp v95, v106, v23 row_newbcast:10 row_mask:0xf bank_mask:0xf
    v_fmac_f32_dpp v96, v106, v24 row_newbcast:10 row_mask:0xf bank_mask:0xf
    v_fmac_f32_dpp v97, v106, v25 row_newbcast:10 row_mask:0xf bank_mask:0xf
    v_fmac_f32_dpp v98, v106, v26 row_newbcast:10 row_mask:0xf bank_mask:0xf
    v_fmac_f32_dpp v99, v106, v27 row_newbcast:10 row_mask:0xf bank_mask:0xf
    buffer_load_dwordx4 v[16:19], v1, s[28:31], s61 offen offset:3072
    buffer_load_dwordx4 v[20:23], v1, s[28:31], s61 offen offset:3328
    buffer_load_dwordx4 v[24:27], v1, s[28:31], s61 offen offset:3584
    s_add_u32 s61, s61, 6144
    s_waitcnt vmcnt(9)
    v_cvt_f32_i32 v28, v28
    v_cvt_f32_i32 v29, v29
    v_cvt_f32_i32 v30, v30
    v_cvt_f32_i32 v31, v31
    v_cvt_f32_i32 v32, v32
    v_cvt_f32_i32 v33, v33
    v_cvt_f32_i32 v34, v34
    v_cvt_f32_i32 v35, v35
    v_cvt_f32_i32 v36, v36
    v_cvt_f32_i32 v37, v37
    v_cvt_f32_i32 v38, v38
    v_cvt_f32_i32 v39, v39
    v_fmac_f32_dpp v88, v106, v28 row_newbcast:6 row_mask:0xf bank_mask:0xf
    v_fmac_f32_dpp v89, v106, v29 row_newbcast:6 row_mask:0xf bank_mask:0xf
    v_fmac_f32_dpp v90, v106, v30 row_newbcast:6 row_mask:0xf bank_mask:0xf
    v_fmac_f32_dpp v91, v106, v31 row_newbcast:6 row_mask:0xf bank_mask:0xf
    v_fmac_f32_dpp v92, v106, v32 row_newbcast:6 row_mask:0xf bank_mask:0xf
    v_fmac_f32_dpp v93, v106, v33 row_newbcast:6 row_mask:0xf bank_mask:0xf
    v_fmac_f32_dpp v94, v106, v34 row_newbcast:6 row_mask:0xf bank_mask:0xf
    v_fmac_f32_dpp v95, v106, v35 row_newbcast:6 row_mask:0xf bank_mask:0xf
    v_fmac_f32_dpp v96, v106, v36 row_newbcast:6 row_mask:0xf bank_mask:0xf
    v_fmac_f32_dpp v97, v106, v37 row_newbcast:6 row_mask:0xf bank_mask:0xf
    v_fmac_f32_dpp v98, v106, v38 row_newbcast:6 row_mask:0xf bank_mask:0xf
    v_fmac_f32_dpp v99, v106, v39 row_newbcast:6 row_mask:0xf bank_mask:0xf
    buffer_load_dwordx4 v[28:31], v1, s[28:31], s61 offen offset:0
    buffer_load_dwordx4 v[32:35], v1, s[28:31], s61 offen offset:256
    buffer_load_dwordx4 v[36:39], v1, s[28:31], s61 offen offset:512
    s_waitcnt vmcnt(9)
    v_cvt_f32_i32 v40, v40
    v_cvt_f32_i32 v41, v41
    v_cvt_f32_i32 v42, v42
    v_cvt_f32_i32 v43, v43
    v_cvt_f32_i32 v44, v44
    v_cvt_f32_i32 v45, v45
    v_cvt_f32_i32 v46, v46
    v_cvt_f32_i32 v47, v47
    v_cvt_f32_i32 v48, v48
    v_cvt_f32_i32 v49, v49
    v_cvt_f32_i32 v50, v50
    v_cvt_f32_i32 v51, v51
    v_fmac_f32_dpp v88, v106, v40 row_newbcast:14 row_mask:0xf bank_mask:0xf
    v_fmac_f32_dpp v89, v106, v41 row_newbcast:14 row_mask:0xf bank_mask:0xf
    v_fmac_f32_dpp v90, v106, v42 row_newbcast:14 row_mask:0xf bank_mask:0xf
    v_fmac_f32_dpp v91, v106, v43 row_newbcast:14 row_mask:0xf bank_mask:0xf
    v_fmac_f32_dpp v92, v106, v44 row_newbcast:14 row_mask:0xf bank_mask:0xf
    v_fmac_f32_dpp v93, v106, v45 row_newbcast:14 row_mask:0xf bank_mask:0xf
    v_fmac_f32_dpp v94, v106, v46 row_newbcast:14 row_mask:0xf bank_mask:0xf
    v_fmac_f32_dpp v95, v106, v47 row_newbcast:14 row_mask:0xf bank_mask:0xf
    v_fmac_f32_dpp v96, v106, v48 row_newbcast:14 row_mask:0xf bank_mask:0xf
    v_fmac_f32_dpp v97, v106, v49 row_newbcast:14 row_mask:0xf bank_mask:0xf
    v_fmac_f32_dpp v98, v106, v50 row_newbcast:14 row_mask:0xf bank_mask:0xf
    v_fmac_f32_dpp v99, v106, v51 row_newbcast:14 row_mask:0xf bank_mask:0xf
    buffer_load_dwordx4 v[40:43], v1, s[28:31], s61 offen offset:3072
    buffer_load_dwordx4 v[44:47], v1, s[28:31], s61 offen offset:3328
    buffer_load_dwordx4 v[48:51], v1, s[28:31], s61 offen offset:3584
    s_add_u32 s61, s61, 6144
    s_waitcnt vmcnt(9)
    v_cvt_f32_i32 v4, v4
    v_cvt_f32_i32 v5, v5
    v_cvt_f32_i32 v6, v6
    v_cvt_f32_i32 v7, v7
    v_cvt_f32_i32 v8, v8
    v_cvt_f32_i32 v9, v9
    v_cvt_f32_i32 v10, v10
    v_cvt_f32_i32 v11, v11
    v_cvt_f32_i32 v12, v12
    v_cvt_f32_i32 v13, v13
    v_cvt_f32_i32 v14, v14
    v_cvt_f32_i32 v15, v15
    v_fmac_f32_dpp v88, v106, v4 row_newbcast:1 row_mask:0xf bank_mask:0xf
    v_fmac_f32_dpp v89, v106, v5 row_newbcast:1 row_mask:0xf bank_mask:0xf
    v_fmac_f32_dpp v90, v106, v6 row_newbcast:1 row_mask:0xf bank_mask:0xf
    v_fmac_f32_dpp v91, v106, v7 row_newbcast:1 row_mask:0xf bank_mask:0xf
    v_fmac_f32_dpp v92, v106, v8 row_newbcast:1 row_mask:0xf bank_mask:0xf
    v_fmac_f32_dpp v93, v106, v9 row_newbcast:1 row_mask:0xf bank_mask:0xf
    v_fmac_f32_dpp v94, v106, v10 row_newbcast:1 row_mask:0xf bank_mask:0xf
    v_fmac_f32_dpp v95, v106, v11 row_newbcast:1 row_mask:0xf bank_mask:0xf
    v_fmac_f32_dpp v96, v106, v12 row_newbcast:1 row_mask:0xf bank_mask:0xf
    v_fmac_f32_dpp v97, v106, v13 row_newbcast:1 row_mask:0xf bank_mask:0xf
    v_fmac_f32_dpp v98, v106, v14 row_newbcast:1 row_mask:0xf bank_mask:0xf
    v_fmac_f32_dpp v99, v106, v15 row_newbcast:1 row_mask:0xf bank_mask:0xf
    buffer_load_dwordx4 v[4:7], v1, s[28:31], s61 offen offset:0
    buffer_load_dwordx4 v[8:11], v1, s[28:31], s61 offen offset:256
    buffer_load_dwordx4 v[12:15], v1, s[28:31], s61 offen offset:512
    s_waitcnt vmcnt(9)
    v_cvt_f32_i32 v16, v16
    v_cvt_f32_i32 v17, v17
    v_cvt_f32_i32 v18, v18
    v_cvt_f32_i32 v19, v19
    v_cvt_f32_i32 v20, v20
    v_cvt_f32_i32 v21, v21
    v_cvt_f32_i32 v22, v22
    v_cvt_f32_i32 v23, v23
    v_cvt_f32_i32 v24, v24
    v_cvt_f32_i32 v25, v25
    v_cvt_f32_i32 v26, v26
    v_cvt_f32_i32 v27, v27
    v_fmac_f32_dpp v88, v106, v16 row_newbcast:9 row_mask:0xf bank_mask:0xf
    v_fmac_f32_dpp v89, v106, v17 row_newbcast:9 row_mask:0xf bank_mask:0xf
    v_fmac_f32_dpp v90, v106, v18 row_newbcast:9 row_mask:0xf bank_mask:0xf
    v_fmac_f32_dpp v91, v106, v19 row_newbcast:9 row_mask:0xf bank_mask:0xf
    v_fmac_f32_dpp v92, v106, v20 row_newbcast:9 row_mask:0xf bank_mask:0xf
    v_fmac_f32_dpp v93, v106, v21 row_newbcast:9 row_mask:0xf bank_mask:0xf
    v_fmac_f32_dpp v94, v106, v22 row_newbcast:9 row_mask:0xf bank_mask:0xf
    v_fmac_f32_dpp v95, v106, v23 row_newbcast:9 row_mask:0xf bank_mask:0xf
    v_fmac_f32_dpp v96, v106, v24 row_newbcast:9 row_mask:0xf bank_mask:0xf
    v_fmac_f32_dpp v97, v106, v25 row_newbcast:9 row_mask:0xf bank_mask:0xf
    v_fmac_f32_dpp v98, v106, v26 row_newbcast:9 row_mask:0xf bank_mask:0xf
    v_fmac_f32_dpp v99, v106, v27 row_newbcast:9 row_mask:0xf bank_mask:0xf
    buffer_load_dwordx4 v[16:19], v1, s[28:31], s61 offen offset:3072
    buffer_load_dwordx4 v[20:23], v1, s[28:31], s61 offen offset:3328
    buffer_load_dwordx4 v[24:27], v1, s[28:31], s61 offen offset:3584
    s_add_u32 s61, s61, 6144
    s_waitcnt vmcnt(9)
    v_cvt_f32_i32 v28, v28
    v_cvt_f32_i32 v29, v29
    v_cvt_f32_i32 v30, v30
    v_cvt_f32_i32 v31, v31
    v_cvt_f32_i32 v32, v32
    v_cvt_f32_i32 v33, v33
    v_cvt_f32_i32 v34, v34
    v_cvt_f32_i32 v35, v35
    v_cvt_f32_i32 v36, v36
    v_cvt_f32_i32 v37, v37
    v_cvt_f32_i32 v38, v38
    v_cvt_f32_i32 v39, v39
    v_fmac_f32_dpp v88, v106, v28 row_newbcast:5 row_mask:0xf bank_mask:0xf
    v_fmac_f32_dpp v89, v106, v29 row_newbcast:5 row_mask:0xf bank_mask:0xf
    v_fmac_f32_dpp v90, v106, v30 row_newbcast:5 row_mask:0xf bank_mask:0xf
    v_fmac_f32_dpp v91, v106, v31 row_newbcast:5 row_mask:0xf bank_mask:0xf
    v_fmac_f32_dpp v92, v106, v32 row_newbcast:5 row_mask:0xf bank_mask:0xf
    v_fmac_f32_dpp v93, v106, v33 row_newbcast:5 row_mask:0xf bank_mask:0xf
    v_fmac_f32_dpp v94, v106, v34 row_newbcast:5 row_mask:0xf bank_mask:0xf
    v_fmac_f32_dpp v95, v106, v35 row_newbcast:5 row_mask:0xf bank_mask:0xf
    v_fmac_f32_dpp v96, v106, v36 row_newbcast:5 row_mask:0xf bank_mask:0xf
    v_fmac_f32_dpp v97, v106, v37 row_newbcast:5 row_mask:0xf bank_mask:0xf
    v_fmac_f32_dpp v98, v106, v38 row_newbcast:5 row_mask:0xf bank_mask:0xf
    v_fmac_f32_dpp v99, v106, v39 row_newbcast:5 row_mask:0xf bank_mask:0xf
    buffer_load_dwordx4 v[28:31], v1, s[28:31], s61 offen offset:0
    buffer_load_dwordx4 v[32:35], v1, s[28:31], s61 offen offset:256
    buffer_load_dwordx4 v[36:39], v1, s[28:31], s61 offen offset:512
    s_waitcnt vmcnt(9)
    v_cvt_f32_i32 v40, v40
    v_cvt_f32_i32 v41, v41
    v_cvt_f32_i32 v42, v42
    v_cvt_f32_i32 v43, v43
    v_cvt_f32_i32 v44, v44
    v_cvt_f32_i32 v45, v45
    v_cvt_f32_i32 v46, v46
    v_cvt_f32_i32 v47, v47
    v_cvt_f32_i32 v48, v48
    v_cvt_f32_i32 v49, v49
    v_cvt_f32_i32 v50, v50
    v_cvt_f32_i32 v51, v51
    v_fmac_f32_dpp v88, v106, v40 row_newbcast:13 row_mask:0xf bank_mask:0xf
    v_fmac_f32_dpp v89, v106, v41 row_newbcast:13 row_mask:0xf bank_mask:0xf
    v_fmac_f32_dpp v90, v106, v42 row_newbcast:13 row_mask:0xf bank_mask:0xf
    v_fmac_f32_dpp v91, v106, v43 row_newbcast:13 row_mask:0xf bank_mask:0xf
    v_fmac_f32_dpp v92, v106, v44 row_newbcast:13 row_mask:0xf bank_mask:0xf
    v_fmac_f32_dpp v93, v106, v45 row_newbcast:13 row_mask:0xf bank_mask:0xf
    v_fmac_f32_dpp v94, v106, v46 row_newbcast:13 row_mask:0xf bank_mask:0xf
    v_fmac_f32_dpp v95, v106, v47 row_newbcast:13 row_mask:0xf bank_mask:0xf
    v_fmac_f32_dpp v96, v106, v48 row_newbcast:13 row_mask:0xf bank_mask:0xf
    v_fmac_f32_dpp v97, v106, v49 row_newbcast:13 row_mask:0xf bank_mask:0xf
    v_fmac_f32_dpp v98, v106, v50 row_newbcast:13 row_mask:0xf bank_mask:0xf
    v_fmac_f32_dpp v99, v106, v51 row_newbcast:13 row_mask:0xf bank_mask:0xf
    buffer_load_dwordx4 v[40:43], v1, s[28:31], s61 offen offset:3072
    buffer_load_dwordx4 v[44:47], v1, s[28:31], s61 offen offset:3328
    buffer_load_dwordx4 v[48:51], v1, s[28:31], s61 offen offset:3584
    s_add_u32 s61, s61, 6144
    s_waitcnt vmcnt(9)
    v_cvt_f32_i32 v4, v4
    v_cvt_f32_i32 v5, v5
    v_cvt_f32_i32 v6, v6
    v_cvt_f32_i32 v7, v7
    v_cvt_f32_i32 v8, v8
    v_cvt_f32_i32 v9, v9
    v_cvt_f32_i32 v10, v10
    v_cvt_f32_i32 v11, v11
    v_cvt_f32_i32 v12, v12
    v_cvt_f32_i32 v13, v13
    v_cvt_f32_i32 v14, v14
    v_cvt_f32_i32 v15, v15
    v_fmac_f32_dpp v88, v106, v4 row_newbcast:3 row_mask:0xf bank_mask:0xf
    v_fmac_f32_dpp v89, v106, v5 row_newbcast:3 row_mask:0xf bank_mask:0xf
    v_fmac_f32_dpp v90, v106, v6 row_newbcast:3 row_mask:0xf bank_mask:0xf
    v_fmac_f32_dpp v91, v106, v7 row_newbcast:3 row_mask:0xf bank_mask:0xf
    v_fmac_f32_dpp v92, v106, v8 row_newbcast:3 row_mask:0xf bank_mask:0xf
    v_fmac_f32_dpp v93, v106, v9 row_newbcast:3 row_mask:0xf bank_mask:0xf
    v_fmac_f32_dpp v94, v106, v10 row_newbcast:3 row_mask:0xf bank_mask:0xf
    v_fmac_f32_dpp v95, v106, v11 row_newbcast:3 row_mask:0xf bank_mask:0xf
    v_fmac_f32_dpp v96, v106, v12 row_newbcast:3 row_mask:0xf bank_mask:0xf
    v_fmac_f32_dpp v97, v106, v13 row_newbcast:3 row_mask:0xf bank_mask:0xf
    v_fmac_f32_dpp v98, v106, v14 row_newbcast:3 row_mask:0xf bank_mask:0xf
    v_fmac_f32_dpp v99, v106, v15 row_newbcast:3 row_mask:0xf bank_mask:0xf
    buffer_load_dwordx2 v[76:77], v2, s[32:35], s62 offen offset:0
    buffer_load_dwordx2 v[78:79], v2, s[32:35], s62 offen offset:128
    buffer_load_dwordx2 v[80:81], v2, s[32:35], s62 offen offset:256
    buffer_load_dwordx2 v[82:83], v2, s[36:39], s62 offen offset:0
    buffer_load_dwordx2 v[84:85], v2, s[36:39], s62 offen offset:128
    buffer_load_dwordx2 v[86:87], v2, s[36:39], s62 offen offset:256
    s_add_u32 s62, s62, 384
    buffer_load_dwordx4 v[4:7], v1, s[24:27], s60 offen offset:0
    buffer_load_dwordx4 v[8:11], v1, s[24:27], s60 offen offset:256
    buffer_load_dwordx4 v[12:15], v1, s[24:27], s60 offen offset:512
    s_waitcnt vmcnt(15)
    v_cvt_f32_i32 v16, v16
    v_cvt_f32_i32 v17, v17
    v_cvt_f32_i32 v18, v18
    v_cvt_f32_i32 v19, v19
    v_cvt_f32_i32 v20, v20
    v_cvt_f32_i32 v21, v21
    v_cvt_f32_i32 v22, v22
    v_cvt_f32_i32 v23, v23
    v_cvt_f32_i32 v24, v24
    v_cvt_f32_i32 v25, v25
    v_cvt_f32_i32 v26, v26
    v_cvt_f32_i32 v27, v27
    v_fmac_f32_dpp v88, v106, v16 row_newbcast:11 row_mask:0xf bank_mask:0xf
    v_fmac_f32_dpp v89, v106, v17 row_newbcast:11 row_mask:0xf bank_mask:0xf
    v_fmac_f32_dpp v90, v106, v18 row_newbcast:11 row_mask:0xf bank_mask:0xf
    v_fmac_f32_dpp v91, v106, v19 row_newbcast:11 row_mask:0xf bank_mask:0xf
    v_fmac_f32_dpp v92, v106, v20 row_newbcast:11 row_mask:0xf bank_mask:0xf
    v_fmac_f32_dpp v93, v106, v21 row_newbcast:11 row_mask:0xf bank_mask:0xf
    v_fmac_f32_dpp v94, v106, v22 row_newbcast:11 row_mask:0xf bank_mask:0xf
    v_fmac_f32_dpp v95, v106, v23 row_newbcast:11 row_mask:0xf bank_mask:0xf
    v_fmac_f32_dpp v96, v106, v24 row_newbcast:11 row_mask:0xf bank_mask:0xf
    v_fmac_f32_dpp v97, v106, v25 row_newbcast:11 row_mask:0xf bank_mask:0xf
    v_fmac_f32_dpp v98, v106, v26 row_newbcast:11 row_mask:0xf bank_mask:0xf
    v_fmac_f32_dpp v99, v106, v27 row_newbcast:11 row_mask:0xf bank_mask:0xf
    buffer_load_dwordx4 v[16:19], v1, s[24:27], s60 offen offset:3072
    buffer_load_dwordx4 v[20:23], v1, s[24:27], s60 offen offset:3328
    buffer_load_dwordx4 v[24:27], v1, s[24:27], s60 offen offset:3584
    s_add_u32 s60, s60, 6144
    s_waitcnt vmcnt(15)
    v_cvt_f32_i32 v28, v28
    v_cvt_f32_i32 v29, v29
    v_cvt_f32_i32 v30, v30
    v_cvt_f32_i32 v31, v31
    v_cvt_f32_i32 v32, v32
    v_cvt_f32_i32 v33, v33
    v_cvt_f32_i32 v34, v34
    v_cvt_f32_i32 v35, v35
    v_cvt_f32_i32 v36, v36
    v_cvt_f32_i32 v37, v37
    v_cvt_f32_i32 v38, v38
    v_cvt_f32_i32 v39, v39
    v_fmac_f32_dpp v88, v106, v28 row_newbcast:7 row_mask:0xf bank_mask:0xf
    v_fmac_f32_dpp v89, v106, v29 row_newbcast:7 row_mask:0xf bank_mask:0xf
    v_fmac_f32_dpp v90, v106, v30 row_newbcast:7 row_mask:0xf bank_mask:0xf
    v_fmac_f32_dpp v91, v106, v31 row_newbcast:7 row_mask:0xf bank_mask:0xf
    v_fmac_f32_dpp v92, v106, v32 row_newbcast:7 row_mask:0xf bank_mask:0xf
    v_fmac_f32_dpp v93, v106, v33 row_newbcast:7 row_mask:0xf bank_mask:0xf
    v_fmac_f32_dpp v94, v106, v34 row_newbcast:7 row_mask:0xf bank_mask:0xf
    v_fmac_f32_dpp v95, v106, v35 row_newbcast:7 row_mask:0xf bank_mask:0xf
    v_fmac_f32_dpp v96, v106, v36 row_newbcast:7 row_mask:0xf bank_mask:0xf
    v_fmac_f32_dpp v97, v106, v37 row_newbcast:7 row_mask:0xf bank_mask:0xf
    v_fmac_f32_dpp v98, v106, v38 row_newbcast:7 row_mask:0xf bank_mask:0xf
    v_fmac_f32_dpp v99, v106, v39 row_newbcast:7 row_mask:0xf bank_mask:0xf
    buffer_load_dwordx4 v[28:31], v1, s[24:27], s60 offen offset:0
    buffer_load_dwordx4 v[32:35], v1, s[24:27], s60 offen offset:256
    buffer_load_dwordx4 v[36:39], v1, s[24:27], s60 offen offset:512
    s_waitcnt vmcnt(15)
    v_cvt_f32_i32 v40, v40
    v_cvt_f32_i32 v41, v41
    v_cvt_f32_i32 v42, v42
    v_cvt_f32_i32 v43, v43
    v_cvt_f32_i32 v44, v44
    v_cvt_f32_i32 v45, v45
    v_cvt_f32_i32 v46, v46
    v_cvt_f32_i32 v47, v47
    v_cvt_f32_i32 v48, v48
    v_cvt_f32_i32 v49, v49
    v_cvt_f32_i32 v50, v50
    v_cvt_f32_i32 v51, v51
    v_fmac_f32_dpp v88, v106, v40 row_newbcast:15 row_mask:0xf bank_mask:0xf
    v_fmac_f32_dpp v89, v106, v41 row_newbcast:15 row_mask:0xf bank_mask:0xf
    v_fmac_f32_dpp v90, v106, v42 row_newbcast:15 row_mask:0xf bank_mask:0xf
    v_fmac_f32_dpp v91, v106, v43 row_newbcast:15 row_mask:0xf bank_mask:0xf
    v_fmac_f32_dpp v92, v106, v44 row_newbcast:15 row_mask:0xf bank_mask:0xf
    v_fmac_f32_dpp v93, v106, v45 row_newbcast:15 row_mask:0xf bank_mask:0xf
    v_fmac_f32_dpp v94, v106, v46 row_newbcast:15 row_mask:0xf bank_mask:0xf
    v_fmac_f32_dpp v95, v106, v47 row_newbcast:15 row_mask:0xf bank_mask:0xf
    v_fmac_f32_dpp v96, v106, v48 row_newbcast:15 row_mask:0xf bank_mask:0xf
    v_fmac_f32_dpp v97, v106, v49 row_newbcast:15 row_mask:0xf bank_mask:0xf
    v_fmac_f32_dpp v98, v106, v50 row_newbcast:15 row_mask:0xf bank_mask:0xf
    v_fmac_f32_dpp v99, v106, v51 row_newbcast:15 row_mask:0xf bank_mask:0xf
    buffer_load_dwordx4 v[40:43], v1, s[24:27], s60 offen offset:3072
    buffer_load_dwordx4 v[44:47], v1, s[24:27], s60 offen offset:3328
    buffer_load_dwordx4 v[48:51], v1, s[24:27], s60 offen offset:3584
    s_add_u32 s60, s60, 6144
    s_sub_u32 s64, s64, 1
    s_cmp_lg_u32 s64, 0
    s_cbranch_scc1 L_loop
    s_waitcnt vmcnt(9)
    v_lshlrev_b32 v113, 16, v76
    v_and_b32 v114, 0xffff0000, v76
    v_mul_f32 v64, v113, v52
    v_mul_f32 v65, v114, v53
    v_lshlrev_b32 v113, 16, v82
    v_and_b32 v114, 0xffff0000, v82
    v_mul_f32 v100, v64, v113
    v_fmac_f32 v100, v65, v114
    v_lshlrev_b32 v113, 16, v77
    v_and_b32 v114, 0xffff0000, v77
    v_mul_f32 v66, v113, v54
    v_mul_f32 v67, v114, v55
    v_lshlrev_b32 v113, 16, v83
    v_and_b32 v114, 0xffff0000, v83
    v_fmac_f32 v100, v66, v113
    v_fmac_f32 v100, v67, v114
    v_lshlrev_b32 v113, 16, v78
    v_and_b32 v114, 0xffff0000, v78
    v_mul_f32 v68, v113, v56
    v_mul_f32 v69, v114, v57
    v_lshlrev_b32 v113, 16, v84
    v_and_b32 v114, 0xffff0000, v84
    v_fmac_f32 v100, v68, v113
    v_fmac_f32 v100, v69, v114
    v_lshlrev_b32 v113, 16, v79
    v_and_b32 v114, 0xffff0000, v79
    v_mul_f32 v70, v113, v58
    v_mul_f32 v71, v114, v59
    v_lshlrev_b32 v113, 16, v85
    v_and_b32 v114, 0xffff0000, v85
    v_fmac_f32 v100, v70, v113
    v_fmac_f32 v100, v71, v114
    v_lshlrev_b32 v113, 16, v80
    v_and_b32 v114, 0xffff0000, v80
    v_mul_f32 v72, v113, v60
    v_mul_f32 v73, v114, v61
    v_lshlrev_b32 v113, 16, v86
    v_and_b32 v114, 0xffff0000, v86
    v_fmac_f32 v100, v72, v113
    v_fmac_f32 v100, v73, v114
    v_lshlrev_b32 v113, 16, v81
    v_and_b32 v114, 0xffff0000, v81
    v_mul_f32 v74, v113, v62
    v_mul_f32 v75, v114, v63
    v_lshlrev_b32 v113, 16, v87
    v_and_b32 v114, 0xffff0000, v87
    v_fmac_f32 v100, v74, v113
    v_fmac_f32 v100, v75, v114
    v_cvt_f32_i32 v4, v4
    v_cvt_f32_i32 v5, v5
    v_cvt_f32_i32 v6, v6
    v_cvt_f32_i32 v7, v7
    v_cvt_f32_i32 v8, v8
    v_cvt_f32_i32 v9, v9
    v_cvt_f32_i32 v10, v10
    v_cvt_f32_i32 v11, v11
    v_cvt_f32_i32 v12, v12
    v_cvt_f32_i32 v13, v13
    v_cvt_f32_i32 v14, v14
    v_cvt_f32_i32 v15, v15
    v_fma_f32 v107, v64, v4, -v100
    v_fmac_f32 v107, v65, v5
    v_fmac_f32 v107, v66, v6
    v_fmac_f32 v107, v67, v7
    v_fmac_f32 v107, v68, v8
    v_fmac_f32 v107, v69, v9
    v_fmac_f32 v107, v70, v10
    v_fmac_f32 v107, v71, v11
    v_fmac_f32 v107, v72, v12
    v_fmac_f32 v107, v73, v13
    v_fmac_f32 v107, v74, v14
    v_fmac_f32 v107, v75, v15
    buffer_load_dwordx4 v[4:7], v1, s[24:27], s60 offen offset:0
    buffer_load_dwordx4 v[8:11], v1, s[24:27], s60 offen offset:256
    buffer_load_dwordx4 v[12:15], v1, s[24:27], s60 offen offset:512
    v_add_f32_dpp v108, v107, v107 row_ror:8 row_mask:0xf bank_mask:0x3
    s_waitcnt vmcnt(9)
    v_cvt_f32_i32 v16, v16
    v_cvt_f32_i32 v17, v17
    v_cvt_f32_i32 v18, v18
    v_cvt_f32_i32 v19, v19
    v_cvt_f32_i32 v20, v20
    v_cvt_f32_i32 v21, v21
    v_cvt_f32_i32 v22, v22
    v_cvt_f32_i32 v23, v23
    v_cvt_f32_i32 v24, v24
    v_cvt_f32_i32 v25, v25
    v_cvt_f32_i32 v26, v26
    v_cvt_f32_i32 v27, v27
    v_fma_f32 v107, v64, v16, -v100
    v_fmac_f32 v107, v65, v17
    v_fmac_f32 v107, v66, v18
    v_fmac_f32 v107, v67, v19
    v_fmac_f32 v107, v68, v20
    v_fmac_f32 v107, v69, v21
    v_fmac_f32 v107, v70, v22
    v_fmac_f32 v107, v71, v23
    v_fmac_f32 v107, v72, v24
    v_fmac_f32 v107, v73, v25
    v_fmac_f32 v107, v74, v26
    v_fmac_f32 v107, v75, v27
    buffer_load_dwordx4 v[16:19], v1, s[24:27], s60 offen offset:3072
    buffer_load_dwordx4 v[20:23], v1, s[24:27], s60 offen offset:3328
    buffer_load_dwordx4 v[24:27], v1, s[24:27], s60 offen offset:3584
    s_add_u32 s60, s60, 6144
    v_add_f32_dpp v108, v107, v107 row_ror:8 row_mask:0xf bank_mask:0xc
    s_nop 1
    v_add_f32_dpp v109, v108, v108 row_shl:4 row_mask:0xf bank_mask:0x5
    s_waitcnt vmcnt(9)
    v_cvt_f32_i32 v28, v28
    v_cvt_f32_i32 v29, v29
    v_cvt_f32_i32 v30, v30
    v_cvt_f32_i32 v31, v31
    v_cvt_f32_i32 v32, v32
    v_cvt_f32_i32 v33, v33
    v_cvt_f32_i32 v34, v34
    v_cvt_f32_i32 v35, v35
    v_cvt_f32_i32 v36, v36
    v_cvt_f32_i32 v37, v37
    v_cvt_f32_i32 v38, v38
    v_cvt_f32_i32 v39, v39
    v_fma_f32 v107, v64, v28, -v100
    v_fmac_f32 v107, v65, v29
    v_fmac_f32 v107, v66, v30
    v_fmac_f32 v107, v67, v31
    v_fmac_f32 v107, v68, v32
    v_fmac_f32 v107, v69, v33
    v_fmac_f32 v107, v70, v34
    v_fmac_f32 v107, v71, v35
    v_fmac_f32 v107, v72, v36
    v_fmac_f32 v107, v73, v37
    v_fmac_f32 v107, v74, v38
    v_fmac_f32 v107, v75, v39
    buffer_load_dwordx4 v[28:31], v1, s[24:27], s60 offen offset:0
    buffer_load_dwordx4 v[32:35], v1, s[24:27], s60 offen offset:256
    buffer_load_dwordx4 v[36:39], v1, s[24:27], s60 offen offset:512
    v_add_f32_dpp v108, v107, v107 row_ror:8 row_mask:0xf bank_mask:0x3
    s_waitcnt vmcnt(9)
    v_cvt_f32_i32 v40, v40
    v_cvt_f32_i32 v41, v41
    v_cvt_f32_i32 v42, v42
    v_cvt_f32_i32 v43, v43
    v_cvt_f32_i32 v44, v44
    v_cvt_f32_i32 v45, v45
    v_cvt_f32_i32 v46, v46
    v_cvt_f32_i32 v47, v47
    v_cvt_f32_i32 v48, v48
    v_cvt_f32_i32 v49, v49
    v_cvt_f32_i32 v50, v50
    v_cvt_f32_i32 v51, v51
    v_fma_f32 v107, v64, v40, -v100
    v_fmac_f32 v107, v65, v41
    v_fmac_f32 v107, v66, v42
    v_fmac_f32 v107, v67, v43
    v_fmac_f32 v107, v68, v44
    v_fmac_f32 v107, v69, v45
    v_fmac_f32 v107, v70, v46
    v_fmac_f32 v107, v71, v47
    v_fmac_f32 v107, v72, v48
    v_fmac_f32 v107, v73, v49
    v_fmac_f32 v107, v74, v50
    v_fmac_f32 v107, v75, v51
    buffer_load_dwordx4 v[40:43], v1, s[24:27], s60 offen offset:3072
    buffer_load_dwordx4 v[44:47], v1, s[24:27], s60 offen offset:3328
    buffer_load_dwordx4 v[48:51], v1, s[24:27], s60 offen offset:3584
    s_add_u32 s60, s60, 6144
    v_add_f32_dpp v108, v107, v107 row_ror:8 row_mask:0xf bank_mask:0xc
    s_nop 1
    v_add_f32_dpp v109, v108, v108 row_shr:4 row_mask:0xf bank_mask:0xa
    s_nop 1
    v_add_f32_dpp v110, v109, v109 quad_perm:[2,3,0,1] row_mask:0xf bank_mask:0xf
    s_waitcnt vmcnt(9)
    v_cvt_f32_i32 v4, v4
    v_cvt_f32_i32 v5, v5
    v_cvt_f32_i32 v6, v6
    v_cvt_f32_i32 v7, v7
    v_cvt_f32_i32 v8, v8
    v_cvt_f32_i32 v9, v9
    v_cvt_f32_i32 v10, v10
    v_cvt_f32_i32 v11, v11
    v_cvt_f32_i32 v12, v12
    v_cvt_f32_i32 v13, v13
    v_cvt_f32_i32 v14, v14
    v_cvt_f32_i32 v15, v15
    v_fma_f32 v107, v64, v4, -v100
    v_fmac_f32 v107, v65, v5
    v_fmac_f32 v107, v66, v6
    v_fmac_f32 v107, v67, v7
    v_fmac_f32 v107, v68, v8
    v_fmac_f32 v107, v69, v9
    v_fmac_f32 v107, v70, v10
    v_fmac_f32 v107, v71, v11
    v_fmac_f32 v107, v72, v12
    v_fmac_f32 v107, v73, v13
    v_fmac_f32 v107, v74, v14
    v_fmac_f32 v107, v75, v15
    buffer_load_dwordx4 v[4:7], v1, s[24:27], s60 offen offset:0
    buffer_load_dwordx4 v[8:11], v1, s[24:27], s60 offen offset:256
    buffer_load_dwordx4 v[12:15], v1, s[24:27], s60 offen offset:512
    v_add_f32_dpp v108, v107, v107 row_ror:8 row_mask:0xf bank_mask:0x3
    s_waitcnt vmcnt(9)
    v_cvt_f32_i32 v16, v16
    v_cvt_f32_i32 v17, v17
    v_cvt_f32_i32 v18, v18
    v_cvt_f32_i32 v19, v19
    v_cvt_f32_i32 v20, v20
    v_cvt_f32_i32 v21, v21
    v_cvt_f32_i32 v22, v22
    v_cvt_f32_i32 v23, v23
    v_cvt_f32_i32 v24, v24
    v_cvt_f32_i32 v25, v25
    v_cvt_f32_i32 v26, v26
    v_cvt_f32_i32 v27, v27
    v_fma_f32 v107, v64, v16, -v100
    v_fmac_f32 v107, v65, v17
    v_fmac_f32 v107, v66, v18
    v_fmac_f32 v107, v67, v19
    v_fmac_f32 v107, v68, v20
    v_fmac_f32 v107, v69, v21
    v_fmac_f32 v107, v70, v22
    v_fmac_f32 v107, v71, v23
    v_fmac_f32 v107, v72, v24
    v_fmac_f32 v107, v73, v25
    v_fmac_f32 v107, v74, v26
    v_fmac_f32 v107, v75, v27
    buffer_load_dwordx4 v[16:19], v1, s[24:27], s60 offen offset:3072
    buffer_load_dwordx4 v[20:23], v1, s[24:27], s60 offen offset:3328
    buffer_load_dwordx4 v[24:27], v1, s[24:27], s60 offen offset:3584
    s_add_u32 s60, s60, 6144
    v_add_f32_dpp v108, v107, v107 row_ror:8 row_mask:0xf bank_mask:0xc
    s_nop 1
    v_add_f32_dpp v109, v108, v108 row_shl:4 row_mask:0xf bank_mask:0x5
    s_waitcnt vmcnt(9)
    v_cvt_f32_i32 v28, v28
    v_cvt_f32_i32 v29, v29
    v_cvt_f32_i32 v30, v30
    v_cvt_f32_i32 v31, v31
    v_cvt_f32_i32 v32, v32
    v_cvt_f32_i32 v33, v33
    v_cvt_f32_i32 v34, v34
    v_cvt_f32_i32 v35, v35
    v_cvt_f32_i32 v36, v36
    v_cvt_f32_i32 v37, v37
    v_cvt_f32_i32 v38, v38
    v_cvt_f32_i32 v39, v39
    v_fma_f32 v107, v64, v28, -v100
    v_fmac_f32 v107, v65, v29
    v_fmac_f32 v107, v66, v30
    v_fmac_f32 v107, v67, v31
    v_fmac_f32 v107, v68, v32
    v_fmac_f32 v107, v69, v33
    v_fmac_f32 v107, v70, v34
    v_fmac_f32 v107, v71, v35
    v_fmac_f32 v107, v72, v36
    v_fmac_f32 v107, v73, v37
    v_fmac_f32 v107, v74, v38
    v_fmac_f32 v107, v75, v39
    buffer_load_dwordx4 v[28:31], v1, s[24:27], s60 offen offset:0
    buffer_load_dwordx4 v[32:35], v1, s[24:27], s60 offen offset:256
    buffer_load_dwordx4 v[36:39], v1, s[24:27], s60 offen offset:512
    v_add_f32_dpp v108, v107, v107 row_ror:8 row_mask:0xf bank_mask:0x3
    s_waitcnt vmcnt(9)
    v_cvt_f32_i32 v40, v40
    v_cvt_f32_i32 v41, v41
    v_cvt_f32_i32 v42, v42
    v_cvt_f32_i32 v43, v43
    v_cvt_f32_i32 v44, v44
    v_cvt_f32_i32 v45, v45
    v_cvt_f32_i32 v46, v46
    v_cvt_f32_i32 v47, v47
    v_cvt_f32_i32 v48, v48
    v_cvt_f32_i32 v49, v49
    v_cvt_f32_i32 v50, v50
    v_cvt_f32_i32 v51, v51
    v_fma_f32 v107, v64, v40, -v100
    v_fmac_f32 v107, v65, v41
    v_fmac_f32 v107, v66, v42
    v_fmac_f32 v107, v67, v43
    v_fmac_f32 v107, v68, v44
    v_fmac_f32 v107, v69, v45
    v_fmac_f32 v107, v70, v46
    v_fmac_f32 v107, v71, v47
    v_fmac_f32 v107, v72, v48
    v_fmac_f32 v107, v73, v49
    v_fmac_f32 v107, v74, v50
    v_fmac_f32 v107, v75, v51
    buffer_load_dwordx4 v[40:43], v1, s[24:27], s60 offen offset:3072
    buffer_load_dwordx4 v[44:47], v1, s[24:27], s60 offen offset:3328
    buffer_load_dwordx4 v[48:51], v1, s[24:27], s60 offen offset:3584
    s_add_u32 s60, s60, 6144
    v_add_f32_dpp v108, v107, v107 row_ror:8 row_mask:0xf bank_mask:0xc
    s_nop 1
    v_add_f32_dpp v109, v108, v108 row_shr:4 row_mask:0xf bank_mask:0xa
    s_nop 1
    v_add_f32_dpp v111, v109, v109 quad_perm:[2,3,0,1] row_mask:0xf bank_mask:0xf
    v_cndmask_b32 v111, v110, v111, s[66:67]
    s_nop 1
    v_add_f32_dpp v112, v111, v111 quad_perm:[1,0,3,2] row_mask:0xf bank_mask:0xf
    s_waitcnt vmcnt(9)
    v_cvt_f32_i32 v4, v4
    v_cvt_f32_i32 v5, v5
    v_cvt_f32_i32 v6, v6
    v_cvt_f32_i32 v7, v7
    v_cvt_f32_i32 v8, v8
    v_cvt_f32_i32 v9, v9
    v_cvt_f32_i32 v10, v10
    v_cvt_f32_i32 v11, v11
    v_cvt_f32_i32 v12, v12
    v_cvt_f32_i32 v13, v13
    v_cvt_f32_i32 v14, v14
    v_cvt_f32_i32 v15, v15
    v_fma_f32 v107, v64, v4, -v100
    v_fmac_f32 v107, v65, v5
    v_fmac_f32 v107, v66, v6
    v_fmac_f32 v107, v67, v7
    v_fmac_f32 v107, v68, v8
    v_fmac_f32 v107, v69, v9
    v_fmac_f32 v107, v70, v10
    v_fmac_f32 v107, v71, v11
    v_fmac_f32 v107, v72, v12
    v_fmac_f32 v107, v73, v13
    v_fmac_f32 v107, v74, v14
    v_fmac_f32 v107, v75, v15
    buffer_load_dwordx4 v[4:7], v1, s[24:27], s60 offen offset:0
    buffer_load_dwordx4 v[8:11], v1, s[24:27], s60 offen offset:256
    buffer_load_dwordx4 v[12:15], v1, s[24:27], s60 offen offset:512
    v_add_f32_dpp v108, v107, v107 row_ror:8 row_mask:0xf bank_mask:0x3
    s_waitcnt vmcnt(9)
    v_cvt_f32_i32 v16, v16
    v_cvt_f32_i32 v17, v17
    v_cvt_f32_i32 v18, v18
    v_cvt_f32_i32 v19, v19
    v_cvt_f32_i32 v20, v20
    v_cvt_f32_i32 v21, v21
    v_cvt_f32_i32 v22, v22
    v_cvt_f32_i32 v23, v23
    v_cvt_f32_i32 v24, v24
    v_cvt_f32_i32 v25, v25
    v_cvt_f32_i32 v26, v26
    v_cvt_f32_i32 v27, v27
    v_fma_f32 v107, v64, v16, -v100
    v_fmac_f32 v107, v65, v17
    v_fmac_f32 v107, v66, v18
    v_fmac_f32 v107, v67, v19
    v_fmac_f32 v107, v68, v20
    v_fmac_f32 v107, v69, v21
    v_fmac_f32 v107, v70, v22
    v_fmac_f32 v107, v71, v23
    v_fmac_f32 v107, v72, v24
    v_fmac_f32 v107, v73, v25
    v_fmac_f32 v107, v74, v26
    v_fmac_f32 v107, v75, v27
    buffer_load_dwordx4 v[16:19], v1, s[24:27], s60 offen offset:3072
    buffer_load_dwordx4 v[20:23], v1, s[24:27], s60 offen offset:3328
    buffer_load_dwordx4 v[24:27], v1, s[24:27], s60 offen offset:3584
    s_add_u32 s60, s60, 6144
    v_add_f32_dpp v108, v107, v107 row_ror:8 row_mask:0xf bank_mask:0xc
    s_nop 1
    v_add_f32_dpp v109, v108, v108 row_shl:4 row_mask:0xf bank_mask:0x5
    s_waitcnt vmcnt(9)
    v_cvt_f32_i32 v28, v28
    v_cvt_f32_i32 v29, v29
    v_cvt_f32_i32 v30, v30
    v_cvt_f32_i32 v31, v31
    v_cvt_f32_i32 v32, v32
    v_cvt_f32_i32 v33, v33
    v_cvt_f32_i32 v34, v34
    v_cvt_f32_i32 v35, v35
    v_cvt_f32_i32 v36, v36
    v_cvt_f32_i32 v37, v37
    v_cvt_f32_i32 v38, v38
    v_cvt_f32_i32 v39, v39
    v_fma_f32 v107, v64, v28, -v100
    v_fmac_f32 v107, v65, v29
    v_fmac_f32 v107, v66, v30
    v_fmac_f32 v107, v67, v31
    v_fmac_f32 v107, v68, v32
    v_fmac_f32 v107, v69, v33
    v_fmac_f32 v107, v70, v34
    v_fmac_f32 v107, v71, v35
    v_fmac_f32 v107, v72, v36
    v_fmac_f32 v107, v73, v37
    v_fmac_f32 v107, v74, v38
    v_fmac_f32 v107, v75, v39
    buffer_load_dwordx4 v[28:31], v1, s[24:27], s60 offen offset:0
    buffer_load_dwordx4 v[32:35], v1, s[24:27], s60 offen offset:256
    buffer_load_dwordx4 v[36:39], v1, s[24:27], s60 offen offset:512
    v_add_f32_dpp v108, v107, v107 row_ror:8 row_mask:0xf bank_mask:0x3
    s_waitcnt vmcnt(9)
    v_cvt_f32_i32 v40, v40
    v_cvt_f32_i32 v41, v41
    v_cvt_f32_i32 v42, v42
    v_cvt_f32_i32 v43, v43
    v_cvt_f32_i32 v44, v44
    v_cvt_f32_i32 v45, v45
    v_cvt_f32_i32 v46, v46
    v_cvt_f32_i32 v47, v47
    v_cvt_f32_i32 v48, v48
    v_cvt_f32_i32 v49, v49
    v_cvt_f32_i32 v50, v50
    v_cvt_f32_i32 v51, v51
    v_fma_f32 v107, v64, v40, -v100
    v_fmac_f32 v107, v65, v41
    v_fmac_f32 v107, v66, v42
    v_fmac_f32 v107, v67, v43
    v_fmac_f32 v107, v68, v44
    v_fmac_f32 v107, v69, v45
    v_fmac_f32 v107, v70, v46
    v_fmac_f32 v107, v71, v47
    v_fmac_f32 v107, v72, v48
    v_fmac_f32 v107, v73, v49
    v_fmac_f32 v107, v74, v50
    v_fmac_f32 v107, v75, v51
    buffer_load_dwordx4 v[40:43], v1, s[24:27], s60 offen offset:3072
    buffer_load_dwordx4 v[44:47], v1, s[24:27], s60 offen offset:3328
    buffer_load_dwordx4 v[48:51], v1, s[24:27], s60 offen offset:3584
    s_add_u32 s60, s60, 6144
    v_add_f32_dpp v108, v107, v107 row_ror:8 row_mask:0xf bank_mask:0xc
    s_nop 1
    v_add_f32_dpp v109, v108, v108 row_shr:4 row_mask:0xf bank_mask:0xa
    s_nop 1
    v_add_f32_dpp v110, v109, v109 quad_perm:[2,3,0,1] row_mask:0xf bank_mask:0xf
    s_waitcnt vmcnt(9)
    v_cvt_f32_i32 v4, v4
    v_cvt_f32_i32 v5, v5
    v_cvt_f32_i32 v6, v6
    v_cvt_f32_i32 v7, v7
    v_cvt_f32_i32 v8, v8
    v_cvt_f32_i32 v9, v9
    v_cvt_f32_i32 v10, v10
    v_cvt_f32_i32 v11, v11
    v_cvt_f32_i32 v12, v12
    v_cvt_f32_i32 v13, v13
    v_cvt_f32_i32 v14, v14
    v_cvt_f32_i32 v15, v15
    v_fma_f32 v107, v64, v4, -v100
    v_fmac_f32 v107, v65, v5
    v_fmac_f32 v107, v66, v6
    v_fmac_f32 v107, v67, v7
    v_fmac_f32 v107, v68, v8
    v_fmac_f32 v107, v69, v9
    v_fmac_f32 v107, v70, v10
    v_fmac_f32 v107, v71, v11
    v_fmac_f32 v107, v72, v12
    v_fmac_f32 v107, v73, v13
    v_fmac_f32 v107, v74, v14
    v_fmac_f32 v107, v75, v15
    buffer_load_ushort v104, v3, s[40:43], s63 offen
    buffer_load_ushort v105, v3, s[44:47], s63 offen
    s_add_u32 s63, s63, 128
    buffer_load_dwordx4 v[4:7], v1, s[28:31], s61 offen offset:0
    buffer_load_dwordx4 v[8:11], v1, s[28:31], s61 offen offset:256
    buffer_load_dwordx4 v[12:15], v1, s[28:31], s61 offen offset:512
    v_add_f32_dpp v108, v107, v107 row_ror:8 row_mask:0xf bank_mask:0x3
    s_waitcnt vmcnt(11)
    v_cvt_f32_i32 v16, v16
    v_cvt_f32_i32 v17, v17
    v_cvt_f32_i32 v18, v18
    v_cvt_f32_i32 v19, v19
    v_cvt_f32_i32 v20, v20
    v_cvt_f32_i32 v21, v21
    v_cvt_f32_i32 v22, v22
    v_cvt_f32_i32 v23, v23
    v_cvt_f32_i32 v24, v24
    v_cvt_f32_i32 v25, v25
    v_cvt_f32_i32 v26, v26
    v_cvt_f32_i32 v27, v27
    v_fma_f32 v107, v64, v16, -v100
    v_fmac_f32 v107, v65, v17
    v_fmac_f32 v107, v66, v18
    v_fmac_f32 v107, v67, v19
    v_fmac_f32 v107, v68, v20
    v_fmac_f32 v107, v69, v21
    v_fmac_f32 v107, v70, v22
    v_fmac_f32 v107, v71, v23
    v_fmac_f32 v107, v72, v24
    v_fmac_f32 v107, v73, v25
    v_fmac_f32 v107, v74, v26
    v_fmac_f32 v107, v75, v27
    buffer_load_dwordx4 v[16:19], v1, s[28:31], s61 offen offset:3072
    buffer_load_dwordx4 v[20:23], v1, s[28:31], s61 offen offset:3328
    buffer_load_dwordx4 v[24:27], v1, s[28:31], s61 offen offset:3584
    s_add_u32 s61, s61, 6144
    v_add_f32_dpp v108, v107, v107 row_ror:8 row_mask:0xf bank_mask:0xc
    s_nop 1
    v_add_f32_dpp v109, v108, v108 row_shl:4 row_mask:0xf bank_mask:0x5
    s_waitcnt vmcnt(11)
    v_cvt_f32_i32 v28, v28
    v_cvt_f32_i32 v29, v29
    v_cvt_f32_i32 v30, v30
    v_cvt_f32_i32 v31, v31
    v_cvt_f32_i32 v32, v32
    v_cvt_f32_i32 v33, v33
    v_cvt_f32_i32 v34, v34
    v_cvt_f32_i32 v35, v35
    v_cvt_f32_i32 v36, v36
    v_cvt_f32_i32 v37, v37
    v_cvt_f32_i32 v38, v38
    v_cvt_f32_i32 v39, v39
    v_fma_f32 v107, v64, v28, -v100
    v_fmac_f32 v107, v65, v29
    v_fmac_f32 v107, v66, v30
    v_fmac_f32 v107, v67, v31
    v_fmac_f32 v107, v68, v32
    v_fmac_f32 v107, v69, v33
    v_fmac_f32 v107, v70, v34
    v_fmac_f32 v107, v71, v35
    v_fmac_f32 v107, v72, v36
    v_fmac_f32 v107, v73, v37
    v_fmac_f32 v107, v74, v38
    v_fmac_f32 v107, v75, v39
    buffer_load_dwordx4 v[28:31], v1, s[28:31], s61 offen offset:0
    buffer_load_dwordx4 v[32:35], v1, s[28:31], s61 offen offset:256
    buffer_load_dwordx4 v[36:39], v1, s[28:31], s61 offen offset:512
    v_add_f32_dpp v108, v107, v107 row_ror:8 row_mask:0xf bank_mask:0x3
    s_waitcnt vmcnt(11)
    v_cvt_f32_i32 v40, v40
    v_cvt_f32_i32 v41, v41
    v_cvt_f32_i32 v42, v42
    v_cvt_f32_i32 v43, v43
    v_cvt_f32_i32 v44, v44
    v_cvt_f32_i32 v45, v45
    v_cvt_f32_i32 v46, v46
    v_cvt_f32_i32 v47, v47
    v_cvt_f32_i32 v48, v48
    v_cvt_f32_i32 v49, v49
    v_cvt_f32_i32 v50, v50
    v_cvt_f32_i32 v51, v51
    v_fma_f32 v107, v64, v40, -v100
    v_fmac_f32 v107, v65, v41
    v_fmac_f32 v107, v66, v42
    v_fmac_f32 v107, v67, v43
    v_fmac_f32 v107, v68, v44
    v_fmac_f32 v107, v69, v45
    v_fmac_f32 v107, v70, v46
    v_fmac_f32 v107, v71, v47
    v_fmac_f32 v107, v72, v48
    v_fmac_f32 v107, v73, v49
    v_fmac_f32 v107, v74, v50
    v_fmac_f32 v107, v75, v51
    buffer_load_dwordx4 v[40:43], v1, s[28:31], s61 offen offset:3072
    buffer_load_dwordx4 v[44:47], v1, s[28:31], s61 offen offset:3328
    buffer_load_dwordx4 v[48:51], v1, s[28:31], s61 offen offset:3584
    s_add_u32 s61, s61, 6144
    v_add_f32_dpp v108, v107, v107 row_ror:8 row_mask:0xf bank_mask:0xc
    s_nop 1
    v_add_f32_dpp v109, v108, v108 row_shr:4 row_mask:0xf bank_mask:0xa
    s_nop 1
    v_add_f32_dpp v111, v109, v109 quad_perm:[2,3,0,1] row_mask:0xf bank_mask:0xf
    v_cndmask_b32 v111, v110, v111, s[66:67]
    s_nop 1
    v_add_f32_dpp v110, v111, v111 quad_perm:[1,0,3,2] row_mask:0xf bank_mask:0xf
    v_cndmask_b32 v112, v112, v110, s[68:69]
    s_nop 1
    s_waitcnt vmcnt(9)
    v_max_f32_dpp v113, v112, v112 row_ror:8 row_mask:0xf bank_mask:0xf
    v_lshlrev_b32 v104, 16, v104
    v_lshlrev_b32 v105, 16, v105
    v_max_f32_dpp v113, v113, v113 row_ror:4 row_mask:0xf bank_mask:0xf
    s_nop 1
    v_max_f32_dpp v113, v113, v113 row_ror:2 row_mask:0xf bank_mask:0xf
    s_nop 1
    v_max_f32_dpp v113, v113, v113 row_ror:1 row_mask:0xf bank_mask:0xf
    v_max_f32 v113, v113, v101
    v_sub_f32 v114, v101, v113
    v_sub_f32 v106, v112, v113
    v_exp_f32 v114, v114
    v_exp_f32 v106, v106
    v_mov_b32 v101, v113
    v_fma_f32 v102, v102, v114, v106
    v_mul_f32 v106, v106, v104
    v_mul_f32 v103, v103, v114
    v_fmac_f32 v103, v106, v105
    v_mul_f32 v88, v88, v114
    v_mul_f32 v89, v89, v114
    v_mul_f32 v90, v90, v114
    v_mul_f32 v91, v91, v114
    v_mul_f32 v92, v92, v114
    v_mul_f32 v93, v93, v114
    v_mul_f32 v94, v94, v114
    v_mul_f32 v95, v95, v114
    v_mul_f32 v96, v96, v114
    v_mul_f32 v97, v97, v114
    v_mul_f32 v98, v98, v114
    v_mul_f32 v99, v99, v114
    v_cvt_f32_i32 v4, v4
    v_cvt_f32_i32 v5, v5
    v_cvt_f32_i32 v6, v6
    v_cvt_f32_i32 v7, v7
    v_cvt_f32_i32 v8, v8
    v_cvt_f32_i32 v9, v9
    v_cvt_f32_i32 v10, v10
    v_cvt_f32_i32 v11, v11
    v_cvt_f32_i32 v12, v12
    v_cvt_f32_i32 v13, v13
    v_cvt_f32_i32 v14, v14
    v_cvt_f32_i32 v15, v15
    v_fmac_f32_dpp v88, v106, v4 row_newbcast:0 row_mask:0xf bank_mask:0xf
    v_fmac_f32_dpp v89, v106, v5 row_newbcast:0 row_mask:0xf bank_mask:0xf
    v_fmac_f32_dpp v90, v106, v6 row_newbcast:0 row_mask:0xf bank_mask:0xf
    v_fmac_f32_dpp v91, v106, v7 row_newbcast:0 row_mask:0xf bank_mask:0xf
    v_fmac_f32_dpp v92, v106, v8 row_newbcast:0 row_mask:0xf bank_mask:0xf
    v_fmac_f32_dpp v93, v106, v9 row_newbcast:0 row_mask:0xf bank_mask:0xf
    v_fmac_f32_dpp v94, v106, v10 row_newbcast:0 row_mask:0xf bank_mask:0xf
    v_fmac_f32_dpp v95, v106, v11 row_newbcast:0 row_mask:0xf bank_mask:0xf
    v_fmac_f32_dpp v96, v106, v12 row_newbcast:0 row_mask:0xf bank_mask:0xf
    v_fmac_f32_dpp v97, v106, v13 row_newbcast:0 row_mask:0xf bank_mask:0xf
    v_fmac_f32_dpp v98, v106, v14 row_newbcast:0 row_mask:0xf bank_mask:0xf
    v_fmac_f32_dpp v99, v106, v15 row_newbcast:0 row_mask:0xf bank_mask:0xf
    buffer_load_dwordx4 v[4:7], v1, s[28:31], s61 offen offset:0
    buffer_load_dwordx4 v[8:11], v1, s[28:31], s61 offen offset:256
    buffer_load_dwordx4 v[12:15], v1, s[28:31], s61 offen offset:512
    s_waitcnt vmcnt(9)
    v_cvt_f32_i32 v16, v16
    v_cvt_f32_i32 v17, v17
    v_cvt_f32_i32 v18, v18
    v_cvt_f32_i32 v19, v19
    v_cvt_f32_i32 v20, v20
    v_cvt_f32_i32 v21, v21
    v_cvt_f32_i32 v22, v22
    v_cvt_f32_i32 v23, v23
    v_cvt_f32_i32 v24, v24
    v_cvt_f32_i32 v25, v25
    v_cvt_f32_i32 v26, v26
    v_cvt_f32_i32 v27, v27
    v_fmac_f32_dpp v88, v106, v16 row_newbcast:8 row_mask:0xf bank_mask:0xf
    v_fmac_f32_dpp v89, v106, v17 row_newbcast:8 row_mask:0xf bank_mask:0xf
    v_fmac_f32_dpp v90, v106, v18 row_newbcast:8 row_mask:0xf bank_mask:0xf
    v_fmac_f32_dpp v91, v106, v19 row_newbcast:8 row_mask:0xf bank_mask:0xf
    v_fmac_f32_dpp v92, v106, v20 row_newbcast:8 row_mask:0xf bank_mask:0xf
    v_fmac_f32_dpp v93, v106, v21 row_newbcast:8 row_mask:0xf bank_mask:0xf
    v_fmac_f32_dpp v94, v106, v22 row_newbcast:8 row_mask:0xf bank_mask:0xf
    v_fmac_f32_dpp v95, v106, v23 row_newbcast:8 row_mask:0xf bank_mask:0xf
    v_fmac_f32_dpp v96, v106, v24 row_newbcast:8 row_mask:0xf bank_mask:0xf
    v_fmac_f32_dpp v97, v106, v25 row_newbcast:8 row_mask:0xf bank_mask:0xf
    v_fmac_f32_dpp v98, v106, v26 row_newbcast:8 row_mask:0xf bank_mask:0xf
    v_fmac_f32_dpp v99, v106, v27 row_newbcast:8 row_mask:0xf bank_mask:0xf
    buffer_load_dwordx4 v[16:19], v1, s[28:31], s61 offen offset:3072
    buffer_load_dwordx4 v[20:23], v1, s[28:31], s61 offen offset:3328
    buffer_load_dwordx4 v[24:27], v1, s[28:31], s61 offen offset:3584
    s_add_u32 s61, s61, 6144
    s_waitcnt vmcnt(9)
    v_cvt_f32_i32 v28, v28
    v_cvt_f32_i32 v29, v29
    v_cvt_f32_i32 v30, v30
    v_cvt_f32_i32 v31, v31
    v_cvt_f32_i32 v32, v32
    v_cvt_f32_i32 v33, v33
    v_cvt_f32_i32 v34, v34
    v_cvt_f32_i32 v35, v35
    v_cvt_f32_i32 v36, v36
    v_cvt_f32_i32 v37, v37
    v_cvt_f32_i32 v38, v38
    v_cvt_f32_i32 v39, v39
    v_fmac_f32_dpp v88, v106, v28 row_newbcast:4 row_mask:0xf bank_mask:0xf
    v_fmac_f32_dpp v89, v106, v29 row_newbcast:4 row_mask:0xf bank_mask:0xf
    v_fmac_f32_dpp v90, v106, v30 row_newbcast:4 row_mask:0xf bank_mask:0xf
    v_fmac_f32_dpp v91, v106, v31 row_newbcast:4 row_mask:0xf bank_mask:0xf
    v_fmac_f32_dpp v92, v106, v32 row_newbcast:4 row_mask:0xf bank_mask:0xf
    v_fmac_f32_dpp v93, v106, v33 row_newbcast:4 row_mask:0xf bank_mask:0xf
    v_fmac_f32_dpp v94, v106, v34 row_newbcast:4 row_mask:0xf bank_mask:0xf
    v_fmac_f32_dpp v95, v106, v35 row_newbcast:4 row_mask:0xf bank_mask:0xf
    v_fmac_f32_dpp v96, v106, v36 row_newbcast:4 row_mask:0xf bank_mask:0xf
    v_fmac_f32_dpp v97, v106, v37 row_newbcast:4 row_mask:0xf bank_mask:0xf
    v_fmac_f32_dpp v98, v106, v38 row_newbcast:4 row_mask:0xf bank_mask:0xf
    v_fmac_f32_dpp v99, v106, v39 row_newbcast:4 row_mask:0xf bank_mask:0xf
    buffer_load_dwordx4 v[28:31], v1, s[28:31], s61 offen offset:0
    buffer_load_dwordx4 v[32:35], v1, s[28:31], s61 offen offset:256
    buffer_load_dwordx4 v[36:39], v1, s[28:31], s61 offen offset:512
    s_waitcnt vmcnt(9)
    v_cvt_f32_i32 v40, v40
    v_cvt_f32_i32 v41, v41
    v_cvt_f32_i32 v42, v42
    v_cvt_f32_i32 v43, v43
    v_cvt_f32_i32 v44, v44
    v_cvt_f32_i32 v45, v45
    v_cvt_f32_i32 v46, v46
    v_cvt_f32_i32 v47, v47
    v_cvt_f32_i32 v48, v48
    v_cvt_f32_i32 v49, v49
    v_cvt_f32_i32 v50, v50
    v_cvt_f32_i32 v51, v51
    v_fmac_f32_dpp v88, v106, v40 row_newbcast:12 row_mask:0xf bank_mask:0xf
    v_fmac_f32_dpp v89, v106, v41 row_newbcast:12 row_mask:0xf bank_mask:0xf
    v_fmac_f32_dpp v90, v106, v42 row_newbcast:12 row_mask:0xf bank_mask:0xf
    v_fmac_f32_dpp v91, v106, v43 row_newbcast:12 row_mask:0xf bank_mask:0xf
    v_fmac_f32_dpp v92, v106, v44 row_newbcast:12 row_mask:0xf bank_mask:0xf
    v_fmac_f32_dpp v93, v106, v45 row_newbcast:12 row_mask:0xf bank_mask:0xf
    v_fmac_f32_dpp v94, v106, v46 row_newbcast:12 row_mask:0xf bank_mask:0xf
    v_fmac_f32_dpp v95, v106, v47 row_newbcast:12 row_mask:0xf bank_mask:0xf
    v_fmac_f32_dpp v96, v106, v48 row_newbcast:12 row_mask:0xf bank_mask:0xf
    v_fmac_f32_dpp v97, v106, v49 row_newbcast:12 row_mask:0xf bank_mask:0xf
    v_fmac_f32_dpp v98, v106, v50 row_newbcast:12 row_mask:0xf bank_mask:0xf
    v_fmac_f32_dpp v99, v106, v51 row_newbcast:12 row_mask:0xf bank_mask:0xf
    buffer_load_dwordx4 v[40:43], v1, s[28:31], s61 offen offset:3072
    buffer_load_dwordx4 v[44:47], v1, s[28:31], s61 offen offset:3328
    buffer_load_dwordx4 v[48:51], v1, s[28:31], s61 offen offset:3584
    s_add_u32 s61, s61, 6144
    s_waitcnt vmcnt(9)
    v_cvt_f32_i32 v4, v4
    v_cvt_f32_i32 v5, v5
    v_cvt_f32_i32 v6, v6
    v_cvt_f32_i32 v7, v7
    v_cvt_f32_i32 v8, v8
    v_cvt_f32_i32 v9, v9
    v_cvt_f32_i32 v10, v10
    v_cvt_f32_i32 v11, v11
    v_cvt_f32_i32 v12, v12
    v_cvt_f32_i32 v13, v13
    v_cvt_f32_i32 v14, v14
    v_cvt_f32_i32 v15, v15
    v_fmac_f32_dpp v88, v106, v4 row_newbcast:2 row_mask:0xf bank_mask:0xf
    v_fmac_f32_dpp v89, v106, v5 row_newbcast:2 row_mask:0xf bank_mask:0xf
    v_fmac_f32_dpp v90, v106, v6 row_newbcast:2 row_mask:0xf bank_mask:0xf
    v_fmac_f32_dpp v91, v106, v7 row_newbcast:2 row_mask:0xf bank_mask:0xf
    v_fmac_f32_dpp v92, v106, v8 row_newbcast:2 row_mask:0xf bank_mask:0xf
    v_fmac_f32_dpp v93, v106, v9 row_newbcast:2 row_mask:0xf bank_mask:0xf
    v_fmac_f32_dpp v94, v106, v10 row_newbcast:2 row_mask:0xf bank_mask:0xf
    v_fmac_f32_dpp v95, v106, v11 row_newbcast:2 row_mask:0xf bank_mask:0xf
    v_fmac_f32_dpp v96, v106, v12 row_newbcast:2 row_mask:0xf bank_mask:0xf
    v_fmac_f32_dpp v97, v106, v13 row_newbcast:2 row_mask:0xf bank_mask:0xf
    v_fmac_f32_dpp v98, v106, v14 row_newbcast:2 row_mask:0xf bank_mask:0xf
    v_fmac_f32_dpp v99, v106, v15 row_newbcast:2 row_mask:0xf bank_mask:0xf
    buffer_load_dwordx4 v[4:7], v1, s[28:31], s61 offen offset:0
    buffer_load_dwordx4 v[8:11], v1, s[28:31], s61 offen offset:256
    buffer_load_dwordx4 v[12:15], v1, s[28:31], s61 offen offset:512
    s_waitcnt vmcnt(9)
    v_cvt_f32_i32 v16, v16
    v_cvt_f32_i32 v17, v17
    v_cvt_f32_i32 v18, v18
    v_cvt_f32_i32 v19, v19
    v_cvt_f32_i32 v20, v20
    v_cvt_f32_i32 v21, v21
    v_cvt_f32_i32 v22, v22
    v_cvt_f32_i32 v23, v23
    v_cvt_f32_i32 v24, v24
    v_cvt_f32_i32 v25, v25
    v_cvt_f32_i32 v26, v26
    v_cvt_f32_i32 v27, v27
    v_fmac_f32_dpp v88, v106, v16 row_newbcast:10 row_mask:0xf bank_mask:0xf
    v_fmac_f32_dpp v89, v106, v17 row_newbcast:10 row_mask:0xf bank_mask:0xf
    v_fmac_f32_dpp v90, v106, v18 row_newbcast:10 row_mask:0xf bank_mask:0xf
    v_fmac_f32_dpp v91, v106, v19 row_newbcast:10 row_mask:0xf bank_mask:0xf
    v_fmac_f32_dpp v92, v106, v20 row_newbcast:10 row_mask:0xf bank_mask:0xf
    v_fmac_f32_dpp v93, v106, v21 row_newbcast:10 row_mask:0xf bank_mask:0xf
    v_fmac_f32_dpp v94, v106, v22 row_newbcast:10 row_mask:0xf bank_mask:0xf
    v_fmac_f32_dpp v95, v106, v23 row_newbcast:10 row_mask:0xf bank_mask:0xf
    v_fmac_f32_dpp v96, v106, v24 row_newbcast:10 row_mask:0xf bank_mask:0xf
    v_fmac_f32_dpp v97, v106, v25 row_newbcast:10 row_mask:0xf bank_mask:0xf
    v_fmac_f32_dpp v98, v106, v26 row_newbcast:10 row_mask:0xf bank_mask:0xf
    v_fmac_f32_dpp v99, v106, v27 row_newbcast:10 row_mask:0xf bank_mask:0xf
    buffer_load_dwordx4 v[16:19], v1, s[28:31], s61 offen offset:3072
    buffer_load_dwordx4 v[20:23], v1, s[28:31], s61 offen offset:3328
    buffer_load_dwordx4 v[24:27], v1, s[28:31], s61 offen offset:3584
    s_add_u32 s61, s61, 6144
    s_waitcnt vmcnt(9)
    v_cvt_f32_i32 v28, v28
    v_cvt_f32_i32 v29, v29
    v_cvt_f32_i32 v30, v30
    v_cvt_f32_i32 v31, v31
    v_cvt_f32_i32 v32, v32
    v_cvt_f32_i32 v33, v33
    v_cvt_f32_i32 v34, v34
    v_cvt_f32_i32 v35, v35
    v_cvt_f32_i32 v36, v36
    v_cvt_f32_i32 v37, v37
    v_cvt_f32_i32 v38, v38
    v_cvt_f32_i32 v39, v39
    v_fmac_f32_dpp v88, v106, v28 row_newbcast:6 row_mask:0xf bank_mask:0xf
    v_fmac_f32_dpp v89, v106, v29 row_newbcast:6 row_mask:0xf bank_mask:0xf
    v_fmac_f32_dpp v90, v106, v30 row_newbcast:6 row_mask:0xf bank_mask:0xf
    v_fmac_f32_dpp v91, v106, v31 row_newbcast:6 row_mask:0xf bank_mask:0xf
    v_fmac_f32_dpp v92, v106, v32 row_newbcast:6 row_mask:0xf bank_mask:0xf
    v_fmac_f32_dpp v93, v106, v33 row_newbcast:6 row_mask:0xf bank_mask:0xf
    v_fmac_f32_dpp v94, v106, v34 row_newbcast:6 row_mask:0xf bank_mask:0xf
    v_fmac_f32_dpp v95, v106, v35 row_newbcast:6 row_mask:0xf bank_mask:0xf
    v_fmac_f32_dpp v96, v106, v36 row_newbcast:6 row_mask:0xf bank_mask:0xf
    v_fmac_f32_dpp v97, v106, v37 row_newbcast:6 row_mask:0xf bank_mask:0xf
    v_fmac_f32_dpp v98, v106, v38 row_newbcast:6 row_mask:0xf bank_mask:0xf
    v_fmac_f32_dpp v99, v106, v39 row_newbcast:6 row_mask:0xf bank_mask:0xf
    buffer_load_dwordx4 v[28:31], v1, s[28:31], s61 offen offset:0
    buffer_load_dwordx4 v[32:35], v1, s[28:31], s61 offen offset:256
    buffer_load_dwordx4 v[36:39], v1, s[28:31], s61 offen offset:512
    s_waitcnt vmcnt(9)
    v_cvt_f32_i32 v40, v40
    v_cvt_f32_i32 v41, v41
    v_cvt_f32_i32 v42, v42
    v_cvt_f32_i32 v43, v43
    v_cvt_f32_i32 v44, v44
    v_cvt_f32_i32 v45, v45
    v_cvt_f32_i32 v46, v46
    v_cvt_f32_i32 v47, v47
    v_cvt_f32_i32 v48, v48
    v_cvt_f32_i32 v49, v49
    v_cvt_f32_i32 v50, v50
    v_cvt_f32_i32 v51, v51
    v_fmac_f32_dpp v88, v106, v40 row_newbcast:14 row_mask:0xf bank_mask:0xf
    v_fmac_f32_dpp v89, v106, v41 row_newbcast:14 row_mask:0xf bank_mask:0xf
    v_fmac_f32_dpp v90, v106, v42 row_newbcast:14 row_mask:0xf bank_mask:0xf
    v_fmac_f32_dpp v91, v106, v43 row_newbcast:14 row_mask:0xf bank_mask:0xf
    v_fmac_f32_dpp v92, v106, v44 row_newbcast:14 row_mask:0xf bank_mask:0xf
    v_fmac_f32_dpp v93, v106, v45 row_newbcast:14 row_mask:0xf bank_mask:0xf
    v_fmac_f32_dpp v94, v106, v46 row_newbcast:14 row_mask:0xf bank_mask:0xf
    v_fmac_f32_dpp v95, v106, v47 row_newbcast:14 row_mask:0xf bank_mask:0xf
    v_fmac_f32_dpp v96, v106, v48 row_newbcast:14 row_mask:0xf bank_mask:0xf
    v_fmac_f32_dpp v97, v106, v49 row_newbcast:14 row_mask:0xf bank_mask:0xf
    v_fmac_f32_dpp v98, v106, v50 row_newbcast:14 row_mask:0xf bank_mask:0xf
    v_fmac_f32_dpp v99, v106, v51 row_newbcast:14 row_mask:0xf bank_mask:0xf
    buffer_load_dwordx4 v[40:43], v1, s[28:31], s61 offen offset:3072
    buffer_load_dwordx4 v[44:47], v1, s[28:31], s61 offen offset:3328
    buffer_load_dwordx4 v[48:51], v1, s[28:31], s61 offen offset:3584
    s_add_u32 s61, s61, 6144
    s_waitcnt vmcnt(9)
    v_cvt_f32_i32 v4, v4
    v_cvt_f32_i32 v5, v5
    v_cvt_f32_i32 v6, v6
    v_cvt_f32_i32 v7, v7
    v_cvt_f32_i32 v8, v8
    v_cvt_f32_i32 v9, v9
    v_cvt_f32_i32 v10, v10
    v_cvt_f32_i32 v11, v11
    v_cvt_f32_i32 v12, v12
    v_cvt_f32_i32 v13, v13
    v_cvt_f32_i32 v14, v14
    v_cvt_f32_i32 v15, v15
    v_fmac_f32_dpp v88, v106, v4 row_newbcast:1 row_mask:0xf bank_mask:0xf
    v_fmac_f32_dpp v89, v106, v5 row_newbcast:1 row_mask:0xf bank_mask:0xf
    v_fmac_f32_dpp v90, v106, v6 row_newbcast:1 row_mask:0xf bank_mask:0xf
    v_fmac_f32_dpp v91, v106, v7 row_newbcast:1 row_mask:0xf bank_mask:0xf
    v_fmac_f32_dpp v92, v106, v8 row_newbcast:1 row_mask:0xf bank_mask:0xf
    v_fmac_f32_dpp v93, v106, v9 row_newbcast:1 row_mask:0xf bank_mask:0xf
    v_fmac_f32_dpp v94, v106, v10 row_newbcast:1 row_mask:0xf bank_mask:0xf
    v_fmac_f32_dpp v95, v106, v11 row_newbcast:1 row_mask:0xf bank_mask:0xf
    v_fmac_f32_dpp v96, v106, v12 row_newbcast:1 row_mask:0xf bank_mask:0xf
    v_fmac_f32_dpp v97, v106, v13 row_newbcast:1 row_mask:0xf bank_mask:0xf
    v_fmac_f32_dpp v98, v106, v14 row_newbcast:1 row_mask:0xf bank_mask:0xf
    v_fmac_f32_dpp v99, v106, v15 row_newbcast:1 row_mask:0xf bank_mask:0xf
    buffer_load_dwordx4 v[4:7], v1, s[28:31], s61 offen offset:0
    buffer_load_dwordx4 v[8:11], v1, s[28:31], s61 offen offset:256
    buffer_load_dwordx4 v[12:15], v1, s[28:31], s61 offen offset:512
    s_waitcnt vmcnt(9)
    v_cvt_f32_i32 v16, v16
    v_cvt_f32_i32 v17, v17
    v_cvt_f32_i32 v18, v18
    v_cvt_f32_i32 v19, v19
    v_cvt_f32_i32 v20, v20
    v_cvt_f32_i32 v21, v21
    v_cvt_f32_i32 v22, v22
    v_cvt_f32_i32 v23, v23
    v_cvt_f32_i32 v24, v24
    v_cvt_f32_i32 v25, v25
    v_cvt_f32_i32 v26, v26
    v_cvt_f32_i32 v27, v27
    v_fmac_f32_dpp v88, v106, v16 row_newbcast:9 row_mask:0xf bank_mask:0xf
    v_fmac_f32_dpp v89, v106, v17 row_newbcast:9 row_mask:0xf bank_mask:0xf
    v_fmac_f32_dpp v90, v106, v18 row_newbcast:9 row_mask:0xf bank_mask:0xf
    v_fmac_f32_dpp v91, v106, v19 row_newbcast:9 row_mask:0xf bank_mask:0xf
    v_fmac_f32_dpp v92, v106, v20 row_newbcast:9 row_mask:0xf bank_mask:0xf
    v_fmac_f32_dpp v93, v106, v21 row_newbcast:9 row_mask:0xf bank_mask:0xf
    v_fmac_f32_dpp v94, v106, v22 row_newbcast:9 row_mask:0xf bank_mask:0xf
    v_fmac_f32_dpp v95, v106, v23 row_newbcast:9 row_mask:0xf bank_mask:0xf
    v_fmac_f32_dpp v96, v106, v24 row_newbcast:9 row_mask:0xf bank_mask:0xf
    v_fmac_f32_dpp v97, v106, v25 row_newbcast:9 row_mask:0xf bank_mask:0xf
    v_fmac_f32_dpp v98, v106, v26 row_newbcast:9 row_mask:0xf bank_mask:0xf
    v_fmac_f32_dpp v99, v106, v27 row_newbcast:9 row_mask:0xf bank_mask:0xf
    buffer_load_dwordx4 v[16:19], v1, s[28:31], s61 offen offset:3072
    buffer_load_dwordx4 v[20:23], v1, s[28:31], s61 offen offset:3328
    buffer_load_dwordx4 v[24:27], v1, s[28:31], s61 offen offset:3584
    s_add_u32 s61, s61, 6144
    s_waitcnt vmcnt(9)
    v_cvt_f32_i32 v28, v28
    v_cvt_f32_i32 v29, v29
    v_cvt_f32_i32 v30, v30
    v_cvt_f32_i32 v31, v31
    v_cvt_f32_i32 v32, v32
    v_cvt_f32_i32 v33, v33
    v_cvt_f32_i32 v34, v34
    v_cvt_f32_i32 v35, v35
    v_cvt_f32_i32 v36, v36
    v_cvt_f32_i32 v37, v37
    v_cvt_f32_i32 v38, v38
    v_cvt_f32_i32 v39, v39
    v_fmac_f32_dpp v88, v106, v28 row_newbcast:5 row_mask:0xf bank_mask:0xf
    v_fmac_f32_dpp v89, v106, v29 row_newbcast:5 row_mask:0xf bank_mask:0xf
    v_fmac_f32_dpp v90, v106, v30 row_newbcast:5 row_mask:0xf bank_mask:0xf
    v_fmac_f32_dpp v91, v106, v31 row_newbcast:5 row_mask:0xf bank_mask:0xf
    v_fmac_f32_dpp v92, v106, v32 row_newbcast:5 row_mask:0xf bank_mask:0xf
    v_fmac_f32_dpp v93, v106, v33 row_newbcast:5 row_mask:0xf bank_mask:0xf
    v_fmac_f32_dpp v94, v106, v34 row_newbcast:5 row_mask:0xf bank_mask:0xf
    v_fmac_f32_dpp v95, v106, v35 row_newbcast:5 row_mask:0xf bank_mask:0xf
    v_fmac_f32_dpp v96, v106, v36 row_newbcast:5 row_mask:0xf bank_mask:0xf
    v_fmac_f32_dpp v97, v106, v37 row_newbcast:5 row_mask:0xf bank_mask:0xf
    v_fmac_f32_dpp v98, v106, v38 row_newbcast:5 row_mask:0xf bank_mask:0xf
    v_fmac_f32_dpp v99, v106, v39 row_newbcast:5 row_mask:0xf bank_mask:0xf
    buffer_load_dwordx4 v[28:31], v1, s[28:31], s61 offen offset:0
    buffer_load_dwordx4 v[32:35], v1, s[28:31], s61 offen offset:256
    buffer_load_dwordx4 v[36:39], v1, s[28:31], s61 offen offset:512
    s_waitcnt vmcnt(9)
    v_cvt_f32_i32 v40, v40
    v_cvt_f32_i32 v41, v41
    v_cvt_f32_i32 v42, v42
    v_cvt_f32_i32 v43, v43
    v_cvt_f32_i32 v44, v44
    v_cvt_f32_i32 v45, v45
    v_cvt_f32_i32 v46, v46
    v_cvt_f32_i32 v47, v47
    v_cvt_f32_i32 v48, v48
    v_cvt_f32_i32 v49, v49
    v_cvt_f32_i32 v50, v50
    v_cvt_f32_i32 v51, v51
    v_fmac_f32_dpp v88, v106, v40 row_newbcast:13 row_mask:0xf bank_mask:0xf
    v_fmac_f32_dpp v89, v106, v41 row_newbcast:13 row_mask:0xf bank_mask:0xf
    v_fmac_f32_dpp v90, v106, v42 row_newbcast:13 row_mask:0xf bank_mask:0xf
    v_fmac_f32_dpp v91, v106, v43 row_newbcast:13 row_mask:0xf bank_mask:0xf
    v_fmac_f32_dpp v92, v106, v44 row_newbcast:13 row_mask:0xf bank_mask:0xf
    v_fmac_f32_dpp v93, v106, v45 row_newbcast:13 row_mask:0xf bank_mask:0xf
    v_fmac_f32_dpp v94, v106, v46 row_newbcast:13 row_mask:0xf bank_mask:0xf
    v_fmac_f32_dpp v95, v106, v47 row_newbcast:13 row_mask:0xf bank_mask:0xf
    v_fmac_f32_dpp v96, v106, v48 row_newbcast:13 row_mask:0xf bank_mask:0xf
    v_fmac_f32_dpp v97, v106, v49 row_newbcast:13 row_mask:0xf bank_mask:0xf
    v_fmac_f32_dpp v98, v106, v50 row_newbcast:13 row_mask:0xf bank_mask:0xf
    v_fmac_f32_dpp v99, v106, v51 row_newbcast:13 row_mask:0xf bank_mask:0xf
    buffer_load_dwordx4 v[40:43], v1, s[28:31], s61 offen offset:3072
    buffer_load_dwordx4 v[44:47], v1, s[28:31], s61 offen offset:3328
    buffer_load_dwordx4 v[48:51], v1, s[28:31], s61 offen offset:3584
    s_add_u32 s61, s61, 6144
    s_waitcnt vmcnt(9)
    v_cvt_f32_i32 v4, v4
    v_cvt_f32_i32 v5, v5
    v_cvt_f32_i32 v6, v6
    v_cvt_f32_i32 v7, v7
    v_cvt_f32_i32 v8, v8
    v_cvt_f32_i32 v9, v9
    v_cvt_f32_i32 v10, v10
    v_cvt_f32_i32 v11, v11
    v_cvt_f32_i32 v12, v12
    v_cvt_f32_i32 v13, v13
    v_cvt_f32_i32 v14, v14
    v_cvt_f32_i32 v15, v15
    v_fmac_f32_dpp v88, v106, v4 row_newbcast:3 row_mask:0xf bank_mask:0xf
    v_fmac_f32_dpp v89, v106, v5 row_newbcast:3 row_mask:0xf bank_mask:0xf
    v_fmac_f32_dpp v90, v106, v6 row_newbcast:3 row_mask:0xf bank_mask:0xf
    v_fmac_f32_dpp v91, v106, v7 row_newbcast:3 row_mask:0xf bank_mask:0xf
    v_fmac_f32_dpp v92, v106, v8 row_newbcast:3 row_mask:0xf bank_mask:0xf
    v_fmac_f32_dpp v93, v106, v9 row_newbcast:3 row_mask:0xf bank_mask:0xf
    v_fmac_f32_dpp v94, v106, v10 row_newbcast:3 row_mask:0xf bank_mask:0xf
    v_fmac_f32_dpp v95, v106, v11 row_newbcast:3 row_mask:0xf bank_mask:0xf
    v_fmac_f32_dpp v96, v106, v12 row_newbcast:3 row_mask:0xf bank_mask:0xf
    v_fmac_f32_dpp v97, v106, v13 row_newbcast:3 row_mask:0xf bank_mask:0xf
    v_fmac_f32_dpp v98, v106, v14 row_newbcast:3 row_mask:0xf bank_mask:0xf
    v_fmac_f32_dpp v99, v106, v15 row_newbcast:3 row_mask:0xf bank_mask:0xf
    s_waitcnt vmcnt(6)
    v_cvt_f32_i32 v16, v16
    v_cvt_f32_i32 v17, v17
    v_cvt_f32_i32 v18, v18
    v_cvt_f32_i32 v19, v19
    v_cvt_f32_i32 v20, v20
    v_cvt_f32_i32 v21, v21
    v_cvt_f32_i32 v22, v22
    v_cvt_f32_i32 v23, v23
    v_cvt_f32_i32 v24, v24
    v_cvt_f32_i32 v25, v25
    v_cvt_f32_i32 v26, v26
    v_cvt_f32_i32 v27, v27
    v_fmac_f32_dpp v88, v106, v16 row_newbcast:11 row_mask:0xf bank_mask:0xf
    v_fmac_f32_dpp v89, v106, v17 row_newbcast:11 row_mask:0xf bank_mask:0xf
    v_fmac_f32_dpp v90, v106, v18 row_newbcast:11 row_mask:0xf bank_mask:0xf
    v_fmac_f32_dpp v91, v106, v19 row_newbcast:11 row_mask:0xf bank_mask:0xf
    v_fmac_f32_dpp v92, v106, v20 row_newbcast:11 row_mask:0xf bank_mask:0xf
    v_fmac_f32_dpp v93, v106, v21 row_newbcast:11 row_mask:0xf bank_mask:0xf
    v_fmac_f32_dpp v94, v106, v22 row_newbcast:11 row_mask:0xf bank_mask:0xf
    v_fmac_f32_dpp v95, v106, v23 row_newbcast:11 row_mask:0xf bank_mask:0xf
    v_fmac_f32_dpp v96, v106, v24 row_newbcast:11 row_mask:0xf bank_mask:0xf
    v_fmac_f32_dpp v97, v106, v25 row_newbcast:11 row_mask:0xf bank_mask:0xf
    v_fmac_f32_dpp v98, v106, v26 row_newbcast:11 row_mask:0xf bank_mask:0xf
    v_fmac_f32_dpp v99, v106, v27 row_newbcast:11 row_mask:0xf bank_mask:0xf
    s_waitcnt vmcnt(3)
    v_cvt_f32_i32 v28, v28
    v_cvt_f32_i32 v29, v29
    v_cvt_f32_i32 v30, v30
    v_cvt_f32_i32 v31, v31
    v_cvt_f32_i32 v32, v32
    v_cvt_f32_i32 v33, v33
    v_cvt_f32_i32 v34, v34
    v_cvt_f32_i32 v35, v35
    v_cvt_f32_i32 v36, v36
    v_cvt_f32_i32 v37, v37
    v_cvt_f32_i32 v38, v38
    v_cvt_f32_i32 v39, v39
    v_fmac_f32_dpp v88, v106, v28 row_newbcast:7 row_mask:0xf bank_mask:0xf
    v_fmac_f32_dpp v89, v106, v29 row_newbcast:7 row_mask:0xf bank_mask:0xf
    v_fmac_f32_dpp v90, v106, v30 row_newbcast:7 row_mask:0xf bank_mask:0xf
    v_fmac_f32_dpp v91, v106, v31 row_newbcast:7 row_mask:0xf bank_mask:0xf
    v_fmac_f32_dpp v92, v106, v32 row_newbcast:7 row_mask:0xf bank_mask:0xf
    v_fmac_f32_dpp v93, v106, v33 row_newbcast:7 row_mask:0xf bank_mask:0xf
    v_fmac_f32_dpp v94, v106, v34 row_newbcast:7 row_mask:0xf bank_mask:0xf
    v_fmac_f32_dpp v95, v106, v35 row_newbcast:7 row_mask:0xf bank_mask:0xf
    v_fmac_f32_dpp v96, v106, v36 row_newbcast:7 row_mask:0xf bank_mask:0xf
    v_fmac_f32_dpp v97, v106, v37 row_newbcast:7 row_mask:0xf bank_mask:0xf
    v_fmac_f32_dpp v98, v106, v38 row_newbcast:7 row_mask:0xf bank_mask:0xf
    v_fmac_f32_dpp v99, v106, v39 row_newbcast:7 row_mask:0xf bank_mask:0xf
    s_waitcnt vmcnt(0)
    v_cvt_f32_i32 v40, v40
    v_cvt_f32_i32 v41, v41
    v_cvt_f32_i32 v42, v42
    v_cvt_f32_i32 v43, v43
    v_cvt_f32_i32 v44, v44
    v_cvt_f32_i32 v45, v45
    v_cvt_f32_i32 v46, v46
    v_cvt_f32_i32 v47, v47
    v_cvt_f32_i32 v48, v48
    v_cvt_f32_i32 v49, v49
    v_cvt_f32_i32 v50, v50
    v_cvt_f32_i32 v51, v51
    v_fmac_f32_dpp v88, v106, v40 row_newbcast:15 row_mask:0xf bank_mask:0xf
    v_fmac_f32_dpp v89, v106, v41 row_newbcast:15 row_mask:0xf bank_mask:0xf
    v_fmac_f32_dpp v90, v106, v42 row_newbcast:15 row_mask:0xf bank_mask:0xf
    v_fmac_f32_dpp v91, v106, v43 row_newbcast:15 row_mask:0xf bank_mask:0xf
    v_fmac_f32_dpp v92, v106, v44 row_newbcast:15 row_mask:0xf bank_mask:0xf
    v_fmac_f32_dpp v93, v106, v45 row_newbcast:15 row_mask:0xf bank_mask:0xf
    v_fmac_f32_dpp v94, v106, v46 row_newbcast:15 row_mask:0xf bank_mask:0xf
    v_fmac_f32_dpp v95, v106, v47 row_newbcast:15 row_mask:0xf bank_mask:0xf
    v_fmac_f32_dpp v96, v106, v48 row_newbcast:15 row_mask:0xf bank_mask:0xf
    v_fmac_f32_dpp v97, v106, v49 row_newbcast:15 row_mask:0xf bank_mask:0xf
    v_fmac_f32_dpp v98, v106, v50 row_newbcast:15 row_mask:0xf bank_mask:0xf
    v_fmac_f32_dpp v99, v106, v51 row_newbcast:15 row_mask:0xf bank_mask:0xf
    s_nop 0
    v_add_f32_dpp v102, v102, v102 row_ror:8 row_mask:0xf bank_mask:0xf
    v_add_f32_dpp v103, v103, v103 row_ror:8 row_mask:0xf bank_mask:0xf
    s_nop 0
    v_add_f32_dpp v102, v102, v102 row_ror:4 row_mask:0xf bank_mask:0xf
    v_add_f32_dpp v103, v103, v103 row_ror:4 row_mask:0xf bank_mask:0xf
    s_nop 0
    v_add_f32_dpp v102, v102, v102 row_ror:2 row_mask:0xf bank_mask:0xf
    v_add_f32_dpp v103, v103, v103 row_ror:2 row_mask:0xf bank_mask:0xf
    s_nop 0
    v_add_f32_dpp v102, v102, v102 row_ror:1 row_mask:0xf bank_mask:0xf
    v_add_f32_dpp v103, v103, v103 row_ror:1 row_mask:0xf bank_mask:0xf
    v_mov_b32 v113, v101
    v_mov_b32 v114, v101
    s_nop 1
    v_permlane32_swap_b32 v113, v114
    s_nop 1
    v_max_f32 v113, v113, v114
    v_mov_b32 v114, v113
    s_nop 1
    v_permlane16_swap_b32 v113, v114
    s_nop 1
    v_max_f32 v113, v113, v114
    v_sub_f32 v114, v101, v113
    v_exp_f32 v114, v114
    v_mov_b32 v101, v113
    v_mul_f32 v102, v102, v114
    v_mul_f32 v103, v103, v114
    v_fma_f32 v88, v88, v114, -v103
    v_fma_f32 v89, v89, v114, -v103
    v_fma_f32 v90, v90, v114, -v103
    v_fma_f32 v91, v91, v114, -v103
    v_fma_f32 v92, v92, v114, -v103
    v_fma_f32 v93, v93, v114, -v103
    v_fma_f32 v94, v94, v114, -v103
    v_fma_f32 v95, v95, v114, -v103
    v_fma_f32 v96, v96, v114, -v103
    v_fma_f32 v97, v97, v114, -v103
    v_fma_f32 v98, v98, v114, -v103
    v_fma_f32 v99, v99, v114, -v103
    v_mov_b32 v113, v102
    s_nop 1
    v_permlane32_swap_b32 v102, v113
    v_permlane32_swap_b32 v88, v90
    v_permlane32_swap_b32 v89, v91
    v_permlane32_swap_b32 v92, v94
    v_permlane32_swap_b32 v93, v95
    v_permlane32_swap_b32 v96, v98
    v_permlane32_swap_b32 v97, v99
    s_nop 1
    v_add_f32 v102, v102, v113
    v_add_f32 v88, v88, v90
    v_add_f32 v89, v89, v91
    v_add_f32 v92, v92, v94
    v_add_f32 v93, v93, v95
    v_add_f32 v96, v96, v98
    v_add_f32 v97, v97, v99
    v_mov_b32 v113, v102
    s_nop 1
    v_permlane16_swap_b32 v102, v113
    v_permlane16_swap_b32 v88, v89
    v_permlane16_swap_b32 v92, v93
    v_permlane16_swap_b32 v96, v97
    s_nop 1
    v_add_f32 v102, v102, v113
    v_add_f32 v88, v88, v89
    v_add_f32 v92, v92, v93
    v_add_f32 v96, v96, v97
    v_and_b32 v114, 15, v0
    v_lshrrev_b32 v113, 4, v0
    v_lshlrev_b32 v113, 2, v113
    v_lshl_add_u32 v113, v114, 4, v113
    s_lshl_b32 s80, s58, 10
    v_add_u32 v114, s80, v113
    v_mov_b32 v108, s80
    v_mov_b32 v109, v102
    ds_write_b32 v114, v88 offset:0
    ds_write_b32 v114, v92 offset:256
    ds_write_b32 v114, v96 offset:512
    ds_write_b32 v108, v101 offset:768
    ds_write_b32 v108, v102 offset:772
    s_waitcnt lgkmcnt(0)
    s_barrier
    s_cmp_lg_u32 s58, 0
    s_cbranch_scc1 L_end
    v_lshlrev_b32 v113, 2, v0
    v_mov_b32 v114, 0
    ds_read_b64 v[4:5], v114 offset:768
    ds_read_b64 v[6:7], v114 offset:1792
    ds_read_b64 v[8:9], v114 offset:2816
    ds_read_b64 v[10:11], v114 offset:3840
    ds_read_b64 v[12:13], v114 offset:4864
    ds_read_b64 v[14:15], v114 offset:5888
    ds_read_b64 v[16:17], v114 offset:6912
    ds_read_b64 v[18:19], v114 offset:7936
    ds_read_b64 v[20:21], v114 offset:8960
    ds_read_b64 v[22:23], v114 offset:9984
    ds_read_b64 v[24:25], v114 offset:11008
    ds_read_b64 v[26:27], v114 offset:12032
    ds_read_b64 v[28:29], v114 offset:13056
    ds_read_b64 v[30:31], v114 offset:14080
    ds_read_b64 v[32:33], v114 offset:15104
    ds_read_b64 v[34:35], v114 offset:16128
    ds_read_b32 v36, v113 offset:0
    ds_read_b32 v37, v113 offset:256
    ds_read_b32 v38, v113 offset:512
    ds_read_b32 v39, v113 offset:1024
    ds_read_b32 v40, v113 offset:1280
    ds_read_b32 v41, v113 offset:1536
    ds_read_b32 v42, v113 offset:2048
    ds_read_b32 v43, v113 offset:2304
    ds_read_b32 v44, v113 offset:2560
    ds_read_b32 v45, v113 offset:3072
    ds_read_b32 v46, v113 offset:3328
    ds_read_b32 v47, v113 offset:3584
    ds_read_b32 v48, v113 offset:4096
    ds_read_b32 v49, v113 offset:4352
    ds_read_b32 v50, v113 offset:4608
    ds_read_b32 v51, v113 offset:5120
    ds_read_b32 v52, v113 offset:5376
    ds_read_b32 v53, v113 offset:5632
    ds_read_b32 v54, v113 offset:6144
    ds_read_b32 v55, v113 offset:6400
    ds_read_b32 v56, v113 offset:6656
    ds_read_b32 v57, v113 offset:7168
    ds_read_b32 v58, v113 offset:7424
    ds_read_b32 v59, v113 offset:7680
    ds_read_b32 v60, v113 offset:8192
    ds_read_b32 v61, v113 offset:8448
    ds_read_b32 v62, v113 offset:8704
    ds_read_b32 v63, v113 offset:9216
    ds_read_b32 v64, v113 offset:9472
    ds_read_b32 v65, v113 offset:9728
    ds_read_b32 v66, v113 offset:10240
    ds_read_b32 v67, v113 offset:10496
    ds_read_b32 v68, v113 offset:10752
    ds_read_b32 v69, v113 offset:11264
    ds_read_b32 v70, v113 offset:11520
    ds_read_b32 v71, v113 offset:11776
    ds_read_b32 v72, v113 offset:12288
    ds_read_b32 v73, v113 offset:12544
    ds_read_b32 v74, v113 offset:12800
    ds_read_b32 v75, v113 offset:13312
    ds_read_b32 v76, v113 offset:13568
    ds_read_b32 v77, v113 offset:13824
    ds_read_b32 v78, v113 offset:14336
    ds_read_b32 v79, v113 offset:14592
    ds_read_b32 v80, v113 offset:14848
    ds_read_b32 v81, v113 offset:15360
    ds_read_b32 v82, v113 offset:15616
    ds_read_b32 v83, v113 offset:15872
    s_waitcnt lgkmcnt(0)
    v_mov_b32 v101, v4
    v_max_f32 v101, v101, v6
    v_max_f32 v101, v101, v8
    v_max_f32 v101, v101, v10
    v_max_f32 v101, v101, v12
    v_max_f32 v101, v101, v14
    v_max_f32 v101, v101, v16
    v_max_f32 v101, v101, v18
    v_max_f32 v101, v101, v20
    v_max_f32 v101, v101, v22
    v_max_f32 v101, v101, v24
    v_max_f32 v101, v101, v26
    v_max_f32 v101, v101, v28
    v_max_f32 v101, v101, v30
    v_max_f32 v101, v101, v32
    v_max_f32 v101, v101, v34
    v_sub_f32 v4, v4, v101
    v_sub_f32 v6, v6, v101
    v_sub_f32 v8, v8, v101
    v_sub_f32 v10, v10, v101
    v_sub_f32 v12, v12, v101
    v_sub_f32 v14, v14, v101
    v_sub_f32 v16, v16, v101
    v_sub_f32 v18, v18, v101
    v_sub_f32 v20, v20, v101
    v_sub_f32 v22, v22, v101
    v_sub_f32 v24, v24, v101
    v_sub_f32 v26, v26, v101
    v_sub_f32 v28, v28, v101
    v_sub_f32 v30, v30, v101
    v_sub_f32 v32, v32, v101
    v_sub_f32 v34, v34, v101
    v_exp_f32 v4, v4
    v_exp_f32 v6, v6
    v_exp_f32 v8, v8
    v_exp_f32 v10, v10
    v_exp_f32 v12, v12
    v_exp_f32 v14, v14
    v_exp_f32 v16, v16
    v_exp_f32 v18, v18
    v_exp_f32 v20, v20
    v_exp_f32 v22, v22
    v_exp_f32 v24, v24
    v_exp_f32 v26, v26
    v_exp_f32 v28, v28
    v_exp_f32 v30, v30
    v_exp_f32 v32, v32
    v_exp_f32 v34, v34
    s_nop 0
    v_mul_f32 v102, v4, v5
    v_mul_f32 v88, v4, v36
    v_mul_f32 v89, v4, v37
    v_mul_f32 v90, v4, v38
    v_fmac_f32 v102, v6, v7
    v_fmac_f32 v88, v6, v39
    v_fmac_f32 v89, v6, v40
    v_fmac_f32 v90, v6, v41
    v_fmac_f32 v102, v8, v9
    v_fmac_f32 v88, v8, v42
    v_fmac_f32 v89, v8, v43
    v_fmac_f32 v90, v8, v44
    v_fmac_f32 v102, v10, v11
    v_fmac_f32 v88, v10, v45
    v_fmac_f32 v89, v10, v46
    v_fmac_f32 v90, v10, v47
    v_fmac_f32 v102, v12, v13
    v_fmac_f32 v88, v12, v48
    v_fmac_f32 v89, v12, v49
    v_fmac_f32 v90, v12, v50
    v_fmac_f32 v102, v14, v15
    v_fmac_f32 v88, v14, v51
    v_fmac_f32 v89, v14, v52
    v_fmac_f32 v90, v14, v53
    v_fmac_f32 v102, v16, v17
    v_fmac_f32 v88, v16, v54
    v_fmac_f32 v89, v16, v55
    v_fmac_f32 v90, v16, v56
    v_fmac_f32 v102, v18, v19
    v_fmac_f32 v88, v18, v57
    v_fmac_f32 v89, v18, v58
    v_fmac_f32 v90, v18, v59
    v_fmac_f32 v102, v20, v21
    v_fmac_f32 v88, v20, v60
    v_fmac_f32 v89, v20, v61
    v_fmac_f32 v90, v20, v62
    v_fmac_f32 v102, v22, v23
    v_fmac_f32 v88, v22, v63
    v_fmac_f32 v89, v22, v64
    v_fmac_f32 v90, v22, v65
    v_fmac_f32 v102, v24, v25
    v_fmac_f32 v88, v24, v66
    v_fmac_f32 v89, v24, v67
    v_fmac_f32 v90, v24, v68
    v_fmac_f32 v102, v26, v27
    v_fmac_f32 v88, v26, v69
    v_fmac_f32 v89, v26, v70
    v_fmac_f32 v90, v26, v71
    v_fmac_f32 v102, v28, v29
    v_fmac_f32 v88, v28, v72
    v_fmac_f32 v89, v28, v73
    v_fmac_f32 v90, v28, v74
    v_fmac_f32 v102, v30, v31
    v_fmac_f32 v88, v30, v75
    v_fmac_f32 v89, v30, v76
    v_fmac_f32 v90, v30, v77
    v_fmac_f32 v102, v32, v33
    v_fmac_f32 v88, v32, v78
    v_fmac_f32 v89, v32, v79
    v_fmac_f32 v90, v32, v80
    v_fmac_f32 v102, v34, v35
    v_fmac_f32 v88, v34, v81
    v_fmac_f32 v89, v34, v82
    v_fmac_f32 v90, v34, v83
    s_lshl_b32 s80, s2, 10
    buffer_store_dword v88, v113, s[52:55], s80 offen offset:0 sc0 sc1
    buffer_store_dword v89, v113, s[52:55], s80 offen offset:256 sc0 sc1
    buffer_store_dword v90, v113, s[52:55], s80 offen offset:512 sc0 sc1
    v_mov_b32 v92, v101
    v_mov_b32 v93, v102
    v_cmp_eq_u32 vcc, 0, v0
    s_and_saveexec_b64 s[82:83], vcc
    buffer_store_dwordx2 v[92:93], v114, s[52:55], s80 offen offset:768 sc0 sc1
    s_waitcnt vmcnt(0)
    v_mov_b32 v108, 1
    s_lshl_b32 s81, s56, 2
    buffer_atomic_add v108, v114, s[76:79], s81 offen sc0 sc1
    s_waitcnt vmcnt(0)
    v_readfirstlane_b32 s81, v108
    s_mov_b64 exec, s[82:83]
    s_cmp_lg_u32 s81, 7
    s_cbranch_scc1 L_end
    s_lshl_b32 s80, s56, 13
    buffer_load_dwordx2 v[4:5], v114, s[52:55], s80 offen offset:768 sc0 sc1
    buffer_load_dword v20, v113, s[52:55], s80 offen offset:0 sc0 sc1
    buffer_load_dword v21, v113, s[52:55], s80 offen offset:256 sc0 sc1
    buffer_load_dword v22, v113, s[52:55], s80 offen offset:512 sc0 sc1
    buffer_load_dwordx2 v[6:7], v114, s[52:55], s80 offen offset:1792 sc0 sc1
    buffer_load_dword v23, v113, s[52:55], s80 offen offset:1024 sc0 sc1
    buffer_load_dword v24, v113, s[52:55], s80 offen offset:1280 sc0 sc1
    buffer_load_dword v25, v113, s[52:55], s80 offen offset:1536 sc0 sc1
    buffer_load_dwordx2 v[8:9], v114, s[52:55], s80 offen offset:2816 sc0 sc1
    buffer_load_dword v26, v113, s[52:55], s80 offen offset:2048 sc0 sc1
    buffer_load_dword v27, v113, s[52:55], s80 offen offset:2304 sc0 sc1
    buffer_load_dword v28, v113, s[52:55], s80 offen offset:2560 sc0 sc1
    buffer_load_dwordx2 v[10:11], v114, s[52:55], s80 offen offset:3840 sc0 sc1
    buffer_load_dword v29, v113, s[52:55], s80 offen offset:3072 sc0 sc1
    buffer_load_dword v30, v113, s[52:55], s80 offen offset:3328 sc0 sc1
    buffer_load_dword v31, v113, s[52:55], s80 offen offset:3584 sc0 sc1
    s_add_u32 s80, s80, 4096
    buffer_load_dwordx2 v[12:13], v114, s[52:55], s80 offen offset:768 sc0 sc1
    buffer_load_dword v32, v113, s[52:55], s80 offen offset:0 sc0 sc1
    buffer_load_dword v33, v113, s[52:55], s80 offen offset:256 sc0 sc1
    buffer_load_dword v34, v113, s[52:55], s80 offen offset:512 sc0 sc1
    buffer_load_dwordx2 v[14:15], v114, s[52:55], s80 offen offset:1792 sc0 sc1
    buffer_load_dword v35, v113, s[52:55], s80 offen offset:1024 sc0 sc1
    buffer_load_dword v36, v113, s[52:55], s80 offen offset:1280 sc0 sc1
    buffer_load_dword v37, v113, s[52:55], s80 offen offset:1536 sc0 sc1
    buffer_load_dwordx2 v[16:17], v114, s[52:55], s80 offen offset:2816 sc0 sc1
    buffer_load_dword v38, v113, s[52:55], s80 offen offset:2048 sc0 sc1
    buffer_load_dword v39, v113, s[52:55], s80 offen offset:2304 sc0 sc1
    buffer_load_dword v40, v113, s[52:55], s80 offen offset:2560 sc0 sc1
    buffer_load_dwordx2 v[18:19], v114, s[52:55], s80 offen offset:3840 sc0 sc1
    buffer_load_dword v41, v113, s[52:55], s80 offen offset:3072 sc0 sc1
    buffer_load_dword v42, v113, s[52:55], s80 offen offset:3328 sc0 sc1
    buffer_load_dword v43, v113, s[52:55], s80 offen offset:3584 sc0 sc1
    s_waitcnt vmcnt(0)
    v_mov_b32 v101, v4
    v_max_f32 v101, v101, v6
    v_max_f32 v101, v101, v8
    v_max_f32 v101, v101, v10
    v_max_f32 v101, v101, v12
    v_max_f32 v101, v101, v14
    v_max_f32 v101, v101, v16
    v_max_f32 v101, v101, v18
    v_sub_f32 v4, v4, v101
    v_sub_f32 v6, v6, v101
    v_sub_f32 v8, v8, v101
    v_sub_f32 v10, v10, v101
    v_sub_f32 v12, v12, v101
    v_sub_f32 v14, v14, v101
    v_sub_f32 v16, v16, v101
    v_sub_f32 v18, v18, v101
    v_exp_f32 v4, v4
    v_exp_f32 v6, v6
    v_exp_f32 v8, v8
    v_exp_f32 v10, v10
    v_exp_f32 v12, v12
    v_exp_f32 v14, v14
    v_exp_f32 v16, v16
    v_exp_f32 v18, v18
    s_nop 0
    v_mul_f32 v102, v4, v5
    v_mul_f32 v88, v4, v20
    v_mul_f32 v89, v4, v21
    v_mul_f32 v90, v4, v22
    v_fmac_f32 v102, v6, v7
    v_fmac_f32 v88, v6, v23
    v_fmac_f32 v89, v6, v24
    v_fmac_f32 v90, v6, v25
    v_fmac_f32 v102, v8, v9
    v_fmac_f32 v88, v8, v26
    v_fmac_f32 v89, v8, v27
    v_fmac_f32 v90, v8, v28
    v_fmac_f32 v102, v10, v11
    v_fmac_f32 v88, v10, v29
    v_fmac_f32 v89, v10, v30
    v_fmac_f32 v90, v10, v31
    v_fmac_f32 v102, v12, v13
    v_fmac_f32 v88, v12, v32
    v_fmac_f32 v89, v12, v33
    v_fmac_f32 v90, v12, v34
    v_fmac_f32 v102, v14, v15
    v_fmac_f32 v88, v14, v35
    v_fmac_f32 v89, v14, v36
    v_fmac_f32 v90, v14, v37
    v_fmac_f32 v102, v16, v17
    v_fmac_f32 v88, v16, v38
    v_fmac_f32 v89, v16, v39
    v_fmac_f32 v90, v16, v40
    v_fmac_f32 v102, v18, v19
    v_fmac_f32 v88, v18, v41
    v_fmac_f32 v89, v18, v42
    v_fmac_f32 v90, v18, v43
    v_rcp_f32 v102, v102
    s_mul_i32 s80, s56, 384
    v_lshrrev_b32 v113, 1, v113
    v_mul_f32 v88, v88, v102
    v_mul_f32 v89, v89, v102
    v_mul_f32 v90, v90, v102
    v_cvt_pk_bf16_f32 v88, v88, v88
    v_cvt_pk_bf16_f32 v89, v89, v89
    v_cvt_pk_bf16_f32 v90, v90, v90
    buffer_store_short v88, v113, s[72:75], s80 offen offset:0
    buffer_store_short v89, v113, s[72:75], s80 offen offset:128
    buffer_store_short v90, v113, s[72:75], s80 offen offset:256
L_end:
    s_endpgm
.section .rodata,"a"
.p2align 6
.amdhsa_kernel standalone__kv_cache_quant_int4_int2_kv_with_per_channel_or_per_token_scales__decode_kernel
  .amdhsa_next_free_vgpr 115
  .amdhsa_next_free_sgpr 88
  .amdhsa_accum_offset 116
  .amdhsa_group_segment_fixed_size 0
  .amdhsa_kernarg_size 80
  .amdhsa_user_sgpr_count 2
  .amdhsa_user_sgpr_kernarg_segment_ptr 1
  .amdhsa_system_sgpr_workgroup_id_x 1
.end_amdhsa_kernel
```

```asm
; @launch grid=(256,1,1) block=(1024,1,1) lds=16384
.amdgcn_target "amdgcn-amd-amdhsa--gfx950"
.text
.globl standalone__kv_cache_quant_int4_int2_kv_with_per_channel_or_per_token_scales__decode_kernel
.p2align 8
.type standalone__kv_cache_quant_int4_int2_kv_with_per_channel_or_per_token_scales__decode_kernel,@function
standalone__kv_cache_quant_int4_int2_kv_with_per_channel_or_per_token_scales__decode_kernel:
    s_cmp_ge_u32 s2, 256
    s_cbranch_scc1 L_end
    s_load_dwordx16 s[4:19], s[0:1], 0
    s_load_dwordx4 s[20:23], s[0:1], 64
    v_lshrrev_b32 v113, 6, v0
    v_and_b32 v0, 63, v0
    v_readfirstlane_b32 s58, v113
    v_and_b32 v114, 15, v0
    v_lshrrev_b32 v113, 4, v0
    v_mul_u32_u24 v1, 768, v113
    v_lshl_add_u32 v1, v114, 4, v1
    v_lshlrev_b32 v2, 3, v114
    v_bfrev_b32 v3, v114
    v_lshrrev_b32 v3, 28, v3
    v_lshl_add_u32 v3, v3, 2, v113
    v_lshlrev_b32 v3, 1, v3
    s_lshr_b32 s56, s2, 3
    s_and_b32 s57, s2, 7
    s_mul_i32 s59, s57, 16
    s_add_u32 s59, s59, s58
    s_mul_i32 s59, s59, 4
    s_lshl_b32 s80, s56, 9
    s_add_u32 s59, s59, s80
    s_mul_i32 s60, s59, 49152
    s_mov_b32 s61, s60
    s_mul_i32 s62, s59, 384
    s_lshl_b32 s63, s59, 7
    s_mul_i32 s80, s56, 384
    s_mov_b32 s66, 0xcccccccc
    s_mov_b32 s67, 0xcccccccc
    s_mov_b32 s68, 0xaaaaaaaa
    s_mov_b32 s69, 0xaaaaaaaa
    s_waitcnt lgkmcnt(0)
    s_mov_b32 s24, s6
    s_and_b32 s25, s7, 0xffff
    s_mov_b32 s26, 805306368
    s_mov_b32 s27, 0x00020000
    s_mov_b32 s32, s10
    s_and_b32 s33, s11, 0xffff
    s_mov_b32 s34, 6291456
    s_mov_b32 s35, 0x00020000
    s_mov_b32 s36, s12
    s_and_b32 s37, s13, 0xffff
    s_mov_b32 s38, 6291456
    s_mov_b32 s39, 0x00020000
    s_mov_b32 s48, s4
    s_and_b32 s49, s5, 0xffff
    s_mov_b32 s50, 12288
    s_mov_b32 s51, 0x00020000
    buffer_load_dwordx2 v[88:89], v2, s[48:51], s80 offen offset:0
    buffer_load_dwordx2 v[90:91], v2, s[48:51], s80 offen offset:128
    buffer_load_dwordx2 v[92:93], v2, s[48:51], s80 offen offset:256
    buffer_load_dwordx2 v[76:77], v2, s[32:35], s62 offen offset:0
    buffer_load_dwordx2 v[78:79], v2, s[32:35], s62 offen offset:128
    buffer_load_dwordx2 v[80:81], v2, s[32:35], s62 offen offset:256
    buffer_load_dwordx2 v[82:83], v2, s[36:39], s62 offen offset:0
    buffer_load_dwordx2 v[84:85], v2, s[36:39], s62 offen offset:128
    buffer_load_dwordx2 v[86:87], v2, s[36:39], s62 offen offset:256
    s_add_u32 s62, s62, 384
    buffer_load_dwordx4 v[4:7], v1, s[24:27], s60 offen offset:0 nt
    buffer_load_dwordx4 v[8:11], v1, s[24:27], s60 offen offset:256 nt
    buffer_load_dwordx4 v[12:15], v1, s[24:27], s60 offen offset:512 nt
    s_mov_b32 s28, s8
    s_and_b32 s29, s9, 0xffff
    s_mov_b32 s30, 805306368
    s_mov_b32 s31, 0x00020000
    s_mov_b32 s40, s14
    s_and_b32 s41, s15, 0xffff
    s_mov_b32 s42, 2097152
    s_mov_b32 s43, 0x00020000
    s_mov_b32 s44, s16
    s_and_b32 s45, s17, 0xffff
    s_mov_b32 s46, 2097152
    s_mov_b32 s47, 0x00020000
    buffer_load_dwordx4 v[16:19], v1, s[24:27], s60 offen offset:3072 nt
    buffer_load_dwordx4 v[20:23], v1, s[24:27], s60 offen offset:3328 nt
    buffer_load_dwordx4 v[24:27], v1, s[24:27], s60 offen offset:3584 nt
    s_add_u32 s60, s60, 6144
    buffer_load_dwordx4 v[28:31], v1, s[24:27], s60 offen offset:0 nt
    buffer_load_dwordx4 v[32:35], v1, s[24:27], s60 offen offset:256 nt
    buffer_load_dwordx4 v[36:39], v1, s[24:27], s60 offen offset:512 nt
    buffer_load_dwordx4 v[40:43], v1, s[24:27], s60 offen offset:3072 nt
    buffer_load_dwordx4 v[44:47], v1, s[24:27], s60 offen offset:3328 nt
    buffer_load_dwordx4 v[48:51], v1, s[24:27], s60 offen offset:3584 nt
    s_add_u32 s60, s60, 6144
    s_mov_b32 s52, s22
    s_and_b32 s53, s23, 0xffff
    s_mov_b32 s54, 262144
    s_mov_b32 s55, 0x00020000
    s_mov_b32 s72, s18
    s_and_b32 s73, s19, 0xffff
    s_mov_b32 s74, 12288
    s_mov_b32 s75, 0x00020000
    s_mov_b32 s76, s20
    s_and_b32 s77, s21, 0xffff
    s_mov_b32 s78, 256
    s_mov_b32 s79, 0x00020000
    s_mov_b32 s80, 0x3dd53b95
    v_mov_b32 v101, 0xf149f2ca
    v_mov_b32 v102, 0
    v_mov_b32 v103, 0
    s_waitcnt vmcnt(18)
    v_lshlrev_b32 v52, 16, v88
    v_and_b32 v53, 0xffff0000, v88
    v_lshlrev_b32 v54, 16, v89
    v_and_b32 v55, 0xffff0000, v89
    v_lshlrev_b32 v56, 16, v90
    v_and_b32 v57, 0xffff0000, v90
    v_lshlrev_b32 v58, 16, v91
    v_and_b32 v59, 0xffff0000, v91
    v_lshlrev_b32 v60, 16, v92
    v_and_b32 v61, 0xffff0000, v92
    v_lshlrev_b32 v62, 16, v93
    v_and_b32 v63, 0xffff0000, v93
    v_mul_f32 v52, s80, v52
    v_mul_f32 v53, s80, v53
    v_mul_f32 v54, s80, v54
    v_mul_f32 v55, s80, v55
    v_mul_f32 v56, s80, v56
    v_mul_f32 v57, s80, v57
    v_mul_f32 v58, s80, v58
    v_mul_f32 v59, s80, v59
    v_mul_f32 v60, s80, v60
    v_mul_f32 v61, s80, v61
    v_mul_f32 v62, s80, v62
    v_mul_f32 v63, s80, v63
    v_mov_b32 v88, 0
    v_mov_b32 v89, 0
    v_mov_b32 v90, 0
    v_mov_b32 v91, 0
    v_mov_b32 v92, 0
    v_mov_b32 v93, 0
    v_mov_b32 v94, 0
    v_mov_b32 v95, 0
    v_mov_b32 v96, 0
    v_mov_b32 v97, 0
    v_mov_b32 v98, 0
    v_mov_b32 v99, 0
    s_mov_b32 s64, 3
    s_nop 0
L_loop:
    s_waitcnt vmcnt(9)
    v_lshlrev_b32 v113, 16, v76
    v_and_b32 v114, 0xffff0000, v76
    v_mul_f32 v64, v113, v52
    v_mul_f32 v65, v114, v53
    v_lshlrev_b32 v113, 16, v82
    v_and_b32 v114, 0xffff0000, v82
    v_mul_f32 v100, v64, v113
    v_fmac_f32 v100, v65, v114
    v_lshlrev_b32 v113, 16, v77
    v_and_b32 v114, 0xffff0000, v77
    v_mul_f32 v66, v113, v54
    v_mul_f32 v67, v114, v55
    v_lshlrev_b32 v113, 16, v83
    v_and_b32 v114, 0xffff0000, v83
    v_fmac_f32 v100, v66, v113
    v_fmac_f32 v100, v67, v114
    v_lshlrev_b32 v113, 16, v78
    v_and_b32 v114, 0xffff0000, v78
    v_mul_f32 v68, v113, v56
    v_mul_f32 v69, v114, v57
    v_lshlrev_b32 v113, 16, v84
    v_and_b32 v114, 0xffff0000, v84
    v_fmac_f32 v100, v68, v113
    v_fmac_f32 v100, v69, v114
    v_lshlrev_b32 v113, 16, v79
    v_and_b32 v114, 0xffff0000, v79
    v_mul_f32 v70, v113, v58
    v_mul_f32 v71, v114, v59
    v_lshlrev_b32 v113, 16, v85
    v_and_b32 v114, 0xffff0000, v85
    v_fmac_f32 v100, v70, v113
    v_fmac_f32 v100, v71, v114
    v_lshlrev_b32 v113, 16, v80
    v_and_b32 v114, 0xffff0000, v80
    v_mul_f32 v72, v113, v60
    v_mul_f32 v73, v114, v61
    v_lshlrev_b32 v113, 16, v86
    v_and_b32 v114, 0xffff0000, v86
    v_fmac_f32 v100, v72, v113
    v_fmac_f32 v100, v73, v114
    v_lshlrev_b32 v113, 16, v81
    v_and_b32 v114, 0xffff0000, v81
    v_mul_f32 v74, v113, v62
    v_mul_f32 v75, v114, v63
    v_lshlrev_b32 v113, 16, v87
    v_and_b32 v114, 0xffff0000, v87
    v_fmac_f32 v100, v74, v113
    v_fmac_f32 v100, v75, v114
    v_cvt_f32_i32 v4, v4
    v_cvt_f32_i32 v5, v5
    v_cvt_f32_i32 v6, v6
    v_cvt_f32_i32 v7, v7
    v_cvt_f32_i32 v8, v8
    v_cvt_f32_i32 v9, v9
    v_cvt_f32_i32 v10, v10
    v_cvt_f32_i32 v11, v11
    v_cvt_f32_i32 v12, v12
    v_cvt_f32_i32 v13, v13
    v_cvt_f32_i32 v14, v14
    v_cvt_f32_i32 v15, v15
    v_fma_f32 v107, v64, v4, -v100
    v_fmac_f32 v107, v65, v5
    v_fmac_f32 v107, v66, v6
    v_fmac_f32 v107, v67, v7
    v_fmac_f32 v107, v68, v8
    v_fmac_f32 v107, v69, v9
    v_fmac_f32 v107, v70, v10
    v_fmac_f32 v107, v71, v11
    v_fmac_f32 v107, v72, v12
    v_fmac_f32 v107, v73, v13
    v_fmac_f32 v107, v74, v14
    v_fmac_f32 v107, v75, v15
    buffer_load_dwordx4 v[4:7], v1, s[24:27], s60 offen offset:0 nt
    buffer_load_dwordx4 v[8:11], v1, s[24:27], s60 offen offset:256 nt
    buffer_load_dwordx4 v[12:15], v1, s[24:27], s60 offen offset:512 nt
    v_add_f32_dpp v108, v107, v107 row_ror:8 row_mask:0xf bank_mask:0x3
    s_waitcnt vmcnt(9)
    v_cvt_f32_i32 v16, v16
    v_cvt_f32_i32 v17, v17
    v_cvt_f32_i32 v18, v18
    v_cvt_f32_i32 v19, v19
    v_cvt_f32_i32 v20, v20
    v_cvt_f32_i32 v21, v21
    v_cvt_f32_i32 v22, v22
    v_cvt_f32_i32 v23, v23
    v_cvt_f32_i32 v24, v24
    v_cvt_f32_i32 v25, v25
    v_cvt_f32_i32 v26, v26
    v_cvt_f32_i32 v27, v27
    v_fma_f32 v107, v64, v16, -v100
    v_fmac_f32 v107, v65, v17
    v_fmac_f32 v107, v66, v18
    v_fmac_f32 v107, v67, v19
    v_fmac_f32 v107, v68, v20
    v_fmac_f32 v107, v69, v21
    v_fmac_f32 v107, v70, v22
    v_fmac_f32 v107, v71, v23
    v_fmac_f32 v107, v72, v24
    v_fmac_f32 v107, v73, v25
    v_fmac_f32 v107, v74, v26
    v_fmac_f32 v107, v75, v27
    buffer_load_dwordx4 v[16:19], v1, s[24:27], s60 offen offset:3072 nt
    buffer_load_dwordx4 v[20:23], v1, s[24:27], s60 offen offset:3328 nt
    buffer_load_dwordx4 v[24:27], v1, s[24:27], s60 offen offset:3584 nt
    s_add_u32 s60, s60, 6144
    v_add_f32_dpp v108, v107, v107 row_ror:8 row_mask:0xf bank_mask:0xc
    s_nop 1
    v_add_f32_dpp v109, v108, v108 row_shl:4 row_mask:0xf bank_mask:0x5
    s_waitcnt vmcnt(9)
    v_cvt_f32_i32 v28, v28
    v_cvt_f32_i32 v29, v29
    v_cvt_f32_i32 v30, v30
    v_cvt_f32_i32 v31, v31
    v_cvt_f32_i32 v32, v32
    v_cvt_f32_i32 v33, v33
    v_cvt_f32_i32 v34, v34
    v_cvt_f32_i32 v35, v35
    v_cvt_f32_i32 v36, v36
    v_cvt_f32_i32 v37, v37
    v_cvt_f32_i32 v38, v38
    v_cvt_f32_i32 v39, v39
    v_fma_f32 v107, v64, v28, -v100
    v_fmac_f32 v107, v65, v29
    v_fmac_f32 v107, v66, v30
    v_fmac_f32 v107, v67, v31
    v_fmac_f32 v107, v68, v32
    v_fmac_f32 v107, v69, v33
    v_fmac_f32 v107, v70, v34
    v_fmac_f32 v107, v71, v35
    v_fmac_f32 v107, v72, v36
    v_fmac_f32 v107, v73, v37
    v_fmac_f32 v107, v74, v38
    v_fmac_f32 v107, v75, v39
    buffer_load_dwordx4 v[28:31], v1, s[24:27], s60 offen offset:0 nt
    buffer_load_dwordx4 v[32:35], v1, s[24:27], s60 offen offset:256 nt
    buffer_load_dwordx4 v[36:39], v1, s[24:27], s60 offen offset:512 nt
    v_add_f32_dpp v108, v107, v107 row_ror:8 row_mask:0xf bank_mask:0x3
    s_waitcnt vmcnt(9)
    v_cvt_f32_i32 v40, v40
    v_cvt_f32_i32 v41, v41
    v_cvt_f32_i32 v42, v42
    v_cvt_f32_i32 v43, v43
    v_cvt_f32_i32 v44, v44
    v_cvt_f32_i32 v45, v45
    v_cvt_f32_i32 v46, v46
    v_cvt_f32_i32 v47, v47
    v_cvt_f32_i32 v48, v48
    v_cvt_f32_i32 v49, v49
    v_cvt_f32_i32 v50, v50
    v_cvt_f32_i32 v51, v51
    v_fma_f32 v107, v64, v40, -v100
    v_fmac_f32 v107, v65, v41
    v_fmac_f32 v107, v66, v42
    v_fmac_f32 v107, v67, v43
    v_fmac_f32 v107, v68, v44
    v_fmac_f32 v107, v69, v45
    v_fmac_f32 v107, v70, v46
    v_fmac_f32 v107, v71, v47
    v_fmac_f32 v107, v72, v48
    v_fmac_f32 v107, v73, v49
    v_fmac_f32 v107, v74, v50
    v_fmac_f32 v107, v75, v51
    buffer_load_dwordx4 v[40:43], v1, s[24:27], s60 offen offset:3072 nt
    buffer_load_dwordx4 v[44:47], v1, s[24:27], s60 offen offset:3328 nt
    buffer_load_dwordx4 v[48:51], v1, s[24:27], s60 offen offset:3584 nt
    s_add_u32 s60, s60, 6144
    v_add_f32_dpp v108, v107, v107 row_ror:8 row_mask:0xf bank_mask:0xc
    s_nop 1
    v_add_f32_dpp v109, v108, v108 row_shr:4 row_mask:0xf bank_mask:0xa
    s_nop 1
    v_add_f32_dpp v110, v109, v109 quad_perm:[2,3,0,1] row_mask:0xf bank_mask:0xf
    s_waitcnt vmcnt(9)
    v_cvt_f32_i32 v4, v4
    v_cvt_f32_i32 v5, v5
    v_cvt_f32_i32 v6, v6
    v_cvt_f32_i32 v7, v7
    v_cvt_f32_i32 v8, v8
    v_cvt_f32_i32 v9, v9
    v_cvt_f32_i32 v10, v10
    v_cvt_f32_i32 v11, v11
    v_cvt_f32_i32 v12, v12
    v_cvt_f32_i32 v13, v13
    v_cvt_f32_i32 v14, v14
    v_cvt_f32_i32 v15, v15
    v_fma_f32 v107, v64, v4, -v100
    v_fmac_f32 v107, v65, v5
    v_fmac_f32 v107, v66, v6
    v_fmac_f32 v107, v67, v7
    v_fmac_f32 v107, v68, v8
    v_fmac_f32 v107, v69, v9
    v_fmac_f32 v107, v70, v10
    v_fmac_f32 v107, v71, v11
    v_fmac_f32 v107, v72, v12
    v_fmac_f32 v107, v73, v13
    v_fmac_f32 v107, v74, v14
    v_fmac_f32 v107, v75, v15
    buffer_load_dwordx4 v[4:7], v1, s[24:27], s60 offen offset:0 nt
    buffer_load_dwordx4 v[8:11], v1, s[24:27], s60 offen offset:256 nt
    buffer_load_dwordx4 v[12:15], v1, s[24:27], s60 offen offset:512 nt
    v_add_f32_dpp v108, v107, v107 row_ror:8 row_mask:0xf bank_mask:0x3
    s_waitcnt vmcnt(9)
    v_cvt_f32_i32 v16, v16
    v_cvt_f32_i32 v17, v17
    v_cvt_f32_i32 v18, v18
    v_cvt_f32_i32 v19, v19
    v_cvt_f32_i32 v20, v20
    v_cvt_f32_i32 v21, v21
    v_cvt_f32_i32 v22, v22
    v_cvt_f32_i32 v23, v23
    v_cvt_f32_i32 v24, v24
    v_cvt_f32_i32 v25, v25
    v_cvt_f32_i32 v26, v26
    v_cvt_f32_i32 v27, v27
    v_fma_f32 v107, v64, v16, -v100
    v_fmac_f32 v107, v65, v17
    v_fmac_f32 v107, v66, v18
    v_fmac_f32 v107, v67, v19
    v_fmac_f32 v107, v68, v20
    v_fmac_f32 v107, v69, v21
    v_fmac_f32 v107, v70, v22
    v_fmac_f32 v107, v71, v23
    v_fmac_f32 v107, v72, v24
    v_fmac_f32 v107, v73, v25
    v_fmac_f32 v107, v74, v26
    v_fmac_f32 v107, v75, v27
    buffer_load_dwordx4 v[16:19], v1, s[24:27], s60 offen offset:3072 nt
    buffer_load_dwordx4 v[20:23], v1, s[24:27], s60 offen offset:3328 nt
    buffer_load_dwordx4 v[24:27], v1, s[24:27], s60 offen offset:3584 nt
    s_add_u32 s60, s60, 6144
    v_add_f32_dpp v108, v107, v107 row_ror:8 row_mask:0xf bank_mask:0xc
    s_nop 1
    v_add_f32_dpp v109, v108, v108 row_shl:4 row_mask:0xf bank_mask:0x5
    s_waitcnt vmcnt(9)
    v_cvt_f32_i32 v28, v28
    v_cvt_f32_i32 v29, v29
    v_cvt_f32_i32 v30, v30
    v_cvt_f32_i32 v31, v31
    v_cvt_f32_i32 v32, v32
    v_cvt_f32_i32 v33, v33
    v_cvt_f32_i32 v34, v34
    v_cvt_f32_i32 v35, v35
    v_cvt_f32_i32 v36, v36
    v_cvt_f32_i32 v37, v37
    v_cvt_f32_i32 v38, v38
    v_cvt_f32_i32 v39, v39
    v_fma_f32 v107, v64, v28, -v100
    v_fmac_f32 v107, v65, v29
    v_fmac_f32 v107, v66, v30
    v_fmac_f32 v107, v67, v31
    v_fmac_f32 v107, v68, v32
    v_fmac_f32 v107, v69, v33
    v_fmac_f32 v107, v70, v34
    v_fmac_f32 v107, v71, v35
    v_fmac_f32 v107, v72, v36
    v_fmac_f32 v107, v73, v37
    v_fmac_f32 v107, v74, v38
    v_fmac_f32 v107, v75, v39
    buffer_load_dwordx4 v[28:31], v1, s[24:27], s60 offen offset:0 nt
    buffer_load_dwordx4 v[32:35], v1, s[24:27], s60 offen offset:256 nt
    buffer_load_dwordx4 v[36:39], v1, s[24:27], s60 offen offset:512 nt
    v_add_f32_dpp v108, v107, v107 row_ror:8 row_mask:0xf bank_mask:0x3
    s_waitcnt vmcnt(9)
    v_cvt_f32_i32 v40, v40
    v_cvt_f32_i32 v41, v41
    v_cvt_f32_i32 v42, v42
    v_cvt_f32_i32 v43, v43
    v_cvt_f32_i32 v44, v44
    v_cvt_f32_i32 v45, v45
    v_cvt_f32_i32 v46, v46
    v_cvt_f32_i32 v47, v47
    v_cvt_f32_i32 v48, v48
    v_cvt_f32_i32 v49, v49
    v_cvt_f32_i32 v50, v50
    v_cvt_f32_i32 v51, v51
    v_fma_f32 v107, v64, v40, -v100
    v_fmac_f32 v107, v65, v41
    v_fmac_f32 v107, v66, v42
    v_fmac_f32 v107, v67, v43
    v_fmac_f32 v107, v68, v44
    v_fmac_f32 v107, v69, v45
    v_fmac_f32 v107, v70, v46
    v_fmac_f32 v107, v71, v47
    v_fmac_f32 v107, v72, v48
    v_fmac_f32 v107, v73, v49
    v_fmac_f32 v107, v74, v50
    v_fmac_f32 v107, v75, v51
    buffer_load_dwordx4 v[40:43], v1, s[24:27], s60 offen offset:3072 nt
    buffer_load_dwordx4 v[44:47], v1, s[24:27], s60 offen offset:3328 nt
    buffer_load_dwordx4 v[48:51], v1, s[24:27], s60 offen offset:3584 nt
    s_add_u32 s60, s60, 6144
    v_add_f32_dpp v108, v107, v107 row_ror:8 row_mask:0xf bank_mask:0xc
    s_nop 1
    v_add_f32_dpp v109, v108, v108 row_shr:4 row_mask:0xf bank_mask:0xa
    s_nop 1
    v_add_f32_dpp v111, v109, v109 quad_perm:[2,3,0,1] row_mask:0xf bank_mask:0xf
    v_cndmask_b32 v111, v110, v111, s[66:67]
    s_nop 1
    v_add_f32_dpp v112, v111, v111 quad_perm:[1,0,3,2] row_mask:0xf bank_mask:0xf
    s_waitcnt vmcnt(9)
    v_cvt_f32_i32 v4, v4
    v_cvt_f32_i32 v5, v5
    v_cvt_f32_i32 v6, v6
    v_cvt_f32_i32 v7, v7
    v_cvt_f32_i32 v8, v8
    v_cvt_f32_i32 v9, v9
    v_cvt_f32_i32 v10, v10
    v_cvt_f32_i32 v11, v11
    v_cvt_f32_i32 v12, v12
    v_cvt_f32_i32 v13, v13
    v_cvt_f32_i32 v14, v14
    v_cvt_f32_i32 v15, v15
    v_fma_f32 v107, v64, v4, -v100
    v_fmac_f32 v107, v65, v5
    v_fmac_f32 v107, v66, v6
    v_fmac_f32 v107, v67, v7
    v_fmac_f32 v107, v68, v8
    v_fmac_f32 v107, v69, v9
    v_fmac_f32 v107, v70, v10
    v_fmac_f32 v107, v71, v11
    v_fmac_f32 v107, v72, v12
    v_fmac_f32 v107, v73, v13
    v_fmac_f32 v107, v74, v14
    v_fmac_f32 v107, v75, v15
    buffer_load_dwordx4 v[4:7], v1, s[24:27], s60 offen offset:0 nt
    buffer_load_dwordx4 v[8:11], v1, s[24:27], s60 offen offset:256 nt
    buffer_load_dwordx4 v[12:15], v1, s[24:27], s60 offen offset:512 nt
    v_add_f32_dpp v108, v107, v107 row_ror:8 row_mask:0xf bank_mask:0x3
    s_waitcnt vmcnt(9)
    v_cvt_f32_i32 v16, v16
    v_cvt_f32_i32 v17, v17
    v_cvt_f32_i32 v18, v18
    v_cvt_f32_i32 v19, v19
    v_cvt_f32_i32 v20, v20
    v_cvt_f32_i32 v21, v21
    v_cvt_f32_i32 v22, v22
    v_cvt_f32_i32 v23, v23
    v_cvt_f32_i32 v24, v24
    v_cvt_f32_i32 v25, v25
    v_cvt_f32_i32 v26, v26
    v_cvt_f32_i32 v27, v27
    v_fma_f32 v107, v64, v16, -v100
    v_fmac_f32 v107, v65, v17
    v_fmac_f32 v107, v66, v18
    v_fmac_f32 v107, v67, v19
    v_fmac_f32 v107, v68, v20
    v_fmac_f32 v107, v69, v21
    v_fmac_f32 v107, v70, v22
    v_fmac_f32 v107, v71, v23
    v_fmac_f32 v107, v72, v24
    v_fmac_f32 v107, v73, v25
    v_fmac_f32 v107, v74, v26
    v_fmac_f32 v107, v75, v27
    buffer_load_dwordx4 v[16:19], v1, s[24:27], s60 offen offset:3072 nt
    buffer_load_dwordx4 v[20:23], v1, s[24:27], s60 offen offset:3328 nt
    buffer_load_dwordx4 v[24:27], v1, s[24:27], s60 offen offset:3584 nt
    s_add_u32 s60, s60, 6144
    v_add_f32_dpp v108, v107, v107 row_ror:8 row_mask:0xf bank_mask:0xc
    s_nop 1
    v_add_f32_dpp v109, v108, v108 row_shl:4 row_mask:0xf bank_mask:0x5
    s_waitcnt vmcnt(9)
    v_cvt_f32_i32 v28, v28
    v_cvt_f32_i32 v29, v29
    v_cvt_f32_i32 v30, v30
    v_cvt_f32_i32 v31, v31
    v_cvt_f32_i32 v32, v32
    v_cvt_f32_i32 v33, v33
    v_cvt_f32_i32 v34, v34
    v_cvt_f32_i32 v35, v35
    v_cvt_f32_i32 v36, v36
    v_cvt_f32_i32 v37, v37
    v_cvt_f32_i32 v38, v38
    v_cvt_f32_i32 v39, v39
    v_fma_f32 v107, v64, v28, -v100
    v_fmac_f32 v107, v65, v29
    v_fmac_f32 v107, v66, v30
    v_fmac_f32 v107, v67, v31
    v_fmac_f32 v107, v68, v32
    v_fmac_f32 v107, v69, v33
    v_fmac_f32 v107, v70, v34
    v_fmac_f32 v107, v71, v35
    v_fmac_f32 v107, v72, v36
    v_fmac_f32 v107, v73, v37
    v_fmac_f32 v107, v74, v38
    v_fmac_f32 v107, v75, v39
    buffer_load_dwordx4 v[28:31], v1, s[24:27], s60 offen offset:0 nt
    buffer_load_dwordx4 v[32:35], v1, s[24:27], s60 offen offset:256 nt
    buffer_load_dwordx4 v[36:39], v1, s[24:27], s60 offen offset:512 nt
    v_add_f32_dpp v108, v107, v107 row_ror:8 row_mask:0xf bank_mask:0x3
    s_waitcnt vmcnt(9)
    v_cvt_f32_i32 v40, v40
    v_cvt_f32_i32 v41, v41
    v_cvt_f32_i32 v42, v42
    v_cvt_f32_i32 v43, v43
    v_cvt_f32_i32 v44, v44
    v_cvt_f32_i32 v45, v45
    v_cvt_f32_i32 v46, v46
    v_cvt_f32_i32 v47, v47
    v_cvt_f32_i32 v48, v48
    v_cvt_f32_i32 v49, v49
    v_cvt_f32_i32 v50, v50
    v_cvt_f32_i32 v51, v51
    v_fma_f32 v107, v64, v40, -v100
    v_fmac_f32 v107, v65, v41
    v_fmac_f32 v107, v66, v42
    v_fmac_f32 v107, v67, v43
    v_fmac_f32 v107, v68, v44
    v_fmac_f32 v107, v69, v45
    v_fmac_f32 v107, v70, v46
    v_fmac_f32 v107, v71, v47
    v_fmac_f32 v107, v72, v48
    v_fmac_f32 v107, v73, v49
    v_fmac_f32 v107, v74, v50
    v_fmac_f32 v107, v75, v51
    buffer_load_dwordx4 v[40:43], v1, s[24:27], s60 offen offset:3072 nt
    buffer_load_dwordx4 v[44:47], v1, s[24:27], s60 offen offset:3328 nt
    buffer_load_dwordx4 v[48:51], v1, s[24:27], s60 offen offset:3584 nt
    s_add_u32 s60, s60, 6144
    v_add_f32_dpp v108, v107, v107 row_ror:8 row_mask:0xf bank_mask:0xc
    s_nop 1
    v_add_f32_dpp v109, v108, v108 row_shr:4 row_mask:0xf bank_mask:0xa
    s_nop 1
    v_add_f32_dpp v110, v109, v109 quad_perm:[2,3,0,1] row_mask:0xf bank_mask:0xf
    s_waitcnt vmcnt(9)
    v_cvt_f32_i32 v4, v4
    v_cvt_f32_i32 v5, v5
    v_cvt_f32_i32 v6, v6
    v_cvt_f32_i32 v7, v7
    v_cvt_f32_i32 v8, v8
    v_cvt_f32_i32 v9, v9
    v_cvt_f32_i32 v10, v10
    v_cvt_f32_i32 v11, v11
    v_cvt_f32_i32 v12, v12
    v_cvt_f32_i32 v13, v13
    v_cvt_f32_i32 v14, v14
    v_cvt_f32_i32 v15, v15
    v_fma_f32 v107, v64, v4, -v100
    v_fmac_f32 v107, v65, v5
    v_fmac_f32 v107, v66, v6
    v_fmac_f32 v107, v67, v7
    v_fmac_f32 v107, v68, v8
    v_fmac_f32 v107, v69, v9
    v_fmac_f32 v107, v70, v10
    v_fmac_f32 v107, v71, v11
    v_fmac_f32 v107, v72, v12
    v_fmac_f32 v107, v73, v13
    v_fmac_f32 v107, v74, v14
    v_fmac_f32 v107, v75, v15
    buffer_load_ushort v104, v3, s[40:43], s63 offen
    buffer_load_ushort v105, v3, s[44:47], s63 offen
    s_add_u32 s63, s63, 128
    buffer_load_dwordx4 v[4:7], v1, s[28:31], s61 offen offset:0 nt
    buffer_load_dwordx4 v[8:11], v1, s[28:31], s61 offen offset:256 nt
    buffer_load_dwordx4 v[12:15], v1, s[28:31], s61 offen offset:512 nt
    v_add_f32_dpp v108, v107, v107 row_ror:8 row_mask:0xf bank_mask:0x3
    s_waitcnt vmcnt(11)
    v_cvt_f32_i32 v16, v16
    v_cvt_f32_i32 v17, v17
    v_cvt_f32_i32 v18, v18
    v_cvt_f32_i32 v19, v19
    v_cvt_f32_i32 v20, v20
    v_cvt_f32_i32 v21, v21
    v_cvt_f32_i32 v22, v22
    v_cvt_f32_i32 v23, v23
    v_cvt_f32_i32 v24, v24
    v_cvt_f32_i32 v25, v25
    v_cvt_f32_i32 v26, v26
    v_cvt_f32_i32 v27, v27
    v_fma_f32 v107, v64, v16, -v100
    v_fmac_f32 v107, v65, v17
    v_fmac_f32 v107, v66, v18
    v_fmac_f32 v107, v67, v19
    v_fmac_f32 v107, v68, v20
    v_fmac_f32 v107, v69, v21
    v_fmac_f32 v107, v70, v22
    v_fmac_f32 v107, v71, v23
    v_fmac_f32 v107, v72, v24
    v_fmac_f32 v107, v73, v25
    v_fmac_f32 v107, v74, v26
    v_fmac_f32 v107, v75, v27
    buffer_load_dwordx4 v[16:19], v1, s[28:31], s61 offen offset:3072 nt
    buffer_load_dwordx4 v[20:23], v1, s[28:31], s61 offen offset:3328 nt
    buffer_load_dwordx4 v[24:27], v1, s[28:31], s61 offen offset:3584 nt
    s_add_u32 s61, s61, 6144
    v_add_f32_dpp v108, v107, v107 row_ror:8 row_mask:0xf bank_mask:0xc
    s_nop 1
    v_add_f32_dpp v109, v108, v108 row_shl:4 row_mask:0xf bank_mask:0x5
    s_waitcnt vmcnt(11)
    v_cvt_f32_i32 v28, v28
    v_cvt_f32_i32 v29, v29
    v_cvt_f32_i32 v30, v30
    v_cvt_f32_i32 v31, v31
    v_cvt_f32_i32 v32, v32
    v_cvt_f32_i32 v33, v33
    v_cvt_f32_i32 v34, v34
    v_cvt_f32_i32 v35, v35
    v_cvt_f32_i32 v36, v36
    v_cvt_f32_i32 v37, v37
    v_cvt_f32_i32 v38, v38
    v_cvt_f32_i32 v39, v39
    v_fma_f32 v107, v64, v28, -v100
    v_fmac_f32 v107, v65, v29
    v_fmac_f32 v107, v66, v30
    v_fmac_f32 v107, v67, v31
    v_fmac_f32 v107, v68, v32
    v_fmac_f32 v107, v69, v33
    v_fmac_f32 v107, v70, v34
    v_fmac_f32 v107, v71, v35
    v_fmac_f32 v107, v72, v36
    v_fmac_f32 v107, v73, v37
    v_fmac_f32 v107, v74, v38
    v_fmac_f32 v107, v75, v39
    buffer_load_dwordx4 v[28:31], v1, s[28:31], s61 offen offset:0 nt
    buffer_load_dwordx4 v[32:35], v1, s[28:31], s61 offen offset:256 nt
    buffer_load_dwordx4 v[36:39], v1, s[28:31], s61 offen offset:512 nt
    v_add_f32_dpp v108, v107, v107 row_ror:8 row_mask:0xf bank_mask:0x3
    s_waitcnt vmcnt(11)
    v_cvt_f32_i32 v40, v40
    v_cvt_f32_i32 v41, v41
    v_cvt_f32_i32 v42, v42
    v_cvt_f32_i32 v43, v43
    v_cvt_f32_i32 v44, v44
    v_cvt_f32_i32 v45, v45
    v_cvt_f32_i32 v46, v46
    v_cvt_f32_i32 v47, v47
    v_cvt_f32_i32 v48, v48
    v_cvt_f32_i32 v49, v49
    v_cvt_f32_i32 v50, v50
    v_cvt_f32_i32 v51, v51
    v_fma_f32 v107, v64, v40, -v100
    v_fmac_f32 v107, v65, v41
    v_fmac_f32 v107, v66, v42
    v_fmac_f32 v107, v67, v43
    v_fmac_f32 v107, v68, v44
    v_fmac_f32 v107, v69, v45
    v_fmac_f32 v107, v70, v46
    v_fmac_f32 v107, v71, v47
    v_fmac_f32 v107, v72, v48
    v_fmac_f32 v107, v73, v49
    v_fmac_f32 v107, v74, v50
    v_fmac_f32 v107, v75, v51
    buffer_load_dwordx4 v[40:43], v1, s[28:31], s61 offen offset:3072 nt
    buffer_load_dwordx4 v[44:47], v1, s[28:31], s61 offen offset:3328 nt
    buffer_load_dwordx4 v[48:51], v1, s[28:31], s61 offen offset:3584 nt
    s_add_u32 s61, s61, 6144
    v_add_f32_dpp v108, v107, v107 row_ror:8 row_mask:0xf bank_mask:0xc
    s_nop 1
    v_add_f32_dpp v109, v108, v108 row_shr:4 row_mask:0xf bank_mask:0xa
    s_nop 1
    v_add_f32_dpp v111, v109, v109 quad_perm:[2,3,0,1] row_mask:0xf bank_mask:0xf
    v_cndmask_b32 v111, v110, v111, s[66:67]
    s_nop 1
    v_add_f32_dpp v110, v111, v111 quad_perm:[1,0,3,2] row_mask:0xf bank_mask:0xf
    v_cndmask_b32 v112, v112, v110, s[68:69]
    s_nop 1
    s_waitcnt vmcnt(9)
    v_max_f32_dpp v113, v112, v112 row_ror:8 row_mask:0xf bank_mask:0xf
    v_lshlrev_b32 v104, 16, v104
    v_lshlrev_b32 v105, 16, v105
    v_max_f32_dpp v113, v113, v113 row_ror:4 row_mask:0xf bank_mask:0xf
    s_nop 1
    v_max_f32_dpp v113, v113, v113 row_ror:2 row_mask:0xf bank_mask:0xf
    s_nop 1
    v_max_f32_dpp v113, v113, v113 row_ror:1 row_mask:0xf bank_mask:0xf
    v_max_f32 v113, v113, v101
    v_sub_f32 v114, v101, v113
    v_sub_f32 v106, v112, v113
    v_exp_f32 v114, v114
    v_exp_f32 v106, v106
    v_mov_b32 v101, v113
    v_fma_f32 v102, v102, v114, v106
    v_mul_f32 v106, v106, v104
    v_mul_f32 v103, v103, v114
    v_fmac_f32 v103, v106, v105
    v_mul_f32 v88, v88, v114
    v_mul_f32 v89, v89, v114
    v_mul_f32 v90, v90, v114
    v_mul_f32 v91, v91, v114
    v_mul_f32 v92, v92, v114
    v_mul_f32 v93, v93, v114
    v_mul_f32 v94, v94, v114
    v_mul_f32 v95, v95, v114
    v_mul_f32 v96, v96, v114
    v_mul_f32 v97, v97, v114
    v_mul_f32 v98, v98, v114
    v_mul_f32 v99, v99, v114
    v_cvt_f32_i32 v4, v4
    v_cvt_f32_i32 v5, v5
    v_cvt_f32_i32 v6, v6
    v_cvt_f32_i32 v7, v7
    v_cvt_f32_i32 v8, v8
    v_cvt_f32_i32 v9, v9
    v_cvt_f32_i32 v10, v10
    v_cvt_f32_i32 v11, v11
    v_cvt_f32_i32 v12, v12
    v_cvt_f32_i32 v13, v13
    v_cvt_f32_i32 v14, v14
    v_cvt_f32_i32 v15, v15
    v_fmac_f32_dpp v88, v106, v4 row_newbcast:0 row_mask:0xf bank_mask:0xf
    v_fmac_f32_dpp v89, v106, v5 row_newbcast:0 row_mask:0xf bank_mask:0xf
    v_fmac_f32_dpp v90, v106, v6 row_newbcast:0 row_mask:0xf bank_mask:0xf
    v_fmac_f32_dpp v91, v106, v7 row_newbcast:0 row_mask:0xf bank_mask:0xf
    v_fmac_f32_dpp v92, v106, v8 row_newbcast:0 row_mask:0xf bank_mask:0xf
    v_fmac_f32_dpp v93, v106, v9 row_newbcast:0 row_mask:0xf bank_mask:0xf
    v_fmac_f32_dpp v94, v106, v10 row_newbcast:0 row_mask:0xf bank_mask:0xf
    v_fmac_f32_dpp v95, v106, v11 row_newbcast:0 row_mask:0xf bank_mask:0xf
    v_fmac_f32_dpp v96, v106, v12 row_newbcast:0 row_mask:0xf bank_mask:0xf
    v_fmac_f32_dpp v97, v106, v13 row_newbcast:0 row_mask:0xf bank_mask:0xf
    v_fmac_f32_dpp v98, v106, v14 row_newbcast:0 row_mask:0xf bank_mask:0xf
    v_fmac_f32_dpp v99, v106, v15 row_newbcast:0 row_mask:0xf bank_mask:0xf
    buffer_load_dwordx4 v[4:7], v1, s[28:31], s61 offen offset:0 nt
    buffer_load_dwordx4 v[8:11], v1, s[28:31], s61 offen offset:256 nt
    buffer_load_dwordx4 v[12:15], v1, s[28:31], s61 offen offset:512 nt
    s_waitcnt vmcnt(9)
    v_cvt_f32_i32 v16, v16
    v_cvt_f32_i32 v17, v17
    v_cvt_f32_i32 v18, v18
    v_cvt_f32_i32 v19, v19
    v_cvt_f32_i32 v20, v20
    v_cvt_f32_i32 v21, v21
    v_cvt_f32_i32 v22, v22
    v_cvt_f32_i32 v23, v23
    v_cvt_f32_i32 v24, v24
    v_cvt_f32_i32 v25, v25
    v_cvt_f32_i32 v26, v26
    v_cvt_f32_i32 v27, v27
    v_fmac_f32_dpp v88, v106, v16 row_newbcast:8 row_mask:0xf bank_mask:0xf
    v_fmac_f32_dpp v89, v106, v17 row_newbcast:8 row_mask:0xf bank_mask:0xf
    v_fmac_f32_dpp v90, v106, v18 row_newbcast:8 row_mask:0xf bank_mask:0xf
    v_fmac_f32_dpp v91, v106, v19 row_newbcast:8 row_mask:0xf bank_mask:0xf
    v_fmac_f32_dpp v92, v106, v20 row_newbcast:8 row_mask:0xf bank_mask:0xf
    v_fmac_f32_dpp v93, v106, v21 row_newbcast:8 row_mask:0xf bank_mask:0xf
    v_fmac_f32_dpp v94, v106, v22 row_newbcast:8 row_mask:0xf bank_mask:0xf
    v_fmac_f32_dpp v95, v106, v23 row_newbcast:8 row_mask:0xf bank_mask:0xf
    v_fmac_f32_dpp v96, v106, v24 row_newbcast:8 row_mask:0xf bank_mask:0xf
    v_fmac_f32_dpp v97, v106, v25 row_newbcast:8 row_mask:0xf bank_mask:0xf
    v_fmac_f32_dpp v98, v106, v26 row_newbcast:8 row_mask:0xf bank_mask:0xf
    v_fmac_f32_dpp v99, v106, v27 row_newbcast:8 row_mask:0xf bank_mask:0xf
    buffer_load_dwordx4 v[16:19], v1, s[28:31], s61 offen offset:3072 nt
    buffer_load_dwordx4 v[20:23], v1, s[28:31], s61 offen offset:3328 nt
    buffer_load_dwordx4 v[24:27], v1, s[28:31], s61 offen offset:3584 nt
    s_add_u32 s61, s61, 6144
    s_waitcnt vmcnt(9)
    v_cvt_f32_i32 v28, v28
    v_cvt_f32_i32 v29, v29
    v_cvt_f32_i32 v30, v30
    v_cvt_f32_i32 v31, v31
    v_cvt_f32_i32 v32, v32
    v_cvt_f32_i32 v33, v33
    v_cvt_f32_i32 v34, v34
    v_cvt_f32_i32 v35, v35
    v_cvt_f32_i32 v36, v36
    v_cvt_f32_i32 v37, v37
    v_cvt_f32_i32 v38, v38
    v_cvt_f32_i32 v39, v39
    v_fmac_f32_dpp v88, v106, v28 row_newbcast:4 row_mask:0xf bank_mask:0xf
    v_fmac_f32_dpp v89, v106, v29 row_newbcast:4 row_mask:0xf bank_mask:0xf
    v_fmac_f32_dpp v90, v106, v30 row_newbcast:4 row_mask:0xf bank_mask:0xf
    v_fmac_f32_dpp v91, v106, v31 row_newbcast:4 row_mask:0xf bank_mask:0xf
    v_fmac_f32_dpp v92, v106, v32 row_newbcast:4 row_mask:0xf bank_mask:0xf
    v_fmac_f32_dpp v93, v106, v33 row_newbcast:4 row_mask:0xf bank_mask:0xf
    v_fmac_f32_dpp v94, v106, v34 row_newbcast:4 row_mask:0xf bank_mask:0xf
    v_fmac_f32_dpp v95, v106, v35 row_newbcast:4 row_mask:0xf bank_mask:0xf
    v_fmac_f32_dpp v96, v106, v36 row_newbcast:4 row_mask:0xf bank_mask:0xf
    v_fmac_f32_dpp v97, v106, v37 row_newbcast:4 row_mask:0xf bank_mask:0xf
    v_fmac_f32_dpp v98, v106, v38 row_newbcast:4 row_mask:0xf bank_mask:0xf
    v_fmac_f32_dpp v99, v106, v39 row_newbcast:4 row_mask:0xf bank_mask:0xf
    buffer_load_dwordx4 v[28:31], v1, s[28:31], s61 offen offset:0 nt
    buffer_load_dwordx4 v[32:35], v1, s[28:31], s61 offen offset:256 nt
    buffer_load_dwordx4 v[36:39], v1, s[28:31], s61 offen offset:512 nt
    s_waitcnt vmcnt(9)
    v_cvt_f32_i32 v40, v40
    v_cvt_f32_i32 v41, v41
    v_cvt_f32_i32 v42, v42
    v_cvt_f32_i32 v43, v43
    v_cvt_f32_i32 v44, v44
    v_cvt_f32_i32 v45, v45
    v_cvt_f32_i32 v46, v46
    v_cvt_f32_i32 v47, v47
    v_cvt_f32_i32 v48, v48
    v_cvt_f32_i32 v49, v49
    v_cvt_f32_i32 v50, v50
    v_cvt_f32_i32 v51, v51
    v_fmac_f32_dpp v88, v106, v40 row_newbcast:12 row_mask:0xf bank_mask:0xf
    v_fmac_f32_dpp v89, v106, v41 row_newbcast:12 row_mask:0xf bank_mask:0xf
    v_fmac_f32_dpp v90, v106, v42 row_newbcast:12 row_mask:0xf bank_mask:0xf
    v_fmac_f32_dpp v91, v106, v43 row_newbcast:12 row_mask:0xf bank_mask:0xf
    v_fmac_f32_dpp v92, v106, v44 row_newbcast:12 row_mask:0xf bank_mask:0xf
    v_fmac_f32_dpp v93, v106, v45 row_newbcast:12 row_mask:0xf bank_mask:0xf
    v_fmac_f32_dpp v94, v106, v46 row_newbcast:12 row_mask:0xf bank_mask:0xf
    v_fmac_f32_dpp v95, v106, v47 row_newbcast:12 row_mask:0xf bank_mask:0xf
    v_fmac_f32_dpp v96, v106, v48 row_newbcast:12 row_mask:0xf bank_mask:0xf
    v_fmac_f32_dpp v97, v106, v49 row_newbcast:12 row_mask:0xf bank_mask:0xf
    v_fmac_f32_dpp v98, v106, v50 row_newbcast:12 row_mask:0xf bank_mask:0xf
    v_fmac_f32_dpp v99, v106, v51 row_newbcast:12 row_mask:0xf bank_mask:0xf
    buffer_load_dwordx4 v[40:43], v1, s[28:31], s61 offen offset:3072 nt
    buffer_load_dwordx4 v[44:47], v1, s[28:31], s61 offen offset:3328 nt
    buffer_load_dwordx4 v[48:51], v1, s[28:31], s61 offen offset:3584 nt
    s_add_u32 s61, s61, 6144
    s_waitcnt vmcnt(9)
    v_cvt_f32_i32 v4, v4
    v_cvt_f32_i32 v5, v5
    v_cvt_f32_i32 v6, v6
    v_cvt_f32_i32 v7, v7
    v_cvt_f32_i32 v8, v8
    v_cvt_f32_i32 v9, v9
    v_cvt_f32_i32 v10, v10
    v_cvt_f32_i32 v11, v11
    v_cvt_f32_i32 v12, v12
    v_cvt_f32_i32 v13, v13
    v_cvt_f32_i32 v14, v14
    v_cvt_f32_i32 v15, v15
    v_fmac_f32_dpp v88, v106, v4 row_newbcast:2 row_mask:0xf bank_mask:0xf
    v_fmac_f32_dpp v89, v106, v5 row_newbcast:2 row_mask:0xf bank_mask:0xf
    v_fmac_f32_dpp v90, v106, v6 row_newbcast:2 row_mask:0xf bank_mask:0xf
    v_fmac_f32_dpp v91, v106, v7 row_newbcast:2 row_mask:0xf bank_mask:0xf
    v_fmac_f32_dpp v92, v106, v8 row_newbcast:2 row_mask:0xf bank_mask:0xf
    v_fmac_f32_dpp v93, v106, v9 row_newbcast:2 row_mask:0xf bank_mask:0xf
    v_fmac_f32_dpp v94, v106, v10 row_newbcast:2 row_mask:0xf bank_mask:0xf
    v_fmac_f32_dpp v95, v106, v11 row_newbcast:2 row_mask:0xf bank_mask:0xf
    v_fmac_f32_dpp v96, v106, v12 row_newbcast:2 row_mask:0xf bank_mask:0xf
    v_fmac_f32_dpp v97, v106, v13 row_newbcast:2 row_mask:0xf bank_mask:0xf
    v_fmac_f32_dpp v98, v106, v14 row_newbcast:2 row_mask:0xf bank_mask:0xf
    v_fmac_f32_dpp v99, v106, v15 row_newbcast:2 row_mask:0xf bank_mask:0xf
    buffer_load_dwordx4 v[4:7], v1, s[28:31], s61 offen offset:0 nt
    buffer_load_dwordx4 v[8:11], v1, s[28:31], s61 offen offset:256 nt
    buffer_load_dwordx4 v[12:15], v1, s[28:31], s61 offen offset:512 nt
    s_waitcnt vmcnt(9)
    v_cvt_f32_i32 v16, v16
    v_cvt_f32_i32 v17, v17
    v_cvt_f32_i32 v18, v18
    v_cvt_f32_i32 v19, v19
    v_cvt_f32_i32 v20, v20
    v_cvt_f32_i32 v21, v21
    v_cvt_f32_i32 v22, v22
    v_cvt_f32_i32 v23, v23
    v_cvt_f32_i32 v24, v24
    v_cvt_f32_i32 v25, v25
    v_cvt_f32_i32 v26, v26
    v_cvt_f32_i32 v27, v27
    v_fmac_f32_dpp v88, v106, v16 row_newbcast:10 row_mask:0xf bank_mask:0xf
    v_fmac_f32_dpp v89, v106, v17 row_newbcast:10 row_mask:0xf bank_mask:0xf
    v_fmac_f32_dpp v90, v106, v18 row_newbcast:10 row_mask:0xf bank_mask:0xf
    v_fmac_f32_dpp v91, v106, v19 row_newbcast:10 row_mask:0xf bank_mask:0xf
    v_fmac_f32_dpp v92, v106, v20 row_newbcast:10 row_mask:0xf bank_mask:0xf
    v_fmac_f32_dpp v93, v106, v21 row_newbcast:10 row_mask:0xf bank_mask:0xf
    v_fmac_f32_dpp v94, v106, v22 row_newbcast:10 row_mask:0xf bank_mask:0xf
    v_fmac_f32_dpp v95, v106, v23 row_newbcast:10 row_mask:0xf bank_mask:0xf
    v_fmac_f32_dpp v96, v106, v24 row_newbcast:10 row_mask:0xf bank_mask:0xf
    v_fmac_f32_dpp v97, v106, v25 row_newbcast:10 row_mask:0xf bank_mask:0xf
    v_fmac_f32_dpp v98, v106, v26 row_newbcast:10 row_mask:0xf bank_mask:0xf
    v_fmac_f32_dpp v99, v106, v27 row_newbcast:10 row_mask:0xf bank_mask:0xf
    buffer_load_dwordx4 v[16:19], v1, s[28:31], s61 offen offset:3072 nt
    buffer_load_dwordx4 v[20:23], v1, s[28:31], s61 offen offset:3328 nt
    buffer_load_dwordx4 v[24:27], v1, s[28:31], s61 offen offset:3584 nt
    s_add_u32 s61, s61, 6144
    s_waitcnt vmcnt(9)
    v_cvt_f32_i32 v28, v28
    v_cvt_f32_i32 v29, v29
    v_cvt_f32_i32 v30, v30
    v_cvt_f32_i32 v31, v31
    v_cvt_f32_i32 v32, v32
    v_cvt_f32_i32 v33, v33
    v_cvt_f32_i32 v34, v34
    v_cvt_f32_i32 v35, v35
    v_cvt_f32_i32 v36, v36
    v_cvt_f32_i32 v37, v37
    v_cvt_f32_i32 v38, v38
    v_cvt_f32_i32 v39, v39
    v_fmac_f32_dpp v88, v106, v28 row_newbcast:6 row_mask:0xf bank_mask:0xf
    v_fmac_f32_dpp v89, v106, v29 row_newbcast:6 row_mask:0xf bank_mask:0xf
    v_fmac_f32_dpp v90, v106, v30 row_newbcast:6 row_mask:0xf bank_mask:0xf
    v_fmac_f32_dpp v91, v106, v31 row_newbcast:6 row_mask:0xf bank_mask:0xf
    v_fmac_f32_dpp v92, v106, v32 row_newbcast:6 row_mask:0xf bank_mask:0xf
    v_fmac_f32_dpp v93, v106, v33 row_newbcast:6 row_mask:0xf bank_mask:0xf
    v_fmac_f32_dpp v94, v106, v34 row_newbcast:6 row_mask:0xf bank_mask:0xf
    v_fmac_f32_dpp v95, v106, v35 row_newbcast:6 row_mask:0xf bank_mask:0xf
    v_fmac_f32_dpp v96, v106, v36 row_newbcast:6 row_mask:0xf bank_mask:0xf
    v_fmac_f32_dpp v97, v106, v37 row_newbcast:6 row_mask:0xf bank_mask:0xf
    v_fmac_f32_dpp v98, v106, v38 row_newbcast:6 row_mask:0xf bank_mask:0xf
    v_fmac_f32_dpp v99, v106, v39 row_newbcast:6 row_mask:0xf bank_mask:0xf
    buffer_load_dwordx4 v[28:31], v1, s[28:31], s61 offen offset:0 nt
    buffer_load_dwordx4 v[32:35], v1, s[28:31], s61 offen offset:256 nt
    buffer_load_dwordx4 v[36:39], v1, s[28:31], s61 offen offset:512 nt
    s_waitcnt vmcnt(9)
    v_cvt_f32_i32 v40, v40
    v_cvt_f32_i32 v41, v41
    v_cvt_f32_i32 v42, v42
    v_cvt_f32_i32 v43, v43
    v_cvt_f32_i32 v44, v44
    v_cvt_f32_i32 v45, v45
    v_cvt_f32_i32 v46, v46
    v_cvt_f32_i32 v47, v47
    v_cvt_f32_i32 v48, v48
    v_cvt_f32_i32 v49, v49
    v_cvt_f32_i32 v50, v50
    v_cvt_f32_i32 v51, v51
    v_fmac_f32_dpp v88, v106, v40 row_newbcast:14 row_mask:0xf bank_mask:0xf
    v_fmac_f32_dpp v89, v106, v41 row_newbcast:14 row_mask:0xf bank_mask:0xf
    v_fmac_f32_dpp v90, v106, v42 row_newbcast:14 row_mask:0xf bank_mask:0xf
    v_fmac_f32_dpp v91, v106, v43 row_newbcast:14 row_mask:0xf bank_mask:0xf
    v_fmac_f32_dpp v92, v106, v44 row_newbcast:14 row_mask:0xf bank_mask:0xf
    v_fmac_f32_dpp v93, v106, v45 row_newbcast:14 row_mask:0xf bank_mask:0xf
    v_fmac_f32_dpp v94, v106, v46 row_newbcast:14 row_mask:0xf bank_mask:0xf
    v_fmac_f32_dpp v95, v106, v47 row_newbcast:14 row_mask:0xf bank_mask:0xf
    v_fmac_f32_dpp v96, v106, v48 row_newbcast:14 row_mask:0xf bank_mask:0xf
    v_fmac_f32_dpp v97, v106, v49 row_newbcast:14 row_mask:0xf bank_mask:0xf
    v_fmac_f32_dpp v98, v106, v50 row_newbcast:14 row_mask:0xf bank_mask:0xf
    v_fmac_f32_dpp v99, v106, v51 row_newbcast:14 row_mask:0xf bank_mask:0xf
    buffer_load_dwordx4 v[40:43], v1, s[28:31], s61 offen offset:3072 nt
    buffer_load_dwordx4 v[44:47], v1, s[28:31], s61 offen offset:3328 nt
    buffer_load_dwordx4 v[48:51], v1, s[28:31], s61 offen offset:3584 nt
    s_add_u32 s61, s61, 6144
    s_waitcnt vmcnt(9)
    v_cvt_f32_i32 v4, v4
    v_cvt_f32_i32 v5, v5
    v_cvt_f32_i32 v6, v6
    v_cvt_f32_i32 v7, v7
    v_cvt_f32_i32 v8, v8
    v_cvt_f32_i32 v9, v9
    v_cvt_f32_i32 v10, v10
    v_cvt_f32_i32 v11, v11
    v_cvt_f32_i32 v12, v12
    v_cvt_f32_i32 v13, v13
    v_cvt_f32_i32 v14, v14
    v_cvt_f32_i32 v15, v15
    v_fmac_f32_dpp v88, v106, v4 row_newbcast:1 row_mask:0xf bank_mask:0xf
    v_fmac_f32_dpp v89, v106, v5 row_newbcast:1 row_mask:0xf bank_mask:0xf
    v_fmac_f32_dpp v90, v106, v6 row_newbcast:1 row_mask:0xf bank_mask:0xf
    v_fmac_f32_dpp v91, v106, v7 row_newbcast:1 row_mask:0xf bank_mask:0xf
    v_fmac_f32_dpp v92, v106, v8 row_newbcast:1 row_mask:0xf bank_mask:0xf
    v_fmac_f32_dpp v93, v106, v9 row_newbcast:1 row_mask:0xf bank_mask:0xf
    v_fmac_f32_dpp v94, v106, v10 row_newbcast:1 row_mask:0xf bank_mask:0xf
    v_fmac_f32_dpp v95, v106, v11 row_newbcast:1 row_mask:0xf bank_mask:0xf
    v_fmac_f32_dpp v96, v106, v12 row_newbcast:1 row_mask:0xf bank_mask:0xf
    v_fmac_f32_dpp v97, v106, v13 row_newbcast:1 row_mask:0xf bank_mask:0xf
    v_fmac_f32_dpp v98, v106, v14 row_newbcast:1 row_mask:0xf bank_mask:0xf
    v_fmac_f32_dpp v99, v106, v15 row_newbcast:1 row_mask:0xf bank_mask:0xf
    buffer_load_dwordx4 v[4:7], v1, s[28:31], s61 offen offset:0 nt
    buffer_load_dwordx4 v[8:11], v1, s[28:31], s61 offen offset:256 nt
    buffer_load_dwordx4 v[12:15], v1, s[28:31], s61 offen offset:512 nt
    s_waitcnt vmcnt(9)
    v_cvt_f32_i32 v16, v16
    v_cvt_f32_i32 v17, v17
    v_cvt_f32_i32 v18, v18
    v_cvt_f32_i32 v19, v19
    v_cvt_f32_i32 v20, v20
    v_cvt_f32_i32 v21, v21
    v_cvt_f32_i32 v22, v22
    v_cvt_f32_i32 v23, v23
    v_cvt_f32_i32 v24, v24
    v_cvt_f32_i32 v25, v25
    v_cvt_f32_i32 v26, v26
    v_cvt_f32_i32 v27, v27
    v_fmac_f32_dpp v88, v106, v16 row_newbcast:9 row_mask:0xf bank_mask:0xf
    v_fmac_f32_dpp v89, v106, v17 row_newbcast:9 row_mask:0xf bank_mask:0xf
    v_fmac_f32_dpp v90, v106, v18 row_newbcast:9 row_mask:0xf bank_mask:0xf
    v_fmac_f32_dpp v91, v106, v19 row_newbcast:9 row_mask:0xf bank_mask:0xf
    v_fmac_f32_dpp v92, v106, v20 row_newbcast:9 row_mask:0xf bank_mask:0xf
    v_fmac_f32_dpp v93, v106, v21 row_newbcast:9 row_mask:0xf bank_mask:0xf
    v_fmac_f32_dpp v94, v106, v22 row_newbcast:9 row_mask:0xf bank_mask:0xf
    v_fmac_f32_dpp v95, v106, v23 row_newbcast:9 row_mask:0xf bank_mask:0xf
    v_fmac_f32_dpp v96, v106, v24 row_newbcast:9 row_mask:0xf bank_mask:0xf
    v_fmac_f32_dpp v97, v106, v25 row_newbcast:9 row_mask:0xf bank_mask:0xf
    v_fmac_f32_dpp v98, v106, v26 row_newbcast:9 row_mask:0xf bank_mask:0xf
    v_fmac_f32_dpp v99, v106, v27 row_newbcast:9 row_mask:0xf bank_mask:0xf
    buffer_load_dwordx4 v[16:19], v1, s[28:31], s61 offen offset:3072 nt
    buffer_load_dwordx4 v[20:23], v1, s[28:31], s61 offen offset:3328 nt
    buffer_load_dwordx4 v[24:27], v1, s[28:31], s61 offen offset:3584 nt
    s_add_u32 s61, s61, 6144
    s_waitcnt vmcnt(9)
    v_cvt_f32_i32 v28, v28
    v_cvt_f32_i32 v29, v29
    v_cvt_f32_i32 v30, v30
    v_cvt_f32_i32 v31, v31
    v_cvt_f32_i32 v32, v32
    v_cvt_f32_i32 v33, v33
    v_cvt_f32_i32 v34, v34
    v_cvt_f32_i32 v35, v35
    v_cvt_f32_i32 v36, v36
    v_cvt_f32_i32 v37, v37
    v_cvt_f32_i32 v38, v38
    v_cvt_f32_i32 v39, v39
    v_fmac_f32_dpp v88, v106, v28 row_newbcast:5 row_mask:0xf bank_mask:0xf
    v_fmac_f32_dpp v89, v106, v29 row_newbcast:5 row_mask:0xf bank_mask:0xf
    v_fmac_f32_dpp v90, v106, v30 row_newbcast:5 row_mask:0xf bank_mask:0xf
    v_fmac_f32_dpp v91, v106, v31 row_newbcast:5 row_mask:0xf bank_mask:0xf
    v_fmac_f32_dpp v92, v106, v32 row_newbcast:5 row_mask:0xf bank_mask:0xf
    v_fmac_f32_dpp v93, v106, v33 row_newbcast:5 row_mask:0xf bank_mask:0xf
    v_fmac_f32_dpp v94, v106, v34 row_newbcast:5 row_mask:0xf bank_mask:0xf
    v_fmac_f32_dpp v95, v106, v35 row_newbcast:5 row_mask:0xf bank_mask:0xf
    v_fmac_f32_dpp v96, v106, v36 row_newbcast:5 row_mask:0xf bank_mask:0xf
    v_fmac_f32_dpp v97, v106, v37 row_newbcast:5 row_mask:0xf bank_mask:0xf
    v_fmac_f32_dpp v98, v106, v38 row_newbcast:5 row_mask:0xf bank_mask:0xf
    v_fmac_f32_dpp v99, v106, v39 row_newbcast:5 row_mask:0xf bank_mask:0xf
    buffer_load_dwordx4 v[28:31], v1, s[28:31], s61 offen offset:0 nt
    buffer_load_dwordx4 v[32:35], v1, s[28:31], s61 offen offset:256 nt
    buffer_load_dwordx4 v[36:39], v1, s[28:31], s61 offen offset:512 nt
    s_waitcnt vmcnt(9)
    v_cvt_f32_i32 v40, v40
    v_cvt_f32_i32 v41, v41
    v_cvt_f32_i32 v42, v42
    v_cvt_f32_i32 v43, v43
    v_cvt_f32_i32 v44, v44
    v_cvt_f32_i32 v45, v45
    v_cvt_f32_i32 v46, v46
    v_cvt_f32_i32 v47, v47
    v_cvt_f32_i32 v48, v48
    v_cvt_f32_i32 v49, v49
    v_cvt_f32_i32 v50, v50
    v_cvt_f32_i32 v51, v51
    v_fmac_f32_dpp v88, v106, v40 row_newbcast:13 row_mask:0xf bank_mask:0xf
    v_fmac_f32_dpp v89, v106, v41 row_newbcast:13 row_mask:0xf bank_mask:0xf
    v_fmac_f32_dpp v90, v106, v42 row_newbcast:13 row_mask:0xf bank_mask:0xf
    v_fmac_f32_dpp v91, v106, v43 row_newbcast:13 row_mask:0xf bank_mask:0xf
    v_fmac_f32_dpp v92, v106, v44 row_newbcast:13 row_mask:0xf bank_mask:0xf
    v_fmac_f32_dpp v93, v106, v45 row_newbcast:13 row_mask:0xf bank_mask:0xf
    v_fmac_f32_dpp v94, v106, v46 row_newbcast:13 row_mask:0xf bank_mask:0xf
    v_fmac_f32_dpp v95, v106, v47 row_newbcast:13 row_mask:0xf bank_mask:0xf
    v_fmac_f32_dpp v96, v106, v48 row_newbcast:13 row_mask:0xf bank_mask:0xf
    v_fmac_f32_dpp v97, v106, v49 row_newbcast:13 row_mask:0xf bank_mask:0xf
    v_fmac_f32_dpp v98, v106, v50 row_newbcast:13 row_mask:0xf bank_mask:0xf
    v_fmac_f32_dpp v99, v106, v51 row_newbcast:13 row_mask:0xf bank_mask:0xf
    buffer_load_dwordx4 v[40:43], v1, s[28:31], s61 offen offset:3072 nt
    buffer_load_dwordx4 v[44:47], v1, s[28:31], s61 offen offset:3328 nt
    buffer_load_dwordx4 v[48:51], v1, s[28:31], s61 offen offset:3584 nt
    s_add_u32 s61, s61, 6144
    s_waitcnt vmcnt(9)
    v_cvt_f32_i32 v4, v4
    v_cvt_f32_i32 v5, v5
    v_cvt_f32_i32 v6, v6
    v_cvt_f32_i32 v7, v7
    v_cvt_f32_i32 v8, v8
    v_cvt_f32_i32 v9, v9
    v_cvt_f32_i32 v10, v10
    v_cvt_f32_i32 v11, v11
    v_cvt_f32_i32 v12, v12
    v_cvt_f32_i32 v13, v13
    v_cvt_f32_i32 v14, v14
    v_cvt_f32_i32 v15, v15
    v_fmac_f32_dpp v88, v106, v4 row_newbcast:3 row_mask:0xf bank_mask:0xf
    v_fmac_f32_dpp v89, v106, v5 row_newbcast:3 row_mask:0xf bank_mask:0xf
    v_fmac_f32_dpp v90, v106, v6 row_newbcast:3 row_mask:0xf bank_mask:0xf
    v_fmac_f32_dpp v91, v106, v7 row_newbcast:3 row_mask:0xf bank_mask:0xf
    v_fmac_f32_dpp v92, v106, v8 row_newbcast:3 row_mask:0xf bank_mask:0xf
    v_fmac_f32_dpp v93, v106, v9 row_newbcast:3 row_mask:0xf bank_mask:0xf
    v_fmac_f32_dpp v94, v106, v10 row_newbcast:3 row_mask:0xf bank_mask:0xf
    v_fmac_f32_dpp v95, v106, v11 row_newbcast:3 row_mask:0xf bank_mask:0xf
    v_fmac_f32_dpp v96, v106, v12 row_newbcast:3 row_mask:0xf bank_mask:0xf
    v_fmac_f32_dpp v97, v106, v13 row_newbcast:3 row_mask:0xf bank_mask:0xf
    v_fmac_f32_dpp v98, v106, v14 row_newbcast:3 row_mask:0xf bank_mask:0xf
    v_fmac_f32_dpp v99, v106, v15 row_newbcast:3 row_mask:0xf bank_mask:0xf
    buffer_load_dwordx2 v[76:77], v2, s[32:35], s62 offen offset:0
    buffer_load_dwordx2 v[78:79], v2, s[32:35], s62 offen offset:128
    buffer_load_dwordx2 v[80:81], v2, s[32:35], s62 offen offset:256
    buffer_load_dwordx2 v[82:83], v2, s[36:39], s62 offen offset:0
    buffer_load_dwordx2 v[84:85], v2, s[36:39], s62 offen offset:128
    buffer_load_dwordx2 v[86:87], v2, s[36:39], s62 offen offset:256
    s_add_u32 s62, s62, 384
    buffer_load_dwordx4 v[4:7], v1, s[24:27], s60 offen offset:0 nt
    buffer_load_dwordx4 v[8:11], v1, s[24:27], s60 offen offset:256 nt
    buffer_load_dwordx4 v[12:15], v1, s[24:27], s60 offen offset:512 nt
    s_waitcnt vmcnt(15)
    v_cvt_f32_i32 v16, v16
    v_cvt_f32_i32 v17, v17
    v_cvt_f32_i32 v18, v18
    v_cvt_f32_i32 v19, v19
    v_cvt_f32_i32 v20, v20
    v_cvt_f32_i32 v21, v21
    v_cvt_f32_i32 v22, v22
    v_cvt_f32_i32 v23, v23
    v_cvt_f32_i32 v24, v24
    v_cvt_f32_i32 v25, v25
    v_cvt_f32_i32 v26, v26
    v_cvt_f32_i32 v27, v27
    v_fmac_f32_dpp v88, v106, v16 row_newbcast:11 row_mask:0xf bank_mask:0xf
    v_fmac_f32_dpp v89, v106, v17 row_newbcast:11 row_mask:0xf bank_mask:0xf
    v_fmac_f32_dpp v90, v106, v18 row_newbcast:11 row_mask:0xf bank_mask:0xf
    v_fmac_f32_dpp v91, v106, v19 row_newbcast:11 row_mask:0xf bank_mask:0xf
    v_fmac_f32_dpp v92, v106, v20 row_newbcast:11 row_mask:0xf bank_mask:0xf
    v_fmac_f32_dpp v93, v106, v21 row_newbcast:11 row_mask:0xf bank_mask:0xf
    v_fmac_f32_dpp v94, v106, v22 row_newbcast:11 row_mask:0xf bank_mask:0xf
    v_fmac_f32_dpp v95, v106, v23 row_newbcast:11 row_mask:0xf bank_mask:0xf
    v_fmac_f32_dpp v96, v106, v24 row_newbcast:11 row_mask:0xf bank_mask:0xf
    v_fmac_f32_dpp v97, v106, v25 row_newbcast:11 row_mask:0xf bank_mask:0xf
    v_fmac_f32_dpp v98, v106, v26 row_newbcast:11 row_mask:0xf bank_mask:0xf
    v_fmac_f32_dpp v99, v106, v27 row_newbcast:11 row_mask:0xf bank_mask:0xf
    buffer_load_dwordx4 v[16:19], v1, s[24:27], s60 offen offset:3072 nt
    buffer_load_dwordx4 v[20:23], v1, s[24:27], s60 offen offset:3328 nt
    buffer_load_dwordx4 v[24:27], v1, s[24:27], s60 offen offset:3584 nt
    s_add_u32 s60, s60, 6144
    s_waitcnt vmcnt(15)
    v_cvt_f32_i32 v28, v28
    v_cvt_f32_i32 v29, v29
    v_cvt_f32_i32 v30, v30
    v_cvt_f32_i32 v31, v31
    v_cvt_f32_i32 v32, v32
    v_cvt_f32_i32 v33, v33
    v_cvt_f32_i32 v34, v34
    v_cvt_f32_i32 v35, v35
    v_cvt_f32_i32 v36, v36
    v_cvt_f32_i32 v37, v37
    v_cvt_f32_i32 v38, v38
    v_cvt_f32_i32 v39, v39
    v_fmac_f32_dpp v88, v106, v28 row_newbcast:7 row_mask:0xf bank_mask:0xf
    v_fmac_f32_dpp v89, v106, v29 row_newbcast:7 row_mask:0xf bank_mask:0xf
    v_fmac_f32_dpp v90, v106, v30 row_newbcast:7 row_mask:0xf bank_mask:0xf
    v_fmac_f32_dpp v91, v106, v31 row_newbcast:7 row_mask:0xf bank_mask:0xf
    v_fmac_f32_dpp v92, v106, v32 row_newbcast:7 row_mask:0xf bank_mask:0xf
    v_fmac_f32_dpp v93, v106, v33 row_newbcast:7 row_mask:0xf bank_mask:0xf
    v_fmac_f32_dpp v94, v106, v34 row_newbcast:7 row_mask:0xf bank_mask:0xf
    v_fmac_f32_dpp v95, v106, v35 row_newbcast:7 row_mask:0xf bank_mask:0xf
    v_fmac_f32_dpp v96, v106, v36 row_newbcast:7 row_mask:0xf bank_mask:0xf
    v_fmac_f32_dpp v97, v106, v37 row_newbcast:7 row_mask:0xf bank_mask:0xf
    v_fmac_f32_dpp v98, v106, v38 row_newbcast:7 row_mask:0xf bank_mask:0xf
    v_fmac_f32_dpp v99, v106, v39 row_newbcast:7 row_mask:0xf bank_mask:0xf
    buffer_load_dwordx4 v[28:31], v1, s[24:27], s60 offen offset:0 nt
    buffer_load_dwordx4 v[32:35], v1, s[24:27], s60 offen offset:256 nt
    buffer_load_dwordx4 v[36:39], v1, s[24:27], s60 offen offset:512 nt
    s_waitcnt vmcnt(15)
    v_cvt_f32_i32 v40, v40
    v_cvt_f32_i32 v41, v41
    v_cvt_f32_i32 v42, v42
    v_cvt_f32_i32 v43, v43
    v_cvt_f32_i32 v44, v44
    v_cvt_f32_i32 v45, v45
    v_cvt_f32_i32 v46, v46
    v_cvt_f32_i32 v47, v47
    v_cvt_f32_i32 v48, v48
    v_cvt_f32_i32 v49, v49
    v_cvt_f32_i32 v50, v50
    v_cvt_f32_i32 v51, v51
    v_fmac_f32_dpp v88, v106, v40 row_newbcast:15 row_mask:0xf bank_mask:0xf
    v_fmac_f32_dpp v89, v106, v41 row_newbcast:15 row_mask:0xf bank_mask:0xf
    v_fmac_f32_dpp v90, v106, v42 row_newbcast:15 row_mask:0xf bank_mask:0xf
    v_fmac_f32_dpp v91, v106, v43 row_newbcast:15 row_mask:0xf bank_mask:0xf
    v_fmac_f32_dpp v92, v106, v44 row_newbcast:15 row_mask:0xf bank_mask:0xf
    v_fmac_f32_dpp v93, v106, v45 row_newbcast:15 row_mask:0xf bank_mask:0xf
    v_fmac_f32_dpp v94, v106, v46 row_newbcast:15 row_mask:0xf bank_mask:0xf
    v_fmac_f32_dpp v95, v106, v47 row_newbcast:15 row_mask:0xf bank_mask:0xf
    v_fmac_f32_dpp v96, v106, v48 row_newbcast:15 row_mask:0xf bank_mask:0xf
    v_fmac_f32_dpp v97, v106, v49 row_newbcast:15 row_mask:0xf bank_mask:0xf
    v_fmac_f32_dpp v98, v106, v50 row_newbcast:15 row_mask:0xf bank_mask:0xf
    v_fmac_f32_dpp v99, v106, v51 row_newbcast:15 row_mask:0xf bank_mask:0xf
    buffer_load_dwordx4 v[40:43], v1, s[24:27], s60 offen offset:3072 nt
    buffer_load_dwordx4 v[44:47], v1, s[24:27], s60 offen offset:3328 nt
    buffer_load_dwordx4 v[48:51], v1, s[24:27], s60 offen offset:3584 nt
    s_add_u32 s60, s60, 6144
    s_sub_u32 s64, s64, 1
    s_cmp_lg_u32 s64, 0
    s_cbranch_scc1 L_loop
    s_waitcnt vmcnt(9)
    v_lshlrev_b32 v113, 16, v76
    v_and_b32 v114, 0xffff0000, v76
    v_mul_f32 v64, v113, v52
    v_mul_f32 v65, v114, v53
    v_lshlrev_b32 v113, 16, v82
    v_and_b32 v114, 0xffff0000, v82
    v_mul_f32 v100, v64, v113
    v_fmac_f32 v100, v65, v114
    v_lshlrev_b32 v113, 16, v77
    v_and_b32 v114, 0xffff0000, v77
    v_mul_f32 v66, v113, v54
    v_mul_f32 v67, v114, v55
    v_lshlrev_b32 v113, 16, v83
    v_and_b32 v114, 0xffff0000, v83
    v_fmac_f32 v100, v66, v113
    v_fmac_f32 v100, v67, v114
    v_lshlrev_b32 v113, 16, v78
    v_and_b32 v114, 0xffff0000, v78
    v_mul_f32 v68, v113, v56
    v_mul_f32 v69, v114, v57
    v_lshlrev_b32 v113, 16, v84
    v_and_b32 v114, 0xffff0000, v84
    v_fmac_f32 v100, v68, v113
    v_fmac_f32 v100, v69, v114
    v_lshlrev_b32 v113, 16, v79
    v_and_b32 v114, 0xffff0000, v79
    v_mul_f32 v70, v113, v58
    v_mul_f32 v71, v114, v59
    v_lshlrev_b32 v113, 16, v85
    v_and_b32 v114, 0xffff0000, v85
    v_fmac_f32 v100, v70, v113
    v_fmac_f32 v100, v71, v114
    v_lshlrev_b32 v113, 16, v80
    v_and_b32 v114, 0xffff0000, v80
    v_mul_f32 v72, v113, v60
    v_mul_f32 v73, v114, v61
    v_lshlrev_b32 v113, 16, v86
    v_and_b32 v114, 0xffff0000, v86
    v_fmac_f32 v100, v72, v113
    v_fmac_f32 v100, v73, v114
    v_lshlrev_b32 v113, 16, v81
    v_and_b32 v114, 0xffff0000, v81
    v_mul_f32 v74, v113, v62
    v_mul_f32 v75, v114, v63
    v_lshlrev_b32 v113, 16, v87
    v_and_b32 v114, 0xffff0000, v87
    v_fmac_f32 v100, v74, v113
    v_fmac_f32 v100, v75, v114
    v_cvt_f32_i32 v4, v4
    v_cvt_f32_i32 v5, v5
    v_cvt_f32_i32 v6, v6
    v_cvt_f32_i32 v7, v7
    v_cvt_f32_i32 v8, v8
    v_cvt_f32_i32 v9, v9
    v_cvt_f32_i32 v10, v10
    v_cvt_f32_i32 v11, v11
    v_cvt_f32_i32 v12, v12
    v_cvt_f32_i32 v13, v13
    v_cvt_f32_i32 v14, v14
    v_cvt_f32_i32 v15, v15
    v_fma_f32 v107, v64, v4, -v100
    v_fmac_f32 v107, v65, v5
    v_fmac_f32 v107, v66, v6
    v_fmac_f32 v107, v67, v7
    v_fmac_f32 v107, v68, v8
    v_fmac_f32 v107, v69, v9
    v_fmac_f32 v107, v70, v10
    v_fmac_f32 v107, v71, v11
    v_fmac_f32 v107, v72, v12
    v_fmac_f32 v107, v73, v13
    v_fmac_f32 v107, v74, v14
    v_fmac_f32 v107, v75, v15
    buffer_load_dwordx4 v[4:7], v1, s[24:27], s60 offen offset:0 nt
    buffer_load_dwordx4 v[8:11], v1, s[24:27], s60 offen offset:256 nt
    buffer_load_dwordx4 v[12:15], v1, s[24:27], s60 offen offset:512 nt
    v_add_f32_dpp v108, v107, v107 row_ror:8 row_mask:0xf bank_mask:0x3
    s_waitcnt vmcnt(9)
    v_cvt_f32_i32 v16, v16
    v_cvt_f32_i32 v17, v17
    v_cvt_f32_i32 v18, v18
    v_cvt_f32_i32 v19, v19
    v_cvt_f32_i32 v20, v20
    v_cvt_f32_i32 v21, v21
    v_cvt_f32_i32 v22, v22
    v_cvt_f32_i32 v23, v23
    v_cvt_f32_i32 v24, v24
    v_cvt_f32_i32 v25, v25
    v_cvt_f32_i32 v26, v26
    v_cvt_f32_i32 v27, v27
    v_fma_f32 v107, v64, v16, -v100
    v_fmac_f32 v107, v65, v17
    v_fmac_f32 v107, v66, v18
    v_fmac_f32 v107, v67, v19
    v_fmac_f32 v107, v68, v20
    v_fmac_f32 v107, v69, v21
    v_fmac_f32 v107, v70, v22
    v_fmac_f32 v107, v71, v23
    v_fmac_f32 v107, v72, v24
    v_fmac_f32 v107, v73, v25
    v_fmac_f32 v107, v74, v26
    v_fmac_f32 v107, v75, v27
    buffer_load_dwordx4 v[16:19], v1, s[24:27], s60 offen offset:3072 nt
    buffer_load_dwordx4 v[20:23], v1, s[24:27], s60 offen offset:3328 nt
    buffer_load_dwordx4 v[24:27], v1, s[24:27], s60 offen offset:3584 nt
    s_add_u32 s60, s60, 6144
    v_add_f32_dpp v108, v107, v107 row_ror:8 row_mask:0xf bank_mask:0xc
    s_nop 1
    v_add_f32_dpp v109, v108, v108 row_shl:4 row_mask:0xf bank_mask:0x5
    s_waitcnt vmcnt(9)
    v_cvt_f32_i32 v28, v28
    v_cvt_f32_i32 v29, v29
    v_cvt_f32_i32 v30, v30
    v_cvt_f32_i32 v31, v31
    v_cvt_f32_i32 v32, v32
    v_cvt_f32_i32 v33, v33
    v_cvt_f32_i32 v34, v34
    v_cvt_f32_i32 v35, v35
    v_cvt_f32_i32 v36, v36
    v_cvt_f32_i32 v37, v37
    v_cvt_f32_i32 v38, v38
    v_cvt_f32_i32 v39, v39
    v_fma_f32 v107, v64, v28, -v100
    v_fmac_f32 v107, v65, v29
    v_fmac_f32 v107, v66, v30
    v_fmac_f32 v107, v67, v31
    v_fmac_f32 v107, v68, v32
    v_fmac_f32 v107, v69, v33
    v_fmac_f32 v107, v70, v34
    v_fmac_f32 v107, v71, v35
    v_fmac_f32 v107, v72, v36
    v_fmac_f32 v107, v73, v37
    v_fmac_f32 v107, v74, v38
    v_fmac_f32 v107, v75, v39
    buffer_load_dwordx4 v[28:31], v1, s[24:27], s60 offen offset:0 nt
    buffer_load_dwordx4 v[32:35], v1, s[24:27], s60 offen offset:256 nt
    buffer_load_dwordx4 v[36:39], v1, s[24:27], s60 offen offset:512 nt
    v_add_f32_dpp v108, v107, v107 row_ror:8 row_mask:0xf bank_mask:0x3
    s_waitcnt vmcnt(9)
    v_cvt_f32_i32 v40, v40
    v_cvt_f32_i32 v41, v41
    v_cvt_f32_i32 v42, v42
    v_cvt_f32_i32 v43, v43
    v_cvt_f32_i32 v44, v44
    v_cvt_f32_i32 v45, v45
    v_cvt_f32_i32 v46, v46
    v_cvt_f32_i32 v47, v47
    v_cvt_f32_i32 v48, v48
    v_cvt_f32_i32 v49, v49
    v_cvt_f32_i32 v50, v50
    v_cvt_f32_i32 v51, v51
    v_fma_f32 v107, v64, v40, -v100
    v_fmac_f32 v107, v65, v41
    v_fmac_f32 v107, v66, v42
    v_fmac_f32 v107, v67, v43
    v_fmac_f32 v107, v68, v44
    v_fmac_f32 v107, v69, v45
    v_fmac_f32 v107, v70, v46
    v_fmac_f32 v107, v71, v47
    v_fmac_f32 v107, v72, v48
    v_fmac_f32 v107, v73, v49
    v_fmac_f32 v107, v74, v50
    v_fmac_f32 v107, v75, v51
    buffer_load_dwordx4 v[40:43], v1, s[24:27], s60 offen offset:3072 nt
    buffer_load_dwordx4 v[44:47], v1, s[24:27], s60 offen offset:3328 nt
    buffer_load_dwordx4 v[48:51], v1, s[24:27], s60 offen offset:3584 nt
    s_add_u32 s60, s60, 6144
    v_add_f32_dpp v108, v107, v107 row_ror:8 row_mask:0xf bank_mask:0xc
    s_nop 1
    v_add_f32_dpp v109, v108, v108 row_shr:4 row_mask:0xf bank_mask:0xa
    s_nop 1
    v_add_f32_dpp v110, v109, v109 quad_perm:[2,3,0,1] row_mask:0xf bank_mask:0xf
    s_waitcnt vmcnt(9)
    v_cvt_f32_i32 v4, v4
    v_cvt_f32_i32 v5, v5
    v_cvt_f32_i32 v6, v6
    v_cvt_f32_i32 v7, v7
    v_cvt_f32_i32 v8, v8
    v_cvt_f32_i32 v9, v9
    v_cvt_f32_i32 v10, v10
    v_cvt_f32_i32 v11, v11
    v_cvt_f32_i32 v12, v12
    v_cvt_f32_i32 v13, v13
    v_cvt_f32_i32 v14, v14
    v_cvt_f32_i32 v15, v15
    v_fma_f32 v107, v64, v4, -v100
    v_fmac_f32 v107, v65, v5
    v_fmac_f32 v107, v66, v6
    v_fmac_f32 v107, v67, v7
    v_fmac_f32 v107, v68, v8
    v_fmac_f32 v107, v69, v9
    v_fmac_f32 v107, v70, v10
    v_fmac_f32 v107, v71, v11
    v_fmac_f32 v107, v72, v12
    v_fmac_f32 v107, v73, v13
    v_fmac_f32 v107, v74, v14
    v_fmac_f32 v107, v75, v15
    buffer_load_dwordx4 v[4:7], v1, s[24:27], s60 offen offset:0 nt
    buffer_load_dwordx4 v[8:11], v1, s[24:27], s60 offen offset:256 nt
    buffer_load_dwordx4 v[12:15], v1, s[24:27], s60 offen offset:512 nt
    v_add_f32_dpp v108, v107, v107 row_ror:8 row_mask:0xf bank_mask:0x3
    s_waitcnt vmcnt(9)
    v_cvt_f32_i32 v16, v16
    v_cvt_f32_i32 v17, v17
    v_cvt_f32_i32 v18, v18
    v_cvt_f32_i32 v19, v19
    v_cvt_f32_i32 v20, v20
    v_cvt_f32_i32 v21, v21
    v_cvt_f32_i32 v22, v22
    v_cvt_f32_i32 v23, v23
    v_cvt_f32_i32 v24, v24
    v_cvt_f32_i32 v25, v25
    v_cvt_f32_i32 v26, v26
    v_cvt_f32_i32 v27, v27
    v_fma_f32 v107, v64, v16, -v100
    v_fmac_f32 v107, v65, v17
    v_fmac_f32 v107, v66, v18
    v_fmac_f32 v107, v67, v19
    v_fmac_f32 v107, v68, v20
    v_fmac_f32 v107, v69, v21
    v_fmac_f32 v107, v70, v22
    v_fmac_f32 v107, v71, v23
    v_fmac_f32 v107, v72, v24
    v_fmac_f32 v107, v73, v25
    v_fmac_f32 v107, v74, v26
    v_fmac_f32 v107, v75, v27
    buffer_load_dwordx4 v[16:19], v1, s[24:27], s60 offen offset:3072 nt
    buffer_load_dwordx4 v[20:23], v1, s[24:27], s60 offen offset:3328 nt
    buffer_load_dwordx4 v[24:27], v1, s[24:27], s60 offen offset:3584 nt
    s_add_u32 s60, s60, 6144
    v_add_f32_dpp v108, v107, v107 row_ror:8 row_mask:0xf bank_mask:0xc
    s_nop 1
    v_add_f32_dpp v109, v108, v108 row_shl:4 row_mask:0xf bank_mask:0x5
    s_waitcnt vmcnt(9)
    v_cvt_f32_i32 v28, v28
    v_cvt_f32_i32 v29, v29
    v_cvt_f32_i32 v30, v30
    v_cvt_f32_i32 v31, v31
    v_cvt_f32_i32 v32, v32
    v_cvt_f32_i32 v33, v33
    v_cvt_f32_i32 v34, v34
    v_cvt_f32_i32 v35, v35
    v_cvt_f32_i32 v36, v36
    v_cvt_f32_i32 v37, v37
    v_cvt_f32_i32 v38, v38
    v_cvt_f32_i32 v39, v39
    v_fma_f32 v107, v64, v28, -v100
    v_fmac_f32 v107, v65, v29
    v_fmac_f32 v107, v66, v30
    v_fmac_f32 v107, v67, v31
    v_fmac_f32 v107, v68, v32
    v_fmac_f32 v107, v69, v33
    v_fmac_f32 v107, v70, v34
    v_fmac_f32 v107, v71, v35
    v_fmac_f32 v107, v72, v36
    v_fmac_f32 v107, v73, v37
    v_fmac_f32 v107, v74, v38
    v_fmac_f32 v107, v75, v39
    buffer_load_dwordx4 v[28:31], v1, s[24:27], s60 offen offset:0 nt
    buffer_load_dwordx4 v[32:35], v1, s[24:27], s60 offen offset:256 nt
    buffer_load_dwordx4 v[36:39], v1, s[24:27], s60 offen offset:512 nt
    v_add_f32_dpp v108, v107, v107 row_ror:8 row_mask:0xf bank_mask:0x3
    s_waitcnt vmcnt(9)
    v_cvt_f32_i32 v40, v40
    v_cvt_f32_i32 v41, v41
    v_cvt_f32_i32 v42, v42
    v_cvt_f32_i32 v43, v43
    v_cvt_f32_i32 v44, v44
    v_cvt_f32_i32 v45, v45
    v_cvt_f32_i32 v46, v46
    v_cvt_f32_i32 v47, v47
    v_cvt_f32_i32 v48, v48
    v_cvt_f32_i32 v49, v49
    v_cvt_f32_i32 v50, v50
    v_cvt_f32_i32 v51, v51
    v_fma_f32 v107, v64, v40, -v100
    v_fmac_f32 v107, v65, v41
    v_fmac_f32 v107, v66, v42
    v_fmac_f32 v107, v67, v43
    v_fmac_f32 v107, v68, v44
    v_fmac_f32 v107, v69, v45
    v_fmac_f32 v107, v70, v46
    v_fmac_f32 v107, v71, v47
    v_fmac_f32 v107, v72, v48
    v_fmac_f32 v107, v73, v49
    v_fmac_f32 v107, v74, v50
    v_fmac_f32 v107, v75, v51
    buffer_load_dwordx4 v[40:43], v1, s[24:27], s60 offen offset:3072 nt
    buffer_load_dwordx4 v[44:47], v1, s[24:27], s60 offen offset:3328 nt
    buffer_load_dwordx4 v[48:51], v1, s[24:27], s60 offen offset:3584 nt
    s_add_u32 s60, s60, 6144
    v_add_f32_dpp v108, v107, v107 row_ror:8 row_mask:0xf bank_mask:0xc
    s_nop 1
    v_add_f32_dpp v109, v108, v108 row_shr:4 row_mask:0xf bank_mask:0xa
    s_nop 1
    v_add_f32_dpp v111, v109, v109 quad_perm:[2,3,0,1] row_mask:0xf bank_mask:0xf
    v_cndmask_b32 v111, v110, v111, s[66:67]
    s_nop 1
    v_add_f32_dpp v112, v111, v111 quad_perm:[1,0,3,2] row_mask:0xf bank_mask:0xf
    s_waitcnt vmcnt(9)
    v_cvt_f32_i32 v4, v4
    v_cvt_f32_i32 v5, v5
    v_cvt_f32_i32 v6, v6
    v_cvt_f32_i32 v7, v7
    v_cvt_f32_i32 v8, v8
    v_cvt_f32_i32 v9, v9
    v_cvt_f32_i32 v10, v10
    v_cvt_f32_i32 v11, v11
    v_cvt_f32_i32 v12, v12
    v_cvt_f32_i32 v13, v13
    v_cvt_f32_i32 v14, v14
    v_cvt_f32_i32 v15, v15
    v_fma_f32 v107, v64, v4, -v100
    v_fmac_f32 v107, v65, v5
    v_fmac_f32 v107, v66, v6
    v_fmac_f32 v107, v67, v7
    v_fmac_f32 v107, v68, v8
    v_fmac_f32 v107, v69, v9
    v_fmac_f32 v107, v70, v10
    v_fmac_f32 v107, v71, v11
    v_fmac_f32 v107, v72, v12
    v_fmac_f32 v107, v73, v13
    v_fmac_f32 v107, v74, v14
    v_fmac_f32 v107, v75, v15
    buffer_load_dwordx4 v[4:7], v1, s[24:27], s60 offen offset:0 nt
    buffer_load_dwordx4 v[8:11], v1, s[24:27], s60 offen offset:256 nt
    buffer_load_dwordx4 v[12:15], v1, s[24:27], s60 offen offset:512 nt
    v_add_f32_dpp v108, v107, v107 row_ror:8 row_mask:0xf bank_mask:0x3
    s_waitcnt vmcnt(9)
    v_cvt_f32_i32 v16, v16
    v_cvt_f32_i32 v17, v17
    v_cvt_f32_i32 v18, v18
    v_cvt_f32_i32 v19, v19
    v_cvt_f32_i32 v20, v20
    v_cvt_f32_i32 v21, v21
    v_cvt_f32_i32 v22, v22
    v_cvt_f32_i32 v23, v23
    v_cvt_f32_i32 v24, v24
    v_cvt_f32_i32 v25, v25
    v_cvt_f32_i32 v26, v26
    v_cvt_f32_i32 v27, v27
    v_fma_f32 v107, v64, v16, -v100
    v_fmac_f32 v107, v65, v17
    v_fmac_f32 v107, v66, v18
    v_fmac_f32 v107, v67, v19
    v_fmac_f32 v107, v68, v20
    v_fmac_f32 v107, v69, v21
    v_fmac_f32 v107, v70, v22
    v_fmac_f32 v107, v71, v23
    v_fmac_f32 v107, v72, v24
    v_fmac_f32 v107, v73, v25
    v_fmac_f32 v107, v74, v26
    v_fmac_f32 v107, v75, v27
    buffer_load_dwordx4 v[16:19], v1, s[24:27], s60 offen offset:3072 nt
    buffer_load_dwordx4 v[20:23], v1, s[24:27], s60 offen offset:3328 nt
    buffer_load_dwordx4 v[24:27], v1, s[24:27], s60 offen offset:3584 nt
    s_add_u32 s60, s60, 6144
    v_add_f32_dpp v108, v107, v107 row_ror:8 row_mask:0xf bank_mask:0xc
    s_nop 1
    v_add_f32_dpp v109, v108, v108 row_shl:4 row_mask:0xf bank_mask:0x5
    s_waitcnt vmcnt(9)
    v_cvt_f32_i32 v28, v28
    v_cvt_f32_i32 v29, v29
    v_cvt_f32_i32 v30, v30
    v_cvt_f32_i32 v31, v31
    v_cvt_f32_i32 v32, v32
    v_cvt_f32_i32 v33, v33
    v_cvt_f32_i32 v34, v34
    v_cvt_f32_i32 v35, v35
    v_cvt_f32_i32 v36, v36
    v_cvt_f32_i32 v37, v37
    v_cvt_f32_i32 v38, v38
    v_cvt_f32_i32 v39, v39
    v_fma_f32 v107, v64, v28, -v100
    v_fmac_f32 v107, v65, v29
    v_fmac_f32 v107, v66, v30
    v_fmac_f32 v107, v67, v31
    v_fmac_f32 v107, v68, v32
    v_fmac_f32 v107, v69, v33
    v_fmac_f32 v107, v70, v34
    v_fmac_f32 v107, v71, v35
    v_fmac_f32 v107, v72, v36
    v_fmac_f32 v107, v73, v37
    v_fmac_f32 v107, v74, v38
    v_fmac_f32 v107, v75, v39
    buffer_load_dwordx4 v[28:31], v1, s[24:27], s60 offen offset:0 nt
    buffer_load_dwordx4 v[32:35], v1, s[24:27], s60 offen offset:256 nt
    buffer_load_dwordx4 v[36:39], v1, s[24:27], s60 offen offset:512 nt
    v_add_f32_dpp v108, v107, v107 row_ror:8 row_mask:0xf bank_mask:0x3
    s_waitcnt vmcnt(9)
    v_cvt_f32_i32 v40, v40
    v_cvt_f32_i32 v41, v41
    v_cvt_f32_i32 v42, v42
    v_cvt_f32_i32 v43, v43
    v_cvt_f32_i32 v44, v44
    v_cvt_f32_i32 v45, v45
    v_cvt_f32_i32 v46, v46
    v_cvt_f32_i32 v47, v47
    v_cvt_f32_i32 v48, v48
    v_cvt_f32_i32 v49, v49
    v_cvt_f32_i32 v50, v50
    v_cvt_f32_i32 v51, v51
    v_fma_f32 v107, v64, v40, -v100
    v_fmac_f32 v107, v65, v41
    v_fmac_f32 v107, v66, v42
    v_fmac_f32 v107, v67, v43
    v_fmac_f32 v107, v68, v44
    v_fmac_f32 v107, v69, v45
    v_fmac_f32 v107, v70, v46
    v_fmac_f32 v107, v71, v47
    v_fmac_f32 v107, v72, v48
    v_fmac_f32 v107, v73, v49
    v_fmac_f32 v107, v74, v50
    v_fmac_f32 v107, v75, v51
    buffer_load_dwordx4 v[40:43], v1, s[24:27], s60 offen offset:3072 nt
    buffer_load_dwordx4 v[44:47], v1, s[24:27], s60 offen offset:3328 nt
    buffer_load_dwordx4 v[48:51], v1, s[24:27], s60 offen offset:3584 nt
    s_add_u32 s60, s60, 6144
    v_add_f32_dpp v108, v107, v107 row_ror:8 row_mask:0xf bank_mask:0xc
    s_nop 1
    v_add_f32_dpp v109, v108, v108 row_shr:4 row_mask:0xf bank_mask:0xa
    s_nop 1
    v_add_f32_dpp v110, v109, v109 quad_perm:[2,3,0,1] row_mask:0xf bank_mask:0xf
    s_waitcnt vmcnt(9)
    v_cvt_f32_i32 v4, v4
    v_cvt_f32_i32 v5, v5
    v_cvt_f32_i32 v6, v6
    v_cvt_f32_i32 v7, v7
    v_cvt_f32_i32 v8, v8
    v_cvt_f32_i32 v9, v9
    v_cvt_f32_i32 v10, v10
    v_cvt_f32_i32 v11, v11
    v_cvt_f32_i32 v12, v12
    v_cvt_f32_i32 v13, v13
    v_cvt_f32_i32 v14, v14
    v_cvt_f32_i32 v15, v15
    v_fma_f32 v107, v64, v4, -v100
    v_fmac_f32 v107, v65, v5
    v_fmac_f32 v107, v66, v6
    v_fmac_f32 v107, v67, v7
    v_fmac_f32 v107, v68, v8
    v_fmac_f32 v107, v69, v9
    v_fmac_f32 v107, v70, v10
    v_fmac_f32 v107, v71, v11
    v_fmac_f32 v107, v72, v12
    v_fmac_f32 v107, v73, v13
    v_fmac_f32 v107, v74, v14
    v_fmac_f32 v107, v75, v15
    buffer_load_ushort v104, v3, s[40:43], s63 offen
    buffer_load_ushort v105, v3, s[44:47], s63 offen
    s_add_u32 s63, s63, 128
    buffer_load_dwordx4 v[4:7], v1, s[28:31], s61 offen offset:0 nt
    buffer_load_dwordx4 v[8:11], v1, s[28:31], s61 offen offset:256 nt
    buffer_load_dwordx4 v[12:15], v1, s[28:31], s61 offen offset:512 nt
    v_add_f32_dpp v108, v107, v107 row_ror:8 row_mask:0xf bank_mask:0x3
    s_waitcnt vmcnt(11)
    v_cvt_f32_i32 v16, v16
    v_cvt_f32_i32 v17, v17
    v_cvt_f32_i32 v18, v18
    v_cvt_f32_i32 v19, v19
    v_cvt_f32_i32 v20, v20
    v_cvt_f32_i32 v21, v21
    v_cvt_f32_i32 v22, v22
    v_cvt_f32_i32 v23, v23
    v_cvt_f32_i32 v24, v24
    v_cvt_f32_i32 v25, v25
    v_cvt_f32_i32 v26, v26
    v_cvt_f32_i32 v27, v27
    v_fma_f32 v107, v64, v16, -v100
    v_fmac_f32 v107, v65, v17
    v_fmac_f32 v107, v66, v18
    v_fmac_f32 v107, v67, v19
    v_fmac_f32 v107, v68, v20
    v_fmac_f32 v107, v69, v21
    v_fmac_f32 v107, v70, v22
    v_fmac_f32 v107, v71, v23
    v_fmac_f32 v107, v72, v24
    v_fmac_f32 v107, v73, v25
    v_fmac_f32 v107, v74, v26
    v_fmac_f32 v107, v75, v27
    buffer_load_dwordx4 v[16:19], v1, s[28:31], s61 offen offset:3072 nt
    buffer_load_dwordx4 v[20:23], v1, s[28:31], s61 offen offset:3328 nt
    buffer_load_dwordx4 v[24:27], v1, s[28:31], s61 offen offset:3584 nt
    s_add_u32 s61, s61, 6144
    v_add_f32_dpp v108, v107, v107 row_ror:8 row_mask:0xf bank_mask:0xc
    s_nop 1
    v_add_f32_dpp v109, v108, v108 row_shl:4 row_mask:0xf bank_mask:0x5
    s_waitcnt vmcnt(11)
    v_cvt_f32_i32 v28, v28
    v_cvt_f32_i32 v29, v29
    v_cvt_f32_i32 v30, v30
    v_cvt_f32_i32 v31, v31
    v_cvt_f32_i32 v32, v32
    v_cvt_f32_i32 v33, v33
    v_cvt_f32_i32 v34, v34
    v_cvt_f32_i32 v35, v35
    v_cvt_f32_i32 v36, v36
    v_cvt_f32_i32 v37, v37
    v_cvt_f32_i32 v38, v38
    v_cvt_f32_i32 v39, v39
    v_fma_f32 v107, v64, v28, -v100
    v_fmac_f32 v107, v65, v29
    v_fmac_f32 v107, v66, v30
    v_fmac_f32 v107, v67, v31
    v_fmac_f32 v107, v68, v32
    v_fmac_f32 v107, v69, v33
    v_fmac_f32 v107, v70, v34
    v_fmac_f32 v107, v71, v35
    v_fmac_f32 v107, v72, v36
    v_fmac_f32 v107, v73, v37
    v_fmac_f32 v107, v74, v38
    v_fmac_f32 v107, v75, v39
    buffer_load_dwordx4 v[28:31], v1, s[28:31], s61 offen offset:0 nt
    buffer_load_dwordx4 v[32:35], v1, s[28:31], s61 offen offset:256 nt
    buffer_load_dwordx4 v[36:39], v1, s[28:31], s61 offen offset:512 nt
    v_add_f32_dpp v108, v107, v107 row_ror:8 row_mask:0xf bank_mask:0x3
    s_waitcnt vmcnt(11)
    v_cvt_f32_i32 v40, v40
    v_cvt_f32_i32 v41, v41
    v_cvt_f32_i32 v42, v42
    v_cvt_f32_i32 v43, v43
    v_cvt_f32_i32 v44, v44
    v_cvt_f32_i32 v45, v45
    v_cvt_f32_i32 v46, v46
    v_cvt_f32_i32 v47, v47
    v_cvt_f32_i32 v48, v48
    v_cvt_f32_i32 v49, v49
    v_cvt_f32_i32 v50, v50
    v_cvt_f32_i32 v51, v51
    v_fma_f32 v107, v64, v40, -v100
    v_fmac_f32 v107, v65, v41
    v_fmac_f32 v107, v66, v42
    v_fmac_f32 v107, v67, v43
    v_fmac_f32 v107, v68, v44
    v_fmac_f32 v107, v69, v45
    v_fmac_f32 v107, v70, v46
    v_fmac_f32 v107, v71, v47
    v_fmac_f32 v107, v72, v48
    v_fmac_f32 v107, v73, v49
    v_fmac_f32 v107, v74, v50
    v_fmac_f32 v107, v75, v51
    buffer_load_dwordx4 v[40:43], v1, s[28:31], s61 offen offset:3072 nt
    buffer_load_dwordx4 v[44:47], v1, s[28:31], s61 offen offset:3328 nt
    buffer_load_dwordx4 v[48:51], v1, s[28:31], s61 offen offset:3584 nt
    s_add_u32 s61, s61, 6144
    v_add_f32_dpp v108, v107, v107 row_ror:8 row_mask:0xf bank_mask:0xc
    s_nop 1
    v_add_f32_dpp v109, v108, v108 row_shr:4 row_mask:0xf bank_mask:0xa
    s_nop 1
    v_add_f32_dpp v111, v109, v109 quad_perm:[2,3,0,1] row_mask:0xf bank_mask:0xf
    v_cndmask_b32 v111, v110, v111, s[66:67]
    s_nop 1
    v_add_f32_dpp v110, v111, v111 quad_perm:[1,0,3,2] row_mask:0xf bank_mask:0xf
    v_cndmask_b32 v112, v112, v110, s[68:69]
    s_nop 1
    s_waitcnt vmcnt(9)
    v_max_f32_dpp v113, v112, v112 row_ror:8 row_mask:0xf bank_mask:0xf
    v_lshlrev_b32 v104, 16, v104
    v_lshlrev_b32 v105, 16, v105
    v_max_f32_dpp v113, v113, v113 row_ror:4 row_mask:0xf bank_mask:0xf
    s_nop 1
    v_max_f32_dpp v113, v113, v113 row_ror:2 row_mask:0xf bank_mask:0xf
    s_nop 1
    v_max_f32_dpp v113, v113, v113 row_ror:1 row_mask:0xf bank_mask:0xf
    v_max_f32 v113, v113, v101
    v_sub_f32 v114, v101, v113
    v_sub_f32 v106, v112, v113
    v_exp_f32 v114, v114
    v_exp_f32 v106, v106
    v_mov_b32 v101, v113
    v_fma_f32 v102, v102, v114, v106
    v_mul_f32 v106, v106, v104
    v_mul_f32 v103, v103, v114
    v_fmac_f32 v103, v106, v105
    v_mul_f32 v88, v88, v114
    v_mul_f32 v89, v89, v114
    v_mul_f32 v90, v90, v114
    v_mul_f32 v91, v91, v114
    v_mul_f32 v92, v92, v114
    v_mul_f32 v93, v93, v114
    v_mul_f32 v94, v94, v114
    v_mul_f32 v95, v95, v114
    v_mul_f32 v96, v96, v114
    v_mul_f32 v97, v97, v114
    v_mul_f32 v98, v98, v114
    v_mul_f32 v99, v99, v114
    v_cvt_f32_i32 v4, v4
    v_cvt_f32_i32 v5, v5
    v_cvt_f32_i32 v6, v6
    v_cvt_f32_i32 v7, v7
    v_cvt_f32_i32 v8, v8
    v_cvt_f32_i32 v9, v9
    v_cvt_f32_i32 v10, v10
    v_cvt_f32_i32 v11, v11
    v_cvt_f32_i32 v12, v12
    v_cvt_f32_i32 v13, v13
    v_cvt_f32_i32 v14, v14
    v_cvt_f32_i32 v15, v15
    v_fmac_f32_dpp v88, v106, v4 row_newbcast:0 row_mask:0xf bank_mask:0xf
    v_fmac_f32_dpp v89, v106, v5 row_newbcast:0 row_mask:0xf bank_mask:0xf
    v_fmac_f32_dpp v90, v106, v6 row_newbcast:0 row_mask:0xf bank_mask:0xf
    v_fmac_f32_dpp v91, v106, v7 row_newbcast:0 row_mask:0xf bank_mask:0xf
    v_fmac_f32_dpp v92, v106, v8 row_newbcast:0 row_mask:0xf bank_mask:0xf
    v_fmac_f32_dpp v93, v106, v9 row_newbcast:0 row_mask:0xf bank_mask:0xf
    v_fmac_f32_dpp v94, v106, v10 row_newbcast:0 row_mask:0xf bank_mask:0xf
    v_fmac_f32_dpp v95, v106, v11 row_newbcast:0 row_mask:0xf bank_mask:0xf
    v_fmac_f32_dpp v96, v106, v12 row_newbcast:0 row_mask:0xf bank_mask:0xf
    v_fmac_f32_dpp v97, v106, v13 row_newbcast:0 row_mask:0xf bank_mask:0xf
    v_fmac_f32_dpp v98, v106, v14 row_newbcast:0 row_mask:0xf bank_mask:0xf
    v_fmac_f32_dpp v99, v106, v15 row_newbcast:0 row_mask:0xf bank_mask:0xf
    buffer_load_dwordx4 v[4:7], v1, s[28:31], s61 offen offset:0 nt
    buffer_load_dwordx4 v[8:11], v1, s[28:31], s61 offen offset:256 nt
    buffer_load_dwordx4 v[12:15], v1, s[28:31], s61 offen offset:512 nt
    s_waitcnt vmcnt(9)
    v_cvt_f32_i32 v16, v16
    v_cvt_f32_i32 v17, v17
    v_cvt_f32_i32 v18, v18
    v_cvt_f32_i32 v19, v19
    v_cvt_f32_i32 v20, v20
    v_cvt_f32_i32 v21, v21
    v_cvt_f32_i32 v22, v22
    v_cvt_f32_i32 v23, v23
    v_cvt_f32_i32 v24, v24
    v_cvt_f32_i32 v25, v25
    v_cvt_f32_i32 v26, v26
    v_cvt_f32_i32 v27, v27
    v_fmac_f32_dpp v88, v106, v16 row_newbcast:8 row_mask:0xf bank_mask:0xf
    v_fmac_f32_dpp v89, v106, v17 row_newbcast:8 row_mask:0xf bank_mask:0xf
    v_fmac_f32_dpp v90, v106, v18 row_newbcast:8 row_mask:0xf bank_mask:0xf
    v_fmac_f32_dpp v91, v106, v19 row_newbcast:8 row_mask:0xf bank_mask:0xf
    v_fmac_f32_dpp v92, v106, v20 row_newbcast:8 row_mask:0xf bank_mask:0xf
    v_fmac_f32_dpp v93, v106, v21 row_newbcast:8 row_mask:0xf bank_mask:0xf
    v_fmac_f32_dpp v94, v106, v22 row_newbcast:8 row_mask:0xf bank_mask:0xf
    v_fmac_f32_dpp v95, v106, v23 row_newbcast:8 row_mask:0xf bank_mask:0xf
    v_fmac_f32_dpp v96, v106, v24 row_newbcast:8 row_mask:0xf bank_mask:0xf
    v_fmac_f32_dpp v97, v106, v25 row_newbcast:8 row_mask:0xf bank_mask:0xf
    v_fmac_f32_dpp v98, v106, v26 row_newbcast:8 row_mask:0xf bank_mask:0xf
    v_fmac_f32_dpp v99, v106, v27 row_newbcast:8 row_mask:0xf bank_mask:0xf
    buffer_load_dwordx4 v[16:19], v1, s[28:31], s61 offen offset:3072 nt
    buffer_load_dwordx4 v[20:23], v1, s[28:31], s61 offen offset:3328 nt
    buffer_load_dwordx4 v[24:27], v1, s[28:31], s61 offen offset:3584 nt
    s_add_u32 s61, s61, 6144
    s_waitcnt vmcnt(9)
    v_cvt_f32_i32 v28, v28
    v_cvt_f32_i32 v29, v29
    v_cvt_f32_i32 v30, v30
    v_cvt_f32_i32 v31, v31
    v_cvt_f32_i32 v32, v32
    v_cvt_f32_i32 v33, v33
    v_cvt_f32_i32 v34, v34
    v_cvt_f32_i32 v35, v35
    v_cvt_f32_i32 v36, v36
    v_cvt_f32_i32 v37, v37
    v_cvt_f32_i32 v38, v38
    v_cvt_f32_i32 v39, v39
    v_fmac_f32_dpp v88, v106, v28 row_newbcast:4 row_mask:0xf bank_mask:0xf
    v_fmac_f32_dpp v89, v106, v29 row_newbcast:4 row_mask:0xf bank_mask:0xf
    v_fmac_f32_dpp v90, v106, v30 row_newbcast:4 row_mask:0xf bank_mask:0xf
    v_fmac_f32_dpp v91, v106, v31 row_newbcast:4 row_mask:0xf bank_mask:0xf
    v_fmac_f32_dpp v92, v106, v32 row_newbcast:4 row_mask:0xf bank_mask:0xf
    v_fmac_f32_dpp v93, v106, v33 row_newbcast:4 row_mask:0xf bank_mask:0xf
    v_fmac_f32_dpp v94, v106, v34 row_newbcast:4 row_mask:0xf bank_mask:0xf
    v_fmac_f32_dpp v95, v106, v35 row_newbcast:4 row_mask:0xf bank_mask:0xf
    v_fmac_f32_dpp v96, v106, v36 row_newbcast:4 row_mask:0xf bank_mask:0xf
    v_fmac_f32_dpp v97, v106, v37 row_newbcast:4 row_mask:0xf bank_mask:0xf
    v_fmac_f32_dpp v98, v106, v38 row_newbcast:4 row_mask:0xf bank_mask:0xf
    v_fmac_f32_dpp v99, v106, v39 row_newbcast:4 row_mask:0xf bank_mask:0xf
    buffer_load_dwordx4 v[28:31], v1, s[28:31], s61 offen offset:0 nt
    buffer_load_dwordx4 v[32:35], v1, s[28:31], s61 offen offset:256 nt
    buffer_load_dwordx4 v[36:39], v1, s[28:31], s61 offen offset:512 nt
    s_waitcnt vmcnt(9)
    v_cvt_f32_i32 v40, v40
    v_cvt_f32_i32 v41, v41
    v_cvt_f32_i32 v42, v42
    v_cvt_f32_i32 v43, v43
    v_cvt_f32_i32 v44, v44
    v_cvt_f32_i32 v45, v45
    v_cvt_f32_i32 v46, v46
    v_cvt_f32_i32 v47, v47
    v_cvt_f32_i32 v48, v48
    v_cvt_f32_i32 v49, v49
    v_cvt_f32_i32 v50, v50
    v_cvt_f32_i32 v51, v51
    v_fmac_f32_dpp v88, v106, v40 row_newbcast:12 row_mask:0xf bank_mask:0xf
    v_fmac_f32_dpp v89, v106, v41 row_newbcast:12 row_mask:0xf bank_mask:0xf
    v_fmac_f32_dpp v90, v106, v42 row_newbcast:12 row_mask:0xf bank_mask:0xf
    v_fmac_f32_dpp v91, v106, v43 row_newbcast:12 row_mask:0xf bank_mask:0xf
    v_fmac_f32_dpp v92, v106, v44 row_newbcast:12 row_mask:0xf bank_mask:0xf
    v_fmac_f32_dpp v93, v106, v45 row_newbcast:12 row_mask:0xf bank_mask:0xf
    v_fmac_f32_dpp v94, v106, v46 row_newbcast:12 row_mask:0xf bank_mask:0xf
    v_fmac_f32_dpp v95, v106, v47 row_newbcast:12 row_mask:0xf bank_mask:0xf
    v_fmac_f32_dpp v96, v106, v48 row_newbcast:12 row_mask:0xf bank_mask:0xf
    v_fmac_f32_dpp v97, v106, v49 row_newbcast:12 row_mask:0xf bank_mask:0xf
    v_fmac_f32_dpp v98, v106, v50 row_newbcast:12 row_mask:0xf bank_mask:0xf
    v_fmac_f32_dpp v99, v106, v51 row_newbcast:12 row_mask:0xf bank_mask:0xf
    buffer_load_dwordx4 v[40:43], v1, s[28:31], s61 offen offset:3072 nt
    buffer_load_dwordx4 v[44:47], v1, s[28:31], s61 offen offset:3328 nt
    buffer_load_dwordx4 v[48:51], v1, s[28:31], s61 offen offset:3584 nt
    s_add_u32 s61, s61, 6144
    s_waitcnt vmcnt(9)
    v_cvt_f32_i32 v4, v4
    v_cvt_f32_i32 v5, v5
    v_cvt_f32_i32 v6, v6
    v_cvt_f32_i32 v7, v7
    v_cvt_f32_i32 v8, v8
    v_cvt_f32_i32 v9, v9
    v_cvt_f32_i32 v10, v10
    v_cvt_f32_i32 v11, v11
    v_cvt_f32_i32 v12, v12
    v_cvt_f32_i32 v13, v13
    v_cvt_f32_i32 v14, v14
    v_cvt_f32_i32 v15, v15
    v_fmac_f32_dpp v88, v106, v4 row_newbcast:2 row_mask:0xf bank_mask:0xf
    v_fmac_f32_dpp v89, v106, v5 row_newbcast:2 row_mask:0xf bank_mask:0xf
    v_fmac_f32_dpp v90, v106, v6 row_newbcast:2 row_mask:0xf bank_mask:0xf
    v_fmac_f32_dpp v91, v106, v7 row_newbcast:2 row_mask:0xf bank_mask:0xf
    v_fmac_f32_dpp v92, v106, v8 row_newbcast:2 row_mask:0xf bank_mask:0xf
    v_fmac_f32_dpp v93, v106, v9 row_newbcast:2 row_mask:0xf bank_mask:0xf
    v_fmac_f32_dpp v94, v106, v10 row_newbcast:2 row_mask:0xf bank_mask:0xf
    v_fmac_f32_dpp v95, v106, v11 row_newbcast:2 row_mask:0xf bank_mask:0xf
    v_fmac_f32_dpp v96, v106, v12 row_newbcast:2 row_mask:0xf bank_mask:0xf
    v_fmac_f32_dpp v97, v106, v13 row_newbcast:2 row_mask:0xf bank_mask:0xf
    v_fmac_f32_dpp v98, v106, v14 row_newbcast:2 row_mask:0xf bank_mask:0xf
    v_fmac_f32_dpp v99, v106, v15 row_newbcast:2 row_mask:0xf bank_mask:0xf
    buffer_load_dwordx4 v[4:7], v1, s[28:31], s61 offen offset:0 nt
    buffer_load_dwordx4 v[8:11], v1, s[28:31], s61 offen offset:256 nt
    buffer_load_dwordx4 v[12:15], v1, s[28:31], s61 offen offset:512 nt
    s_waitcnt vmcnt(9)
    v_cvt_f32_i32 v16, v16
    v_cvt_f32_i32 v17, v17
    v_cvt_f32_i32 v18, v18
    v_cvt_f32_i32 v19, v19
    v_cvt_f32_i32 v20, v20
    v_cvt_f32_i32 v21, v21
    v_cvt_f32_i32 v22, v22
    v_cvt_f32_i32 v23, v23
    v_cvt_f32_i32 v24, v24
    v_cvt_f32_i32 v25, v25
    v_cvt_f32_i32 v26, v26
    v_cvt_f32_i32 v27, v27
    v_fmac_f32_dpp v88, v106, v16 row_newbcast:10 row_mask:0xf bank_mask:0xf
    v_fmac_f32_dpp v89, v106, v17 row_newbcast:10 row_mask:0xf bank_mask:0xf
    v_fmac_f32_dpp v90, v106, v18 row_newbcast:10 row_mask:0xf bank_mask:0xf
    v_fmac_f32_dpp v91, v106, v19 row_newbcast:10 row_mask:0xf bank_mask:0xf
    v_fmac_f32_dpp v92, v106, v20 row_newbcast:10 row_mask:0xf bank_mask:0xf
    v_fmac_f32_dpp v93, v106, v21 row_newbcast:10 row_mask:0xf bank_mask:0xf
    v_fmac_f32_dpp v94, v106, v22 row_newbcast:10 row_mask:0xf bank_mask:0xf
    v_fmac_f32_dpp v95, v106, v23 row_newbcast:10 row_mask:0xf bank_mask:0xf
    v_fmac_f32_dpp v96, v106, v24 row_newbcast:10 row_mask:0xf bank_mask:0xf
    v_fmac_f32_dpp v97, v106, v25 row_newbcast:10 row_mask:0xf bank_mask:0xf
    v_fmac_f32_dpp v98, v106, v26 row_newbcast:10 row_mask:0xf bank_mask:0xf
    v_fmac_f32_dpp v99, v106, v27 row_newbcast:10 row_mask:0xf bank_mask:0xf
    buffer_load_dwordx4 v[16:19], v1, s[28:31], s61 offen offset:3072 nt
    buffer_load_dwordx4 v[20:23], v1, s[28:31], s61 offen offset:3328 nt
    buffer_load_dwordx4 v[24:27], v1, s[28:31], s61 offen offset:3584 nt
    s_add_u32 s61, s61, 6144
    s_waitcnt vmcnt(9)
    v_cvt_f32_i32 v28, v28
    v_cvt_f32_i32 v29, v29
    v_cvt_f32_i32 v30, v30
    v_cvt_f32_i32 v31, v31
    v_cvt_f32_i32 v32, v32
    v_cvt_f32_i32 v33, v33
    v_cvt_f32_i32 v34, v34
    v_cvt_f32_i32 v35, v35
    v_cvt_f32_i32 v36, v36
    v_cvt_f32_i32 v37, v37
    v_cvt_f32_i32 v38, v38
    v_cvt_f32_i32 v39, v39
    v_fmac_f32_dpp v88, v106, v28 row_newbcast:6 row_mask:0xf bank_mask:0xf
    v_fmac_f32_dpp v89, v106, v29 row_newbcast:6 row_mask:0xf bank_mask:0xf
    v_fmac_f32_dpp v90, v106, v30 row_newbcast:6 row_mask:0xf bank_mask:0xf
    v_fmac_f32_dpp v91, v106, v31 row_newbcast:6 row_mask:0xf bank_mask:0xf
    v_fmac_f32_dpp v92, v106, v32 row_newbcast:6 row_mask:0xf bank_mask:0xf
    v_fmac_f32_dpp v93, v106, v33 row_newbcast:6 row_mask:0xf bank_mask:0xf
    v_fmac_f32_dpp v94, v106, v34 row_newbcast:6 row_mask:0xf bank_mask:0xf
    v_fmac_f32_dpp v95, v106, v35 row_newbcast:6 row_mask:0xf bank_mask:0xf
    v_fmac_f32_dpp v96, v106, v36 row_newbcast:6 row_mask:0xf bank_mask:0xf
    v_fmac_f32_dpp v97, v106, v37 row_newbcast:6 row_mask:0xf bank_mask:0xf
    v_fmac_f32_dpp v98, v106, v38 row_newbcast:6 row_mask:0xf bank_mask:0xf
    v_fmac_f32_dpp v99, v106, v39 row_newbcast:6 row_mask:0xf bank_mask:0xf
    buffer_load_dwordx4 v[28:31], v1, s[28:31], s61 offen offset:0 nt
    buffer_load_dwordx4 v[32:35], v1, s[28:31], s61 offen offset:256 nt
    buffer_load_dwordx4 v[36:39], v1, s[28:31], s61 offen offset:512 nt
    s_waitcnt vmcnt(9)
    v_cvt_f32_i32 v40, v40
    v_cvt_f32_i32 v41, v41
    v_cvt_f32_i32 v42, v42
    v_cvt_f32_i32 v43, v43
    v_cvt_f32_i32 v44, v44
    v_cvt_f32_i32 v45, v45
    v_cvt_f32_i32 v46, v46
    v_cvt_f32_i32 v47, v47
    v_cvt_f32_i32 v48, v48
    v_cvt_f32_i32 v49, v49
    v_cvt_f32_i32 v50, v50
    v_cvt_f32_i32 v51, v51
    v_fmac_f32_dpp v88, v106, v40 row_newbcast:14 row_mask:0xf bank_mask:0xf
    v_fmac_f32_dpp v89, v106, v41 row_newbcast:14 row_mask:0xf bank_mask:0xf
    v_fmac_f32_dpp v90, v106, v42 row_newbcast:14 row_mask:0xf bank_mask:0xf
    v_fmac_f32_dpp v91, v106, v43 row_newbcast:14 row_mask:0xf bank_mask:0xf
    v_fmac_f32_dpp v92, v106, v44 row_newbcast:14 row_mask:0xf bank_mask:0xf
    v_fmac_f32_dpp v93, v106, v45 row_newbcast:14 row_mask:0xf bank_mask:0xf
    v_fmac_f32_dpp v94, v106, v46 row_newbcast:14 row_mask:0xf bank_mask:0xf
    v_fmac_f32_dpp v95, v106, v47 row_newbcast:14 row_mask:0xf bank_mask:0xf
    v_fmac_f32_dpp v96, v106, v48 row_newbcast:14 row_mask:0xf bank_mask:0xf
    v_fmac_f32_dpp v97, v106, v49 row_newbcast:14 row_mask:0xf bank_mask:0xf
    v_fmac_f32_dpp v98, v106, v50 row_newbcast:14 row_mask:0xf bank_mask:0xf
    v_fmac_f32_dpp v99, v106, v51 row_newbcast:14 row_mask:0xf bank_mask:0xf
    buffer_load_dwordx4 v[40:43], v1, s[28:31], s61 offen offset:3072 nt
    buffer_load_dwordx4 v[44:47], v1, s[28:31], s61 offen offset:3328 nt
    buffer_load_dwordx4 v[48:51], v1, s[28:31], s61 offen offset:3584 nt
    s_add_u32 s61, s61, 6144
    s_waitcnt vmcnt(9)
    v_cvt_f32_i32 v4, v4
    v_cvt_f32_i32 v5, v5
    v_cvt_f32_i32 v6, v6
    v_cvt_f32_i32 v7, v7
    v_cvt_f32_i32 v8, v8
    v_cvt_f32_i32 v9, v9
    v_cvt_f32_i32 v10, v10
    v_cvt_f32_i32 v11, v11
    v_cvt_f32_i32 v12, v12
    v_cvt_f32_i32 v13, v13
    v_cvt_f32_i32 v14, v14
    v_cvt_f32_i32 v15, v15
    v_fmac_f32_dpp v88, v106, v4 row_newbcast:1 row_mask:0xf bank_mask:0xf
    v_fmac_f32_dpp v89, v106, v5 row_newbcast:1 row_mask:0xf bank_mask:0xf
    v_fmac_f32_dpp v90, v106, v6 row_newbcast:1 row_mask:0xf bank_mask:0xf
    v_fmac_f32_dpp v91, v106, v7 row_newbcast:1 row_mask:0xf bank_mask:0xf
    v_fmac_f32_dpp v92, v106, v8 row_newbcast:1 row_mask:0xf bank_mask:0xf
    v_fmac_f32_dpp v93, v106, v9 row_newbcast:1 row_mask:0xf bank_mask:0xf
    v_fmac_f32_dpp v94, v106, v10 row_newbcast:1 row_mask:0xf bank_mask:0xf
    v_fmac_f32_dpp v95, v106, v11 row_newbcast:1 row_mask:0xf bank_mask:0xf
    v_fmac_f32_dpp v96, v106, v12 row_newbcast:1 row_mask:0xf bank_mask:0xf
    v_fmac_f32_dpp v97, v106, v13 row_newbcast:1 row_mask:0xf bank_mask:0xf
    v_fmac_f32_dpp v98, v106, v14 row_newbcast:1 row_mask:0xf bank_mask:0xf
    v_fmac_f32_dpp v99, v106, v15 row_newbcast:1 row_mask:0xf bank_mask:0xf
    buffer_load_dwordx4 v[4:7], v1, s[28:31], s61 offen offset:0 nt
    buffer_load_dwordx4 v[8:11], v1, s[28:31], s61 offen offset:256 nt
    buffer_load_dwordx4 v[12:15], v1, s[28:31], s61 offen offset:512 nt
    s_waitcnt vmcnt(9)
    v_cvt_f32_i32 v16, v16
    v_cvt_f32_i32 v17, v17
    v_cvt_f32_i32 v18, v18
    v_cvt_f32_i32 v19, v19
    v_cvt_f32_i32 v20, v20
    v_cvt_f32_i32 v21, v21
    v_cvt_f32_i32 v22, v22
    v_cvt_f32_i32 v23, v23
    v_cvt_f32_i32 v24, v24
    v_cvt_f32_i32 v25, v25
    v_cvt_f32_i32 v26, v26
    v_cvt_f32_i32 v27, v27
    v_fmac_f32_dpp v88, v106, v16 row_newbcast:9 row_mask:0xf bank_mask:0xf
    v_fmac_f32_dpp v89, v106, v17 row_newbcast:9 row_mask:0xf bank_mask:0xf
    v_fmac_f32_dpp v90, v106, v18 row_newbcast:9 row_mask:0xf bank_mask:0xf
    v_fmac_f32_dpp v91, v106, v19 row_newbcast:9 row_mask:0xf bank_mask:0xf
    v_fmac_f32_dpp v92, v106, v20 row_newbcast:9 row_mask:0xf bank_mask:0xf
    v_fmac_f32_dpp v93, v106, v21 row_newbcast:9 row_mask:0xf bank_mask:0xf
    v_fmac_f32_dpp v94, v106, v22 row_newbcast:9 row_mask:0xf bank_mask:0xf
    v_fmac_f32_dpp v95, v106, v23 row_newbcast:9 row_mask:0xf bank_mask:0xf
    v_fmac_f32_dpp v96, v106, v24 row_newbcast:9 row_mask:0xf bank_mask:0xf
    v_fmac_f32_dpp v97, v106, v25 row_newbcast:9 row_mask:0xf bank_mask:0xf
    v_fmac_f32_dpp v98, v106, v26 row_newbcast:9 row_mask:0xf bank_mask:0xf
    v_fmac_f32_dpp v99, v106, v27 row_newbcast:9 row_mask:0xf bank_mask:0xf
    buffer_load_dwordx4 v[16:19], v1, s[28:31], s61 offen offset:3072 nt
    buffer_load_dwordx4 v[20:23], v1, s[28:31], s61 offen offset:3328 nt
    buffer_load_dwordx4 v[24:27], v1, s[28:31], s61 offen offset:3584 nt
    s_add_u32 s61, s61, 6144
    s_waitcnt vmcnt(9)
    v_cvt_f32_i32 v28, v28
    v_cvt_f32_i32 v29, v29
    v_cvt_f32_i32 v30, v30
    v_cvt_f32_i32 v31, v31
    v_cvt_f32_i32 v32, v32
    v_cvt_f32_i32 v33, v33
    v_cvt_f32_i32 v34, v34
    v_cvt_f32_i32 v35, v35
    v_cvt_f32_i32 v36, v36
    v_cvt_f32_i32 v37, v37
    v_cvt_f32_i32 v38, v38
    v_cvt_f32_i32 v39, v39
    v_fmac_f32_dpp v88, v106, v28 row_newbcast:5 row_mask:0xf bank_mask:0xf
    v_fmac_f32_dpp v89, v106, v29 row_newbcast:5 row_mask:0xf bank_mask:0xf
    v_fmac_f32_dpp v90, v106, v30 row_newbcast:5 row_mask:0xf bank_mask:0xf
    v_fmac_f32_dpp v91, v106, v31 row_newbcast:5 row_mask:0xf bank_mask:0xf
    v_fmac_f32_dpp v92, v106, v32 row_newbcast:5 row_mask:0xf bank_mask:0xf
    v_fmac_f32_dpp v93, v106, v33 row_newbcast:5 row_mask:0xf bank_mask:0xf
    v_fmac_f32_dpp v94, v106, v34 row_newbcast:5 row_mask:0xf bank_mask:0xf
    v_fmac_f32_dpp v95, v106, v35 row_newbcast:5 row_mask:0xf bank_mask:0xf
    v_fmac_f32_dpp v96, v106, v36 row_newbcast:5 row_mask:0xf bank_mask:0xf
    v_fmac_f32_dpp v97, v106, v37 row_newbcast:5 row_mask:0xf bank_mask:0xf
    v_fmac_f32_dpp v98, v106, v38 row_newbcast:5 row_mask:0xf bank_mask:0xf
    v_fmac_f32_dpp v99, v106, v39 row_newbcast:5 row_mask:0xf bank_mask:0xf
    buffer_load_dwordx4 v[28:31], v1, s[28:31], s61 offen offset:0 nt
    buffer_load_dwordx4 v[32:35], v1, s[28:31], s61 offen offset:256 nt
    buffer_load_dwordx4 v[36:39], v1, s[28:31], s61 offen offset:512 nt
    s_waitcnt vmcnt(9)
    v_cvt_f32_i32 v40, v40
    v_cvt_f32_i32 v41, v41
    v_cvt_f32_i32 v42, v42
    v_cvt_f32_i32 v43, v43
    v_cvt_f32_i32 v44, v44
    v_cvt_f32_i32 v45, v45
    v_cvt_f32_i32 v46, v46
    v_cvt_f32_i32 v47, v47
    v_cvt_f32_i32 v48, v48
    v_cvt_f32_i32 v49, v49
    v_cvt_f32_i32 v50, v50
    v_cvt_f32_i32 v51, v51
    v_fmac_f32_dpp v88, v106, v40 row_newbcast:13 row_mask:0xf bank_mask:0xf
    v_fmac_f32_dpp v89, v106, v41 row_newbcast:13 row_mask:0xf bank_mask:0xf
    v_fmac_f32_dpp v90, v106, v42 row_newbcast:13 row_mask:0xf bank_mask:0xf
    v_fmac_f32_dpp v91, v106, v43 row_newbcast:13 row_mask:0xf bank_mask:0xf
    v_fmac_f32_dpp v92, v106, v44 row_newbcast:13 row_mask:0xf bank_mask:0xf
    v_fmac_f32_dpp v93, v106, v45 row_newbcast:13 row_mask:0xf bank_mask:0xf
    v_fmac_f32_dpp v94, v106, v46 row_newbcast:13 row_mask:0xf bank_mask:0xf
    v_fmac_f32_dpp v95, v106, v47 row_newbcast:13 row_mask:0xf bank_mask:0xf
    v_fmac_f32_dpp v96, v106, v48 row_newbcast:13 row_mask:0xf bank_mask:0xf
    v_fmac_f32_dpp v97, v106, v49 row_newbcast:13 row_mask:0xf bank_mask:0xf
    v_fmac_f32_dpp v98, v106, v50 row_newbcast:13 row_mask:0xf bank_mask:0xf
    v_fmac_f32_dpp v99, v106, v51 row_newbcast:13 row_mask:0xf bank_mask:0xf
    buffer_load_dwordx4 v[40:43], v1, s[28:31], s61 offen offset:3072 nt
    buffer_load_dwordx4 v[44:47], v1, s[28:31], s61 offen offset:3328 nt
    buffer_load_dwordx4 v[48:51], v1, s[28:31], s61 offen offset:3584 nt
    s_add_u32 s61, s61, 6144
    s_waitcnt vmcnt(9)
    v_cvt_f32_i32 v4, v4
    v_cvt_f32_i32 v5, v5
    v_cvt_f32_i32 v6, v6
    v_cvt_f32_i32 v7, v7
    v_cvt_f32_i32 v8, v8
    v_cvt_f32_i32 v9, v9
    v_cvt_f32_i32 v10, v10
    v_cvt_f32_i32 v11, v11
    v_cvt_f32_i32 v12, v12
    v_cvt_f32_i32 v13, v13
    v_cvt_f32_i32 v14, v14
    v_cvt_f32_i32 v15, v15
    v_fmac_f32_dpp v88, v106, v4 row_newbcast:3 row_mask:0xf bank_mask:0xf
    v_fmac_f32_dpp v89, v106, v5 row_newbcast:3 row_mask:0xf bank_mask:0xf
    v_fmac_f32_dpp v90, v106, v6 row_newbcast:3 row_mask:0xf bank_mask:0xf
    v_fmac_f32_dpp v91, v106, v7 row_newbcast:3 row_mask:0xf bank_mask:0xf
    v_fmac_f32_dpp v92, v106, v8 row_newbcast:3 row_mask:0xf bank_mask:0xf
    v_fmac_f32_dpp v93, v106, v9 row_newbcast:3 row_mask:0xf bank_mask:0xf
    v_fmac_f32_dpp v94, v106, v10 row_newbcast:3 row_mask:0xf bank_mask:0xf
    v_fmac_f32_dpp v95, v106, v11 row_newbcast:3 row_mask:0xf bank_mask:0xf
    v_fmac_f32_dpp v96, v106, v12 row_newbcast:3 row_mask:0xf bank_mask:0xf
    v_fmac_f32_dpp v97, v106, v13 row_newbcast:3 row_mask:0xf bank_mask:0xf
    v_fmac_f32_dpp v98, v106, v14 row_newbcast:3 row_mask:0xf bank_mask:0xf
    v_fmac_f32_dpp v99, v106, v15 row_newbcast:3 row_mask:0xf bank_mask:0xf
    s_waitcnt vmcnt(6)
    v_cvt_f32_i32 v16, v16
    v_cvt_f32_i32 v17, v17
    v_cvt_f32_i32 v18, v18
    v_cvt_f32_i32 v19, v19
    v_cvt_f32_i32 v20, v20
    v_cvt_f32_i32 v21, v21
    v_cvt_f32_i32 v22, v22
    v_cvt_f32_i32 v23, v23
    v_cvt_f32_i32 v24, v24
    v_cvt_f32_i32 v25, v25
    v_cvt_f32_i32 v26, v26
    v_cvt_f32_i32 v27, v27
    v_fmac_f32_dpp v88, v106, v16 row_newbcast:11 row_mask:0xf bank_mask:0xf
    v_fmac_f32_dpp v89, v106, v17 row_newbcast:11 row_mask:0xf bank_mask:0xf
    v_fmac_f32_dpp v90, v106, v18 row_newbcast:11 row_mask:0xf bank_mask:0xf
    v_fmac_f32_dpp v91, v106, v19 row_newbcast:11 row_mask:0xf bank_mask:0xf
    v_fmac_f32_dpp v92, v106, v20 row_newbcast:11 row_mask:0xf bank_mask:0xf
    v_fmac_f32_dpp v93, v106, v21 row_newbcast:11 row_mask:0xf bank_mask:0xf
    v_fmac_f32_dpp v94, v106, v22 row_newbcast:11 row_mask:0xf bank_mask:0xf
    v_fmac_f32_dpp v95, v106, v23 row_newbcast:11 row_mask:0xf bank_mask:0xf
    v_fmac_f32_dpp v96, v106, v24 row_newbcast:11 row_mask:0xf bank_mask:0xf
    v_fmac_f32_dpp v97, v106, v25 row_newbcast:11 row_mask:0xf bank_mask:0xf
    v_fmac_f32_dpp v98, v106, v26 row_newbcast:11 row_mask:0xf bank_mask:0xf
    v_fmac_f32_dpp v99, v106, v27 row_newbcast:11 row_mask:0xf bank_mask:0xf
    s_waitcnt vmcnt(3)
    v_cvt_f32_i32 v28, v28
    v_cvt_f32_i32 v29, v29
    v_cvt_f32_i32 v30, v30
    v_cvt_f32_i32 v31, v31
    v_cvt_f32_i32 v32, v32
    v_cvt_f32_i32 v33, v33
    v_cvt_f32_i32 v34, v34
    v_cvt_f32_i32 v35, v35
    v_cvt_f32_i32 v36, v36
    v_cvt_f32_i32 v37, v37
    v_cvt_f32_i32 v38, v38
    v_cvt_f32_i32 v39, v39
    v_fmac_f32_dpp v88, v106, v28 row_newbcast:7 row_mask:0xf bank_mask:0xf
    v_fmac_f32_dpp v89, v106, v29 row_newbcast:7 row_mask:0xf bank_mask:0xf
    v_fmac_f32_dpp v90, v106, v30 row_newbcast:7 row_mask:0xf bank_mask:0xf
    v_fmac_f32_dpp v91, v106, v31 row_newbcast:7 row_mask:0xf bank_mask:0xf
    v_fmac_f32_dpp v92, v106, v32 row_newbcast:7 row_mask:0xf bank_mask:0xf
    v_fmac_f32_dpp v93, v106, v33 row_newbcast:7 row_mask:0xf bank_mask:0xf
    v_fmac_f32_dpp v94, v106, v34 row_newbcast:7 row_mask:0xf bank_mask:0xf
    v_fmac_f32_dpp v95, v106, v35 row_newbcast:7 row_mask:0xf bank_mask:0xf
    v_fmac_f32_dpp v96, v106, v36 row_newbcast:7 row_mask:0xf bank_mask:0xf
    v_fmac_f32_dpp v97, v106, v37 row_newbcast:7 row_mask:0xf bank_mask:0xf
    v_fmac_f32_dpp v98, v106, v38 row_newbcast:7 row_mask:0xf bank_mask:0xf
    v_fmac_f32_dpp v99, v106, v39 row_newbcast:7 row_mask:0xf bank_mask:0xf
    s_waitcnt vmcnt(0)
    v_cvt_f32_i32 v40, v40
    v_cvt_f32_i32 v41, v41
    v_cvt_f32_i32 v42, v42
    v_cvt_f32_i32 v43, v43
    v_cvt_f32_i32 v44, v44
    v_cvt_f32_i32 v45, v45
    v_cvt_f32_i32 v46, v46
    v_cvt_f32_i32 v47, v47
    v_cvt_f32_i32 v48, v48
    v_cvt_f32_i32 v49, v49
    v_cvt_f32_i32 v50, v50
    v_cvt_f32_i32 v51, v51
    v_fmac_f32_dpp v88, v106, v40 row_newbcast:15 row_mask:0xf bank_mask:0xf
    v_fmac_f32_dpp v89, v106, v41 row_newbcast:15 row_mask:0xf bank_mask:0xf
    v_fmac_f32_dpp v90, v106, v42 row_newbcast:15 row_mask:0xf bank_mask:0xf
    v_fmac_f32_dpp v91, v106, v43 row_newbcast:15 row_mask:0xf bank_mask:0xf
    v_fmac_f32_dpp v92, v106, v44 row_newbcast:15 row_mask:0xf bank_mask:0xf
    v_fmac_f32_dpp v93, v106, v45 row_newbcast:15 row_mask:0xf bank_mask:0xf
    v_fmac_f32_dpp v94, v106, v46 row_newbcast:15 row_mask:0xf bank_mask:0xf
    v_fmac_f32_dpp v95, v106, v47 row_newbcast:15 row_mask:0xf bank_mask:0xf
    v_fmac_f32_dpp v96, v106, v48 row_newbcast:15 row_mask:0xf bank_mask:0xf
    v_fmac_f32_dpp v97, v106, v49 row_newbcast:15 row_mask:0xf bank_mask:0xf
    v_fmac_f32_dpp v98, v106, v50 row_newbcast:15 row_mask:0xf bank_mask:0xf
    v_fmac_f32_dpp v99, v106, v51 row_newbcast:15 row_mask:0xf bank_mask:0xf
    s_nop 0
    v_add_f32_dpp v102, v102, v102 row_ror:8 row_mask:0xf bank_mask:0xf
    v_add_f32_dpp v103, v103, v103 row_ror:8 row_mask:0xf bank_mask:0xf
    s_nop 0
    v_add_f32_dpp v102, v102, v102 row_ror:4 row_mask:0xf bank_mask:0xf
    v_add_f32_dpp v103, v103, v103 row_ror:4 row_mask:0xf bank_mask:0xf
    s_nop 0
    v_add_f32_dpp v102, v102, v102 row_ror:2 row_mask:0xf bank_mask:0xf
    v_add_f32_dpp v103, v103, v103 row_ror:2 row_mask:0xf bank_mask:0xf
    s_nop 0
    v_add_f32_dpp v102, v102, v102 row_ror:1 row_mask:0xf bank_mask:0xf
    v_add_f32_dpp v103, v103, v103 row_ror:1 row_mask:0xf bank_mask:0xf
    v_mov_b32 v113, v101
    v_mov_b32 v114, v101
    s_nop 1
    v_permlane32_swap_b32 v113, v114
    s_nop 1
    v_max_f32 v113, v113, v114
    v_mov_b32 v114, v113
    s_nop 1
    v_permlane16_swap_b32 v113, v114
    s_nop 1
    v_max_f32 v113, v113, v114
    v_sub_f32 v114, v101, v113
    v_exp_f32 v114, v114
    v_mov_b32 v101, v113
    v_mul_f32 v102, v102, v114
    v_mul_f32 v103, v103, v114
    v_fma_f32 v88, v88, v114, -v103
    v_fma_f32 v89, v89, v114, -v103
    v_fma_f32 v90, v90, v114, -v103
    v_fma_f32 v91, v91, v114, -v103
    v_fma_f32 v92, v92, v114, -v103
    v_fma_f32 v93, v93, v114, -v103
    v_fma_f32 v94, v94, v114, -v103
    v_fma_f32 v95, v95, v114, -v103
    v_fma_f32 v96, v96, v114, -v103
    v_fma_f32 v97, v97, v114, -v103
    v_fma_f32 v98, v98, v114, -v103
    v_fma_f32 v99, v99, v114, -v103
    v_mov_b32 v113, v102
    s_nop 1
    v_permlane32_swap_b32 v102, v113
    v_permlane32_swap_b32 v88, v90
    v_permlane32_swap_b32 v89, v91
    v_permlane32_swap_b32 v92, v94
    v_permlane32_swap_b32 v93, v95
    v_permlane32_swap_b32 v96, v98
    v_permlane32_swap_b32 v97, v99
    s_nop 1
    v_add_f32 v102, v102, v113
    v_add_f32 v88, v88, v90
    v_add_f32 v89, v89, v91
    v_add_f32 v92, v92, v94
    v_add_f32 v93, v93, v95
    v_add_f32 v96, v96, v98
    v_add_f32 v97, v97, v99
    v_mov_b32 v113, v102
    s_nop 1
    v_permlane16_swap_b32 v102, v113
    v_permlane16_swap_b32 v88, v89
    v_permlane16_swap_b32 v92, v93
    v_permlane16_swap_b32 v96, v97
    s_nop 1
    v_add_f32 v102, v102, v113
    v_add_f32 v88, v88, v89
    v_add_f32 v92, v92, v93
    v_add_f32 v96, v96, v97
    v_and_b32 v114, 15, v0
    v_lshrrev_b32 v113, 4, v0
    v_lshlrev_b32 v113, 2, v113
    v_lshl_add_u32 v113, v114, 4, v113
    s_lshl_b32 s80, s58, 10
    v_add_u32 v114, s80, v113
    v_mov_b32 v108, s80
    v_mov_b32 v109, v102
    ds_write_b32 v114, v88 offset:0
    ds_write_b32 v114, v92 offset:256
    ds_write_b32 v114, v96 offset:512
    ds_write_b32 v108, v101 offset:768
    ds_write_b32 v108, v102 offset:772
    s_waitcnt lgkmcnt(0)
    s_barrier
    s_cmp_lg_u32 s58, 0
    s_cbranch_scc1 L_end
    v_lshlrev_b32 v113, 2, v0
    v_mov_b32 v114, 0
    ds_read_b64 v[4:5], v114 offset:768
    ds_read_b64 v[6:7], v114 offset:1792
    ds_read_b64 v[8:9], v114 offset:2816
    ds_read_b64 v[10:11], v114 offset:3840
    ds_read_b64 v[12:13], v114 offset:4864
    ds_read_b64 v[14:15], v114 offset:5888
    ds_read_b64 v[16:17], v114 offset:6912
    ds_read_b64 v[18:19], v114 offset:7936
    ds_read_b64 v[20:21], v114 offset:8960
    ds_read_b64 v[22:23], v114 offset:9984
    ds_read_b64 v[24:25], v114 offset:11008
    ds_read_b64 v[26:27], v114 offset:12032
    ds_read_b64 v[28:29], v114 offset:13056
    ds_read_b64 v[30:31], v114 offset:14080
    ds_read_b64 v[32:33], v114 offset:15104
    ds_read_b64 v[34:35], v114 offset:16128
    ds_read_b32 v36, v113 offset:0
    ds_read_b32 v37, v113 offset:256
    ds_read_b32 v38, v113 offset:512
    ds_read_b32 v39, v113 offset:1024
    ds_read_b32 v40, v113 offset:1280
    ds_read_b32 v41, v113 offset:1536
    ds_read_b32 v42, v113 offset:2048
    ds_read_b32 v43, v113 offset:2304
    ds_read_b32 v44, v113 offset:2560
    ds_read_b32 v45, v113 offset:3072
    ds_read_b32 v46, v113 offset:3328
    ds_read_b32 v47, v113 offset:3584
    ds_read_b32 v48, v113 offset:4096
    ds_read_b32 v49, v113 offset:4352
    ds_read_b32 v50, v113 offset:4608
    ds_read_b32 v51, v113 offset:5120
    ds_read_b32 v52, v113 offset:5376
    ds_read_b32 v53, v113 offset:5632
    ds_read_b32 v54, v113 offset:6144
    ds_read_b32 v55, v113 offset:6400
    ds_read_b32 v56, v113 offset:6656
    ds_read_b32 v57, v113 offset:7168
    ds_read_b32 v58, v113 offset:7424
    ds_read_b32 v59, v113 offset:7680
    ds_read_b32 v60, v113 offset:8192
    ds_read_b32 v61, v113 offset:8448
    ds_read_b32 v62, v113 offset:8704
    ds_read_b32 v63, v113 offset:9216
    ds_read_b32 v64, v113 offset:9472
    ds_read_b32 v65, v113 offset:9728
    ds_read_b32 v66, v113 offset:10240
    ds_read_b32 v67, v113 offset:10496
    ds_read_b32 v68, v113 offset:10752
    ds_read_b32 v69, v113 offset:11264
    ds_read_b32 v70, v113 offset:11520
    ds_read_b32 v71, v113 offset:11776
    ds_read_b32 v72, v113 offset:12288
    ds_read_b32 v73, v113 offset:12544
    ds_read_b32 v74, v113 offset:12800
    ds_read_b32 v75, v113 offset:13312
    ds_read_b32 v76, v113 offset:13568
    ds_read_b32 v77, v113 offset:13824
    ds_read_b32 v78, v113 offset:14336
    ds_read_b32 v79, v113 offset:14592
    ds_read_b32 v80, v113 offset:14848
    ds_read_b32 v81, v113 offset:15360
    ds_read_b32 v82, v113 offset:15616
    ds_read_b32 v83, v113 offset:15872
    s_waitcnt lgkmcnt(0)
    v_mov_b32 v101, v4
    v_max_f32 v101, v101, v6
    v_max_f32 v101, v101, v8
    v_max_f32 v101, v101, v10
    v_max_f32 v101, v101, v12
    v_max_f32 v101, v101, v14
    v_max_f32 v101, v101, v16
    v_max_f32 v101, v101, v18
    v_max_f32 v101, v101, v20
    v_max_f32 v101, v101, v22
    v_max_f32 v101, v101, v24
    v_max_f32 v101, v101, v26
    v_max_f32 v101, v101, v28
    v_max_f32 v101, v101, v30
    v_max_f32 v101, v101, v32
    v_max_f32 v101, v101, v34
    v_sub_f32 v4, v4, v101
    v_sub_f32 v6, v6, v101
    v_sub_f32 v8, v8, v101
    v_sub_f32 v10, v10, v101
    v_sub_f32 v12, v12, v101
    v_sub_f32 v14, v14, v101
    v_sub_f32 v16, v16, v101
    v_sub_f32 v18, v18, v101
    v_sub_f32 v20, v20, v101
    v_sub_f32 v22, v22, v101
    v_sub_f32 v24, v24, v101
    v_sub_f32 v26, v26, v101
    v_sub_f32 v28, v28, v101
    v_sub_f32 v30, v30, v101
    v_sub_f32 v32, v32, v101
    v_sub_f32 v34, v34, v101
    v_exp_f32 v4, v4
    v_exp_f32 v6, v6
    v_exp_f32 v8, v8
    v_exp_f32 v10, v10
    v_exp_f32 v12, v12
    v_exp_f32 v14, v14
    v_exp_f32 v16, v16
    v_exp_f32 v18, v18
    v_exp_f32 v20, v20
    v_exp_f32 v22, v22
    v_exp_f32 v24, v24
    v_exp_f32 v26, v26
    v_exp_f32 v28, v28
    v_exp_f32 v30, v30
    v_exp_f32 v32, v32
    v_exp_f32 v34, v34
    s_nop 0
    v_mul_f32 v102, v4, v5
    v_mul_f32 v88, v4, v36
    v_mul_f32 v89, v4, v37
    v_mul_f32 v90, v4, v38
    v_fmac_f32 v102, v6, v7
    v_fmac_f32 v88, v6, v39
    v_fmac_f32 v89, v6, v40
    v_fmac_f32 v90, v6, v41
    v_fmac_f32 v102, v8, v9
    v_fmac_f32 v88, v8, v42
    v_fmac_f32 v89, v8, v43
    v_fmac_f32 v90, v8, v44
    v_fmac_f32 v102, v10, v11
    v_fmac_f32 v88, v10, v45
    v_fmac_f32 v89, v10, v46
    v_fmac_f32 v90, v10, v47
    v_fmac_f32 v102, v12, v13
    v_fmac_f32 v88, v12, v48
    v_fmac_f32 v89, v12, v49
    v_fmac_f32 v90, v12, v50
    v_fmac_f32 v102, v14, v15
    v_fmac_f32 v88, v14, v51
    v_fmac_f32 v89, v14, v52
    v_fmac_f32 v90, v14, v53
    v_fmac_f32 v102, v16, v17
    v_fmac_f32 v88, v16, v54
    v_fmac_f32 v89, v16, v55
    v_fmac_f32 v90, v16, v56
    v_fmac_f32 v102, v18, v19
    v_fmac_f32 v88, v18, v57
    v_fmac_f32 v89, v18, v58
    v_fmac_f32 v90, v18, v59
    v_fmac_f32 v102, v20, v21
    v_fmac_f32 v88, v20, v60
    v_fmac_f32 v89, v20, v61
    v_fmac_f32 v90, v20, v62
    v_fmac_f32 v102, v22, v23
    v_fmac_f32 v88, v22, v63
    v_fmac_f32 v89, v22, v64
    v_fmac_f32 v90, v22, v65
    v_fmac_f32 v102, v24, v25
    v_fmac_f32 v88, v24, v66
    v_fmac_f32 v89, v24, v67
    v_fmac_f32 v90, v24, v68
    v_fmac_f32 v102, v26, v27
    v_fmac_f32 v88, v26, v69
    v_fmac_f32 v89, v26, v70
    v_fmac_f32 v90, v26, v71
    v_fmac_f32 v102, v28, v29
    v_fmac_f32 v88, v28, v72
    v_fmac_f32 v89, v28, v73
    v_fmac_f32 v90, v28, v74
    v_fmac_f32 v102, v30, v31
    v_fmac_f32 v88, v30, v75
    v_fmac_f32 v89, v30, v76
    v_fmac_f32 v90, v30, v77
    v_fmac_f32 v102, v32, v33
    v_fmac_f32 v88, v32, v78
    v_fmac_f32 v89, v32, v79
    v_fmac_f32 v90, v32, v80
    v_fmac_f32 v102, v34, v35
    v_fmac_f32 v88, v34, v81
    v_fmac_f32 v89, v34, v82
    v_fmac_f32 v90, v34, v83
    s_lshl_b32 s80, s2, 10
    buffer_store_dword v88, v113, s[52:55], s80 offen offset:0 sc0 sc1
    buffer_store_dword v89, v113, s[52:55], s80 offen offset:256 sc0 sc1
    buffer_store_dword v90, v113, s[52:55], s80 offen offset:512 sc0 sc1
    v_mov_b32 v92, v101
    v_mov_b32 v93, v102
    v_cmp_eq_u32 vcc, 0, v0
    s_and_saveexec_b64 s[82:83], vcc
    buffer_store_dwordx2 v[92:93], v114, s[52:55], s80 offen offset:768 sc0 sc1
    s_waitcnt vmcnt(0)
    v_mov_b32 v108, 1
    s_lshl_b32 s81, s56, 2
    buffer_atomic_add v108, v114, s[76:79], s81 offen sc0 sc1
    s_waitcnt vmcnt(0)
    v_readfirstlane_b32 s81, v108
    s_mov_b64 exec, s[82:83]
    s_cmp_lg_u32 s81, 7
    s_cbranch_scc1 L_end
    s_lshl_b32 s80, s56, 13
    buffer_load_dwordx2 v[4:5], v114, s[52:55], s80 offen offset:768 sc0 sc1
    buffer_load_dword v20, v113, s[52:55], s80 offen offset:0 sc0 sc1
    buffer_load_dword v21, v113, s[52:55], s80 offen offset:256 sc0 sc1
    buffer_load_dword v22, v113, s[52:55], s80 offen offset:512 sc0 sc1
    buffer_load_dwordx2 v[6:7], v114, s[52:55], s80 offen offset:1792 sc0 sc1
    buffer_load_dword v23, v113, s[52:55], s80 offen offset:1024 sc0 sc1
    buffer_load_dword v24, v113, s[52:55], s80 offen offset:1280 sc0 sc1
    buffer_load_dword v25, v113, s[52:55], s80 offen offset:1536 sc0 sc1
    buffer_load_dwordx2 v[8:9], v114, s[52:55], s80 offen offset:2816 sc0 sc1
    buffer_load_dword v26, v113, s[52:55], s80 offen offset:2048 sc0 sc1
    buffer_load_dword v27, v113, s[52:55], s80 offen offset:2304 sc0 sc1
    buffer_load_dword v28, v113, s[52:55], s80 offen offset:2560 sc0 sc1
    buffer_load_dwordx2 v[10:11], v114, s[52:55], s80 offen offset:3840 sc0 sc1
    buffer_load_dword v29, v113, s[52:55], s80 offen offset:3072 sc0 sc1
    buffer_load_dword v30, v113, s[52:55], s80 offen offset:3328 sc0 sc1
    buffer_load_dword v31, v113, s[52:55], s80 offen offset:3584 sc0 sc1
    s_add_u32 s80, s80, 4096
    buffer_load_dwordx2 v[12:13], v114, s[52:55], s80 offen offset:768 sc0 sc1
    buffer_load_dword v32, v113, s[52:55], s80 offen offset:0 sc0 sc1
    buffer_load_dword v33, v113, s[52:55], s80 offen offset:256 sc0 sc1
    buffer_load_dword v34, v113, s[52:55], s80 offen offset:512 sc0 sc1
    buffer_load_dwordx2 v[14:15], v114, s[52:55], s80 offen offset:1792 sc0 sc1
    buffer_load_dword v35, v113, s[52:55], s80 offen offset:1024 sc0 sc1
    buffer_load_dword v36, v113, s[52:55], s80 offen offset:1280 sc0 sc1
    buffer_load_dword v37, v113, s[52:55], s80 offen offset:1536 sc0 sc1
    buffer_load_dwordx2 v[16:17], v114, s[52:55], s80 offen offset:2816 sc0 sc1
    buffer_load_dword v38, v113, s[52:55], s80 offen offset:2048 sc0 sc1
    buffer_load_dword v39, v113, s[52:55], s80 offen offset:2304 sc0 sc1
    buffer_load_dword v40, v113, s[52:55], s80 offen offset:2560 sc0 sc1
    buffer_load_dwordx2 v[18:19], v114, s[52:55], s80 offen offset:3840 sc0 sc1
    buffer_load_dword v41, v113, s[52:55], s80 offen offset:3072 sc0 sc1
    buffer_load_dword v42, v113, s[52:55], s80 offen offset:3328 sc0 sc1
    buffer_load_dword v43, v113, s[52:55], s80 offen offset:3584 sc0 sc1
    s_waitcnt vmcnt(0)
    v_mov_b32 v101, v4
    v_max_f32 v101, v101, v6
    v_max_f32 v101, v101, v8
    v_max_f32 v101, v101, v10
    v_max_f32 v101, v101, v12
    v_max_f32 v101, v101, v14
    v_max_f32 v101, v101, v16
    v_max_f32 v101, v101, v18
    v_sub_f32 v4, v4, v101
    v_sub_f32 v6, v6, v101
    v_sub_f32 v8, v8, v101
    v_sub_f32 v10, v10, v101
    v_sub_f32 v12, v12, v101
    v_sub_f32 v14, v14, v101
    v_sub_f32 v16, v16, v101
    v_sub_f32 v18, v18, v101
    v_exp_f32 v4, v4
    v_exp_f32 v6, v6
    v_exp_f32 v8, v8
    v_exp_f32 v10, v10
    v_exp_f32 v12, v12
    v_exp_f32 v14, v14
    v_exp_f32 v16, v16
    v_exp_f32 v18, v18
    s_nop 0
    v_mul_f32 v102, v4, v5
    v_mul_f32 v88, v4, v20
    v_mul_f32 v89, v4, v21
    v_mul_f32 v90, v4, v22
    v_fmac_f32 v102, v6, v7
    v_fmac_f32 v88, v6, v23
    v_fmac_f32 v89, v6, v24
    v_fmac_f32 v90, v6, v25
    v_fmac_f32 v102, v8, v9
    v_fmac_f32 v88, v8, v26
    v_fmac_f32 v89, v8, v27
    v_fmac_f32 v90, v8, v28
    v_fmac_f32 v102, v10, v11
    v_fmac_f32 v88, v10, v29
    v_fmac_f32 v89, v10, v30
    v_fmac_f32 v90, v10, v31
    v_fmac_f32 v102, v12, v13
    v_fmac_f32 v88, v12, v32
    v_fmac_f32 v89, v12, v33
    v_fmac_f32 v90, v12, v34
    v_fmac_f32 v102, v14, v15
    v_fmac_f32 v88, v14, v35
    v_fmac_f32 v89, v14, v36
    v_fmac_f32 v90, v14, v37
    v_fmac_f32 v102, v16, v17
    v_fmac_f32 v88, v16, v38
    v_fmac_f32 v89, v16, v39
    v_fmac_f32 v90, v16, v40
    v_fmac_f32 v102, v18, v19
    v_fmac_f32 v88, v18, v41
    v_fmac_f32 v89, v18, v42
    v_fmac_f32 v90, v18, v43
    v_rcp_f32 v102, v102
    s_mul_i32 s80, s56, 384
    v_lshrrev_b32 v113, 1, v113
    v_mul_f32 v88, v88, v102
    v_mul_f32 v89, v89, v102
    v_mul_f32 v90, v90, v102
    v_cvt_pk_bf16_f32 v88, v88, v88
    v_cvt_pk_bf16_f32 v89, v89, v89
    v_cvt_pk_bf16_f32 v90, v90, v90
    buffer_store_short v88, v113, s[72:75], s80 offen offset:0
    buffer_store_short v89, v113, s[72:75], s80 offen offset:128
    buffer_store_short v90, v113, s[72:75], s80 offen offset:256
L_end:
    s_endpgm
.section .rodata,"a"
.p2align 6
.amdhsa_kernel standalone__kv_cache_quant_int4_int2_kv_with_per_channel_or_per_token_scales__decode_kernel
  .amdhsa_next_free_vgpr 115
  .amdhsa_next_free_sgpr 88
  .amdhsa_accum_offset 116
  .amdhsa_group_segment_fixed_size 0
  .amdhsa_kernarg_size 80
  .amdhsa_user_sgpr_count 2
  .amdhsa_user_sgpr_kernarg_segment_ptr 1
  .amdhsa_system_sgpr_workgroup_id_x 1
.end_amdhsa_kernel
```

```asm
; @launch grid=(256,1,1) block=(320,1,1) lds=98304
.amdgcn_target "amdgcn-amd-amdhsa--gfx950"
.text
.globl standalone__kv_cache_quant_int4_int2_kv_with_per_channel_or_per_token_scales__decode_kernel
.p2align 8
.type standalone__kv_cache_quant_int4_int2_kv_with_per_channel_or_per_token_scales__decode_kernel,@function
standalone__kv_cache_quant_int4_int2_kv_with_per_channel_or_per_token_scales__decode_kernel:
    s_cmp_ge_u32 s2, 256
    s_cbranch_scc1 L_end
    s_load_dwordx16 s[4:19], s[0:1], 0
    s_load_dwordx4 s[20:23], s[0:1], 64
    v_lshrrev_b32 v97, 6, v0
    v_and_b32 v0, 63, v0
    v_readfirstlane_b32 s68, v97
    s_lshr_b32 s79, s2, 6
    s_and_b32 s92, s2, 63
    s_cmp_eq_u32 s68, 4
    s_cbranch_scc1 L_service
    s_setprio 1
    v_and_b32 v103, 15, v0
    v_lshrrev_b32 v102, 4, v0
    v_mul_u32_u24 v1, 768, v102
    v_lshl_add_u32 v1, v103, 4, v1
    v_mul_u32_u24 v98, 12288, v97
    v_add_u32 v1, v1, v98
    v_lshlrev_b32 v2, 3, v103
    v_bfrev_b32 v99, v103
    v_lshrrev_b32 v99, 28, v99
    v_and_b32 v99, 15, v99
    v_lshrrev_b32 v100, 2, v99
    v_and_b32 v99, 3, v99
    v_mul_u32_u24 v3, 4096, v100
    v_mul_u32_u24 v99, 4, v99
    v_add_u32 v3, v3, v99
    v_mul_u32_u24 v99, 16, v97
    v_add3_u32 v3, v3, v99, v102
    v_lshlrev_b32 v3, 1, v3
    v_mul_u32_u24 v104, 4096, v97
    v_lshl_add_u32 v104, v0, 2, v104
    v_mov_b32 v105, v104
    v_lshlrev_b32 v107, 10, v97
    v_lshlrev_b32 v106, 2, v102
    v_lshl_add_u32 v106, v103, 4, v106
    v_add_u32 v106, v106, v107
    v_mov_b32 v108, 16384
    v_mov_b32 v109, 1
    s_lshl_b32 s69, s79, 9
    s_add_u32 s69, s69, s92
    s_mov_b32 s64, 0xcccccccc
    s_mov_b32 s65, 0xcccccccc
    s_mov_b32 s66, 0xaaaaaaaa
    s_mov_b32 s67, 0xaaaaaaaa
    s_mov_b32 s78, 0x3dd53b95
    s_waitcnt lgkmcnt(0)
    s_mov_b32 s24, s6
    s_and_b32 s25, s7, 0xffff
    s_mov_b32 s26, 805306368
    s_mov_b32 s27, 0x00020000
    s_mov_b32 s48, s4
    s_and_b32 s49, s5, 0xffff
    s_mov_b32 s50, 12288
    s_mov_b32 s51, 0x00020000
    s_mov_b32 s32, s10
    s_and_b32 s33, s11, 0xffff
    s_mov_b32 s34, 6291456
    s_mov_b32 s35, 0x00020000
    s_mov_b32 s36, s12
    s_and_b32 s37, s13, 0xffff
    s_mov_b32 s38, 6291456
    s_mov_b32 s39, 0x00020000
    s_mov_b32 s70, s69
    s_mov_b32 s75, 2
    s_lshr_b32 s74, s70, 9
    s_mul_i32 s74, s74, 384
    buffer_load_dwordx2 v[68:69], v2, s[48:51], s74 offen offset:0
    buffer_load_dwordx2 v[70:71], v2, s[48:51], s74 offen offset:128
    buffer_load_dwordx2 v[72:73], v2, s[48:51], s74 offen offset:256
    s_mul_i32 s71, s70, 49152
    s_mul_i32 s72, s70, 384
    buffer_load_dwordx2 v[56:57], v2, s[32:35], s72 offen offset:0
    buffer_load_dwordx2 v[58:59], v2, s[32:35], s72 offen offset:128
    buffer_load_dwordx2 v[60:61], v2, s[32:35], s72 offen offset:256
    buffer_load_dwordx2 v[62:63], v2, s[36:39], s72 offen offset:0
    buffer_load_dwordx2 v[64:65], v2, s[36:39], s72 offen offset:128
    buffer_load_dwordx2 v[66:67], v2, s[36:39], s72 offen offset:256
    buffer_load_dwordx4 v[4:7], v1, s[24:27], s71 offen offset:0 nt
    buffer_load_dwordx4 v[8:11], v1, s[24:27], s71 offen offset:256 nt
    buffer_load_dwordx4 v[12:15], v1, s[24:27], s71 offen offset:512 nt
    s_add_u32 s71, s71, 3072
    buffer_load_dwordx4 v[16:19], v1, s[24:27], s71 offen offset:0 nt
    buffer_load_dwordx4 v[20:23], v1, s[24:27], s71 offen offset:256 nt
    s_mov_b32 s28, s8
    s_and_b32 s29, s9, 0xffff
    s_mov_b32 s30, 805306368
    s_mov_b32 s31, 0x00020000
    s_mov_b32 s40, s14
    s_and_b32 s41, s15, 0xffff
    s_mov_b32 s42, 2097152
    s_mov_b32 s43, 0x00020000
    s_mov_b32 s44, s16
    s_and_b32 s45, s17, 0xffff
    s_mov_b32 s46, 2097152
    s_mov_b32 s47, 0x00020000
    s_mov_b32 s77, 2
    v_mov_b32 v89, 0xf149f2ca
    v_mov_b32 v90, 0
    v_mov_b32 v91, 0
    v_mov_b32 v76, 0
    v_mov_b32 v77, 0
    v_mov_b32 v78, 0
    v_mov_b32 v79, 0
    v_mov_b32 v80, 0
    v_mov_b32 v81, 0
    v_mov_b32 v82, 0
    v_mov_b32 v83, 0
    v_mov_b32 v84, 0
    v_mov_b32 v85, 0
    v_mov_b32 v86, 0
    v_mov_b32 v87, 0
    s_barrier
    s_mov_b32 s76, 3
L_loop0:
    s_waitcnt vmcnt(11)
    v_lshlrev_b32 v32, 16, v68
    v_and_b32 v33, 0xffff0000, v68
    v_lshlrev_b32 v34, 16, v69
    v_and_b32 v35, 0xffff0000, v69
    v_lshlrev_b32 v36, 16, v70
    v_and_b32 v37, 0xffff0000, v70
    v_lshlrev_b32 v38, 16, v71
    v_and_b32 v39, 0xffff0000, v71
    v_lshlrev_b32 v40, 16, v72
    v_and_b32 v41, 0xffff0000, v72
    v_lshlrev_b32 v42, 16, v73
    v_and_b32 v43, 0xffff0000, v73
    v_mul_f32 v32, s78, v32
    v_mul_f32 v33, s78, v33
    v_mul_f32 v34, s78, v34
    v_mul_f32 v35, s78, v35
    v_mul_f32 v36, s78, v36
    v_mul_f32 v37, s78, v37
    v_mul_f32 v38, s78, v38
    v_mul_f32 v39, s78, v39
    v_mul_f32 v40, s78, v40
    v_mul_f32 v41, s78, v41
    v_mul_f32 v42, s78, v42
    v_mul_f32 v43, s78, v43
    s_waitcnt vmcnt(5)
    v_lshlrev_b32 v102, 16, v56
    v_and_b32 v103, 0xffff0000, v56
    v_mul_f32 v44, v102, v32
    v_mul_f32 v45, v103, v33
    v_lshlrev_b32 v102, 16, v62
    v_and_b32 v103, 0xffff0000, v62
    v_mul_f32 v88, v44, v102
    v_fmac_f32 v88, v45, v103
    v_lshlrev_b32 v102, 16, v57
    v_and_b32 v103, 0xffff0000, v57
    v_mul_f32 v46, v102, v34
    v_mul_f32 v47, v103, v35
    v_lshlrev_b32 v102, 16, v63
    v_and_b32 v103, 0xffff0000, v63
    v_fmac_f32 v88, v46, v102
    v_fmac_f32 v88, v47, v103
    v_lshlrev_b32 v102, 16, v58
    v_and_b32 v103, 0xffff0000, v58
    v_mul_f32 v48, v102, v36
    v_mul_f32 v49, v103, v37
    v_lshlrev_b32 v102, 16, v64
    v_and_b32 v103, 0xffff0000, v64
    v_fmac_f32 v88, v48, v102
    v_fmac_f32 v88, v49, v103
    v_lshlrev_b32 v102, 16, v59
    v_and_b32 v103, 0xffff0000, v59
    v_mul_f32 v50, v102, v38
    v_mul_f32 v51, v103, v39
    v_lshlrev_b32 v102, 16, v65
    v_and_b32 v103, 0xffff0000, v65
    v_fmac_f32 v88, v50, v102
    v_fmac_f32 v88, v51, v103
    v_lshlrev_b32 v102, 16, v60
    v_and_b32 v103, 0xffff0000, v60
    v_mul_f32 v52, v102, v40
    v_mul_f32 v53, v103, v41
    v_lshlrev_b32 v102, 16, v66
    v_and_b32 v103, 0xffff0000, v66
    v_fmac_f32 v88, v52, v102
    v_fmac_f32 v88, v53, v103
    v_lshlrev_b32 v102, 16, v61
    v_and_b32 v103, 0xffff0000, v61
    v_mul_f32 v54, v102, v42
    v_mul_f32 v55, v103, v43
    v_lshlrev_b32 v102, 16, v67
    v_and_b32 v103, 0xffff0000, v67
    v_fmac_f32 v88, v54, v102
    v_fmac_f32 v88, v55, v103
    s_waitcnt vmcnt(4)
    v_cvt_f32_i32 v24, v4
    v_cvt_f32_i32 v25, v5
    v_cvt_f32_i32 v26, v6
    v_cvt_f32_i32 v27, v7
    buffer_load_dwordx4 v[4:7], v1, s[24:27], s71 offen offset:512 nt
    v_fma_f32 v96, v44, v24, -v88
    v_fmac_f32 v96, v45, v25
    v_fmac_f32 v96, v46, v26
    v_fmac_f32 v96, v47, v27
    s_waitcnt vmcnt(4)
    v_cvt_f32_i32 v28, v8
    v_cvt_f32_i32 v29, v9
    v_cvt_f32_i32 v30, v10
    v_cvt_f32_i32 v31, v11
    s_add_u32 s71, s71, 3072
    buffer_load_dwordx4 v[8:11], v1, s[24:27], s71 offen offset:0 nt
    v_fmac_f32 v96, v48, v28
    v_fmac_f32 v96, v49, v29
    v_fmac_f32 v96, v50, v30
    v_fmac_f32 v96, v51, v31
    s_waitcnt vmcnt(4)
    v_cvt_f32_i32 v24, v12
    v_cvt_f32_i32 v25, v13
    v_cvt_f32_i32 v26, v14
    v_cvt_f32_i32 v27, v15
    buffer_load_dwordx4 v[12:15], v1, s[24:27], s71 offen offset:256 nt
    v_fmac_f32 v96, v52, v24
    v_fmac_f32 v96, v53, v25
    v_fmac_f32 v96, v54, v26
    v_fmac_f32 v96, v55, v27
    s_nop 1
    v_add_f32_dpp v97, v96, v96 row_ror:8 row_mask:0xf bank_mask:0x3
    s_waitcnt vmcnt(4)
    v_cvt_f32_i32 v28, v16
    v_cvt_f32_i32 v29, v17
    v_cvt_f32_i32 v30, v18
    v_cvt_f32_i32 v31, v19
    buffer_load_dwordx4 v[16:19], v1, s[24:27], s71 offen offset:512 nt
    v_fma_f32 v96, v44, v28, -v88
    v_fmac_f32 v96, v45, v29
    v_fmac_f32 v96, v46, v30
    v_fmac_f32 v96, v47, v31
    s_waitcnt vmcnt(4)
    v_cvt_f32_i32 v24, v20
    v_cvt_f32_i32 v25, v21
    v_cvt_f32_i32 v26, v22
    v_cvt_f32_i32 v27, v23
    s_add_u32 s71, s71, 3072
    buffer_load_dwordx4 v[20:23], v1, s[24:27], s71 offen offset:0 nt
    v_fmac_f32 v96, v48, v24
    v_fmac_f32 v96, v49, v25
    v_fmac_f32 v96, v50, v26
    v_fmac_f32 v96, v51, v27
    s_waitcnt vmcnt(4)
    v_cvt_f32_i32 v28, v4
    v_cvt_f32_i32 v29, v5
    v_cvt_f32_i32 v30, v6
    v_cvt_f32_i32 v31, v7
    buffer_load_dwordx4 v[4:7], v1, s[24:27], s71 offen offset:256 nt
    v_fmac_f32 v96, v52, v28
    v_fmac_f32 v96, v53, v29
    v_fmac_f32 v96, v54, v30
    v_fmac_f32 v96, v55, v31
    s_nop 1
    v_add_f32_dpp v97, v96, v96 row_ror:8 row_mask:0xf bank_mask:0xc
    s_nop 1
    v_add_f32_dpp v98, v97, v97 row_shl:4 row_mask:0xf bank_mask:0x5
    s_waitcnt vmcnt(4)
    v_cvt_f32_i32 v24, v8
    v_cvt_f32_i32 v25, v9
    v_cvt_f32_i32 v26, v10
    v_cvt_f32_i32 v27, v11
    buffer_load_dwordx4 v[8:11], v1, s[24:27], s71 offen offset:512 nt
    v_fma_f32 v96, v44, v24, -v88
    v_fmac_f32 v96, v45, v25
    v_fmac_f32 v96, v46, v26
    v_fmac_f32 v96, v47, v27
    s_waitcnt vmcnt(4)
    v_cvt_f32_i32 v28, v12
    v_cvt_f32_i32 v29, v13
    v_cvt_f32_i32 v30, v14
    v_cvt_f32_i32 v31, v15
    s_add_u32 s70, s70, 64
    s_mul_i32 s71, s70, 49152
    s_mul_i32 s72, s70, 384
    buffer_load_dwordx2 v[56:57], v2, s[32:35], s72 offen offset:0
    buffer_load_dwordx2 v[58:59], v2, s[32:35], s72 offen offset:128
    buffer_load_dwordx2 v[60:61], v2, s[32:35], s72 offen offset:256
    buffer_load_dwordx2 v[62:63], v2, s[36:39], s72 offen offset:0
    buffer_load_dwordx2 v[64:65], v2, s[36:39], s72 offen offset:128
    buffer_load_dwordx2 v[66:67], v2, s[36:39], s72 offen offset:256
    buffer_load_dwordx4 v[12:15], v1, s[24:27], s71 offen offset:0 nt
    v_fmac_f32 v96, v48, v28
    v_fmac_f32 v96, v49, v29
    v_fmac_f32 v96, v50, v30
    v_fmac_f32 v96, v51, v31
    s_waitcnt vmcnt(10)
    v_cvt_f32_i32 v24, v16
    v_cvt_f32_i32 v25, v17
    v_cvt_f32_i32 v26, v18
    v_cvt_f32_i32 v27, v19
    buffer_load_dwordx4 v[16:19], v1, s[24:27], s71 offen offset:256 nt
    v_fmac_f32 v96, v52, v24
    v_fmac_f32 v96, v53, v25
    v_fmac_f32 v96, v54, v26
    v_fmac_f32 v96, v55, v27
    s_nop 1
    v_add_f32_dpp v97, v96, v96 row_ror:8 row_mask:0xf bank_mask:0x3
    s_waitcnt vmcnt(10)
    v_cvt_f32_i32 v28, v20
    v_cvt_f32_i32 v29, v21
    v_cvt_f32_i32 v30, v22
    v_cvt_f32_i32 v31, v23
    buffer_load_dwordx4 v[20:23], v1, s[24:27], s71 offen offset:512 nt
    v_fma_f32 v96, v44, v28, -v88
    v_fmac_f32 v96, v45, v29
    v_fmac_f32 v96, v46, v30
    v_fmac_f32 v96, v47, v31
    s_waitcnt vmcnt(10)
    v_cvt_f32_i32 v24, v4
    v_cvt_f32_i32 v25, v5
    v_cvt_f32_i32 v26, v6
    v_cvt_f32_i32 v27, v7
    s_add_u32 s71, s71, 3072
    buffer_load_dwordx4 v[4:7], v1, s[24:27], s71 offen offset:0 nt
    v_fmac_f32 v96, v48, v24
    v_fmac_f32 v96, v49, v25
    v_fmac_f32 v96, v50, v26
    v_fmac_f32 v96, v51, v27
    s_waitcnt vmcnt(10)
    v_cvt_f32_i32 v28, v8
    v_cvt_f32_i32 v29, v9
    v_cvt_f32_i32 v30, v10
    v_cvt_f32_i32 v31, v11
    buffer_load_dwordx4 v[8:11], v1, s[24:27], s71 offen offset:256 nt
    v_fmac_f32 v96, v52, v28
    v_fmac_f32 v96, v53, v29
    v_fmac_f32 v96, v54, v30
    v_fmac_f32 v96, v55, v31
    s_nop 1
    v_add_f32_dpp v97, v96, v96 row_ror:8 row_mask:0xf bank_mask:0xc
    s_nop 1
    v_add_f32_dpp v98, v97, v97 row_shr:4 row_mask:0xf bank_mask:0xa
    s_nop 1
    v_add_f32_dpp v99, v98, v98 quad_perm:[2,3,0,1] row_mask:0xf bank_mask:0xf
    s_waitcnt vmcnt(5)
    v_lshlrev_b32 v102, 16, v56
    v_and_b32 v103, 0xffff0000, v56
    v_mul_f32 v44, v102, v32
    v_mul_f32 v45, v103, v33
    v_lshlrev_b32 v102, 16, v62
    v_and_b32 v103, 0xffff0000, v62
    v_mul_f32 v88, v44, v102
    v_fmac_f32 v88, v45, v103
    v_lshlrev_b32 v102, 16, v57
    v_and_b32 v103, 0xffff0000, v57
    v_mul_f32 v46, v102, v34
    v_mul_f32 v47, v103, v35
    v_lshlrev_b32 v102, 16, v63
    v_and_b32 v103, 0xffff0000, v63
    v_fmac_f32 v88, v46, v102
    v_fmac_f32 v88, v47, v103
    v_lshlrev_b32 v102, 16, v58
    v_and_b32 v103, 0xffff0000, v58
    v_mul_f32 v48, v102, v36
    v_mul_f32 v49, v103, v37
    v_lshlrev_b32 v102, 16, v64
    v_and_b32 v103, 0xffff0000, v64
    v_fmac_f32 v88, v48, v102
    v_fmac_f32 v88, v49, v103
    v_lshlrev_b32 v102, 16, v59
    v_and_b32 v103, 0xffff0000, v59
    v_mul_f32 v50, v102, v38
    v_mul_f32 v51, v103, v39
    v_lshlrev_b32 v102, 16, v65
    v_and_b32 v103, 0xffff0000, v65
    v_fmac_f32 v88, v50, v102
    v_fmac_f32 v88, v51, v103
    v_lshlrev_b32 v102, 16, v60
    v_and_b32 v103, 0xffff0000, v60
    v_mul_f32 v52, v102, v40
    v_mul_f32 v53, v103, v41
    v_lshlrev_b32 v102, 16, v66
    v_and_b32 v103, 0xffff0000, v66
    v_fmac_f32 v88, v52, v102
    v_fmac_f32 v88, v53, v103
    v_lshlrev_b32 v102, 16, v61
    v_and_b32 v103, 0xffff0000, v61
    v_mul_f32 v54, v102, v42
    v_mul_f32 v55, v103, v43
    v_lshlrev_b32 v102, 16, v67
    v_and_b32 v103, 0xffff0000, v67
    v_fmac_f32 v88, v54, v102
    v_fmac_f32 v88, v55, v103
    s_waitcnt vmcnt(4)
    v_cvt_f32_i32 v24, v12
    v_cvt_f32_i32 v25, v13
    v_cvt_f32_i32 v26, v14
    v_cvt_f32_i32 v27, v15
    buffer_load_dwordx4 v[12:15], v1, s[24:27], s71 offen offset:512 nt
    v_fma_f32 v96, v44, v24, -v88
    v_fmac_f32 v96, v45, v25
    v_fmac_f32 v96, v46, v26
    v_fmac_f32 v96, v47, v27
    s_waitcnt vmcnt(4)
    v_cvt_f32_i32 v28, v16
    v_cvt_f32_i32 v29, v17
    v_cvt_f32_i32 v30, v18
    v_cvt_f32_i32 v31, v19
    s_add_u32 s71, s71, 3072
    buffer_load_dwordx4 v[16:19], v1, s[24:27], s71 offen offset:0 nt
    v_fmac_f32 v96, v48, v28
    v_fmac_f32 v96, v49, v29
    v_fmac_f32 v96, v50, v30
    v_fmac_f32 v96, v51, v31
    s_waitcnt vmcnt(4)
    v_cvt_f32_i32 v24, v20
    v_cvt_f32_i32 v25, v21
    v_cvt_f32_i32 v26, v22
    v_cvt_f32_i32 v27, v23
    buffer_load_dwordx4 v[20:23], v1, s[24:27], s71 offen offset:256 nt
    v_fmac_f32 v96, v52, v24
    v_fmac_f32 v96, v53, v25
    v_fmac_f32 v96, v54, v26
    v_fmac_f32 v96, v55, v27
    s_nop 1
    v_add_f32_dpp v97, v96, v96 row_ror:8 row_mask:0xf bank_mask:0x3
    s_waitcnt vmcnt(4)
    v_cvt_f32_i32 v28, v4
    v_cvt_f32_i32 v29, v5
    v_cvt_f32_i32 v30, v6
    v_cvt_f32_i32 v31, v7
    buffer_load_dwordx4 v[4:7], v1, s[24:27], s71 offen offset:512 nt
    v_fma_f32 v96, v44, v28, -v88
    v_fmac_f32 v96, v45, v29
    v_fmac_f32 v96, v46, v30
    v_fmac_f32 v96, v47, v31
    s_waitcnt vmcnt(4)
    v_cvt_f32_i32 v24, v8
    v_cvt_f32_i32 v25, v9
    v_cvt_f32_i32 v26, v10
    v_cvt_f32_i32 v27, v11
    s_add_u32 s71, s71, 3072
    buffer_load_dwordx4 v[8:11], v1, s[24:27], s71 offen offset:0 nt
    v_fmac_f32 v96, v48, v24
    v_fmac_f32 v96, v49, v25
    v_fmac_f32 v96, v50, v26
    v_fmac_f32 v96, v51, v27
    s_waitcnt vmcnt(4)
    v_cvt_f32_i32 v28, v12
    v_cvt_f32_i32 v29, v13
    v_cvt_f32_i32 v30, v14
    v_cvt_f32_i32 v31, v15
    buffer_load_dwordx4 v[12:15], v1, s[24:27], s71 offen offset:256 nt
    v_fmac_f32 v96, v52, v28
    v_fmac_f32 v96, v53, v29
    v_fmac_f32 v96, v54, v30
    v_fmac_f32 v96, v55, v31
    s_nop 1
    v_add_f32_dpp v97, v96, v96 row_ror:8 row_mask:0xf bank_mask:0xc
    s_nop 1
    v_add_f32_dpp v98, v97, v97 row_shl:4 row_mask:0xf bank_mask:0x5
    s_waitcnt vmcnt(4)
    v_cvt_f32_i32 v24, v16
    v_cvt_f32_i32 v25, v17
    v_cvt_f32_i32 v26, v18
    v_cvt_f32_i32 v27, v19
    buffer_load_dwordx4 v[16:19], v1, s[24:27], s71 offen offset:512 nt
    v_fma_f32 v96, v44, v24, -v88
    v_fmac_f32 v96, v45, v25
    v_fmac_f32 v96, v46, v26
    v_fmac_f32 v96, v47, v27
    s_waitcnt vmcnt(4)
    v_cvt_f32_i32 v28, v20
    v_cvt_f32_i32 v29, v21
    v_cvt_f32_i32 v30, v22
    v_cvt_f32_i32 v31, v23
    s_add_u32 s70, s70, 64
    s_mul_i32 s71, s70, 49152
    s_mul_i32 s72, s70, 384
    buffer_load_dwordx2 v[56:57], v2, s[32:35], s72 offen offset:0
    buffer_load_dwordx2 v[58:59], v2, s[32:35], s72 offen offset:128
    buffer_load_dwordx2 v[60:61], v2, s[32:35], s72 offen offset:256
    buffer_load_dwordx2 v[62:63], v2, s[36:39], s72 offen offset:0
    buffer_load_dwordx2 v[64:65], v2, s[36:39], s72 offen offset:128
    buffer_load_dwordx2 v[66:67], v2, s[36:39], s72 offen offset:256
    buffer_load_dwordx4 v[20:23], v1, s[24:27], s71 offen offset:0 nt
    v_fmac_f32 v96, v48, v28
    v_fmac_f32 v96, v49, v29
    v_fmac_f32 v96, v50, v30
    v_fmac_f32 v96, v51, v31
    s_waitcnt vmcnt(10)
    v_cvt_f32_i32 v24, v4
    v_cvt_f32_i32 v25, v5
    v_cvt_f32_i32 v26, v6
    v_cvt_f32_i32 v27, v7
    buffer_load_dwordx4 v[4:7], v1, s[24:27], s71 offen offset:256 nt
    v_fmac_f32 v96, v52, v24
    v_fmac_f32 v96, v53, v25
    v_fmac_f32 v96, v54, v26
    v_fmac_f32 v96, v55, v27
    s_nop 1
    v_add_f32_dpp v97, v96, v96 row_ror:8 row_mask:0xf bank_mask:0x3
    s_waitcnt vmcnt(10)
    v_cvt_f32_i32 v28, v8
    v_cvt_f32_i32 v29, v9
    v_cvt_f32_i32 v30, v10
    v_cvt_f32_i32 v31, v11
    buffer_load_dwordx4 v[8:11], v1, s[24:27], s71 offen offset:512 nt
    v_fma_f32 v96, v44, v28, -v88
    v_fmac_f32 v96, v45, v29
    v_fmac_f32 v96, v46, v30
    v_fmac_f32 v96, v47, v31
    s_waitcnt vmcnt(10)
    v_cvt_f32_i32 v24, v12
    v_cvt_f32_i32 v25, v13
    v_cvt_f32_i32 v26, v14
    v_cvt_f32_i32 v27, v15
    s_add_u32 s71, s71, 3072
    buffer_load_dwordx4 v[12:15], v1, s[24:27], s71 offen offset:0 nt
    v_fmac_f32 v96, v48, v24
    v_fmac_f32 v96, v49, v25
    v_fmac_f32 v96, v50, v26
    v_fmac_f32 v96, v51, v27
    s_waitcnt vmcnt(10)
    v_cvt_f32_i32 v28, v16
    v_cvt_f32_i32 v29, v17
    v_cvt_f32_i32 v30, v18
    v_cvt_f32_i32 v31, v19
    buffer_load_dwordx4 v[16:19], v1, s[24:27], s71 offen offset:256 nt
    v_fmac_f32 v96, v52, v28
    v_fmac_f32 v96, v53, v29
    v_fmac_f32 v96, v54, v30
    v_fmac_f32 v96, v55, v31
    s_nop 1
    v_add_f32_dpp v97, v96, v96 row_ror:8 row_mask:0xf bank_mask:0xc
    s_nop 1
    v_add_f32_dpp v98, v97, v97 row_shr:4 row_mask:0xf bank_mask:0xa
    s_nop 1
    v_add_f32_dpp v100, v98, v98 quad_perm:[2,3,0,1] row_mask:0xf bank_mask:0xf
    v_cndmask_b32 v100, v99, v100, s[64:65]
    s_nop 1
    v_add_f32_dpp v101, v100, v100 quad_perm:[1,0,3,2] row_mask:0xf bank_mask:0xf
    s_waitcnt vmcnt(5)
    v_lshlrev_b32 v102, 16, v56
    v_and_b32 v103, 0xffff0000, v56
    v_mul_f32 v44, v102, v32
    v_mul_f32 v45, v103, v33
    v_lshlrev_b32 v102, 16, v62
    v_and_b32 v103, 0xffff0000, v62
    v_mul_f32 v88, v44, v102
    v_fmac_f32 v88, v45, v103
    v_lshlrev_b32 v102, 16, v57
    v_and_b32 v103, 0xffff0000, v57
    v_mul_f32 v46, v102, v34
    v_mul_f32 v47, v103, v35
    v_lshlrev_b32 v102, 16, v63
    v_and_b32 v103, 0xffff0000, v63
    v_fmac_f32 v88, v46, v102
    v_fmac_f32 v88, v47, v103
    v_lshlrev_b32 v102, 16, v58
    v_and_b32 v103, 0xffff0000, v58
    v_mul_f32 v48, v102, v36
    v_mul_f32 v49, v103, v37
    v_lshlrev_b32 v102, 16, v64
    v_and_b32 v103, 0xffff0000, v64
    v_fmac_f32 v88, v48, v102
    v_fmac_f32 v88, v49, v103
    v_lshlrev_b32 v102, 16, v59
    v_and_b32 v103, 0xffff0000, v59
    v_mul_f32 v50, v102, v38
    v_mul_f32 v51, v103, v39
    v_lshlrev_b32 v102, 16, v65
    v_and_b32 v103, 0xffff0000, v65
    v_fmac_f32 v88, v50, v102
    v_fmac_f32 v88, v51, v103
    v_lshlrev_b32 v102, 16, v60
    v_and_b32 v103, 0xffff0000, v60
    v_mul_f32 v52, v102, v40
    v_mul_f32 v53, v103, v41
    v_lshlrev_b32 v102, 16, v66
    v_and_b32 v103, 0xffff0000, v66
    v_fmac_f32 v88, v52, v102
    v_fmac_f32 v88, v53, v103
    v_lshlrev_b32 v102, 16, v61
    v_and_b32 v103, 0xffff0000, v61
    v_mul_f32 v54, v102, v42
    v_mul_f32 v55, v103, v43
    v_lshlrev_b32 v102, 16, v67
    v_and_b32 v103, 0xffff0000, v67
    v_fmac_f32 v88, v54, v102
    v_fmac_f32 v88, v55, v103
    s_waitcnt vmcnt(4)
    v_cvt_f32_i32 v24, v20
    v_cvt_f32_i32 v25, v21
    v_cvt_f32_i32 v26, v22
    v_cvt_f32_i32 v27, v23
    buffer_load_dwordx4 v[20:23], v1, s[24:27], s71 offen offset:512 nt
    v_fma_f32 v96, v44, v24, -v88
    v_fmac_f32 v96, v45, v25
    v_fmac_f32 v96, v46, v26
    v_fmac_f32 v96, v47, v27
    s_waitcnt vmcnt(4)
    v_cvt_f32_i32 v28, v4
    v_cvt_f32_i32 v29, v5
    v_cvt_f32_i32 v30, v6
    v_cvt_f32_i32 v31, v7
    s_add_u32 s71, s71, 3072
    buffer_load_dwordx4 v[4:7], v1, s[24:27], s71 offen offset:0 nt
    v_fmac_f32 v96, v48, v28
    v_fmac_f32 v96, v49, v29
    v_fmac_f32 v96, v50, v30
    v_fmac_f32 v96, v51, v31
    s_waitcnt vmcnt(4)
    v_cvt_f32_i32 v24, v8
    v_cvt_f32_i32 v25, v9
    v_cvt_f32_i32 v26, v10
    v_cvt_f32_i32 v27, v11
    buffer_load_dwordx4 v[8:11], v1, s[24:27], s71 offen offset:256 nt
    v_fmac_f32 v96, v52, v24
    v_fmac_f32 v96, v53, v25
    v_fmac_f32 v96, v54, v26
    v_fmac_f32 v96, v55, v27
    s_nop 1
    v_add_f32_dpp v97, v96, v96 row_ror:8 row_mask:0xf bank_mask:0x3
    s_waitcnt vmcnt(4)
    v_cvt_f32_i32 v28, v12
    v_cvt_f32_i32 v29, v13
    v_cvt_f32_i32 v30, v14
    v_cvt_f32_i32 v31, v15
    buffer_load_dwordx4 v[12:15], v1, s[24:27], s71 offen offset:512 nt
    v_fma_f32 v96, v44, v28, -v88
    v_fmac_f32 v96, v45, v29
    v_fmac_f32 v96, v46, v30
    v_fmac_f32 v96, v47, v31
    s_waitcnt vmcnt(4)
    v_cvt_f32_i32 v24, v16
    v_cvt_f32_i32 v25, v17
    v_cvt_f32_i32 v26, v18
    v_cvt_f32_i32 v27, v19
    s_add_u32 s71, s71, 3072
    buffer_load_dwordx4 v[16:19], v1, s[24:27], s71 offen offset:0 nt
    v_fmac_f32 v96, v48, v24
    v_fmac_f32 v96, v49, v25
    v_fmac_f32 v96, v50, v26
    v_fmac_f32 v96, v51, v27
    s_waitcnt vmcnt(4)
    v_cvt_f32_i32 v28, v20
    v_cvt_f32_i32 v29, v21
    v_cvt_f32_i32 v30, v22
    v_cvt_f32_i32 v31, v23
    buffer_load_dwordx4 v[20:23], v1, s[24:27], s71 offen offset:256 nt
    v_fmac_f32 v96, v52, v28
    v_fmac_f32 v96, v53, v29
    v_fmac_f32 v96, v54, v30
    v_fmac_f32 v96, v55, v31
    s_nop 1
    v_add_f32_dpp v97, v96, v96 row_ror:8 row_mask:0xf bank_mask:0xc
    s_nop 1
    v_add_f32_dpp v98, v97, v97 row_shl:4 row_mask:0xf bank_mask:0x5
    s_waitcnt vmcnt(4)
    v_cvt_f32_i32 v24, v4
    v_cvt_f32_i32 v25, v5
    v_cvt_f32_i32 v26, v6
    v_cvt_f32_i32 v27, v7
    buffer_load_dwordx4 v[4:7], v1, s[24:27], s71 offen offset:512 nt
    v_fma_f32 v96, v44, v24, -v88
    v_fmac_f32 v96, v45, v25
    v_fmac_f32 v96, v46, v26
    v_fmac_f32 v96, v47, v27
    s_waitcnt vmcnt(4)
    v_cvt_f32_i32 v28, v8
    v_cvt_f32_i32 v29, v9
    v_cvt_f32_i32 v30, v10
    v_cvt_f32_i32 v31, v11
    s_add_u32 s70, s70, 64
    s_mul_i32 s71, s70, 49152
    s_mul_i32 s72, s70, 384
    buffer_load_dwordx2 v[56:57], v2, s[32:35], s72 offen offset:0
    buffer_load_dwordx2 v[58:59], v2, s[32:35], s72 offen offset:128
    buffer_load_dwordx2 v[60:61], v2, s[32:35], s72 offen offset:256
    buffer_load_dwordx2 v[62:63], v2, s[36:39], s72 offen offset:0
    buffer_load_dwordx2 v[64:65], v2, s[36:39], s72 offen offset:128
    buffer_load_dwordx2 v[66:67], v2, s[36:39], s72 offen offset:256
    buffer_load_dwordx4 v[8:11], v1, s[24:27], s71 offen offset:0 nt
    v_fmac_f32 v96, v48, v28
    v_fmac_f32 v96, v49, v29
    v_fmac_f32 v96, v50, v30
    v_fmac_f32 v96, v51, v31
    s_waitcnt vmcnt(10)
    v_cvt_f32_i32 v24, v12
    v_cvt_f32_i32 v25, v13
    v_cvt_f32_i32 v26, v14
    v_cvt_f32_i32 v27, v15
    buffer_load_dwordx4 v[12:15], v1, s[24:27], s71 offen offset:256 nt
    v_fmac_f32 v96, v52, v24
    v_fmac_f32 v96, v53, v25
    v_fmac_f32 v96, v54, v26
    v_fmac_f32 v96, v55, v27
    s_nop 1
    v_add_f32_dpp v97, v96, v96 row_ror:8 row_mask:0xf bank_mask:0x3
    s_waitcnt vmcnt(10)
    v_cvt_f32_i32 v28, v16
    v_cvt_f32_i32 v29, v17
    v_cvt_f32_i32 v30, v18
    v_cvt_f32_i32 v31, v19
    buffer_load_dwordx4 v[16:19], v1, s[24:27], s71 offen offset:512 nt
    v_fma_f32 v96, v44, v28, -v88
    v_fmac_f32 v96, v45, v29
    v_fmac_f32 v96, v46, v30
    v_fmac_f32 v96, v47, v31
    s_waitcnt vmcnt(10)
    v_cvt_f32_i32 v24, v20
    v_cvt_f32_i32 v25, v21
    v_cvt_f32_i32 v26, v22
    v_cvt_f32_i32 v27, v23
    s_add_u32 s71, s71, 3072
    buffer_load_dwordx4 v[20:23], v1, s[24:27], s71 offen offset:0 nt
    v_fmac_f32 v96, v48, v24
    v_fmac_f32 v96, v49, v25
    v_fmac_f32 v96, v50, v26
    v_fmac_f32 v96, v51, v27
    s_waitcnt vmcnt(10)
    v_cvt_f32_i32 v28, v4
    v_cvt_f32_i32 v29, v5
    v_cvt_f32_i32 v30, v6
    v_cvt_f32_i32 v31, v7
    buffer_load_dwordx4 v[4:7], v1, s[24:27], s71 offen offset:256 nt
    v_fmac_f32 v96, v52, v28
    v_fmac_f32 v96, v53, v29
    v_fmac_f32 v96, v54, v30
    v_fmac_f32 v96, v55, v31
    s_nop 1
    v_add_f32_dpp v97, v96, v96 row_ror:8 row_mask:0xf bank_mask:0xc
    s_nop 1
    v_add_f32_dpp v98, v97, v97 row_shr:4 row_mask:0xf bank_mask:0xa
    s_nop 1
    v_add_f32_dpp v99, v98, v98 quad_perm:[2,3,0,1] row_mask:0xf bank_mask:0xf
    s_waitcnt vmcnt(5)
    v_lshlrev_b32 v102, 16, v56
    v_and_b32 v103, 0xffff0000, v56
    v_mul_f32 v44, v102, v32
    v_mul_f32 v45, v103, v33
    v_lshlrev_b32 v102, 16, v62
    v_and_b32 v103, 0xffff0000, v62
    v_mul_f32 v88, v44, v102
    v_fmac_f32 v88, v45, v103
    v_lshlrev_b32 v102, 16, v57
    v_and_b32 v103, 0xffff0000, v57
    v_mul_f32 v46, v102, v34
    v_mul_f32 v47, v103, v35
    v_lshlrev_b32 v102, 16, v63
    v_and_b32 v103, 0xffff0000, v63
    v_fmac_f32 v88, v46, v102
    v_fmac_f32 v88, v47, v103
    v_lshlrev_b32 v102, 16, v58
    v_and_b32 v103, 0xffff0000, v58
    v_mul_f32 v48, v102, v36
    v_mul_f32 v49, v103, v37
    v_lshlrev_b32 v102, 16, v64
    v_and_b32 v103, 0xffff0000, v64
    v_fmac_f32 v88, v48, v102
    v_fmac_f32 v88, v49, v103
    v_lshlrev_b32 v102, 16, v59
    v_and_b32 v103, 0xffff0000, v59
    v_mul_f32 v50, v102, v38
    v_mul_f32 v51, v103, v39
    v_lshlrev_b32 v102, 16, v65
    v_and_b32 v103, 0xffff0000, v65
    v_fmac_f32 v88, v50, v102
    v_fmac_f32 v88, v51, v103
    v_lshlrev_b32 v102, 16, v60
    v_and_b32 v103, 0xffff0000, v60
    v_mul_f32 v52, v102, v40
    v_mul_f32 v53, v103, v41
    v_lshlrev_b32 v102, 16, v66
    v_and_b32 v103, 0xffff0000, v66
    v_fmac_f32 v88, v52, v102
    v_fmac_f32 v88, v53, v103
    v_lshlrev_b32 v102, 16, v61
    v_and_b32 v103, 0xffff0000, v61
    v_mul_f32 v54, v102, v42
    v_mul_f32 v55, v103, v43
    v_lshlrev_b32 v102, 16, v67
    v_and_b32 v103, 0xffff0000, v67
    v_fmac_f32 v88, v54, v102
    v_fmac_f32 v88, v55, v103
    s_waitcnt vmcnt(4)
    v_cvt_f32_i32 v24, v8
    v_cvt_f32_i32 v25, v9
    v_cvt_f32_i32 v26, v10
    v_cvt_f32_i32 v27, v11
    buffer_load_dwordx4 v[8:11], v1, s[24:27], s71 offen offset:512 nt
    v_fma_f32 v96, v44, v24, -v88
    v_fmac_f32 v96, v45, v25
    v_fmac_f32 v96, v46, v26
    v_fmac_f32 v96, v47, v27
    s_waitcnt vmcnt(4)
    v_cvt_f32_i32 v28, v12
    v_cvt_f32_i32 v29, v13
    v_cvt_f32_i32 v30, v14
    v_cvt_f32_i32 v31, v15
    s_add_u32 s71, s71, 3072
    buffer_load_dwordx4 v[12:15], v1, s[24:27], s71 offen offset:0 nt
    v_fmac_f32 v96, v48, v28
    v_fmac_f32 v96, v49, v29
    v_fmac_f32 v96, v50, v30
    v_fmac_f32 v96, v51, v31
    s_waitcnt vmcnt(4)
    v_cvt_f32_i32 v24, v16
    v_cvt_f32_i32 v25, v17
    v_cvt_f32_i32 v26, v18
    v_cvt_f32_i32 v27, v19
    buffer_load_dwordx4 v[16:19], v1, s[24:27], s71 offen offset:256 nt
    v_fmac_f32 v96, v52, v24
    v_fmac_f32 v96, v53, v25
    v_fmac_f32 v96, v54, v26
    v_fmac_f32 v96, v55, v27
    s_nop 1
    v_add_f32_dpp v97, v96, v96 row_ror:8 row_mask:0xf bank_mask:0x3
    s_waitcnt vmcnt(4)
    v_cvt_f32_i32 v28, v20
    v_cvt_f32_i32 v29, v21
    v_cvt_f32_i32 v30, v22
    v_cvt_f32_i32 v31, v23
    buffer_load_dwordx4 v[20:23], v1, s[24:27], s71 offen offset:512 nt
    v_fma_f32 v96, v44, v28, -v88
    v_fmac_f32 v96, v45, v29
    v_fmac_f32 v96, v46, v30
    v_fmac_f32 v96, v47, v31
    s_waitcnt vmcnt(4)
    v_cvt_f32_i32 v24, v4
    v_cvt_f32_i32 v25, v5
    v_cvt_f32_i32 v26, v6
    v_cvt_f32_i32 v27, v7
    s_add_u32 s71, s71, 3072
    buffer_load_dwordx4 v[4:7], v1, s[24:27], s71 offen offset:0 nt
    v_fmac_f32 v96, v48, v24
    v_fmac_f32 v96, v49, v25
    v_fmac_f32 v96, v50, v26
    v_fmac_f32 v96, v51, v27
    s_waitcnt vmcnt(4)
    v_cvt_f32_i32 v28, v8
    v_cvt_f32_i32 v29, v9
    v_cvt_f32_i32 v30, v10
    v_cvt_f32_i32 v31, v11
    buffer_load_dwordx4 v[8:11], v1, s[24:27], s71 offen offset:256 nt
    v_fmac_f32 v96, v52, v28
    v_fmac_f32 v96, v53, v29
    v_fmac_f32 v96, v54, v30
    v_fmac_f32 v96, v55, v31
    s_nop 1
    v_add_f32_dpp v97, v96, v96 row_ror:8 row_mask:0xf bank_mask:0xc
    s_nop 1
    v_add_f32_dpp v98, v97, v97 row_shl:4 row_mask:0xf bank_mask:0x5
    s_waitcnt vmcnt(4)
    v_cvt_f32_i32 v24, v12
    v_cvt_f32_i32 v25, v13
    v_cvt_f32_i32 v26, v14
    v_cvt_f32_i32 v27, v15
    buffer_load_dwordx4 v[12:15], v1, s[24:27], s71 offen offset:512 nt
    v_fma_f32 v96, v44, v24, -v88
    v_fmac_f32 v96, v45, v25
    v_fmac_f32 v96, v46, v26
    v_fmac_f32 v96, v47, v27
    s_waitcnt vmcnt(4)
    v_cvt_f32_i32 v28, v16
    v_cvt_f32_i32 v29, v17
    v_cvt_f32_i32 v30, v18
    v_cvt_f32_i32 v31, v19
    s_add_u32 s70, s70, 64
    s_sub_u32 s75, s75, 1
    s_cmp_eq_u32 s75, 0
    s_cselect_b32 s80, 1536, 0
    s_cselect_b32 s75, 2, s75
    s_add_u32 s70, s70, s80
    s_lshr_b32 s74, s70, 9
    s_mul_i32 s74, s74, 384
    buffer_load_dwordx2 v[68:69], v2, s[48:51], s74 offen offset:0
    buffer_load_dwordx2 v[70:71], v2, s[48:51], s74 offen offset:128
    buffer_load_dwordx2 v[72:73], v2, s[48:51], s74 offen offset:256
    s_mul_i32 s71, s70, 49152
    s_mul_i32 s72, s70, 384
    buffer_load_dwordx2 v[56:57], v2, s[32:35], s72 offen offset:0
    buffer_load_dwordx2 v[58:59], v2, s[32:35], s72 offen offset:128
    buffer_load_dwordx2 v[60:61], v2, s[32:35], s72 offen offset:256
    buffer_load_dwordx2 v[62:63], v2, s[36:39], s72 offen offset:0
    buffer_load_dwordx2 v[64:65], v2, s[36:39], s72 offen offset:128
    buffer_load_dwordx2 v[66:67], v2, s[36:39], s72 offen offset:256
    buffer_load_dwordx4 v[16:19], v1, s[24:27], s71 offen offset:0 nt
    v_fmac_f32 v96, v48, v28
    v_fmac_f32 v96, v49, v29
    v_fmac_f32 v96, v50, v30
    v_fmac_f32 v96, v51, v31
    s_waitcnt vmcnt(13)
    v_cvt_f32_i32 v24, v20
    v_cvt_f32_i32 v25, v21
    v_cvt_f32_i32 v26, v22
    v_cvt_f32_i32 v27, v23
    buffer_load_dwordx4 v[20:23], v1, s[24:27], s71 offen offset:256 nt
    v_fmac_f32 v96, v52, v24
    v_fmac_f32 v96, v53, v25
    v_fmac_f32 v96, v54, v26
    v_fmac_f32 v96, v55, v27
    s_nop 1
    v_add_f32_dpp v97, v96, v96 row_ror:8 row_mask:0xf bank_mask:0x3
    s_waitcnt vmcnt(13)
    v_cvt_f32_i32 v28, v4
    v_cvt_f32_i32 v29, v5
    v_cvt_f32_i32 v30, v6
    v_cvt_f32_i32 v31, v7
    buffer_load_dwordx4 v[4:7], v1, s[24:27], s71 offen offset:512 nt
    v_fma_f32 v96, v44, v28, -v88
    v_fmac_f32 v96, v45, v29
    v_fmac_f32 v96, v46, v30
    v_fmac_f32 v96, v47, v31
    s_waitcnt vmcnt(13)
    v_cvt_f32_i32 v24, v8
    v_cvt_f32_i32 v25, v9
    v_cvt_f32_i32 v26, v10
    v_cvt_f32_i32 v27, v11
    s_add_u32 s71, s71, 3072
    buffer_load_dwordx4 v[8:11], v1, s[24:27], s71 offen offset:0 nt
    v_fmac_f32 v96, v48, v24
    v_fmac_f32 v96, v49, v25
    v_fmac_f32 v96, v50, v26
    v_fmac_f32 v96, v51, v27
    s_waitcnt vmcnt(13)
    v_cvt_f32_i32 v28, v12
    v_cvt_f32_i32 v29, v13
    v_cvt_f32_i32 v30, v14
    v_cvt_f32_i32 v31, v15
    buffer_load_dwordx4 v[12:15], v1, s[24:27], s71 offen offset:256 nt
    v_fmac_f32 v96, v52, v28
    v_fmac_f32 v96, v53, v29
    v_fmac_f32 v96, v54, v30
    v_fmac_f32 v96, v55, v31
    s_nop 1
    v_add_f32_dpp v97, v96, v96 row_ror:8 row_mask:0xf bank_mask:0xc
    s_nop 1
    v_add_f32_dpp v98, v97, v97 row_shr:4 row_mask:0xf bank_mask:0xa
    s_nop 1
    v_add_f32_dpp v100, v98, v98 quad_perm:[2,3,0,1] row_mask:0xf bank_mask:0xf
    v_cndmask_b32 v100, v99, v100, s[64:65]
    s_nop 1
    v_add_f32_dpp v99, v100, v100 quad_perm:[1,0,3,2] row_mask:0xf bank_mask:0xf
    v_cndmask_b32 v101, v101, v99, s[66:67]
    ds_write_b32 v104, v101
    v_add_u32 v104, 256, v104
    s_waitcnt vmcnt(11)
    v_lshlrev_b32 v32, 16, v68
    v_and_b32 v33, 0xffff0000, v68
    v_lshlrev_b32 v34, 16, v69
    v_and_b32 v35, 0xffff0000, v69
    v_lshlrev_b32 v36, 16, v70
    v_and_b32 v37, 0xffff0000, v70
    v_lshlrev_b32 v38, 16, v71
    v_and_b32 v39, 0xffff0000, v71
    v_lshlrev_b32 v40, 16, v72
    v_and_b32 v41, 0xffff0000, v72
    v_lshlrev_b32 v42, 16, v73
    v_and_b32 v43, 0xffff0000, v73
    v_mul_f32 v32, s78, v32
    v_mul_f32 v33, s78, v33
    v_mul_f32 v34, s78, v34
    v_mul_f32 v35, s78, v35
    v_mul_f32 v36, s78, v36
    v_mul_f32 v37, s78, v37
    v_mul_f32 v38, s78, v38
    v_mul_f32 v39, s78, v39
    v_mul_f32 v40, s78, v40
    v_mul_f32 v41, s78, v41
    v_mul_f32 v42, s78, v42
    v_mul_f32 v43, s78, v43
    s_waitcnt vmcnt(5)
    v_lshlrev_b32 v102, 16, v56
    v_and_b32 v103, 0xffff0000, v56
    v_mul_f32 v44, v102, v32
    v_mul_f32 v45, v103, v33
    v_lshlrev_b32 v102, 16, v62
    v_and_b32 v103, 0xffff0000, v62
    v_mul_f32 v88, v44, v102
    v_fmac_f32 v88, v45, v103
    v_lshlrev_b32 v102, 16, v57
    v_and_b32 v103, 0xffff0000, v57
    v_mul_f32 v46, v102, v34
    v_mul_f32 v47, v103, v35
    v_lshlrev_b32 v102, 16, v63
    v_and_b32 v103, 0xffff0000, v63
    v_fmac_f32 v88, v46, v102
    v_fmac_f32 v88, v47, v103
    v_lshlrev_b32 v102, 16, v58
    v_and_b32 v103, 0xffff0000, v58
    v_mul_f32 v48, v102, v36
    v_mul_f32 v49, v103, v37
    v_lshlrev_b32 v102, 16, v64
    v_and_b32 v103, 0xffff0000, v64
    v_fmac_f32 v88, v48, v102
    v_fmac_f32 v88, v49, v103
    v_lshlrev_b32 v102, 16, v59
    v_and_b32 v103, 0xffff0000, v59
    v_mul_f32 v50, v102, v38
    v_mul_f32 v51, v103, v39
    v_lshlrev_b32 v102, 16, v65
    v_and_b32 v103, 0xffff0000, v65
    v_fmac_f32 v88, v50, v102
    v_fmac_f32 v88, v51, v103
    v_lshlrev_b32 v102, 16, v60
    v_and_b32 v103, 0xffff0000, v60
    v_mul_f32 v52, v102, v40
    v_mul_f32 v53, v103, v41
    v_lshlrev_b32 v102, 16, v66
    v_and_b32 v103, 0xffff0000, v66
    v_fmac_f32 v88, v52, v102
    v_fmac_f32 v88, v53, v103
    v_lshlrev_b32 v102, 16, v61
    v_and_b32 v103, 0xffff0000, v61
    v_mul_f32 v54, v102, v42
    v_mul_f32 v55, v103, v43
    v_lshlrev_b32 v102, 16, v67
    v_and_b32 v103, 0xffff0000, v67
    v_fmac_f32 v88, v54, v102
    v_fmac_f32 v88, v55, v103
    s_waitcnt vmcnt(4)
    v_cvt_f32_i32 v24, v16
    v_cvt_f32_i32 v25, v17
    v_cvt_f32_i32 v26, v18
    v_cvt_f32_i32 v27, v19
    buffer_load_dwordx4 v[16:19], v1, s[24:27], s71 offen offset:512 nt
    v_fma_f32 v96, v44, v24, -v88
    v_fmac_f32 v96, v45, v25
    v_fmac_f32 v96, v46, v26
    v_fmac_f32 v96, v47, v27
    s_waitcnt vmcnt(4)
    v_cvt_f32_i32 v28, v20
    v_cvt_f32_i32 v29, v21
    v_cvt_f32_i32 v30, v22
    v_cvt_f32_i32 v31, v23
    s_add_u32 s71, s71, 3072
    buffer_load_dwordx4 v[20:23], v1, s[24:27], s71 offen offset:0 nt
    v_fmac_f32 v96, v48, v28
    v_fmac_f32 v96, v49, v29
    v_fmac_f32 v96, v50, v30
    v_fmac_f32 v96, v51, v31
    s_waitcnt vmcnt(4)
    v_cvt_f32_i32 v24, v4
    v_cvt_f32_i32 v25, v5
    v_cvt_f32_i32 v26, v6
    v_cvt_f32_i32 v27, v7
    buffer_load_dwordx4 v[4:7], v1, s[24:27], s71 offen offset:256 nt
    v_fmac_f32 v96, v52, v24
    v_fmac_f32 v96, v53, v25
    v_fmac_f32 v96, v54, v26
    v_fmac_f32 v96, v55, v27
    s_nop 1
    v_add_f32_dpp v97, v96, v96 row_ror:8 row_mask:0xf bank_mask:0x3
    s_waitcnt vmcnt(4)
    v_cvt_f32_i32 v28, v8
    v_cvt_f32_i32 v29, v9
    v_cvt_f32_i32 v30, v10
    v_cvt_f32_i32 v31, v11
    buffer_load_dwordx4 v[8:11], v1, s[24:27], s71 offen offset:512 nt
    v_fma_f32 v96, v44, v28, -v88
    v_fmac_f32 v96, v45, v29
    v_fmac_f32 v96, v46, v30
    v_fmac_f32 v96, v47, v31
    s_waitcnt vmcnt(4)
    v_cvt_f32_i32 v24, v12
    v_cvt_f32_i32 v25, v13
    v_cvt_f32_i32 v26, v14
    v_cvt_f32_i32 v27, v15
    s_add_u32 s71, s71, 3072
    buffer_load_dwordx4 v[12:15], v1, s[24:27], s71 offen offset:0 nt
    v_fmac_f32 v96, v48, v24
    v_fmac_f32 v96, v49, v25
    v_fmac_f32 v96, v50, v26
    v_fmac_f32 v96, v51, v27
    s_waitcnt vmcnt(4)
    v_cvt_f32_i32 v28, v16
    v_cvt_f32_i32 v29, v17
    v_cvt_f32_i32 v30, v18
    v_cvt_f32_i32 v31, v19
    buffer_load_dwordx4 v[16:19], v1, s[24:27], s71 offen offset:256 nt
    v_fmac_f32 v96, v52, v28
    v_fmac_f32 v96, v53, v29
    v_fmac_f32 v96, v54, v30
    v_fmac_f32 v96, v55, v31
    s_nop 1
    v_add_f32_dpp v97, v96, v96 row_ror:8 row_mask:0xf bank_mask:0xc
    s_nop 1
    v_add_f32_dpp v98, v97, v97 row_shl:4 row_mask:0xf bank_mask:0x5
    s_waitcnt vmcnt(4)
    v_cvt_f32_i32 v24, v20
    v_cvt_f32_i32 v25, v21
    v_cvt_f32_i32 v26, v22
    v_cvt_f32_i32 v27, v23
    buffer_load_dwordx4 v[20:23], v1, s[24:27], s71 offen offset:512 nt
    v_fma_f32 v96, v44, v24, -v88
    v_fmac_f32 v96, v45, v25
    v_fmac_f32 v96, v46, v26
    v_fmac_f32 v96, v47, v27
    s_waitcnt vmcnt(4)
    v_cvt_f32_i32 v28, v4
    v_cvt_f32_i32 v29, v5
    v_cvt_f32_i32 v30, v6
    v_cvt_f32_i32 v31, v7
    s_add_u32 s70, s70, 64
    s_mul_i32 s71, s70, 49152
    s_mul_i32 s72, s70, 384
    buffer_load_dwordx2 v[56:57], v2, s[32:35], s72 offen offset:0
    buffer_load_dwordx2 v[58:59], v2, s[32:35], s72 offen offset:128
    buffer_load_dwordx2 v[60:61], v2, s[32:35], s72 offen offset:256
    buffer_load_dwordx2 v[62:63], v2, s[36:39], s72 offen offset:0
    buffer_load_dwordx2 v[64:65], v2, s[36:39], s72 offen offset:128
    buffer_load_dwordx2 v[66:67], v2, s[36:39], s72 offen offset:256
    buffer_load_dwordx4 v[4:7], v1, s[24:27], s71 offen offset:0 nt
    v_fmac_f32 v96, v48, v28
    v_fmac_f32 v96, v49, v29
    v_fmac_f32 v96, v50, v30
    v_fmac_f32 v96, v51, v31
    s_waitcnt vmcnt(10)
    v_cvt_f32_i32 v24, v8
    v_cvt_f32_i32 v25, v9
    v_cvt_f32_i32 v26, v10
    v_cvt_f32_i32 v27, v11
    buffer_load_dwordx4 v[8:11], v1, s[24:27], s71 offen offset:256 nt
    v_fmac_f32 v96, v52, v24
    v_fmac_f32 v96, v53, v25
    v_fmac_f32 v96, v54, v26
    v_fmac_f32 v96, v55, v27
    s_nop 1
    v_add_f32_dpp v97, v96, v96 row_ror:8 row_mask:0xf bank_mask:0x3
    s_waitcnt vmcnt(10)
    v_cvt_f32_i32 v28, v12
    v_cvt_f32_i32 v29, v13
    v_cvt_f32_i32 v30, v14
    v_cvt_f32_i32 v31, v15
    buffer_load_dwordx4 v[12:15], v1, s[24:27], s71 offen offset:512 nt
    v_fma_f32 v96, v44, v28, -v88
    v_fmac_f32 v96, v45, v29
    v_fmac_f32 v96, v46, v30
    v_fmac_f32 v96, v47, v31
    s_waitcnt vmcnt(10)
    v_cvt_f32_i32 v24, v16
    v_cvt_f32_i32 v25, v17
    v_cvt_f32_i32 v26, v18
    v_cvt_f32_i32 v27, v19
    s_add_u32 s71, s71, 3072
    buffer_load_dwordx4 v[16:19], v1, s[24:27], s71 offen offset:0 nt
    v_fmac_f32 v96, v48, v24
    v_fmac_f32 v96, v49, v25
    v_fmac_f32 v96, v50, v26
    v_fmac_f32 v96, v51, v27
    s_waitcnt vmcnt(10)
    v_cvt_f32_i32 v28, v20
    v_cvt_f32_i32 v29, v21
    v_cvt_f32_i32 v30, v22
    v_cvt_f32_i32 v31, v23
    buffer_load_dwordx4 v[20:23], v1, s[24:27], s71 offen offset:256 nt
    v_fmac_f32 v96, v52, v28
    v_fmac_f32 v96, v53, v29
    v_fmac_f32 v96, v54, v30
    v_fmac_f32 v96, v55, v31
    s_nop 1
    v_add_f32_dpp v97, v96, v96 row_ror:8 row_mask:0xf bank_mask:0xc
    s_nop 1
    v_add_f32_dpp v98, v97, v97 row_shr:4 row_mask:0xf bank_mask:0xa
    s_nop 1
    v_add_f32_dpp v99, v98, v98 quad_perm:[2,3,0,1] row_mask:0xf bank_mask:0xf
    s_waitcnt vmcnt(5)
    v_lshlrev_b32 v102, 16, v56
    v_and_b32 v103, 0xffff0000, v56
    v_mul_f32 v44, v102, v32
    v_mul_f32 v45, v103, v33
    v_lshlrev_b32 v102, 16, v62
    v_and_b32 v103, 0xffff0000, v62
    v_mul_f32 v88, v44, v102
    v_fmac_f32 v88, v45, v103
    v_lshlrev_b32 v102, 16, v57
    v_and_b32 v103, 0xffff0000, v57
    v_mul_f32 v46, v102, v34
    v_mul_f32 v47, v103, v35
    v_lshlrev_b32 v102, 16, v63
    v_and_b32 v103, 0xffff0000, v63
    v_fmac_f32 v88, v46, v102
    v_fmac_f32 v88, v47, v103
    v_lshlrev_b32 v102, 16, v58
    v_and_b32 v103, 0xffff0000, v58
    v_mul_f32 v48, v102, v36
    v_mul_f32 v49, v103, v37
    v_lshlrev_b32 v102, 16, v64
    v_and_b32 v103, 0xffff0000, v64
    v_fmac_f32 v88, v48, v102
    v_fmac_f32 v88, v49, v103
    v_lshlrev_b32 v102, 16, v59
    v_and_b32 v103, 0xffff0000, v59
    v_mul_f32 v50, v102, v38
    v_mul_f32 v51, v103, v39
    v_lshlrev_b32 v102, 16, v65
    v_and_b32 v103, 0xffff0000, v65
    v_fmac_f32 v88, v50, v102
    v_fmac_f32 v88, v51, v103
    v_lshlrev_b32 v102, 16, v60
    v_and_b32 v103, 0xffff0000, v60
    v_mul_f32 v52, v102, v40
    v_mul_f32 v53, v103, v41
    v_lshlrev_b32 v102, 16, v66
    v_and_b32 v103, 0xffff0000, v66
    v_fmac_f32 v88, v52, v102
    v_fmac_f32 v88, v53, v103
    v_lshlrev_b32 v102, 16, v61
    v_and_b32 v103, 0xffff0000, v61
    v_mul_f32 v54, v102, v42
    v_mul_f32 v55, v103, v43
    v_lshlrev_b32 v102, 16, v67
    v_and_b32 v103, 0xffff0000, v67
    v_fmac_f32 v88, v54, v102
    v_fmac_f32 v88, v55, v103
    s_waitcnt vmcnt(4)
    v_cvt_f32_i32 v24, v4
    v_cvt_f32_i32 v25, v5
    v_cvt_f32_i32 v26, v6
    v_cvt_f32_i32 v27, v7
    buffer_load_dwordx4 v[4:7], v1, s[24:27], s71 offen offset:512 nt
    v_fma_f32 v96, v44, v24, -v88
    v_fmac_f32 v96, v45, v25
    v_fmac_f32 v96, v46, v26
    v_fmac_f32 v96, v47, v27
    s_waitcnt vmcnt(4)
    v_cvt_f32_i32 v28, v8
    v_cvt_f32_i32 v29, v9
    v_cvt_f32_i32 v30, v10
    v_cvt_f32_i32 v31, v11
    s_add_u32 s71, s71, 3072
    buffer_load_dwordx4 v[8:11], v1, s[24:27], s71 offen offset:0 nt
    v_fmac_f32 v96, v48, v28
    v_fmac_f32 v96, v49, v29
    v_fmac_f32 v96, v50, v30
    v_fmac_f32 v96, v51, v31
    s_waitcnt vmcnt(4)
    v_cvt_f32_i32 v24, v12
    v_cvt_f32_i32 v25, v13
    v_cvt_f32_i32 v26, v14
    v_cvt_f32_i32 v27, v15
    buffer_load_dwordx4 v[12:15], v1, s[24:27], s71 offen offset:256 nt
    v_fmac_f32 v96, v52, v24
    v_fmac_f32 v96, v53, v25
    v_fmac_f32 v96, v54, v26
    v_fmac_f32 v96, v55, v27
    s_nop 1
    v_add_f32_dpp v97, v96, v96 row_ror:8 row_mask:0xf bank_mask:0x3
    s_waitcnt vmcnt(4)
    v_cvt_f32_i32 v28, v16
    v_cvt_f32_i32 v29, v17
    v_cvt_f32_i32 v30, v18
    v_cvt_f32_i32 v31, v19
    buffer_load_dwordx4 v[16:19], v1, s[24:27], s71 offen offset:512 nt
    v_fma_f32 v96, v44, v28, -v88
    v_fmac_f32 v96, v45, v29
    v_fmac_f32 v96, v46, v30
    v_fmac_f32 v96, v47, v31
    s_waitcnt vmcnt(4)
    v_cvt_f32_i32 v24, v20
    v_cvt_f32_i32 v25, v21
    v_cvt_f32_i32 v26, v22
    v_cvt_f32_i32 v27, v23
    s_add_u32 s71, s71, 3072
    buffer_load_dwordx4 v[20:23], v1, s[24:27], s71 offen offset:0 nt
    v_fmac_f32 v96, v48, v24
    v_fmac_f32 v96, v49, v25
    v_fmac_f32 v96, v50, v26
    v_fmac_f32 v96, v51, v27
    s_waitcnt vmcnt(4)
    v_cvt_f32_i32 v28, v4
    v_cvt_f32_i32 v29, v5
    v_cvt_f32_i32 v30, v6
    v_cvt_f32_i32 v31, v7
    buffer_load_dwordx4 v[4:7], v1, s[24:27], s71 offen offset:256 nt
    v_fmac_f32 v96, v52, v28
    v_fmac_f32 v96, v53, v29
    v_fmac_f32 v96, v54, v30
    v_fmac_f32 v96, v55, v31
    s_nop 1
    v_add_f32_dpp v97, v96, v96 row_ror:8 row_mask:0xf bank_mask:0xc
    s_nop 1
    v_add_f32_dpp v98, v97, v97 row_shl:4 row_mask:0xf bank_mask:0x5
    s_waitcnt vmcnt(4)
    v_cvt_f32_i32 v24, v8
    v_cvt_f32_i32 v25, v9
    v_cvt_f32_i32 v26, v10
    v_cvt_f32_i32 v27, v11
    buffer_load_dwordx4 v[8:11], v1, s[24:27], s71 offen offset:512 nt
    v_fma_f32 v96, v44, v24, -v88
    v_fmac_f32 v96, v45, v25
    v_fmac_f32 v96, v46, v26
    v_fmac_f32 v96, v47, v27
    s_waitcnt vmcnt(4)
    v_cvt_f32_i32 v28, v12
    v_cvt_f32_i32 v29, v13
    v_cvt_f32_i32 v30, v14
    v_cvt_f32_i32 v31, v15
    s_add_u32 s70, s70, 64
    s_mul_i32 s71, s70, 49152
    s_mul_i32 s72, s70, 384
    buffer_load_dwordx2 v[56:57], v2, s[32:35], s72 offen offset:0
    buffer_load_dwordx2 v[58:59], v2, s[32:35], s72 offen offset:128
    buffer_load_dwordx2 v[60:61], v2, s[32:35], s72 offen offset:256
    buffer_load_dwordx2 v[62:63], v2, s[36:39], s72 offen offset:0
    buffer_load_dwordx2 v[64:65], v2, s[36:39], s72 offen offset:128
    buffer_load_dwordx2 v[66:67], v2, s[36:39], s72 offen offset:256
    buffer_load_dwordx4 v[12:15], v1, s[24:27], s71 offen offset:0 nt
    v_fmac_f32 v96, v48, v28
    v_fmac_f32 v96, v49, v29
    v_fmac_f32 v96, v50, v30
    v_fmac_f32 v96, v51, v31
    s_waitcnt vmcnt(10)
    v_cvt_f32_i32 v24, v16
    v_cvt_f32_i32 v25, v17
    v_cvt_f32_i32 v26, v18
    v_cvt_f32_i32 v27, v19
    buffer_load_dwordx4 v[16:19], v1, s[24:27], s71 offen offset:256 nt
    v_fmac_f32 v96, v52, v24
    v_fmac_f32 v96, v53, v25
    v_fmac_f32 v96, v54, v26
    v_fmac_f32 v96, v55, v27
    s_nop 1
    v_add_f32_dpp v97, v96, v96 row_ror:8 row_mask:0xf bank_mask:0x3
    s_waitcnt vmcnt(10)
    v_cvt_f32_i32 v28, v20
    v_cvt_f32_i32 v29, v21
    v_cvt_f32_i32 v30, v22
    v_cvt_f32_i32 v31, v23
    buffer_load_dwordx4 v[20:23], v1, s[24:27], s71 offen offset:512 nt
    v_fma_f32 v96, v44, v28, -v88
    v_fmac_f32 v96, v45, v29
    v_fmac_f32 v96, v46, v30
    v_fmac_f32 v96, v47, v31
    s_waitcnt vmcnt(10)
    v_cvt_f32_i32 v24, v4
    v_cvt_f32_i32 v25, v5
    v_cvt_f32_i32 v26, v6
    v_cvt_f32_i32 v27, v7
    s_add_u32 s71, s71, 3072
    buffer_load_dwordx4 v[4:7], v1, s[24:27], s71 offen offset:0 nt
    v_fmac_f32 v96, v48, v24
    v_fmac_f32 v96, v49, v25
    v_fmac_f32 v96, v50, v26
    v_fmac_f32 v96, v51, v27
    s_waitcnt vmcnt(10)
    v_cvt_f32_i32 v28, v8
    v_cvt_f32_i32 v29, v9
    v_cvt_f32_i32 v30, v10
    v_cvt_f32_i32 v31, v11
    buffer_load_dwordx4 v[8:11], v1, s[24:27], s71 offen offset:256 nt
    v_fmac_f32 v96, v52, v28
    v_fmac_f32 v96, v53, v29
    v_fmac_f32 v96, v54, v30
    v_fmac_f32 v96, v55, v31
    s_nop 1
    v_add_f32_dpp v97, v96, v96 row_ror:8 row_mask:0xf bank_mask:0xc
    s_nop 1
    v_add_f32_dpp v98, v97, v97 row_shr:4 row_mask:0xf bank_mask:0xa
    s_nop 1
    v_add_f32_dpp v100, v98, v98 quad_perm:[2,3,0,1] row_mask:0xf bank_mask:0xf
    v_cndmask_b32 v100, v99, v100, s[64:65]
    s_nop 1
    v_add_f32_dpp v101, v100, v100 quad_perm:[1,0,3,2] row_mask:0xf bank_mask:0xf
    s_waitcnt vmcnt(5)
    v_lshlrev_b32 v102, 16, v56
    v_and_b32 v103, 0xffff0000, v56
    v_mul_f32 v44, v102, v32
    v_mul_f32 v45, v103, v33
    v_lshlrev_b32 v102, 16, v62
    v_and_b32 v103, 0xffff0000, v62
    v_mul_f32 v88, v44, v102
    v_fmac_f32 v88, v45, v103
    v_lshlrev_b32 v102, 16, v57
    v_and_b32 v103, 0xffff0000, v57
    v_mul_f32 v46, v102, v34
    v_mul_f32 v47, v103, v35
    v_lshlrev_b32 v102, 16, v63
    v_and_b32 v103, 0xffff0000, v63
    v_fmac_f32 v88, v46, v102
    v_fmac_f32 v88, v47, v103
    v_lshlrev_b32 v102, 16, v58
    v_and_b32 v103, 0xffff0000, v58
    v_mul_f32 v48, v102, v36
    v_mul_f32 v49, v103, v37
    v_lshlrev_b32 v102, 16, v64
    v_and_b32 v103, 0xffff0000, v64
    v_fmac_f32 v88, v48, v102
    v_fmac_f32 v88, v49, v103
    v_lshlrev_b32 v102, 16, v59
    v_and_b32 v103, 0xffff0000, v59
    v_mul_f32 v50, v102, v38
    v_mul_f32 v51, v103, v39
    v_lshlrev_b32 v102, 16, v65
    v_and_b32 v103, 0xffff0000, v65
    v_fmac_f32 v88, v50, v102
    v_fmac_f32 v88, v51, v103
    v_lshlrev_b32 v102, 16, v60
    v_and_b32 v103, 0xffff0000, v60
    v_mul_f32 v52, v102, v40
    v_mul_f32 v53, v103, v41
    v_lshlrev_b32 v102, 16, v66
    v_and_b32 v103, 0xffff0000, v66
    v_fmac_f32 v88, v52, v102
    v_fmac_f32 v88, v53, v103
    v_lshlrev_b32 v102, 16, v61
    v_and_b32 v103, 0xffff0000, v61
    v_mul_f32 v54, v102, v42
    v_mul_f32 v55, v103, v43
    v_lshlrev_b32 v102, 16, v67
    v_and_b32 v103, 0xffff0000, v67
    v_fmac_f32 v88, v54, v102
    v_fmac_f32 v88, v55, v103
    s_waitcnt vmcnt(4)
    v_cvt_f32_i32 v24, v12
    v_cvt_f32_i32 v25, v13
    v_cvt_f32_i32 v26, v14
    v_cvt_f32_i32 v27, v15
    buffer_load_dwordx4 v[12:15], v1, s[24:27], s71 offen offset:512 nt
    v_fma_f32 v96, v44, v24, -v88
    v_fmac_f32 v96, v45, v25
    v_fmac_f32 v96, v46, v26
    v_fmac_f32 v96, v47, v27
    s_waitcnt vmcnt(4)
    v_cvt_f32_i32 v28, v16
    v_cvt_f32_i32 v29, v17
    v_cvt_f32_i32 v30, v18
    v_cvt_f32_i32 v31, v19
    s_add_u32 s71, s71, 3072
    buffer_load_dwordx4 v[16:19], v1, s[24:27], s71 offen offset:0 nt
    v_fmac_f32 v96, v48, v28
    v_fmac_f32 v96, v49, v29
    v_fmac_f32 v96, v50, v30
    v_fmac_f32 v96, v51, v31
    s_waitcnt vmcnt(4)
    v_cvt_f32_i32 v24, v20
    v_cvt_f32_i32 v25, v21
    v_cvt_f32_i32 v26, v22
    v_cvt_f32_i32 v27, v23
    buffer_load_dwordx4 v[20:23], v1, s[24:27], s71 offen offset:256 nt
    v_fmac_f32 v96, v52, v24
    v_fmac_f32 v96, v53, v25
    v_fmac_f32 v96, v54, v26
    v_fmac_f32 v96, v55, v27
    s_nop 1
    v_add_f32_dpp v97, v96, v96 row_ror:8 row_mask:0xf bank_mask:0x3
    s_waitcnt vmcnt(4)
    v_cvt_f32_i32 v28, v4
    v_cvt_f32_i32 v29, v5
    v_cvt_f32_i32 v30, v6
    v_cvt_f32_i32 v31, v7
    buffer_load_dwordx4 v[4:7], v1, s[24:27], s71 offen offset:512 nt
    v_fma_f32 v96, v44, v28, -v88
    v_fmac_f32 v96, v45, v29
    v_fmac_f32 v96, v46, v30
    v_fmac_f32 v96, v47, v31
    s_waitcnt vmcnt(4)
    v_cvt_f32_i32 v24, v8
    v_cvt_f32_i32 v25, v9
    v_cvt_f32_i32 v26, v10
    v_cvt_f32_i32 v27, v11
    s_add_u32 s71, s71, 3072
    buffer_load_dwordx4 v[8:11], v1, s[24:27], s71 offen offset:0 nt
    v_fmac_f32 v96, v48, v24
    v_fmac_f32 v96, v49, v25
    v_fmac_f32 v96, v50, v26
    v_fmac_f32 v96, v51, v27
    s_waitcnt vmcnt(4)
    v_cvt_f32_i32 v28, v12
    v_cvt_f32_i32 v29, v13
    v_cvt_f32_i32 v30, v14
    v_cvt_f32_i32 v31, v15
    buffer_load_dwordx4 v[12:15], v1, s[24:27], s71 offen offset:256 nt
    v_fmac_f32 v96, v52, v28
    v_fmac_f32 v96, v53, v29
    v_fmac_f32 v96, v54, v30
    v_fmac_f32 v96, v55, v31
    s_nop 1
    v_add_f32_dpp v97, v96, v96 row_ror:8 row_mask:0xf bank_mask:0xc
    s_nop 1
    v_add_f32_dpp v98, v97, v97 row_shl:4 row_mask:0xf bank_mask:0x5
    s_waitcnt vmcnt(4)
    v_cvt_f32_i32 v24, v16
    v_cvt_f32_i32 v25, v17
    v_cvt_f32_i32 v26, v18
    v_cvt_f32_i32 v27, v19
    buffer_load_dwordx4 v[16:19], v1, s[24:27], s71 offen offset:512 nt
    v_fma_f32 v96, v44, v24, -v88
    v_fmac_f32 v96, v45, v25
    v_fmac_f32 v96, v46, v26
    v_fmac_f32 v96, v47, v27
    s_waitcnt vmcnt(4)
    v_cvt_f32_i32 v28, v20
    v_cvt_f32_i32 v29, v21
    v_cvt_f32_i32 v30, v22
    v_cvt_f32_i32 v31, v23
    s_add_u32 s70, s70, 64
    s_mul_i32 s71, s70, 49152
    s_mul_i32 s72, s70, 384
    buffer_load_dwordx2 v[56:57], v2, s[32:35], s72 offen offset:0
    buffer_load_dwordx2 v[58:59], v2, s[32:35], s72 offen offset:128
    buffer_load_dwordx2 v[60:61], v2, s[32:35], s72 offen offset:256
    buffer_load_dwordx2 v[62:63], v2, s[36:39], s72 offen offset:0
    buffer_load_dwordx2 v[64:65], v2, s[36:39], s72 offen offset:128
    buffer_load_dwordx2 v[66:67], v2, s[36:39], s72 offen offset:256
    buffer_load_dwordx4 v[20:23], v1, s[24:27], s71 offen offset:0 nt
    v_fmac_f32 v96, v48, v28
    v_fmac_f32 v96, v49, v29
    v_fmac_f32 v96, v50, v30
    v_fmac_f32 v96, v51, v31
    s_waitcnt vmcnt(10)
    v_cvt_f32_i32 v24, v4
    v_cvt_f32_i32 v25, v5
    v_cvt_f32_i32 v26, v6
    v_cvt_f32_i32 v27, v7
    buffer_load_dwordx4 v[4:7], v1, s[24:27], s71 offen offset:256 nt
    v_fmac_f32 v96, v52, v24
    v_fmac_f32 v96, v53, v25
    v_fmac_f32 v96, v54, v26
    v_fmac_f32 v96, v55, v27
    s_nop 1
    v_add_f32_dpp v97, v96, v96 row_ror:8 row_mask:0xf bank_mask:0x3
    s_waitcnt vmcnt(10)
    v_cvt_f32_i32 v28, v8
    v_cvt_f32_i32 v29, v9
    v_cvt_f32_i32 v30, v10
    v_cvt_f32_i32 v31, v11
    buffer_load_dwordx4 v[8:11], v1, s[24:27], s71 offen offset:512 nt
    v_fma_f32 v96, v44, v28, -v88
    v_fmac_f32 v96, v45, v29
    v_fmac_f32 v96, v46, v30
    v_fmac_f32 v96, v47, v31
    s_waitcnt vmcnt(10)
    v_cvt_f32_i32 v24, v12
    v_cvt_f32_i32 v25, v13
    v_cvt_f32_i32 v26, v14
    v_cvt_f32_i32 v27, v15
    s_add_u32 s71, s71, 3072
    buffer_load_dwordx4 v[12:15], v1, s[24:27], s71 offen offset:0 nt
    v_fmac_f32 v96, v48, v24
    v_fmac_f32 v96, v49, v25
    v_fmac_f32 v96, v50, v26
    v_fmac_f32 v96, v51, v27
    s_waitcnt vmcnt(10)
    v_cvt_f32_i32 v28, v16
    v_cvt_f32_i32 v29, v17
    v_cvt_f32_i32 v30, v18
    v_cvt_f32_i32 v31, v19
    buffer_load_dwordx4 v[16:19], v1, s[24:27], s71 offen offset:256 nt
    v_fmac_f32 v96, v52, v28
    v_fmac_f32 v96, v53, v29
    v_fmac_f32 v96, v54, v30
    v_fmac_f32 v96, v55, v31
    s_nop 1
    v_add_f32_dpp v97, v96, v96 row_ror:8 row_mask:0xf bank_mask:0xc
    s_nop 1
    v_add_f32_dpp v98, v97, v97 row_shr:4 row_mask:0xf bank_mask:0xa
    s_nop 1
    v_add_f32_dpp v99, v98, v98 quad_perm:[2,3,0,1] row_mask:0xf bank_mask:0xf
    s_waitcnt vmcnt(5)
    v_lshlrev_b32 v102, 16, v56
    v_and_b32 v103, 0xffff0000, v56
    v_mul_f32 v44, v102, v32
    v_mul_f32 v45, v103, v33
    v_lshlrev_b32 v102, 16, v62
    v_and_b32 v103, 0xffff0000, v62
    v_mul_f32 v88, v44, v102
    v_fmac_f32 v88, v45, v103
    v_lshlrev_b32 v102, 16, v57
    v_and_b32 v103, 0xffff0000, v57
    v_mul_f32 v46, v102, v34
    v_mul_f32 v47, v103, v35
    v_lshlrev_b32 v102, 16, v63
    v_and_b32 v103, 0xffff0000, v63
    v_fmac_f32 v88, v46, v102
    v_fmac_f32 v88, v47, v103
    v_lshlrev_b32 v102, 16, v58
    v_and_b32 v103, 0xffff0000, v58
    v_mul_f32 v48, v102, v36
    v_mul_f32 v49, v103, v37
    v_lshlrev_b32 v102, 16, v64
    v_and_b32 v103, 0xffff0000, v64
    v_fmac_f32 v88, v48, v102
    v_fmac_f32 v88, v49, v103
    v_lshlrev_b32 v102, 16, v59
    v_and_b32 v103, 0xffff0000, v59
    v_mul_f32 v50, v102, v38
    v_mul_f32 v51, v103, v39
    v_lshlrev_b32 v102, 16, v65
    v_and_b32 v103, 0xffff0000, v65
    v_fmac_f32 v88, v50, v102
    v_fmac_f32 v88, v51, v103
    v_lshlrev_b32 v102, 16, v60
    v_and_b32 v103, 0xffff0000, v60
    v_mul_f32 v52, v102, v40
    v_mul_f32 v53, v103, v41
    v_lshlrev_b32 v102, 16, v66
    v_and_b32 v103, 0xffff0000, v66
    v_fmac_f32 v88, v52, v102
    v_fmac_f32 v88, v53, v103
    v_lshlrev_b32 v102, 16, v61
    v_and_b32 v103, 0xffff0000, v61
    v_mul_f32 v54, v102, v42
    v_mul_f32 v55, v103, v43
    v_lshlrev_b32 v102, 16, v67
    v_and_b32 v103, 0xffff0000, v67
    v_fmac_f32 v88, v54, v102
    v_fmac_f32 v88, v55, v103
    s_waitcnt vmcnt(4)
    v_cvt_f32_i32 v24, v20
    v_cvt_f32_i32 v25, v21
    v_cvt_f32_i32 v26, v22
    v_cvt_f32_i32 v27, v23
    buffer_load_dwordx4 v[20:23], v1, s[24:27], s71 offen offset:512 nt
    v_fma_f32 v96, v44, v24, -v88
    v_fmac_f32 v96, v45, v25
    v_fmac_f32 v96, v46, v26
    v_fmac_f32 v96, v47, v27
    s_waitcnt vmcnt(4)
    v_cvt_f32_i32 v28, v4
    v_cvt_f32_i32 v29, v5
    v_cvt_f32_i32 v30, v6
    v_cvt_f32_i32 v31, v7
    s_add_u32 s71, s71, 3072
    buffer_load_dwordx4 v[4:7], v1, s[24:27], s71 offen offset:0 nt
    v_fmac_f32 v96, v48, v28
    v_fmac_f32 v96, v49, v29
    v_fmac_f32 v96, v50, v30
    v_fmac_f32 v96, v51, v31
    s_waitcnt vmcnt(4)
    v_cvt_f32_i32 v24, v8
    v_cvt_f32_i32 v25, v9
    v_cvt_f32_i32 v26, v10
    v_cvt_f32_i32 v27, v11
    buffer_load_dwordx4 v[8:11], v1, s[24:27], s71 offen offset:256 nt
    v_fmac_f32 v96, v52, v24
    v_fmac_f32 v96, v53, v25
    v_fmac_f32 v96, v54, v26
    v_fmac_f32 v96, v55, v27
    s_nop 1
    v_add_f32_dpp v97, v96, v96 row_ror:8 row_mask:0xf bank_mask:0x3
    s_waitcnt vmcnt(4)
    v_cvt_f32_i32 v28, v12
    v_cvt_f32_i32 v29, v13
    v_cvt_f32_i32 v30, v14
    v_cvt_f32_i32 v31, v15
    buffer_load_dwordx4 v[12:15], v1, s[24:27], s71 offen offset:512 nt
    v_fma_f32 v96, v44, v28, -v88
    v_fmac_f32 v96, v45, v29
    v_fmac_f32 v96, v46, v30
    v_fmac_f32 v96, v47, v31
    s_waitcnt vmcnt(4)
    v_cvt_f32_i32 v24, v16
    v_cvt_f32_i32 v25, v17
    v_cvt_f32_i32 v26, v18
    v_cvt_f32_i32 v27, v19
    s_add_u32 s71, s71, 3072
    buffer_load_dwordx4 v[16:19], v1, s[24:27], s71 offen offset:0 nt
    v_fmac_f32 v96, v48, v24
    v_fmac_f32 v96, v49, v25
    v_fmac_f32 v96, v50, v26
    v_fmac_f32 v96, v51, v27
    s_waitcnt vmcnt(4)
    v_cvt_f32_i32 v28, v20
    v_cvt_f32_i32 v29, v21
    v_cvt_f32_i32 v30, v22
    v_cvt_f32_i32 v31, v23
    buffer_load_dwordx4 v[20:23], v1, s[24:27], s71 offen offset:256 nt
    v_fmac_f32 v96, v52, v28
    v_fmac_f32 v96, v53, v29
    v_fmac_f32 v96, v54, v30
    v_fmac_f32 v96, v55, v31
    s_nop 1
    v_add_f32_dpp v97, v96, v96 row_ror:8 row_mask:0xf bank_mask:0xc
    s_nop 1
    v_add_f32_dpp v98, v97, v97 row_shl:4 row_mask:0xf bank_mask:0x5
    s_waitcnt vmcnt(4)
    v_cvt_f32_i32 v24, v4
    v_cvt_f32_i32 v25, v5
    v_cvt_f32_i32 v26, v6
    v_cvt_f32_i32 v27, v7
    buffer_load_dwordx4 v[4:7], v1, s[24:27], s71 offen offset:512 nt
    v_fma_f32 v96, v44, v24, -v88
    v_fmac_f32 v96, v45, v25
    v_fmac_f32 v96, v46, v26
    v_fmac_f32 v96, v47, v27
    s_waitcnt vmcnt(4)
    v_cvt_f32_i32 v28, v8
    v_cvt_f32_i32 v29, v9
    v_cvt_f32_i32 v30, v10
    v_cvt_f32_i32 v31, v11
    s_add_u32 s70, s70, 64
    s_sub_u32 s75, s75, 1
    s_cmp_eq_u32 s75, 0
    s_cselect_b32 s80, 1536, 0
    s_cselect_b32 s75, 2, s75
    s_add_u32 s70, s70, s80
    s_lshr_b32 s74, s70, 9
    s_mul_i32 s74, s74, 384
    buffer_load_dwordx2 v[68:69], v2, s[48:51], s74 offen offset:0
    buffer_load_dwordx2 v[70:71], v2, s[48:51], s74 offen offset:128
    buffer_load_dwordx2 v[72:73], v2, s[48:51], s74 offen offset:256
    s_mul_i32 s71, s70, 49152
    s_mul_i32 s72, s70, 384
    buffer_load_dwordx2 v[56:57], v2, s[32:35], s72 offen offset:0
    buffer_load_dwordx2 v[58:59], v2, s[32:35], s72 offen offset:128
    buffer_load_dwordx2 v[60:61], v2, s[32:35], s72 offen offset:256
    buffer_load_dwordx2 v[62:63], v2, s[36:39], s72 offen offset:0
    buffer_load_dwordx2 v[64:65], v2, s[36:39], s72 offen offset:128
    buffer_load_dwordx2 v[66:67], v2, s[36:39], s72 offen offset:256
    buffer_load_dwordx4 v[8:11], v1, s[24:27], s71 offen offset:0 nt
    v_fmac_f32 v96, v48, v28
    v_fmac_f32 v96, v49, v29
    v_fmac_f32 v96, v50, v30
    v_fmac_f32 v96, v51, v31
    s_waitcnt vmcnt(13)
    v_cvt_f32_i32 v24, v12
    v_cvt_f32_i32 v25, v13
    v_cvt_f32_i32 v26, v14
    v_cvt_f32_i32 v27, v15
    buffer_load_dwordx4 v[12:15], v1, s[24:27], s71 offen offset:256 nt
    v_fmac_f32 v96, v52, v24
    v_fmac_f32 v96, v53, v25
    v_fmac_f32 v96, v54, v26
    v_fmac_f32 v96, v55, v27
    s_nop 1
    v_add_f32_dpp v97, v96, v96 row_ror:8 row_mask:0xf bank_mask:0x3
    s_waitcnt vmcnt(13)
    v_cvt_f32_i32 v28, v16
    v_cvt_f32_i32 v29, v17
    v_cvt_f32_i32 v30, v18
    v_cvt_f32_i32 v31, v19
    buffer_load_dwordx4 v[16:19], v1, s[24:27], s71 offen offset:512 nt
    v_fma_f32 v96, v44, v28, -v88
    v_fmac_f32 v96, v45, v29
    v_fmac_f32 v96, v46, v30
    v_fmac_f32 v96, v47, v31
    s_waitcnt vmcnt(13)
    v_cvt_f32_i32 v24, v20
    v_cvt_f32_i32 v25, v21
    v_cvt_f32_i32 v26, v22
    v_cvt_f32_i32 v27, v23
    s_add_u32 s71, s71, 3072
    buffer_load_dwordx4 v[20:23], v1, s[24:27], s71 offen offset:0 nt
    v_fmac_f32 v96, v48, v24
    v_fmac_f32 v96, v49, v25
    v_fmac_f32 v96, v50, v26
    v_fmac_f32 v96, v51, v27
    s_waitcnt vmcnt(13)
    v_cvt_f32_i32 v28, v4
    v_cvt_f32_i32 v29, v5
    v_cvt_f32_i32 v30, v6
    v_cvt_f32_i32 v31, v7
    buffer_load_dwordx4 v[4:7], v1, s[24:27], s71 offen offset:256 nt
    v_fmac_f32 v96, v52, v28
    v_fmac_f32 v96, v53, v29
    v_fmac_f32 v96, v54, v30
    v_fmac_f32 v96, v55, v31
    s_nop 1
    v_add_f32_dpp v97, v96, v96 row_ror:8 row_mask:0xf bank_mask:0xc
    s_nop 1
    v_add_f32_dpp v98, v97, v97 row_shr:4 row_mask:0xf bank_mask:0xa
    s_nop 1
    v_add_f32_dpp v100, v98, v98 quad_perm:[2,3,0,1] row_mask:0xf bank_mask:0xf
    v_cndmask_b32 v100, v99, v100, s[64:65]
    s_nop 1
    v_add_f32_dpp v99, v100, v100 quad_perm:[1,0,3,2] row_mask:0xf bank_mask:0xf
    v_cndmask_b32 v101, v101, v99, s[66:67]
    ds_write_b32 v104, v101
    v_add_u32 v104, 256, v104
    s_waitcnt vmcnt(11)
    v_lshlrev_b32 v32, 16, v68
    v_and_b32 v33, 0xffff0000, v68
    v_lshlrev_b32 v34, 16, v69
    v_and_b32 v35, 0xffff0000, v69
    v_lshlrev_b32 v36, 16, v70
    v_and_b32 v37, 0xffff0000, v70
    v_lshlrev_b32 v38, 16, v71
    v_and_b32 v39, 0xffff0000, v71
    v_lshlrev_b32 v40, 16, v72
    v_and_b32 v41, 0xffff0000, v72
    v_lshlrev_b32 v42, 16, v73
    v_and_b32 v43, 0xffff0000, v73
    v_mul_f32 v32, s78, v32
    v_mul_f32 v33, s78, v33
    v_mul_f32 v34, s78, v34
    v_mul_f32 v35, s78, v35
    v_mul_f32 v36, s78, v36
    v_mul_f32 v37, s78, v37
    v_mul_f32 v38, s78, v38
    v_mul_f32 v39, s78, v39
    v_mul_f32 v40, s78, v40
    v_mul_f32 v41, s78, v41
    v_mul_f32 v42, s78, v42
    v_mul_f32 v43, s78, v43
    s_waitcnt vmcnt(5)
    v_lshlrev_b32 v102, 16, v56
    v_and_b32 v103, 0xffff0000, v56
    v_mul_f32 v44, v102, v32
    v_mul_f32 v45, v103, v33
    v_lshlrev_b32 v102, 16, v62
    v_and_b32 v103, 0xffff0000, v62
    v_mul_f32 v88, v44, v102
    v_fmac_f32 v88, v45, v103
    v_lshlrev_b32 v102, 16, v57
    v_and_b32 v103, 0xffff0000, v57
    v_mul_f32 v46, v102, v34
    v_mul_f32 v47, v103, v35
    v_lshlrev_b32 v102, 16, v63
    v_and_b32 v103, 0xffff0000, v63
    v_fmac_f32 v88, v46, v102
    v_fmac_f32 v88, v47, v103
    v_lshlrev_b32 v102, 16, v58
    v_and_b32 v103, 0xffff0000, v58
    v_mul_f32 v48, v102, v36
    v_mul_f32 v49, v103, v37
    v_lshlrev_b32 v102, 16, v64
    v_and_b32 v103, 0xffff0000, v64
    v_fmac_f32 v88, v48, v102
    v_fmac_f32 v88, v49, v103
    v_lshlrev_b32 v102, 16, v59
    v_and_b32 v103, 0xffff0000, v59
    v_mul_f32 v50, v102, v38
    v_mul_f32 v51, v103, v39
    v_lshlrev_b32 v102, 16, v65
    v_and_b32 v103, 0xffff0000, v65
    v_fmac_f32 v88, v50, v102
    v_fmac_f32 v88, v51, v103
    v_lshlrev_b32 v102, 16, v60
    v_and_b32 v103, 0xffff0000, v60
    v_mul_f32 v52, v102, v40
    v_mul_f32 v53, v103, v41
    v_lshlrev_b32 v102, 16, v66
    v_and_b32 v103, 0xffff0000, v66
    v_fmac_f32 v88, v52, v102
    v_fmac_f32 v88, v53, v103
    v_lshlrev_b32 v102, 16, v61
    v_and_b32 v103, 0xffff0000, v61
    v_mul_f32 v54, v102, v42
    v_mul_f32 v55, v103, v43
    v_lshlrev_b32 v102, 16, v67
    v_and_b32 v103, 0xffff0000, v67
    v_fmac_f32 v88, v54, v102
    v_fmac_f32 v88, v55, v103
    s_waitcnt vmcnt(4)
    v_cvt_f32_i32 v24, v8
    v_cvt_f32_i32 v25, v9
    v_cvt_f32_i32 v26, v10
    v_cvt_f32_i32 v27, v11
    buffer_load_dwordx4 v[8:11], v1, s[24:27], s71 offen offset:512 nt
    v_fma_f32 v96, v44, v24, -v88
    v_fmac_f32 v96, v45, v25
    v_fmac_f32 v96, v46, v26
    v_fmac_f32 v96, v47, v27
    s_waitcnt vmcnt(4)
    v_cvt_f32_i32 v28, v12
    v_cvt_f32_i32 v29, v13
    v_cvt_f32_i32 v30, v14
    v_cvt_f32_i32 v31, v15
    s_add_u32 s71, s71, 3072
    buffer_load_dwordx4 v[12:15], v1, s[24:27], s71 offen offset:0 nt
    v_fmac_f32 v96, v48, v28
    v_fmac_f32 v96, v49, v29
    v_fmac_f32 v96, v50, v30
    v_fmac_f32 v96, v51, v31
    s_waitcnt vmcnt(4)
    v_cvt_f32_i32 v24, v16
    v_cvt_f32_i32 v25, v17
    v_cvt_f32_i32 v26, v18
    v_cvt_f32_i32 v27, v19
    buffer_load_dwordx4 v[16:19], v1, s[24:27], s71 offen offset:256 nt
    v_fmac_f32 v96, v52, v24
    v_fmac_f32 v96, v53, v25
    v_fmac_f32 v96, v54, v26
    v_fmac_f32 v96, v55, v27
    s_nop 1
    v_add_f32_dpp v97, v96, v96 row_ror:8 row_mask:0xf bank_mask:0x3
    s_waitcnt vmcnt(4)
    v_cvt_f32_i32 v28, v20
    v_cvt_f32_i32 v29, v21
    v_cvt_f32_i32 v30, v22
    v_cvt_f32_i32 v31, v23
    buffer_load_dwordx4 v[20:23], v1, s[24:27], s71 offen offset:512 nt
    v_fma_f32 v96, v44, v28, -v88
    v_fmac_f32 v96, v45, v29
    v_fmac_f32 v96, v46, v30
    v_fmac_f32 v96, v47, v31
    s_waitcnt vmcnt(4)
    v_cvt_f32_i32 v24, v4
    v_cvt_f32_i32 v25, v5
    v_cvt_f32_i32 v26, v6
    v_cvt_f32_i32 v27, v7
    s_add_u32 s71, s71, 3072
    buffer_load_dwordx4 v[4:7], v1, s[24:27], s71 offen offset:0 nt
    v_fmac_f32 v96, v48, v24
    v_fmac_f32 v96, v49, v25
    v_fmac_f32 v96, v50, v26
    v_fmac_f32 v96, v51, v27
    s_waitcnt vmcnt(4)
    v_cvt_f32_i32 v28, v8
    v_cvt_f32_i32 v29, v9
    v_cvt_f32_i32 v30, v10
    v_cvt_f32_i32 v31, v11
    buffer_load_dwordx4 v[8:11], v1, s[24:27], s71 offen offset:256 nt
    v_fmac_f32 v96, v52, v28
    v_fmac_f32 v96, v53, v29
    v_fmac_f32 v96, v54, v30
    v_fmac_f32 v96, v55, v31
    s_nop 1
    v_add_f32_dpp v97, v96, v96 row_ror:8 row_mask:0xf bank_mask:0xc
    s_nop 1
    v_add_f32_dpp v98, v97, v97 row_shl:4 row_mask:0xf bank_mask:0x5
    s_waitcnt vmcnt(4)
    v_cvt_f32_i32 v24, v12
    v_cvt_f32_i32 v25, v13
    v_cvt_f32_i32 v26, v14
    v_cvt_f32_i32 v27, v15
    buffer_load_dwordx4 v[12:15], v1, s[24:27], s71 offen offset:512 nt
    v_fma_f32 v96, v44, v24, -v88
    v_fmac_f32 v96, v45, v25
    v_fmac_f32 v96, v46, v26
    v_fmac_f32 v96, v47, v27
    s_waitcnt vmcnt(4)
    v_cvt_f32_i32 v28, v16
    v_cvt_f32_i32 v29, v17
    v_cvt_f32_i32 v30, v18
    v_cvt_f32_i32 v31, v19
    s_add_u32 s70, s70, 64
    s_mul_i32 s71, s70, 49152
    s_mul_i32 s72, s70, 384
    buffer_load_dwordx2 v[56:57], v2, s[32:35], s72 offen offset:0
    buffer_load_dwordx2 v[58:59], v2, s[32:35], s72 offen offset:128
    buffer_load_dwordx2 v[60:61], v2, s[32:35], s72 offen offset:256
    buffer_load_dwordx2 v[62:63], v2, s[36:39], s72 offen offset:0
    buffer_load_dwordx2 v[64:65], v2, s[36:39], s72 offen offset:128
    buffer_load_dwordx2 v[66:67], v2, s[36:39], s72 offen offset:256
    buffer_load_dwordx4 v[16:19], v1, s[24:27], s71 offen offset:0 nt
    v_fmac_f32 v96, v48, v28
    v_fmac_f32 v96, v49, v29
    v_fmac_f32 v96, v50, v30
    v_fmac_f32 v96, v51, v31
    s_waitcnt vmcnt(10)
    v_cvt_f32_i32 v24, v20
    v_cvt_f32_i32 v25, v21
    v_cvt_f32_i32 v26, v22
    v_cvt_f32_i32 v27, v23
    buffer_load_dwordx4 v[20:23], v1, s[24:27], s71 offen offset:256 nt
    v_fmac_f32 v96, v52, v24
    v_fmac_f32 v96, v53, v25
    v_fmac_f32 v96, v54, v26
    v_fmac_f32 v96, v55, v27
    s_nop 1
    v_add_f32_dpp v97, v96, v96 row_ror:8 row_mask:0xf bank_mask:0x3
    s_waitcnt vmcnt(10)
    v_cvt_f32_i32 v28, v4
    v_cvt_f32_i32 v29, v5
    v_cvt_f32_i32 v30, v6
    v_cvt_f32_i32 v31, v7
    buffer_load_dwordx4 v[4:7], v1, s[24:27], s71 offen offset:512 nt
    v_fma_f32 v96, v44, v28, -v88
    v_fmac_f32 v96, v45, v29
    v_fmac_f32 v96, v46, v30
    v_fmac_f32 v96, v47, v31
    s_waitcnt vmcnt(10)
    v_cvt_f32_i32 v24, v8
    v_cvt_f32_i32 v25, v9
    v_cvt_f32_i32 v26, v10
    v_cvt_f32_i32 v27, v11
    s_add_u32 s71, s71, 3072
    buffer_load_dwordx4 v[8:11], v1, s[24:27], s71 offen offset:0 nt
    v_fmac_f32 v96, v48, v24
    v_fmac_f32 v96, v49, v25
    v_fmac_f32 v96, v50, v26
    v_fmac_f32 v96, v51, v27
    s_waitcnt vmcnt(10)
    v_cvt_f32_i32 v28, v12
    v_cvt_f32_i32 v29, v13
    v_cvt_f32_i32 v30, v14
    v_cvt_f32_i32 v31, v15
    buffer_load_dwordx4 v[12:15], v1, s[24:27], s71 offen offset:256 nt
    v_fmac_f32 v96, v52, v28
    v_fmac_f32 v96, v53, v29
    v_fmac_f32 v96, v54, v30
    v_fmac_f32 v96, v55, v31
    s_nop 1
    v_add_f32_dpp v97, v96, v96 row_ror:8 row_mask:0xf bank_mask:0xc
    s_nop 1
    v_add_f32_dpp v98, v97, v97 row_shr:4 row_mask:0xf bank_mask:0xa
    s_nop 1
    v_add_f32_dpp v99, v98, v98 quad_perm:[2,3,0,1] row_mask:0xf bank_mask:0xf
    s_waitcnt vmcnt(5)
    v_lshlrev_b32 v102, 16, v56
    v_and_b32 v103, 0xffff0000, v56
    v_mul_f32 v44, v102, v32
    v_mul_f32 v45, v103, v33
    v_lshlrev_b32 v102, 16, v62
    v_and_b32 v103, 0xffff0000, v62
    v_mul_f32 v88, v44, v102
    v_fmac_f32 v88, v45, v103
    v_lshlrev_b32 v102, 16, v57
    v_and_b32 v103, 0xffff0000, v57
    v_mul_f32 v46, v102, v34
    v_mul_f32 v47, v103, v35
    v_lshlrev_b32 v102, 16, v63
    v_and_b32 v103, 0xffff0000, v63
    v_fmac_f32 v88, v46, v102
    v_fmac_f32 v88, v47, v103
    v_lshlrev_b32 v102, 16, v58
    v_and_b32 v103, 0xffff0000, v58
    v_mul_f32 v48, v102, v36
    v_mul_f32 v49, v103, v37
    v_lshlrev_b32 v102, 16, v64
    v_and_b32 v103, 0xffff0000, v64
    v_fmac_f32 v88, v48, v102
    v_fmac_f32 v88, v49, v103
    v_lshlrev_b32 v102, 16, v59
    v_and_b32 v103, 0xffff0000, v59
    v_mul_f32 v50, v102, v38
    v_mul_f32 v51, v103, v39
    v_lshlrev_b32 v102, 16, v65
    v_and_b32 v103, 0xffff0000, v65
    v_fmac_f32 v88, v50, v102
    v_fmac_f32 v88, v51, v103
    v_lshlrev_b32 v102, 16, v60
    v_and_b32 v103, 0xffff0000, v60
    v_mul_f32 v52, v102, v40
    v_mul_f32 v53, v103, v41
    v_lshlrev_b32 v102, 16, v66
    v_and_b32 v103, 0xffff0000, v66
    v_fmac_f32 v88, v52, v102
    v_fmac_f32 v88, v53, v103
    v_lshlrev_b32 v102, 16, v61
    v_and_b32 v103, 0xffff0000, v61
    v_mul_f32 v54, v102, v42
    v_mul_f32 v55, v103, v43
    v_lshlrev_b32 v102, 16, v67
    v_and_b32 v103, 0xffff0000, v67
    v_fmac_f32 v88, v54, v102
    v_fmac_f32 v88, v55, v103
    s_waitcnt vmcnt(4)
    v_cvt_f32_i32 v24, v16
    v_cvt_f32_i32 v25, v17
    v_cvt_f32_i32 v26, v18
    v_cvt_f32_i32 v27, v19
    buffer_load_dwordx4 v[16:19], v1, s[24:27], s71 offen offset:512 nt
    v_fma_f32 v96, v44, v24, -v88
    v_fmac_f32 v96, v45, v25
    v_fmac_f32 v96, v46, v26
    v_fmac_f32 v96, v47, v27
    s_waitcnt vmcnt(4)
    v_cvt_f32_i32 v28, v20
    v_cvt_f32_i32 v29, v21
    v_cvt_f32_i32 v30, v22
    v_cvt_f32_i32 v31, v23
    s_add_u32 s71, s71, 3072
    buffer_load_dwordx4 v[20:23], v1, s[24:27], s71 offen offset:0 nt
    v_fmac_f32 v96, v48, v28
    v_fmac_f32 v96, v49, v29
    v_fmac_f32 v96, v50, v30
    v_fmac_f32 v96, v51, v31
    s_waitcnt vmcnt(4)
    v_cvt_f32_i32 v24, v4
    v_cvt_f32_i32 v25, v5
    v_cvt_f32_i32 v26, v6
    v_cvt_f32_i32 v27, v7
    buffer_load_dwordx4 v[4:7], v1, s[24:27], s71 offen offset:256 nt
    v_fmac_f32 v96, v52, v24
    v_fmac_f32 v96, v53, v25
    v_fmac_f32 v96, v54, v26
    v_fmac_f32 v96, v55, v27
    s_nop 1
    v_add_f32_dpp v97, v96, v96 row_ror:8 row_mask:0xf bank_mask:0x3
    s_waitcnt vmcnt(4)
    v_cvt_f32_i32 v28, v8
    v_cvt_f32_i32 v29, v9
    v_cvt_f32_i32 v30, v10
    v_cvt_f32_i32 v31, v11
    buffer_load_dwordx4 v[8:11], v1, s[24:27], s71 offen offset:512 nt
    v_fma_f32 v96, v44, v28, -v88
    v_fmac_f32 v96, v45, v29
    v_fmac_f32 v96, v46, v30
    v_fmac_f32 v96, v47, v31
    s_waitcnt vmcnt(4)
    v_cvt_f32_i32 v24, v12
    v_cvt_f32_i32 v25, v13
    v_cvt_f32_i32 v26, v14
    v_cvt_f32_i32 v27, v15
    s_add_u32 s71, s71, 3072
    buffer_load_dwordx4 v[12:15], v1, s[24:27], s71 offen offset:0 nt
    v_fmac_f32 v96, v48, v24
    v_fmac_f32 v96, v49, v25
    v_fmac_f32 v96, v50, v26
    v_fmac_f32 v96, v51, v27
    s_waitcnt vmcnt(4)
    v_cvt_f32_i32 v28, v16
    v_cvt_f32_i32 v29, v17
    v_cvt_f32_i32 v30, v18
    v_cvt_f32_i32 v31, v19
    buffer_load_dwordx4 v[16:19], v1, s[24:27], s71 offen offset:256 nt
    v_fmac_f32 v96, v52, v28
    v_fmac_f32 v96, v53, v29
    v_fmac_f32 v96, v54, v30
    v_fmac_f32 v96, v55, v31
    s_nop 1
    v_add_f32_dpp v97, v96, v96 row_ror:8 row_mask:0xf bank_mask:0xc
    s_nop 1
    v_add_f32_dpp v98, v97, v97 row_shl:4 row_mask:0xf bank_mask:0x5
    s_waitcnt vmcnt(4)
    v_cvt_f32_i32 v24, v20
    v_cvt_f32_i32 v25, v21
    v_cvt_f32_i32 v26, v22
    v_cvt_f32_i32 v27, v23
    buffer_load_dwordx4 v[20:23], v1, s[24:27], s71 offen offset:512 nt
    v_fma_f32 v96, v44, v24, -v88
    v_fmac_f32 v96, v45, v25
    v_fmac_f32 v96, v46, v26
    v_fmac_f32 v96, v47, v27
    s_waitcnt vmcnt(4)
    v_cvt_f32_i32 v28, v4
    v_cvt_f32_i32 v29, v5
    v_cvt_f32_i32 v30, v6
    v_cvt_f32_i32 v31, v7
    s_add_u32 s70, s70, 64
    s_mul_i32 s71, s70, 49152
    s_mul_i32 s72, s70, 384
    buffer_load_dwordx2 v[56:57], v2, s[32:35], s72 offen offset:0
    buffer_load_dwordx2 v[58:59], v2, s[32:35], s72 offen offset:128
    buffer_load_dwordx2 v[60:61], v2, s[32:35], s72 offen offset:256
    buffer_load_dwordx2 v[62:63], v2, s[36:39], s72 offen offset:0
    buffer_load_dwordx2 v[64:65], v2, s[36:39], s72 offen offset:128
    buffer_load_dwordx2 v[66:67], v2, s[36:39], s72 offen offset:256
    buffer_load_dwordx4 v[4:7], v1, s[24:27], s71 offen offset:0 nt
    v_fmac_f32 v96, v48, v28
    v_fmac_f32 v96, v49, v29
    v_fmac_f32 v96, v50, v30
    v_fmac_f32 v96, v51, v31
    s_waitcnt vmcnt(10)
    v_cvt_f32_i32 v24, v8
    v_cvt_f32_i32 v25, v9
    v_cvt_f32_i32 v26, v10
    v_cvt_f32_i32 v27, v11
    buffer_load_dwordx4 v[8:11], v1, s[24:27], s71 offen offset:256 nt
    v_fmac_f32 v96, v52, v24
    v_fmac_f32 v96, v53, v25
    v_fmac_f32 v96, v54, v26
    v_fmac_f32 v96, v55, v27
    s_nop 1
    v_add_f32_dpp v97, v96, v96 row_ror:8 row_mask:0xf bank_mask:0x3
    s_waitcnt vmcnt(10)
    v_cvt_f32_i32 v28, v12
    v_cvt_f32_i32 v29, v13
    v_cvt_f32_i32 v30, v14
    v_cvt_f32_i32 v31, v15
    buffer_load_dwordx4 v[12:15], v1, s[24:27], s71 offen offset:512 nt
    v_fma_f32 v96, v44, v28, -v88
    v_fmac_f32 v96, v45, v29
    v_fmac_f32 v96, v46, v30
    v_fmac_f32 v96, v47, v31
    s_waitcnt vmcnt(10)
    v_cvt_f32_i32 v24, v16
    v_cvt_f32_i32 v25, v17
    v_cvt_f32_i32 v26, v18
    v_cvt_f32_i32 v27, v19
    s_add_u32 s71, s71, 3072
    buffer_load_dwordx4 v[16:19], v1, s[24:27], s71 offen offset:0 nt
    v_fmac_f32 v96, v48, v24
    v_fmac_f32 v96, v49, v25
    v_fmac_f32 v96, v50, v26
    v_fmac_f32 v96, v51, v27
    s_waitcnt vmcnt(10)
    v_cvt_f32_i32 v28, v20
    v_cvt_f32_i32 v29, v21
    v_cvt_f32_i32 v30, v22
    v_cvt_f32_i32 v31, v23
    buffer_load_dwordx4 v[20:23], v1, s[24:27], s71 offen offset:256 nt
    v_fmac_f32 v96, v52, v28
    v_fmac_f32 v96, v53, v29
    v_fmac_f32 v96, v54, v30
    v_fmac_f32 v96, v55, v31
    s_nop 1
    v_add_f32_dpp v97, v96, v96 row_ror:8 row_mask:0xf bank_mask:0xc
    s_nop 1
    v_add_f32_dpp v98, v97, v97 row_shr:4 row_mask:0xf bank_mask:0xa
    s_nop 1
    v_add_f32_dpp v100, v98, v98 quad_perm:[2,3,0,1] row_mask:0xf bank_mask:0xf
    v_cndmask_b32 v100, v99, v100, s[64:65]
    s_nop 1
    v_add_f32_dpp v101, v100, v100 quad_perm:[1,0,3,2] row_mask:0xf bank_mask:0xf
    s_waitcnt vmcnt(5)
    v_lshlrev_b32 v102, 16, v56
    v_and_b32 v103, 0xffff0000, v56
    v_mul_f32 v44, v102, v32
    v_mul_f32 v45, v103, v33
    v_lshlrev_b32 v102, 16, v62
    v_and_b32 v103, 0xffff0000, v62
    v_mul_f32 v88, v44, v102
    v_fmac_f32 v88, v45, v103
    v_lshlrev_b32 v102, 16, v57
    v_and_b32 v103, 0xffff0000, v57
    v_mul_f32 v46, v102, v34
    v_mul_f32 v47, v103, v35
    v_lshlrev_b32 v102, 16, v63
    v_and_b32 v103, 0xffff0000, v63
    v_fmac_f32 v88, v46, v102
    v_fmac_f32 v88, v47, v103
    v_lshlrev_b32 v102, 16, v58
    v_and_b32 v103, 0xffff0000, v58
    v_mul_f32 v48, v102, v36
    v_mul_f32 v49, v103, v37
    v_lshlrev_b32 v102, 16, v64
    v_and_b32 v103, 0xffff0000, v64
    v_fmac_f32 v88, v48, v102
    v_fmac_f32 v88, v49, v103
    v_lshlrev_b32 v102, 16, v59
    v_and_b32 v103, 0xffff0000, v59
    v_mul_f32 v50, v102, v38
    v_mul_f32 v51, v103, v39
    v_lshlrev_b32 v102, 16, v65
    v_and_b32 v103, 0xffff0000, v65
    v_fmac_f32 v88, v50, v102
    v_fmac_f32 v88, v51, v103
    v_lshlrev_b32 v102, 16, v60
    v_and_b32 v103, 0xffff0000, v60
    v_mul_f32 v52, v102, v40
    v_mul_f32 v53, v103, v41
    v_lshlrev_b32 v102, 16, v66
    v_and_b32 v103, 0xffff0000, v66
    v_fmac_f32 v88, v52, v102
    v_fmac_f32 v88, v53, v103
    v_lshlrev_b32 v102, 16, v61
    v_and_b32 v103, 0xffff0000, v61
    v_mul_f32 v54, v102, v42
    v_mul_f32 v55, v103, v43
    v_lshlrev_b32 v102, 16, v67
    v_and_b32 v103, 0xffff0000, v67
    v_fmac_f32 v88, v54, v102
    v_fmac_f32 v88, v55, v103
    s_waitcnt vmcnt(4)
    v_cvt_f32_i32 v24, v4
    v_cvt_f32_i32 v25, v5
    v_cvt_f32_i32 v26, v6
    v_cvt_f32_i32 v27, v7
    buffer_load_dwordx4 v[4:7], v1, s[24:27], s71 offen offset:512 nt
    v_fma_f32 v96, v44, v24, -v88
    v_fmac_f32 v96, v45, v25
    v_fmac_f32 v96, v46, v26
    v_fmac_f32 v96, v47, v27
    s_waitcnt vmcnt(4)
    v_cvt_f32_i32 v28, v8
    v_cvt_f32_i32 v29, v9
    v_cvt_f32_i32 v30, v10
    v_cvt_f32_i32 v31, v11
    s_add_u32 s71, s71, 3072
    buffer_load_dwordx4 v[8:11], v1, s[24:27], s71 offen offset:0 nt
    v_fmac_f32 v96, v48, v28
    v_fmac_f32 v96, v49, v29
    v_fmac_f32 v96, v50, v30
    v_fmac_f32 v96, v51, v31
    s_waitcnt vmcnt(4)
    v_cvt_f32_i32 v24, v12
    v_cvt_f32_i32 v25, v13
    v_cvt_f32_i32 v26, v14
    v_cvt_f32_i32 v27, v15
    buffer_load_dwordx4 v[12:15], v1, s[24:27], s71 offen offset:256 nt
    v_fmac_f32 v96, v52, v24
    v_fmac_f32 v96, v53, v25
    v_fmac_f32 v96, v54, v26
    v_fmac_f32 v96, v55, v27
    s_nop 1
    v_add_f32_dpp v97, v96, v96 row_ror:8 row_mask:0xf bank_mask:0x3
    s_waitcnt vmcnt(4)
    v_cvt_f32_i32 v28, v16
    v_cvt_f32_i32 v29, v17
    v_cvt_f32_i32 v30, v18
    v_cvt_f32_i32 v31, v19
    buffer_load_dwordx4 v[16:19], v1, s[24:27], s71 offen offset:512 nt
    v_fma_f32 v96, v44, v28, -v88
    v_fmac_f32 v96, v45, v29
    v_fmac_f32 v96, v46, v30
    v_fmac_f32 v96, v47, v31
    s_waitcnt vmcnt(4)
    v_cvt_f32_i32 v24, v20
    v_cvt_f32_i32 v25, v21
    v_cvt_f32_i32 v26, v22
    v_cvt_f32_i32 v27, v23
    s_add_u32 s71, s71, 3072
    buffer_load_dwordx4 v[20:23], v1, s[24:27], s71 offen offset:0 nt
    v_fmac_f32 v96, v48, v24
    v_fmac_f32 v96, v49, v25
    v_fmac_f32 v96, v50, v26
    v_fmac_f32 v96, v51, v27
    s_waitcnt vmcnt(4)
    v_cvt_f32_i32 v28, v4
    v_cvt_f32_i32 v29, v5
    v_cvt_f32_i32 v30, v6
    v_cvt_f32_i32 v31, v7
    buffer_load_dwordx4 v[4:7], v1, s[24:27], s71 offen offset:256 nt
    v_fmac_f32 v96, v52, v28
    v_fmac_f32 v96, v53, v29
    v_fmac_f32 v96, v54, v30
    v_fmac_f32 v96, v55, v31
    s_nop 1
    v_add_f32_dpp v97, v96, v96 row_ror:8 row_mask:0xf bank_mask:0xc
    s_nop 1
    v_add_f32_dpp v98, v97, v97 row_shl:4 row_mask:0xf bank_mask:0x5
    s_waitcnt vmcnt(4)
    v_cvt_f32_i32 v24, v8
    v_cvt_f32_i32 v25, v9
    v_cvt_f32_i32 v26, v10
    v_cvt_f32_i32 v27, v11
    buffer_load_dwordx4 v[8:11], v1, s[24:27], s71 offen offset:512 nt
    v_fma_f32 v96, v44, v24, -v88
    v_fmac_f32 v96, v45, v25
    v_fmac_f32 v96, v46, v26
    v_fmac_f32 v96, v47, v27
    s_waitcnt vmcnt(4)
    v_cvt_f32_i32 v28, v12
    v_cvt_f32_i32 v29, v13
    v_cvt_f32_i32 v30, v14
    v_cvt_f32_i32 v31, v15
    s_add_u32 s70, s70, 64
    s_mul_i32 s71, s70, 49152
    s_mul_i32 s72, s70, 384
    buffer_load_dwordx2 v[56:57], v2, s[32:35], s72 offen offset:0
    buffer_load_dwordx2 v[58:59], v2, s[32:35], s72 offen offset:128
    buffer_load_dwordx2 v[60:61], v2, s[32:35], s72 offen offset:256
    buffer_load_dwordx2 v[62:63], v2, s[36:39], s72 offen offset:0
    buffer_load_dwordx2 v[64:65], v2, s[36:39], s72 offen offset:128
    buffer_load_dwordx2 v[66:67], v2, s[36:39], s72 offen offset:256
    buffer_load_dwordx4 v[12:15], v1, s[24:27], s71 offen offset:0 nt
    v_fmac_f32 v96, v48, v28
    v_fmac_f32 v96, v49, v29
    v_fmac_f32 v96, v50, v30
    v_fmac_f32 v96, v51, v31
    s_waitcnt vmcnt(10)
    v_cvt_f32_i32 v24, v16
    v_cvt_f32_i32 v25, v17
    v_cvt_f32_i32 v26, v18
    v_cvt_f32_i32 v27, v19
    buffer_load_dwordx4 v[16:19], v1, s[24:27], s71 offen offset:256 nt
    v_fmac_f32 v96, v52, v24
    v_fmac_f32 v96, v53, v25
    v_fmac_f32 v96, v54, v26
    v_fmac_f32 v96, v55, v27
    s_nop 1
    v_add_f32_dpp v97, v96, v96 row_ror:8 row_mask:0xf bank_mask:0x3
    s_waitcnt vmcnt(10)
    v_cvt_f32_i32 v28, v20
    v_cvt_f32_i32 v29, v21
    v_cvt_f32_i32 v30, v22
    v_cvt_f32_i32 v31, v23
    buffer_load_dwordx4 v[20:23], v1, s[24:27], s71 offen offset:512 nt
    v_fma_f32 v96, v44, v28, -v88
    v_fmac_f32 v96, v45, v29
    v_fmac_f32 v96, v46, v30
    v_fmac_f32 v96, v47, v31
    s_waitcnt vmcnt(10)
    v_cvt_f32_i32 v24, v4
    v_cvt_f32_i32 v25, v5
    v_cvt_f32_i32 v26, v6
    v_cvt_f32_i32 v27, v7
    s_add_u32 s71, s71, 3072
    buffer_load_dwordx4 v[4:7], v1, s[24:27], s71 offen offset:0 nt
    v_fmac_f32 v96, v48, v24
    v_fmac_f32 v96, v49, v25
    v_fmac_f32 v96, v50, v26
    v_fmac_f32 v96, v51, v27
    s_waitcnt vmcnt(10)
    v_cvt_f32_i32 v28, v8
    v_cvt_f32_i32 v29, v9
    v_cvt_f32_i32 v30, v10
    v_cvt_f32_i32 v31, v11
    buffer_load_dwordx4 v[8:11], v1, s[24:27], s71 offen offset:256 nt
    v_fmac_f32 v96, v52, v28
    v_fmac_f32 v96, v53, v29
    v_fmac_f32 v96, v54, v30
    v_fmac_f32 v96, v55, v31
    s_nop 1
    v_add_f32_dpp v97, v96, v96 row_ror:8 row_mask:0xf bank_mask:0xc
    s_nop 1
    v_add_f32_dpp v98, v97, v97 row_shr:4 row_mask:0xf bank_mask:0xa
    s_nop 1
    v_add_f32_dpp v99, v98, v98 quad_perm:[2,3,0,1] row_mask:0xf bank_mask:0xf
    s_waitcnt vmcnt(5)
    v_lshlrev_b32 v102, 16, v56
    v_and_b32 v103, 0xffff0000, v56
    v_mul_f32 v44, v102, v32
    v_mul_f32 v45, v103, v33
    v_lshlrev_b32 v102, 16, v62
    v_and_b32 v103, 0xffff0000, v62
    v_mul_f32 v88, v44, v102
    v_fmac_f32 v88, v45, v103
    v_lshlrev_b32 v102, 16, v57
    v_and_b32 v103, 0xffff0000, v57
    v_mul_f32 v46, v102, v34
    v_mul_f32 v47, v103, v35
    v_lshlrev_b32 v102, 16, v63
    v_and_b32 v103, 0xffff0000, v63
    v_fmac_f32 v88, v46, v102
    v_fmac_f32 v88, v47, v103
    v_lshlrev_b32 v102, 16, v58
    v_and_b32 v103, 0xffff0000, v58
    v_mul_f32 v48, v102, v36
    v_mul_f32 v49, v103, v37
    v_lshlrev_b32 v102, 16, v64
    v_and_b32 v103, 0xffff0000, v64
    v_fmac_f32 v88, v48, v102
    v_fmac_f32 v88, v49, v103
    v_lshlrev_b32 v102, 16, v59
    v_and_b32 v103, 0xffff0000, v59
    v_mul_f32 v50, v102, v38
    v_mul_f32 v51, v103, v39
    v_lshlrev_b32 v102, 16, v65
    v_and_b32 v103, 0xffff0000, v65
    v_fmac_f32 v88, v50, v102
    v_fmac_f32 v88, v51, v103
    v_lshlrev_b32 v102, 16, v60
    v_and_b32 v103, 0xffff0000, v60
    v_mul_f32 v52, v102, v40
    v_mul_f32 v53, v103, v41
    v_lshlrev_b32 v102, 16, v66
    v_and_b32 v103, 0xffff0000, v66
    v_fmac_f32 v88, v52, v102
    v_fmac_f32 v88, v53, v103
    v_lshlrev_b32 v102, 16, v61
    v_and_b32 v103, 0xffff0000, v61
    v_mul_f32 v54, v102, v42
    v_mul_f32 v55, v103, v43
    v_lshlrev_b32 v102, 16, v67
    v_and_b32 v103, 0xffff0000, v67
    v_fmac_f32 v88, v54, v102
    v_fmac_f32 v88, v55, v103
    s_waitcnt vmcnt(4)
    v_cvt_f32_i32 v24, v12
    v_cvt_f32_i32 v25, v13
    v_cvt_f32_i32 v26, v14
    v_cvt_f32_i32 v27, v15
    buffer_load_dwordx4 v[12:15], v1, s[24:27], s71 offen offset:512 nt
    v_fma_f32 v96, v44, v24, -v88
    v_fmac_f32 v96, v45, v25
    v_fmac_f32 v96, v46, v26
    v_fmac_f32 v96, v47, v27
    s_waitcnt vmcnt(4)
    v_cvt_f32_i32 v28, v16
    v_cvt_f32_i32 v29, v17
    v_cvt_f32_i32 v30, v18
    v_cvt_f32_i32 v31, v19
    s_add_u32 s71, s71, 3072
    buffer_load_dwordx4 v[16:19], v1, s[24:27], s71 offen offset:0 nt
    v_fmac_f32 v96, v48, v28
    v_fmac_f32 v96, v49, v29
    v_fmac_f32 v96, v50, v30
    v_fmac_f32 v96, v51, v31
    s_waitcnt vmcnt(4)
    v_cvt_f32_i32 v24, v20
    v_cvt_f32_i32 v25, v21
    v_cvt_f32_i32 v26, v22
    v_cvt_f32_i32 v27, v23
    buffer_load_dwordx4 v[20:23], v1, s[24:27], s71 offen offset:256 nt
    v_fmac_f32 v96, v52, v24
    v_fmac_f32 v96, v53, v25
    v_fmac_f32 v96, v54, v26
    v_fmac_f32 v96, v55, v27
    s_nop 1
    v_add_f32_dpp v97, v96, v96 row_ror:8 row_mask:0xf bank_mask:0x3
    s_waitcnt vmcnt(4)
    v_cvt_f32_i32 v28, v4
    v_cvt_f32_i32 v29, v5
    v_cvt_f32_i32 v30, v6
    v_cvt_f32_i32 v31, v7
    buffer_load_dwordx4 v[4:7], v1, s[24:27], s71 offen offset:512 nt
    v_fma_f32 v96, v44, v28, -v88
    v_fmac_f32 v96, v45, v29
    v_fmac_f32 v96, v46, v30
    v_fmac_f32 v96, v47, v31
    s_waitcnt vmcnt(4)
    v_cvt_f32_i32 v24, v8
    v_cvt_f32_i32 v25, v9
    v_cvt_f32_i32 v26, v10
    v_cvt_f32_i32 v27, v11
    s_add_u32 s71, s71, 3072
    buffer_load_dwordx4 v[8:11], v1, s[24:27], s71 offen offset:0 nt
    v_fmac_f32 v96, v48, v24
    v_fmac_f32 v96, v49, v25
    v_fmac_f32 v96, v50, v26
    v_fmac_f32 v96, v51, v27
    s_waitcnt vmcnt(4)
    v_cvt_f32_i32 v28, v12
    v_cvt_f32_i32 v29, v13
    v_cvt_f32_i32 v30, v14
    v_cvt_f32_i32 v31, v15
    buffer_load_dwordx4 v[12:15], v1, s[24:27], s71 offen offset:256 nt
    v_fmac_f32 v96, v52, v28
    v_fmac_f32 v96, v53, v29
    v_fmac_f32 v96, v54, v30
    v_fmac_f32 v96, v55, v31
    s_nop 1
    v_add_f32_dpp v97, v96, v96 row_ror:8 row_mask:0xf bank_mask:0xc
    s_nop 1
    v_add_f32_dpp v98, v97, v97 row_shl:4 row_mask:0xf bank_mask:0x5
    s_waitcnt vmcnt(4)
    v_cvt_f32_i32 v24, v16
    v_cvt_f32_i32 v25, v17
    v_cvt_f32_i32 v26, v18
    v_cvt_f32_i32 v27, v19
    buffer_load_dwordx4 v[16:19], v1, s[24:27], s71 offen offset:512 nt
    v_fma_f32 v96, v44, v24, -v88
    v_fmac_f32 v96, v45, v25
    v_fmac_f32 v96, v46, v26
    v_fmac_f32 v96, v47, v27
    s_waitcnt vmcnt(4)
    v_cvt_f32_i32 v28, v20
    v_cvt_f32_i32 v29, v21
    v_cvt_f32_i32 v30, v22
    v_cvt_f32_i32 v31, v23
    s_add_u32 s70, s70, 64
    s_sub_u32 s75, s75, 1
    s_cmp_eq_u32 s75, 0
    s_cselect_b32 s80, 1536, 0
    s_cselect_b32 s75, 2, s75
    s_add_u32 s70, s70, s80
    s_lshr_b32 s74, s70, 9
    s_mul_i32 s74, s74, 384
    buffer_load_dwordx2 v[68:69], v2, s[48:51], s74 offen offset:0
    buffer_load_dwordx2 v[70:71], v2, s[48:51], s74 offen offset:128
    buffer_load_dwordx2 v[72:73], v2, s[48:51], s74 offen offset:256
    s_mul_i32 s71, s70, 49152
    s_mul_i32 s72, s70, 384
    buffer_load_dwordx2 v[56:57], v2, s[32:35], s72 offen offset:0
    buffer_load_dwordx2 v[58:59], v2, s[32:35], s72 offen offset:128
    buffer_load_dwordx2 v[60:61], v2, s[32:35], s72 offen offset:256
    buffer_load_dwordx2 v[62:63], v2, s[36:39], s72 offen offset:0
    buffer_load_dwordx2 v[64:65], v2, s[36:39], s72 offen offset:128
    buffer_load_dwordx2 v[66:67], v2, s[36:39], s72 offen offset:256
    buffer_load_dwordx4 v[20:23], v1, s[24:27], s71 offen offset:0 nt
    v_fmac_f32 v96, v48, v28
    v_fmac_f32 v96, v49, v29
    v_fmac_f32 v96, v50, v30
    v_fmac_f32 v96, v51, v31
    s_waitcnt vmcnt(13)
    v_cvt_f32_i32 v24, v4
    v_cvt_f32_i32 v25, v5
    v_cvt_f32_i32 v26, v6
    v_cvt_f32_i32 v27, v7
    buffer_load_dwordx4 v[4:7], v1, s[24:27], s71 offen offset:256 nt
    v_fmac_f32 v96, v52, v24
    v_fmac_f32 v96, v53, v25
    v_fmac_f32 v96, v54, v26
    v_fmac_f32 v96, v55, v27
    s_nop 1
    v_add_f32_dpp v97, v96, v96 row_ror:8 row_mask:0xf bank_mask:0x3
    s_waitcnt vmcnt(13)
    v_cvt_f32_i32 v28, v8
    v_cvt_f32_i32 v29, v9
    v_cvt_f32_i32 v30, v10
    v_cvt_f32_i32 v31, v11
    buffer_load_dwordx4 v[8:11], v1, s[24:27], s71 offen offset:512 nt
    v_fma_f32 v96, v44, v28, -v88
    v_fmac_f32 v96, v45, v29
    v_fmac_f32 v96, v46, v30
    v_fmac_f32 v96, v47, v31
    s_waitcnt vmcnt(13)
    v_cvt_f32_i32 v24, v12
    v_cvt_f32_i32 v25, v13
    v_cvt_f32_i32 v26, v14
    v_cvt_f32_i32 v27, v15
    s_add_u32 s71, s71, 3072
    buffer_load_dwordx4 v[12:15], v1, s[24:27], s71 offen offset:0 nt
    v_fmac_f32 v96, v48, v24
    v_fmac_f32 v96, v49, v25
    v_fmac_f32 v96, v50, v26
    v_fmac_f32 v96, v51, v27
    s_waitcnt vmcnt(13)
    v_cvt_f32_i32 v28, v16
    v_cvt_f32_i32 v29, v17
    v_cvt_f32_i32 v30, v18
    v_cvt_f32_i32 v31, v19
    buffer_load_dwordx4 v[16:19], v1, s[24:27], s71 offen offset:256 nt
    v_fmac_f32 v96, v52, v28
    v_fmac_f32 v96, v53, v29
    v_fmac_f32 v96, v54, v30
    v_fmac_f32 v96, v55, v31
    s_nop 1
    v_add_f32_dpp v97, v96, v96 row_ror:8 row_mask:0xf bank_mask:0xc
    s_nop 1
    v_add_f32_dpp v98, v97, v97 row_shr:4 row_mask:0xf bank_mask:0xa
    s_nop 1
    v_add_f32_dpp v100, v98, v98 quad_perm:[2,3,0,1] row_mask:0xf bank_mask:0xf
    v_cndmask_b32 v100, v99, v100, s[64:65]
    s_nop 1
    v_add_f32_dpp v99, v100, v100 quad_perm:[1,0,3,2] row_mask:0xf bank_mask:0xf
    v_cndmask_b32 v101, v101, v99, s[66:67]
    ds_write_b32 v104, v101
    v_add_u32 v104, 256, v104
    s_waitcnt vmcnt(11)
    v_lshlrev_b32 v32, 16, v68
    v_and_b32 v33, 0xffff0000, v68
    v_lshlrev_b32 v34, 16, v69
    v_and_b32 v35, 0xffff0000, v69
    v_lshlrev_b32 v36, 16, v70
    v_and_b32 v37, 0xffff0000, v70
    v_lshlrev_b32 v38, 16, v71
    v_and_b32 v39, 0xffff0000, v71
    v_lshlrev_b32 v40, 16, v72
    v_and_b32 v41, 0xffff0000, v72
    v_lshlrev_b32 v42, 16, v73
    v_and_b32 v43, 0xffff0000, v73
    v_mul_f32 v32, s78, v32
    v_mul_f32 v33, s78, v33
    v_mul_f32 v34, s78, v34
    v_mul_f32 v35, s78, v35
    v_mul_f32 v36, s78, v36
    v_mul_f32 v37, s78, v37
    v_mul_f32 v38, s78, v38
    v_mul_f32 v39, s78, v39
    v_mul_f32 v40, s78, v40
    v_mul_f32 v41, s78, v41
    v_mul_f32 v42, s78, v42
    v_mul_f32 v43, s78, v43
    s_waitcnt vmcnt(5)
    v_lshlrev_b32 v102, 16, v56
    v_and_b32 v103, 0xffff0000, v56
    v_mul_f32 v44, v102, v32
    v_mul_f32 v45, v103, v33
    v_lshlrev_b32 v102, 16, v62
    v_and_b32 v103, 0xffff0000, v62
    v_mul_f32 v88, v44, v102
    v_fmac_f32 v88, v45, v103
    v_lshlrev_b32 v102, 16, v57
    v_and_b32 v103, 0xffff0000, v57
    v_mul_f32 v46, v102, v34
    v_mul_f32 v47, v103, v35
    v_lshlrev_b32 v102, 16, v63
    v_and_b32 v103, 0xffff0000, v63
    v_fmac_f32 v88, v46, v102
    v_fmac_f32 v88, v47, v103
    v_lshlrev_b32 v102, 16, v58
    v_and_b32 v103, 0xffff0000, v58
    v_mul_f32 v48, v102, v36
    v_mul_f32 v49, v103, v37
    v_lshlrev_b32 v102, 16, v64
    v_and_b32 v103, 0xffff0000, v64
    v_fmac_f32 v88, v48, v102
    v_fmac_f32 v88, v49, v103
    v_lshlrev_b32 v102, 16, v59
    v_and_b32 v103, 0xffff0000, v59
    v_mul_f32 v50, v102, v38
    v_mul_f32 v51, v103, v39
    v_lshlrev_b32 v102, 16, v65
    v_and_b32 v103, 0xffff0000, v65
    v_fmac_f32 v88, v50, v102
    v_fmac_f32 v88, v51, v103
    v_lshlrev_b32 v102, 16, v60
    v_and_b32 v103, 0xffff0000, v60
    v_mul_f32 v52, v102, v40
    v_mul_f32 v53, v103, v41
    v_lshlrev_b32 v102, 16, v66
    v_and_b32 v103, 0xffff0000, v66
    v_fmac_f32 v88, v52, v102
    v_fmac_f32 v88, v53, v103
    v_lshlrev_b32 v102, 16, v61
    v_and_b32 v103, 0xffff0000, v61
    v_mul_f32 v54, v102, v42
    v_mul_f32 v55, v103, v43
    v_lshlrev_b32 v102, 16, v67
    v_and_b32 v103, 0xffff0000, v67
    v_fmac_f32 v88, v54, v102
    v_fmac_f32 v88, v55, v103
    s_waitcnt vmcnt(4)
    v_cvt_f32_i32 v24, v20
    v_cvt_f32_i32 v25, v21
    v_cvt_f32_i32 v26, v22
    v_cvt_f32_i32 v27, v23
    buffer_load_dwordx4 v[20:23], v1, s[24:27], s71 offen offset:512 nt
    v_fma_f32 v96, v44, v24, -v88
    v_fmac_f32 v96, v45, v25
    v_fmac_f32 v96, v46, v26
    v_fmac_f32 v96, v47, v27
    s_waitcnt vmcnt(4)
    v_cvt_f32_i32 v28, v4
    v_cvt_f32_i32 v29, v5
    v_cvt_f32_i32 v30, v6
    v_cvt_f32_i32 v31, v7
    s_add_u32 s71, s71, 3072
    buffer_load_dwordx4 v[4:7], v1, s[24:27], s71 offen offset:0 nt
    v_fmac_f32 v96, v48, v28
    v_fmac_f32 v96, v49, v29
    v_fmac_f32 v96, v50, v30
    v_fmac_f32 v96, v51, v31
    s_waitcnt vmcnt(4)
    v_cvt_f32_i32 v24, v8
    v_cvt_f32_i32 v25, v9
    v_cvt_f32_i32 v26, v10
    v_cvt_f32_i32 v27, v11
    buffer_load_dwordx4 v[8:11], v1, s[24:27], s71 offen offset:256 nt
    v_fmac_f32 v96, v52, v24
    v_fmac_f32 v96, v53, v25
    v_fmac_f32 v96, v54, v26
    v_fmac_f32 v96, v55, v27
    s_nop 1
    v_add_f32_dpp v97, v96, v96 row_ror:8 row_mask:0xf bank_mask:0x3
    s_waitcnt vmcnt(4)
    v_cvt_f32_i32 v28, v12
    v_cvt_f32_i32 v29, v13
    v_cvt_f32_i32 v30, v14
    v_cvt_f32_i32 v31, v15
    buffer_load_dwordx4 v[12:15], v1, s[24:27], s71 offen offset:512 nt
    v_fma_f32 v96, v44, v28, -v88
    v_fmac_f32 v96, v45, v29
    v_fmac_f32 v96, v46, v30
    v_fmac_f32 v96, v47, v31
    s_waitcnt vmcnt(4)
    v_cvt_f32_i32 v24, v16
    v_cvt_f32_i32 v25, v17
    v_cvt_f32_i32 v26, v18
    v_cvt_f32_i32 v27, v19
    s_add_u32 s71, s71, 3072
    buffer_load_dwordx4 v[16:19], v1, s[24:27], s71 offen offset:0 nt
    v_fmac_f32 v96, v48, v24
    v_fmac_f32 v96, v49, v25
    v_fmac_f32 v96, v50, v26
    v_fmac_f32 v96, v51, v27
    s_waitcnt vmcnt(4)
    v_cvt_f32_i32 v28, v20
    v_cvt_f32_i32 v29, v21
    v_cvt_f32_i32 v30, v22
    v_cvt_f32_i32 v31, v23
    buffer_load_dwordx4 v[20:23], v1, s[24:27], s71 offen offset:256 nt
    v_fmac_f32 v96, v52, v28
    v_fmac_f32 v96, v53, v29
    v_fmac_f32 v96, v54, v30
    v_fmac_f32 v96, v55, v31
    s_nop 1
    v_add_f32_dpp v97, v96, v96 row_ror:8 row_mask:0xf bank_mask:0xc
    s_nop 1
    v_add_f32_dpp v98, v97, v97 row_shl:4 row_mask:0xf bank_mask:0x5
    s_waitcnt vmcnt(4)
    v_cvt_f32_i32 v24, v4
    v_cvt_f32_i32 v25, v5
    v_cvt_f32_i32 v26, v6
    v_cvt_f32_i32 v27, v7
    buffer_load_dwordx4 v[4:7], v1, s[24:27], s71 offen offset:512 nt
    v_fma_f32 v96, v44, v24, -v88
    v_fmac_f32 v96, v45, v25
    v_fmac_f32 v96, v46, v26
    v_fmac_f32 v96, v47, v27
    s_waitcnt vmcnt(4)
    v_cvt_f32_i32 v28, v8
    v_cvt_f32_i32 v29, v9
    v_cvt_f32_i32 v30, v10
    v_cvt_f32_i32 v31, v11
    s_add_u32 s70, s70, 64
    s_mul_i32 s71, s70, 49152
    s_mul_i32 s72, s70, 384
    buffer_load_dwordx2 v[56:57], v2, s[32:35], s72 offen offset:0
    buffer_load_dwordx2 v[58:59], v2, s[32:35], s72 offen offset:128
    buffer_load_dwordx2 v[60:61], v2, s[32:35], s72 offen offset:256
    buffer_load_dwordx2 v[62:63], v2, s[36:39], s72 offen offset:0
    buffer_load_dwordx2 v[64:65], v2, s[36:39], s72 offen offset:128
    buffer_load_dwordx2 v[66:67], v2, s[36:39], s72 offen offset:256
    buffer_load_dwordx4 v[8:11], v1, s[24:27], s71 offen offset:0 nt
    v_fmac_f32 v96, v48, v28
    v_fmac_f32 v96, v49, v29
    v_fmac_f32 v96, v50, v30
    v_fmac_f32 v96, v51, v31
    s_waitcnt vmcnt(10)
    v_cvt_f32_i32 v24, v12
    v_cvt_f32_i32 v25, v13
    v_cvt_f32_i32 v26, v14
    v_cvt_f32_i32 v27, v15
    buffer_load_dwordx4 v[12:15], v1, s[24:27], s71 offen offset:256 nt
    v_fmac_f32 v96, v52, v24
    v_fmac_f32 v96, v53, v25
    v_fmac_f32 v96, v54, v26
    v_fmac_f32 v96, v55, v27
    s_nop 1
    v_add_f32_dpp v97, v96, v96 row_ror:8 row_mask:0xf bank_mask:0x3
    s_waitcnt vmcnt(10)
    v_cvt_f32_i32 v28, v16
    v_cvt_f32_i32 v29, v17
    v_cvt_f32_i32 v30, v18
    v_cvt_f32_i32 v31, v19
    buffer_load_dwordx4 v[16:19], v1, s[24:27], s71 offen offset:512 nt
    v_fma_f32 v96, v44, v28, -v88
    v_fmac_f32 v96, v45, v29
    v_fmac_f32 v96, v46, v30
    v_fmac_f32 v96, v47, v31
    s_waitcnt vmcnt(10)
    v_cvt_f32_i32 v24, v20
    v_cvt_f32_i32 v25, v21
    v_cvt_f32_i32 v26, v22
    v_cvt_f32_i32 v27, v23
    s_add_u32 s71, s71, 3072
    buffer_load_dwordx4 v[20:23], v1, s[24:27], s71 offen offset:0 nt
    v_fmac_f32 v96, v48, v24
    v_fmac_f32 v96, v49, v25
    v_fmac_f32 v96, v50, v26
    v_fmac_f32 v96, v51, v27
    s_waitcnt vmcnt(10)
    v_cvt_f32_i32 v28, v4
    v_cvt_f32_i32 v29, v5
    v_cvt_f32_i32 v30, v6
    v_cvt_f32_i32 v31, v7
    buffer_load_dwordx4 v[4:7], v1, s[24:27], s71 offen offset:256 nt
    v_fmac_f32 v96, v52, v28
    v_fmac_f32 v96, v53, v29
    v_fmac_f32 v96, v54, v30
    v_fmac_f32 v96, v55, v31
    s_nop 1
    v_add_f32_dpp v97, v96, v96 row_ror:8 row_mask:0xf bank_mask:0xc
    s_nop 1
    v_add_f32_dpp v98, v97, v97 row_shr:4 row_mask:0xf bank_mask:0xa
    s_nop 1
    v_add_f32_dpp v99, v98, v98 quad_perm:[2,3,0,1] row_mask:0xf bank_mask:0xf
    s_waitcnt vmcnt(5)
    v_lshlrev_b32 v102, 16, v56
    v_and_b32 v103, 0xffff0000, v56
    v_mul_f32 v44, v102, v32
    v_mul_f32 v45, v103, v33
    v_lshlrev_b32 v102, 16, v62
    v_and_b32 v103, 0xffff0000, v62
    v_mul_f32 v88, v44, v102
    v_fmac_f32 v88, v45, v103
    v_lshlrev_b32 v102, 16, v57
    v_and_b32 v103, 0xffff0000, v57
    v_mul_f32 v46, v102, v34
    v_mul_f32 v47, v103, v35
    v_lshlrev_b32 v102, 16, v63
    v_and_b32 v103, 0xffff0000, v63
    v_fmac_f32 v88, v46, v102
    v_fmac_f32 v88, v47, v103
    v_lshlrev_b32 v102, 16, v58
    v_and_b32 v103, 0xffff0000, v58
    v_mul_f32 v48, v102, v36
    v_mul_f32 v49, v103, v37
    v_lshlrev_b32 v102, 16, v64
    v_and_b32 v103, 0xffff0000, v64
    v_fmac_f32 v88, v48, v102
    v_fmac_f32 v88, v49, v103
    v_lshlrev_b32 v102, 16, v59
    v_and_b32 v103, 0xffff0000, v59
    v_mul_f32 v50, v102, v38
    v_mul_f32 v51, v103, v39
    v_lshlrev_b32 v102, 16, v65
    v_and_b32 v103, 0xffff0000, v65
    v_fmac_f32 v88, v50, v102
    v_fmac_f32 v88, v51, v103
    v_lshlrev_b32 v102, 16, v60
    v_and_b32 v103, 0xffff0000, v60
    v_mul_f32 v52, v102, v40
    v_mul_f32 v53, v103, v41
    v_lshlrev_b32 v102, 16, v66
    v_and_b32 v103, 0xffff0000, v66
    v_fmac_f32 v88, v52, v102
    v_fmac_f32 v88, v53, v103
    v_lshlrev_b32 v102, 16, v61
    v_and_b32 v103, 0xffff0000, v61
    v_mul_f32 v54, v102, v42
    v_mul_f32 v55, v103, v43
    v_lshlrev_b32 v102, 16, v67
    v_and_b32 v103, 0xffff0000, v67
    v_fmac_f32 v88, v54, v102
    v_fmac_f32 v88, v55, v103
    s_waitcnt vmcnt(4)
    v_cvt_f32_i32 v24, v8
    v_cvt_f32_i32 v25, v9
    v_cvt_f32_i32 v26, v10
    v_cvt_f32_i32 v27, v11
    buffer_load_dwordx4 v[8:11], v1, s[24:27], s71 offen offset:512 nt
    v_fma_f32 v96, v44, v24, -v88
    v_fmac_f32 v96, v45, v25
    v_fmac_f32 v96, v46, v26
    v_fmac_f32 v96, v47, v27
    s_waitcnt vmcnt(4)
    v_cvt_f32_i32 v28, v12
    v_cvt_f32_i32 v29, v13
    v_cvt_f32_i32 v30, v14
    v_cvt_f32_i32 v31, v15
    s_add_u32 s71, s71, 3072
    buffer_load_dwordx4 v[12:15], v1, s[24:27], s71 offen offset:0 nt
    v_fmac_f32 v96, v48, v28
    v_fmac_f32 v96, v49, v29
    v_fmac_f32 v96, v50, v30
    v_fmac_f32 v96, v51, v31
    s_waitcnt vmcnt(4)
    v_cvt_f32_i32 v24, v16
    v_cvt_f32_i32 v25, v17
    v_cvt_f32_i32 v26, v18
    v_cvt_f32_i32 v27, v19
    buffer_load_dwordx4 v[16:19], v1, s[24:27], s71 offen offset:256 nt
    v_fmac_f32 v96, v52, v24
    v_fmac_f32 v96, v53, v25
    v_fmac_f32 v96, v54, v26
    v_fmac_f32 v96, v55, v27
    s_nop 1
    v_add_f32_dpp v97, v96, v96 row_ror:8 row_mask:0xf bank_mask:0x3
    s_waitcnt vmcnt(4)
    v_cvt_f32_i32 v28, v20
    v_cvt_f32_i32 v29, v21
    v_cvt_f32_i32 v30, v22
    v_cvt_f32_i32 v31, v23
    buffer_load_dwordx4 v[20:23], v1, s[24:27], s71 offen offset:512 nt
    v_fma_f32 v96, v44, v28, -v88
    v_fmac_f32 v96, v45, v29
    v_fmac_f32 v96, v46, v30
    v_fmac_f32 v96, v47, v31
    s_waitcnt vmcnt(4)
    v_cvt_f32_i32 v24, v4
    v_cvt_f32_i32 v25, v5
    v_cvt_f32_i32 v26, v6
    v_cvt_f32_i32 v27, v7
    s_add_u32 s71, s71, 3072
    buffer_load_dwordx4 v[4:7], v1, s[24:27], s71 offen offset:0 nt
    v_fmac_f32 v96, v48, v24
    v_fmac_f32 v96, v49, v25
    v_fmac_f32 v96, v50, v26
    v_fmac_f32 v96, v51, v27
    s_waitcnt vmcnt(4)
    v_cvt_f32_i32 v28, v8
    v_cvt_f32_i32 v29, v9
    v_cvt_f32_i32 v30, v10
    v_cvt_f32_i32 v31, v11
    buffer_load_dwordx4 v[8:11], v1, s[24:27], s71 offen offset:256 nt
    v_fmac_f32 v96, v52, v28
    v_fmac_f32 v96, v53, v29
    v_fmac_f32 v96, v54, v30
    v_fmac_f32 v96, v55, v31
    s_nop 1
    v_add_f32_dpp v97, v96, v96 row_ror:8 row_mask:0xf bank_mask:0xc
    s_nop 1
    v_add_f32_dpp v98, v97, v97 row_shl:4 row_mask:0xf bank_mask:0x5
    s_waitcnt vmcnt(4)
    v_cvt_f32_i32 v24, v12
    v_cvt_f32_i32 v25, v13
    v_cvt_f32_i32 v26, v14
    v_cvt_f32_i32 v27, v15
    buffer_load_dwordx4 v[12:15], v1, s[24:27], s71 offen offset:512 nt
    v_fma_f32 v96, v44, v24, -v88
    v_fmac_f32 v96, v45, v25
    v_fmac_f32 v96, v46, v26
    v_fmac_f32 v96, v47, v27
    s_waitcnt vmcnt(4)
    v_cvt_f32_i32 v28, v16
    v_cvt_f32_i32 v29, v17
    v_cvt_f32_i32 v30, v18
    v_cvt_f32_i32 v31, v19
    s_add_u32 s70, s70, 64
    s_mul_i32 s71, s70, 49152
    s_mul_i32 s72, s70, 384
    buffer_load_dwordx2 v[56:57], v2, s[32:35], s72 offen offset:0
    buffer_load_dwordx2 v[58:59], v2, s[32:35], s72 offen offset:128
    buffer_load_dwordx2 v[60:61], v2, s[32:35], s72 offen offset:256
    buffer_load_dwordx2 v[62:63], v2, s[36:39], s72 offen offset:0
    buffer_load_dwordx2 v[64:65], v2, s[36:39], s72 offen offset:128
    buffer_load_dwordx2 v[66:67], v2, s[36:39], s72 offen offset:256
    buffer_load_dwordx4 v[16:19], v1, s[24:27], s71 offen offset:0 nt
    v_fmac_f32 v96, v48, v28
    v_fmac_f32 v96, v49, v29
    v_fmac_f32 v96, v50, v30
    v_fmac_f32 v96, v51, v31
    s_waitcnt vmcnt(10)
    v_cvt_f32_i32 v24, v20
    v_cvt_f32_i32 v25, v21
    v_cvt_f32_i32 v26, v22
    v_cvt_f32_i32 v27, v23
    buffer_load_dwordx4 v[20:23], v1, s[24:27], s71 offen offset:256 nt
    v_fmac_f32 v96, v52, v24
    v_fmac_f32 v96, v53, v25
    v_fmac_f32 v96, v54, v26
    v_fmac_f32 v96, v55, v27
    s_nop 1
    v_add_f32_dpp v97, v96, v96 row_ror:8 row_mask:0xf bank_mask:0x3
    s_waitcnt vmcnt(10)
    v_cvt_f32_i32 v28, v4
    v_cvt_f32_i32 v29, v5
    v_cvt_f32_i32 v30, v6
    v_cvt_f32_i32 v31, v7
    buffer_load_dwordx4 v[4:7], v1, s[24:27], s71 offen offset:512 nt
    v_fma_f32 v96, v44, v28, -v88
    v_fmac_f32 v96, v45, v29
    v_fmac_f32 v96, v46, v30
    v_fmac_f32 v96, v47, v31
    s_waitcnt vmcnt(10)
    v_cvt_f32_i32 v24, v8
    v_cvt_f32_i32 v25, v9
    v_cvt_f32_i32 v26, v10
    v_cvt_f32_i32 v27, v11
    s_add_u32 s71, s71, 3072
    buffer_load_dwordx4 v[8:11], v1, s[24:27], s71 offen offset:0 nt
    v_fmac_f32 v96, v48, v24
    v_fmac_f32 v96, v49, v25
    v_fmac_f32 v96, v50, v26
    v_fmac_f32 v96, v51, v27
    s_waitcnt vmcnt(10)
    v_cvt_f32_i32 v28, v12
    v_cvt_f32_i32 v29, v13
    v_cvt_f32_i32 v30, v14
    v_cvt_f32_i32 v31, v15
    buffer_load_dwordx4 v[12:15], v1, s[24:27], s71 offen offset:256 nt
    v_fmac_f32 v96, v52, v28
    v_fmac_f32 v96, v53, v29
    v_fmac_f32 v96, v54, v30
    v_fmac_f32 v96, v55, v31
    s_nop 1
    v_add_f32_dpp v97, v96, v96 row_ror:8 row_mask:0xf bank_mask:0xc
    s_nop 1
    v_add_f32_dpp v98, v97, v97 row_shr:4 row_mask:0xf bank_mask:0xa
    s_nop 1
    v_add_f32_dpp v100, v98, v98 quad_perm:[2,3,0,1] row_mask:0xf bank_mask:0xf
    v_cndmask_b32 v100, v99, v100, s[64:65]
    s_nop 1
    v_add_f32_dpp v101, v100, v100 quad_perm:[1,0,3,2] row_mask:0xf bank_mask:0xf
    s_waitcnt vmcnt(5)
    v_lshlrev_b32 v102, 16, v56
    v_and_b32 v103, 0xffff0000, v56
    v_mul_f32 v44, v102, v32
    v_mul_f32 v45, v103, v33
    v_lshlrev_b32 v102, 16, v62
    v_and_b32 v103, 0xffff0000, v62
    v_mul_f32 v88, v44, v102
    v_fmac_f32 v88, v45, v103
    v_lshlrev_b32 v102, 16, v57
    v_and_b32 v103, 0xffff0000, v57
    v_mul_f32 v46, v102, v34
    v_mul_f32 v47, v103, v35
    v_lshlrev_b32 v102, 16, v63
    v_and_b32 v103, 0xffff0000, v63
    v_fmac_f32 v88, v46, v102
    v_fmac_f32 v88, v47, v103
    v_lshlrev_b32 v102, 16, v58
    v_and_b32 v103, 0xffff0000, v58
    v_mul_f32 v48, v102, v36
    v_mul_f32 v49, v103, v37
    v_lshlrev_b32 v102, 16, v64
    v_and_b32 v103, 0xffff0000, v64
    v_fmac_f32 v88, v48, v102
    v_fmac_f32 v88, v49, v103
    v_lshlrev_b32 v102, 16, v59
    v_and_b32 v103, 0xffff0000, v59
    v_mul_f32 v50, v102, v38
    v_mul_f32 v51, v103, v39
    v_lshlrev_b32 v102, 16, v65
    v_and_b32 v103, 0xffff0000, v65
    v_fmac_f32 v88, v50, v102
    v_fmac_f32 v88, v51, v103
    v_lshlrev_b32 v102, 16, v60
    v_and_b32 v103, 0xffff0000, v60
    v_mul_f32 v52, v102, v40
    v_mul_f32 v53, v103, v41
    v_lshlrev_b32 v102, 16, v66
    v_and_b32 v103, 0xffff0000, v66
    v_fmac_f32 v88, v52, v102
    v_fmac_f32 v88, v53, v103
    v_lshlrev_b32 v102, 16, v61
    v_and_b32 v103, 0xffff0000, v61
    v_mul_f32 v54, v102, v42
    v_mul_f32 v55, v103, v43
    v_lshlrev_b32 v102, 16, v67
    v_and_b32 v103, 0xffff0000, v67
    v_fmac_f32 v88, v54, v102
    v_fmac_f32 v88, v55, v103
    s_waitcnt vmcnt(4)
    v_cvt_f32_i32 v24, v16
    v_cvt_f32_i32 v25, v17
    v_cvt_f32_i32 v26, v18
    v_cvt_f32_i32 v27, v19
    buffer_load_dwordx4 v[16:19], v1, s[24:27], s71 offen offset:512 nt
    v_fma_f32 v96, v44, v24, -v88
    v_fmac_f32 v96, v45, v25
    v_fmac_f32 v96, v46, v26
    v_fmac_f32 v96, v47, v27
    s_waitcnt vmcnt(4)
    v_cvt_f32_i32 v28, v20
    v_cvt_f32_i32 v29, v21
    v_cvt_f32_i32 v30, v22
    v_cvt_f32_i32 v31, v23
    s_add_u32 s71, s71, 3072
    buffer_load_dwordx4 v[20:23], v1, s[24:27], s71 offen offset:0 nt
    v_fmac_f32 v96, v48, v28
    v_fmac_f32 v96, v49, v29
    v_fmac_f32 v96, v50, v30
    v_fmac_f32 v96, v51, v31
    s_waitcnt vmcnt(4)
    v_cvt_f32_i32 v24, v4
    v_cvt_f32_i32 v25, v5
    v_cvt_f32_i32 v26, v6
    v_cvt_f32_i32 v27, v7
    buffer_load_dwordx4 v[4:7], v1, s[24:27], s71 offen offset:256 nt
    v_fmac_f32 v96, v52, v24
    v_fmac_f32 v96, v53, v25
    v_fmac_f32 v96, v54, v26
    v_fmac_f32 v96, v55, v27
    s_nop 1
    v_add_f32_dpp v97, v96, v96 row_ror:8 row_mask:0xf bank_mask:0x3
    s_waitcnt vmcnt(4)
    v_cvt_f32_i32 v28, v8
    v_cvt_f32_i32 v29, v9
    v_cvt_f32_i32 v30, v10
    v_cvt_f32_i32 v31, v11
    buffer_load_dwordx4 v[8:11], v1, s[24:27], s71 offen offset:512 nt
    v_fma_f32 v96, v44, v28, -v88
    v_fmac_f32 v96, v45, v29
    v_fmac_f32 v96, v46, v30
    v_fmac_f32 v96, v47, v31
    s_waitcnt vmcnt(4)
    v_cvt_f32_i32 v24, v12
    v_cvt_f32_i32 v25, v13
    v_cvt_f32_i32 v26, v14
    v_cvt_f32_i32 v27, v15
    s_add_u32 s71, s71, 3072
    buffer_load_dwordx4 v[12:15], v1, s[24:27], s71 offen offset:0 nt
    v_fmac_f32 v96, v48, v24
    v_fmac_f32 v96, v49, v25
    v_fmac_f32 v96, v50, v26
    v_fmac_f32 v96, v51, v27
    s_waitcnt vmcnt(4)
    v_cvt_f32_i32 v28, v16
    v_cvt_f32_i32 v29, v17
    v_cvt_f32_i32 v30, v18
    v_cvt_f32_i32 v31, v19
    buffer_load_dwordx4 v[16:19], v1, s[24:27], s71 offen offset:256 nt
    v_fmac_f32 v96, v52, v28
    v_fmac_f32 v96, v53, v29
    v_fmac_f32 v96, v54, v30
    v_fmac_f32 v96, v55, v31
    s_nop 1
    v_add_f32_dpp v97, v96, v96 row_ror:8 row_mask:0xf bank_mask:0xc
    s_nop 1
    v_add_f32_dpp v98, v97, v97 row_shl:4 row_mask:0xf bank_mask:0x5
    s_waitcnt vmcnt(4)
    v_cvt_f32_i32 v24, v20
    v_cvt_f32_i32 v25, v21
    v_cvt_f32_i32 v26, v22
    v_cvt_f32_i32 v27, v23
    buffer_load_dwordx4 v[20:23], v1, s[24:27], s71 offen offset:512 nt
    v_fma_f32 v96, v44, v24, -v88
    v_fmac_f32 v96, v45, v25
    v_fmac_f32 v96, v46, v26
    v_fmac_f32 v96, v47, v27
    s_waitcnt vmcnt(4)
    v_cvt_f32_i32 v28, v4
    v_cvt_f32_i32 v29, v5
    v_cvt_f32_i32 v30, v6
    v_cvt_f32_i32 v31, v7
    s_add_u32 s70, s70, 64
    s_mul_i32 s71, s70, 49152
    s_mul_i32 s72, s70, 384
    buffer_load_dwordx2 v[56:57], v2, s[32:35], s72 offen offset:0
    buffer_load_dwordx2 v[58:59], v2, s[32:35], s72 offen offset:128
    buffer_load_dwordx2 v[60:61], v2, s[32:35], s72 offen offset:256
    buffer_load_dwordx2 v[62:63], v2, s[36:39], s72 offen offset:0
    buffer_load_dwordx2 v[64:65], v2, s[36:39], s72 offen offset:128
    buffer_load_dwordx2 v[66:67], v2, s[36:39], s72 offen offset:256
    buffer_load_dwordx4 v[4:7], v1, s[24:27], s71 offen offset:0 nt
    v_fmac_f32 v96, v48, v28
    v_fmac_f32 v96, v49, v29
    v_fmac_f32 v96, v50, v30
    v_fmac_f32 v96, v51, v31
    s_waitcnt vmcnt(10)
    v_cvt_f32_i32 v24, v8
    v_cvt_f32_i32 v25, v9
    v_cvt_f32_i32 v26, v10
    v_cvt_f32_i32 v27, v11
    buffer_load_dwordx4 v[8:11], v1, s[24:27], s71 offen offset:256 nt
    v_fmac_f32 v96, v52, v24
    v_fmac_f32 v96, v53, v25
    v_fmac_f32 v96, v54, v26
    v_fmac_f32 v96, v55, v27
    s_nop 1
    v_add_f32_dpp v97, v96, v96 row_ror:8 row_mask:0xf bank_mask:0x3
    s_waitcnt vmcnt(10)
    v_cvt_f32_i32 v28, v12
    v_cvt_f32_i32 v29, v13
    v_cvt_f32_i32 v30, v14
    v_cvt_f32_i32 v31, v15
    buffer_load_dwordx4 v[12:15], v1, s[24:27], s71 offen offset:512 nt
    v_fma_f32 v96, v44, v28, -v88
    v_fmac_f32 v96, v45, v29
    v_fmac_f32 v96, v46, v30
    v_fmac_f32 v96, v47, v31
    s_waitcnt vmcnt(10)
    v_cvt_f32_i32 v24, v16
    v_cvt_f32_i32 v25, v17
    v_cvt_f32_i32 v26, v18
    v_cvt_f32_i32 v27, v19
    s_add_u32 s71, s71, 3072
    buffer_load_dwordx4 v[16:19], v1, s[24:27], s71 offen offset:0 nt
    v_fmac_f32 v96, v48, v24
    v_fmac_f32 v96, v49, v25
    v_fmac_f32 v96, v50, v26
    v_fmac_f32 v96, v51, v27
    s_waitcnt vmcnt(10)
    v_cvt_f32_i32 v28, v20
    v_cvt_f32_i32 v29, v21
    v_cvt_f32_i32 v30, v22
    v_cvt_f32_i32 v31, v23
    buffer_load_dwordx4 v[20:23], v1, s[24:27], s71 offen offset:256 nt
    v_fmac_f32 v96, v52, v28
    v_fmac_f32 v96, v53, v29
    v_fmac_f32 v96, v54, v30
    v_fmac_f32 v96, v55, v31
    s_nop 1
    v_add_f32_dpp v97, v96, v96 row_ror:8 row_mask:0xf bank_mask:0xc
    s_nop 1
    v_add_f32_dpp v98, v97, v97 row_shr:4 row_mask:0xf bank_mask:0xa
    s_nop 1
    v_add_f32_dpp v99, v98, v98 quad_perm:[2,3,0,1] row_mask:0xf bank_mask:0xf
    s_waitcnt vmcnt(5)
    v_lshlrev_b32 v102, 16, v56
    v_and_b32 v103, 0xffff0000, v56
    v_mul_f32 v44, v102, v32
    v_mul_f32 v45, v103, v33
    v_lshlrev_b32 v102, 16, v62
    v_and_b32 v103, 0xffff0000, v62
    v_mul_f32 v88, v44, v102
    v_fmac_f32 v88, v45, v103
    v_lshlrev_b32 v102, 16, v57
    v_and_b32 v103, 0xffff0000, v57
    v_mul_f32 v46, v102, v34
    v_mul_f32 v47, v103, v35
    v_lshlrev_b32 v102, 16, v63
    v_and_b32 v103, 0xffff0000, v63
    v_fmac_f32 v88, v46, v102
    v_fmac_f32 v88, v47, v103
    v_lshlrev_b32 v102, 16, v58
    v_and_b32 v103, 0xffff0000, v58
    v_mul_f32 v48, v102, v36
    v_mul_f32 v49, v103, v37
    v_lshlrev_b32 v102, 16, v64
    v_and_b32 v103, 0xffff0000, v64
    v_fmac_f32 v88, v48, v102
    v_fmac_f32 v88, v49, v103
    v_lshlrev_b32 v102, 16, v59
    v_and_b32 v103, 0xffff0000, v59
    v_mul_f32 v50, v102, v38
    v_mul_f32 v51, v103, v39
    v_lshlrev_b32 v102, 16, v65
    v_and_b32 v103, 0xffff0000, v65
    v_fmac_f32 v88, v50, v102
    v_fmac_f32 v88, v51, v103
    v_lshlrev_b32 v102, 16, v60
    v_and_b32 v103, 0xffff0000, v60
    v_mul_f32 v52, v102, v40
    v_mul_f32 v53, v103, v41
    v_lshlrev_b32 v102, 16, v66
    v_and_b32 v103, 0xffff0000, v66
    v_fmac_f32 v88, v52, v102
    v_fmac_f32 v88, v53, v103
    v_lshlrev_b32 v102, 16, v61
    v_and_b32 v103, 0xffff0000, v61
    v_mul_f32 v54, v102, v42
    v_mul_f32 v55, v103, v43
    v_lshlrev_b32 v102, 16, v67
    v_and_b32 v103, 0xffff0000, v67
    v_fmac_f32 v88, v54, v102
    v_fmac_f32 v88, v55, v103
    s_waitcnt vmcnt(4)
    v_cvt_f32_i32 v24, v4
    v_cvt_f32_i32 v25, v5
    v_cvt_f32_i32 v26, v6
    v_cvt_f32_i32 v27, v7
    buffer_load_dwordx4 v[4:7], v1, s[24:27], s71 offen offset:512 nt
    v_fma_f32 v96, v44, v24, -v88
    v_fmac_f32 v96, v45, v25
    v_fmac_f32 v96, v46, v26
    v_fmac_f32 v96, v47, v27
    s_waitcnt vmcnt(4)
    v_cvt_f32_i32 v28, v8
    v_cvt_f32_i32 v29, v9
    v_cvt_f32_i32 v30, v10
    v_cvt_f32_i32 v31, v11
    s_add_u32 s71, s71, 3072
    buffer_load_dwordx4 v[8:11], v1, s[24:27], s71 offen offset:0 nt
    v_fmac_f32 v96, v48, v28
    v_fmac_f32 v96, v49, v29
    v_fmac_f32 v96, v50, v30
    v_fmac_f32 v96, v51, v31
    s_waitcnt vmcnt(4)
    v_cvt_f32_i32 v24, v12
    v_cvt_f32_i32 v25, v13
    v_cvt_f32_i32 v26, v14
    v_cvt_f32_i32 v27, v15
    buffer_load_dwordx4 v[12:15], v1, s[24:27], s71 offen offset:256 nt
    v_fmac_f32 v96, v52, v24
    v_fmac_f32 v96, v53, v25
    v_fmac_f32 v96, v54, v26
    v_fmac_f32 v96, v55, v27
    s_nop 1
    v_add_f32_dpp v97, v96, v96 row_ror:8 row_mask:0xf bank_mask:0x3
    s_waitcnt vmcnt(4)
    v_cvt_f32_i32 v28, v16
    v_cvt_f32_i32 v29, v17
    v_cvt_f32_i32 v30, v18
    v_cvt_f32_i32 v31, v19
    buffer_load_dwordx4 v[16:19], v1, s[24:27], s71 offen offset:512 nt
    v_fma_f32 v96, v44, v28, -v88
    v_fmac_f32 v96, v45, v29
    v_fmac_f32 v96, v46, v30
    v_fmac_f32 v96, v47, v31
    s_waitcnt vmcnt(4)
    v_cvt_f32_i32 v24, v20
    v_cvt_f32_i32 v25, v21
    v_cvt_f32_i32 v26, v22
    v_cvt_f32_i32 v27, v23
    s_add_u32 s71, s71, 3072
    buffer_load_dwordx4 v[20:23], v1, s[24:27], s71 offen offset:0 nt
    v_fmac_f32 v96, v48, v24
    v_fmac_f32 v96, v49, v25
    v_fmac_f32 v96, v50, v26
    v_fmac_f32 v96, v51, v27
    s_waitcnt vmcnt(4)
    v_cvt_f32_i32 v28, v4
    v_cvt_f32_i32 v29, v5
    v_cvt_f32_i32 v30, v6
    v_cvt_f32_i32 v31, v7
    buffer_load_dwordx4 v[4:7], v1, s[24:27], s71 offen offset:256 nt
    v_fmac_f32 v96, v52, v28
    v_fmac_f32 v96, v53, v29
    v_fmac_f32 v96, v54, v30
    v_fmac_f32 v96, v55, v31
    s_nop 1
    v_add_f32_dpp v97, v96, v96 row_ror:8 row_mask:0xf bank_mask:0xc
    s_nop 1
    v_add_f32_dpp v98, v97, v97 row_shl:4 row_mask:0xf bank_mask:0x5
    s_waitcnt vmcnt(4)
    v_cvt_f32_i32 v24, v8
    v_cvt_f32_i32 v25, v9
    v_cvt_f32_i32 v26, v10
    v_cvt_f32_i32 v27, v11
    buffer_load_dwordx4 v[8:11], v1, s[24:27], s71 offen offset:512 nt
    v_fma_f32 v96, v44, v24, -v88
    v_fmac_f32 v96, v45, v25
    v_fmac_f32 v96, v46, v26
    v_fmac_f32 v96, v47, v27
    s_waitcnt vmcnt(4)
    v_cvt_f32_i32 v28, v12
    v_cvt_f32_i32 v29, v13
    v_cvt_f32_i32 v30, v14
    v_cvt_f32_i32 v31, v15
    s_add_u32 s70, s70, 64
    s_sub_u32 s75, s75, 1
    s_cmp_eq_u32 s75, 0
    s_cselect_b32 s80, 1536, 0
    s_cselect_b32 s75, 2, s75
    s_add_u32 s70, s70, s80
    s_lshr_b32 s74, s70, 9
    s_mul_i32 s74, s74, 384
    buffer_load_dwordx2 v[68:69], v2, s[48:51], s74 offen offset:0
    buffer_load_dwordx2 v[70:71], v2, s[48:51], s74 offen offset:128
    buffer_load_dwordx2 v[72:73], v2, s[48:51], s74 offen offset:256
    s_mul_i32 s71, s70, 49152
    s_mul_i32 s72, s70, 384
    buffer_load_dwordx2 v[56:57], v2, s[32:35], s72 offen offset:0
    buffer_load_dwordx2 v[58:59], v2, s[32:35], s72 offen offset:128
    buffer_load_dwordx2 v[60:61], v2, s[32:35], s72 offen offset:256
    buffer_load_dwordx2 v[62:63], v2, s[36:39], s72 offen offset:0
    buffer_load_dwordx2 v[64:65], v2, s[36:39], s72 offen offset:128
    buffer_load_dwordx2 v[66:67], v2, s[36:39], s72 offen offset:256
    buffer_load_dwordx4 v[12:15], v1, s[24:27], s71 offen offset:0 nt
    v_fmac_f32 v96, v48, v28
    v_fmac_f32 v96, v49, v29
    v_fmac_f32 v96, v50, v30
    v_fmac_f32 v96, v51, v31
    s_waitcnt vmcnt(13)
    v_cvt_f32_i32 v24, v16
    v_cvt_f32_i32 v25, v17
    v_cvt_f32_i32 v26, v18
    v_cvt_f32_i32 v27, v19
    buffer_load_dwordx4 v[16:19], v1, s[24:27], s71 offen offset:256 nt
    v_fmac_f32 v96, v52, v24
    v_fmac_f32 v96, v53, v25
    v_fmac_f32 v96, v54, v26
    v_fmac_f32 v96, v55, v27
    s_nop 1
    v_add_f32_dpp v97, v96, v96 row_ror:8 row_mask:0xf bank_mask:0x3
    s_waitcnt vmcnt(13)
    v_cvt_f32_i32 v28, v20
    v_cvt_f32_i32 v29, v21
    v_cvt_f32_i32 v30, v22
    v_cvt_f32_i32 v31, v23
    buffer_load_dwordx4 v[20:23], v1, s[24:27], s71 offen offset:512 nt
    v_fma_f32 v96, v44, v28, -v88
    v_fmac_f32 v96, v45, v29
    v_fmac_f32 v96, v46, v30
    v_fmac_f32 v96, v47, v31
    s_waitcnt vmcnt(13)
    v_cvt_f32_i32 v24, v4
    v_cvt_f32_i32 v25, v5
    v_cvt_f32_i32 v26, v6
    v_cvt_f32_i32 v27, v7
    s_add_u32 s71, s71, 3072
    buffer_load_dwordx4 v[4:7], v1, s[24:27], s71 offen offset:0 nt
    v_fmac_f32 v96, v48, v24
    v_fmac_f32 v96, v49, v25
    v_fmac_f32 v96, v50, v26
    v_fmac_f32 v96, v51, v27
    s_waitcnt vmcnt(13)
    v_cvt_f32_i32 v28, v8
    v_cvt_f32_i32 v29, v9
    v_cvt_f32_i32 v30, v10
    v_cvt_f32_i32 v31, v11
    buffer_load_dwordx4 v[8:11], v1, s[24:27], s71 offen offset:256 nt
    v_fmac_f32 v96, v52, v28
    v_fmac_f32 v96, v53, v29
    v_fmac_f32 v96, v54, v30
    v_fmac_f32 v96, v55, v31
    s_nop 1
    v_add_f32_dpp v97, v96, v96 row_ror:8 row_mask:0xf bank_mask:0xc
    s_nop 1
    v_add_f32_dpp v98, v97, v97 row_shr:4 row_mask:0xf bank_mask:0xa
    s_nop 1
    v_add_f32_dpp v100, v98, v98 quad_perm:[2,3,0,1] row_mask:0xf bank_mask:0xf
    v_cndmask_b32 v100, v99, v100, s[64:65]
    s_nop 1
    v_add_f32_dpp v99, v100, v100 quad_perm:[1,0,3,2] row_mask:0xf bank_mask:0xf
    v_cndmask_b32 v101, v101, v99, s[66:67]
    ds_write_b32 v104, v101
    v_add_u32 v104, 256, v104
    s_waitcnt vmcnt(11)
    v_lshlrev_b32 v32, 16, v68
    v_and_b32 v33, 0xffff0000, v68
    v_lshlrev_b32 v34, 16, v69
    v_and_b32 v35, 0xffff0000, v69
    v_lshlrev_b32 v36, 16, v70
    v_and_b32 v37, 0xffff0000, v70
    v_lshlrev_b32 v38, 16, v71
    v_and_b32 v39, 0xffff0000, v71
    v_lshlrev_b32 v40, 16, v72
    v_and_b32 v41, 0xffff0000, v72
    v_lshlrev_b32 v42, 16, v73
    v_and_b32 v43, 0xffff0000, v73
    v_mul_f32 v32, s78, v32
    v_mul_f32 v33, s78, v33
    v_mul_f32 v34, s78, v34
    v_mul_f32 v35, s78, v35
    v_mul_f32 v36, s78, v36
    v_mul_f32 v37, s78, v37
    v_mul_f32 v38, s78, v38
    v_mul_f32 v39, s78, v39
    v_mul_f32 v40, s78, v40
    v_mul_f32 v41, s78, v41
    v_mul_f32 v42, s78, v42
    v_mul_f32 v43, s78, v43
    s_waitcnt vmcnt(5)
    v_lshlrev_b32 v102, 16, v56
    v_and_b32 v103, 0xffff0000, v56
    v_mul_f32 v44, v102, v32
    v_mul_f32 v45, v103, v33
    v_lshlrev_b32 v102, 16, v62
    v_and_b32 v103, 0xffff0000, v62
    v_mul_f32 v88, v44, v102
    v_fmac_f32 v88, v45, v103
    v_lshlrev_b32 v102, 16, v57
    v_and_b32 v103, 0xffff0000, v57
    v_mul_f32 v46, v102, v34
    v_mul_f32 v47, v103, v35
    v_lshlrev_b32 v102, 16, v63
    v_and_b32 v103, 0xffff0000, v63
    v_fmac_f32 v88, v46, v102
    v_fmac_f32 v88, v47, v103
    v_lshlrev_b32 v102, 16, v58
    v_and_b32 v103, 0xffff0000, v58
    v_mul_f32 v48, v102, v36
    v_mul_f32 v49, v103, v37
    v_lshlrev_b32 v102, 16, v64
    v_and_b32 v103, 0xffff0000, v64
    v_fmac_f32 v88, v48, v102
    v_fmac_f32 v88, v49, v103
    v_lshlrev_b32 v102, 16, v59
    v_and_b32 v103, 0xffff0000, v59
    v_mul_f32 v50, v102, v38
    v_mul_f32 v51, v103, v39
    v_lshlrev_b32 v102, 16, v65
    v_and_b32 v103, 0xffff0000, v65
    v_fmac_f32 v88, v50, v102
    v_fmac_f32 v88, v51, v103
    v_lshlrev_b32 v102, 16, v60
    v_and_b32 v103, 0xffff0000, v60
    v_mul_f32 v52, v102, v40
    v_mul_f32 v53, v103, v41
    v_lshlrev_b32 v102, 16, v66
    v_and_b32 v103, 0xffff0000, v66
    v_fmac_f32 v88, v52, v102
    v_fmac_f32 v88, v53, v103
    v_lshlrev_b32 v102, 16, v61
    v_and_b32 v103, 0xffff0000, v61
    v_mul_f32 v54, v102, v42
    v_mul_f32 v55, v103, v43
    v_lshlrev_b32 v102, 16, v67
    v_and_b32 v103, 0xffff0000, v67
    v_fmac_f32 v88, v54, v102
    v_fmac_f32 v88, v55, v103
    s_waitcnt vmcnt(4)
    v_cvt_f32_i32 v24, v12
    v_cvt_f32_i32 v25, v13
    v_cvt_f32_i32 v26, v14
    v_cvt_f32_i32 v27, v15
    buffer_load_dwordx4 v[12:15], v1, s[24:27], s71 offen offset:512 nt
    v_fma_f32 v96, v44, v24, -v88
    v_fmac_f32 v96, v45, v25
    v_fmac_f32 v96, v46, v26
    v_fmac_f32 v96, v47, v27
    s_waitcnt vmcnt(4)
    v_cvt_f32_i32 v28, v16
    v_cvt_f32_i32 v29, v17
    v_cvt_f32_i32 v30, v18
    v_cvt_f32_i32 v31, v19
    s_add_u32 s71, s71, 3072
    buffer_load_dwordx4 v[16:19], v1, s[24:27], s71 offen offset:0 nt
    v_fmac_f32 v96, v48, v28
    v_fmac_f32 v96, v49, v29
    v_fmac_f32 v96, v50, v30
    v_fmac_f32 v96, v51, v31
    s_waitcnt vmcnt(4)
    v_cvt_f32_i32 v24, v20
    v_cvt_f32_i32 v25, v21
    v_cvt_f32_i32 v26, v22
    v_cvt_f32_i32 v27, v23
    buffer_load_dwordx4 v[20:23], v1, s[24:27], s71 offen offset:256 nt
    v_fmac_f32 v96, v52, v24
    v_fmac_f32 v96, v53, v25
    v_fmac_f32 v96, v54, v26
    v_fmac_f32 v96, v55, v27
    s_nop 1
    v_add_f32_dpp v97, v96, v96 row_ror:8 row_mask:0xf bank_mask:0x3
    s_waitcnt vmcnt(4)
    v_cvt_f32_i32 v28, v4
    v_cvt_f32_i32 v29, v5
    v_cvt_f32_i32 v30, v6
    v_cvt_f32_i32 v31, v7
    buffer_load_dwordx4 v[4:7], v1, s[24:27], s71 offen offset:512 nt
    v_fma_f32 v96, v44, v28, -v88
    v_fmac_f32 v96, v45, v29
    v_fmac_f32 v96, v46, v30
    v_fmac_f32 v96, v47, v31
    s_waitcnt vmcnt(4)
    v_cvt_f32_i32 v24, v8
    v_cvt_f32_i32 v25, v9
    v_cvt_f32_i32 v26, v10
    v_cvt_f32_i32 v27, v11
    s_add_u32 s71, s71, 3072
    buffer_load_dwordx4 v[8:11], v1, s[24:27], s71 offen offset:0 nt
    v_fmac_f32 v96, v48, v24
    v_fmac_f32 v96, v49, v25
    v_fmac_f32 v96, v50, v26
    v_fmac_f32 v96, v51, v27
    s_waitcnt vmcnt(4)
    v_cvt_f32_i32 v28, v12
    v_cvt_f32_i32 v29, v13
    v_cvt_f32_i32 v30, v14
    v_cvt_f32_i32 v31, v15
    buffer_load_dwordx4 v[12:15], v1, s[24:27], s71 offen offset:256 nt
    v_fmac_f32 v96, v52, v28
    v_fmac_f32 v96, v53, v29
    v_fmac_f32 v96, v54, v30
    v_fmac_f32 v96, v55, v31
    s_nop 1
    v_add_f32_dpp v97, v96, v96 row_ror:8 row_mask:0xf bank_mask:0xc
    s_nop 1
    v_add_f32_dpp v98, v97, v97 row_shl:4 row_mask:0xf bank_mask:0x5
    s_waitcnt vmcnt(4)
    v_cvt_f32_i32 v24, v16
    v_cvt_f32_i32 v25, v17
    v_cvt_f32_i32 v26, v18
    v_cvt_f32_i32 v27, v19
    buffer_load_dwordx4 v[16:19], v1, s[24:27], s71 offen offset:512 nt
    v_fma_f32 v96, v44, v24, -v88
    v_fmac_f32 v96, v45, v25
    v_fmac_f32 v96, v46, v26
    v_fmac_f32 v96, v47, v27
    s_waitcnt vmcnt(4)
    v_cvt_f32_i32 v28, v20
    v_cvt_f32_i32 v29, v21
    v_cvt_f32_i32 v30, v22
    v_cvt_f32_i32 v31, v23
    s_add_u32 s70, s70, 64
    s_mul_i32 s71, s70, 49152
    s_mul_i32 s72, s70, 384
    buffer_load_dwordx2 v[56:57], v2, s[32:35], s72 offen offset:0
    buffer_load_dwordx2 v[58:59], v2, s[32:35], s72 offen offset:128
    buffer_load_dwordx2 v[60:61], v2, s[32:35], s72 offen offset:256
    buffer_load_dwordx2 v[62:63], v2, s[36:39], s72 offen offset:0
    buffer_load_dwordx2 v[64:65], v2, s[36:39], s72 offen offset:128
    buffer_load_dwordx2 v[66:67], v2, s[36:39], s72 offen offset:256
    buffer_load_dwordx4 v[20:23], v1, s[24:27], s71 offen offset:0 nt
    v_fmac_f32 v96, v48, v28
    v_fmac_f32 v96, v49, v29
    v_fmac_f32 v96, v50, v30
    v_fmac_f32 v96, v51, v31
    s_waitcnt vmcnt(10)
    v_cvt_f32_i32 v24, v4
    v_cvt_f32_i32 v25, v5
    v_cvt_f32_i32 v26, v6
    v_cvt_f32_i32 v27, v7
    buffer_load_dwordx4 v[4:7], v1, s[24:27], s71 offen offset:256 nt
    v_fmac_f32 v96, v52, v24
    v_fmac_f32 v96, v53, v25
    v_fmac_f32 v96, v54, v26
    v_fmac_f32 v96, v55, v27
    s_nop 1
    v_add_f32_dpp v97, v96, v96 row_ror:8 row_mask:0xf bank_mask:0x3
    s_waitcnt vmcnt(10)
    v_cvt_f32_i32 v28, v8
    v_cvt_f32_i32 v29, v9
    v_cvt_f32_i32 v30, v10
    v_cvt_f32_i32 v31, v11
    buffer_load_dwordx4 v[8:11], v1, s[24:27], s71 offen offset:512 nt
    v_fma_f32 v96, v44, v28, -v88
    v_fmac_f32 v96, v45, v29
    v_fmac_f32 v96, v46, v30
    v_fmac_f32 v96, v47, v31
    s_waitcnt vmcnt(10)
    v_cvt_f32_i32 v24, v12
    v_cvt_f32_i32 v25, v13
    v_cvt_f32_i32 v26, v14
    v_cvt_f32_i32 v27, v15
    s_add_u32 s71, s71, 3072
    buffer_load_dwordx4 v[12:15], v1, s[24:27], s71 offen offset:0 nt
    v_fmac_f32 v96, v48, v24
    v_fmac_f32 v96, v49, v25
    v_fmac_f32 v96, v50, v26
    v_fmac_f32 v96, v51, v27
    s_waitcnt vmcnt(10)
    v_cvt_f32_i32 v28, v16
    v_cvt_f32_i32 v29, v17
    v_cvt_f32_i32 v30, v18
    v_cvt_f32_i32 v31, v19
    buffer_load_dwordx4 v[16:19], v1, s[24:27], s71 offen offset:256 nt
    v_fmac_f32 v96, v52, v28
    v_fmac_f32 v96, v53, v29
    v_fmac_f32 v96, v54, v30
    v_fmac_f32 v96, v55, v31
    s_nop 1
    v_add_f32_dpp v97, v96, v96 row_ror:8 row_mask:0xf bank_mask:0xc
    s_nop 1
    v_add_f32_dpp v98, v97, v97 row_shr:4 row_mask:0xf bank_mask:0xa
    s_nop 1
    v_add_f32_dpp v99, v98, v98 quad_perm:[2,3,0,1] row_mask:0xf bank_mask:0xf
    s_waitcnt vmcnt(5)
    v_lshlrev_b32 v102, 16, v56
    v_and_b32 v103, 0xffff0000, v56
    v_mul_f32 v44, v102, v32
    v_mul_f32 v45, v103, v33
    v_lshlrev_b32 v102, 16, v62
    v_and_b32 v103, 0xffff0000, v62
    v_mul_f32 v88, v44, v102
    v_fmac_f32 v88, v45, v103
    v_lshlrev_b32 v102, 16, v57
    v_and_b32 v103, 0xffff0000, v57
    v_mul_f32 v46, v102, v34
    v_mul_f32 v47, v103, v35
    v_lshlrev_b32 v102, 16, v63
    v_and_b32 v103, 0xffff0000, v63
    v_fmac_f32 v88, v46, v102
    v_fmac_f32 v88, v47, v103
    v_lshlrev_b32 v102, 16, v58
    v_and_b32 v103, 0xffff0000, v58
    v_mul_f32 v48, v102, v36
    v_mul_f32 v49, v103, v37
    v_lshlrev_b32 v102, 16, v64
    v_and_b32 v103, 0xffff0000, v64
    v_fmac_f32 v88, v48, v102
    v_fmac_f32 v88, v49, v103
    v_lshlrev_b32 v102, 16, v59
    v_and_b32 v103, 0xffff0000, v59
    v_mul_f32 v50, v102, v38
    v_mul_f32 v51, v103, v39
    v_lshlrev_b32 v102, 16, v65
    v_and_b32 v103, 0xffff0000, v65
    v_fmac_f32 v88, v50, v102
    v_fmac_f32 v88, v51, v103
    v_lshlrev_b32 v102, 16, v60
    v_and_b32 v103, 0xffff0000, v60
    v_mul_f32 v52, v102, v40
    v_mul_f32 v53, v103, v41
    v_lshlrev_b32 v102, 16, v66
    v_and_b32 v103, 0xffff0000, v66
    v_fmac_f32 v88, v52, v102
    v_fmac_f32 v88, v53, v103
    v_lshlrev_b32 v102, 16, v61
    v_and_b32 v103, 0xffff0000, v61
    v_mul_f32 v54, v102, v42
    v_mul_f32 v55, v103, v43
    v_lshlrev_b32 v102, 16, v67
    v_and_b32 v103, 0xffff0000, v67
    v_fmac_f32 v88, v54, v102
    v_fmac_f32 v88, v55, v103
    s_waitcnt vmcnt(4)
    v_cvt_f32_i32 v24, v20
    v_cvt_f32_i32 v25, v21
    v_cvt_f32_i32 v26, v22
    v_cvt_f32_i32 v27, v23
    buffer_load_dwordx4 v[20:23], v1, s[24:27], s71 offen offset:512 nt
    v_fma_f32 v96, v44, v24, -v88
    v_fmac_f32 v96, v45, v25
    v_fmac_f32 v96, v46, v26
    v_fmac_f32 v96, v47, v27
    s_waitcnt vmcnt(4)
    v_cvt_f32_i32 v28, v4
    v_cvt_f32_i32 v29, v5
    v_cvt_f32_i32 v30, v6
    v_cvt_f32_i32 v31, v7
    s_add_u32 s71, s71, 3072
    buffer_load_dwordx4 v[4:7], v1, s[24:27], s71 offen offset:0 nt
    v_fmac_f32 v96, v48, v28
    v_fmac_f32 v96, v49, v29
    v_fmac_f32 v96, v50, v30
    v_fmac_f32 v96, v51, v31
    s_waitcnt vmcnt(4)
    v_cvt_f32_i32 v24, v8
    v_cvt_f32_i32 v25, v9
    v_cvt_f32_i32 v26, v10
    v_cvt_f32_i32 v27, v11
    buffer_load_dwordx4 v[8:11], v1, s[24:27], s71 offen offset:256 nt
    v_fmac_f32 v96, v52, v24
    v_fmac_f32 v96, v53, v25
    v_fmac_f32 v96, v54, v26
    v_fmac_f32 v96, v55, v27
    s_nop 1
    v_add_f32_dpp v97, v96, v96 row_ror:8 row_mask:0xf bank_mask:0x3
    s_waitcnt vmcnt(4)
    v_cvt_f32_i32 v28, v12
    v_cvt_f32_i32 v29, v13
    v_cvt_f32_i32 v30, v14
    v_cvt_f32_i32 v31, v15
    buffer_load_dwordx4 v[12:15], v1, s[24:27], s71 offen offset:512 nt
    v_fma_f32 v96, v44, v28, -v88
    v_fmac_f32 v96, v45, v29
    v_fmac_f32 v96, v46, v30
    v_fmac_f32 v96, v47, v31
    s_waitcnt vmcnt(4)
    v_cvt_f32_i32 v24, v16
    v_cvt_f32_i32 v25, v17
    v_cvt_f32_i32 v26, v18
    v_cvt_f32_i32 v27, v19
    s_add_u32 s71, s71, 3072
    buffer_load_dwordx4 v[16:19], v1, s[24:27], s71 offen offset:0 nt
    v_fmac_f32 v96, v48, v24
    v_fmac_f32 v96, v49, v25
    v_fmac_f32 v96, v50, v26
    v_fmac_f32 v96, v51, v27
    s_waitcnt vmcnt(4)
    v_cvt_f32_i32 v28, v20
    v_cvt_f32_i32 v29, v21
    v_cvt_f32_i32 v30, v22
    v_cvt_f32_i32 v31, v23
    buffer_load_dwordx4 v[20:23], v1, s[24:27], s71 offen offset:256 nt
    v_fmac_f32 v96, v52, v28
    v_fmac_f32 v96, v53, v29
    v_fmac_f32 v96, v54, v30
    v_fmac_f32 v96, v55, v31
    s_nop 1
    v_add_f32_dpp v97, v96, v96 row_ror:8 row_mask:0xf bank_mask:0xc
    s_nop 1
    v_add_f32_dpp v98, v97, v97 row_shl:4 row_mask:0xf bank_mask:0x5
    s_waitcnt vmcnt(4)
    v_cvt_f32_i32 v24, v4
    v_cvt_f32_i32 v25, v5
    v_cvt_f32_i32 v26, v6
    v_cvt_f32_i32 v27, v7
    buffer_load_dwordx4 v[4:7], v1, s[24:27], s71 offen offset:512 nt
    v_fma_f32 v96, v44, v24, -v88
    v_fmac_f32 v96, v45, v25
    v_fmac_f32 v96, v46, v26
    v_fmac_f32 v96, v47, v27
    s_waitcnt vmcnt(4)
    v_cvt_f32_i32 v28, v8
    v_cvt_f32_i32 v29, v9
    v_cvt_f32_i32 v30, v10
    v_cvt_f32_i32 v31, v11
    s_add_u32 s70, s70, 64
    s_mul_i32 s71, s70, 49152
    s_mul_i32 s72, s70, 384
    buffer_load_dwordx2 v[56:57], v2, s[32:35], s72 offen offset:0
    buffer_load_dwordx2 v[58:59], v2, s[32:35], s72 offen offset:128
    buffer_load_dwordx2 v[60:61], v2, s[32:35], s72 offen offset:256
    buffer_load_dwordx2 v[62:63], v2, s[36:39], s72 offen offset:0
    buffer_load_dwordx2 v[64:65], v2, s[36:39], s72 offen offset:128
    buffer_load_dwordx2 v[66:67], v2, s[36:39], s72 offen offset:256
    buffer_load_dwordx4 v[8:11], v1, s[24:27], s71 offen offset:0 nt
    v_fmac_f32 v96, v48, v28
    v_fmac_f32 v96, v49, v29
    v_fmac_f32 v96, v50, v30
    v_fmac_f32 v96, v51, v31
    s_waitcnt vmcnt(10)
    v_cvt_f32_i32 v24, v12
    v_cvt_f32_i32 v25, v13
    v_cvt_f32_i32 v26, v14
    v_cvt_f32_i32 v27, v15
    buffer_load_dwordx4 v[12:15], v1, s[24:27], s71 offen offset:256 nt
    v_fmac_f32 v96, v52, v24
    v_fmac_f32 v96, v53, v25
    v_fmac_f32 v96, v54, v26
    v_fmac_f32 v96, v55, v27
    s_nop 1
    v_add_f32_dpp v97, v96, v96 row_ror:8 row_mask:0xf bank_mask:0x3
    s_waitcnt vmcnt(10)
    v_cvt_f32_i32 v28, v16
    v_cvt_f32_i32 v29, v17
    v_cvt_f32_i32 v30, v18
    v_cvt_f32_i32 v31, v19
    buffer_load_dwordx4 v[16:19], v1, s[24:27], s71 offen offset:512 nt
    v_fma_f32 v96, v44, v28, -v88
    v_fmac_f32 v96, v45, v29
    v_fmac_f32 v96, v46, v30
    v_fmac_f32 v96, v47, v31
    s_waitcnt vmcnt(10)
    v_cvt_f32_i32 v24, v20
    v_cvt_f32_i32 v25, v21
    v_cvt_f32_i32 v26, v22
    v_cvt_f32_i32 v27, v23
    s_add_u32 s71, s71, 3072
    buffer_load_dwordx4 v[20:23], v1, s[24:27], s71 offen offset:0 nt
    v_fmac_f32 v96, v48, v24
    v_fmac_f32 v96, v49, v25
    v_fmac_f32 v96, v50, v26
    v_fmac_f32 v96, v51, v27
    s_waitcnt vmcnt(10)
    v_cvt_f32_i32 v28, v4
    v_cvt_f32_i32 v29, v5
    v_cvt_f32_i32 v30, v6
    v_cvt_f32_i32 v31, v7
    buffer_load_dwordx4 v[4:7], v1, s[24:27], s71 offen offset:256 nt
    v_fmac_f32 v96, v52, v28
    v_fmac_f32 v96, v53, v29
    v_fmac_f32 v96, v54, v30
    v_fmac_f32 v96, v55, v31
    s_nop 1
    v_add_f32_dpp v97, v96, v96 row_ror:8 row_mask:0xf bank_mask:0xc
    s_nop 1
    v_add_f32_dpp v98, v97, v97 row_shr:4 row_mask:0xf bank_mask:0xa
    s_nop 1
    v_add_f32_dpp v100, v98, v98 quad_perm:[2,3,0,1] row_mask:0xf bank_mask:0xf
    v_cndmask_b32 v100, v99, v100, s[64:65]
    s_nop 1
    v_add_f32_dpp v101, v100, v100 quad_perm:[1,0,3,2] row_mask:0xf bank_mask:0xf
    s_waitcnt vmcnt(5)
    v_lshlrev_b32 v102, 16, v56
    v_and_b32 v103, 0xffff0000, v56
    v_mul_f32 v44, v102, v32
    v_mul_f32 v45, v103, v33
    v_lshlrev_b32 v102, 16, v62
    v_and_b32 v103, 0xffff0000, v62
    v_mul_f32 v88, v44, v102
    v_fmac_f32 v88, v45, v103
    v_lshlrev_b32 v102, 16, v57
    v_and_b32 v103, 0xffff0000, v57
    v_mul_f32 v46, v102, v34
    v_mul_f32 v47, v103, v35
    v_lshlrev_b32 v102, 16, v63
    v_and_b32 v103, 0xffff0000, v63
    v_fmac_f32 v88, v46, v102
    v_fmac_f32 v88, v47, v103
    v_lshlrev_b32 v102, 16, v58
    v_and_b32 v103, 0xffff0000, v58
    v_mul_f32 v48, v102, v36
    v_mul_f32 v49, v103, v37
    v_lshlrev_b32 v102, 16, v64
    v_and_b32 v103, 0xffff0000, v64
    v_fmac_f32 v88, v48, v102
    v_fmac_f32 v88, v49, v103
    v_lshlrev_b32 v102, 16, v59
    v_and_b32 v103, 0xffff0000, v59
    v_mul_f32 v50, v102, v38
    v_mul_f32 v51, v103, v39
    v_lshlrev_b32 v102, 16, v65
    v_and_b32 v103, 0xffff0000, v65
    v_fmac_f32 v88, v50, v102
    v_fmac_f32 v88, v51, v103
    v_lshlrev_b32 v102, 16, v60
    v_and_b32 v103, 0xffff0000, v60
    v_mul_f32 v52, v102, v40
    v_mul_f32 v53, v103, v41
    v_lshlrev_b32 v102, 16, v66
    v_and_b32 v103, 0xffff0000, v66
    v_fmac_f32 v88, v52, v102
    v_fmac_f32 v88, v53, v103
    v_lshlrev_b32 v102, 16, v61
    v_and_b32 v103, 0xffff0000, v61
    v_mul_f32 v54, v102, v42
    v_mul_f32 v55, v103, v43
    v_lshlrev_b32 v102, 16, v67
    v_and_b32 v103, 0xffff0000, v67
    v_fmac_f32 v88, v54, v102
    v_fmac_f32 v88, v55, v103
    s_waitcnt vmcnt(4)
    v_cvt_f32_i32 v24, v8
    v_cvt_f32_i32 v25, v9
    v_cvt_f32_i32 v26, v10
    v_cvt_f32_i32 v27, v11
    buffer_load_dwordx4 v[8:11], v1, s[24:27], s71 offen offset:512 nt
    v_fma_f32 v96, v44, v24, -v88
    v_fmac_f32 v96, v45, v25
    v_fmac_f32 v96, v46, v26
    v_fmac_f32 v96, v47, v27
    s_waitcnt vmcnt(4)
    v_cvt_f32_i32 v28, v12
    v_cvt_f32_i32 v29, v13
    v_cvt_f32_i32 v30, v14
    v_cvt_f32_i32 v31, v15
    s_add_u32 s71, s71, 3072
    buffer_load_dwordx4 v[12:15], v1, s[24:27], s71 offen offset:0 nt
    v_fmac_f32 v96, v48, v28
    v_fmac_f32 v96, v49, v29
    v_fmac_f32 v96, v50, v30
    v_fmac_f32 v96, v51, v31
    s_waitcnt vmcnt(4)
    v_cvt_f32_i32 v24, v16
    v_cvt_f32_i32 v25, v17
    v_cvt_f32_i32 v26, v18
    v_cvt_f32_i32 v27, v19
    buffer_load_dwordx4 v[16:19], v1, s[24:27], s71 offen offset:256 nt
    v_fmac_f32 v96, v52, v24
    v_fmac_f32 v96, v53, v25
    v_fmac_f32 v96, v54, v26
    v_fmac_f32 v96, v55, v27
    s_nop 1
    v_add_f32_dpp v97, v96, v96 row_ror:8 row_mask:0xf bank_mask:0x3
    s_waitcnt vmcnt(4)
    v_cvt_f32_i32 v28, v20
    v_cvt_f32_i32 v29, v21
    v_cvt_f32_i32 v30, v22
    v_cvt_f32_i32 v31, v23
    buffer_load_dwordx4 v[20:23], v1, s[24:27], s71 offen offset:512 nt
    v_fma_f32 v96, v44, v28, -v88
    v_fmac_f32 v96, v45, v29
    v_fmac_f32 v96, v46, v30
    v_fmac_f32 v96, v47, v31
    s_waitcnt vmcnt(4)
    v_cvt_f32_i32 v24, v4
    v_cvt_f32_i32 v25, v5
    v_cvt_f32_i32 v26, v6
    v_cvt_f32_i32 v27, v7
    s_add_u32 s71, s71, 3072
    buffer_load_dwordx4 v[4:7], v1, s[24:27], s71 offen offset:0 nt
    v_fmac_f32 v96, v48, v24
    v_fmac_f32 v96, v49, v25
    v_fmac_f32 v96, v50, v26
    v_fmac_f32 v96, v51, v27
    s_waitcnt vmcnt(4)
    v_cvt_f32_i32 v28, v8
    v_cvt_f32_i32 v29, v9
    v_cvt_f32_i32 v30, v10
    v_cvt_f32_i32 v31, v11
    buffer_load_dwordx4 v[8:11], v1, s[24:27], s71 offen offset:256 nt
    v_fmac_f32 v96, v52, v28
    v_fmac_f32 v96, v53, v29
    v_fmac_f32 v96, v54, v30
    v_fmac_f32 v96, v55, v31
    s_nop 1
    v_add_f32_dpp v97, v96, v96 row_ror:8 row_mask:0xf bank_mask:0xc
    s_nop 1
    v_add_f32_dpp v98, v97, v97 row_shl:4 row_mask:0xf bank_mask:0x5
    s_waitcnt vmcnt(4)
    v_cvt_f32_i32 v24, v12
    v_cvt_f32_i32 v25, v13
    v_cvt_f32_i32 v26, v14
    v_cvt_f32_i32 v27, v15
    buffer_load_dwordx4 v[12:15], v1, s[24:27], s71 offen offset:512 nt
    v_fma_f32 v96, v44, v24, -v88
    v_fmac_f32 v96, v45, v25
    v_fmac_f32 v96, v46, v26
    v_fmac_f32 v96, v47, v27
    s_waitcnt vmcnt(4)
    v_cvt_f32_i32 v28, v16
    v_cvt_f32_i32 v29, v17
    v_cvt_f32_i32 v30, v18
    v_cvt_f32_i32 v31, v19
    s_add_u32 s70, s70, 64
    s_mul_i32 s71, s70, 49152
    s_mul_i32 s72, s70, 384
    buffer_load_dwordx2 v[56:57], v2, s[32:35], s72 offen offset:0
    buffer_load_dwordx2 v[58:59], v2, s[32:35], s72 offen offset:128
    buffer_load_dwordx2 v[60:61], v2, s[32:35], s72 offen offset:256
    buffer_load_dwordx2 v[62:63], v2, s[36:39], s72 offen offset:0
    buffer_load_dwordx2 v[64:65], v2, s[36:39], s72 offen offset:128
    buffer_load_dwordx2 v[66:67], v2, s[36:39], s72 offen offset:256
    buffer_load_dwordx4 v[16:19], v1, s[24:27], s71 offen offset:0 nt
    v_fmac_f32 v96, v48, v28
    v_fmac_f32 v96, v49, v29
    v_fmac_f32 v96, v50, v30
    v_fmac_f32 v96, v51, v31
    s_waitcnt vmcnt(10)
    v_cvt_f32_i32 v24, v20
    v_cvt_f32_i32 v25, v21
    v_cvt_f32_i32 v26, v22
    v_cvt_f32_i32 v27, v23
    buffer_load_dwordx4 v[20:23], v1, s[24:27], s71 offen offset:256 nt
    v_fmac_f32 v96, v52, v24
    v_fmac_f32 v96, v53, v25
    v_fmac_f32 v96, v54, v26
    v_fmac_f32 v96, v55, v27
    s_nop 1
    v_add_f32_dpp v97, v96, v96 row_ror:8 row_mask:0xf bank_mask:0x3
    s_waitcnt vmcnt(10)
    v_cvt_f32_i32 v28, v4
    v_cvt_f32_i32 v29, v5
    v_cvt_f32_i32 v30, v6
    v_cvt_f32_i32 v31, v7
    buffer_load_dwordx4 v[4:7], v1, s[24:27], s71 offen offset:512 nt
    v_fma_f32 v96, v44, v28, -v88
    v_fmac_f32 v96, v45, v29
    v_fmac_f32 v96, v46, v30
    v_fmac_f32 v96, v47, v31
    s_waitcnt vmcnt(10)
    v_cvt_f32_i32 v24, v8
    v_cvt_f32_i32 v25, v9
    v_cvt_f32_i32 v26, v10
    v_cvt_f32_i32 v27, v11
    s_add_u32 s71, s71, 3072
    buffer_load_dwordx4 v[8:11], v1, s[24:27], s71 offen offset:0 nt
    v_fmac_f32 v96, v48, v24
    v_fmac_f32 v96, v49, v25
    v_fmac_f32 v96, v50, v26
    v_fmac_f32 v96, v51, v27
    s_waitcnt vmcnt(10)
    v_cvt_f32_i32 v28, v12
    v_cvt_f32_i32 v29, v13
    v_cvt_f32_i32 v30, v14
    v_cvt_f32_i32 v31, v15
    buffer_load_dwordx4 v[12:15], v1, s[24:27], s71 offen offset:256 nt
    v_fmac_f32 v96, v52, v28
    v_fmac_f32 v96, v53, v29
    v_fmac_f32 v96, v54, v30
    v_fmac_f32 v96, v55, v31
    s_nop 1
    v_add_f32_dpp v97, v96, v96 row_ror:8 row_mask:0xf bank_mask:0xc
    s_nop 1
    v_add_f32_dpp v98, v97, v97 row_shr:4 row_mask:0xf bank_mask:0xa
    s_nop 1
    v_add_f32_dpp v99, v98, v98 quad_perm:[2,3,0,1] row_mask:0xf bank_mask:0xf
    s_waitcnt vmcnt(5)
    v_lshlrev_b32 v102, 16, v56
    v_and_b32 v103, 0xffff0000, v56
    v_mul_f32 v44, v102, v32
    v_mul_f32 v45, v103, v33
    v_lshlrev_b32 v102, 16, v62
    v_and_b32 v103, 0xffff0000, v62
    v_mul_f32 v88, v44, v102
    v_fmac_f32 v88, v45, v103
    v_lshlrev_b32 v102, 16, v57
    v_and_b32 v103, 0xffff0000, v57
    v_mul_f32 v46, v102, v34
    v_mul_f32 v47, v103, v35
    v_lshlrev_b32 v102, 16, v63
    v_and_b32 v103, 0xffff0000, v63
    v_fmac_f32 v88, v46, v102
    v_fmac_f32 v88, v47, v103
    v_lshlrev_b32 v102, 16, v58
    v_and_b32 v103, 0xffff0000, v58
    v_mul_f32 v48, v102, v36
    v_mul_f32 v49, v103, v37
    v_lshlrev_b32 v102, 16, v64
    v_and_b32 v103, 0xffff0000, v64
    v_fmac_f32 v88, v48, v102
    v_fmac_f32 v88, v49, v103
    v_lshlrev_b32 v102, 16, v59
    v_and_b32 v103, 0xffff0000, v59
    v_mul_f32 v50, v102, v38
    v_mul_f32 v51, v103, v39
    v_lshlrev_b32 v102, 16, v65
    v_and_b32 v103, 0xffff0000, v65
    v_fmac_f32 v88, v50, v102
    v_fmac_f32 v88, v51, v103
    v_lshlrev_b32 v102, 16, v60
    v_and_b32 v103, 0xffff0000, v60
    v_mul_f32 v52, v102, v40
    v_mul_f32 v53, v103, v41
    v_lshlrev_b32 v102, 16, v66
    v_and_b32 v103, 0xffff0000, v66
    v_fmac_f32 v88, v52, v102
    v_fmac_f32 v88, v53, v103
    v_lshlrev_b32 v102, 16, v61
    v_and_b32 v103, 0xffff0000, v61
    v_mul_f32 v54, v102, v42
    v_mul_f32 v55, v103, v43
    v_lshlrev_b32 v102, 16, v67
    v_and_b32 v103, 0xffff0000, v67
    v_fmac_f32 v88, v54, v102
    v_fmac_f32 v88, v55, v103
    s_waitcnt vmcnt(4)
    v_cvt_f32_i32 v24, v16
    v_cvt_f32_i32 v25, v17
    v_cvt_f32_i32 v26, v18
    v_cvt_f32_i32 v27, v19
    buffer_load_dwordx4 v[16:19], v1, s[24:27], s71 offen offset:512 nt
    v_fma_f32 v96, v44, v24, -v88
    v_fmac_f32 v96, v45, v25
    v_fmac_f32 v96, v46, v26
    v_fmac_f32 v96, v47, v27
    s_waitcnt vmcnt(4)
    v_cvt_f32_i32 v28, v20
    v_cvt_f32_i32 v29, v21
    v_cvt_f32_i32 v30, v22
    v_cvt_f32_i32 v31, v23
    s_add_u32 s71, s71, 3072
    buffer_load_dwordx4 v[20:23], v1, s[24:27], s71 offen offset:0 nt
    v_fmac_f32 v96, v48, v28
    v_fmac_f32 v96, v49, v29
    v_fmac_f32 v96, v50, v30
    v_fmac_f32 v96, v51, v31
    s_waitcnt vmcnt(4)
    v_cvt_f32_i32 v24, v4
    v_cvt_f32_i32 v25, v5
    v_cvt_f32_i32 v26, v6
    v_cvt_f32_i32 v27, v7
    buffer_load_dwordx4 v[4:7], v1, s[24:27], s71 offen offset:256 nt
    v_fmac_f32 v96, v52, v24
    v_fmac_f32 v96, v53, v25
    v_fmac_f32 v96, v54, v26
    v_fmac_f32 v96, v55, v27
    s_nop 1
    v_add_f32_dpp v97, v96, v96 row_ror:8 row_mask:0xf bank_mask:0x3
    s_waitcnt vmcnt(4)
    v_cvt_f32_i32 v28, v8
    v_cvt_f32_i32 v29, v9
    v_cvt_f32_i32 v30, v10
    v_cvt_f32_i32 v31, v11
    buffer_load_dwordx4 v[8:11], v1, s[24:27], s71 offen offset:512 nt
    v_fma_f32 v96, v44, v28, -v88
    v_fmac_f32 v96, v45, v29
    v_fmac_f32 v96, v46, v30
    v_fmac_f32 v96, v47, v31
    s_waitcnt vmcnt(4)
    v_cvt_f32_i32 v24, v12
    v_cvt_f32_i32 v25, v13
    v_cvt_f32_i32 v26, v14
    v_cvt_f32_i32 v27, v15
    s_add_u32 s71, s71, 3072
    buffer_load_dwordx4 v[12:15], v1, s[24:27], s71 offen offset:0 nt
    v_fmac_f32 v96, v48, v24
    v_fmac_f32 v96, v49, v25
    v_fmac_f32 v96, v50, v26
    v_fmac_f32 v96, v51, v27
    s_waitcnt vmcnt(4)
    v_cvt_f32_i32 v28, v16
    v_cvt_f32_i32 v29, v17
    v_cvt_f32_i32 v30, v18
    v_cvt_f32_i32 v31, v19
    buffer_load_dwordx4 v[16:19], v1, s[24:27], s71 offen offset:256 nt
    v_fmac_f32 v96, v52, v28
    v_fmac_f32 v96, v53, v29
    v_fmac_f32 v96, v54, v30
    v_fmac_f32 v96, v55, v31
    s_nop 1
    v_add_f32_dpp v97, v96, v96 row_ror:8 row_mask:0xf bank_mask:0xc
    s_nop 1
    v_add_f32_dpp v98, v97, v97 row_shl:4 row_mask:0xf bank_mask:0x5
    s_waitcnt vmcnt(4)
    v_cvt_f32_i32 v24, v20
    v_cvt_f32_i32 v25, v21
    v_cvt_f32_i32 v26, v22
    v_cvt_f32_i32 v27, v23
    buffer_load_dwordx4 v[20:23], v1, s[24:27], s71 offen offset:512 nt
    v_fma_f32 v96, v44, v24, -v88
    v_fmac_f32 v96, v45, v25
    v_fmac_f32 v96, v46, v26
    v_fmac_f32 v96, v47, v27
    s_waitcnt vmcnt(4)
    v_cvt_f32_i32 v28, v4
    v_cvt_f32_i32 v29, v5
    v_cvt_f32_i32 v30, v6
    v_cvt_f32_i32 v31, v7
    s_add_u32 s70, s70, 64
    s_sub_u32 s75, s75, 1
    s_cmp_eq_u32 s75, 0
    s_cselect_b32 s80, 1536, 0
    s_cselect_b32 s75, 2, s75
    s_add_u32 s70, s70, s80
    s_lshr_b32 s74, s70, 9
    s_mul_i32 s74, s74, 384
    buffer_load_dwordx2 v[68:69], v2, s[48:51], s74 offen offset:0
    buffer_load_dwordx2 v[70:71], v2, s[48:51], s74 offen offset:128
    buffer_load_dwordx2 v[72:73], v2, s[48:51], s74 offen offset:256
    s_mul_i32 s71, s70, 49152
    s_mul_i32 s72, s70, 384
    buffer_load_dwordx2 v[56:57], v2, s[32:35], s72 offen offset:0
    buffer_load_dwordx2 v[58:59], v2, s[32:35], s72 offen offset:128
    buffer_load_dwordx2 v[60:61], v2, s[32:35], s72 offen offset:256
    buffer_load_dwordx2 v[62:63], v2, s[36:39], s72 offen offset:0
    buffer_load_dwordx2 v[64:65], v2, s[36:39], s72 offen offset:128
    buffer_load_dwordx2 v[66:67], v2, s[36:39], s72 offen offset:256
    buffer_load_dwordx4 v[4:7], v1, s[24:27], s71 offen offset:0 nt
    v_fmac_f32 v96, v48, v28
    v_fmac_f32 v96, v49, v29
    v_fmac_f32 v96, v50, v30
    v_fmac_f32 v96, v51, v31
    s_waitcnt vmcnt(13)
    v_cvt_f32_i32 v24, v8
    v_cvt_f32_i32 v25, v9
    v_cvt_f32_i32 v26, v10
    v_cvt_f32_i32 v27, v11
    buffer_load_dwordx4 v[8:11], v1, s[24:27], s71 offen offset:256 nt
    v_fmac_f32 v96, v52, v24
    v_fmac_f32 v96, v53, v25
    v_fmac_f32 v96, v54, v26
    v_fmac_f32 v96, v55, v27
    s_nop 1
    v_add_f32_dpp v97, v96, v96 row_ror:8 row_mask:0xf bank_mask:0x3
    s_waitcnt vmcnt(13)
    v_cvt_f32_i32 v28, v12
    v_cvt_f32_i32 v29, v13
    v_cvt_f32_i32 v30, v14
    v_cvt_f32_i32 v31, v15
    buffer_load_dwordx4 v[12:15], v1, s[24:27], s71 offen offset:512 nt
    v_fma_f32 v96, v44, v28, -v88
    v_fmac_f32 v96, v45, v29
    v_fmac_f32 v96, v46, v30
    v_fmac_f32 v96, v47, v31
    s_waitcnt vmcnt(13)
    v_cvt_f32_i32 v24, v16
    v_cvt_f32_i32 v25, v17
    v_cvt_f32_i32 v26, v18
    v_cvt_f32_i32 v27, v19
    s_add_u32 s71, s71, 3072
    buffer_load_dwordx4 v[16:19], v1, s[24:27], s71 offen offset:0 nt
    v_fmac_f32 v96, v48, v24
    v_fmac_f32 v96, v49, v25
    v_fmac_f32 v96, v50, v26
    v_fmac_f32 v96, v51, v27
    s_waitcnt vmcnt(13)
    v_cvt_f32_i32 v28, v20
    v_cvt_f32_i32 v29, v21
    v_cvt_f32_i32 v30, v22
    v_cvt_f32_i32 v31, v23
    buffer_load_dwordx4 v[20:23], v1, s[24:27], s71 offen offset:256 nt
    v_fmac_f32 v96, v52, v28
    v_fmac_f32 v96, v53, v29
    v_fmac_f32 v96, v54, v30
    v_fmac_f32 v96, v55, v31
    s_nop 1
    v_add_f32_dpp v97, v96, v96 row_ror:8 row_mask:0xf bank_mask:0xc
    s_nop 1
    v_add_f32_dpp v98, v97, v97 row_shr:4 row_mask:0xf bank_mask:0xa
    s_nop 1
    v_add_f32_dpp v100, v98, v98 quad_perm:[2,3,0,1] row_mask:0xf bank_mask:0xf
    v_cndmask_b32 v100, v99, v100, s[64:65]
    s_nop 1
    v_add_f32_dpp v99, v100, v100 quad_perm:[1,0,3,2] row_mask:0xf bank_mask:0xf
    v_cndmask_b32 v101, v101, v99, s[66:67]
    ds_write_b32 v104, v101
    v_add_u32 v104, 256, v104
    s_sub_u32 s76, s76, 1
    s_cmp_lg_u32 s76, 0
    s_cbranch_scc1 L_loop0
    s_waitcnt vmcnt(11)
    v_lshlrev_b32 v32, 16, v68
    v_and_b32 v33, 0xffff0000, v68
    v_lshlrev_b32 v34, 16, v69
    v_and_b32 v35, 0xffff0000, v69
    v_lshlrev_b32 v36, 16, v70
    v_and_b32 v37, 0xffff0000, v70
    v_lshlrev_b32 v38, 16, v71
    v_and_b32 v39, 0xffff0000, v71
    v_lshlrev_b32 v40, 16, v72
    v_and_b32 v41, 0xffff0000, v72
    v_lshlrev_b32 v42, 16, v73
    v_and_b32 v43, 0xffff0000, v73
    v_mul_f32 v32, s78, v32
    v_mul_f32 v33, s78, v33
    v_mul_f32 v34, s78, v34
    v_mul_f32 v35, s78, v35
    v_mul_f32 v36, s78, v36
    v_mul_f32 v37, s78, v37
    v_mul_f32 v38, s78, v38
    v_mul_f32 v39, s78, v39
    v_mul_f32 v40, s78, v40
    v_mul_f32 v41, s78, v41
    v_mul_f32 v42, s78, v42
    v_mul_f32 v43, s78, v43
    s_waitcnt vmcnt(5)
    v_lshlrev_b32 v102, 16, v56
    v_and_b32 v103, 0xffff0000, v56
    v_mul_f32 v44, v102, v32
    v_mul_f32 v45, v103, v33
    v_lshlrev_b32 v102, 16, v62
    v_and_b32 v103, 0xffff0000, v62
    v_mul_f32 v88, v44, v102
    v_fmac_f32 v88, v45, v103
    v_lshlrev_b32 v102, 16, v57
    v_and_b32 v103, 0xffff0000, v57
    v_mul_f32 v46, v102, v34
    v_mul_f32 v47, v103, v35
    v_lshlrev_b32 v102, 16, v63
    v_and_b32 v103, 0xffff0000, v63
    v_fmac_f32 v88, v46, v102
    v_fmac_f32 v88, v47, v103
    v_lshlrev_b32 v102, 16, v58
    v_and_b32 v103, 0xffff0000, v58
    v_mul_f32 v48, v102, v36
    v_mul_f32 v49, v103, v37
    v_lshlrev_b32 v102, 16, v64
    v_and_b32 v103, 0xffff0000, v64
    v_fmac_f32 v88, v48, v102
    v_fmac_f32 v88, v49, v103
    v_lshlrev_b32 v102, 16, v59
    v_and_b32 v103, 0xffff0000, v59
    v_mul_f32 v50, v102, v38
    v_mul_f32 v51, v103, v39
    v_lshlrev_b32 v102, 16, v65
    v_and_b32 v103, 0xffff0000, v65
    v_fmac_f32 v88, v50, v102
    v_fmac_f32 v88, v51, v103
    v_lshlrev_b32 v102, 16, v60
    v_and_b32 v103, 0xffff0000, v60
    v_mul_f32 v52, v102, v40
    v_mul_f32 v53, v103, v41
    v_lshlrev_b32 v102, 16, v66
    v_and_b32 v103, 0xffff0000, v66
    v_fmac_f32 v88, v52, v102
    v_fmac_f32 v88, v53, v103
    v_lshlrev_b32 v102, 16, v61
    v_and_b32 v103, 0xffff0000, v61
    v_mul_f32 v54, v102, v42
    v_mul_f32 v55, v103, v43
    v_lshlrev_b32 v102, 16, v67
    v_and_b32 v103, 0xffff0000, v67
    v_fmac_f32 v88, v54, v102
    v_fmac_f32 v88, v55, v103
    s_waitcnt vmcnt(4)
    v_cvt_f32_i32 v24, v4
    v_cvt_f32_i32 v25, v5
    v_cvt_f32_i32 v26, v6
    v_cvt_f32_i32 v27, v7
    buffer_load_dwordx4 v[4:7], v1, s[24:27], s71 offen offset:512 nt
    v_fma_f32 v96, v44, v24, -v88
    v_fmac_f32 v96, v45, v25
    v_fmac_f32 v96, v46, v26
    v_fmac_f32 v96, v47, v27
    s_waitcnt vmcnt(4)
    v_cvt_f32_i32 v28, v8
    v_cvt_f32_i32 v29, v9
    v_cvt_f32_i32 v30, v10
    v_cvt_f32_i32 v31, v11
    s_add_u32 s71, s71, 3072
    buffer_load_dwordx4 v[8:11], v1, s[24:27], s71 offen offset:0 nt
    v_fmac_f32 v96, v48, v28
    v_fmac_f32 v96, v49, v29
    v_fmac_f32 v96, v50, v30
    v_fmac_f32 v96, v51, v31
    s_waitcnt vmcnt(4)
    v_cvt_f32_i32 v24, v12
    v_cvt_f32_i32 v25, v13
    v_cvt_f32_i32 v26, v14
    v_cvt_f32_i32 v27, v15
    buffer_load_dwordx4 v[12:15], v1, s[24:27], s71 offen offset:256 nt
    v_fmac_f32 v96, v52, v24
    v_fmac_f32 v96, v53, v25
    v_fmac_f32 v96, v54, v26
    v_fmac_f32 v96, v55, v27
    s_nop 1
    v_add_f32_dpp v97, v96, v96 row_ror:8 row_mask:0xf bank_mask:0x3
    s_waitcnt vmcnt(4)
    v_cvt_f32_i32 v28, v16
    v_cvt_f32_i32 v29, v17
    v_cvt_f32_i32 v30, v18
    v_cvt_f32_i32 v31, v19
    buffer_load_dwordx4 v[16:19], v1, s[24:27], s71 offen offset:512 nt
    v_fma_f32 v96, v44, v28, -v88
    v_fmac_f32 v96, v45, v29
    v_fmac_f32 v96, v46, v30
    v_fmac_f32 v96, v47, v31
    s_waitcnt vmcnt(4)
    v_cvt_f32_i32 v24, v20
    v_cvt_f32_i32 v25, v21
    v_cvt_f32_i32 v26, v22
    v_cvt_f32_i32 v27, v23
    s_add_u32 s71, s71, 3072
    buffer_load_dwordx4 v[20:23], v1, s[24:27], s71 offen offset:0 nt
    v_fmac_f32 v96, v48, v24
    v_fmac_f32 v96, v49, v25
    v_fmac_f32 v96, v50, v26
    v_fmac_f32 v96, v51, v27
    s_waitcnt vmcnt(4)
    v_cvt_f32_i32 v28, v4
    v_cvt_f32_i32 v29, v5
    v_cvt_f32_i32 v30, v6
    v_cvt_f32_i32 v31, v7
    buffer_load_dwordx4 v[4:7], v1, s[24:27], s71 offen offset:256 nt
    v_fmac_f32 v96, v52, v28
    v_fmac_f32 v96, v53, v29
    v_fmac_f32 v96, v54, v30
    v_fmac_f32 v96, v55, v31
    s_nop 1
    v_add_f32_dpp v97, v96, v96 row_ror:8 row_mask:0xf bank_mask:0xc
    s_nop 1
    v_add_f32_dpp v98, v97, v97 row_shl:4 row_mask:0xf bank_mask:0x5
    s_waitcnt vmcnt(4)
    v_cvt_f32_i32 v24, v8
    v_cvt_f32_i32 v25, v9
    v_cvt_f32_i32 v26, v10
    v_cvt_f32_i32 v27, v11
    buffer_load_dwordx4 v[8:11], v1, s[24:27], s71 offen offset:512 nt
    v_fma_f32 v96, v44, v24, -v88
    v_fmac_f32 v96, v45, v25
    v_fmac_f32 v96, v46, v26
    v_fmac_f32 v96, v47, v27
    s_waitcnt vmcnt(4)
    v_cvt_f32_i32 v28, v12
    v_cvt_f32_i32 v29, v13
    v_cvt_f32_i32 v30, v14
    v_cvt_f32_i32 v31, v15
    s_add_u32 s70, s70, 64
    s_mul_i32 s71, s70, 49152
    s_mul_i32 s72, s70, 384
    buffer_load_dwordx2 v[56:57], v2, s[32:35], s72 offen offset:0
    buffer_load_dwordx2 v[58:59], v2, s[32:35], s72 offen offset:128
    buffer_load_dwordx2 v[60:61], v2, s[32:35], s72 offen offset:256
    buffer_load_dwordx2 v[62:63], v2, s[36:39], s72 offen offset:0
    buffer_load_dwordx2 v[64:65], v2, s[36:39], s72 offen offset:128
    buffer_load_dwordx2 v[66:67], v2, s[36:39], s72 offen offset:256
    buffer_load_dwordx4 v[12:15], v1, s[24:27], s71 offen offset:0 nt
    v_fmac_f32 v96, v48, v28
    v_fmac_f32 v96, v49, v29
    v_fmac_f32 v96, v50, v30
    v_fmac_f32 v96, v51, v31
    s_waitcnt vmcnt(10)
    v_cvt_f32_i32 v24, v16
    v_cvt_f32_i32 v25, v17
    v_cvt_f32_i32 v26, v18
    v_cvt_f32_i32 v27, v19
    buffer_load_dwordx4 v[16:19], v1, s[24:27], s71 offen offset:256 nt
    v_fmac_f32 v96, v52, v24
    v_fmac_f32 v96, v53, v25
    v_fmac_f32 v96, v54, v26
    v_fmac_f32 v96, v55, v27
    s_nop 1
    v_add_f32_dpp v97, v96, v96 row_ror:8 row_mask:0xf bank_mask:0x3
    s_waitcnt vmcnt(10)
    v_cvt_f32_i32 v28, v20
    v_cvt_f32_i32 v29, v21
    v_cvt_f32_i32 v30, v22
    v_cvt_f32_i32 v31, v23
    buffer_load_dwordx4 v[20:23], v1, s[24:27], s71 offen offset:512 nt
    v_fma_f32 v96, v44, v28, -v88
    v_fmac_f32 v96, v45, v29
    v_fmac_f32 v96, v46, v30
    v_fmac_f32 v96, v47, v31
    s_waitcnt vmcnt(10)
    v_cvt_f32_i32 v24, v4
    v_cvt_f32_i32 v25, v5
    v_cvt_f32_i32 v26, v6
    v_cvt_f32_i32 v27, v7
    s_add_u32 s71, s71, 3072
    buffer_load_dwordx4 v[4:7], v1, s[24:27], s71 offen offset:0 nt
    v_fmac_f32 v96, v48, v24
    v_fmac_f32 v96, v49, v25
    v_fmac_f32 v96, v50, v26
    v_fmac_f32 v96, v51, v27
    s_waitcnt vmcnt(10)
    v_cvt_f32_i32 v28, v8
    v_cvt_f32_i32 v29, v9
    v_cvt_f32_i32 v30, v10
    v_cvt_f32_i32 v31, v11
    buffer_load_dwordx4 v[8:11], v1, s[24:27], s71 offen offset:256 nt
    v_fmac_f32 v96, v52, v28
    v_fmac_f32 v96, v53, v29
    v_fmac_f32 v96, v54, v30
    v_fmac_f32 v96, v55, v31
    s_nop 1
    v_add_f32_dpp v97, v96, v96 row_ror:8 row_mask:0xf bank_mask:0xc
    s_nop 1
    v_add_f32_dpp v98, v97, v97 row_shr:4 row_mask:0xf bank_mask:0xa
    s_nop 1
    v_add_f32_dpp v99, v98, v98 quad_perm:[2,3,0,1] row_mask:0xf bank_mask:0xf
    s_waitcnt vmcnt(5)
    v_lshlrev_b32 v102, 16, v56
    v_and_b32 v103, 0xffff0000, v56
    v_mul_f32 v44, v102, v32
    v_mul_f32 v45, v103, v33
    v_lshlrev_b32 v102, 16, v62
    v_and_b32 v103, 0xffff0000, v62
    v_mul_f32 v88, v44, v102
    v_fmac_f32 v88, v45, v103
    v_lshlrev_b32 v102, 16, v57
    v_and_b32 v103, 0xffff0000, v57
    v_mul_f32 v46, v102, v34
    v_mul_f32 v47, v103, v35
    v_lshlrev_b32 v102, 16, v63
    v_and_b32 v103, 0xffff0000, v63
    v_fmac_f32 v88, v46, v102
    v_fmac_f32 v88, v47, v103
    v_lshlrev_b32 v102, 16, v58
    v_and_b32 v103, 0xffff0000, v58
    v_mul_f32 v48, v102, v36
    v_mul_f32 v49, v103, v37
    v_lshlrev_b32 v102, 16, v64
    v_and_b32 v103, 0xffff0000, v64
    v_fmac_f32 v88, v48, v102
    v_fmac_f32 v88, v49, v103
    v_lshlrev_b32 v102, 16, v59
    v_and_b32 v103, 0xffff0000, v59
    v_mul_f32 v50, v102, v38
    v_mul_f32 v51, v103, v39
    v_lshlrev_b32 v102, 16, v65
    v_and_b32 v103, 0xffff0000, v65
    v_fmac_f32 v88, v50, v102
    v_fmac_f32 v88, v51, v103
    v_lshlrev_b32 v102, 16, v60
    v_and_b32 v103, 0xffff0000, v60
    v_mul_f32 v52, v102, v40
    v_mul_f32 v53, v103, v41
    v_lshlrev_b32 v102, 16, v66
    v_and_b32 v103, 0xffff0000, v66
    v_fmac_f32 v88, v52, v102
    v_fmac_f32 v88, v53, v103
    v_lshlrev_b32 v102, 16, v61
    v_and_b32 v103, 0xffff0000, v61
    v_mul_f32 v54, v102, v42
    v_mul_f32 v55, v103, v43
    v_lshlrev_b32 v102, 16, v67
    v_and_b32 v103, 0xffff0000, v67
    v_fmac_f32 v88, v54, v102
    v_fmac_f32 v88, v55, v103
    s_waitcnt vmcnt(4)
    v_cvt_f32_i32 v24, v12
    v_cvt_f32_i32 v25, v13
    v_cvt_f32_i32 v26, v14
    v_cvt_f32_i32 v27, v15
    buffer_load_dwordx4 v[12:15], v1, s[24:27], s71 offen offset:512 nt
    v_fma_f32 v96, v44, v24, -v88
    v_fmac_f32 v96, v45, v25
    v_fmac_f32 v96, v46, v26
    v_fmac_f32 v96, v47, v27
    s_waitcnt vmcnt(4)
    v_cvt_f32_i32 v28, v16
    v_cvt_f32_i32 v29, v17
    v_cvt_f32_i32 v30, v18
    v_cvt_f32_i32 v31, v19
    s_add_u32 s71, s71, 3072
    buffer_load_dwordx4 v[16:19], v1, s[24:27], s71 offen offset:0 nt
    v_fmac_f32 v96, v48, v28
    v_fmac_f32 v96, v49, v29
    v_fmac_f32 v96, v50, v30
    v_fmac_f32 v96, v51, v31
    s_waitcnt vmcnt(4)
    v_cvt_f32_i32 v24, v20
    v_cvt_f32_i32 v25, v21
    v_cvt_f32_i32 v26, v22
    v_cvt_f32_i32 v27, v23
    buffer_load_dwordx4 v[20:23], v1, s[24:27], s71 offen offset:256 nt
    v_fmac_f32 v96, v52, v24
    v_fmac_f32 v96, v53, v25
    v_fmac_f32 v96, v54, v26
    v_fmac_f32 v96, v55, v27
    s_nop 1
    v_add_f32_dpp v97, v96, v96 row_ror:8 row_mask:0xf bank_mask:0x3
    s_waitcnt vmcnt(4)
    v_cvt_f32_i32 v28, v4
    v_cvt_f32_i32 v29, v5
    v_cvt_f32_i32 v30, v6
    v_cvt_f32_i32 v31, v7
    buffer_load_dwordx4 v[4:7], v1, s[24:27], s71 offen offset:512 nt
    v_fma_f32 v96, v44, v28, -v88
    v_fmac_f32 v96, v45, v29
    v_fmac_f32 v96, v46, v30
    v_fmac_f32 v96, v47, v31
    s_waitcnt vmcnt(4)
    v_cvt_f32_i32 v24, v8
    v_cvt_f32_i32 v25, v9
    v_cvt_f32_i32 v26, v10
    v_cvt_f32_i32 v27, v11
    s_add_u32 s71, s71, 3072
    buffer_load_dwordx4 v[8:11], v1, s[24:27], s71 offen offset:0 nt
    v_fmac_f32 v96, v48, v24
    v_fmac_f32 v96, v49, v25
    v_fmac_f32 v96, v50, v26
    v_fmac_f32 v96, v51, v27
    s_waitcnt vmcnt(4)
    v_cvt_f32_i32 v28, v12
    v_cvt_f32_i32 v29, v13
    v_cvt_f32_i32 v30, v14
    v_cvt_f32_i32 v31, v15
    buffer_load_dwordx4 v[12:15], v1, s[24:27], s71 offen offset:256 nt
    v_fmac_f32 v96, v52, v28
    v_fmac_f32 v96, v53, v29
    v_fmac_f32 v96, v54, v30
    v_fmac_f32 v96, v55, v31
    s_nop 1
    v_add_f32_dpp v97, v96, v96 row_ror:8 row_mask:0xf bank_mask:0xc
    s_nop 1
    v_add_f32_dpp v98, v97, v97 row_shl:4 row_mask:0xf bank_mask:0x5
    s_waitcnt vmcnt(4)
    v_cvt_f32_i32 v24, v16
    v_cvt_f32_i32 v25, v17
    v_cvt_f32_i32 v26, v18
    v_cvt_f32_i32 v27, v19
    buffer_load_dwordx4 v[16:19], v1, s[24:27], s71 offen offset:512 nt
    v_fma_f32 v96, v44, v24, -v88
    v_fmac_f32 v96, v45, v25
    v_fmac_f32 v96, v46, v26
    v_fmac_f32 v96, v47, v27
    s_waitcnt vmcnt(4)
    v_cvt_f32_i32 v28, v20
    v_cvt_f32_i32 v29, v21
    v_cvt_f32_i32 v30, v22
    v_cvt_f32_i32 v31, v23
    s_add_u32 s70, s70, 64
    s_mul_i32 s71, s70, 49152
    s_mul_i32 s72, s70, 384
    buffer_load_dwordx2 v[56:57], v2, s[32:35], s72 offen offset:0
    buffer_load_dwordx2 v[58:59], v2, s[32:35], s72 offen offset:128
    buffer_load_dwordx2 v[60:61], v2, s[32:35], s72 offen offset:256
    buffer_load_dwordx2 v[62:63], v2, s[36:39], s72 offen offset:0
    buffer_load_dwordx2 v[64:65], v2, s[36:39], s72 offen offset:128
    buffer_load_dwordx2 v[66:67], v2, s[36:39], s72 offen offset:256
    buffer_load_dwordx4 v[20:23], v1, s[24:27], s71 offen offset:0 nt
    v_fmac_f32 v96, v48, v28
    v_fmac_f32 v96, v49, v29
    v_fmac_f32 v96, v50, v30
    v_fmac_f32 v96, v51, v31
    s_waitcnt vmcnt(10)
    v_cvt_f32_i32 v24, v4
    v_cvt_f32_i32 v25, v5
    v_cvt_f32_i32 v26, v6
    v_cvt_f32_i32 v27, v7
    buffer_load_dwordx4 v[4:7], v1, s[24:27], s71 offen offset:256 nt
    v_fmac_f32 v96, v52, v24
    v_fmac_f32 v96, v53, v25
    v_fmac_f32 v96, v54, v26
    v_fmac_f32 v96, v55, v27
    s_nop 1
    v_add_f32_dpp v97, v96, v96 row_ror:8 row_mask:0xf bank_mask:0x3
    s_waitcnt vmcnt(10)
    v_cvt_f32_i32 v28, v8
    v_cvt_f32_i32 v29, v9
    v_cvt_f32_i32 v30, v10
    v_cvt_f32_i32 v31, v11
    buffer_load_dwordx4 v[8:11], v1, s[24:27], s71 offen offset:512 nt
    v_fma_f32 v96, v44, v28, -v88
    v_fmac_f32 v96, v45, v29
    v_fmac_f32 v96, v46, v30
    v_fmac_f32 v96, v47, v31
    s_waitcnt vmcnt(10)
    v_cvt_f32_i32 v24, v12
    v_cvt_f32_i32 v25, v13
    v_cvt_f32_i32 v26, v14
    v_cvt_f32_i32 v27, v15
    s_add_u32 s71, s71, 3072
    buffer_load_dwordx4 v[12:15], v1, s[24:27], s71 offen offset:0 nt
    v_fmac_f32 v96, v48, v24
    v_fmac_f32 v96, v49, v25
    v_fmac_f32 v96, v50, v26
    v_fmac_f32 v96, v51, v27
    s_waitcnt vmcnt(10)
    v_cvt_f32_i32 v28, v16
    v_cvt_f32_i32 v29, v17
    v_cvt_f32_i32 v30, v18
    v_cvt_f32_i32 v31, v19
    buffer_load_dwordx4 v[16:19], v1, s[24:27], s71 offen offset:256 nt
    v_fmac_f32 v96, v52, v28
    v_fmac_f32 v96, v53, v29
    v_fmac_f32 v96, v54, v30
    v_fmac_f32 v96, v55, v31
    s_nop 1
    v_add_f32_dpp v97, v96, v96 row_ror:8 row_mask:0xf bank_mask:0xc
    s_nop 1
    v_add_f32_dpp v98, v97, v97 row_shr:4 row_mask:0xf bank_mask:0xa
    s_nop 1
    v_add_f32_dpp v100, v98, v98 quad_perm:[2,3,0,1] row_mask:0xf bank_mask:0xf
    v_cndmask_b32 v100, v99, v100, s[64:65]
    s_nop 1
    v_add_f32_dpp v101, v100, v100 quad_perm:[1,0,3,2] row_mask:0xf bank_mask:0xf
    s_waitcnt vmcnt(5)
    v_lshlrev_b32 v102, 16, v56
    v_and_b32 v103, 0xffff0000, v56
    v_mul_f32 v44, v102, v32
    v_mul_f32 v45, v103, v33
    v_lshlrev_b32 v102, 16, v62
    v_and_b32 v103, 0xffff0000, v62
    v_mul_f32 v88, v44, v102
    v_fmac_f32 v88, v45, v103
    v_lshlrev_b32 v102, 16, v57
    v_and_b32 v103, 0xffff0000, v57
    v_mul_f32 v46, v102, v34
    v_mul_f32 v47, v103, v35
    v_lshlrev_b32 v102, 16, v63
    v_and_b32 v103, 0xffff0000, v63
    v_fmac_f32 v88, v46, v102
    v_fmac_f32 v88, v47, v103
    v_lshlrev_b32 v102, 16, v58
    v_and_b32 v103, 0xffff0000, v58
    v_mul_f32 v48, v102, v36
    v_mul_f32 v49, v103, v37
    v_lshlrev_b32 v102, 16, v64
    v_and_b32 v103, 0xffff0000, v64
    v_fmac_f32 v88, v48, v102
    v_fmac_f32 v88, v49, v103
    v_lshlrev_b32 v102, 16, v59
    v_and_b32 v103, 0xffff0000, v59
    v_mul_f32 v50, v102, v38
    v_mul_f32 v51, v103, v39
    v_lshlrev_b32 v102, 16, v65
    v_and_b32 v103, 0xffff0000, v65
    v_fmac_f32 v88, v50, v102
    v_fmac_f32 v88, v51, v103
    v_lshlrev_b32 v102, 16, v60
    v_and_b32 v103, 0xffff0000, v60
    v_mul_f32 v52, v102, v40
    v_mul_f32 v53, v103, v41
    v_lshlrev_b32 v102, 16, v66
    v_and_b32 v103, 0xffff0000, v66
    v_fmac_f32 v88, v52, v102
    v_fmac_f32 v88, v53, v103
    v_lshlrev_b32 v102, 16, v61
    v_and_b32 v103, 0xffff0000, v61
    v_mul_f32 v54, v102, v42
    v_mul_f32 v55, v103, v43
    v_lshlrev_b32 v102, 16, v67
    v_and_b32 v103, 0xffff0000, v67
    v_fmac_f32 v88, v54, v102
    v_fmac_f32 v88, v55, v103
    s_waitcnt vmcnt(4)
    v_cvt_f32_i32 v24, v20
    v_cvt_f32_i32 v25, v21
    v_cvt_f32_i32 v26, v22
    v_cvt_f32_i32 v27, v23
    buffer_load_dwordx4 v[20:23], v1, s[24:27], s71 offen offset:512 nt
    v_fma_f32 v96, v44, v24, -v88
    v_fmac_f32 v96, v45, v25
    v_fmac_f32 v96, v46, v26
    v_fmac_f32 v96, v47, v27
    s_waitcnt vmcnt(4)
    v_cvt_f32_i32 v28, v4
    v_cvt_f32_i32 v29, v5
    v_cvt_f32_i32 v30, v6
    v_cvt_f32_i32 v31, v7
    s_add_u32 s71, s71, 3072
    buffer_load_dwordx4 v[4:7], v1, s[24:27], s71 offen offset:0 nt
    v_fmac_f32 v96, v48, v28
    v_fmac_f32 v96, v49, v29
    v_fmac_f32 v96, v50, v30
    v_fmac_f32 v96, v51, v31
    s_waitcnt vmcnt(4)
    v_cvt_f32_i32 v24, v8
    v_cvt_f32_i32 v25, v9
    v_cvt_f32_i32 v26, v10
    v_cvt_f32_i32 v27, v11
    buffer_load_dwordx4 v[8:11], v1, s[24:27], s71 offen offset:256 nt
    v_fmac_f32 v96, v52, v24
    v_fmac_f32 v96, v53, v25
    v_fmac_f32 v96, v54, v26
    v_fmac_f32 v96, v55, v27
    s_nop 1
    v_add_f32_dpp v97, v96, v96 row_ror:8 row_mask:0xf bank_mask:0x3
    s_waitcnt vmcnt(4)
    v_cvt_f32_i32 v28, v12
    v_cvt_f32_i32 v29, v13
    v_cvt_f32_i32 v30, v14
    v_cvt_f32_i32 v31, v15
    buffer_load_dwordx4 v[12:15], v1, s[24:27], s71 offen offset:512 nt
    v_fma_f32 v96, v44, v28, -v88
    v_fmac_f32 v96, v45, v29
    v_fmac_f32 v96, v46, v30
    v_fmac_f32 v96, v47, v31
    s_waitcnt vmcnt(4)
    v_cvt_f32_i32 v24, v16
    v_cvt_f32_i32 v25, v17
    v_cvt_f32_i32 v26, v18
    v_cvt_f32_i32 v27, v19
    s_add_u32 s71, s71, 3072
    buffer_load_dwordx4 v[16:19], v1, s[24:27], s71 offen offset:0 nt
    v_fmac_f32 v96, v48, v24
    v_fmac_f32 v96, v49, v25
    v_fmac_f32 v96, v50, v26
    v_fmac_f32 v96, v51, v27
    s_waitcnt vmcnt(4)
    v_cvt_f32_i32 v28, v20
    v_cvt_f32_i32 v29, v21
    v_cvt_f32_i32 v30, v22
    v_cvt_f32_i32 v31, v23
    buffer_load_dwordx4 v[20:23], v1, s[24:27], s71 offen offset:256 nt
    v_fmac_f32 v96, v52, v28
    v_fmac_f32 v96, v53, v29
    v_fmac_f32 v96, v54, v30
    v_fmac_f32 v96, v55, v31
    s_nop 1
    v_add_f32_dpp v97, v96, v96 row_ror:8 row_mask:0xf bank_mask:0xc
    s_nop 1
    v_add_f32_dpp v98, v97, v97 row_shl:4 row_mask:0xf bank_mask:0x5
    s_waitcnt vmcnt(4)
    v_cvt_f32_i32 v24, v4
    v_cvt_f32_i32 v25, v5
    v_cvt_f32_i32 v26, v6
    v_cvt_f32_i32 v27, v7
    buffer_load_dwordx4 v[4:7], v1, s[24:27], s71 offen offset:512 nt
    v_fma_f32 v96, v44, v24, -v88
    v_fmac_f32 v96, v45, v25
    v_fmac_f32 v96, v46, v26
    v_fmac_f32 v96, v47, v27
    s_waitcnt vmcnt(4)
    v_cvt_f32_i32 v28, v8
    v_cvt_f32_i32 v29, v9
    v_cvt_f32_i32 v30, v10
    v_cvt_f32_i32 v31, v11
    s_add_u32 s70, s70, 64
    s_mul_i32 s71, s70, 49152
    s_mul_i32 s72, s70, 384
    buffer_load_dwordx2 v[56:57], v2, s[32:35], s72 offen offset:0
    buffer_load_dwordx2 v[58:59], v2, s[32:35], s72 offen offset:128
    buffer_load_dwordx2 v[60:61], v2, s[32:35], s72 offen offset:256
    buffer_load_dwordx2 v[62:63], v2, s[36:39], s72 offen offset:0
    buffer_load_dwordx2 v[64:65], v2, s[36:39], s72 offen offset:128
    buffer_load_dwordx2 v[66:67], v2, s[36:39], s72 offen offset:256
    buffer_load_dwordx4 v[8:11], v1, s[24:27], s71 offen offset:0 nt
    v_fmac_f32 v96, v48, v28
    v_fmac_f32 v96, v49, v29
    v_fmac_f32 v96, v50, v30
    v_fmac_f32 v96, v51, v31
    s_waitcnt vmcnt(10)
    v_cvt_f32_i32 v24, v12
    v_cvt_f32_i32 v25, v13
    v_cvt_f32_i32 v26, v14
    v_cvt_f32_i32 v27, v15
    buffer_load_dwordx4 v[12:15], v1, s[24:27], s71 offen offset:256 nt
    v_fmac_f32 v96, v52, v24
    v_fmac_f32 v96, v53, v25
    v_fmac_f32 v96, v54, v26
    v_fmac_f32 v96, v55, v27
    s_nop 1
    v_add_f32_dpp v97, v96, v96 row_ror:8 row_mask:0xf bank_mask:0x3
    s_waitcnt vmcnt(10)
    v_cvt_f32_i32 v28, v16
    v_cvt_f32_i32 v29, v17
    v_cvt_f32_i32 v30, v18
    v_cvt_f32_i32 v31, v19
    buffer_load_dwordx4 v[16:19], v1, s[24:27], s71 offen offset:512 nt
    v_fma_f32 v96, v44, v28, -v88
    v_fmac_f32 v96, v45, v29
    v_fmac_f32 v96, v46, v30
    v_fmac_f32 v96, v47, v31
    s_waitcnt vmcnt(10)
    v_cvt_f32_i32 v24, v20
    v_cvt_f32_i32 v25, v21
    v_cvt_f32_i32 v26, v22
    v_cvt_f32_i32 v27, v23
    s_add_u32 s71, s71, 3072
    buffer_load_dwordx4 v[20:23], v1, s[24:27], s71 offen offset:0 nt
    v_fmac_f32 v96, v48, v24
    v_fmac_f32 v96, v49, v25
    v_fmac_f32 v96, v50, v26
    v_fmac_f32 v96, v51, v27
    s_waitcnt vmcnt(10)
    v_cvt_f32_i32 v28, v4
    v_cvt_f32_i32 v29, v5
    v_cvt_f32_i32 v30, v6
    v_cvt_f32_i32 v31, v7
    buffer_load_dwordx4 v[4:7], v1, s[24:27], s71 offen offset:256 nt
    v_fmac_f32 v96, v52, v28
    v_fmac_f32 v96, v53, v29
    v_fmac_f32 v96, v54, v30
    v_fmac_f32 v96, v55, v31
    s_nop 1
    v_add_f32_dpp v97, v96, v96 row_ror:8 row_mask:0xf bank_mask:0xc
    s_nop 1
    v_add_f32_dpp v98, v97, v97 row_shr:4 row_mask:0xf bank_mask:0xa
    s_nop 1
    v_add_f32_dpp v99, v98, v98 quad_perm:[2,3,0,1] row_mask:0xf bank_mask:0xf
    s_waitcnt vmcnt(5)
    v_lshlrev_b32 v102, 16, v56
    v_and_b32 v103, 0xffff0000, v56
    v_mul_f32 v44, v102, v32
    v_mul_f32 v45, v103, v33
    v_lshlrev_b32 v102, 16, v62
    v_and_b32 v103, 0xffff0000, v62
    v_mul_f32 v88, v44, v102
    v_fmac_f32 v88, v45, v103
    v_lshlrev_b32 v102, 16, v57
    v_and_b32 v103, 0xffff0000, v57
    v_mul_f32 v46, v102, v34
    v_mul_f32 v47, v103, v35
    v_lshlrev_b32 v102, 16, v63
    v_and_b32 v103, 0xffff0000, v63
    v_fmac_f32 v88, v46, v102
    v_fmac_f32 v88, v47, v103
    v_lshlrev_b32 v102, 16, v58
    v_and_b32 v103, 0xffff0000, v58
    v_mul_f32 v48, v102, v36
    v_mul_f32 v49, v103, v37
    v_lshlrev_b32 v102, 16, v64
    v_and_b32 v103, 0xffff0000, v64
    v_fmac_f32 v88, v48, v102
    v_fmac_f32 v88, v49, v103
    v_lshlrev_b32 v102, 16, v59
    v_and_b32 v103, 0xffff0000, v59
    v_mul_f32 v50, v102, v38
    v_mul_f32 v51, v103, v39
    v_lshlrev_b32 v102, 16, v65
    v_and_b32 v103, 0xffff0000, v65
    v_fmac_f32 v88, v50, v102
    v_fmac_f32 v88, v51, v103
    v_lshlrev_b32 v102, 16, v60
    v_and_b32 v103, 0xffff0000, v60
    v_mul_f32 v52, v102, v40
    v_mul_f32 v53, v103, v41
    v_lshlrev_b32 v102, 16, v66
    v_and_b32 v103, 0xffff0000, v66
    v_fmac_f32 v88, v52, v102
    v_fmac_f32 v88, v53, v103
    v_lshlrev_b32 v102, 16, v61
    v_and_b32 v103, 0xffff0000, v61
    v_mul_f32 v54, v102, v42
    v_mul_f32 v55, v103, v43
    v_lshlrev_b32 v102, 16, v67
    v_and_b32 v103, 0xffff0000, v67
    v_fmac_f32 v88, v54, v102
    v_fmac_f32 v88, v55, v103
    s_waitcnt vmcnt(4)
    v_cvt_f32_i32 v24, v8
    v_cvt_f32_i32 v25, v9
    v_cvt_f32_i32 v26, v10
    v_cvt_f32_i32 v27, v11
    buffer_load_dwordx4 v[8:11], v1, s[24:27], s71 offen offset:512 nt
    v_fma_f32 v96, v44, v24, -v88
    v_fmac_f32 v96, v45, v25
    v_fmac_f32 v96, v46, v26
    v_fmac_f32 v96, v47, v27
    s_waitcnt vmcnt(4)
    v_cvt_f32_i32 v28, v12
    v_cvt_f32_i32 v29, v13
    v_cvt_f32_i32 v30, v14
    v_cvt_f32_i32 v31, v15
    s_add_u32 s71, s71, 3072
    buffer_load_dwordx4 v[12:15], v1, s[24:27], s71 offen offset:0 nt
    v_fmac_f32 v96, v48, v28
    v_fmac_f32 v96, v49, v29
    v_fmac_f32 v96, v50, v30
    v_fmac_f32 v96, v51, v31
    s_waitcnt vmcnt(4)
    v_cvt_f32_i32 v24, v16
    v_cvt_f32_i32 v25, v17
    v_cvt_f32_i32 v26, v18
    v_cvt_f32_i32 v27, v19
    buffer_load_dwordx4 v[16:19], v1, s[24:27], s71 offen offset:256 nt
    v_fmac_f32 v96, v52, v24
    v_fmac_f32 v96, v53, v25
    v_fmac_f32 v96, v54, v26
    v_fmac_f32 v96, v55, v27
    s_nop 1
    v_add_f32_dpp v97, v96, v96 row_ror:8 row_mask:0xf bank_mask:0x3
    s_waitcnt vmcnt(4)
    v_cvt_f32_i32 v28, v20
    v_cvt_f32_i32 v29, v21
    v_cvt_f32_i32 v30, v22
    v_cvt_f32_i32 v31, v23
    buffer_load_dwordx4 v[20:23], v1, s[24:27], s71 offen offset:512 nt
    v_fma_f32 v96, v44, v28, -v88
    v_fmac_f32 v96, v45, v29
    v_fmac_f32 v96, v46, v30
    v_fmac_f32 v96, v47, v31
    s_waitcnt vmcnt(4)
    v_cvt_f32_i32 v24, v4
    v_cvt_f32_i32 v25, v5
    v_cvt_f32_i32 v26, v6
    v_cvt_f32_i32 v27, v7
    s_add_u32 s71, s71, 3072
    buffer_load_dwordx4 v[4:7], v1, s[24:27], s71 offen offset:0 nt
    v_fmac_f32 v96, v48, v24
    v_fmac_f32 v96, v49, v25
    v_fmac_f32 v96, v50, v26
    v_fmac_f32 v96, v51, v27
    s_waitcnt vmcnt(4)
    v_cvt_f32_i32 v28, v8
    v_cvt_f32_i32 v29, v9
    v_cvt_f32_i32 v30, v10
    v_cvt_f32_i32 v31, v11
    buffer_load_dwordx4 v[8:11], v1, s[24:27], s71 offen offset:256 nt
    v_fmac_f32 v96, v52, v28
    v_fmac_f32 v96, v53, v29
    v_fmac_f32 v96, v54, v30
    v_fmac_f32 v96, v55, v31
    s_nop 1
    v_add_f32_dpp v97, v96, v96 row_ror:8 row_mask:0xf bank_mask:0xc
    s_nop 1
    v_add_f32_dpp v98, v97, v97 row_shl:4 row_mask:0xf bank_mask:0x5
    s_waitcnt vmcnt(4)
    v_cvt_f32_i32 v24, v12
    v_cvt_f32_i32 v25, v13
    v_cvt_f32_i32 v26, v14
    v_cvt_f32_i32 v27, v15
    buffer_load_dwordx4 v[12:15], v1, s[24:27], s71 offen offset:512 nt
    v_fma_f32 v96, v44, v24, -v88
    v_fmac_f32 v96, v45, v25
    v_fmac_f32 v96, v46, v26
    v_fmac_f32 v96, v47, v27
    s_waitcnt vmcnt(4)
    v_cvt_f32_i32 v28, v16
    v_cvt_f32_i32 v29, v17
    v_cvt_f32_i32 v30, v18
    v_cvt_f32_i32 v31, v19
    s_mov_b32 s70, s69
    s_mov_b32 s75, 2
    s_lshl_b32 s73, s70, 7
    buffer_load_ushort v92, v3, s[40:43], s73 offen
    buffer_load_ushort v93, v3, s[44:47], s73 offen
    s_mul_i32 s71, s70, 49152
    buffer_load_dwordx4 v[16:19], v1, s[28:31], s71 offen offset:0 nt
    v_fmac_f32 v96, v48, v28
    v_fmac_f32 v96, v49, v29
    v_fmac_f32 v96, v50, v30
    v_fmac_f32 v96, v51, v31
    s_waitcnt vmcnt(6)
    v_cvt_f32_i32 v24, v20
    v_cvt_f32_i32 v25, v21
    v_cvt_f32_i32 v26, v22
    v_cvt_f32_i32 v27, v23
    buffer_load_dwordx4 v[20:23], v1, s[28:31], s71 offen offset:256 nt
    v_fmac_f32 v96, v52, v24
    v_fmac_f32 v96, v53, v25
    v_fmac_f32 v96, v54, v26
    v_fmac_f32 v96, v55, v27
    s_nop 1
    v_add_f32_dpp v97, v96, v96 row_ror:8 row_mask:0xf bank_mask:0x3
    s_waitcnt vmcnt(6)
    v_cvt_f32_i32 v28, v4
    v_cvt_f32_i32 v29, v5
    v_cvt_f32_i32 v30, v6
    v_cvt_f32_i32 v31, v7
    buffer_load_dwordx4 v[4:7], v1, s[28:31], s71 offen offset:512 nt
    v_fma_f32 v96, v44, v28, -v88
    v_fmac_f32 v96, v45, v29
    v_fmac_f32 v96, v46, v30
    v_fmac_f32 v96, v47, v31
    s_waitcnt vmcnt(6)
    v_cvt_f32_i32 v24, v8
    v_cvt_f32_i32 v25, v9
    v_cvt_f32_i32 v26, v10
    v_cvt_f32_i32 v27, v11
    s_add_u32 s71, s71, 3072
    buffer_load_dwordx4 v[8:11], v1, s[28:31], s71 offen offset:0 nt
    v_fmac_f32 v96, v48, v24
    v_fmac_f32 v96, v49, v25
    v_fmac_f32 v96, v50, v26
    v_fmac_f32 v96, v51, v27
    s_waitcnt vmcnt(6)
    v_cvt_f32_i32 v28, v12
    v_cvt_f32_i32 v29, v13
    v_cvt_f32_i32 v30, v14
    v_cvt_f32_i32 v31, v15
    buffer_load_dwordx4 v[12:15], v1, s[28:31], s71 offen offset:256 nt
    v_fmac_f32 v96, v52, v28
    v_fmac_f32 v96, v53, v29
    v_fmac_f32 v96, v54, v30
    v_fmac_f32 v96, v55, v31
    s_nop 1
    v_add_f32_dpp v97, v96, v96 row_ror:8 row_mask:0xf bank_mask:0xc
    s_nop 1
    v_add_f32_dpp v98, v97, v97 row_shr:4 row_mask:0xf bank_mask:0xa
    s_nop 1
    v_add_f32_dpp v100, v98, v98 quad_perm:[2,3,0,1] row_mask:0xf bank_mask:0xf
    v_cndmask_b32 v100, v99, v100, s[64:65]
    s_nop 1
    v_add_f32_dpp v99, v100, v100 quad_perm:[1,0,3,2] row_mask:0xf bank_mask:0xf
    v_cndmask_b32 v101, v101, v99, s[66:67]
    ds_write_b32 v104, v101
    v_add_u32 v104, 256, v104
    ds_read_b32 v95, v105
    v_add_u32 v105, 256, v105
    s_mov_b32 s76, 3
L_loop1:
    s_waitcnt vmcnt(5)
    v_lshlrev_b32 v92, 16, v92
    v_lshlrev_b32 v93, 16, v93
    s_waitcnt lgkmcnt(0)
    v_max_f32_dpp v102, v95, v95 row_ror:8 row_mask:0xf bank_mask:0xf
    s_nop 1
    v_max_f32_dpp v102, v102, v102 row_ror:4 row_mask:0xf bank_mask:0xf
    s_nop 1
    v_max_f32_dpp v102, v102, v102 row_ror:2 row_mask:0xf bank_mask:0xf
    s_nop 1
    v_max_f32_dpp v102, v102, v102 row_ror:1 row_mask:0xf bank_mask:0xf
    v_max_f32 v102, v102, v89
    v_sub_f32 v103, v89, v102
    v_sub_f32 v94, v95, v102
    v_exp_f32 v103, v103
    v_exp_f32 v94, v94
    v_mov_b32 v89, v102
    v_fma_f32 v90, v90, v103, v94
    v_mul_f32 v94, v94, v92
    v_mul_f32 v91, v91, v103
    v_fmac_f32 v91, v94, v93
    ds_read_b32 v95, v105
    v_add_u32 v105, 256, v105
    v_mul_f32 v76, v76, v103
    v_mul_f32 v77, v77, v103
    v_mul_f32 v78, v78, v103
    v_mul_f32 v79, v79, v103
    v_mul_f32 v80, v80, v103
    v_mul_f32 v81, v81, v103
    v_mul_f32 v82, v82, v103
    v_mul_f32 v83, v83, v103
    v_mul_f32 v84, v84, v103
    v_mul_f32 v85, v85, v103
    v_mul_f32 v86, v86, v103
    v_mul_f32 v87, v87, v103
    s_waitcnt vmcnt(4)
    v_cvt_f32_i32 v24, v16
    v_cvt_f32_i32 v25, v17
    v_cvt_f32_i32 v26, v18
    v_cvt_f32_i32 v27, v19
    buffer_load_dwordx4 v[16:19], v1, s[28:31], s71 offen offset:512 nt
    v_fmac_f32_dpp v76, v94, v24 row_newbcast:0 row_mask:0xf bank_mask:0xf
    v_fmac_f32_dpp v77, v94, v25 row_newbcast:0 row_mask:0xf bank_mask:0xf
    v_fmac_f32_dpp v78, v94, v26 row_newbcast:0 row_mask:0xf bank_mask:0xf
    v_fmac_f32_dpp v79, v94, v27 row_newbcast:0 row_mask:0xf bank_mask:0xf
    s_waitcnt vmcnt(4)
    v_cvt_f32_i32 v28, v20
    v_cvt_f32_i32 v29, v21
    v_cvt_f32_i32 v30, v22
    v_cvt_f32_i32 v31, v23
    s_add_u32 s71, s71, 3072
    buffer_load_dwordx4 v[20:23], v1, s[28:31], s71 offen offset:0 nt
    v_fmac_f32_dpp v80, v94, v28 row_newbcast:0 row_mask:0xf bank_mask:0xf
    v_fmac_f32_dpp v81, v94, v29 row_newbcast:0 row_mask:0xf bank_mask:0xf
    v_fmac_f32_dpp v82, v94, v30 row_newbcast:0 row_mask:0xf bank_mask:0xf
    v_fmac_f32_dpp v83, v94, v31 row_newbcast:0 row_mask:0xf bank_mask:0xf
    s_waitcnt vmcnt(4)
    v_cvt_f32_i32 v24, v4
    v_cvt_f32_i32 v25, v5
    v_cvt_f32_i32 v26, v6
    v_cvt_f32_i32 v27, v7
    buffer_load_dwordx4 v[4:7], v1, s[28:31], s71 offen offset:256 nt
    v_fmac_f32_dpp v84, v94, v24 row_newbcast:0 row_mask:0xf bank_mask:0xf
    v_fmac_f32_dpp v85, v94, v25 row_newbcast:0 row_mask:0xf bank_mask:0xf
    v_fmac_f32_dpp v86, v94, v26 row_newbcast:0 row_mask:0xf bank_mask:0xf
    v_fmac_f32_dpp v87, v94, v27 row_newbcast:0 row_mask:0xf bank_mask:0xf
    s_waitcnt vmcnt(4)
    v_cvt_f32_i32 v28, v8
    v_cvt_f32_i32 v29, v9
    v_cvt_f32_i32 v30, v10
    v_cvt_f32_i32 v31, v11
    buffer_load_dwordx4 v[8:11], v1, s[28:31], s71 offen offset:512 nt
    v_fmac_f32_dpp v76, v94, v28 row_newbcast:8 row_mask:0xf bank_mask:0xf
    v_fmac_f32_dpp v77, v94, v29 row_newbcast:8 row_mask:0xf bank_mask:0xf
    v_fmac_f32_dpp v78, v94, v30 row_newbcast:8 row_mask:0xf bank_mask:0xf
    v_fmac_f32_dpp v79, v94, v31 row_newbcast:8 row_mask:0xf bank_mask:0xf
    s_waitcnt vmcnt(4)
    v_cvt_f32_i32 v24, v12
    v_cvt_f32_i32 v25, v13
    v_cvt_f32_i32 v26, v14
    v_cvt_f32_i32 v27, v15
    s_add_u32 s71, s71, 3072
    buffer_load_dwordx4 v[12:15], v1, s[28:31], s71 offen offset:0 nt
    v_fmac_f32_dpp v80, v94, v24 row_newbcast:8 row_mask:0xf bank_mask:0xf
    v_fmac_f32_dpp v81, v94, v25 row_newbcast:8 row_mask:0xf bank_mask:0xf
    v_fmac_f32_dpp v82, v94, v26 row_newbcast:8 row_mask:0xf bank_mask:0xf
    v_fmac_f32_dpp v83, v94, v27 row_newbcast:8 row_mask:0xf bank_mask:0xf
    s_waitcnt vmcnt(4)
    v_cvt_f32_i32 v28, v16
    v_cvt_f32_i32 v29, v17
    v_cvt_f32_i32 v30, v18
    v_cvt_f32_i32 v31, v19
    buffer_load_dwordx4 v[16:19], v1, s[28:31], s71 offen offset:256 nt
    v_fmac_f32_dpp v84, v94, v28 row_newbcast:8 row_mask:0xf bank_mask:0xf
    v_fmac_f32_dpp v85, v94, v29 row_newbcast:8 row_mask:0xf bank_mask:0xf
    v_fmac_f32_dpp v86, v94, v30 row_newbcast:8 row_mask:0xf bank_mask:0xf
    v_fmac_f32_dpp v87, v94, v31 row_newbcast:8 row_mask:0xf bank_mask:0xf
    s_waitcnt vmcnt(4)
    v_cvt_f32_i32 v24, v20
    v_cvt_f32_i32 v25, v21
    v_cvt_f32_i32 v26, v22
    v_cvt_f32_i32 v27, v23
    buffer_load_dwordx4 v[20:23], v1, s[28:31], s71 offen offset:512 nt
    v_fmac_f32_dpp v76, v94, v24 row_newbcast:4 row_mask:0xf bank_mask:0xf
    v_fmac_f32_dpp v77, v94, v25 row_newbcast:4 row_mask:0xf bank_mask:0xf
    v_fmac_f32_dpp v78, v94, v26 row_newbcast:4 row_mask:0xf bank_mask:0xf
    v_fmac_f32_dpp v79, v94, v27 row_newbcast:4 row_mask:0xf bank_mask:0xf
    s_waitcnt vmcnt(4)
    v_cvt_f32_i32 v28, v4
    v_cvt_f32_i32 v29, v5
    v_cvt_f32_i32 v30, v6
    v_cvt_f32_i32 v31, v7
    s_add_u32 s70, s70, 64
    s_mul_i32 s71, s70, 49152
    buffer_load_dwordx4 v[4:7], v1, s[28:31], s71 offen offset:0 nt
    v_fmac_f32_dpp v80, v94, v28 row_newbcast:4 row_mask:0xf bank_mask:0xf
    v_fmac_f32_dpp v81, v94, v29 row_newbcast:4 row_mask:0xf bank_mask:0xf
    v_fmac_f32_dpp v82, v94, v30 row_newbcast:4 row_mask:0xf bank_mask:0xf
    v_fmac_f32_dpp v83, v94, v31 row_newbcast:4 row_mask:0xf bank_mask:0xf
    s_waitcnt vmcnt(4)
    v_cvt_f32_i32 v24, v8
    v_cvt_f32_i32 v25, v9
    v_cvt_f32_i32 v26, v10
    v_cvt_f32_i32 v27, v11
    buffer_load_dwordx4 v[8:11], v1, s[28:31], s71 offen offset:256 nt
    v_fmac_f32_dpp v84, v94, v24 row_newbcast:4 row_mask:0xf bank_mask:0xf
    v_fmac_f32_dpp v85, v94, v25 row_newbcast:4 row_mask:0xf bank_mask:0xf
    v_fmac_f32_dpp v86, v94, v26 row_newbcast:4 row_mask:0xf bank_mask:0xf
    v_fmac_f32_dpp v87, v94, v27 row_newbcast:4 row_mask:0xf bank_mask:0xf
    s_waitcnt vmcnt(4)
    v_cvt_f32_i32 v28, v12
    v_cvt_f32_i32 v29, v13
    v_cvt_f32_i32 v30, v14
    v_cvt_f32_i32 v31, v15
    buffer_load_dwordx4 v[12:15], v1, s[28:31], s71 offen offset:512 nt
    v_fmac_f32_dpp v76, v94, v28 row_newbcast:12 row_mask:0xf bank_mask:0xf
    v_fmac_f32_dpp v77, v94, v29 row_newbcast:12 row_mask:0xf bank_mask:0xf
    v_fmac_f32_dpp v78, v94, v30 row_newbcast:12 row_mask:0xf bank_mask:0xf
    v_fmac_f32_dpp v79, v94, v31 row_newbcast:12 row_mask:0xf bank_mask:0xf
    s_waitcnt vmcnt(4)
    v_cvt_f32_i32 v24, v16
    v_cvt_f32_i32 v25, v17
    v_cvt_f32_i32 v26, v18
    v_cvt_f32_i32 v27, v19
    s_add_u32 s71, s71, 3072
    buffer_load_dwordx4 v[16:19], v1, s[28:31], s71 offen offset:0 nt
    v_fmac_f32_dpp v80, v94, v24 row_newbcast:12 row_mask:0xf bank_mask:0xf
    v_fmac_f32_dpp v81, v94, v25 row_newbcast:12 row_mask:0xf bank_mask:0xf
    v_fmac_f32_dpp v82, v94, v26 row_newbcast:12 row_mask:0xf bank_mask:0xf
    v_fmac_f32_dpp v83, v94, v27 row_newbcast:12 row_mask:0xf bank_mask:0xf
    s_waitcnt vmcnt(4)
    v_cvt_f32_i32 v28, v20
    v_cvt_f32_i32 v29, v21
    v_cvt_f32_i32 v30, v22
    v_cvt_f32_i32 v31, v23
    buffer_load_dwordx4 v[20:23], v1, s[28:31], s71 offen offset:256 nt
    v_fmac_f32_dpp v84, v94, v28 row_newbcast:12 row_mask:0xf bank_mask:0xf
    v_fmac_f32_dpp v85, v94, v29 row_newbcast:12 row_mask:0xf bank_mask:0xf
    v_fmac_f32_dpp v86, v94, v30 row_newbcast:12 row_mask:0xf bank_mask:0xf
    v_fmac_f32_dpp v87, v94, v31 row_newbcast:12 row_mask:0xf bank_mask:0xf
    s_waitcnt vmcnt(4)
    v_cvt_f32_i32 v24, v4
    v_cvt_f32_i32 v25, v5
    v_cvt_f32_i32 v26, v6
    v_cvt_f32_i32 v27, v7
    buffer_load_dwordx4 v[4:7], v1, s[28:31], s71 offen offset:512 nt
    v_fmac_f32_dpp v76, v94, v24 row_newbcast:2 row_mask:0xf bank_mask:0xf
    v_fmac_f32_dpp v77, v94, v25 row_newbcast:2 row_mask:0xf bank_mask:0xf
    v_fmac_f32_dpp v78, v94, v26 row_newbcast:2 row_mask:0xf bank_mask:0xf
    v_fmac_f32_dpp v79, v94, v27 row_newbcast:2 row_mask:0xf bank_mask:0xf
    s_waitcnt vmcnt(4)
    v_cvt_f32_i32 v28, v8
    v_cvt_f32_i32 v29, v9
    v_cvt_f32_i32 v30, v10
    v_cvt_f32_i32 v31, v11
    s_add_u32 s71, s71, 3072
    buffer_load_dwordx4 v[8:11], v1, s[28:31], s71 offen offset:0 nt
    v_fmac_f32_dpp v80, v94, v28 row_newbcast:2 row_mask:0xf bank_mask:0xf
    v_fmac_f32_dpp v81, v94, v29 row_newbcast:2 row_mask:0xf bank_mask:0xf
    v_fmac_f32_dpp v82, v94, v30 row_newbcast:2 row_mask:0xf bank_mask:0xf
    v_fmac_f32_dpp v83, v94, v31 row_newbcast:2 row_mask:0xf bank_mask:0xf
    s_waitcnt vmcnt(4)
    v_cvt_f32_i32 v24, v12
    v_cvt_f32_i32 v25, v13
    v_cvt_f32_i32 v26, v14
    v_cvt_f32_i32 v27, v15
    buffer_load_dwordx4 v[12:15], v1, s[28:31], s71 offen offset:256 nt
    v_fmac_f32_dpp v84, v94, v24 row_newbcast:2 row_mask:0xf bank_mask:0xf
    v_fmac_f32_dpp v85, v94, v25 row_newbcast:2 row_mask:0xf bank_mask:0xf
    v_fmac_f32_dpp v86, v94, v26 row_newbcast:2 row_mask:0xf bank_mask:0xf
    v_fmac_f32_dpp v87, v94, v27 row_newbcast:2 row_mask:0xf bank_mask:0xf
    s_waitcnt vmcnt(4)
    v_cvt_f32_i32 v28, v16
    v_cvt_f32_i32 v29, v17
    v_cvt_f32_i32 v30, v18
    v_cvt_f32_i32 v31, v19
    buffer_load_dwordx4 v[16:19], v1, s[28:31], s71 offen offset:512 nt
    v_fmac_f32_dpp v76, v94, v28 row_newbcast:10 row_mask:0xf bank_mask:0xf
    v_fmac_f32_dpp v77, v94, v29 row_newbcast:10 row_mask:0xf bank_mask:0xf
    v_fmac_f32_dpp v78, v94, v30 row_newbcast:10 row_mask:0xf bank_mask:0xf
    v_fmac_f32_dpp v79, v94, v31 row_newbcast:10 row_mask:0xf bank_mask:0xf
    s_waitcnt vmcnt(4)
    v_cvt_f32_i32 v24, v20
    v_cvt_f32_i32 v25, v21
    v_cvt_f32_i32 v26, v22
    v_cvt_f32_i32 v27, v23
    s_add_u32 s71, s71, 3072
    buffer_load_dwordx4 v[20:23], v1, s[28:31], s71 offen offset:0 nt
    v_fmac_f32_dpp v80, v94, v24 row_newbcast:10 row_mask:0xf bank_mask:0xf
    v_fmac_f32_dpp v81, v94, v25 row_newbcast:10 row_mask:0xf bank_mask:0xf
    v_fmac_f32_dpp v82, v94, v26 row_newbcast:10 row_mask:0xf bank_mask:0xf
    v_fmac_f32_dpp v83, v94, v27 row_newbcast:10 row_mask:0xf bank_mask:0xf
    s_waitcnt vmcnt(4)
    v_cvt_f32_i32 v28, v4
    v_cvt_f32_i32 v29, v5
    v_cvt_f32_i32 v30, v6
    v_cvt_f32_i32 v31, v7
    buffer_load_dwordx4 v[4:7], v1, s[28:31], s71 offen offset:256 nt
    v_fmac_f32_dpp v84, v94, v28 row_newbcast:10 row_mask:0xf bank_mask:0xf
    v_fmac_f32_dpp v85, v94, v29 row_newbcast:10 row_mask:0xf bank_mask:0xf
    v_fmac_f32_dpp v86, v94, v30 row_newbcast:10 row_mask:0xf bank_mask:0xf
    v_fmac_f32_dpp v87, v94, v31 row_newbcast:10 row_mask:0xf bank_mask:0xf
    s_waitcnt vmcnt(4)
    v_cvt_f32_i32 v24, v8
    v_cvt_f32_i32 v25, v9
    v_cvt_f32_i32 v26, v10
    v_cvt_f32_i32 v27, v11
    buffer_load_dwordx4 v[8:11], v1, s[28:31], s71 offen offset:512 nt
    v_fmac_f32_dpp v76, v94, v24 row_newbcast:6 row_mask:0xf bank_mask:0xf
    v_fmac_f32_dpp v77, v94, v25 row_newbcast:6 row_mask:0xf bank_mask:0xf
    v_fmac_f32_dpp v78, v94, v26 row_newbcast:6 row_mask:0xf bank_mask:0xf
    v_fmac_f32_dpp v79, v94, v27 row_newbcast:6 row_mask:0xf bank_mask:0xf
    s_waitcnt vmcnt(4)
    v_cvt_f32_i32 v28, v12
    v_cvt_f32_i32 v29, v13
    v_cvt_f32_i32 v30, v14
    v_cvt_f32_i32 v31, v15
    s_add_u32 s70, s70, 64
    s_mul_i32 s71, s70, 49152
    buffer_load_dwordx4 v[12:15], v1, s[28:31], s71 offen offset:0 nt
    v_fmac_f32_dpp v80, v94, v28 row_newbcast:6 row_mask:0xf bank_mask:0xf
    v_fmac_f32_dpp v81, v94, v29 row_newbcast:6 row_mask:0xf bank_mask:0xf
    v_fmac_f32_dpp v82, v94, v30 row_newbcast:6 row_mask:0xf bank_mask:0xf
    v_fmac_f32_dpp v83, v94, v31 row_newbcast:6 row_mask:0xf bank_mask:0xf
    s_waitcnt vmcnt(4)
    v_cvt_f32_i32 v24, v16
    v_cvt_f32_i32 v25, v17
    v_cvt_f32_i32 v26, v18
    v_cvt_f32_i32 v27, v19
    buffer_load_dwordx4 v[16:19], v1, s[28:31], s71 offen offset:256 nt
    v_fmac_f32_dpp v84, v94, v24 row_newbcast:6 row_mask:0xf bank_mask:0xf
    v_fmac_f32_dpp v85, v94, v25 row_newbcast:6 row_mask:0xf bank_mask:0xf
    v_fmac_f32_dpp v86, v94, v26 row_newbcast:6 row_mask:0xf bank_mask:0xf
    v_fmac_f32_dpp v87, v94, v27 row_newbcast:6 row_mask:0xf bank_mask:0xf
    s_waitcnt vmcnt(4)
    v_cvt_f32_i32 v28, v20
    v_cvt_f32_i32 v29, v21
    v_cvt_f32_i32 v30, v22
    v_cvt_f32_i32 v31, v23
    buffer_load_dwordx4 v[20:23], v1, s[28:31], s71 offen offset:512 nt
    v_fmac_f32_dpp v76, v94, v28 row_newbcast:14 row_mask:0xf bank_mask:0xf
    v_fmac_f32_dpp v77, v94, v29 row_newbcast:14 row_mask:0xf bank_mask:0xf
    v_fmac_f32_dpp v78, v94, v30 row_newbcast:14 row_mask:0xf bank_mask:0xf
    v_fmac_f32_dpp v79, v94, v31 row_newbcast:14 row_mask:0xf bank_mask:0xf
    s_waitcnt vmcnt(4)
    v_cvt_f32_i32 v24, v4
    v_cvt_f32_i32 v25, v5
    v_cvt_f32_i32 v26, v6
    v_cvt_f32_i32 v27, v7
    s_add_u32 s71, s71, 3072
    buffer_load_dwordx4 v[4:7], v1, s[28:31], s71 offen offset:0 nt
    v_fmac_f32_dpp v80, v94, v24 row_newbcast:14 row_mask:0xf bank_mask:0xf
    v_fmac_f32_dpp v81, v94, v25 row_newbcast:14 row_mask:0xf bank_mask:0xf
    v_fmac_f32_dpp v82, v94, v26 row_newbcast:14 row_mask:0xf bank_mask:0xf
    v_fmac_f32_dpp v83, v94, v27 row_newbcast:14 row_mask:0xf bank_mask:0xf
    s_waitcnt vmcnt(4)
    v_cvt_f32_i32 v28, v8
    v_cvt_f32_i32 v29, v9
    v_cvt_f32_i32 v30, v10
    v_cvt_f32_i32 v31, v11
    buffer_load_dwordx4 v[8:11], v1, s[28:31], s71 offen offset:256 nt
    v_fmac_f32_dpp v84, v94, v28 row_newbcast:14 row_mask:0xf bank_mask:0xf
    v_fmac_f32_dpp v85, v94, v29 row_newbcast:14 row_mask:0xf bank_mask:0xf
    v_fmac_f32_dpp v86, v94, v30 row_newbcast:14 row_mask:0xf bank_mask:0xf
    v_fmac_f32_dpp v87, v94, v31 row_newbcast:14 row_mask:0xf bank_mask:0xf
    s_waitcnt vmcnt(4)
    v_cvt_f32_i32 v24, v12
    v_cvt_f32_i32 v25, v13
    v_cvt_f32_i32 v26, v14
    v_cvt_f32_i32 v27, v15
    buffer_load_dwordx4 v[12:15], v1, s[28:31], s71 offen offset:512 nt
    v_fmac_f32_dpp v76, v94, v24 row_newbcast:1 row_mask:0xf bank_mask:0xf
    v_fmac_f32_dpp v77, v94, v25 row_newbcast:1 row_mask:0xf bank_mask:0xf
    v_fmac_f32_dpp v78, v94, v26 row_newbcast:1 row_mask:0xf bank_mask:0xf
    v_fmac_f32_dpp v79, v94, v27 row_newbcast:1 row_mask:0xf bank_mask:0xf
    s_waitcnt vmcnt(4)
    v_cvt_f32_i32 v28, v16
    v_cvt_f32_i32 v29, v17
    v_cvt_f32_i32 v30, v18
    v_cvt_f32_i32 v31, v19
    s_add_u32 s71, s71, 3072
    buffer_load_dwordx4 v[16:19], v1, s[28:31], s71 offen offset:0 nt
    v_fmac_f32_dpp v80, v94, v28 row_newbcast:1 row_mask:0xf bank_mask:0xf
    v_fmac_f32_dpp v81, v94, v29 row_newbcast:1 row_mask:0xf bank_mask:0xf
    v_fmac_f32_dpp v82, v94, v30 row_newbcast:1 row_mask:0xf bank_mask:0xf
    v_fmac_f32_dpp v83, v94, v31 row_newbcast:1 row_mask:0xf bank_mask:0xf
    s_waitcnt vmcnt(4)
    v_cvt_f32_i32 v24, v20
    v_cvt_f32_i32 v25, v21
    v_cvt_f32_i32 v26, v22
    v_cvt_f32_i32 v27, v23
    buffer_load_dwordx4 v[20:23], v1, s[28:31], s71 offen offset:256 nt
    v_fmac_f32_dpp v84, v94, v24 row_newbcast:1 row_mask:0xf bank_mask:0xf
    v_fmac_f32_dpp v85, v94, v25 row_newbcast:1 row_mask:0xf bank_mask:0xf
    v_fmac_f32_dpp v86, v94, v26 row_newbcast:1 row_mask:0xf bank_mask:0xf
    v_fmac_f32_dpp v87, v94, v27 row_newbcast:1 row_mask:0xf bank_mask:0xf
    s_waitcnt vmcnt(4)
    v_cvt_f32_i32 v28, v4
    v_cvt_f32_i32 v29, v5
    v_cvt_f32_i32 v30, v6
    v_cvt_f32_i32 v31, v7
    buffer_load_dwordx4 v[4:7], v1, s[28:31], s71 offen offset:512 nt
    v_fmac_f32_dpp v76, v94, v28 row_newbcast:9 row_mask:0xf bank_mask:0xf
    v_fmac_f32_dpp v77, v94, v29 row_newbcast:9 row_mask:0xf bank_mask:0xf
    v_fmac_f32_dpp v78, v94, v30 row_newbcast:9 row_mask:0xf bank_mask:0xf
    v_fmac_f32_dpp v79, v94, v31 row_newbcast:9 row_mask:0xf bank_mask:0xf
    s_waitcnt vmcnt(4)
    v_cvt_f32_i32 v24, v8
    v_cvt_f32_i32 v25, v9
    v_cvt_f32_i32 v26, v10
    v_cvt_f32_i32 v27, v11
    s_add_u32 s71, s71, 3072
    buffer_load_dwordx4 v[8:11], v1, s[28:31], s71 offen offset:0 nt
    v_fmac_f32_dpp v80, v94, v24 row_newbcast:9 row_mask:0xf bank_mask:0xf
    v_fmac_f32_dpp v81, v94, v25 row_newbcast:9 row_mask:0xf bank_mask:0xf
    v_fmac_f32_dpp v82, v94, v26 row_newbcast:9 row_mask:0xf bank_mask:0xf
    v_fmac_f32_dpp v83, v94, v27 row_newbcast:9 row_mask:0xf bank_mask:0xf
    s_waitcnt vmcnt(4)
    v_cvt_f32_i32 v28, v12
    v_cvt_f32_i32 v29, v13
    v_cvt_f32_i32 v30, v14
    v_cvt_f32_i32 v31, v15
    buffer_load_dwordx4 v[12:15], v1, s[28:31], s71 offen offset:256 nt
    v_fmac_f32_dpp v84, v94, v28 row_newbcast:9 row_mask:0xf bank_mask:0xf
    v_fmac_f32_dpp v85, v94, v29 row_newbcast:9 row_mask:0xf bank_mask:0xf
    v_fmac_f32_dpp v86, v94, v30 row_newbcast:9 row_mask:0xf bank_mask:0xf
    v_fmac_f32_dpp v87, v94, v31 row_newbcast:9 row_mask:0xf bank_mask:0xf
    s_waitcnt vmcnt(4)
    v_cvt_f32_i32 v24, v16
    v_cvt_f32_i32 v25, v17
    v_cvt_f32_i32 v26, v18
    v_cvt_f32_i32 v27, v19
    buffer_load_dwordx4 v[16:19], v1, s[28:31], s71 offen offset:512 nt
    v_fmac_f32_dpp v76, v94, v24 row_newbcast:5 row_mask:0xf bank_mask:0xf
    v_fmac_f32_dpp v77, v94, v25 row_newbcast:5 row_mask:0xf bank_mask:0xf
    v_fmac_f32_dpp v78, v94, v26 row_newbcast:5 row_mask:0xf bank_mask:0xf
    v_fmac_f32_dpp v79, v94, v27 row_newbcast:5 row_mask:0xf bank_mask:0xf
    s_waitcnt vmcnt(4)
    v_cvt_f32_i32 v28, v20
    v_cvt_f32_i32 v29, v21
    v_cvt_f32_i32 v30, v22
    v_cvt_f32_i32 v31, v23
    s_add_u32 s70, s70, 64
    s_mul_i32 s71, s70, 49152
    buffer_load_dwordx4 v[20:23], v1, s[28:31], s71 offen offset:0 nt
    v_fmac_f32_dpp v80, v94, v28 row_newbcast:5 row_mask:0xf bank_mask:0xf
    v_fmac_f32_dpp v81, v94, v29 row_newbcast:5 row_mask:0xf bank_mask:0xf
    v_fmac_f32_dpp v82, v94, v30 row_newbcast:5 row_mask:0xf bank_mask:0xf
    v_fmac_f32_dpp v83, v94, v31 row_newbcast:5 row_mask:0xf bank_mask:0xf
    s_waitcnt vmcnt(4)
    v_cvt_f32_i32 v24, v4
    v_cvt_f32_i32 v25, v5
    v_cvt_f32_i32 v26, v6
    v_cvt_f32_i32 v27, v7
    buffer_load_dwordx4 v[4:7], v1, s[28:31], s71 offen offset:256 nt
    v_fmac_f32_dpp v84, v94, v24 row_newbcast:5 row_mask:0xf bank_mask:0xf
    v_fmac_f32_dpp v85, v94, v25 row_newbcast:5 row_mask:0xf bank_mask:0xf
    v_fmac_f32_dpp v86, v94, v26 row_newbcast:5 row_mask:0xf bank_mask:0xf
    v_fmac_f32_dpp v87, v94, v27 row_newbcast:5 row_mask:0xf bank_mask:0xf
    s_waitcnt vmcnt(4)
    v_cvt_f32_i32 v28, v8
    v_cvt_f32_i32 v29, v9
    v_cvt_f32_i32 v30, v10
    v_cvt_f32_i32 v31, v11
    buffer_load_dwordx4 v[8:11], v1, s[28:31], s71 offen offset:512 nt
    v_fmac_f32_dpp v76, v94, v28 row_newbcast:13 row_mask:0xf bank_mask:0xf
    v_fmac_f32_dpp v77, v94, v29 row_newbcast:13 row_mask:0xf bank_mask:0xf
    v_fmac_f32_dpp v78, v94, v30 row_newbcast:13 row_mask:0xf bank_mask:0xf
    v_fmac_f32_dpp v79, v94, v31 row_newbcast:13 row_mask:0xf bank_mask:0xf
    s_waitcnt vmcnt(4)
    v_cvt_f32_i32 v24, v12
    v_cvt_f32_i32 v25, v13
    v_cvt_f32_i32 v26, v14
    v_cvt_f32_i32 v27, v15
    s_add_u32 s71, s71, 3072
    buffer_load_dwordx4 v[12:15], v1, s[28:31], s71 offen offset:0 nt
    v_fmac_f32_dpp v80, v94, v24 row_newbcast:13 row_mask:0xf bank_mask:0xf
    v_fmac_f32_dpp v81, v94, v25 row_newbcast:13 row_mask:0xf bank_mask:0xf
    v_fmac_f32_dpp v82, v94, v26 row_newbcast:13 row_mask:0xf bank_mask:0xf
    v_fmac_f32_dpp v83, v94, v27 row_newbcast:13 row_mask:0xf bank_mask:0xf
    s_waitcnt vmcnt(4)
    v_cvt_f32_i32 v28, v16
    v_cvt_f32_i32 v29, v17
    v_cvt_f32_i32 v30, v18
    v_cvt_f32_i32 v31, v19
    buffer_load_dwordx4 v[16:19], v1, s[28:31], s71 offen offset:256 nt
    v_fmac_f32_dpp v84, v94, v28 row_newbcast:13 row_mask:0xf bank_mask:0xf
    v_fmac_f32_dpp v85, v94, v29 row_newbcast:13 row_mask:0xf bank_mask:0xf
    v_fmac_f32_dpp v86, v94, v30 row_newbcast:13 row_mask:0xf bank_mask:0xf
    v_fmac_f32_dpp v87, v94, v31 row_newbcast:13 row_mask:0xf bank_mask:0xf
    s_waitcnt vmcnt(4)
    v_cvt_f32_i32 v24, v20
    v_cvt_f32_i32 v25, v21
    v_cvt_f32_i32 v26, v22
    v_cvt_f32_i32 v27, v23
    buffer_load_dwordx4 v[20:23], v1, s[28:31], s71 offen offset:512 nt
    v_fmac_f32_dpp v76, v94, v24 row_newbcast:3 row_mask:0xf bank_mask:0xf
    v_fmac_f32_dpp v77, v94, v25 row_newbcast:3 row_mask:0xf bank_mask:0xf
    v_fmac_f32_dpp v78, v94, v26 row_newbcast:3 row_mask:0xf bank_mask:0xf
    v_fmac_f32_dpp v79, v94, v27 row_newbcast:3 row_mask:0xf bank_mask:0xf
    s_waitcnt vmcnt(4)
    v_cvt_f32_i32 v28, v4
    v_cvt_f32_i32 v29, v5
    v_cvt_f32_i32 v30, v6
    v_cvt_f32_i32 v31, v7
    s_add_u32 s71, s71, 3072
    buffer_load_dwordx4 v[4:7], v1, s[28:31], s71 offen offset:0 nt
    v_fmac_f32_dpp v80, v94, v28 row_newbcast:3 row_mask:0xf bank_mask:0xf
    v_fmac_f32_dpp v81, v94, v29 row_newbcast:3 row_mask:0xf bank_mask:0xf
    v_fmac_f32_dpp v82, v94, v30 row_newbcast:3 row_mask:0xf bank_mask:0xf
    v_fmac_f32_dpp v83, v94, v31 row_newbcast:3 row_mask:0xf bank_mask:0xf
    s_waitcnt vmcnt(4)
    v_cvt_f32_i32 v24, v8
    v_cvt_f32_i32 v25, v9
    v_cvt_f32_i32 v26, v10
    v_cvt_f32_i32 v27, v11
    buffer_load_dwordx4 v[8:11], v1, s[28:31], s71 offen offset:256 nt
    v_fmac_f32_dpp v84, v94, v24 row_newbcast:3 row_mask:0xf bank_mask:0xf
    v_fmac_f32_dpp v85, v94, v25 row_newbcast:3 row_mask:0xf bank_mask:0xf
    v_fmac_f32_dpp v86, v94, v26 row_newbcast:3 row_mask:0xf bank_mask:0xf
    v_fmac_f32_dpp v87, v94, v27 row_newbcast:3 row_mask:0xf bank_mask:0xf
    s_waitcnt vmcnt(4)
    v_cvt_f32_i32 v28, v12
    v_cvt_f32_i32 v29, v13
    v_cvt_f32_i32 v30, v14
    v_cvt_f32_i32 v31, v15
    buffer_load_dwordx4 v[12:15], v1, s[28:31], s71 offen offset:512 nt
    v_fmac_f32_dpp v76, v94, v28 row_newbcast:11 row_mask:0xf bank_mask:0xf
    v_fmac_f32_dpp v77, v94, v29 row_newbcast:11 row_mask:0xf bank_mask:0xf
    v_fmac_f32_dpp v78, v94, v30 row_newbcast:11 row_mask:0xf bank_mask:0xf
    v_fmac_f32_dpp v79, v94, v31 row_newbcast:11 row_mask:0xf bank_mask:0xf
    s_waitcnt vmcnt(4)
    v_cvt_f32_i32 v24, v16
    v_cvt_f32_i32 v25, v17
    v_cvt_f32_i32 v26, v18
    v_cvt_f32_i32 v27, v19
    s_add_u32 s71, s71, 3072
    buffer_load_dwordx4 v[16:19], v1, s[28:31], s71 offen offset:0 nt
    v_fmac_f32_dpp v80, v94, v24 row_newbcast:11 row_mask:0xf bank_mask:0xf
    v_fmac_f32_dpp v81, v94, v25 row_newbcast:11 row_mask:0xf bank_mask:0xf
    v_fmac_f32_dpp v82, v94, v26 row_newbcast:11 row_mask:0xf bank_mask:0xf
    v_fmac_f32_dpp v83, v94, v27 row_newbcast:11 row_mask:0xf bank_mask:0xf
    s_waitcnt vmcnt(4)
    v_cvt_f32_i32 v28, v20
    v_cvt_f32_i32 v29, v21
    v_cvt_f32_i32 v30, v22
    v_cvt_f32_i32 v31, v23
    buffer_load_dwordx4 v[20:23], v1, s[28:31], s71 offen offset:256 nt
    v_fmac_f32_dpp v84, v94, v28 row_newbcast:11 row_mask:0xf bank_mask:0xf
    v_fmac_f32_dpp v85, v94, v29 row_newbcast:11 row_mask:0xf bank_mask:0xf
    v_fmac_f32_dpp v86, v94, v30 row_newbcast:11 row_mask:0xf bank_mask:0xf
    v_fmac_f32_dpp v87, v94, v31 row_newbcast:11 row_mask:0xf bank_mask:0xf
    s_waitcnt vmcnt(4)
    v_cvt_f32_i32 v24, v4
    v_cvt_f32_i32 v25, v5
    v_cvt_f32_i32 v26, v6
    v_cvt_f32_i32 v27, v7
    buffer_load_dwordx4 v[4:7], v1, s[28:31], s71 offen offset:512 nt
    v_fmac_f32_dpp v76, v94, v24 row_newbcast:7 row_mask:0xf bank_mask:0xf
    v_fmac_f32_dpp v77, v94, v25 row_newbcast:7 row_mask:0xf bank_mask:0xf
    v_fmac_f32_dpp v78, v94, v26 row_newbcast:7 row_mask:0xf bank_mask:0xf
    v_fmac_f32_dpp v79, v94, v27 row_newbcast:7 row_mask:0xf bank_mask:0xf
    s_waitcnt vmcnt(4)
    v_cvt_f32_i32 v28, v8
    v_cvt_f32_i32 v29, v9
    v_cvt_f32_i32 v30, v10
    v_cvt_f32_i32 v31, v11
    s_add_u32 s70, s70, 64
    s_sub_u32 s75, s75, 1
    s_cmp_eq_u32 s75, 0
    s_cselect_b32 s80, 1536, 0
    s_cselect_b32 s75, 2, s75
    s_add_u32 s70, s70, s80
    s_lshl_b32 s73, s70, 7
    buffer_load_ushort v92, v3, s[40:43], s73 offen
    buffer_load_ushort v93, v3, s[44:47], s73 offen
    s_mul_i32 s71, s70, 49152
    buffer_load_dwordx4 v[8:11], v1, s[28:31], s71 offen offset:0 nt
    v_fmac_f32_dpp v80, v94, v28 row_newbcast:7 row_mask:0xf bank_mask:0xf
    v_fmac_f32_dpp v81, v94, v29 row_newbcast:7 row_mask:0xf bank_mask:0xf
    v_fmac_f32_dpp v82, v94, v30 row_newbcast:7 row_mask:0xf bank_mask:0xf
    v_fmac_f32_dpp v83, v94, v31 row_newbcast:7 row_mask:0xf bank_mask:0xf
    s_waitcnt vmcnt(6)
    v_cvt_f32_i32 v24, v12
    v_cvt_f32_i32 v25, v13
    v_cvt_f32_i32 v26, v14
    v_cvt_f32_i32 v27, v15
    buffer_load_dwordx4 v[12:15], v1, s[28:31], s71 offen offset:256 nt
    v_fmac_f32_dpp v84, v94, v24 row_newbcast:7 row_mask:0xf bank_mask:0xf
    v_fmac_f32_dpp v85, v94, v25 row_newbcast:7 row_mask:0xf bank_mask:0xf
    v_fmac_f32_dpp v86, v94, v26 row_newbcast:7 row_mask:0xf bank_mask:0xf
    v_fmac_f32_dpp v87, v94, v27 row_newbcast:7 row_mask:0xf bank_mask:0xf
    s_waitcnt vmcnt(6)
    v_cvt_f32_i32 v28, v16
    v_cvt_f32_i32 v29, v17
    v_cvt_f32_i32 v30, v18
    v_cvt_f32_i32 v31, v19
    buffer_load_dwordx4 v[16:19], v1, s[28:31], s71 offen offset:512 nt
    v_fmac_f32_dpp v76, v94, v28 row_newbcast:15 row_mask:0xf bank_mask:0xf
    v_fmac_f32_dpp v77, v94, v29 row_newbcast:15 row_mask:0xf bank_mask:0xf
    v_fmac_f32_dpp v78, v94, v30 row_newbcast:15 row_mask:0xf bank_mask:0xf
    v_fmac_f32_dpp v79, v94, v31 row_newbcast:15 row_mask:0xf bank_mask:0xf
    s_waitcnt vmcnt(6)
    v_cvt_f32_i32 v24, v20
    v_cvt_f32_i32 v25, v21
    v_cvt_f32_i32 v26, v22
    v_cvt_f32_i32 v27, v23
    s_add_u32 s71, s71, 3072
    buffer_load_dwordx4 v[20:23], v1, s[28:31], s71 offen offset:0 nt
    v_fmac_f32_dpp v80, v94, v24 row_newbcast:15 row_mask:0xf bank_mask:0xf
    v_fmac_f32_dpp v81, v94, v25 row_newbcast:15 row_mask:0xf bank_mask:0xf
    v_fmac_f32_dpp v82, v94, v26 row_newbcast:15 row_mask:0xf bank_mask:0xf
    v_fmac_f32_dpp v83, v94, v27 row_newbcast:15 row_mask:0xf bank_mask:0xf
    s_waitcnt vmcnt(6)
    v_cvt_f32_i32 v28, v4
    v_cvt_f32_i32 v29, v5
    v_cvt_f32_i32 v30, v6
    v_cvt_f32_i32 v31, v7
    buffer_load_dwordx4 v[4:7], v1, s[28:31], s71 offen offset:256 nt
    v_fmac_f32_dpp v84, v94, v28 row_newbcast:15 row_mask:0xf bank_mask:0xf
    v_fmac_f32_dpp v85, v94, v29 row_newbcast:15 row_mask:0xf bank_mask:0xf
    v_fmac_f32_dpp v86, v94, v30 row_newbcast:15 row_mask:0xf bank_mask:0xf
    v_fmac_f32_dpp v87, v94, v31 row_newbcast:15 row_mask:0xf bank_mask:0xf
    s_sub_u32 s77, s77, 1
    s_cmp_lg_u32 s77, 0
    s_cbranch_scc1 L_nofl6
    s_nop 0
    v_add_f32_dpp v90, v90, v90 row_ror:8 row_mask:0xf bank_mask:0xf
    v_add_f32_dpp v91, v91, v91 row_ror:8 row_mask:0xf bank_mask:0xf
    s_nop 0
    v_add_f32_dpp v90, v90, v90 row_ror:4 row_mask:0xf bank_mask:0xf
    v_add_f32_dpp v91, v91, v91 row_ror:4 row_mask:0xf bank_mask:0xf
    s_nop 0
    v_add_f32_dpp v90, v90, v90 row_ror:2 row_mask:0xf bank_mask:0xf
    v_add_f32_dpp v91, v91, v91 row_ror:2 row_mask:0xf bank_mask:0xf
    s_nop 0
    v_add_f32_dpp v90, v90, v90 row_ror:1 row_mask:0xf bank_mask:0xf
    v_add_f32_dpp v91, v91, v91 row_ror:1 row_mask:0xf bank_mask:0xf
    v_mov_b32 v102, v89
    v_mov_b32 v103, v89
    s_nop 1
    v_permlane32_swap_b32 v102, v103
    s_nop 1
    v_max_f32 v102, v102, v103
    v_mov_b32 v103, v102
    s_nop 1
    v_permlane16_swap_b32 v102, v103
    s_nop 1
    v_max_f32 v102, v102, v103
    v_sub_f32 v103, v89, v102
    v_exp_f32 v103, v103
    v_mov_b32 v89, v102
    v_mul_f32 v90, v90, v103
    v_mul_f32 v91, v91, v103
    v_fma_f32 v76, v76, v103, -v91
    v_fma_f32 v77, v77, v103, -v91
    v_fma_f32 v78, v78, v103, -v91
    v_fma_f32 v79, v79, v103, -v91
    v_fma_f32 v80, v80, v103, -v91
    v_fma_f32 v81, v81, v103, -v91
    v_fma_f32 v82, v82, v103, -v91
    v_fma_f32 v83, v83, v103, -v91
    v_fma_f32 v84, v84, v103, -v91
    v_fma_f32 v85, v85, v103, -v91
    v_fma_f32 v86, v86, v103, -v91
    v_fma_f32 v87, v87, v103, -v91
    v_mov_b32 v102, v90
    s_nop 1
    v_permlane32_swap_b32 v90, v102
    v_permlane32_swap_b32 v76, v78
    v_permlane32_swap_b32 v77, v79
    v_permlane32_swap_b32 v80, v82
    v_permlane32_swap_b32 v81, v83
    v_permlane32_swap_b32 v84, v86
    v_permlane32_swap_b32 v85, v87
    s_nop 1
    v_add_f32 v90, v90, v102
    v_add_f32 v76, v76, v78
    v_add_f32 v77, v77, v79
    v_add_f32 v80, v80, v82
    v_add_f32 v81, v81, v83
    v_add_f32 v84, v84, v86
    v_add_f32 v85, v85, v87
    v_mov_b32 v102, v90
    s_nop 1
    v_permlane16_swap_b32 v90, v102
    v_permlane16_swap_b32 v76, v77
    v_permlane16_swap_b32 v80, v81
    v_permlane16_swap_b32 v84, v85
    s_nop 1
    v_add_f32 v90, v90, v102
    v_add_f32 v76, v76, v77
    v_add_f32 v80, v80, v81
    v_add_f32 v84, v84, v85
    ds_write_b32 v106, v76 offset:16640
    ds_write_b32 v106, v80 offset:16896
    ds_write_b32 v106, v84 offset:17152
    ds_write_b32 v107, v89 offset:17408
    ds_write_b32 v107, v90 offset:17412
    s_waitcnt lgkmcnt(0)
    s_mov_b64 exec, 1
    ds_add_u32 v108, v109
    s_mov_b64 exec, -1
    v_add_u32 v106, 4096, v106
    v_add_u32 v107, 4096, v107
    v_add_u32 v108, 4, v108
    v_mov_b32 v89, 0xf149f2ca
    v_mov_b32 v90, 0
    v_mov_b32 v91, 0
    v_mov_b32 v76, 0
    v_mov_b32 v77, 0
    v_mov_b32 v78, 0
    v_mov_b32 v79, 0
    v_mov_b32 v80, 0
    v_mov_b32 v81, 0
    v_mov_b32 v82, 0
    v_mov_b32 v83, 0
    v_mov_b32 v84, 0
    v_mov_b32 v85, 0
    v_mov_b32 v86, 0
    v_mov_b32 v87, 0
    s_mov_b32 s77, 2
L_nofl6:
    s_waitcnt vmcnt(5)
    v_lshlrev_b32 v92, 16, v92
    v_lshlrev_b32 v93, 16, v93
    s_waitcnt lgkmcnt(0)
    v_max_f32_dpp v102, v95, v95 row_ror:8 row_mask:0xf bank_mask:0xf
    s_nop 1
    v_max_f32_dpp v102, v102, v102 row_ror:4 row_mask:0xf bank_mask:0xf
    s_nop 1
    v_max_f32_dpp v102, v102, v102 row_ror:2 row_mask:0xf bank_mask:0xf
    s_nop 1
    v_max_f32_dpp v102, v102, v102 row_ror:1 row_mask:0xf bank_mask:0xf
    v_max_f32 v102, v102, v89
    v_sub_f32 v103, v89, v102
    v_sub_f32 v94, v95, v102
    v_exp_f32 v103, v103
    v_exp_f32 v94, v94
    v_mov_b32 v89, v102
    v_fma_f32 v90, v90, v103, v94
    v_mul_f32 v94, v94, v92
    v_mul_f32 v91, v91, v103
    v_fmac_f32 v91, v94, v93
    ds_read_b32 v95, v105
    v_add_u32 v105, 256, v105
    v_mul_f32 v76, v76, v103
    v_mul_f32 v77, v77, v103
    v_mul_f32 v78, v78, v103
    v_mul_f32 v79, v79, v103
    v_mul_f32 v80, v80, v103
    v_mul_f32 v81, v81, v103
    v_mul_f32 v82, v82, v103
    v_mul_f32 v83, v83, v103
    v_mul_f32 v84, v84, v103
    v_mul_f32 v85, v85, v103
    v_mul_f32 v86, v86, v103
    v_mul_f32 v87, v87, v103
    s_waitcnt vmcnt(4)
    v_cvt_f32_i32 v24, v8
    v_cvt_f32_i32 v25, v9
    v_cvt_f32_i32 v26, v10
    v_cvt_f32_i32 v27, v11
    buffer_load_dwordx4 v[8:11], v1, s[28:31], s71 offen offset:512 nt
    v_fmac_f32_dpp v76, v94, v24 row_newbcast:0 row_mask:0xf bank_mask:0xf
    v_fmac_f32_dpp v77, v94, v25 row_newbcast:0 row_mask:0xf bank_mask:0xf
    v_fmac_f32_dpp v78, v94, v26 row_newbcast:0 row_mask:0xf bank_mask:0xf
    v_fmac_f32_dpp v79, v94, v27 row_newbcast:0 row_mask:0xf bank_mask:0xf
    s_waitcnt vmcnt(4)
    v_cvt_f32_i32 v28, v12
    v_cvt_f32_i32 v29, v13
    v_cvt_f32_i32 v30, v14
    v_cvt_f32_i32 v31, v15
    s_add_u32 s71, s71, 3072
    buffer_load_dwordx4 v[12:15], v1, s[28:31], s71 offen offset:0 nt
    v_fmac_f32_dpp v80, v94, v28 row_newbcast:0 row_mask:0xf bank_mask:0xf
    v_fmac_f32_dpp v81, v94, v29 row_newbcast:0 row_mask:0xf bank_mask:0xf
    v_fmac_f32_dpp v82, v94, v30 row_newbcast:0 row_mask:0xf bank_mask:0xf
    v_fmac_f32_dpp v83, v94, v31 row_newbcast:0 row_mask:0xf bank_mask:0xf
    s_waitcnt vmcnt(4)
    v_cvt_f32_i32 v24, v16
    v_cvt_f32_i32 v25, v17
    v_cvt_f32_i32 v26, v18
    v_cvt_f32_i32 v27, v19
    buffer_load_dwordx4 v[16:19], v1, s[28:31], s71 offen offset:256 nt
    v_fmac_f32_dpp v84, v94, v24 row_newbcast:0 row_mask:0xf bank_mask:0xf
    v_fmac_f32_dpp v85, v94, v25 row_newbcast:0 row_mask:0xf bank_mask:0xf
    v_fmac_f32_dpp v86, v94, v26 row_newbcast:0 row_mask:0xf bank_mask:0xf
    v_fmac_f32_dpp v87, v94, v27 row_newbcast:0 row_mask:0xf bank_mask:0xf
    s_waitcnt vmcnt(4)
    v_cvt_f32_i32 v28, v20
    v_cvt_f32_i32 v29, v21
    v_cvt_f32_i32 v30, v22
    v_cvt_f32_i32 v31, v23
    buffer_load_dwordx4 v[20:23], v1, s[28:31], s71 offen offset:512 nt
    v_fmac_f32_dpp v76, v94, v28 row_newbcast:8 row_mask:0xf bank_mask:0xf
    v_fmac_f32_dpp v77, v94, v29 row_newbcast:8 row_mask:0xf bank_mask:0xf
    v_fmac_f32_dpp v78, v94, v30 row_newbcast:8 row_mask:0xf bank_mask:0xf
    v_fmac_f32_dpp v79, v94, v31 row_newbcast:8 row_mask:0xf bank_mask:0xf
    s_waitcnt vmcnt(4)
    v_cvt_f32_i32 v24, v4
    v_cvt_f32_i32 v25, v5
    v_cvt_f32_i32 v26, v6
    v_cvt_f32_i32 v27, v7
    s_add_u32 s71, s71, 3072
    buffer_load_dwordx4 v[4:7], v1, s[28:31], s71 offen offset:0 nt
    v_fmac_f32_dpp v80, v94, v24 row_newbcast:8 row_mask:0xf bank_mask:0xf
    v_fmac_f32_dpp v81, v94, v25 row_newbcast:8 row_mask:0xf bank_mask:0xf
    v_fmac_f32_dpp v82, v94, v26 row_newbcast:8 row_mask:0xf bank_mask:0xf
    v_fmac_f32_dpp v83, v94, v27 row_newbcast:8 row_mask:0xf bank_mask:0xf
    s_waitcnt vmcnt(4)
    v_cvt_f32_i32 v28, v8
    v_cvt_f32_i32 v29, v9
    v_cvt_f32_i32 v30, v10
    v_cvt_f32_i32 v31, v11
    buffer_load_dwordx4 v[8:11], v1, s[28:31], s71 offen offset:256 nt
    v_fmac_f32_dpp v84, v94, v28 row_newbcast:8 row_mask:0xf bank_mask:0xf
    v_fmac_f32_dpp v85, v94, v29 row_newbcast:8 row_mask:0xf bank_mask:0xf
    v_fmac_f32_dpp v86, v94, v30 row_newbcast:8 row_mask:0xf bank_mask:0xf
    v_fmac_f32_dpp v87, v94, v31 row_newbcast:8 row_mask:0xf bank_mask:0xf
    s_waitcnt vmcnt(4)
    v_cvt_f32_i32 v24, v12
    v_cvt_f32_i32 v25, v13
    v_cvt_f32_i32 v26, v14
    v_cvt_f32_i32 v27, v15
    buffer_load_dwordx4 v[12:15], v1, s[28:31], s71 offen offset:512 nt
    v_fmac_f32_dpp v76, v94, v24 row_newbcast:4 row_mask:0xf bank_mask:0xf
    v_fmac_f32_dpp v77, v94, v25 row_newbcast:4 row_mask:0xf bank_mask:0xf
    v_fmac_f32_dpp v78, v94, v26 row_newbcast:4 row_mask:0xf bank_mask:0xf
    v_fmac_f32_dpp v79, v94, v27 row_newbcast:4 row_mask:0xf bank_mask:0xf
    s_waitcnt vmcnt(4)
    v_cvt_f32_i32 v28, v16
    v_cvt_f32_i32 v29, v17
    v_cvt_f32_i32 v30, v18
    v_cvt_f32_i32 v31, v19
    s_add_u32 s70, s70, 64
    s_mul_i32 s71, s70, 49152
    buffer_load_dwordx4 v[16:19], v1, s[28:31], s71 offen offset:0 nt
    v_fmac_f32_dpp v80, v94, v28 row_newbcast:4 row_mask:0xf bank_mask:0xf
    v_fmac_f32_dpp v81, v94, v29 row_newbcast:4 row_mask:0xf bank_mask:0xf
    v_fmac_f32_dpp v82, v94, v30 row_newbcast:4 row_mask:0xf bank_mask:0xf
    v_fmac_f32_dpp v83, v94, v31 row_newbcast:4 row_mask:0xf bank_mask:0xf
    s_waitcnt vmcnt(4)
    v_cvt_f32_i32 v24, v20
    v_cvt_f32_i32 v25, v21
    v_cvt_f32_i32 v26, v22
    v_cvt_f32_i32 v27, v23
    buffer_load_dwordx4 v[20:23], v1, s[28:31], s71 offen offset:256 nt
    v_fmac_f32_dpp v84, v94, v24 row_newbcast:4 row_mask:0xf bank_mask:0xf
    v_fmac_f32_dpp v85, v94, v25 row_newbcast:4 row_mask:0xf bank_mask:0xf
    v_fmac_f32_dpp v86, v94, v26 row_newbcast:4 row_mask:0xf bank_mask:0xf
    v_fmac_f32_dpp v87, v94, v27 row_newbcast:4 row_mask:0xf bank_mask:0xf
    s_waitcnt vmcnt(4)
    v_cvt_f32_i32 v28, v4
    v_cvt_f32_i32 v29, v5
    v_cvt_f32_i32 v30, v6
    v_cvt_f32_i32 v31, v7
    buffer_load_dwordx4 v[4:7], v1, s[28:31], s71 offen offset:512 nt
    v_fmac_f32_dpp v76, v94, v28 row_newbcast:12 row_mask:0xf bank_mask:0xf
    v_fmac_f32_dpp v77, v94, v29 row_newbcast:12 row_mask:0xf bank_mask:0xf
    v_fmac_f32_dpp v78, v94, v30 row_newbcast:12 row_mask:0xf bank_mask:0xf
    v_fmac_f32_dpp v79, v94, v31 row_newbcast:12 row_mask:0xf bank_mask:0xf
    s_waitcnt vmcnt(4)
    v_cvt_f32_i32 v24, v8
    v_cvt_f32_i32 v25, v9
    v_cvt_f32_i32 v26, v10
    v_cvt_f32_i32 v27, v11
    s_add_u32 s71, s71, 3072
    buffer_load_dwordx4 v[8:11], v1, s[28:31], s71 offen offset:0 nt
    v_fmac_f32_dpp v80, v94, v24 row_newbcast:12 row_mask:0xf bank_mask:0xf
    v_fmac_f32_dpp v81, v94, v25 row_newbcast:12 row_mask:0xf bank_mask:0xf
    v_fmac_f32_dpp v82, v94, v26 row_newbcast:12 row_mask:0xf bank_mask:0xf
    v_fmac_f32_dpp v83, v94, v27 row_newbcast:12 row_mask:0xf bank_mask:0xf
    s_waitcnt vmcnt(4)
    v_cvt_f32_i32 v28, v12
    v_cvt_f32_i32 v29, v13
    v_cvt_f32_i32 v30, v14
    v_cvt_f32_i32 v31, v15
    buffer_load_dwordx4 v[12:15], v1, s[28:31], s71 offen offset:256 nt
    v_fmac_f32_dpp v84, v94, v28 row_newbcast:12 row_mask:0xf bank_mask:0xf
    v_fmac_f32_dpp v85, v94, v29 row_newbcast:12 row_mask:0xf bank_mask:0xf
    v_fmac_f32_dpp v86, v94, v30 row_newbcast:12 row_mask:0xf bank_mask:0xf
    v_fmac_f32_dpp v87, v94, v31 row_newbcast:12 row_mask:0xf bank_mask:0xf
    s_waitcnt vmcnt(4)
    v_cvt_f32_i32 v24, v16
    v_cvt_f32_i32 v25, v17
    v_cvt_f32_i32 v26, v18
    v_cvt_f32_i32 v27, v19
    buffer_load_dwordx4 v[16:19], v1, s[28:31], s71 offen offset:512 nt
    v_fmac_f32_dpp v76, v94, v24 row_newbcast:2 row_mask:0xf bank_mask:0xf
    v_fmac_f32_dpp v77, v94, v25 row_newbcast:2 row_mask:0xf bank_mask:0xf
    v_fmac_f32_dpp v78, v94, v26 row_newbcast:2 row_mask:0xf bank_mask:0xf
    v_fmac_f32_dpp v79, v94, v27 row_newbcast:2 row_mask:0xf bank_mask:0xf
    s_waitcnt vmcnt(4)
    v_cvt_f32_i32 v28, v20
    v_cvt_f32_i32 v29, v21
    v_cvt_f32_i32 v30, v22
    v_cvt_f32_i32 v31, v23
    s_add_u32 s71, s71, 3072
    buffer_load_dwordx4 v[20:23], v1, s[28:31], s71 offen offset:0 nt
    v_fmac_f32_dpp v80, v94, v28 row_newbcast:2 row_mask:0xf bank_mask:0xf
    v_fmac_f32_dpp v81, v94, v29 row_newbcast:2 row_mask:0xf bank_mask:0xf
    v_fmac_f32_dpp v82, v94, v30 row_newbcast:2 row_mask:0xf bank_mask:0xf
    v_fmac_f32_dpp v83, v94, v31 row_newbcast:2 row_mask:0xf bank_mask:0xf
    s_waitcnt vmcnt(4)
    v_cvt_f32_i32 v24, v4
    v_cvt_f32_i32 v25, v5
    v_cvt_f32_i32 v26, v6
    v_cvt_f32_i32 v27, v7
    buffer_load_dwordx4 v[4:7], v1, s[28:31], s71 offen offset:256 nt
    v_fmac_f32_dpp v84, v94, v24 row_newbcast:2 row_mask:0xf bank_mask:0xf
    v_fmac_f32_dpp v85, v94, v25 row_newbcast:2 row_mask:0xf bank_mask:0xf
    v_fmac_f32_dpp v86, v94, v26 row_newbcast:2 row_mask:0xf bank_mask:0xf
    v_fmac_f32_dpp v87, v94, v27 row_newbcast:2 row_mask:0xf bank_mask:0xf
    s_waitcnt vmcnt(4)
    v_cvt_f32_i32 v28, v8
    v_cvt_f32_i32 v29, v9
    v_cvt_f32_i32 v30, v10
    v_cvt_f32_i32 v31, v11
    buffer_load_dwordx4 v[8:11], v1, s[28:31], s71 offen offset:512 nt
    v_fmac_f32_dpp v76, v94, v28 row_newbcast:10 row_mask:0xf bank_mask:0xf
    v_fmac_f32_dpp v77, v94, v29 row_newbcast:10 row_mask:0xf bank_mask:0xf
    v_fmac_f32_dpp v78, v94, v30 row_newbcast:10 row_mask:0xf bank_mask:0xf
    v_fmac_f32_dpp v79, v94, v31 row_newbcast:10 row_mask:0xf bank_mask:0xf
    s_waitcnt vmcnt(4)
    v_cvt_f32_i32 v24, v12
    v_cvt_f32_i32 v25, v13
    v_cvt_f32_i32 v26, v14
    v_cvt_f32_i32 v27, v15
    s_add_u32 s71, s71, 3072
    buffer_load_dwordx4 v[12:15], v1, s[28:31], s71 offen offset:0 nt
    v_fmac_f32_dpp v80, v94, v24 row_newbcast:10 row_mask:0xf bank_mask:0xf
    v_fmac_f32_dpp v81, v94, v25 row_newbcast:10 row_mask:0xf bank_mask:0xf
    v_fmac_f32_dpp v82, v94, v26 row_newbcast:10 row_mask:0xf bank_mask:0xf
    v_fmac_f32_dpp v83, v94, v27 row_newbcast:10 row_mask:0xf bank_mask:0xf
    s_waitcnt vmcnt(4)
    v_cvt_f32_i32 v28, v16
    v_cvt_f32_i32 v29, v17
    v_cvt_f32_i32 v30, v18
    v_cvt_f32_i32 v31, v19
    buffer_load_dwordx4 v[16:19], v1, s[28:31], s71 offen offset:256 nt
    v_fmac_f32_dpp v84, v94, v28 row_newbcast:10 row_mask:0xf bank_mask:0xf
    v_fmac_f32_dpp v85, v94, v29 row_newbcast:10 row_mask:0xf bank_mask:0xf
    v_fmac_f32_dpp v86, v94, v30 row_newbcast:10 row_mask:0xf bank_mask:0xf
    v_fmac_f32_dpp v87, v94, v31 row_newbcast:10 row_mask:0xf bank_mask:0xf
    s_waitcnt vmcnt(4)
    v_cvt_f32_i32 v24, v20
    v_cvt_f32_i32 v25, v21
    v_cvt_f32_i32 v26, v22
    v_cvt_f32_i32 v27, v23
    buffer_load_dwordx4 v[20:23], v1, s[28:31], s71 offen offset:512 nt
    v_fmac_f32_dpp v76, v94, v24 row_newbcast:6 row_mask:0xf bank_mask:0xf
    v_fmac_f32_dpp v77, v94, v25 row_newbcast:6 row_mask:0xf bank_mask:0xf
    v_fmac_f32_dpp v78, v94, v26 row_newbcast:6 row_mask:0xf bank_mask:0xf
    v_fmac_f32_dpp v79, v94, v27 row_newbcast:6 row_mask:0xf bank_mask:0xf
    s_waitcnt vmcnt(4)
    v_cvt_f32_i32 v28, v4
    v_cvt_f32_i32 v29, v5
    v_cvt_f32_i32 v30, v6
    v_cvt_f32_i32 v31, v7
    s_add_u32 s70, s70, 64
    s_mul_i32 s71, s70, 49152
    buffer_load_dwordx4 v[4:7], v1, s[28:31], s71 offen offset:0 nt
    v_fmac_f32_dpp v80, v94, v28 row_newbcast:6 row_mask:0xf bank_mask:0xf
    v_fmac_f32_dpp v81, v94, v29 row_newbcast:6 row_mask:0xf bank_mask:0xf
    v_fmac_f32_dpp v82, v94, v30 row_newbcast:6 row_mask:0xf bank_mask:0xf
    v_fmac_f32_dpp v83, v94, v31 row_newbcast:6 row_mask:0xf bank_mask:0xf
    s_waitcnt vmcnt(4)
    v_cvt_f32_i32 v24, v8
    v_cvt_f32_i32 v25, v9
    v_cvt_f32_i32 v26, v10
    v_cvt_f32_i32 v27, v11
    buffer_load_dwordx4 v[8:11], v1, s[28:31], s71 offen offset:256 nt
    v_fmac_f32_dpp v84, v94, v24 row_newbcast:6 row_mask:0xf bank_mask:0xf
    v_fmac_f32_dpp v85, v94, v25 row_newbcast:6 row_mask:0xf bank_mask:0xf
    v_fmac_f32_dpp v86, v94, v26 row_newbcast:6 row_mask:0xf bank_mask:0xf
    v_fmac_f32_dpp v87, v94, v27 row_newbcast:6 row_mask:0xf bank_mask:0xf
    s_waitcnt vmcnt(4)
    v_cvt_f32_i32 v28, v12
    v_cvt_f32_i32 v29, v13
    v_cvt_f32_i32 v30, v14
    v_cvt_f32_i32 v31, v15
    buffer_load_dwordx4 v[12:15], v1, s[28:31], s71 offen offset:512 nt
    v_fmac_f32_dpp v76, v94, v28 row_newbcast:14 row_mask:0xf bank_mask:0xf
    v_fmac_f32_dpp v77, v94, v29 row_newbcast:14 row_mask:0xf bank_mask:0xf
    v_fmac_f32_dpp v78, v94, v30 row_newbcast:14 row_mask:0xf bank_mask:0xf
    v_fmac_f32_dpp v79, v94, v31 row_newbcast:14 row_mask:0xf bank_mask:0xf
    s_waitcnt vmcnt(4)
    v_cvt_f32_i32 v24, v16
    v_cvt_f32_i32 v25, v17
    v_cvt_f32_i32 v26, v18
    v_cvt_f32_i32 v27, v19
    s_add_u32 s71, s71, 3072
    buffer_load_dwordx4 v[16:19], v1, s[28:31], s71 offen offset:0 nt
    v_fmac_f32_dpp v80, v94, v24 row_newbcast:14 row_mask:0xf bank_mask:0xf
    v_fmac_f32_dpp v81, v94, v25 row_newbcast:14 row_mask:0xf bank_mask:0xf
    v_fmac_f32_dpp v82, v94, v26 row_newbcast:14 row_mask:0xf bank_mask:0xf
    v_fmac_f32_dpp v83, v94, v27 row_newbcast:14 row_mask:0xf bank_mask:0xf
    s_waitcnt vmcnt(4)
    v_cvt_f32_i32 v28, v20
    v_cvt_f32_i32 v29, v21
    v_cvt_f32_i32 v30, v22
    v_cvt_f32_i32 v31, v23
    buffer_load_dwordx4 v[20:23], v1, s[28:31], s71 offen offset:256 nt
    v_fmac_f32_dpp v84, v94, v28 row_newbcast:14 row_mask:0xf bank_mask:0xf
    v_fmac_f32_dpp v85, v94, v29 row_newbcast:14 row_mask:0xf bank_mask:0xf
    v_fmac_f32_dpp v86, v94, v30 row_newbcast:14 row_mask:0xf bank_mask:0xf
    v_fmac_f32_dpp v87, v94, v31 row_newbcast:14 row_mask:0xf bank_mask:0xf
    s_waitcnt vmcnt(4)
    v_cvt_f32_i32 v24, v4
    v_cvt_f32_i32 v25, v5
    v_cvt_f32_i32 v26, v6
    v_cvt_f32_i32 v27, v7
    buffer_load_dwordx4 v[4:7], v1, s[28:31], s71 offen offset:512 nt
    v_fmac_f32_dpp v76, v94, v24 row_newbcast:1 row_mask:0xf bank_mask:0xf
    v_fmac_f32_dpp v77, v94, v25 row_newbcast:1 row_mask:0xf bank_mask:0xf
    v_fmac_f32_dpp v78, v94, v26 row_newbcast:1 row_mask:0xf bank_mask:0xf
    v_fmac_f32_dpp v79, v94, v27 row_newbcast:1 row_mask:0xf bank_mask:0xf
    s_waitcnt vmcnt(4)
    v_cvt_f32_i32 v28, v8
    v_cvt_f32_i32 v29, v9
    v_cvt_f32_i32 v30, v10
    v_cvt_f32_i32 v31, v11
    s_add_u32 s71, s71, 3072
    buffer_load_dwordx4 v[8:11], v1, s[28:31], s71 offen offset:0 nt
    v_fmac_f32_dpp v80, v94, v28 row_newbcast:1 row_mask:0xf bank_mask:0xf
    v_fmac_f32_dpp v81, v94, v29 row_newbcast:1 row_mask:0xf bank_mask:0xf
    v_fmac_f32_dpp v82, v94, v30 row_newbcast:1 row_mask:0xf bank_mask:0xf
    v_fmac_f32_dpp v83, v94, v31 row_newbcast:1 row_mask:0xf bank_mask:0xf
    s_waitcnt vmcnt(4)
    v_cvt_f32_i32 v24, v12
    v_cvt_f32_i32 v25, v13
    v_cvt_f32_i32 v26, v14
    v_cvt_f32_i32 v27, v15
    buffer_load_dwordx4 v[12:15], v1, s[28:31], s71 offen offset:256 nt
    v_fmac_f32_dpp v84, v94, v24 row_newbcast:1 row_mask:0xf bank_mask:0xf
    v_fmac_f32_dpp v85, v94, v25 row_newbcast:1 row_mask:0xf bank_mask:0xf
    v_fmac_f32_dpp v86, v94, v26 row_newbcast:1 row_mask:0xf bank_mask:0xf
    v_fmac_f32_dpp v87, v94, v27 row_newbcast:1 row_mask:0xf bank_mask:0xf
    s_waitcnt vmcnt(4)
    v_cvt_f32_i32 v28, v16
    v_cvt_f32_i32 v29, v17
    v_cvt_f32_i32 v30, v18
    v_cvt_f32_i32 v31, v19
    buffer_load_dwordx4 v[16:19], v1, s[28:31], s71 offen offset:512 nt
    v_fmac_f32_dpp v76, v94, v28 row_newbcast:9 row_mask:0xf bank_mask:0xf
    v_fmac_f32_dpp v77, v94, v29 row_newbcast:9 row_mask:0xf bank_mask:0xf
    v_fmac_f32_dpp v78, v94, v30 row_newbcast:9 row_mask:0xf bank_mask:0xf
    v_fmac_f32_dpp v79, v94, v31 row_newbcast:9 row_mask:0xf bank_mask:0xf
    s_waitcnt vmcnt(4)
    v_cvt_f32_i32 v24, v20
    v_cvt_f32_i32 v25, v21
    v_cvt_f32_i32 v26, v22
    v_cvt_f32_i32 v27, v23
    s_add_u32 s71, s71, 3072
    buffer_load_dwordx4 v[20:23], v1, s[28:31], s71 offen offset:0 nt
    v_fmac_f32_dpp v80, v94, v24 row_newbcast:9 row_mask:0xf bank_mask:0xf
    v_fmac_f32_dpp v81, v94, v25 row_newbcast:9 row_mask:0xf bank_mask:0xf
    v_fmac_f32_dpp v82, v94, v26 row_newbcast:9 row_mask:0xf bank_mask:0xf
    v_fmac_f32_dpp v83, v94, v27 row_newbcast:9 row_mask:0xf bank_mask:0xf
    s_waitcnt vmcnt(4)
    v_cvt_f32_i32 v28, v4
    v_cvt_f32_i32 v29, v5
    v_cvt_f32_i32 v30, v6
    v_cvt_f32_i32 v31, v7
    buffer_load_dwordx4 v[4:7], v1, s[28:31], s71 offen offset:256 nt
    v_fmac_f32_dpp v84, v94, v28 row_newbcast:9 row_mask:0xf bank_mask:0xf
    v_fmac_f32_dpp v85, v94, v29 row_newbcast:9 row_mask:0xf bank_mask:0xf
    v_fmac_f32_dpp v86, v94, v30 row_newbcast:9 row_mask:0xf bank_mask:0xf
    v_fmac_f32_dpp v87, v94, v31 row_newbcast:9 row_mask:0xf bank_mask:0xf
    s_waitcnt vmcnt(4)
    v_cvt_f32_i32 v24, v8
    v_cvt_f32_i32 v25, v9
    v_cvt_f32_i32 v26, v10
    v_cvt_f32_i32 v27, v11
    buffer_load_dwordx4 v[8:11], v1, s[28:31], s71 offen offset:512 nt
    v_fmac_f32_dpp v76, v94, v24 row_newbcast:5 row_mask:0xf bank_mask:0xf
    v_fmac_f32_dpp v77, v94, v25 row_newbcast:5 row_mask:0xf bank_mask:0xf
    v_fmac_f32_dpp v78, v94, v26 row_newbcast:5 row_mask:0xf bank_mask:0xf
    v_fmac_f32_dpp v79, v94, v27 row_newbcast:5 row_mask:0xf bank_mask:0xf
    s_waitcnt vmcnt(4)
    v_cvt_f32_i32 v28, v12
    v_cvt_f32_i32 v29, v13
    v_cvt_f32_i32 v30, v14
    v_cvt_f32_i32 v31, v15
    s_add_u32 s70, s70, 64
    s_mul_i32 s71, s70, 49152
    buffer_load_dwordx4 v[12:15], v1, s[28:31], s71 offen offset:0 nt
    v_fmac_f32_dpp v80, v94, v28 row_newbcast:5 row_mask:0xf bank_mask:0xf
    v_fmac_f32_dpp v81, v94, v29 row_newbcast:5 row_mask:0xf bank_mask:0xf
    v_fmac_f32_dpp v82, v94, v30 row_newbcast:5 row_mask:0xf bank_mask:0xf
    v_fmac_f32_dpp v83, v94, v31 row_newbcast:5 row_mask:0xf bank_mask:0xf
    s_waitcnt vmcnt(4)
    v_cvt_f32_i32 v24, v16
    v_cvt_f32_i32 v25, v17
    v_cvt_f32_i32 v26, v18
    v_cvt_f32_i32 v27, v19
    buffer_load_dwordx4 v[16:19], v1, s[28:31], s71 offen offset:256 nt
    v_fmac_f32_dpp v84, v94, v24 row_newbcast:5 row_mask:0xf bank_mask:0xf
    v_fmac_f32_dpp v85, v94, v25 row_newbcast:5 row_mask:0xf bank_mask:0xf
    v_fmac_f32_dpp v86, v94, v26 row_newbcast:5 row_mask:0xf bank_mask:0xf
    v_fmac_f32_dpp v87, v94, v27 row_newbcast:5 row_mask:0xf bank_mask:0xf
    s_waitcnt vmcnt(4)
    v_cvt_f32_i32 v28, v20
    v_cvt_f32_i32 v29, v21
    v_cvt_f32_i32 v30, v22
    v_cvt_f32_i32 v31, v23
    buffer_load_dwordx4 v[20:23], v1, s[28:31], s71 offen offset:512 nt
    v_fmac_f32_dpp v76, v94, v28 row_newbcast:13 row_mask:0xf bank_mask:0xf
    v_fmac_f32_dpp v77, v94, v29 row_newbcast:13 row_mask:0xf bank_mask:0xf
    v_fmac_f32_dpp v78, v94, v30 row_newbcast:13 row_mask:0xf bank_mask:0xf
    v_fmac_f32_dpp v79, v94, v31 row_newbcast:13 row_mask:0xf bank_mask:0xf
    s_waitcnt vmcnt(4)
    v_cvt_f32_i32 v24, v4
    v_cvt_f32_i32 v25, v5
    v_cvt_f32_i32 v26, v6
    v_cvt_f32_i32 v27, v7
    s_add_u32 s71, s71, 3072
    buffer_load_dwordx4 v[4:7], v1, s[28:31], s71 offen offset:0 nt
    v_fmac_f32_dpp v80, v94, v24 row_newbcast:13 row_mask:0xf bank_mask:0xf
    v_fmac_f32_dpp v81, v94, v25 row_newbcast:13 row_mask:0xf bank_mask:0xf
    v_fmac_f32_dpp v82, v94, v26 row_newbcast:13 row_mask:0xf bank_mask:0xf
    v_fmac_f32_dpp v83, v94, v27 row_newbcast:13 row_mask:0xf bank_mask:0xf
    s_waitcnt vmcnt(4)
    v_cvt_f32_i32 v28, v8
    v_cvt_f32_i32 v29, v9
    v_cvt_f32_i32 v30, v10
    v_cvt_f32_i32 v31, v11
    buffer_load_dwordx4 v[8:11], v1, s[28:31], s71 offen offset:256 nt
    v_fmac_f32_dpp v84, v94, v28 row_newbcast:13 row_mask:0xf bank_mask:0xf
    v_fmac_f32_dpp v85, v94, v29 row_newbcast:13 row_mask:0xf bank_mask:0xf
    v_fmac_f32_dpp v86, v94, v30 row_newbcast:13 row_mask:0xf bank_mask:0xf
    v_fmac_f32_dpp v87, v94, v31 row_newbcast:13 row_mask:0xf bank_mask:0xf
    s_waitcnt vmcnt(4)
    v_cvt_f32_i32 v24, v12
    v_cvt_f32_i32 v25, v13
    v_cvt_f32_i32 v26, v14
    v_cvt_f32_i32 v27, v15
    buffer_load_dwordx4 v[12:15], v1, s[28:31], s71 offen offset:512 nt
    v_fmac_f32_dpp v76, v94, v24 row_newbcast:3 row_mask:0xf bank_mask:0xf
    v_fmac_f32_dpp v77, v94, v25 row_newbcast:3 row_mask:0xf bank_mask:0xf
    v_fmac_f32_dpp v78, v94, v26 row_newbcast:3 row_mask:0xf bank_mask:0xf
    v_fmac_f32_dpp v79, v94, v27 row_newbcast:3 row_mask:0xf bank_mask:0xf
    s_waitcnt vmcnt(4)
    v_cvt_f32_i32 v28, v16
    v_cvt_f32_i32 v29, v17
    v_cvt_f32_i32 v30, v18
    v_cvt_f32_i32 v31, v19
    s_add_u32 s71, s71, 3072
    buffer_load_dwordx4 v[16:19], v1, s[28:31], s71 offen offset:0 nt
    v_fmac_f32_dpp v80, v94, v28 row_newbcast:3 row_mask:0xf bank_mask:0xf
    v_fmac_f32_dpp v81, v94, v29 row_newbcast:3 row_mask:0xf bank_mask:0xf
    v_fmac_f32_dpp v82, v94, v30 row_newbcast:3 row_mask:0xf bank_mask:0xf
    v_fmac_f32_dpp v83, v94, v31 row_newbcast:3 row_mask:0xf bank_mask:0xf
    s_waitcnt vmcnt(4)
    v_cvt_f32_i32 v24, v20
    v_cvt_f32_i32 v25, v21
    v_cvt_f32_i32 v26, v22
    v_cvt_f32_i32 v27, v23
    buffer_load_dwordx4 v[20:23], v1, s[28:31], s71 offen offset:256 nt
    v_fmac_f32_dpp v84, v94, v24 row_newbcast:3 row_mask:0xf bank_mask:0xf
    v_fmac_f32_dpp v85, v94, v25 row_newbcast:3 row_mask:0xf bank_mask:0xf
    v_fmac_f32_dpp v86, v94, v26 row_newbcast:3 row_mask:0xf bank_mask:0xf
    v_fmac_f32_dpp v87, v94, v27 row_newbcast:3 row_mask:0xf bank_mask:0xf
    s_waitcnt vmcnt(4)
    v_cvt_f32_i32 v28, v4
    v_cvt_f32_i32 v29, v5
    v_cvt_f32_i32 v30, v6
    v_cvt_f32_i32 v31, v7
    buffer_load_dwordx4 v[4:7], v1, s[28:31], s71 offen offset:512 nt
    v_fmac_f32_dpp v76, v94, v28 row_newbcast:11 row_mask:0xf bank_mask:0xf
    v_fmac_f32_dpp v77, v94, v29 row_newbcast:11 row_mask:0xf bank_mask:0xf
    v_fmac_f32_dpp v78, v94, v30 row_newbcast:11 row_mask:0xf bank_mask:0xf
    v_fmac_f32_dpp v79, v94, v31 row_newbcast:11 row_mask:0xf bank_mask:0xf
    s_waitcnt vmcnt(4)
    v_cvt_f32_i32 v24, v8
    v_cvt_f32_i32 v25, v9
    v_cvt_f32_i32 v26, v10
    v_cvt_f32_i32 v27, v11
    s_add_u32 s71, s71, 3072
    buffer_load_dwordx4 v[8:11], v1, s[28:31], s71 offen offset:0 nt
    v_fmac_f32_dpp v80, v94, v24 row_newbcast:11 row_mask:0xf bank_mask:0xf
    v_fmac_f32_dpp v81, v94, v25 row_newbcast:11 row_mask:0xf bank_mask:0xf
    v_fmac_f32_dpp v82, v94, v26 row_newbcast:11 row_mask:0xf bank_mask:0xf
    v_fmac_f32_dpp v83, v94, v27 row_newbcast:11 row_mask:0xf bank_mask:0xf
    s_waitcnt vmcnt(4)
    v_cvt_f32_i32 v28, v12
    v_cvt_f32_i32 v29, v13
    v_cvt_f32_i32 v30, v14
    v_cvt_f32_i32 v31, v15
    buffer_load_dwordx4 v[12:15], v1, s[28:31], s71 offen offset:256 nt
    v_fmac_f32_dpp v84, v94, v28 row_newbcast:11 row_mask:0xf bank_mask:0xf
    v_fmac_f32_dpp v85, v94, v29 row_newbcast:11 row_mask:0xf bank_mask:0xf
    v_fmac_f32_dpp v86, v94, v30 row_newbcast:11 row_mask:0xf bank_mask:0xf
    v_fmac_f32_dpp v87, v94, v31 row_newbcast:11 row_mask:0xf bank_mask:0xf
    s_waitcnt vmcnt(4)
    v_cvt_f32_i32 v24, v16
    v_cvt_f32_i32 v25, v17
    v_cvt_f32_i32 v26, v18
    v_cvt_f32_i32 v27, v19
    buffer_load_dwordx4 v[16:19], v1, s[28:31], s71 offen offset:512 nt
    v_fmac_f32_dpp v76, v94, v24 row_newbcast:7 row_mask:0xf bank_mask:0xf
    v_fmac_f32_dpp v77, v94, v25 row_newbcast:7 row_mask:0xf bank_mask:0xf
    v_fmac_f32_dpp v78, v94, v26 row_newbcast:7 row_mask:0xf bank_mask:0xf
    v_fmac_f32_dpp v79, v94, v27 row_newbcast:7 row_mask:0xf bank_mask:0xf
    s_waitcnt vmcnt(4)
    v_cvt_f32_i32 v28, v20
    v_cvt_f32_i32 v29, v21
    v_cvt_f32_i32 v30, v22
    v_cvt_f32_i32 v31, v23
    s_add_u32 s70, s70, 64
    s_sub_u32 s75, s75, 1
    s_cmp_eq_u32 s75, 0
    s_cselect_b32 s80, 1536, 0
    s_cselect_b32 s75, 2, s75
    s_add_u32 s70, s70, s80
    s_lshl_b32 s73, s70, 7
    buffer_load_ushort v92, v3, s[40:43], s73 offen
    buffer_load_ushort v93, v3, s[44:47], s73 offen
    s_mul_i32 s71, s70, 49152
    buffer_load_dwordx4 v[20:23], v1, s[28:31], s71 offen offset:0 nt
    v_fmac_f32_dpp v80, v94, v28 row_newbcast:7 row_mask:0xf bank_mask:0xf
    v_fmac_f32_dpp v81, v94, v29 row_newbcast:7 row_mask:0xf bank_mask:0xf
    v_fmac_f32_dpp v82, v94, v30 row_newbcast:7 row_mask:0xf bank_mask:0xf
    v_fmac_f32_dpp v83, v94, v31 row_newbcast:7 row_mask:0xf bank_mask:0xf
    s_waitcnt vmcnt(6)
    v_cvt_f32_i32 v24, v4
    v_cvt_f32_i32 v25, v5
    v_cvt_f32_i32 v26, v6
    v_cvt_f32_i32 v27, v7
    buffer_load_dwordx4 v[4:7], v1, s[28:31], s71 offen offset:256 nt
    v_fmac_f32_dpp v84, v94, v24 row_newbcast:7 row_mask:0xf bank_mask:0xf
    v_fmac_f32_dpp v85, v94, v25 row_newbcast:7 row_mask:0xf bank_mask:0xf
    v_fmac_f32_dpp v86, v94, v26 row_newbcast:7 row_mask:0xf bank_mask:0xf
    v_fmac_f32_dpp v87, v94, v27 row_newbcast:7 row_mask:0xf bank_mask:0xf
    s_waitcnt vmcnt(6)
    v_cvt_f32_i32 v28, v8
    v_cvt_f32_i32 v29, v9
    v_cvt_f32_i32 v30, v10
    v_cvt_f32_i32 v31, v11
    buffer_load_dwordx4 v[8:11], v1, s[28:31], s71 offen offset:512 nt
    v_fmac_f32_dpp v76, v94, v28 row_newbcast:15 row_mask:0xf bank_mask:0xf
    v_fmac_f32_dpp v77, v94, v29 row_newbcast:15 row_mask:0xf bank_mask:0xf
    v_fmac_f32_dpp v78, v94, v30 row_newbcast:15 row_mask:0xf bank_mask:0xf
    v_fmac_f32_dpp v79, v94, v31 row_newbcast:15 row_mask:0xf bank_mask:0xf
    s_waitcnt vmcnt(6)
    v_cvt_f32_i32 v24, v12
    v_cvt_f32_i32 v25, v13
    v_cvt_f32_i32 v26, v14
    v_cvt_f32_i32 v27, v15
    s_add_u32 s71, s71, 3072
    buffer_load_dwordx4 v[12:15], v1, s[28:31], s71 offen offset:0 nt
    v_fmac_f32_dpp v80, v94, v24 row_newbcast:15 row_mask:0xf bank_mask:0xf
    v_fmac_f32_dpp v81, v94, v25 row_newbcast:15 row_mask:0xf bank_mask:0xf
    v_fmac_f32_dpp v82, v94, v26 row_newbcast:15 row_mask:0xf bank_mask:0xf
    v_fmac_f32_dpp v83, v94, v27 row_newbcast:15 row_mask:0xf bank_mask:0xf
    s_waitcnt vmcnt(6)
    v_cvt_f32_i32 v28, v16
    v_cvt_f32_i32 v29, v17
    v_cvt_f32_i32 v30, v18
    v_cvt_f32_i32 v31, v19
    buffer_load_dwordx4 v[16:19], v1, s[28:31], s71 offen offset:256 nt
    v_fmac_f32_dpp v84, v94, v28 row_newbcast:15 row_mask:0xf bank_mask:0xf
    v_fmac_f32_dpp v85, v94, v29 row_newbcast:15 row_mask:0xf bank_mask:0xf
    v_fmac_f32_dpp v86, v94, v30 row_newbcast:15 row_mask:0xf bank_mask:0xf
    v_fmac_f32_dpp v87, v94, v31 row_newbcast:15 row_mask:0xf bank_mask:0xf
    s_sub_u32 s77, s77, 1
    s_cmp_lg_u32 s77, 0
    s_cbranch_scc1 L_nofl7
    s_nop 0
    v_add_f32_dpp v90, v90, v90 row_ror:8 row_mask:0xf bank_mask:0xf
    v_add_f32_dpp v91, v91, v91 row_ror:8 row_mask:0xf bank_mask:0xf
    s_nop 0
    v_add_f32_dpp v90, v90, v90 row_ror:4 row_mask:0xf bank_mask:0xf
    v_add_f32_dpp v91, v91, v91 row_ror:4 row_mask:0xf bank_mask:0xf
    s_nop 0
    v_add_f32_dpp v90, v90, v90 row_ror:2 row_mask:0xf bank_mask:0xf
    v_add_f32_dpp v91, v91, v91 row_ror:2 row_mask:0xf bank_mask:0xf
    s_nop 0
    v_add_f32_dpp v90, v90, v90 row_ror:1 row_mask:0xf bank_mask:0xf
    v_add_f32_dpp v91, v91, v91 row_ror:1 row_mask:0xf bank_mask:0xf
    v_mov_b32 v102, v89
    v_mov_b32 v103, v89
    s_nop 1
    v_permlane32_swap_b32 v102, v103
    s_nop 1
    v_max_f32 v102, v102, v103
    v_mov_b32 v103, v102
    s_nop 1
    v_permlane16_swap_b32 v102, v103
    s_nop 1
    v_max_f32 v102, v102, v103
    v_sub_f32 v103, v89, v102
    v_exp_f32 v103, v103
    v_mov_b32 v89, v102
    v_mul_f32 v90, v90, v103
    v_mul_f32 v91, v91, v103
    v_fma_f32 v76, v76, v103, -v91
    v_fma_f32 v77, v77, v103, -v91
    v_fma_f32 v78, v78, v103, -v91
    v_fma_f32 v79, v79, v103, -v91
    v_fma_f32 v80, v80, v103, -v91
    v_fma_f32 v81, v81, v103, -v91
    v_fma_f32 v82, v82, v103, -v91
    v_fma_f32 v83, v83, v103, -v91
    v_fma_f32 v84, v84, v103, -v91
    v_fma_f32 v85, v85, v103, -v91
    v_fma_f32 v86, v86, v103, -v91
    v_fma_f32 v87, v87, v103, -v91
    v_mov_b32 v102, v90
    s_nop 1
    v_permlane32_swap_b32 v90, v102
    v_permlane32_swap_b32 v76, v78
    v_permlane32_swap_b32 v77, v79
    v_permlane32_swap_b32 v80, v82
    v_permlane32_swap_b32 v81, v83
    v_permlane32_swap_b32 v84, v86
    v_permlane32_swap_b32 v85, v87
    s_nop 1
    v_add_f32 v90, v90, v102
    v_add_f32 v76, v76, v78
    v_add_f32 v77, v77, v79
    v_add_f32 v80, v80, v82
    v_add_f32 v81, v81, v83
    v_add_f32 v84, v84, v86
    v_add_f32 v85, v85, v87
    v_mov_b32 v102, v90
    s_nop 1
    v_permlane16_swap_b32 v90, v102
    v_permlane16_swap_b32 v76, v77
    v_permlane16_swap_b32 v80, v81
    v_permlane16_swap_b32 v84, v85
    s_nop 1
    v_add_f32 v90, v90, v102
    v_add_f32 v76, v76, v77
    v_add_f32 v80, v80, v81
    v_add_f32 v84, v84, v85
    ds_write_b32 v106, v76 offset:16640
    ds_write_b32 v106, v80 offset:16896
    ds_write_b32 v106, v84 offset:17152
    ds_write_b32 v107, v89 offset:17408
    ds_write_b32 v107, v90 offset:17412
    s_waitcnt lgkmcnt(0)
    s_mov_b64 exec, 1
    ds_add_u32 v108, v109
    s_mov_b64 exec, -1
    v_add_u32 v106, 4096, v106
    v_add_u32 v107, 4096, v107
    v_add_u32 v108, 4, v108
    v_mov_b32 v89, 0xf149f2ca
    v_mov_b32 v90, 0
    v_mov_b32 v91, 0
    v_mov_b32 v76, 0
    v_mov_b32 v77, 0
    v_mov_b32 v78, 0
    v_mov_b32 v79, 0
    v_mov_b32 v80, 0
    v_mov_b32 v81, 0
    v_mov_b32 v82, 0
    v_mov_b32 v83, 0
    v_mov_b32 v84, 0
    v_mov_b32 v85, 0
    v_mov_b32 v86, 0
    v_mov_b32 v87, 0
    s_mov_b32 s77, 2
L_nofl7:
    s_waitcnt vmcnt(5)
    v_lshlrev_b32 v92, 16, v92
    v_lshlrev_b32 v93, 16, v93
    s_waitcnt lgkmcnt(0)
    v_max_f32_dpp v102, v95, v95 row_ror:8 row_mask:0xf bank_mask:0xf
    s_nop 1
    v_max_f32_dpp v102, v102, v102 row_ror:4 row_mask:0xf bank_mask:0xf
    s_nop 1
    v_max_f32_dpp v102, v102, v102 row_ror:2 row_mask:0xf bank_mask:0xf
    s_nop 1
    v_max_f32_dpp v102, v102, v102 row_ror:1 row_mask:0xf bank_mask:0xf
    v_max_f32 v102, v102, v89
    v_sub_f32 v103, v89, v102
    v_sub_f32 v94, v95, v102
    v_exp_f32 v103, v103
    v_exp_f32 v94, v94
    v_mov_b32 v89, v102
    v_fma_f32 v90, v90, v103, v94
    v_mul_f32 v94, v94, v92
    v_mul_f32 v91, v91, v103
    v_fmac_f32 v91, v94, v93
    ds_read_b32 v95, v105
    v_add_u32 v105, 256, v105
    v_mul_f32 v76, v76, v103
    v_mul_f32 v77, v77, v103
    v_mul_f32 v78, v78, v103
    v_mul_f32 v79, v79, v103
    v_mul_f32 v80, v80, v103
    v_mul_f32 v81, v81, v103
    v_mul_f32 v82, v82, v103
    v_mul_f32 v83, v83, v103
    v_mul_f32 v84, v84, v103
    v_mul_f32 v85, v85, v103
    v_mul_f32 v86, v86, v103
    v_mul_f32 v87, v87, v103
    s_waitcnt vmcnt(4)
    v_cvt_f32_i32 v24, v20
    v_cvt_f32_i32 v25, v21
    v_cvt_f32_i32 v26, v22
    v_cvt_f32_i32 v27, v23
    buffer_load_dwordx4 v[20:23], v1, s[28:31], s71 offen offset:512 nt
    v_fmac_f32_dpp v76, v94, v24 row_newbcast:0 row_mask:0xf bank_mask:0xf
    v_fmac_f32_dpp v77, v94, v25 row_newbcast:0 row_mask:0xf bank_mask:0xf
    v_fmac_f32_dpp v78, v94, v26 row_newbcast:0 row_mask:0xf bank_mask:0xf
    v_fmac_f32_dpp v79, v94, v27 row_newbcast:0 row_mask:0xf bank_mask:0xf
    s_waitcnt vmcnt(4)
    v_cvt_f32_i32 v28, v4
    v_cvt_f32_i32 v29, v5
    v_cvt_f32_i32 v30, v6
    v_cvt_f32_i32 v31, v7
    s_add_u32 s71, s71, 3072
    buffer_load_dwordx4 v[4:7], v1, s[28:31], s71 offen offset:0 nt
    v_fmac_f32_dpp v80, v94, v28 row_newbcast:0 row_mask:0xf bank_mask:0xf
    v_fmac_f32_dpp v81, v94, v29 row_newbcast:0 row_mask:0xf bank_mask:0xf
    v_fmac_f32_dpp v82, v94, v30 row_newbcast:0 row_mask:0xf bank_mask:0xf
    v_fmac_f32_dpp v83, v94, v31 row_newbcast:0 row_mask:0xf bank_mask:0xf
    s_waitcnt vmcnt(4)
    v_cvt_f32_i32 v24, v8
    v_cvt_f32_i32 v25, v9
    v_cvt_f32_i32 v26, v10
    v_cvt_f32_i32 v27, v11
    buffer_load_dwordx4 v[8:11], v1, s[28:31], s71 offen offset:256 nt
    v_fmac_f32_dpp v84, v94, v24 row_newbcast:0 row_mask:0xf bank_mask:0xf
    v_fmac_f32_dpp v85, v94, v25 row_newbcast:0 row_mask:0xf bank_mask:0xf
    v_fmac_f32_dpp v86, v94, v26 row_newbcast:0 row_mask:0xf bank_mask:0xf
    v_fmac_f32_dpp v87, v94, v27 row_newbcast:0 row_mask:0xf bank_mask:0xf
    s_waitcnt vmcnt(4)
    v_cvt_f32_i32 v28, v12
    v_cvt_f32_i32 v29, v13
    v_cvt_f32_i32 v30, v14
    v_cvt_f32_i32 v31, v15
    buffer_load_dwordx4 v[12:15], v1, s[28:31], s71 offen offset:512 nt
    v_fmac_f32_dpp v76, v94, v28 row_newbcast:8 row_mask:0xf bank_mask:0xf
    v_fmac_f32_dpp v77, v94, v29 row_newbcast:8 row_mask:0xf bank_mask:0xf
    v_fmac_f32_dpp v78, v94, v30 row_newbcast:8 row_mask:0xf bank_mask:0xf
    v_fmac_f32_dpp v79, v94, v31 row_newbcast:8 row_mask:0xf bank_mask:0xf
    s_waitcnt vmcnt(4)
    v_cvt_f32_i32 v24, v16
    v_cvt_f32_i32 v25, v17
    v_cvt_f32_i32 v26, v18
    v_cvt_f32_i32 v27, v19
    s_add_u32 s71, s71, 3072
    buffer_load_dwordx4 v[16:19], v1, s[28:31], s71 offen offset:0 nt
    v_fmac_f32_dpp v80, v94, v24 row_newbcast:8 row_mask:0xf bank_mask:0xf
    v_fmac_f32_dpp v81, v94, v25 row_newbcast:8 row_mask:0xf bank_mask:0xf
    v_fmac_f32_dpp v82, v94, v26 row_newbcast:8 row_mask:0xf bank_mask:0xf
    v_fmac_f32_dpp v83, v94, v27 row_newbcast:8 row_mask:0xf bank_mask:0xf
    s_waitcnt vmcnt(4)
    v_cvt_f32_i32 v28, v20
    v_cvt_f32_i32 v29, v21
    v_cvt_f32_i32 v30, v22
    v_cvt_f32_i32 v31, v23
    buffer_load_dwordx4 v[20:23], v1, s[28:31], s71 offen offset:256 nt
    v_fmac_f32_dpp v84, v94, v28 row_newbcast:8 row_mask:0xf bank_mask:0xf
    v_fmac_f32_dpp v85, v94, v29 row_newbcast:8 row_mask:0xf bank_mask:0xf
    v_fmac_f32_dpp v86, v94, v30 row_newbcast:8 row_mask:0xf bank_mask:0xf
    v_fmac_f32_dpp v87, v94, v31 row_newbcast:8 row_mask:0xf bank_mask:0xf
    s_waitcnt vmcnt(4)
    v_cvt_f32_i32 v24, v4
    v_cvt_f32_i32 v25, v5
    v_cvt_f32_i32 v26, v6
    v_cvt_f32_i32 v27, v7
    buffer_load_dwordx4 v[4:7], v1, s[28:31], s71 offen offset:512 nt
    v_fmac_f32_dpp v76, v94, v24 row_newbcast:4 row_mask:0xf bank_mask:0xf
    v_fmac_f32_dpp v77, v94, v25 row_newbcast:4 row_mask:0xf bank_mask:0xf
    v_fmac_f32_dpp v78, v94, v26 row_newbcast:4 row_mask:0xf bank_mask:0xf
    v_fmac_f32_dpp v79, v94, v27 row_newbcast:4 row_mask:0xf bank_mask:0xf
    s_waitcnt vmcnt(4)
    v_cvt_f32_i32 v28, v8
    v_cvt_f32_i32 v29, v9
    v_cvt_f32_i32 v30, v10
    v_cvt_f32_i32 v31, v11
    s_add_u32 s70, s70, 64
    s_mul_i32 s71, s70, 49152
    buffer_load_dwordx4 v[8:11], v1, s[28:31], s71 offen offset:0 nt
    v_fmac_f32_dpp v80, v94, v28 row_newbcast:4 row_mask:0xf bank_mask:0xf
    v_fmac_f32_dpp v81, v94, v29 row_newbcast:4 row_mask:0xf bank_mask:0xf
    v_fmac_f32_dpp v82, v94, v30 row_newbcast:4 row_mask:0xf bank_mask:0xf
    v_fmac_f32_dpp v83, v94, v31 row_newbcast:4 row_mask:0xf bank_mask:0xf
    s_waitcnt vmcnt(4)
    v_cvt_f32_i32 v24, v12
    v_cvt_f32_i32 v25, v13
    v_cvt_f32_i32 v26, v14
    v_cvt_f32_i32 v27, v15
    buffer_load_dwordx4 v[12:15], v1, s[28:31], s71 offen offset:256 nt
    v_fmac_f32_dpp v84, v94, v24 row_newbcast:4 row_mask:0xf bank_mask:0xf
    v_fmac_f32_dpp v85, v94, v25 row_newbcast:4 row_mask:0xf bank_mask:0xf
    v_fmac_f32_dpp v86, v94, v26 row_newbcast:4 row_mask:0xf bank_mask:0xf
    v_fmac_f32_dpp v87, v94, v27 row_newbcast:4 row_mask:0xf bank_mask:0xf
    s_waitcnt vmcnt(4)
    v_cvt_f32_i32 v28, v16
    v_cvt_f32_i32 v29, v17
    v_cvt_f32_i32 v30, v18
    v_cvt_f32_i32 v31, v19
    buffer_load_dwordx4 v[16:19], v1, s[28:31], s71 offen offset:512 nt
    v_fmac_f32_dpp v76, v94, v28 row_newbcast:12 row_mask:0xf bank_mask:0xf
    v_fmac_f32_dpp v77, v94, v29 row_newbcast:12 row_mask:0xf bank_mask:0xf
    v_fmac_f32_dpp v78, v94, v30 row_newbcast:12 row_mask:0xf bank_mask:0xf
    v_fmac_f32_dpp v79, v94, v31 row_newbcast:12 row_mask:0xf bank_mask:0xf
    s_waitcnt vmcnt(4)
    v_cvt_f32_i32 v24, v20
    v_cvt_f32_i32 v25, v21
    v_cvt_f32_i32 v26, v22
    v_cvt_f32_i32 v27, v23
    s_add_u32 s71, s71, 3072
    buffer_load_dwordx4 v[20:23], v1, s[28:31], s71 offen offset:0 nt
    v_fmac_f32_dpp v80, v94, v24 row_newbcast:12 row_mask:0xf bank_mask:0xf
    v_fmac_f32_dpp v81, v94, v25 row_newbcast:12 row_mask:0xf bank_mask:0xf
    v_fmac_f32_dpp v82, v94, v26 row_newbcast:12 row_mask:0xf bank_mask:0xf
    v_fmac_f32_dpp v83, v94, v27 row_newbcast:12 row_mask:0xf bank_mask:0xf
    s_waitcnt vmcnt(4)
    v_cvt_f32_i32 v28, v4
    v_cvt_f32_i32 v29, v5
    v_cvt_f32_i32 v30, v6
    v_cvt_f32_i32 v31, v7
    buffer_load_dwordx4 v[4:7], v1, s[28:31], s71 offen offset:256 nt
    v_fmac_f32_dpp v84, v94, v28 row_newbcast:12 row_mask:0xf bank_mask:0xf
    v_fmac_f32_dpp v85, v94, v29 row_newbcast:12 row_mask:0xf bank_mask:0xf
    v_fmac_f32_dpp v86, v94, v30 row_newbcast:12 row_mask:0xf bank_mask:0xf
    v_fmac_f32_dpp v87, v94, v31 row_newbcast:12 row_mask:0xf bank_mask:0xf
    s_waitcnt vmcnt(4)
    v_cvt_f32_i32 v24, v8
    v_cvt_f32_i32 v25, v9
    v_cvt_f32_i32 v26, v10
    v_cvt_f32_i32 v27, v11
    buffer_load_dwordx4 v[8:11], v1, s[28:31], s71 offen offset:512 nt
    v_fmac_f32_dpp v76, v94, v24 row_newbcast:2 row_mask:0xf bank_mask:0xf
    v_fmac_f32_dpp v77, v94, v25 row_newbcast:2 row_mask:0xf bank_mask:0xf
    v_fmac_f32_dpp v78, v94, v26 row_newbcast:2 row_mask:0xf bank_mask:0xf
    v_fmac_f32_dpp v79, v94, v27 row_newbcast:2 row_mask:0xf bank_mask:0xf
    s_waitcnt vmcnt(4)
    v_cvt_f32_i32 v28, v12
    v_cvt_f32_i32 v29, v13
    v_cvt_f32_i32 v30, v14
    v_cvt_f32_i32 v31, v15
    s_add_u32 s71, s71, 3072
    buffer_load_dwordx4 v[12:15], v1, s[28:31], s71 offen offset:0 nt
    v_fmac_f32_dpp v80, v94, v28 row_newbcast:2 row_mask:0xf bank_mask:0xf
    v_fmac_f32_dpp v81, v94, v29 row_newbcast:2 row_mask:0xf bank_mask:0xf
    v_fmac_f32_dpp v82, v94, v30 row_newbcast:2 row_mask:0xf bank_mask:0xf
    v_fmac_f32_dpp v83, v94, v31 row_newbcast:2 row_mask:0xf bank_mask:0xf
    s_waitcnt vmcnt(4)
    v_cvt_f32_i32 v24, v16
    v_cvt_f32_i32 v25, v17
    v_cvt_f32_i32 v26, v18
    v_cvt_f32_i32 v27, v19
    buffer_load_dwordx4 v[16:19], v1, s[28:31], s71 offen offset:256 nt
    v_fmac_f32_dpp v84, v94, v24 row_newbcast:2 row_mask:0xf bank_mask:0xf
    v_fmac_f32_dpp v85, v94, v25 row_newbcast:2 row_mask:0xf bank_mask:0xf
    v_fmac_f32_dpp v86, v94, v26 row_newbcast:2 row_mask:0xf bank_mask:0xf
    v_fmac_f32_dpp v87, v94, v27 row_newbcast:2 row_mask:0xf bank_mask:0xf
    s_waitcnt vmcnt(4)
    v_cvt_f32_i32 v28, v20
    v_cvt_f32_i32 v29, v21
    v_cvt_f32_i32 v30, v22
    v_cvt_f32_i32 v31, v23
    buffer_load_dwordx4 v[20:23], v1, s[28:31], s71 offen offset:512 nt
    v_fmac_f32_dpp v76, v94, v28 row_newbcast:10 row_mask:0xf bank_mask:0xf
    v_fmac_f32_dpp v77, v94, v29 row_newbcast:10 row_mask:0xf bank_mask:0xf
    v_fmac_f32_dpp v78, v94, v30 row_newbcast:10 row_mask:0xf bank_mask:0xf
    v_fmac_f32_dpp v79, v94, v31 row_newbcast:10 row_mask:0xf bank_mask:0xf
    s_waitcnt vmcnt(4)
    v_cvt_f32_i32 v24, v4
    v_cvt_f32_i32 v25, v5
    v_cvt_f32_i32 v26, v6
    v_cvt_f32_i32 v27, v7
    s_add_u32 s71, s71, 3072
    buffer_load_dwordx4 v[4:7], v1, s[28:31], s71 offen offset:0 nt
    v_fmac_f32_dpp v80, v94, v24 row_newbcast:10 row_mask:0xf bank_mask:0xf
    v_fmac_f32_dpp v81, v94, v25 row_newbcast:10 row_mask:0xf bank_mask:0xf
    v_fmac_f32_dpp v82, v94, v26 row_newbcast:10 row_mask:0xf bank_mask:0xf
    v_fmac_f32_dpp v83, v94, v27 row_newbcast:10 row_mask:0xf bank_mask:0xf
    s_waitcnt vmcnt(4)
    v_cvt_f32_i32 v28, v8
    v_cvt_f32_i32 v29, v9
    v_cvt_f32_i32 v30, v10
    v_cvt_f32_i32 v31, v11
    buffer_load_dwordx4 v[8:11], v1, s[28:31], s71 offen offset:256 nt
    v_fmac_f32_dpp v84, v94, v28 row_newbcast:10 row_mask:0xf bank_mask:0xf
    v_fmac_f32_dpp v85, v94, v29 row_newbcast:10 row_mask:0xf bank_mask:0xf
    v_fmac_f32_dpp v86, v94, v30 row_newbcast:10 row_mask:0xf bank_mask:0xf
    v_fmac_f32_dpp v87, v94, v31 row_newbcast:10 row_mask:0xf bank_mask:0xf
    s_waitcnt vmcnt(4)
    v_cvt_f32_i32 v24, v12
    v_cvt_f32_i32 v25, v13
    v_cvt_f32_i32 v26, v14
    v_cvt_f32_i32 v27, v15
    buffer_load_dwordx4 v[12:15], v1, s[28:31], s71 offen offset:512 nt
    v_fmac_f32_dpp v76, v94, v24 row_newbcast:6 row_mask:0xf bank_mask:0xf
    v_fmac_f32_dpp v77, v94, v25 row_newbcast:6 row_mask:0xf bank_mask:0xf
    v_fmac_f32_dpp v78, v94, v26 row_newbcast:6 row_mask:0xf bank_mask:0xf
    v_fmac_f32_dpp v79, v94, v27 row_newbcast:6 row_mask:0xf bank_mask:0xf
    s_waitcnt vmcnt(4)
    v_cvt_f32_i32 v28, v16
    v_cvt_f32_i32 v29, v17
    v_cvt_f32_i32 v30, v18
    v_cvt_f32_i32 v31, v19
    s_add_u32 s70, s70, 64
    s_mul_i32 s71, s70, 49152
    buffer_load_dwordx4 v[16:19], v1, s[28:31], s71 offen offset:0 nt
    v_fmac_f32_dpp v80, v94, v28 row_newbcast:6 row_mask:0xf bank_mask:0xf
    v_fmac_f32_dpp v81, v94, v29 row_newbcast:6 row_mask:0xf bank_mask:0xf
    v_fmac_f32_dpp v82, v94, v30 row_newbcast:6 row_mask:0xf bank_mask:0xf
    v_fmac_f32_dpp v83, v94, v31 row_newbcast:6 row_mask:0xf bank_mask:0xf
    s_waitcnt vmcnt(4)
    v_cvt_f32_i32 v24, v20
    v_cvt_f32_i32 v25, v21
    v_cvt_f32_i32 v26, v22
    v_cvt_f32_i32 v27, v23
    buffer_load_dwordx4 v[20:23], v1, s[28:31], s71 offen offset:256 nt
    v_fmac_f32_dpp v84, v94, v24 row_newbcast:6 row_mask:0xf bank_mask:0xf
    v_fmac_f32_dpp v85, v94, v25 row_newbcast:6 row_mask:0xf bank_mask:0xf
    v_fmac_f32_dpp v86, v94, v26 row_newbcast:6 row_mask:0xf bank_mask:0xf
    v_fmac_f32_dpp v87, v94, v27 row_newbcast:6 row_mask:0xf bank_mask:0xf
    s_waitcnt vmcnt(4)
    v_cvt_f32_i32 v28, v4
    v_cvt_f32_i32 v29, v5
    v_cvt_f32_i32 v30, v6
    v_cvt_f32_i32 v31, v7
    buffer_load_dwordx4 v[4:7], v1, s[28:31], s71 offen offset:512 nt
    v_fmac_f32_dpp v76, v94, v28 row_newbcast:14 row_mask:0xf bank_mask:0xf
    v_fmac_f32_dpp v77, v94, v29 row_newbcast:14 row_mask:0xf bank_mask:0xf
    v_fmac_f32_dpp v78, v94, v30 row_newbcast:14 row_mask:0xf bank_mask:0xf
    v_fmac_f32_dpp v79, v94, v31 row_newbcast:14 row_mask:0xf bank_mask:0xf
    s_waitcnt vmcnt(4)
    v_cvt_f32_i32 v24, v8
    v_cvt_f32_i32 v25, v9
    v_cvt_f32_i32 v26, v10
    v_cvt_f32_i32 v27, v11
    s_add_u32 s71, s71, 3072
    buffer_load_dwordx4 v[8:11], v1, s[28:31], s71 offen offset:0 nt
    v_fmac_f32_dpp v80, v94, v24 row_newbcast:14 row_mask:0xf bank_mask:0xf
    v_fmac_f32_dpp v81, v94, v25 row_newbcast:14 row_mask:0xf bank_mask:0xf
    v_fmac_f32_dpp v82, v94, v26 row_newbcast:14 row_mask:0xf bank_mask:0xf
    v_fmac_f32_dpp v83, v94, v27 row_newbcast:14 row_mask:0xf bank_mask:0xf
    s_waitcnt vmcnt(4)
    v_cvt_f32_i32 v28, v12
    v_cvt_f32_i32 v29, v13
    v_cvt_f32_i32 v30, v14
    v_cvt_f32_i32 v31, v15
    buffer_load_dwordx4 v[12:15], v1, s[28:31], s71 offen offset:256 nt
    v_fmac_f32_dpp v84, v94, v28 row_newbcast:14 row_mask:0xf bank_mask:0xf
    v_fmac_f32_dpp v85, v94, v29 row_newbcast:14 row_mask:0xf bank_mask:0xf
    v_fmac_f32_dpp v86, v94, v30 row_newbcast:14 row_mask:0xf bank_mask:0xf
    v_fmac_f32_dpp v87, v94, v31 row_newbcast:14 row_mask:0xf bank_mask:0xf
    s_waitcnt vmcnt(4)
    v_cvt_f32_i32 v24, v16
    v_cvt_f32_i32 v25, v17
    v_cvt_f32_i32 v26, v18
    v_cvt_f32_i32 v27, v19
    buffer_load_dwordx4 v[16:19], v1, s[28:31], s71 offen offset:512 nt
    v_fmac_f32_dpp v76, v94, v24 row_newbcast:1 row_mask:0xf bank_mask:0xf
    v_fmac_f32_dpp v77, v94, v25 row_newbcast:1 row_mask:0xf bank_mask:0xf
    v_fmac_f32_dpp v78, v94, v26 row_newbcast:1 row_mask:0xf bank_mask:0xf
    v_fmac_f32_dpp v79, v94, v27 row_newbcast:1 row_mask:0xf bank_mask:0xf
    s_waitcnt vmcnt(4)
    v_cvt_f32_i32 v28, v20
    v_cvt_f32_i32 v29, v21
    v_cvt_f32_i32 v30, v22
    v_cvt_f32_i32 v31, v23
    s_add_u32 s71, s71, 3072
    buffer_load_dwordx4 v[20:23], v1, s[28:31], s71 offen offset:0 nt
    v_fmac_f32_dpp v80, v94, v28 row_newbcast:1 row_mask:0xf bank_mask:0xf
    v_fmac_f32_dpp v81, v94, v29 row_newbcast:1 row_mask:0xf bank_mask:0xf
    v_fmac_f32_dpp v82, v94, v30 row_newbcast:1 row_mask:0xf bank_mask:0xf
    v_fmac_f32_dpp v83, v94, v31 row_newbcast:1 row_mask:0xf bank_mask:0xf
    s_waitcnt vmcnt(4)
    v_cvt_f32_i32 v24, v4
    v_cvt_f32_i32 v25, v5
    v_cvt_f32_i32 v26, v6
    v_cvt_f32_i32 v27, v7
    buffer_load_dwordx4 v[4:7], v1, s[28:31], s71 offen offset:256 nt
    v_fmac_f32_dpp v84, v94, v24 row_newbcast:1 row_mask:0xf bank_mask:0xf
    v_fmac_f32_dpp v85, v94, v25 row_newbcast:1 row_mask:0xf bank_mask:0xf
    v_fmac_f32_dpp v86, v94, v26 row_newbcast:1 row_mask:0xf bank_mask:0xf
    v_fmac_f32_dpp v87, v94, v27 row_newbcast:1 row_mask:0xf bank_mask:0xf
    s_waitcnt vmcnt(4)
    v_cvt_f32_i32 v28, v8
    v_cvt_f32_i32 v29, v9
    v_cvt_f32_i32 v30, v10
    v_cvt_f32_i32 v31, v11
    buffer_load_dwordx4 v[8:11], v1, s[28:31], s71 offen offset:512 nt
    v_fmac_f32_dpp v76, v94, v28 row_newbcast:9 row_mask:0xf bank_mask:0xf
    v_fmac_f32_dpp v77, v94, v29 row_newbcast:9 row_mask:0xf bank_mask:0xf
    v_fmac_f32_dpp v78, v94, v30 row_newbcast:9 row_mask:0xf bank_mask:0xf
    v_fmac_f32_dpp v79, v94, v31 row_newbcast:9 row_mask:0xf bank_mask:0xf
    s_waitcnt vmcnt(4)
    v_cvt_f32_i32 v24, v12
    v_cvt_f32_i32 v25, v13
    v_cvt_f32_i32 v26, v14
    v_cvt_f32_i32 v27, v15
    s_add_u32 s71, s71, 3072
    buffer_load_dwordx4 v[12:15], v1, s[28:31], s71 offen offset:0 nt
    v_fmac_f32_dpp v80, v94, v24 row_newbcast:9 row_mask:0xf bank_mask:0xf
    v_fmac_f32_dpp v81, v94, v25 row_newbcast:9 row_mask:0xf bank_mask:0xf
    v_fmac_f32_dpp v82, v94, v26 row_newbcast:9 row_mask:0xf bank_mask:0xf
    v_fmac_f32_dpp v83, v94, v27 row_newbcast:9 row_mask:0xf bank_mask:0xf
    s_waitcnt vmcnt(4)
    v_cvt_f32_i32 v28, v16
    v_cvt_f32_i32 v29, v17
    v_cvt_f32_i32 v30, v18
    v_cvt_f32_i32 v31, v19
    buffer_load_dwordx4 v[16:19], v1, s[28:31], s71 offen offset:256 nt
    v_fmac_f32_dpp v84, v94, v28 row_newbcast:9 row_mask:0xf bank_mask:0xf
    v_fmac_f32_dpp v85, v94, v29 row_newbcast:9 row_mask:0xf bank_mask:0xf
    v_fmac_f32_dpp v86, v94, v30 row_newbcast:9 row_mask:0xf bank_mask:0xf
    v_fmac_f32_dpp v87, v94, v31 row_newbcast:9 row_mask:0xf bank_mask:0xf
    s_waitcnt vmcnt(4)
    v_cvt_f32_i32 v24, v20
    v_cvt_f32_i32 v25, v21
    v_cvt_f32_i32 v26, v22
    v_cvt_f32_i32 v27, v23
    buffer_load_dwordx4 v[20:23], v1, s[28:31], s71 offen offset:512 nt
    v_fmac_f32_dpp v76, v94, v24 row_newbcast:5 row_mask:0xf bank_mask:0xf
    v_fmac_f32_dpp v77, v94, v25 row_newbcast:5 row_mask:0xf bank_mask:0xf
    v_fmac_f32_dpp v78, v94, v26 row_newbcast:5 row_mask:0xf bank_mask:0xf
    v_fmac_f32_dpp v79, v94, v27 row_newbcast:5 row_mask:0xf bank_mask:0xf
    s_waitcnt vmcnt(4)
    v_cvt_f32_i32 v28, v4
    v_cvt_f32_i32 v29, v5
    v_cvt_f32_i32 v30, v6
    v_cvt_f32_i32 v31, v7
    s_add_u32 s70, s70, 64
    s_mul_i32 s71, s70, 49152
    buffer_load_dwordx4 v[4:7], v1, s[28:31], s71 offen offset:0 nt
    v_fmac_f32_dpp v80, v94, v28 row_newbcast:5 row_mask:0xf bank_mask:0xf
    v_fmac_f32_dpp v81, v94, v29 row_newbcast:5 row_mask:0xf bank_mask:0xf
    v_fmac_f32_dpp v82, v94, v30 row_newbcast:5 row_mask:0xf bank_mask:0xf
    v_fmac_f32_dpp v83, v94, v31 row_newbcast:5 row_mask:0xf bank_mask:0xf
    s_waitcnt vmcnt(4)
    v_cvt_f32_i32 v24, v8
    v_cvt_f32_i32 v25, v9
    v_cvt_f32_i32 v26, v10
    v_cvt_f32_i32 v27, v11
    buffer_load_dwordx4 v[8:11], v1, s[28:31], s71 offen offset:256 nt
    v_fmac_f32_dpp v84, v94, v24 row_newbcast:5 row_mask:0xf bank_mask:0xf
    v_fmac_f32_dpp v85, v94, v25 row_newbcast:5 row_mask:0xf bank_mask:0xf
    v_fmac_f32_dpp v86, v94, v26 row_newbcast:5 row_mask:0xf bank_mask:0xf
    v_fmac_f32_dpp v87, v94, v27 row_newbcast:5 row_mask:0xf bank_mask:0xf
    s_waitcnt vmcnt(4)
    v_cvt_f32_i32 v28, v12
    v_cvt_f32_i32 v29, v13
    v_cvt_f32_i32 v30, v14
    v_cvt_f32_i32 v31, v15
    buffer_load_dwordx4 v[12:15], v1, s[28:31], s71 offen offset:512 nt
    v_fmac_f32_dpp v76, v94, v28 row_newbcast:13 row_mask:0xf bank_mask:0xf
    v_fmac_f32_dpp v77, v94, v29 row_newbcast:13 row_mask:0xf bank_mask:0xf
    v_fmac_f32_dpp v78, v94, v30 row_newbcast:13 row_mask:0xf bank_mask:0xf
    v_fmac_f32_dpp v79, v94, v31 row_newbcast:13 row_mask:0xf bank_mask:0xf
    s_waitcnt vmcnt(4)
    v_cvt_f32_i32 v24, v16
    v_cvt_f32_i32 v25, v17
    v_cvt_f32_i32 v26, v18
    v_cvt_f32_i32 v27, v19
    s_add_u32 s71, s71, 3072
    buffer_load_dwordx4 v[16:19], v1, s[28:31], s71 offen offset:0 nt
    v_fmac_f32_dpp v80, v94, v24 row_newbcast:13 row_mask:0xf bank_mask:0xf
    v_fmac_f32_dpp v81, v94, v25 row_newbcast:13 row_mask:0xf bank_mask:0xf
    v_fmac_f32_dpp v82, v94, v26 row_newbcast:13 row_mask:0xf bank_mask:0xf
    v_fmac_f32_dpp v83, v94, v27 row_newbcast:13 row_mask:0xf bank_mask:0xf
    s_waitcnt vmcnt(4)
    v_cvt_f32_i32 v28, v20
    v_cvt_f32_i32 v29, v21
    v_cvt_f32_i32 v30, v22
    v_cvt_f32_i32 v31, v23
    buffer_load_dwordx4 v[20:23], v1, s[28:31], s71 offen offset:256 nt
    v_fmac_f32_dpp v84, v94, v28 row_newbcast:13 row_mask:0xf bank_mask:0xf
    v_fmac_f32_dpp v85, v94, v29 row_newbcast:13 row_mask:0xf bank_mask:0xf
    v_fmac_f32_dpp v86, v94, v30 row_newbcast:13 row_mask:0xf bank_mask:0xf
    v_fmac_f32_dpp v87, v94, v31 row_newbcast:13 row_mask:0xf bank_mask:0xf
    s_waitcnt vmcnt(4)
    v_cvt_f32_i32 v24, v4
    v_cvt_f32_i32 v25, v5
    v_cvt_f32_i32 v26, v6
    v_cvt_f32_i32 v27, v7
    buffer_load_dwordx4 v[4:7], v1, s[28:31], s71 offen offset:512 nt
    v_fmac_f32_dpp v76, v94, v24 row_newbcast:3 row_mask:0xf bank_mask:0xf
    v_fmac_f32_dpp v77, v94, v25 row_newbcast:3 row_mask:0xf bank_mask:0xf
    v_fmac_f32_dpp v78, v94, v26 row_newbcast:3 row_mask:0xf bank_mask:0xf
    v_fmac_f32_dpp v79, v94, v27 row_newbcast:3 row_mask:0xf bank_mask:0xf
    s_waitcnt vmcnt(4)
    v_cvt_f32_i32 v28, v8
    v_cvt_f32_i32 v29, v9
    v_cvt_f32_i32 v30, v10
    v_cvt_f32_i32 v31, v11
    s_add_u32 s71, s71, 3072
    buffer_load_dwordx4 v[8:11], v1, s[28:31], s71 offen offset:0 nt
    v_fmac_f32_dpp v80, v94, v28 row_newbcast:3 row_mask:0xf bank_mask:0xf
    v_fmac_f32_dpp v81, v94, v29 row_newbcast:3 row_mask:0xf bank_mask:0xf
    v_fmac_f32_dpp v82, v94, v30 row_newbcast:3 row_mask:0xf bank_mask:0xf
    v_fmac_f32_dpp v83, v94, v31 row_newbcast:3 row_mask:0xf bank_mask:0xf
    s_waitcnt vmcnt(4)
    v_cvt_f32_i32 v24, v12
    v_cvt_f32_i32 v25, v13
    v_cvt_f32_i32 v26, v14
    v_cvt_f32_i32 v27, v15
    buffer_load_dwordx4 v[12:15], v1, s[28:31], s71 offen offset:256 nt
    v_fmac_f32_dpp v84, v94, v24 row_newbcast:3 row_mask:0xf bank_mask:0xf
    v_fmac_f32_dpp v85, v94, v25 row_newbcast:3 row_mask:0xf bank_mask:0xf
    v_fmac_f32_dpp v86, v94, v26 row_newbcast:3 row_mask:0xf bank_mask:0xf
    v_fmac_f32_dpp v87, v94, v27 row_newbcast:3 row_mask:0xf bank_mask:0xf
    s_waitcnt vmcnt(4)
    v_cvt_f32_i32 v28, v16
    v_cvt_f32_i32 v29, v17
    v_cvt_f32_i32 v30, v18
    v_cvt_f32_i32 v31, v19
    buffer_load_dwordx4 v[16:19], v1, s[28:31], s71 offen offset:512 nt
    v_fmac_f32_dpp v76, v94, v28 row_newbcast:11 row_mask:0xf bank_mask:0xf
    v_fmac_f32_dpp v77, v94, v29 row_newbcast:11 row_mask:0xf bank_mask:0xf
    v_fmac_f32_dpp v78, v94, v30 row_newbcast:11 row_mask:0xf bank_mask:0xf
    v_fmac_f32_dpp v79, v94, v31 row_newbcast:11 row_mask:0xf bank_mask:0xf
    s_waitcnt vmcnt(4)
    v_cvt_f32_i32 v24, v20
    v_cvt_f32_i32 v25, v21
    v_cvt_f32_i32 v26, v22
    v_cvt_f32_i32 v27, v23
    s_add_u32 s71, s71, 3072
    buffer_load_dwordx4 v[20:23], v1, s[28:31], s71 offen offset:0 nt
    v_fmac_f32_dpp v80, v94, v24 row_newbcast:11 row_mask:0xf bank_mask:0xf
    v_fmac_f32_dpp v81, v94, v25 row_newbcast:11 row_mask:0xf bank_mask:0xf
    v_fmac_f32_dpp v82, v94, v26 row_newbcast:11 row_mask:0xf bank_mask:0xf
    v_fmac_f32_dpp v83, v94, v27 row_newbcast:11 row_mask:0xf bank_mask:0xf
    s_waitcnt vmcnt(4)
    v_cvt_f32_i32 v28, v4
    v_cvt_f32_i32 v29, v5
    v_cvt_f32_i32 v30, v6
    v_cvt_f32_i32 v31, v7
    buffer_load_dwordx4 v[4:7], v1, s[28:31], s71 offen offset:256 nt
    v_fmac_f32_dpp v84, v94, v28 row_newbcast:11 row_mask:0xf bank_mask:0xf
    v_fmac_f32_dpp v85, v94, v29 row_newbcast:11 row_mask:0xf bank_mask:0xf
    v_fmac_f32_dpp v86, v94, v30 row_newbcast:11 row_mask:0xf bank_mask:0xf
    v_fmac_f32_dpp v87, v94, v31 row_newbcast:11 row_mask:0xf bank_mask:0xf
    s_waitcnt vmcnt(4)
    v_cvt_f32_i32 v24, v8
    v_cvt_f32_i32 v25, v9
    v_cvt_f32_i32 v26, v10
    v_cvt_f32_i32 v27, v11
    buffer_load_dwordx4 v[8:11], v1, s[28:31], s71 offen offset:512 nt
    v_fmac_f32_dpp v76, v94, v24 row_newbcast:7 row_mask:0xf bank_mask:0xf
    v_fmac_f32_dpp v77, v94, v25 row_newbcast:7 row_mask:0xf bank_mask:0xf
    v_fmac_f32_dpp v78, v94, v26 row_newbcast:7 row_mask:0xf bank_mask:0xf
    v_fmac_f32_dpp v79, v94, v27 row_newbcast:7 row_mask:0xf bank_mask:0xf
    s_waitcnt vmcnt(4)
    v_cvt_f32_i32 v28, v12
    v_cvt_f32_i32 v29, v13
    v_cvt_f32_i32 v30, v14
    v_cvt_f32_i32 v31, v15
    s_add_u32 s70, s70, 64
    s_sub_u32 s75, s75, 1
    s_cmp_eq_u32 s75, 0
    s_cselect_b32 s80, 1536, 0
    s_cselect_b32 s75, 2, s75
    s_add_u32 s70, s70, s80
    s_lshl_b32 s73, s70, 7
    buffer_load_ushort v92, v3, s[40:43], s73 offen
    buffer_load_ushort v93, v3, s[44:47], s73 offen
    s_mul_i32 s71, s70, 49152
    buffer_load_dwordx4 v[12:15], v1, s[28:31], s71 offen offset:0 nt
    v_fmac_f32_dpp v80, v94, v28 row_newbcast:7 row_mask:0xf bank_mask:0xf
    v_fmac_f32_dpp v81, v94, v29 row_newbcast:7 row_mask:0xf bank_mask:0xf
    v_fmac_f32_dpp v82, v94, v30 row_newbcast:7 row_mask:0xf bank_mask:0xf
    v_fmac_f32_dpp v83, v94, v31 row_newbcast:7 row_mask:0xf bank_mask:0xf
    s_waitcnt vmcnt(6)
    v_cvt_f32_i32 v24, v16
    v_cvt_f32_i32 v25, v17
    v_cvt_f32_i32 v26, v18
    v_cvt_f32_i32 v27, v19
    buffer_load_dwordx4 v[16:19], v1, s[28:31], s71 offen offset:256 nt
    v_fmac_f32_dpp v84, v94, v24 row_newbcast:7 row_mask:0xf bank_mask:0xf
    v_fmac_f32_dpp v85, v94, v25 row_newbcast:7 row_mask:0xf bank_mask:0xf
    v_fmac_f32_dpp v86, v94, v26 row_newbcast:7 row_mask:0xf bank_mask:0xf
    v_fmac_f32_dpp v87, v94, v27 row_newbcast:7 row_mask:0xf bank_mask:0xf
    s_waitcnt vmcnt(6)
    v_cvt_f32_i32 v28, v20
    v_cvt_f32_i32 v29, v21
    v_cvt_f32_i32 v30, v22
    v_cvt_f32_i32 v31, v23
    buffer_load_dwordx4 v[20:23], v1, s[28:31], s71 offen offset:512 nt
    v_fmac_f32_dpp v76, v94, v28 row_newbcast:15 row_mask:0xf bank_mask:0xf
    v_fmac_f32_dpp v77, v94, v29 row_newbcast:15 row_mask:0xf bank_mask:0xf
    v_fmac_f32_dpp v78, v94, v30 row_newbcast:15 row_mask:0xf bank_mask:0xf
    v_fmac_f32_dpp v79, v94, v31 row_newbcast:15 row_mask:0xf bank_mask:0xf
    s_waitcnt vmcnt(6)
    v_cvt_f32_i32 v24, v4
    v_cvt_f32_i32 v25, v5
    v_cvt_f32_i32 v26, v6
    v_cvt_f32_i32 v27, v7
    s_add_u32 s71, s71, 3072
    buffer_load_dwordx4 v[4:7], v1, s[28:31], s71 offen offset:0 nt
    v_fmac_f32_dpp v80, v94, v24 row_newbcast:15 row_mask:0xf bank_mask:0xf
    v_fmac_f32_dpp v81, v94, v25 row_newbcast:15 row_mask:0xf bank_mask:0xf
    v_fmac_f32_dpp v82, v94, v26 row_newbcast:15 row_mask:0xf bank_mask:0xf
    v_fmac_f32_dpp v83, v94, v27 row_newbcast:15 row_mask:0xf bank_mask:0xf
    s_waitcnt vmcnt(6)
    v_cvt_f32_i32 v28, v8
    v_cvt_f32_i32 v29, v9
    v_cvt_f32_i32 v30, v10
    v_cvt_f32_i32 v31, v11
    buffer_load_dwordx4 v[8:11], v1, s[28:31], s71 offen offset:256 nt
    v_fmac_f32_dpp v84, v94, v28 row_newbcast:15 row_mask:0xf bank_mask:0xf
    v_fmac_f32_dpp v85, v94, v29 row_newbcast:15 row_mask:0xf bank_mask:0xf
    v_fmac_f32_dpp v86, v94, v30 row_newbcast:15 row_mask:0xf bank_mask:0xf
    v_fmac_f32_dpp v87, v94, v31 row_newbcast:15 row_mask:0xf bank_mask:0xf
    s_sub_u32 s77, s77, 1
    s_cmp_lg_u32 s77, 0
    s_cbranch_scc1 L_nofl8
    s_nop 0
    v_add_f32_dpp v90, v90, v90 row_ror:8 row_mask:0xf bank_mask:0xf
    v_add_f32_dpp v91, v91, v91 row_ror:8 row_mask:0xf bank_mask:0xf
    s_nop 0
    v_add_f32_dpp v90, v90, v90 row_ror:4 row_mask:0xf bank_mask:0xf
    v_add_f32_dpp v91, v91, v91 row_ror:4 row_mask:0xf bank_mask:0xf
    s_nop 0
    v_add_f32_dpp v90, v90, v90 row_ror:2 row_mask:0xf bank_mask:0xf
    v_add_f32_dpp v91, v91, v91 row_ror:2 row_mask:0xf bank_mask:0xf
    s_nop 0
    v_add_f32_dpp v90, v90, v90 row_ror:1 row_mask:0xf bank_mask:0xf
    v_add_f32_dpp v91, v91, v91 row_ror:1 row_mask:0xf bank_mask:0xf
    v_mov_b32 v102, v89
    v_mov_b32 v103, v89
    s_nop 1
    v_permlane32_swap_b32 v102, v103
    s_nop 1
    v_max_f32 v102, v102, v103
    v_mov_b32 v103, v102
    s_nop 1
    v_permlane16_swap_b32 v102, v103
    s_nop 1
    v_max_f32 v102, v102, v103
    v_sub_f32 v103, v89, v102
    v_exp_f32 v103, v103
    v_mov_b32 v89, v102
    v_mul_f32 v90, v90, v103
    v_mul_f32 v91, v91, v103
    v_fma_f32 v76, v76, v103, -v91
    v_fma_f32 v77, v77, v103, -v91
    v_fma_f32 v78, v78, v103, -v91
    v_fma_f32 v79, v79, v103, -v91
    v_fma_f32 v80, v80, v103, -v91
    v_fma_f32 v81, v81, v103, -v91
    v_fma_f32 v82, v82, v103, -v91
    v_fma_f32 v83, v83, v103, -v91
    v_fma_f32 v84, v84, v103, -v91
    v_fma_f32 v85, v85, v103, -v91
    v_fma_f32 v86, v86, v103, -v91
    v_fma_f32 v87, v87, v103, -v91
    v_mov_b32 v102, v90
    s_nop 1
    v_permlane32_swap_b32 v90, v102
    v_permlane32_swap_b32 v76, v78
    v_permlane32_swap_b32 v77, v79
    v_permlane32_swap_b32 v80, v82
    v_permlane32_swap_b32 v81, v83
    v_permlane32_swap_b32 v84, v86
    v_permlane32_swap_b32 v85, v87
    s_nop 1
    v_add_f32 v90, v90, v102
    v_add_f32 v76, v76, v78
    v_add_f32 v77, v77, v79
    v_add_f32 v80, v80, v82
    v_add_f32 v81, v81, v83
    v_add_f32 v84, v84, v86
    v_add_f32 v85, v85, v87
    v_mov_b32 v102, v90
    s_nop 1
    v_permlane16_swap_b32 v90, v102
    v_permlane16_swap_b32 v76, v77
    v_permlane16_swap_b32 v80, v81
    v_permlane16_swap_b32 v84, v85
    s_nop 1
    v_add_f32 v90, v90, v102
    v_add_f32 v76, v76, v77
    v_add_f32 v80, v80, v81
    v_add_f32 v84, v84, v85
    ds_write_b32 v106, v76 offset:16640
    ds_write_b32 v106, v80 offset:16896
    ds_write_b32 v106, v84 offset:17152
    ds_write_b32 v107, v89 offset:17408
    ds_write_b32 v107, v90 offset:17412
    s_waitcnt lgkmcnt(0)
    s_mov_b64 exec, 1
    ds_add_u32 v108, v109
    s_mov_b64 exec, -1
    v_add_u32 v106, 4096, v106
    v_add_u32 v107, 4096, v107
    v_add_u32 v108, 4, v108
    v_mov_b32 v89, 0xf149f2ca
    v_mov_b32 v90, 0
    v_mov_b32 v91, 0
    v_mov_b32 v76, 0
    v_mov_b32 v77, 0
    v_mov_b32 v78, 0
    v_mov_b32 v79, 0
    v_mov_b32 v80, 0
    v_mov_b32 v81, 0
    v_mov_b32 v82, 0
    v_mov_b32 v83, 0
    v_mov_b32 v84, 0
    v_mov_b32 v85, 0
    v_mov_b32 v86, 0
    v_mov_b32 v87, 0
    s_mov_b32 s77, 2
L_nofl8:
    s_waitcnt vmcnt(5)
    v_lshlrev_b32 v92, 16, v92
    v_lshlrev_b32 v93, 16, v93
    s_waitcnt lgkmcnt(0)
    v_max_f32_dpp v102, v95, v95 row_ror:8 row_mask:0xf bank_mask:0xf
    s_nop 1
    v_max_f32_dpp v102, v102, v102 row_ror:4 row_mask:0xf bank_mask:0xf
    s_nop 1
    v_max_f32_dpp v102, v102, v102 row_ror:2 row_mask:0xf bank_mask:0xf
    s_nop 1
    v_max_f32_dpp v102, v102, v102 row_ror:1 row_mask:0xf bank_mask:0xf
    v_max_f32 v102, v102, v89
    v_sub_f32 v103, v89, v102
    v_sub_f32 v94, v95, v102
    v_exp_f32 v103, v103
    v_exp_f32 v94, v94
    v_mov_b32 v89, v102
    v_fma_f32 v90, v90, v103, v94
    v_mul_f32 v94, v94, v92
    v_mul_f32 v91, v91, v103
    v_fmac_f32 v91, v94, v93
    ds_read_b32 v95, v105
    v_add_u32 v105, 256, v105
    v_mul_f32 v76, v76, v103
    v_mul_f32 v77, v77, v103
    v_mul_f32 v78, v78, v103
    v_mul_f32 v79, v79, v103
    v_mul_f32 v80, v80, v103
    v_mul_f32 v81, v81, v103
    v_mul_f32 v82, v82, v103
    v_mul_f32 v83, v83, v103
    v_mul_f32 v84, v84, v103
    v_mul_f32 v85, v85, v103
    v_mul_f32 v86, v86, v103
    v_mul_f32 v87, v87, v103
    s_waitcnt vmcnt(4)
    v_cvt_f32_i32 v24, v12
    v_cvt_f32_i32 v25, v13
    v_cvt_f32_i32 v26, v14
    v_cvt_f32_i32 v27, v15
    buffer_load_dwordx4 v[12:15], v1, s[28:31], s71 offen offset:512 nt
    v_fmac_f32_dpp v76, v94, v24 row_newbcast:0 row_mask:0xf bank_mask:0xf
    v_fmac_f32_dpp v77, v94, v25 row_newbcast:0 row_mask:0xf bank_mask:0xf
    v_fmac_f32_dpp v78, v94, v26 row_newbcast:0 row_mask:0xf bank_mask:0xf
    v_fmac_f32_dpp v79, v94, v27 row_newbcast:0 row_mask:0xf bank_mask:0xf
    s_waitcnt vmcnt(4)
    v_cvt_f32_i32 v28, v16
    v_cvt_f32_i32 v29, v17
    v_cvt_f32_i32 v30, v18
    v_cvt_f32_i32 v31, v19
    s_add_u32 s71, s71, 3072
    buffer_load_dwordx4 v[16:19], v1, s[28:31], s71 offen offset:0 nt
    v_fmac_f32_dpp v80, v94, v28 row_newbcast:0 row_mask:0xf bank_mask:0xf
    v_fmac_f32_dpp v81, v94, v29 row_newbcast:0 row_mask:0xf bank_mask:0xf
    v_fmac_f32_dpp v82, v94, v30 row_newbcast:0 row_mask:0xf bank_mask:0xf
    v_fmac_f32_dpp v83, v94, v31 row_newbcast:0 row_mask:0xf bank_mask:0xf
    s_waitcnt vmcnt(4)
    v_cvt_f32_i32 v24, v20
    v_cvt_f32_i32 v25, v21
    v_cvt_f32_i32 v26, v22
    v_cvt_f32_i32 v27, v23
    buffer_load_dwordx4 v[20:23], v1, s[28:31], s71 offen offset:256 nt
    v_fmac_f32_dpp v84, v94, v24 row_newbcast:0 row_mask:0xf bank_mask:0xf
    v_fmac_f32_dpp v85, v94, v25 row_newbcast:0 row_mask:0xf bank_mask:0xf
    v_fmac_f32_dpp v86, v94, v26 row_newbcast:0 row_mask:0xf bank_mask:0xf
    v_fmac_f32_dpp v87, v94, v27 row_newbcast:0 row_mask:0xf bank_mask:0xf
    s_waitcnt vmcnt(4)
    v_cvt_f32_i32 v28, v4
    v_cvt_f32_i32 v29, v5
    v_cvt_f32_i32 v30, v6
    v_cvt_f32_i32 v31, v7
    buffer_load_dwordx4 v[4:7], v1, s[28:31], s71 offen offset:512 nt
    v_fmac_f32_dpp v76, v94, v28 row_newbcast:8 row_mask:0xf bank_mask:0xf
    v_fmac_f32_dpp v77, v94, v29 row_newbcast:8 row_mask:0xf bank_mask:0xf
    v_fmac_f32_dpp v78, v94, v30 row_newbcast:8 row_mask:0xf bank_mask:0xf
    v_fmac_f32_dpp v79, v94, v31 row_newbcast:8 row_mask:0xf bank_mask:0xf
    s_waitcnt vmcnt(4)
    v_cvt_f32_i32 v24, v8
    v_cvt_f32_i32 v25, v9
    v_cvt_f32_i32 v26, v10
    v_cvt_f32_i32 v27, v11
    s_add_u32 s71, s71, 3072
    buffer_load_dwordx4 v[8:11], v1, s[28:31], s71 offen offset:0 nt
    v_fmac_f32_dpp v80, v94, v24 row_newbcast:8 row_mask:0xf bank_mask:0xf
    v_fmac_f32_dpp v81, v94, v25 row_newbcast:8 row_mask:0xf bank_mask:0xf
    v_fmac_f32_dpp v82, v94, v26 row_newbcast:8 row_mask:0xf bank_mask:0xf
    v_fmac_f32_dpp v83, v94, v27 row_newbcast:8 row_mask:0xf bank_mask:0xf
    s_waitcnt vmcnt(4)
    v_cvt_f32_i32 v28, v12
    v_cvt_f32_i32 v29, v13
    v_cvt_f32_i32 v30, v14
    v_cvt_f32_i32 v31, v15
    buffer_load_dwordx4 v[12:15], v1, s[28:31], s71 offen offset:256 nt
    v_fmac_f32_dpp v84, v94, v28 row_newbcast:8 row_mask:0xf bank_mask:0xf
    v_fmac_f32_dpp v85, v94, v29 row_newbcast:8 row_mask:0xf bank_mask:0xf
    v_fmac_f32_dpp v86, v94, v30 row_newbcast:8 row_mask:0xf bank_mask:0xf
    v_fmac_f32_dpp v87, v94, v31 row_newbcast:8 row_mask:0xf bank_mask:0xf
    s_waitcnt vmcnt(4)
    v_cvt_f32_i32 v24, v16
    v_cvt_f32_i32 v25, v17
    v_cvt_f32_i32 v26, v18
    v_cvt_f32_i32 v27, v19
    buffer_load_dwordx4 v[16:19], v1, s[28:31], s71 offen offset:512 nt
    v_fmac_f32_dpp v76, v94, v24 row_newbcast:4 row_mask:0xf bank_mask:0xf
    v_fmac_f32_dpp v77, v94, v25 row_newbcast:4 row_mask:0xf bank_mask:0xf
    v_fmac_f32_dpp v78, v94, v26 row_newbcast:4 row_mask:0xf bank_mask:0xf
    v_fmac_f32_dpp v79, v94, v27 row_newbcast:4 row_mask:0xf bank_mask:0xf
    s_waitcnt vmcnt(4)
    v_cvt_f32_i32 v28, v20
    v_cvt_f32_i32 v29, v21
    v_cvt_f32_i32 v30, v22
    v_cvt_f32_i32 v31, v23
    s_add_u32 s70, s70, 64
    s_mul_i32 s71, s70, 49152
    buffer_load_dwordx4 v[20:23], v1, s[28:31], s71 offen offset:0 nt
    v_fmac_f32_dpp v80, v94, v28 row_newbcast:4 row_mask:0xf bank_mask:0xf
    v_fmac_f32_dpp v81, v94, v29 row_newbcast:4 row_mask:0xf bank_mask:0xf
    v_fmac_f32_dpp v82, v94, v30 row_newbcast:4 row_mask:0xf bank_mask:0xf
    v_fmac_f32_dpp v83, v94, v31 row_newbcast:4 row_mask:0xf bank_mask:0xf
    s_waitcnt vmcnt(4)
    v_cvt_f32_i32 v24, v4
    v_cvt_f32_i32 v25, v5
    v_cvt_f32_i32 v26, v6
    v_cvt_f32_i32 v27, v7
    buffer_load_dwordx4 v[4:7], v1, s[28:31], s71 offen offset:256 nt
    v_fmac_f32_dpp v84, v94, v24 row_newbcast:4 row_mask:0xf bank_mask:0xf
    v_fmac_f32_dpp v85, v94, v25 row_newbcast:4 row_mask:0xf bank_mask:0xf
    v_fmac_f32_dpp v86, v94, v26 row_newbcast:4 row_mask:0xf bank_mask:0xf
    v_fmac_f32_dpp v87, v94, v27 row_newbcast:4 row_mask:0xf bank_mask:0xf
    s_waitcnt vmcnt(4)
    v_cvt_f32_i32 v28, v8
    v_cvt_f32_i32 v29, v9
    v_cvt_f32_i32 v30, v10
    v_cvt_f32_i32 v31, v11
    buffer_load_dwordx4 v[8:11], v1, s[28:31], s71 offen offset:512 nt
    v_fmac_f32_dpp v76, v94, v28 row_newbcast:12 row_mask:0xf bank_mask:0xf
    v_fmac_f32_dpp v77, v94, v29 row_newbcast:12 row_mask:0xf bank_mask:0xf
    v_fmac_f32_dpp v78, v94, v30 row_newbcast:12 row_mask:0xf bank_mask:0xf
    v_fmac_f32_dpp v79, v94, v31 row_newbcast:12 row_mask:0xf bank_mask:0xf
    s_waitcnt vmcnt(4)
    v_cvt_f32_i32 v24, v12
    v_cvt_f32_i32 v25, v13
    v_cvt_f32_i32 v26, v14
    v_cvt_f32_i32 v27, v15
    s_add_u32 s71, s71, 3072
    buffer_load_dwordx4 v[12:15], v1, s[28:31], s71 offen offset:0 nt
    v_fmac_f32_dpp v80, v94, v24 row_newbcast:12 row_mask:0xf bank_mask:0xf
    v_fmac_f32_dpp v81, v94, v25 row_newbcast:12 row_mask:0xf bank_mask:0xf
    v_fmac_f32_dpp v82, v94, v26 row_newbcast:12 row_mask:0xf bank_mask:0xf
    v_fmac_f32_dpp v83, v94, v27 row_newbcast:12 row_mask:0xf bank_mask:0xf
    s_waitcnt vmcnt(4)
    v_cvt_f32_i32 v28, v16
    v_cvt_f32_i32 v29, v17
    v_cvt_f32_i32 v30, v18
    v_cvt_f32_i32 v31, v19
    buffer_load_dwordx4 v[16:19], v1, s[28:31], s71 offen offset:256 nt
    v_fmac_f32_dpp v84, v94, v28 row_newbcast:12 row_mask:0xf bank_mask:0xf
    v_fmac_f32_dpp v85, v94, v29 row_newbcast:12 row_mask:0xf bank_mask:0xf
    v_fmac_f32_dpp v86, v94, v30 row_newbcast:12 row_mask:0xf bank_mask:0xf
    v_fmac_f32_dpp v87, v94, v31 row_newbcast:12 row_mask:0xf bank_mask:0xf
    s_waitcnt vmcnt(4)
    v_cvt_f32_i32 v24, v20
    v_cvt_f32_i32 v25, v21
    v_cvt_f32_i32 v26, v22
    v_cvt_f32_i32 v27, v23
    buffer_load_dwordx4 v[20:23], v1, s[28:31], s71 offen offset:512 nt
    v_fmac_f32_dpp v76, v94, v24 row_newbcast:2 row_mask:0xf bank_mask:0xf
    v_fmac_f32_dpp v77, v94, v25 row_newbcast:2 row_mask:0xf bank_mask:0xf
    v_fmac_f32_dpp v78, v94, v26 row_newbcast:2 row_mask:0xf bank_mask:0xf
    v_fmac_f32_dpp v79, v94, v27 row_newbcast:2 row_mask:0xf bank_mask:0xf
    s_waitcnt vmcnt(4)
    v_cvt_f32_i32 v28, v4
    v_cvt_f32_i32 v29, v5
    v_cvt_f32_i32 v30, v6
    v_cvt_f32_i32 v31, v7
    s_add_u32 s71, s71, 3072
    buffer_load_dwordx4 v[4:7], v1, s[28:31], s71 offen offset:0 nt
    v_fmac_f32_dpp v80, v94, v28 row_newbcast:2 row_mask:0xf bank_mask:0xf
    v_fmac_f32_dpp v81, v94, v29 row_newbcast:2 row_mask:0xf bank_mask:0xf
    v_fmac_f32_dpp v82, v94, v30 row_newbcast:2 row_mask:0xf bank_mask:0xf
    v_fmac_f32_dpp v83, v94, v31 row_newbcast:2 row_mask:0xf bank_mask:0xf
    s_waitcnt vmcnt(4)
    v_cvt_f32_i32 v24, v8
    v_cvt_f32_i32 v25, v9
    v_cvt_f32_i32 v26, v10
    v_cvt_f32_i32 v27, v11
    buffer_load_dwordx4 v[8:11], v1, s[28:31], s71 offen offset:256 nt
    v_fmac_f32_dpp v84, v94, v24 row_newbcast:2 row_mask:0xf bank_mask:0xf
    v_fmac_f32_dpp v85, v94, v25 row_newbcast:2 row_mask:0xf bank_mask:0xf
    v_fmac_f32_dpp v86, v94, v26 row_newbcast:2 row_mask:0xf bank_mask:0xf
    v_fmac_f32_dpp v87, v94, v27 row_newbcast:2 row_mask:0xf bank_mask:0xf
    s_waitcnt vmcnt(4)
    v_cvt_f32_i32 v28, v12
    v_cvt_f32_i32 v29, v13
    v_cvt_f32_i32 v30, v14
    v_cvt_f32_i32 v31, v15
    buffer_load_dwordx4 v[12:15], v1, s[28:31], s71 offen offset:512 nt
    v_fmac_f32_dpp v76, v94, v28 row_newbcast:10 row_mask:0xf bank_mask:0xf
    v_fmac_f32_dpp v77, v94, v29 row_newbcast:10 row_mask:0xf bank_mask:0xf
    v_fmac_f32_dpp v78, v94, v30 row_newbcast:10 row_mask:0xf bank_mask:0xf
    v_fmac_f32_dpp v79, v94, v31 row_newbcast:10 row_mask:0xf bank_mask:0xf
    s_waitcnt vmcnt(4)
    v_cvt_f32_i32 v24, v16
    v_cvt_f32_i32 v25, v17
    v_cvt_f32_i32 v26, v18
    v_cvt_f32_i32 v27, v19
    s_add_u32 s71, s71, 3072
    buffer_load_dwordx4 v[16:19], v1, s[28:31], s71 offen offset:0 nt
    v_fmac_f32_dpp v80, v94, v24 row_newbcast:10 row_mask:0xf bank_mask:0xf
    v_fmac_f32_dpp v81, v94, v25 row_newbcast:10 row_mask:0xf bank_mask:0xf
    v_fmac_f32_dpp v82, v94, v26 row_newbcast:10 row_mask:0xf bank_mask:0xf
    v_fmac_f32_dpp v83, v94, v27 row_newbcast:10 row_mask:0xf bank_mask:0xf
    s_waitcnt vmcnt(4)
    v_cvt_f32_i32 v28, v20
    v_cvt_f32_i32 v29, v21
    v_cvt_f32_i32 v30, v22
    v_cvt_f32_i32 v31, v23
    buffer_load_dwordx4 v[20:23], v1, s[28:31], s71 offen offset:256 nt
    v_fmac_f32_dpp v84, v94, v28 row_newbcast:10 row_mask:0xf bank_mask:0xf
    v_fmac_f32_dpp v85, v94, v29 row_newbcast:10 row_mask:0xf bank_mask:0xf
    v_fmac_f32_dpp v86, v94, v30 row_newbcast:10 row_mask:0xf bank_mask:0xf
    v_fmac_f32_dpp v87, v94, v31 row_newbcast:10 row_mask:0xf bank_mask:0xf
    s_waitcnt vmcnt(4)
    v_cvt_f32_i32 v24, v4
    v_cvt_f32_i32 v25, v5
    v_cvt_f32_i32 v26, v6
    v_cvt_f32_i32 v27, v7
    buffer_load_dwordx4 v[4:7], v1, s[28:31], s71 offen offset:512 nt
    v_fmac_f32_dpp v76, v94, v24 row_newbcast:6 row_mask:0xf bank_mask:0xf
    v_fmac_f32_dpp v77, v94, v25 row_newbcast:6 row_mask:0xf bank_mask:0xf
    v_fmac_f32_dpp v78, v94, v26 row_newbcast:6 row_mask:0xf bank_mask:0xf
    v_fmac_f32_dpp v79, v94, v27 row_newbcast:6 row_mask:0xf bank_mask:0xf
    s_waitcnt vmcnt(4)
    v_cvt_f32_i32 v28, v8
    v_cvt_f32_i32 v29, v9
    v_cvt_f32_i32 v30, v10
    v_cvt_f32_i32 v31, v11
    s_add_u32 s70, s70, 64
    s_mul_i32 s71, s70, 49152
    buffer_load_dwordx4 v[8:11], v1, s[28:31], s71 offen offset:0 nt
    v_fmac_f32_dpp v80, v94, v28 row_newbcast:6 row_mask:0xf bank_mask:0xf
    v_fmac_f32_dpp v81, v94, v29 row_newbcast:6 row_mask:0xf bank_mask:0xf
    v_fmac_f32_dpp v82, v94, v30 row_newbcast:6 row_mask:0xf bank_mask:0xf
    v_fmac_f32_dpp v83, v94, v31 row_newbcast:6 row_mask:0xf bank_mask:0xf
    s_waitcnt vmcnt(4)
    v_cvt_f32_i32 v24, v12
    v_cvt_f32_i32 v25, v13
    v_cvt_f32_i32 v26, v14
    v_cvt_f32_i32 v27, v15
    buffer_load_dwordx4 v[12:15], v1, s[28:31], s71 offen offset:256 nt
    v_fmac_f32_dpp v84, v94, v24 row_newbcast:6 row_mask:0xf bank_mask:0xf
    v_fmac_f32_dpp v85, v94, v25 row_newbcast:6 row_mask:0xf bank_mask:0xf
    v_fmac_f32_dpp v86, v94, v26 row_newbcast:6 row_mask:0xf bank_mask:0xf
    v_fmac_f32_dpp v87, v94, v27 row_newbcast:6 row_mask:0xf bank_mask:0xf
    s_waitcnt vmcnt(4)
    v_cvt_f32_i32 v28, v16
    v_cvt_f32_i32 v29, v17
    v_cvt_f32_i32 v30, v18
    v_cvt_f32_i32 v31, v19
    buffer_load_dwordx4 v[16:19], v1, s[28:31], s71 offen offset:512 nt
    v_fmac_f32_dpp v76, v94, v28 row_newbcast:14 row_mask:0xf bank_mask:0xf
    v_fmac_f32_dpp v77, v94, v29 row_newbcast:14 row_mask:0xf bank_mask:0xf
    v_fmac_f32_dpp v78, v94, v30 row_newbcast:14 row_mask:0xf bank_mask:0xf
    v_fmac_f32_dpp v79, v94, v31 row_newbcast:14 row_mask:0xf bank_mask:0xf
    s_waitcnt vmcnt(4)
    v_cvt_f32_i32 v24, v20
    v_cvt_f32_i32 v25, v21
    v_cvt_f32_i32 v26, v22
    v_cvt_f32_i32 v27, v23
    s_add_u32 s71, s71, 3072
    buffer_load_dwordx4 v[20:23], v1, s[28:31], s71 offen offset:0 nt
    v_fmac_f32_dpp v80, v94, v24 row_newbcast:14 row_mask:0xf bank_mask:0xf
    v_fmac_f32_dpp v81, v94, v25 row_newbcast:14 row_mask:0xf bank_mask:0xf
    v_fmac_f32_dpp v82, v94, v26 row_newbcast:14 row_mask:0xf bank_mask:0xf
    v_fmac_f32_dpp v83, v94, v27 row_newbcast:14 row_mask:0xf bank_mask:0xf
    s_waitcnt vmcnt(4)
    v_cvt_f32_i32 v28, v4
    v_cvt_f32_i32 v29, v5
    v_cvt_f32_i32 v30, v6
    v_cvt_f32_i32 v31, v7
    buffer_load_dwordx4 v[4:7], v1, s[28:31], s71 offen offset:256 nt
    v_fmac_f32_dpp v84, v94, v28 row_newbcast:14 row_mask:0xf bank_mask:0xf
    v_fmac_f32_dpp v85, v94, v29 row_newbcast:14 row_mask:0xf bank_mask:0xf
    v_fmac_f32_dpp v86, v94, v30 row_newbcast:14 row_mask:0xf bank_mask:0xf
    v_fmac_f32_dpp v87, v94, v31 row_newbcast:14 row_mask:0xf bank_mask:0xf
    s_waitcnt vmcnt(4)
    v_cvt_f32_i32 v24, v8
    v_cvt_f32_i32 v25, v9
    v_cvt_f32_i32 v26, v10
    v_cvt_f32_i32 v27, v11
    buffer_load_dwordx4 v[8:11], v1, s[28:31], s71 offen offset:512 nt
    v_fmac_f32_dpp v76, v94, v24 row_newbcast:1 row_mask:0xf bank_mask:0xf
    v_fmac_f32_dpp v77, v94, v25 row_newbcast:1 row_mask:0xf bank_mask:0xf
    v_fmac_f32_dpp v78, v94, v26 row_newbcast:1 row_mask:0xf bank_mask:0xf
    v_fmac_f32_dpp v79, v94, v27 row_newbcast:1 row_mask:0xf bank_mask:0xf
    s_waitcnt vmcnt(4)
    v_cvt_f32_i32 v28, v12
    v_cvt_f32_i32 v29, v13
    v_cvt_f32_i32 v30, v14
    v_cvt_f32_i32 v31, v15
    s_add_u32 s71, s71, 3072
    buffer_load_dwordx4 v[12:15], v1, s[28:31], s71 offen offset:0 nt
    v_fmac_f32_dpp v80, v94, v28 row_newbcast:1 row_mask:0xf bank_mask:0xf
    v_fmac_f32_dpp v81, v94, v29 row_newbcast:1 row_mask:0xf bank_mask:0xf
    v_fmac_f32_dpp v82, v94, v30 row_newbcast:1 row_mask:0xf bank_mask:0xf
    v_fmac_f32_dpp v83, v94, v31 row_newbcast:1 row_mask:0xf bank_mask:0xf
    s_waitcnt vmcnt(4)
    v_cvt_f32_i32 v24, v16
    v_cvt_f32_i32 v25, v17
    v_cvt_f32_i32 v26, v18
    v_cvt_f32_i32 v27, v19
    buffer_load_dwordx4 v[16:19], v1, s[28:31], s71 offen offset:256 nt
    v_fmac_f32_dpp v84, v94, v24 row_newbcast:1 row_mask:0xf bank_mask:0xf
    v_fmac_f32_dpp v85, v94, v25 row_newbcast:1 row_mask:0xf bank_mask:0xf
    v_fmac_f32_dpp v86, v94, v26 row_newbcast:1 row_mask:0xf bank_mask:0xf
    v_fmac_f32_dpp v87, v94, v27 row_newbcast:1 row_mask:0xf bank_mask:0xf
    s_waitcnt vmcnt(4)
    v_cvt_f32_i32 v28, v20
    v_cvt_f32_i32 v29, v21
    v_cvt_f32_i32 v30, v22
    v_cvt_f32_i32 v31, v23
    buffer_load_dwordx4 v[20:23], v1, s[28:31], s71 offen offset:512 nt
    v_fmac_f32_dpp v76, v94, v28 row_newbcast:9 row_mask:0xf bank_mask:0xf
    v_fmac_f32_dpp v77, v94, v29 row_newbcast:9 row_mask:0xf bank_mask:0xf
    v_fmac_f32_dpp v78, v94, v30 row_newbcast:9 row_mask:0xf bank_mask:0xf
    v_fmac_f32_dpp v79, v94, v31 row_newbcast:9 row_mask:0xf bank_mask:0xf
    s_waitcnt vmcnt(4)
    v_cvt_f32_i32 v24, v4
    v_cvt_f32_i32 v25, v5
    v_cvt_f32_i32 v26, v6
    v_cvt_f32_i32 v27, v7
    s_add_u32 s71, s71, 3072
    buffer_load_dwordx4 v[4:7], v1, s[28:31], s71 offen offset:0 nt
    v_fmac_f32_dpp v80, v94, v24 row_newbcast:9 row_mask:0xf bank_mask:0xf
    v_fmac_f32_dpp v81, v94, v25 row_newbcast:9 row_mask:0xf bank_mask:0xf
    v_fmac_f32_dpp v82, v94, v26 row_newbcast:9 row_mask:0xf bank_mask:0xf
    v_fmac_f32_dpp v83, v94, v27 row_newbcast:9 row_mask:0xf bank_mask:0xf
    s_waitcnt vmcnt(4)
    v_cvt_f32_i32 v28, v8
    v_cvt_f32_i32 v29, v9
    v_cvt_f32_i32 v30, v10
    v_cvt_f32_i32 v31, v11
    buffer_load_dwordx4 v[8:11], v1, s[28:31], s71 offen offset:256 nt
    v_fmac_f32_dpp v84, v94, v28 row_newbcast:9 row_mask:0xf bank_mask:0xf
    v_fmac_f32_dpp v85, v94, v29 row_newbcast:9 row_mask:0xf bank_mask:0xf
    v_fmac_f32_dpp v86, v94, v30 row_newbcast:9 row_mask:0xf bank_mask:0xf
    v_fmac_f32_dpp v87, v94, v31 row_newbcast:9 row_mask:0xf bank_mask:0xf
    s_waitcnt vmcnt(4)
    v_cvt_f32_i32 v24, v12
    v_cvt_f32_i32 v25, v13
    v_cvt_f32_i32 v26, v14
    v_cvt_f32_i32 v27, v15
    buffer_load_dwordx4 v[12:15], v1, s[28:31], s71 offen offset:512 nt
    v_fmac_f32_dpp v76, v94, v24 row_newbcast:5 row_mask:0xf bank_mask:0xf
    v_fmac_f32_dpp v77, v94, v25 row_newbcast:5 row_mask:0xf bank_mask:0xf
    v_fmac_f32_dpp v78, v94, v26 row_newbcast:5 row_mask:0xf bank_mask:0xf
    v_fmac_f32_dpp v79, v94, v27 row_newbcast:5 row_mask:0xf bank_mask:0xf
    s_waitcnt vmcnt(4)
    v_cvt_f32_i32 v28, v16
    v_cvt_f32_i32 v29, v17
    v_cvt_f32_i32 v30, v18
    v_cvt_f32_i32 v31, v19
    s_add_u32 s70, s70, 64
    s_mul_i32 s71, s70, 49152
    buffer_load_dwordx4 v[16:19], v1, s[28:31], s71 offen offset:0 nt
    v_fmac_f32_dpp v80, v94, v28 row_newbcast:5 row_mask:0xf bank_mask:0xf
    v_fmac_f32_dpp v81, v94, v29 row_newbcast:5 row_mask:0xf bank_mask:0xf
    v_fmac_f32_dpp v82, v94, v30 row_newbcast:5 row_mask:0xf bank_mask:0xf
    v_fmac_f32_dpp v83, v94, v31 row_newbcast:5 row_mask:0xf bank_mask:0xf
    s_waitcnt vmcnt(4)
    v_cvt_f32_i32 v24, v20
    v_cvt_f32_i32 v25, v21
    v_cvt_f32_i32 v26, v22
    v_cvt_f32_i32 v27, v23
    buffer_load_dwordx4 v[20:23], v1, s[28:31], s71 offen offset:256 nt
    v_fmac_f32_dpp v84, v94, v24 row_newbcast:5 row_mask:0xf bank_mask:0xf
    v_fmac_f32_dpp v85, v94, v25 row_newbcast:5 row_mask:0xf bank_mask:0xf
    v_fmac_f32_dpp v86, v94, v26 row_newbcast:5 row_mask:0xf bank_mask:0xf
    v_fmac_f32_dpp v87, v94, v27 row_newbcast:5 row_mask:0xf bank_mask:0xf
    s_waitcnt vmcnt(4)
    v_cvt_f32_i32 v28, v4
    v_cvt_f32_i32 v29, v5
    v_cvt_f32_i32 v30, v6
    v_cvt_f32_i32 v31, v7
    buffer_load_dwordx4 v[4:7], v1, s[28:31], s71 offen offset:512 nt
    v_fmac_f32_dpp v76, v94, v28 row_newbcast:13 row_mask:0xf bank_mask:0xf
    v_fmac_f32_dpp v77, v94, v29 row_newbcast:13 row_mask:0xf bank_mask:0xf
    v_fmac_f32_dpp v78, v94, v30 row_newbcast:13 row_mask:0xf bank_mask:0xf
    v_fmac_f32_dpp v79, v94, v31 row_newbcast:13 row_mask:0xf bank_mask:0xf
    s_waitcnt vmcnt(4)
    v_cvt_f32_i32 v24, v8
    v_cvt_f32_i32 v25, v9
    v_cvt_f32_i32 v26, v10
    v_cvt_f32_i32 v27, v11
    s_add_u32 s71, s71, 3072
    buffer_load_dwordx4 v[8:11], v1, s[28:31], s71 offen offset:0 nt
    v_fmac_f32_dpp v80, v94, v24 row_newbcast:13 row_mask:0xf bank_mask:0xf
    v_fmac_f32_dpp v81, v94, v25 row_newbcast:13 row_mask:0xf bank_mask:0xf
    v_fmac_f32_dpp v82, v94, v26 row_newbcast:13 row_mask:0xf bank_mask:0xf
    v_fmac_f32_dpp v83, v94, v27 row_newbcast:13 row_mask:0xf bank_mask:0xf
    s_waitcnt vmcnt(4)
    v_cvt_f32_i32 v28, v12
    v_cvt_f32_i32 v29, v13
    v_cvt_f32_i32 v30, v14
    v_cvt_f32_i32 v31, v15
    buffer_load_dwordx4 v[12:15], v1, s[28:31], s71 offen offset:256 nt
    v_fmac_f32_dpp v84, v94, v28 row_newbcast:13 row_mask:0xf bank_mask:0xf
    v_fmac_f32_dpp v85, v94, v29 row_newbcast:13 row_mask:0xf bank_mask:0xf
    v_fmac_f32_dpp v86, v94, v30 row_newbcast:13 row_mask:0xf bank_mask:0xf
    v_fmac_f32_dpp v87, v94, v31 row_newbcast:13 row_mask:0xf bank_mask:0xf
    s_waitcnt vmcnt(4)
    v_cvt_f32_i32 v24, v16
    v_cvt_f32_i32 v25, v17
    v_cvt_f32_i32 v26, v18
    v_cvt_f32_i32 v27, v19
    buffer_load_dwordx4 v[16:19], v1, s[28:31], s71 offen offset:512 nt
    v_fmac_f32_dpp v76, v94, v24 row_newbcast:3 row_mask:0xf bank_mask:0xf
    v_fmac_f32_dpp v77, v94, v25 row_newbcast:3 row_mask:0xf bank_mask:0xf
    v_fmac_f32_dpp v78, v94, v26 row_newbcast:3 row_mask:0xf bank_mask:0xf
    v_fmac_f32_dpp v79, v94, v27 row_newbcast:3 row_mask:0xf bank_mask:0xf
    s_waitcnt vmcnt(4)
    v_cvt_f32_i32 v28, v20
    v_cvt_f32_i32 v29, v21
    v_cvt_f32_i32 v30, v22
    v_cvt_f32_i32 v31, v23
    s_add_u32 s71, s71, 3072
    buffer_load_dwordx4 v[20:23], v1, s[28:31], s71 offen offset:0 nt
    v_fmac_f32_dpp v80, v94, v28 row_newbcast:3 row_mask:0xf bank_mask:0xf
    v_fmac_f32_dpp v81, v94, v29 row_newbcast:3 row_mask:0xf bank_mask:0xf
    v_fmac_f32_dpp v82, v94, v30 row_newbcast:3 row_mask:0xf bank_mask:0xf
    v_fmac_f32_dpp v83, v94, v31 row_newbcast:3 row_mask:0xf bank_mask:0xf
    s_waitcnt vmcnt(4)
    v_cvt_f32_i32 v24, v4
    v_cvt_f32_i32 v25, v5
    v_cvt_f32_i32 v26, v6
    v_cvt_f32_i32 v27, v7
    buffer_load_dwordx4 v[4:7], v1, s[28:31], s71 offen offset:256 nt
    v_fmac_f32_dpp v84, v94, v24 row_newbcast:3 row_mask:0xf bank_mask:0xf
    v_fmac_f32_dpp v85, v94, v25 row_newbcast:3 row_mask:0xf bank_mask:0xf
    v_fmac_f32_dpp v86, v94, v26 row_newbcast:3 row_mask:0xf bank_mask:0xf
    v_fmac_f32_dpp v87, v94, v27 row_newbcast:3 row_mask:0xf bank_mask:0xf
    s_waitcnt vmcnt(4)
    v_cvt_f32_i32 v28, v8
    v_cvt_f32_i32 v29, v9
    v_cvt_f32_i32 v30, v10
    v_cvt_f32_i32 v31, v11
    buffer_load_dwordx4 v[8:11], v1, s[28:31], s71 offen offset:512 nt
    v_fmac_f32_dpp v76, v94, v28 row_newbcast:11 row_mask:0xf bank_mask:0xf
    v_fmac_f32_dpp v77, v94, v29 row_newbcast:11 row_mask:0xf bank_mask:0xf
    v_fmac_f32_dpp v78, v94, v30 row_newbcast:11 row_mask:0xf bank_mask:0xf
    v_fmac_f32_dpp v79, v94, v31 row_newbcast:11 row_mask:0xf bank_mask:0xf
    s_waitcnt vmcnt(4)
    v_cvt_f32_i32 v24, v12
    v_cvt_f32_i32 v25, v13
    v_cvt_f32_i32 v26, v14
    v_cvt_f32_i32 v27, v15
    s_add_u32 s71, s71, 3072
    buffer_load_dwordx4 v[12:15], v1, s[28:31], s71 offen offset:0 nt
    v_fmac_f32_dpp v80, v94, v24 row_newbcast:11 row_mask:0xf bank_mask:0xf
    v_fmac_f32_dpp v81, v94, v25 row_newbcast:11 row_mask:0xf bank_mask:0xf
    v_fmac_f32_dpp v82, v94, v26 row_newbcast:11 row_mask:0xf bank_mask:0xf
    v_fmac_f32_dpp v83, v94, v27 row_newbcast:11 row_mask:0xf bank_mask:0xf
    s_waitcnt vmcnt(4)
    v_cvt_f32_i32 v28, v16
    v_cvt_f32_i32 v29, v17
    v_cvt_f32_i32 v30, v18
    v_cvt_f32_i32 v31, v19
    buffer_load_dwordx4 v[16:19], v1, s[28:31], s71 offen offset:256 nt
    v_fmac_f32_dpp v84, v94, v28 row_newbcast:11 row_mask:0xf bank_mask:0xf
    v_fmac_f32_dpp v85, v94, v29 row_newbcast:11 row_mask:0xf bank_mask:0xf
    v_fmac_f32_dpp v86, v94, v30 row_newbcast:11 row_mask:0xf bank_mask:0xf
    v_fmac_f32_dpp v87, v94, v31 row_newbcast:11 row_mask:0xf bank_mask:0xf
    s_waitcnt vmcnt(4)
    v_cvt_f32_i32 v24, v20
    v_cvt_f32_i32 v25, v21
    v_cvt_f32_i32 v26, v22
    v_cvt_f32_i32 v27, v23
    buffer_load_dwordx4 v[20:23], v1, s[28:31], s71 offen offset:512 nt
    v_fmac_f32_dpp v76, v94, v24 row_newbcast:7 row_mask:0xf bank_mask:0xf
    v_fmac_f32_dpp v77, v94, v25 row_newbcast:7 row_mask:0xf bank_mask:0xf
    v_fmac_f32_dpp v78, v94, v26 row_newbcast:7 row_mask:0xf bank_mask:0xf
    v_fmac_f32_dpp v79, v94, v27 row_newbcast:7 row_mask:0xf bank_mask:0xf
    s_waitcnt vmcnt(4)
    v_cvt_f32_i32 v28, v4
    v_cvt_f32_i32 v29, v5
    v_cvt_f32_i32 v30, v6
    v_cvt_f32_i32 v31, v7
    s_add_u32 s70, s70, 64
    s_sub_u32 s75, s75, 1
    s_cmp_eq_u32 s75, 0
    s_cselect_b32 s80, 1536, 0
    s_cselect_b32 s75, 2, s75
    s_add_u32 s70, s70, s80
    s_lshl_b32 s73, s70, 7
    buffer_load_ushort v92, v3, s[40:43], s73 offen
    buffer_load_ushort v93, v3, s[44:47], s73 offen
    s_mul_i32 s71, s70, 49152
    buffer_load_dwordx4 v[4:7], v1, s[28:31], s71 offen offset:0 nt
    v_fmac_f32_dpp v80, v94, v28 row_newbcast:7 row_mask:0xf bank_mask:0xf
    v_fmac_f32_dpp v81, v94, v29 row_newbcast:7 row_mask:0xf bank_mask:0xf
    v_fmac_f32_dpp v82, v94, v30 row_newbcast:7 row_mask:0xf bank_mask:0xf
    v_fmac_f32_dpp v83, v94, v31 row_newbcast:7 row_mask:0xf bank_mask:0xf
    s_waitcnt vmcnt(6)
    v_cvt_f32_i32 v24, v8
    v_cvt_f32_i32 v25, v9
    v_cvt_f32_i32 v26, v10
    v_cvt_f32_i32 v27, v11
    buffer_load_dwordx4 v[8:11], v1, s[28:31], s71 offen offset:256 nt
    v_fmac_f32_dpp v84, v94, v24 row_newbcast:7 row_mask:0xf bank_mask:0xf
    v_fmac_f32_dpp v85, v94, v25 row_newbcast:7 row_mask:0xf bank_mask:0xf
    v_fmac_f32_dpp v86, v94, v26 row_newbcast:7 row_mask:0xf bank_mask:0xf
    v_fmac_f32_dpp v87, v94, v27 row_newbcast:7 row_mask:0xf bank_mask:0xf
    s_waitcnt vmcnt(6)
    v_cvt_f32_i32 v28, v12
    v_cvt_f32_i32 v29, v13
    v_cvt_f32_i32 v30, v14
    v_cvt_f32_i32 v31, v15
    buffer_load_dwordx4 v[12:15], v1, s[28:31], s71 offen offset:512 nt
    v_fmac_f32_dpp v76, v94, v28 row_newbcast:15 row_mask:0xf bank_mask:0xf
    v_fmac_f32_dpp v77, v94, v29 row_newbcast:15 row_mask:0xf bank_mask:0xf
    v_fmac_f32_dpp v78, v94, v30 row_newbcast:15 row_mask:0xf bank_mask:0xf
    v_fmac_f32_dpp v79, v94, v31 row_newbcast:15 row_mask:0xf bank_mask:0xf
    s_waitcnt vmcnt(6)
    v_cvt_f32_i32 v24, v16
    v_cvt_f32_i32 v25, v17
    v_cvt_f32_i32 v26, v18
    v_cvt_f32_i32 v27, v19
    s_add_u32 s71, s71, 3072
    buffer_load_dwordx4 v[16:19], v1, s[28:31], s71 offen offset:0 nt
    v_fmac_f32_dpp v80, v94, v24 row_newbcast:15 row_mask:0xf bank_mask:0xf
    v_fmac_f32_dpp v81, v94, v25 row_newbcast:15 row_mask:0xf bank_mask:0xf
    v_fmac_f32_dpp v82, v94, v26 row_newbcast:15 row_mask:0xf bank_mask:0xf
    v_fmac_f32_dpp v83, v94, v27 row_newbcast:15 row_mask:0xf bank_mask:0xf
    s_waitcnt vmcnt(6)
    v_cvt_f32_i32 v28, v20
    v_cvt_f32_i32 v29, v21
    v_cvt_f32_i32 v30, v22
    v_cvt_f32_i32 v31, v23
    buffer_load_dwordx4 v[20:23], v1, s[28:31], s71 offen offset:256 nt
    v_fmac_f32_dpp v84, v94, v28 row_newbcast:15 row_mask:0xf bank_mask:0xf
    v_fmac_f32_dpp v85, v94, v29 row_newbcast:15 row_mask:0xf bank_mask:0xf
    v_fmac_f32_dpp v86, v94, v30 row_newbcast:15 row_mask:0xf bank_mask:0xf
    v_fmac_f32_dpp v87, v94, v31 row_newbcast:15 row_mask:0xf bank_mask:0xf
    s_sub_u32 s77, s77, 1
    s_cmp_lg_u32 s77, 0
    s_cbranch_scc1 L_nofl9
    s_nop 0
    v_add_f32_dpp v90, v90, v90 row_ror:8 row_mask:0xf bank_mask:0xf
    v_add_f32_dpp v91, v91, v91 row_ror:8 row_mask:0xf bank_mask:0xf
    s_nop 0
    v_add_f32_dpp v90, v90, v90 row_ror:4 row_mask:0xf bank_mask:0xf
    v_add_f32_dpp v91, v91, v91 row_ror:4 row_mask:0xf bank_mask:0xf
    s_nop 0
    v_add_f32_dpp v90, v90, v90 row_ror:2 row_mask:0xf bank_mask:0xf
    v_add_f32_dpp v91, v91, v91 row_ror:2 row_mask:0xf bank_mask:0xf
    s_nop 0
    v_add_f32_dpp v90, v90, v90 row_ror:1 row_mask:0xf bank_mask:0xf
    v_add_f32_dpp v91, v91, v91 row_ror:1 row_mask:0xf bank_mask:0xf
    v_mov_b32 v102, v89
    v_mov_b32 v103, v89
    s_nop 1
    v_permlane32_swap_b32 v102, v103
    s_nop 1
    v_max_f32 v102, v102, v103
    v_mov_b32 v103, v102
    s_nop 1
    v_permlane16_swap_b32 v102, v103
    s_nop 1
    v_max_f32 v102, v102, v103
    v_sub_f32 v103, v89, v102
    v_exp_f32 v103, v103
    v_mov_b32 v89, v102
    v_mul_f32 v90, v90, v103
    v_mul_f32 v91, v91, v103
    v_fma_f32 v76, v76, v103, -v91
    v_fma_f32 v77, v77, v103, -v91
    v_fma_f32 v78, v78, v103, -v91
    v_fma_f32 v79, v79, v103, -v91
    v_fma_f32 v80, v80, v103, -v91
    v_fma_f32 v81, v81, v103, -v91
    v_fma_f32 v82, v82, v103, -v91
    v_fma_f32 v83, v83, v103, -v91
    v_fma_f32 v84, v84, v103, -v91
    v_fma_f32 v85, v85, v103, -v91
    v_fma_f32 v86, v86, v103, -v91
    v_fma_f32 v87, v87, v103, -v91
    v_mov_b32 v102, v90
    s_nop 1
    v_permlane32_swap_b32 v90, v102
    v_permlane32_swap_b32 v76, v78
    v_permlane32_swap_b32 v77, v79
    v_permlane32_swap_b32 v80, v82
    v_permlane32_swap_b32 v81, v83
    v_permlane32_swap_b32 v84, v86
    v_permlane32_swap_b32 v85, v87
    s_nop 1
    v_add_f32 v90, v90, v102
    v_add_f32 v76, v76, v78
    v_add_f32 v77, v77, v79
    v_add_f32 v80, v80, v82
    v_add_f32 v81, v81, v83
    v_add_f32 v84, v84, v86
    v_add_f32 v85, v85, v87
    v_mov_b32 v102, v90
    s_nop 1
    v_permlane16_swap_b32 v90, v102
    v_permlane16_swap_b32 v76, v77
    v_permlane16_swap_b32 v80, v81
    v_permlane16_swap_b32 v84, v85
    s_nop 1
    v_add_f32 v90, v90, v102
    v_add_f32 v76, v76, v77
    v_add_f32 v80, v80, v81
    v_add_f32 v84, v84, v85
    ds_write_b32 v106, v76 offset:16640
    ds_write_b32 v106, v80 offset:16896
    ds_write_b32 v106, v84 offset:17152
    ds_write_b32 v107, v89 offset:17408
    ds_write_b32 v107, v90 offset:17412
    s_waitcnt lgkmcnt(0)
    s_mov_b64 exec, 1
    ds_add_u32 v108, v109
    s_mov_b64 exec, -1
    v_add_u32 v106, 4096, v106
    v_add_u32 v107, 4096, v107
    v_add_u32 v108, 4, v108
    v_mov_b32 v89, 0xf149f2ca
    v_mov_b32 v90, 0
    v_mov_b32 v91, 0
    v_mov_b32 v76, 0
    v_mov_b32 v77, 0
    v_mov_b32 v78, 0
    v_mov_b32 v79, 0
    v_mov_b32 v80, 0
    v_mov_b32 v81, 0
    v_mov_b32 v82, 0
    v_mov_b32 v83, 0
    v_mov_b32 v84, 0
    v_mov_b32 v85, 0
    v_mov_b32 v86, 0
    v_mov_b32 v87, 0
    s_mov_b32 s77, 2
L_nofl9:
    s_waitcnt vmcnt(5)
    v_lshlrev_b32 v92, 16, v92
    v_lshlrev_b32 v93, 16, v93
    s_waitcnt lgkmcnt(0)
    v_max_f32_dpp v102, v95, v95 row_ror:8 row_mask:0xf bank_mask:0xf
    s_nop 1
    v_max_f32_dpp v102, v102, v102 row_ror:4 row_mask:0xf bank_mask:0xf
    s_nop 1
    v_max_f32_dpp v102, v102, v102 row_ror:2 row_mask:0xf bank_mask:0xf
    s_nop 1
    v_max_f32_dpp v102, v102, v102 row_ror:1 row_mask:0xf bank_mask:0xf
    v_max_f32 v102, v102, v89
    v_sub_f32 v103, v89, v102
    v_sub_f32 v94, v95, v102
    v_exp_f32 v103, v103
    v_exp_f32 v94, v94
    v_mov_b32 v89, v102
    v_fma_f32 v90, v90, v103, v94
    v_mul_f32 v94, v94, v92
    v_mul_f32 v91, v91, v103
    v_fmac_f32 v91, v94, v93
    ds_read_b32 v95, v105
    v_add_u32 v105, 256, v105
    v_mul_f32 v76, v76, v103
    v_mul_f32 v77, v77, v103
    v_mul_f32 v78, v78, v103
    v_mul_f32 v79, v79, v103
    v_mul_f32 v80, v80, v103
    v_mul_f32 v81, v81, v103
    v_mul_f32 v82, v82, v103
    v_mul_f32 v83, v83, v103
    v_mul_f32 v84, v84, v103
    v_mul_f32 v85, v85, v103
    v_mul_f32 v86, v86, v103
    v_mul_f32 v87, v87, v103
    s_waitcnt vmcnt(4)
    v_cvt_f32_i32 v24, v4
    v_cvt_f32_i32 v25, v5
    v_cvt_f32_i32 v26, v6
    v_cvt_f32_i32 v27, v7
    buffer_load_dwordx4 v[4:7], v1, s[28:31], s71 offen offset:512 nt
    v_fmac_f32_dpp v76, v94, v24 row_newbcast:0 row_mask:0xf bank_mask:0xf
    v_fmac_f32_dpp v77, v94, v25 row_newbcast:0 row_mask:0xf bank_mask:0xf
    v_fmac_f32_dpp v78, v94, v26 row_newbcast:0 row_mask:0xf bank_mask:0xf
    v_fmac_f32_dpp v79, v94, v27 row_newbcast:0 row_mask:0xf bank_mask:0xf
    s_waitcnt vmcnt(4)
    v_cvt_f32_i32 v28, v8
    v_cvt_f32_i32 v29, v9
    v_cvt_f32_i32 v30, v10
    v_cvt_f32_i32 v31, v11
    s_add_u32 s71, s71, 3072
    buffer_load_dwordx4 v[8:11], v1, s[28:31], s71 offen offset:0 nt
    v_fmac_f32_dpp v80, v94, v28 row_newbcast:0 row_mask:0xf bank_mask:0xf
    v_fmac_f32_dpp v81, v94, v29 row_newbcast:0 row_mask:0xf bank_mask:0xf
    v_fmac_f32_dpp v82, v94, v30 row_newbcast:0 row_mask:0xf bank_mask:0xf
    v_fmac_f32_dpp v83, v94, v31 row_newbcast:0 row_mask:0xf bank_mask:0xf
    s_waitcnt vmcnt(4)
    v_cvt_f32_i32 v24, v12
    v_cvt_f32_i32 v25, v13
    v_cvt_f32_i32 v26, v14
    v_cvt_f32_i32 v27, v15
    buffer_load_dwordx4 v[12:15], v1, s[28:31], s71 offen offset:256 nt
    v_fmac_f32_dpp v84, v94, v24 row_newbcast:0 row_mask:0xf bank_mask:0xf
    v_fmac_f32_dpp v85, v94, v25 row_newbcast:0 row_mask:0xf bank_mask:0xf
    v_fmac_f32_dpp v86, v94, v26 row_newbcast:0 row_mask:0xf bank_mask:0xf
    v_fmac_f32_dpp v87, v94, v27 row_newbcast:0 row_mask:0xf bank_mask:0xf
    s_waitcnt vmcnt(4)
    v_cvt_f32_i32 v28, v16
    v_cvt_f32_i32 v29, v17
    v_cvt_f32_i32 v30, v18
    v_cvt_f32_i32 v31, v19
    buffer_load_dwordx4 v[16:19], v1, s[28:31], s71 offen offset:512 nt
    v_fmac_f32_dpp v76, v94, v28 row_newbcast:8 row_mask:0xf bank_mask:0xf
    v_fmac_f32_dpp v77, v94, v29 row_newbcast:8 row_mask:0xf bank_mask:0xf
    v_fmac_f32_dpp v78, v94, v30 row_newbcast:8 row_mask:0xf bank_mask:0xf
    v_fmac_f32_dpp v79, v94, v31 row_newbcast:8 row_mask:0xf bank_mask:0xf
    s_waitcnt vmcnt(4)
    v_cvt_f32_i32 v24, v20
    v_cvt_f32_i32 v25, v21
    v_cvt_f32_i32 v26, v22
    v_cvt_f32_i32 v27, v23
    s_add_u32 s71, s71, 3072
    buffer_load_dwordx4 v[20:23], v1, s[28:31], s71 offen offset:0 nt
    v_fmac_f32_dpp v80, v94, v24 row_newbcast:8 row_mask:0xf bank_mask:0xf
    v_fmac_f32_dpp v81, v94, v25 row_newbcast:8 row_mask:0xf bank_mask:0xf
    v_fmac_f32_dpp v82, v94, v26 row_newbcast:8 row_mask:0xf bank_mask:0xf
    v_fmac_f32_dpp v83, v94, v27 row_newbcast:8 row_mask:0xf bank_mask:0xf
    s_waitcnt vmcnt(4)
    v_cvt_f32_i32 v28, v4
    v_cvt_f32_i32 v29, v5
    v_cvt_f32_i32 v30, v6
    v_cvt_f32_i32 v31, v7
    buffer_load_dwordx4 v[4:7], v1, s[28:31], s71 offen offset:256 nt
    v_fmac_f32_dpp v84, v94, v28 row_newbcast:8 row_mask:0xf bank_mask:0xf
    v_fmac_f32_dpp v85, v94, v29 row_newbcast:8 row_mask:0xf bank_mask:0xf
    v_fmac_f32_dpp v86, v94, v30 row_newbcast:8 row_mask:0xf bank_mask:0xf
    v_fmac_f32_dpp v87, v94, v31 row_newbcast:8 row_mask:0xf bank_mask:0xf
    s_waitcnt vmcnt(4)
    v_cvt_f32_i32 v24, v8
    v_cvt_f32_i32 v25, v9
    v_cvt_f32_i32 v26, v10
    v_cvt_f32_i32 v27, v11
    buffer_load_dwordx4 v[8:11], v1, s[28:31], s71 offen offset:512 nt
    v_fmac_f32_dpp v76, v94, v24 row_newbcast:4 row_mask:0xf bank_mask:0xf
    v_fmac_f32_dpp v77, v94, v25 row_newbcast:4 row_mask:0xf bank_mask:0xf
    v_fmac_f32_dpp v78, v94, v26 row_newbcast:4 row_mask:0xf bank_mask:0xf
    v_fmac_f32_dpp v79, v94, v27 row_newbcast:4 row_mask:0xf bank_mask:0xf
    s_waitcnt vmcnt(4)
    v_cvt_f32_i32 v28, v12
    v_cvt_f32_i32 v29, v13
    v_cvt_f32_i32 v30, v14
    v_cvt_f32_i32 v31, v15
    s_add_u32 s70, s70, 64
    s_mul_i32 s71, s70, 49152
    buffer_load_dwordx4 v[12:15], v1, s[28:31], s71 offen offset:0 nt
    v_fmac_f32_dpp v80, v94, v28 row_newbcast:4 row_mask:0xf bank_mask:0xf
    v_fmac_f32_dpp v81, v94, v29 row_newbcast:4 row_mask:0xf bank_mask:0xf
    v_fmac_f32_dpp v82, v94, v30 row_newbcast:4 row_mask:0xf bank_mask:0xf
    v_fmac_f32_dpp v83, v94, v31 row_newbcast:4 row_mask:0xf bank_mask:0xf
    s_waitcnt vmcnt(4)
    v_cvt_f32_i32 v24, v16
    v_cvt_f32_i32 v25, v17
    v_cvt_f32_i32 v26, v18
    v_cvt_f32_i32 v27, v19
    buffer_load_dwordx4 v[16:19], v1, s[28:31], s71 offen offset:256 nt
    v_fmac_f32_dpp v84, v94, v24 row_newbcast:4 row_mask:0xf bank_mask:0xf
    v_fmac_f32_dpp v85, v94, v25 row_newbcast:4 row_mask:0xf bank_mask:0xf
    v_fmac_f32_dpp v86, v94, v26 row_newbcast:4 row_mask:0xf bank_mask:0xf
    v_fmac_f32_dpp v87, v94, v27 row_newbcast:4 row_mask:0xf bank_mask:0xf
    s_waitcnt vmcnt(4)
    v_cvt_f32_i32 v28, v20
    v_cvt_f32_i32 v29, v21
    v_cvt_f32_i32 v30, v22
    v_cvt_f32_i32 v31, v23
    buffer_load_dwordx4 v[20:23], v1, s[28:31], s71 offen offset:512 nt
    v_fmac_f32_dpp v76, v94, v28 row_newbcast:12 row_mask:0xf bank_mask:0xf
    v_fmac_f32_dpp v77, v94, v29 row_newbcast:12 row_mask:0xf bank_mask:0xf
    v_fmac_f32_dpp v78, v94, v30 row_newbcast:12 row_mask:0xf bank_mask:0xf
    v_fmac_f32_dpp v79, v94, v31 row_newbcast:12 row_mask:0xf bank_mask:0xf
    s_waitcnt vmcnt(4)
    v_cvt_f32_i32 v24, v4
    v_cvt_f32_i32 v25, v5
    v_cvt_f32_i32 v26, v6
    v_cvt_f32_i32 v27, v7
    s_add_u32 s71, s71, 3072
    buffer_load_dwordx4 v[4:7], v1, s[28:31], s71 offen offset:0 nt
    v_fmac_f32_dpp v80, v94, v24 row_newbcast:12 row_mask:0xf bank_mask:0xf
    v_fmac_f32_dpp v81, v94, v25 row_newbcast:12 row_mask:0xf bank_mask:0xf
    v_fmac_f32_dpp v82, v94, v26 row_newbcast:12 row_mask:0xf bank_mask:0xf
    v_fmac_f32_dpp v83, v94, v27 row_newbcast:12 row_mask:0xf bank_mask:0xf
    s_waitcnt vmcnt(4)
    v_cvt_f32_i32 v28, v8
    v_cvt_f32_i32 v29, v9
    v_cvt_f32_i32 v30, v10
    v_cvt_f32_i32 v31, v11
    buffer_load_dwordx4 v[8:11], v1, s[28:31], s71 offen offset:256 nt
    v_fmac_f32_dpp v84, v94, v28 row_newbcast:12 row_mask:0xf bank_mask:0xf
    v_fmac_f32_dpp v85, v94, v29 row_newbcast:12 row_mask:0xf bank_mask:0xf
    v_fmac_f32_dpp v86, v94, v30 row_newbcast:12 row_mask:0xf bank_mask:0xf
    v_fmac_f32_dpp v87, v94, v31 row_newbcast:12 row_mask:0xf bank_mask:0xf
    s_waitcnt vmcnt(4)
    v_cvt_f32_i32 v24, v12
    v_cvt_f32_i32 v25, v13
    v_cvt_f32_i32 v26, v14
    v_cvt_f32_i32 v27, v15
    buffer_load_dwordx4 v[12:15], v1, s[28:31], s71 offen offset:512 nt
    v_fmac_f32_dpp v76, v94, v24 row_newbcast:2 row_mask:0xf bank_mask:0xf
    v_fmac_f32_dpp v77, v94, v25 row_newbcast:2 row_mask:0xf bank_mask:0xf
    v_fmac_f32_dpp v78, v94, v26 row_newbcast:2 row_mask:0xf bank_mask:0xf
    v_fmac_f32_dpp v79, v94, v27 row_newbcast:2 row_mask:0xf bank_mask:0xf
    s_waitcnt vmcnt(4)
    v_cvt_f32_i32 v28, v16
    v_cvt_f32_i32 v29, v17
    v_cvt_f32_i32 v30, v18
    v_cvt_f32_i32 v31, v19
    s_add_u32 s71, s71, 3072
    buffer_load_dwordx4 v[16:19], v1, s[28:31], s71 offen offset:0 nt
    v_fmac_f32_dpp v80, v94, v28 row_newbcast:2 row_mask:0xf bank_mask:0xf
    v_fmac_f32_dpp v81, v94, v29 row_newbcast:2 row_mask:0xf bank_mask:0xf
    v_fmac_f32_dpp v82, v94, v30 row_newbcast:2 row_mask:0xf bank_mask:0xf
    v_fmac_f32_dpp v83, v94, v31 row_newbcast:2 row_mask:0xf bank_mask:0xf
    s_waitcnt vmcnt(4)
    v_cvt_f32_i32 v24, v20
    v_cvt_f32_i32 v25, v21
    v_cvt_f32_i32 v26, v22
    v_cvt_f32_i32 v27, v23
    buffer_load_dwordx4 v[20:23], v1, s[28:31], s71 offen offset:256 nt
    v_fmac_f32_dpp v84, v94, v24 row_newbcast:2 row_mask:0xf bank_mask:0xf
    v_fmac_f32_dpp v85, v94, v25 row_newbcast:2 row_mask:0xf bank_mask:0xf
    v_fmac_f32_dpp v86, v94, v26 row_newbcast:2 row_mask:0xf bank_mask:0xf
    v_fmac_f32_dpp v87, v94, v27 row_newbcast:2 row_mask:0xf bank_mask:0xf
    s_waitcnt vmcnt(4)
    v_cvt_f32_i32 v28, v4
    v_cvt_f32_i32 v29, v5
    v_cvt_f32_i32 v30, v6
    v_cvt_f32_i32 v31, v7
    buffer_load_dwordx4 v[4:7], v1, s[28:31], s71 offen offset:512 nt
    v_fmac_f32_dpp v76, v94, v28 row_newbcast:10 row_mask:0xf bank_mask:0xf
    v_fmac_f32_dpp v77, v94, v29 row_newbcast:10 row_mask:0xf bank_mask:0xf
    v_fmac_f32_dpp v78, v94, v30 row_newbcast:10 row_mask:0xf bank_mask:0xf
    v_fmac_f32_dpp v79, v94, v31 row_newbcast:10 row_mask:0xf bank_mask:0xf
    s_waitcnt vmcnt(4)
    v_cvt_f32_i32 v24, v8
    v_cvt_f32_i32 v25, v9
    v_cvt_f32_i32 v26, v10
    v_cvt_f32_i32 v27, v11
    s_add_u32 s71, s71, 3072
    buffer_load_dwordx4 v[8:11], v1, s[28:31], s71 offen offset:0 nt
    v_fmac_f32_dpp v80, v94, v24 row_newbcast:10 row_mask:0xf bank_mask:0xf
    v_fmac_f32_dpp v81, v94, v25 row_newbcast:10 row_mask:0xf bank_mask:0xf
    v_fmac_f32_dpp v82, v94, v26 row_newbcast:10 row_mask:0xf bank_mask:0xf
    v_fmac_f32_dpp v83, v94, v27 row_newbcast:10 row_mask:0xf bank_mask:0xf
    s_waitcnt vmcnt(4)
    v_cvt_f32_i32 v28, v12
    v_cvt_f32_i32 v29, v13
    v_cvt_f32_i32 v30, v14
    v_cvt_f32_i32 v31, v15
    buffer_load_dwordx4 v[12:15], v1, s[28:31], s71 offen offset:256 nt
    v_fmac_f32_dpp v84, v94, v28 row_newbcast:10 row_mask:0xf bank_mask:0xf
    v_fmac_f32_dpp v85, v94, v29 row_newbcast:10 row_mask:0xf bank_mask:0xf
    v_fmac_f32_dpp v86, v94, v30 row_newbcast:10 row_mask:0xf bank_mask:0xf
    v_fmac_f32_dpp v87, v94, v31 row_newbcast:10 row_mask:0xf bank_mask:0xf
    s_waitcnt vmcnt(4)
    v_cvt_f32_i32 v24, v16
    v_cvt_f32_i32 v25, v17
    v_cvt_f32_i32 v26, v18
    v_cvt_f32_i32 v27, v19
    buffer_load_dwordx4 v[16:19], v1, s[28:31], s71 offen offset:512 nt
    v_fmac_f32_dpp v76, v94, v24 row_newbcast:6 row_mask:0xf bank_mask:0xf
    v_fmac_f32_dpp v77, v94, v25 row_newbcast:6 row_mask:0xf bank_mask:0xf
    v_fmac_f32_dpp v78, v94, v26 row_newbcast:6 row_mask:0xf bank_mask:0xf
    v_fmac_f32_dpp v79, v94, v27 row_newbcast:6 row_mask:0xf bank_mask:0xf
    s_waitcnt vmcnt(4)
    v_cvt_f32_i32 v28, v20
    v_cvt_f32_i32 v29, v21
    v_cvt_f32_i32 v30, v22
    v_cvt_f32_i32 v31, v23
    s_add_u32 s70, s70, 64
    s_mul_i32 s71, s70, 49152
    buffer_load_dwordx4 v[20:23], v1, s[28:31], s71 offen offset:0 nt
    v_fmac_f32_dpp v80, v94, v28 row_newbcast:6 row_mask:0xf bank_mask:0xf
    v_fmac_f32_dpp v81, v94, v29 row_newbcast:6 row_mask:0xf bank_mask:0xf
    v_fmac_f32_dpp v82, v94, v30 row_newbcast:6 row_mask:0xf bank_mask:0xf
    v_fmac_f32_dpp v83, v94, v31 row_newbcast:6 row_mask:0xf bank_mask:0xf
    s_waitcnt vmcnt(4)
    v_cvt_f32_i32 v24, v4
    v_cvt_f32_i32 v25, v5
    v_cvt_f32_i32 v26, v6
    v_cvt_f32_i32 v27, v7
    buffer_load_dwordx4 v[4:7], v1, s[28:31], s71 offen offset:256 nt
    v_fmac_f32_dpp v84, v94, v24 row_newbcast:6 row_mask:0xf bank_mask:0xf
    v_fmac_f32_dpp v85, v94, v25 row_newbcast:6 row_mask:0xf bank_mask:0xf
    v_fmac_f32_dpp v86, v94, v26 row_newbcast:6 row_mask:0xf bank_mask:0xf
    v_fmac_f32_dpp v87, v94, v27 row_newbcast:6 row_mask:0xf bank_mask:0xf
    s_waitcnt vmcnt(4)
    v_cvt_f32_i32 v28, v8
    v_cvt_f32_i32 v29, v9
    v_cvt_f32_i32 v30, v10
    v_cvt_f32_i32 v31, v11
    buffer_load_dwordx4 v[8:11], v1, s[28:31], s71 offen offset:512 nt
    v_fmac_f32_dpp v76, v94, v28 row_newbcast:14 row_mask:0xf bank_mask:0xf
    v_fmac_f32_dpp v77, v94, v29 row_newbcast:14 row_mask:0xf bank_mask:0xf
    v_fmac_f32_dpp v78, v94, v30 row_newbcast:14 row_mask:0xf bank_mask:0xf
    v_fmac_f32_dpp v79, v94, v31 row_newbcast:14 row_mask:0xf bank_mask:0xf
    s_waitcnt vmcnt(4)
    v_cvt_f32_i32 v24, v12
    v_cvt_f32_i32 v25, v13
    v_cvt_f32_i32 v26, v14
    v_cvt_f32_i32 v27, v15
    s_add_u32 s71, s71, 3072
    buffer_load_dwordx4 v[12:15], v1, s[28:31], s71 offen offset:0 nt
    v_fmac_f32_dpp v80, v94, v24 row_newbcast:14 row_mask:0xf bank_mask:0xf
    v_fmac_f32_dpp v81, v94, v25 row_newbcast:14 row_mask:0xf bank_mask:0xf
    v_fmac_f32_dpp v82, v94, v26 row_newbcast:14 row_mask:0xf bank_mask:0xf
    v_fmac_f32_dpp v83, v94, v27 row_newbcast:14 row_mask:0xf bank_mask:0xf
    s_waitcnt vmcnt(4)
    v_cvt_f32_i32 v28, v16
    v_cvt_f32_i32 v29, v17
    v_cvt_f32_i32 v30, v18
    v_cvt_f32_i32 v31, v19
    buffer_load_dwordx4 v[16:19], v1, s[28:31], s71 offen offset:256 nt
    v_fmac_f32_dpp v84, v94, v28 row_newbcast:14 row_mask:0xf bank_mask:0xf
    v_fmac_f32_dpp v85, v94, v29 row_newbcast:14 row_mask:0xf bank_mask:0xf
    v_fmac_f32_dpp v86, v94, v30 row_newbcast:14 row_mask:0xf bank_mask:0xf
    v_fmac_f32_dpp v87, v94, v31 row_newbcast:14 row_mask:0xf bank_mask:0xf
    s_waitcnt vmcnt(4)
    v_cvt_f32_i32 v24, v20
    v_cvt_f32_i32 v25, v21
    v_cvt_f32_i32 v26, v22
    v_cvt_f32_i32 v27, v23
    buffer_load_dwordx4 v[20:23], v1, s[28:31], s71 offen offset:512 nt
    v_fmac_f32_dpp v76, v94, v24 row_newbcast:1 row_mask:0xf bank_mask:0xf
    v_fmac_f32_dpp v77, v94, v25 row_newbcast:1 row_mask:0xf bank_mask:0xf
    v_fmac_f32_dpp v78, v94, v26 row_newbcast:1 row_mask:0xf bank_mask:0xf
    v_fmac_f32_dpp v79, v94, v27 row_newbcast:1 row_mask:0xf bank_mask:0xf
    s_waitcnt vmcnt(4)
    v_cvt_f32_i32 v28, v4
    v_cvt_f32_i32 v29, v5
    v_cvt_f32_i32 v30, v6
    v_cvt_f32_i32 v31, v7
    s_add_u32 s71, s71, 3072
    buffer_load_dwordx4 v[4:7], v1, s[28:31], s71 offen offset:0 nt
    v_fmac_f32_dpp v80, v94, v28 row_newbcast:1 row_mask:0xf bank_mask:0xf
    v_fmac_f32_dpp v81, v94, v29 row_newbcast:1 row_mask:0xf bank_mask:0xf
    v_fmac_f32_dpp v82, v94, v30 row_newbcast:1 row_mask:0xf bank_mask:0xf
    v_fmac_f32_dpp v83, v94, v31 row_newbcast:1 row_mask:0xf bank_mask:0xf
    s_waitcnt vmcnt(4)
    v_cvt_f32_i32 v24, v8
    v_cvt_f32_i32 v25, v9
    v_cvt_f32_i32 v26, v10
    v_cvt_f32_i32 v27, v11
    buffer_load_dwordx4 v[8:11], v1, s[28:31], s71 offen offset:256 nt
    v_fmac_f32_dpp v84, v94, v24 row_newbcast:1 row_mask:0xf bank_mask:0xf
    v_fmac_f32_dpp v85, v94, v25 row_newbcast:1 row_mask:0xf bank_mask:0xf
    v_fmac_f32_dpp v86, v94, v26 row_newbcast:1 row_mask:0xf bank_mask:0xf
    v_fmac_f32_dpp v87, v94, v27 row_newbcast:1 row_mask:0xf bank_mask:0xf
    s_waitcnt vmcnt(4)
    v_cvt_f32_i32 v28, v12
    v_cvt_f32_i32 v29, v13
    v_cvt_f32_i32 v30, v14
    v_cvt_f32_i32 v31, v15
    buffer_load_dwordx4 v[12:15], v1, s[28:31], s71 offen offset:512 nt
    v_fmac_f32_dpp v76, v94, v28 row_newbcast:9 row_mask:0xf bank_mask:0xf
    v_fmac_f32_dpp v77, v94, v29 row_newbcast:9 row_mask:0xf bank_mask:0xf
    v_fmac_f32_dpp v78, v94, v30 row_newbcast:9 row_mask:0xf bank_mask:0xf
    v_fmac_f32_dpp v79, v94, v31 row_newbcast:9 row_mask:0xf bank_mask:0xf
    s_waitcnt vmcnt(4)
    v_cvt_f32_i32 v24, v16
    v_cvt_f32_i32 v25, v17
    v_cvt_f32_i32 v26, v18
    v_cvt_f32_i32 v27, v19
    s_add_u32 s71, s71, 3072
    buffer_load_dwordx4 v[16:19], v1, s[28:31], s71 offen offset:0 nt
    v_fmac_f32_dpp v80, v94, v24 row_newbcast:9 row_mask:0xf bank_mask:0xf
    v_fmac_f32_dpp v81, v94, v25 row_newbcast:9 row_mask:0xf bank_mask:0xf
    v_fmac_f32_dpp v82, v94, v26 row_newbcast:9 row_mask:0xf bank_mask:0xf
    v_fmac_f32_dpp v83, v94, v27 row_newbcast:9 row_mask:0xf bank_mask:0xf
    s_waitcnt vmcnt(4)
    v_cvt_f32_i32 v28, v20
    v_cvt_f32_i32 v29, v21
    v_cvt_f32_i32 v30, v22
    v_cvt_f32_i32 v31, v23
    buffer_load_dwordx4 v[20:23], v1, s[28:31], s71 offen offset:256 nt
    v_fmac_f32_dpp v84, v94, v28 row_newbcast:9 row_mask:0xf bank_mask:0xf
    v_fmac_f32_dpp v85, v94, v29 row_newbcast:9 row_mask:0xf bank_mask:0xf
    v_fmac_f32_dpp v86, v94, v30 row_newbcast:9 row_mask:0xf bank_mask:0xf
    v_fmac_f32_dpp v87, v94, v31 row_newbcast:9 row_mask:0xf bank_mask:0xf
    s_waitcnt vmcnt(4)
    v_cvt_f32_i32 v24, v4
    v_cvt_f32_i32 v25, v5
    v_cvt_f32_i32 v26, v6
    v_cvt_f32_i32 v27, v7
    buffer_load_dwordx4 v[4:7], v1, s[28:31], s71 offen offset:512 nt
    v_fmac_f32_dpp v76, v94, v24 row_newbcast:5 row_mask:0xf bank_mask:0xf
    v_fmac_f32_dpp v77, v94, v25 row_newbcast:5 row_mask:0xf bank_mask:0xf
    v_fmac_f32_dpp v78, v94, v26 row_newbcast:5 row_mask:0xf bank_mask:0xf
    v_fmac_f32_dpp v79, v94, v27 row_newbcast:5 row_mask:0xf bank_mask:0xf
    s_waitcnt vmcnt(4)
    v_cvt_f32_i32 v28, v8
    v_cvt_f32_i32 v29, v9
    v_cvt_f32_i32 v30, v10
    v_cvt_f32_i32 v31, v11
    s_add_u32 s70, s70, 64
    s_mul_i32 s71, s70, 49152
    buffer_load_dwordx4 v[8:11], v1, s[28:31], s71 offen offset:0 nt
    v_fmac_f32_dpp v80, v94, v28 row_newbcast:5 row_mask:0xf bank_mask:0xf
    v_fmac_f32_dpp v81, v94, v29 row_newbcast:5 row_mask:0xf bank_mask:0xf
    v_fmac_f32_dpp v82, v94, v30 row_newbcast:5 row_mask:0xf bank_mask:0xf
    v_fmac_f32_dpp v83, v94, v31 row_newbcast:5 row_mask:0xf bank_mask:0xf
    s_waitcnt vmcnt(4)
    v_cvt_f32_i32 v24, v12
    v_cvt_f32_i32 v25, v13
    v_cvt_f32_i32 v26, v14
    v_cvt_f32_i32 v27, v15
    buffer_load_dwordx4 v[12:15], v1, s[28:31], s71 offen offset:256 nt
    v_fmac_f32_dpp v84, v94, v24 row_newbcast:5 row_mask:0xf bank_mask:0xf
    v_fmac_f32_dpp v85, v94, v25 row_newbcast:5 row_mask:0xf bank_mask:0xf
    v_fmac_f32_dpp v86, v94, v26 row_newbcast:5 row_mask:0xf bank_mask:0xf
    v_fmac_f32_dpp v87, v94, v27 row_newbcast:5 row_mask:0xf bank_mask:0xf
    s_waitcnt vmcnt(4)
    v_cvt_f32_i32 v28, v16
    v_cvt_f32_i32 v29, v17
    v_cvt_f32_i32 v30, v18
    v_cvt_f32_i32 v31, v19
    buffer_load_dwordx4 v[16:19], v1, s[28:31], s71 offen offset:512 nt
    v_fmac_f32_dpp v76, v94, v28 row_newbcast:13 row_mask:0xf bank_mask:0xf
    v_fmac_f32_dpp v77, v94, v29 row_newbcast:13 row_mask:0xf bank_mask:0xf
    v_fmac_f32_dpp v78, v94, v30 row_newbcast:13 row_mask:0xf bank_mask:0xf
    v_fmac_f32_dpp v79, v94, v31 row_newbcast:13 row_mask:0xf bank_mask:0xf
    s_waitcnt vmcnt(4)
    v_cvt_f32_i32 v24, v20
    v_cvt_f32_i32 v25, v21
    v_cvt_f32_i32 v26, v22
    v_cvt_f32_i32 v27, v23
    s_add_u32 s71, s71, 3072
    buffer_load_dwordx4 v[20:23], v1, s[28:31], s71 offen offset:0 nt
    v_fmac_f32_dpp v80, v94, v24 row_newbcast:13 row_mask:0xf bank_mask:0xf
    v_fmac_f32_dpp v81, v94, v25 row_newbcast:13 row_mask:0xf bank_mask:0xf
    v_fmac_f32_dpp v82, v94, v26 row_newbcast:13 row_mask:0xf bank_mask:0xf
    v_fmac_f32_dpp v83, v94, v27 row_newbcast:13 row_mask:0xf bank_mask:0xf
    s_waitcnt vmcnt(4)
    v_cvt_f32_i32 v28, v4
    v_cvt_f32_i32 v29, v5
    v_cvt_f32_i32 v30, v6
    v_cvt_f32_i32 v31, v7
    buffer_load_dwordx4 v[4:7], v1, s[28:31], s71 offen offset:256 nt
    v_fmac_f32_dpp v84, v94, v28 row_newbcast:13 row_mask:0xf bank_mask:0xf
    v_fmac_f32_dpp v85, v94, v29 row_newbcast:13 row_mask:0xf bank_mask:0xf
    v_fmac_f32_dpp v86, v94, v30 row_newbcast:13 row_mask:0xf bank_mask:0xf
    v_fmac_f32_dpp v87, v94, v31 row_newbcast:13 row_mask:0xf bank_mask:0xf
    s_waitcnt vmcnt(4)
    v_cvt_f32_i32 v24, v8
    v_cvt_f32_i32 v25, v9
    v_cvt_f32_i32 v26, v10
    v_cvt_f32_i32 v27, v11
    buffer_load_dwordx4 v[8:11], v1, s[28:31], s71 offen offset:512 nt
    v_fmac_f32_dpp v76, v94, v24 row_newbcast:3 row_mask:0xf bank_mask:0xf
    v_fmac_f32_dpp v77, v94, v25 row_newbcast:3 row_mask:0xf bank_mask:0xf
    v_fmac_f32_dpp v78, v94, v26 row_newbcast:3 row_mask:0xf bank_mask:0xf
    v_fmac_f32_dpp v79, v94, v27 row_newbcast:3 row_mask:0xf bank_mask:0xf
    s_waitcnt vmcnt(4)
    v_cvt_f32_i32 v28, v12
    v_cvt_f32_i32 v29, v13
    v_cvt_f32_i32 v30, v14
    v_cvt_f32_i32 v31, v15
    s_add_u32 s71, s71, 3072
    buffer_load_dwordx4 v[12:15], v1, s[28:31], s71 offen offset:0 nt
    v_fmac_f32_dpp v80, v94, v28 row_newbcast:3 row_mask:0xf bank_mask:0xf
    v_fmac_f32_dpp v81, v94, v29 row_newbcast:3 row_mask:0xf bank_mask:0xf
    v_fmac_f32_dpp v82, v94, v30 row_newbcast:3 row_mask:0xf bank_mask:0xf
    v_fmac_f32_dpp v83, v94, v31 row_newbcast:3 row_mask:0xf bank_mask:0xf
    s_waitcnt vmcnt(4)
    v_cvt_f32_i32 v24, v16
    v_cvt_f32_i32 v25, v17
    v_cvt_f32_i32 v26, v18
    v_cvt_f32_i32 v27, v19
    buffer_load_dwordx4 v[16:19], v1, s[28:31], s71 offen offset:256 nt
    v_fmac_f32_dpp v84, v94, v24 row_newbcast:3 row_mask:0xf bank_mask:0xf
    v_fmac_f32_dpp v85, v94, v25 row_newbcast:3 row_mask:0xf bank_mask:0xf
    v_fmac_f32_dpp v86, v94, v26 row_newbcast:3 row_mask:0xf bank_mask:0xf
    v_fmac_f32_dpp v87, v94, v27 row_newbcast:3 row_mask:0xf bank_mask:0xf
    s_waitcnt vmcnt(4)
    v_cvt_f32_i32 v28, v20
    v_cvt_f32_i32 v29, v21
    v_cvt_f32_i32 v30, v22
    v_cvt_f32_i32 v31, v23
    buffer_load_dwordx4 v[20:23], v1, s[28:31], s71 offen offset:512 nt
    v_fmac_f32_dpp v76, v94, v28 row_newbcast:11 row_mask:0xf bank_mask:0xf
    v_fmac_f32_dpp v77, v94, v29 row_newbcast:11 row_mask:0xf bank_mask:0xf
    v_fmac_f32_dpp v78, v94, v30 row_newbcast:11 row_mask:0xf bank_mask:0xf
    v_fmac_f32_dpp v79, v94, v31 row_newbcast:11 row_mask:0xf bank_mask:0xf
    s_waitcnt vmcnt(4)
    v_cvt_f32_i32 v24, v4
    v_cvt_f32_i32 v25, v5
    v_cvt_f32_i32 v26, v6
    v_cvt_f32_i32 v27, v7
    s_add_u32 s71, s71, 3072
    buffer_load_dwordx4 v[4:7], v1, s[28:31], s71 offen offset:0 nt
    v_fmac_f32_dpp v80, v94, v24 row_newbcast:11 row_mask:0xf bank_mask:0xf
    v_fmac_f32_dpp v81, v94, v25 row_newbcast:11 row_mask:0xf bank_mask:0xf
    v_fmac_f32_dpp v82, v94, v26 row_newbcast:11 row_mask:0xf bank_mask:0xf
    v_fmac_f32_dpp v83, v94, v27 row_newbcast:11 row_mask:0xf bank_mask:0xf
    s_waitcnt vmcnt(4)
    v_cvt_f32_i32 v28, v8
    v_cvt_f32_i32 v29, v9
    v_cvt_f32_i32 v30, v10
    v_cvt_f32_i32 v31, v11
    buffer_load_dwordx4 v[8:11], v1, s[28:31], s71 offen offset:256 nt
    v_fmac_f32_dpp v84, v94, v28 row_newbcast:11 row_mask:0xf bank_mask:0xf
    v_fmac_f32_dpp v85, v94, v29 row_newbcast:11 row_mask:0xf bank_mask:0xf
    v_fmac_f32_dpp v86, v94, v30 row_newbcast:11 row_mask:0xf bank_mask:0xf
    v_fmac_f32_dpp v87, v94, v31 row_newbcast:11 row_mask:0xf bank_mask:0xf
    s_waitcnt vmcnt(4)
    v_cvt_f32_i32 v24, v12
    v_cvt_f32_i32 v25, v13
    v_cvt_f32_i32 v26, v14
    v_cvt_f32_i32 v27, v15
    buffer_load_dwordx4 v[12:15], v1, s[28:31], s71 offen offset:512 nt
    v_fmac_f32_dpp v76, v94, v24 row_newbcast:7 row_mask:0xf bank_mask:0xf
    v_fmac_f32_dpp v77, v94, v25 row_newbcast:7 row_mask:0xf bank_mask:0xf
    v_fmac_f32_dpp v78, v94, v26 row_newbcast:7 row_mask:0xf bank_mask:0xf
    v_fmac_f32_dpp v79, v94, v27 row_newbcast:7 row_mask:0xf bank_mask:0xf
    s_waitcnt vmcnt(4)
    v_cvt_f32_i32 v28, v16
    v_cvt_f32_i32 v29, v17
    v_cvt_f32_i32 v30, v18
    v_cvt_f32_i32 v31, v19
    s_add_u32 s70, s70, 64
    s_sub_u32 s75, s75, 1
    s_cmp_eq_u32 s75, 0
    s_cselect_b32 s80, 1536, 0
    s_cselect_b32 s75, 2, s75
    s_add_u32 s70, s70, s80
    s_lshl_b32 s73, s70, 7
    buffer_load_ushort v92, v3, s[40:43], s73 offen
    buffer_load_ushort v93, v3, s[44:47], s73 offen
    s_mul_i32 s71, s70, 49152
    buffer_load_dwordx4 v[16:19], v1, s[28:31], s71 offen offset:0 nt
    v_fmac_f32_dpp v80, v94, v28 row_newbcast:7 row_mask:0xf bank_mask:0xf
    v_fmac_f32_dpp v81, v94, v29 row_newbcast:7 row_mask:0xf bank_mask:0xf
    v_fmac_f32_dpp v82, v94, v30 row_newbcast:7 row_mask:0xf bank_mask:0xf
    v_fmac_f32_dpp v83, v94, v31 row_newbcast:7 row_mask:0xf bank_mask:0xf
    s_waitcnt vmcnt(6)
    v_cvt_f32_i32 v24, v20
    v_cvt_f32_i32 v25, v21
    v_cvt_f32_i32 v26, v22
    v_cvt_f32_i32 v27, v23
    buffer_load_dwordx4 v[20:23], v1, s[28:31], s71 offen offset:256 nt
    v_fmac_f32_dpp v84, v94, v24 row_newbcast:7 row_mask:0xf bank_mask:0xf
    v_fmac_f32_dpp v85, v94, v25 row_newbcast:7 row_mask:0xf bank_mask:0xf
    v_fmac_f32_dpp v86, v94, v26 row_newbcast:7 row_mask:0xf bank_mask:0xf
    v_fmac_f32_dpp v87, v94, v27 row_newbcast:7 row_mask:0xf bank_mask:0xf
    s_waitcnt vmcnt(6)
    v_cvt_f32_i32 v28, v4
    v_cvt_f32_i32 v29, v5
    v_cvt_f32_i32 v30, v6
    v_cvt_f32_i32 v31, v7
    buffer_load_dwordx4 v[4:7], v1, s[28:31], s71 offen offset:512 nt
    v_fmac_f32_dpp v76, v94, v28 row_newbcast:15 row_mask:0xf bank_mask:0xf
    v_fmac_f32_dpp v77, v94, v29 row_newbcast:15 row_mask:0xf bank_mask:0xf
    v_fmac_f32_dpp v78, v94, v30 row_newbcast:15 row_mask:0xf bank_mask:0xf
    v_fmac_f32_dpp v79, v94, v31 row_newbcast:15 row_mask:0xf bank_mask:0xf
    s_waitcnt vmcnt(6)
    v_cvt_f32_i32 v24, v8
    v_cvt_f32_i32 v25, v9
    v_cvt_f32_i32 v26, v10
    v_cvt_f32_i32 v27, v11
    s_add_u32 s71, s71, 3072
    buffer_load_dwordx4 v[8:11], v1, s[28:31], s71 offen offset:0 nt
    v_fmac_f32_dpp v80, v94, v24 row_newbcast:15 row_mask:0xf bank_mask:0xf
    v_fmac_f32_dpp v81, v94, v25 row_newbcast:15 row_mask:0xf bank_mask:0xf
    v_fmac_f32_dpp v82, v94, v26 row_newbcast:15 row_mask:0xf bank_mask:0xf
    v_fmac_f32_dpp v83, v94, v27 row_newbcast:15 row_mask:0xf bank_mask:0xf
    s_waitcnt vmcnt(6)
    v_cvt_f32_i32 v28, v12
    v_cvt_f32_i32 v29, v13
    v_cvt_f32_i32 v30, v14
    v_cvt_f32_i32 v31, v15
    buffer_load_dwordx4 v[12:15], v1, s[28:31], s71 offen offset:256 nt
    v_fmac_f32_dpp v84, v94, v28 row_newbcast:15 row_mask:0xf bank_mask:0xf
    v_fmac_f32_dpp v85, v94, v29 row_newbcast:15 row_mask:0xf bank_mask:0xf
    v_fmac_f32_dpp v86, v94, v30 row_newbcast:15 row_mask:0xf bank_mask:0xf
    v_fmac_f32_dpp v87, v94, v31 row_newbcast:15 row_mask:0xf bank_mask:0xf
    s_sub_u32 s77, s77, 1
    s_cmp_lg_u32 s77, 0
    s_cbranch_scc1 L_nofl10
    s_nop 0
    v_add_f32_dpp v90, v90, v90 row_ror:8 row_mask:0xf bank_mask:0xf
    v_add_f32_dpp v91, v91, v91 row_ror:8 row_mask:0xf bank_mask:0xf
    s_nop 0
    v_add_f32_dpp v90, v90, v90 row_ror:4 row_mask:0xf bank_mask:0xf
    v_add_f32_dpp v91, v91, v91 row_ror:4 row_mask:0xf bank_mask:0xf
    s_nop 0
    v_add_f32_dpp v90, v90, v90 row_ror:2 row_mask:0xf bank_mask:0xf
    v_add_f32_dpp v91, v91, v91 row_ror:2 row_mask:0xf bank_mask:0xf
    s_nop 0
    v_add_f32_dpp v90, v90, v90 row_ror:1 row_mask:0xf bank_mask:0xf
    v_add_f32_dpp v91, v91, v91 row_ror:1 row_mask:0xf bank_mask:0xf
    v_mov_b32 v102, v89
    v_mov_b32 v103, v89
    s_nop 1
    v_permlane32_swap_b32 v102, v103
    s_nop 1
    v_max_f32 v102, v102, v103
    v_mov_b32 v103, v102
    s_nop 1
    v_permlane16_swap_b32 v102, v103
    s_nop 1
    v_max_f32 v102, v102, v103
    v_sub_f32 v103, v89, v102
    v_exp_f32 v103, v103
    v_mov_b32 v89, v102
    v_mul_f32 v90, v90, v103
    v_mul_f32 v91, v91, v103
    v_fma_f32 v76, v76, v103, -v91
    v_fma_f32 v77, v77, v103, -v91
    v_fma_f32 v78, v78, v103, -v91
    v_fma_f32 v79, v79, v103, -v91
    v_fma_f32 v80, v80, v103, -v91
    v_fma_f32 v81, v81, v103, -v91
    v_fma_f32 v82, v82, v103, -v91
    v_fma_f32 v83, v83, v103, -v91
    v_fma_f32 v84, v84, v103, -v91
    v_fma_f32 v85, v85, v103, -v91
    v_fma_f32 v86, v86, v103, -v91
    v_fma_f32 v87, v87, v103, -v91
    v_mov_b32 v102, v90
    s_nop 1
    v_permlane32_swap_b32 v90, v102
    v_permlane32_swap_b32 v76, v78
    v_permlane32_swap_b32 v77, v79
    v_permlane32_swap_b32 v80, v82
    v_permlane32_swap_b32 v81, v83
    v_permlane32_swap_b32 v84, v86
    v_permlane32_swap_b32 v85, v87
    s_nop 1
    v_add_f32 v90, v90, v102
    v_add_f32 v76, v76, v78
    v_add_f32 v77, v77, v79
    v_add_f32 v80, v80, v82
    v_add_f32 v81, v81, v83
    v_add_f32 v84, v84, v86
    v_add_f32 v85, v85, v87
    v_mov_b32 v102, v90
    s_nop 1
    v_permlane16_swap_b32 v90, v102
    v_permlane16_swap_b32 v76, v77
    v_permlane16_swap_b32 v80, v81
    v_permlane16_swap_b32 v84, v85
    s_nop 1
    v_add_f32 v90, v90, v102
    v_add_f32 v76, v76, v77
    v_add_f32 v80, v80, v81
    v_add_f32 v84, v84, v85
    ds_write_b32 v106, v76 offset:16640
    ds_write_b32 v106, v80 offset:16896
    ds_write_b32 v106, v84 offset:17152
    ds_write_b32 v107, v89 offset:17408
    ds_write_b32 v107, v90 offset:17412
    s_waitcnt lgkmcnt(0)
    s_mov_b64 exec, 1
    ds_add_u32 v108, v109
    s_mov_b64 exec, -1
    v_add_u32 v106, 4096, v106
    v_add_u32 v107, 4096, v107
    v_add_u32 v108, 4, v108
    v_mov_b32 v89, 0xf149f2ca
    v_mov_b32 v90, 0
    v_mov_b32 v91, 0
    v_mov_b32 v76, 0
    v_mov_b32 v77, 0
    v_mov_b32 v78, 0
    v_mov_b32 v79, 0
    v_mov_b32 v80, 0
    v_mov_b32 v81, 0
    v_mov_b32 v82, 0
    v_mov_b32 v83, 0
    v_mov_b32 v84, 0
    v_mov_b32 v85, 0
    v_mov_b32 v86, 0
    v_mov_b32 v87, 0
    s_mov_b32 s77, 2
L_nofl10:
    s_sub_u32 s76, s76, 1
    s_cmp_lg_u32 s76, 0
    s_cbranch_scc1 L_loop1
    s_waitcnt vmcnt(5)
    v_lshlrev_b32 v92, 16, v92
    v_lshlrev_b32 v93, 16, v93
    s_waitcnt lgkmcnt(0)
    v_max_f32_dpp v102, v95, v95 row_ror:8 row_mask:0xf bank_mask:0xf
    s_nop 1
    v_max_f32_dpp v102, v102, v102 row_ror:4 row_mask:0xf bank_mask:0xf
    s_nop 1
    v_max_f32_dpp v102, v102, v102 row_ror:2 row_mask:0xf bank_mask:0xf
    s_nop 1
    v_max_f32_dpp v102, v102, v102 row_ror:1 row_mask:0xf bank_mask:0xf
    v_max_f32 v102, v102, v89
    v_sub_f32 v103, v89, v102
    v_sub_f32 v94, v95, v102
    v_exp_f32 v103, v103
    v_exp_f32 v94, v94
    v_mov_b32 v89, v102
    v_fma_f32 v90, v90, v103, v94
    v_mul_f32 v94, v94, v92
    v_mul_f32 v91, v91, v103
    v_fmac_f32 v91, v94, v93
    ds_read_b32 v95, v105
    v_add_u32 v105, 256, v105
    v_mul_f32 v76, v76, v103
    v_mul_f32 v77, v77, v103
    v_mul_f32 v78, v78, v103
    v_mul_f32 v79, v79, v103
    v_mul_f32 v80, v80, v103
    v_mul_f32 v81, v81, v103
    v_mul_f32 v82, v82, v103
    v_mul_f32 v83, v83, v103
    v_mul_f32 v84, v84, v103
    v_mul_f32 v85, v85, v103
    v_mul_f32 v86, v86, v103
    v_mul_f32 v87, v87, v103
    s_waitcnt vmcnt(4)
    v_cvt_f32_i32 v24, v16
    v_cvt_f32_i32 v25, v17
    v_cvt_f32_i32 v26, v18
    v_cvt_f32_i32 v27, v19
    buffer_load_dwordx4 v[16:19], v1, s[28:31], s71 offen offset:512 nt
    v_fmac_f32_dpp v76, v94, v24 row_newbcast:0 row_mask:0xf bank_mask:0xf
    v_fmac_f32_dpp v77, v94, v25 row_newbcast:0 row_mask:0xf bank_mask:0xf
    v_fmac_f32_dpp v78, v94, v26 row_newbcast:0 row_mask:0xf bank_mask:0xf
    v_fmac_f32_dpp v79, v94, v27 row_newbcast:0 row_mask:0xf bank_mask:0xf
    s_waitcnt vmcnt(4)
    v_cvt_f32_i32 v28, v20
    v_cvt_f32_i32 v29, v21
    v_cvt_f32_i32 v30, v22
    v_cvt_f32_i32 v31, v23
    s_add_u32 s71, s71, 3072
    buffer_load_dwordx4 v[20:23], v1, s[28:31], s71 offen offset:0 nt
    v_fmac_f32_dpp v80, v94, v28 row_newbcast:0 row_mask:0xf bank_mask:0xf
    v_fmac_f32_dpp v81, v94, v29 row_newbcast:0 row_mask:0xf bank_mask:0xf
    v_fmac_f32_dpp v82, v94, v30 row_newbcast:0 row_mask:0xf bank_mask:0xf
    v_fmac_f32_dpp v83, v94, v31 row_newbcast:0 row_mask:0xf bank_mask:0xf
    s_waitcnt vmcnt(4)
    v_cvt_f32_i32 v24, v4
    v_cvt_f32_i32 v25, v5
    v_cvt_f32_i32 v26, v6
    v_cvt_f32_i32 v27, v7
    buffer_load_dwordx4 v[4:7], v1, s[28:31], s71 offen offset:256 nt
    v_fmac_f32_dpp v84, v94, v24 row_newbcast:0 row_mask:0xf bank_mask:0xf
    v_fmac_f32_dpp v85, v94, v25 row_newbcast:0 row_mask:0xf bank_mask:0xf
    v_fmac_f32_dpp v86, v94, v26 row_newbcast:0 row_mask:0xf bank_mask:0xf
    v_fmac_f32_dpp v87, v94, v27 row_newbcast:0 row_mask:0xf bank_mask:0xf
    s_waitcnt vmcnt(4)
    v_cvt_f32_i32 v28, v8
    v_cvt_f32_i32 v29, v9
    v_cvt_f32_i32 v30, v10
    v_cvt_f32_i32 v31, v11
    buffer_load_dwordx4 v[8:11], v1, s[28:31], s71 offen offset:512 nt
    v_fmac_f32_dpp v76, v94, v28 row_newbcast:8 row_mask:0xf bank_mask:0xf
    v_fmac_f32_dpp v77, v94, v29 row_newbcast:8 row_mask:0xf bank_mask:0xf
    v_fmac_f32_dpp v78, v94, v30 row_newbcast:8 row_mask:0xf bank_mask:0xf
    v_fmac_f32_dpp v79, v94, v31 row_newbcast:8 row_mask:0xf bank_mask:0xf
    s_waitcnt vmcnt(4)
    v_cvt_f32_i32 v24, v12
    v_cvt_f32_i32 v25, v13
    v_cvt_f32_i32 v26, v14
    v_cvt_f32_i32 v27, v15
    s_add_u32 s71, s71, 3072
    buffer_load_dwordx4 v[12:15], v1, s[28:31], s71 offen offset:0 nt
    v_fmac_f32_dpp v80, v94, v24 row_newbcast:8 row_mask:0xf bank_mask:0xf
    v_fmac_f32_dpp v81, v94, v25 row_newbcast:8 row_mask:0xf bank_mask:0xf
    v_fmac_f32_dpp v82, v94, v26 row_newbcast:8 row_mask:0xf bank_mask:0xf
    v_fmac_f32_dpp v83, v94, v27 row_newbcast:8 row_mask:0xf bank_mask:0xf
    s_waitcnt vmcnt(4)
    v_cvt_f32_i32 v28, v16
    v_cvt_f32_i32 v29, v17
    v_cvt_f32_i32 v30, v18
    v_cvt_f32_i32 v31, v19
    buffer_load_dwordx4 v[16:19], v1, s[28:31], s71 offen offset:256 nt
    v_fmac_f32_dpp v84, v94, v28 row_newbcast:8 row_mask:0xf bank_mask:0xf
    v_fmac_f32_dpp v85, v94, v29 row_newbcast:8 row_mask:0xf bank_mask:0xf
    v_fmac_f32_dpp v86, v94, v30 row_newbcast:8 row_mask:0xf bank_mask:0xf
    v_fmac_f32_dpp v87, v94, v31 row_newbcast:8 row_mask:0xf bank_mask:0xf
    s_waitcnt vmcnt(4)
    v_cvt_f32_i32 v24, v20
    v_cvt_f32_i32 v25, v21
    v_cvt_f32_i32 v26, v22
    v_cvt_f32_i32 v27, v23
    buffer_load_dwordx4 v[20:23], v1, s[28:31], s71 offen offset:512 nt
    v_fmac_f32_dpp v76, v94, v24 row_newbcast:4 row_mask:0xf bank_mask:0xf
    v_fmac_f32_dpp v77, v94, v25 row_newbcast:4 row_mask:0xf bank_mask:0xf
    v_fmac_f32_dpp v78, v94, v26 row_newbcast:4 row_mask:0xf bank_mask:0xf
    v_fmac_f32_dpp v79, v94, v27 row_newbcast:4 row_mask:0xf bank_mask:0xf
    s_waitcnt vmcnt(4)
    v_cvt_f32_i32 v28, v4
    v_cvt_f32_i32 v29, v5
    v_cvt_f32_i32 v30, v6
    v_cvt_f32_i32 v31, v7
    s_add_u32 s70, s70, 64
    s_mul_i32 s71, s70, 49152
    buffer_load_dwordx4 v[4:7], v1, s[28:31], s71 offen offset:0 nt
    v_fmac_f32_dpp v80, v94, v28 row_newbcast:4 row_mask:0xf bank_mask:0xf
    v_fmac_f32_dpp v81, v94, v29 row_newbcast:4 row_mask:0xf bank_mask:0xf
    v_fmac_f32_dpp v82, v94, v30 row_newbcast:4 row_mask:0xf bank_mask:0xf
    v_fmac_f32_dpp v83, v94, v31 row_newbcast:4 row_mask:0xf bank_mask:0xf
    s_waitcnt vmcnt(4)
    v_cvt_f32_i32 v24, v8
    v_cvt_f32_i32 v25, v9
    v_cvt_f32_i32 v26, v10
    v_cvt_f32_i32 v27, v11
    buffer_load_dwordx4 v[8:11], v1, s[28:31], s71 offen offset:256 nt
    v_fmac_f32_dpp v84, v94, v24 row_newbcast:4 row_mask:0xf bank_mask:0xf
    v_fmac_f32_dpp v85, v94, v25 row_newbcast:4 row_mask:0xf bank_mask:0xf
    v_fmac_f32_dpp v86, v94, v26 row_newbcast:4 row_mask:0xf bank_mask:0xf
    v_fmac_f32_dpp v87, v94, v27 row_newbcast:4 row_mask:0xf bank_mask:0xf
    s_waitcnt vmcnt(4)
    v_cvt_f32_i32 v28, v12
    v_cvt_f32_i32 v29, v13
    v_cvt_f32_i32 v30, v14
    v_cvt_f32_i32 v31, v15
    buffer_load_dwordx4 v[12:15], v1, s[28:31], s71 offen offset:512 nt
    v_fmac_f32_dpp v76, v94, v28 row_newbcast:12 row_mask:0xf bank_mask:0xf
    v_fmac_f32_dpp v77, v94, v29 row_newbcast:12 row_mask:0xf bank_mask:0xf
    v_fmac_f32_dpp v78, v94, v30 row_newbcast:12 row_mask:0xf bank_mask:0xf
    v_fmac_f32_dpp v79, v94, v31 row_newbcast:12 row_mask:0xf bank_mask:0xf
    s_waitcnt vmcnt(4)
    v_cvt_f32_i32 v24, v16
    v_cvt_f32_i32 v25, v17
    v_cvt_f32_i32 v26, v18
    v_cvt_f32_i32 v27, v19
    s_add_u32 s71, s71, 3072
    buffer_load_dwordx4 v[16:19], v1, s[28:31], s71 offen offset:0 nt
    v_fmac_f32_dpp v80, v94, v24 row_newbcast:12 row_mask:0xf bank_mask:0xf
    v_fmac_f32_dpp v81, v94, v25 row_newbcast:12 row_mask:0xf bank_mask:0xf
    v_fmac_f32_dpp v82, v94, v26 row_newbcast:12 row_mask:0xf bank_mask:0xf
    v_fmac_f32_dpp v83, v94, v27 row_newbcast:12 row_mask:0xf bank_mask:0xf
    s_waitcnt vmcnt(4)
    v_cvt_f32_i32 v28, v20
    v_cvt_f32_i32 v29, v21
    v_cvt_f32_i32 v30, v22
    v_cvt_f32_i32 v31, v23
    buffer_load_dwordx4 v[20:23], v1, s[28:31], s71 offen offset:256 nt
    v_fmac_f32_dpp v84, v94, v28 row_newbcast:12 row_mask:0xf bank_mask:0xf
    v_fmac_f32_dpp v85, v94, v29 row_newbcast:12 row_mask:0xf bank_mask:0xf
    v_fmac_f32_dpp v86, v94, v30 row_newbcast:12 row_mask:0xf bank_mask:0xf
    v_fmac_f32_dpp v87, v94, v31 row_newbcast:12 row_mask:0xf bank_mask:0xf
    s_waitcnt vmcnt(4)
    v_cvt_f32_i32 v24, v4
    v_cvt_f32_i32 v25, v5
    v_cvt_f32_i32 v26, v6
    v_cvt_f32_i32 v27, v7
    buffer_load_dwordx4 v[4:7], v1, s[28:31], s71 offen offset:512 nt
    v_fmac_f32_dpp v76, v94, v24 row_newbcast:2 row_mask:0xf bank_mask:0xf
    v_fmac_f32_dpp v77, v94, v25 row_newbcast:2 row_mask:0xf bank_mask:0xf
    v_fmac_f32_dpp v78, v94, v26 row_newbcast:2 row_mask:0xf bank_mask:0xf
    v_fmac_f32_dpp v79, v94, v27 row_newbcast:2 row_mask:0xf bank_mask:0xf
    s_waitcnt vmcnt(4)
    v_cvt_f32_i32 v28, v8
    v_cvt_f32_i32 v29, v9
    v_cvt_f32_i32 v30, v10
    v_cvt_f32_i32 v31, v11
    s_add_u32 s71, s71, 3072
    buffer_load_dwordx4 v[8:11], v1, s[28:31], s71 offen offset:0 nt
    v_fmac_f32_dpp v80, v94, v28 row_newbcast:2 row_mask:0xf bank_mask:0xf
    v_fmac_f32_dpp v81, v94, v29 row_newbcast:2 row_mask:0xf bank_mask:0xf
    v_fmac_f32_dpp v82, v94, v30 row_newbcast:2 row_mask:0xf bank_mask:0xf
    v_fmac_f32_dpp v83, v94, v31 row_newbcast:2 row_mask:0xf bank_mask:0xf
    s_waitcnt vmcnt(4)
    v_cvt_f32_i32 v24, v12
    v_cvt_f32_i32 v25, v13
    v_cvt_f32_i32 v26, v14
    v_cvt_f32_i32 v27, v15
    buffer_load_dwordx4 v[12:15], v1, s[28:31], s71 offen offset:256 nt
    v_fmac_f32_dpp v84, v94, v24 row_newbcast:2 row_mask:0xf bank_mask:0xf
    v_fmac_f32_dpp v85, v94, v25 row_newbcast:2 row_mask:0xf bank_mask:0xf
    v_fmac_f32_dpp v86, v94, v26 row_newbcast:2 row_mask:0xf bank_mask:0xf
    v_fmac_f32_dpp v87, v94, v27 row_newbcast:2 row_mask:0xf bank_mask:0xf
    s_waitcnt vmcnt(4)
    v_cvt_f32_i32 v28, v16
    v_cvt_f32_i32 v29, v17
    v_cvt_f32_i32 v30, v18
    v_cvt_f32_i32 v31, v19
    buffer_load_dwordx4 v[16:19], v1, s[28:31], s71 offen offset:512 nt
    v_fmac_f32_dpp v76, v94, v28 row_newbcast:10 row_mask:0xf bank_mask:0xf
    v_fmac_f32_dpp v77, v94, v29 row_newbcast:10 row_mask:0xf bank_mask:0xf
    v_fmac_f32_dpp v78, v94, v30 row_newbcast:10 row_mask:0xf bank_mask:0xf
    v_fmac_f32_dpp v79, v94, v31 row_newbcast:10 row_mask:0xf bank_mask:0xf
    s_waitcnt vmcnt(4)
    v_cvt_f32_i32 v24, v20
    v_cvt_f32_i32 v25, v21
    v_cvt_f32_i32 v26, v22
    v_cvt_f32_i32 v27, v23
    s_add_u32 s71, s71, 3072
    buffer_load_dwordx4 v[20:23], v1, s[28:31], s71 offen offset:0 nt
    v_fmac_f32_dpp v80, v94, v24 row_newbcast:10 row_mask:0xf bank_mask:0xf
    v_fmac_f32_dpp v81, v94, v25 row_newbcast:10 row_mask:0xf bank_mask:0xf
    v_fmac_f32_dpp v82, v94, v26 row_newbcast:10 row_mask:0xf bank_mask:0xf
    v_fmac_f32_dpp v83, v94, v27 row_newbcast:10 row_mask:0xf bank_mask:0xf
    s_waitcnt vmcnt(4)
    v_cvt_f32_i32 v28, v4
    v_cvt_f32_i32 v29, v5
    v_cvt_f32_i32 v30, v6
    v_cvt_f32_i32 v31, v7
    buffer_load_dwordx4 v[4:7], v1, s[28:31], s71 offen offset:256 nt
    v_fmac_f32_dpp v84, v94, v28 row_newbcast:10 row_mask:0xf bank_mask:0xf
    v_fmac_f32_dpp v85, v94, v29 row_newbcast:10 row_mask:0xf bank_mask:0xf
    v_fmac_f32_dpp v86, v94, v30 row_newbcast:10 row_mask:0xf bank_mask:0xf
    v_fmac_f32_dpp v87, v94, v31 row_newbcast:10 row_mask:0xf bank_mask:0xf
    s_waitcnt vmcnt(4)
    v_cvt_f32_i32 v24, v8
    v_cvt_f32_i32 v25, v9
    v_cvt_f32_i32 v26, v10
    v_cvt_f32_i32 v27, v11
    buffer_load_dwordx4 v[8:11], v1, s[28:31], s71 offen offset:512 nt
    v_fmac_f32_dpp v76, v94, v24 row_newbcast:6 row_mask:0xf bank_mask:0xf
    v_fmac_f32_dpp v77, v94, v25 row_newbcast:6 row_mask:0xf bank_mask:0xf
    v_fmac_f32_dpp v78, v94, v26 row_newbcast:6 row_mask:0xf bank_mask:0xf
    v_fmac_f32_dpp v79, v94, v27 row_newbcast:6 row_mask:0xf bank_mask:0xf
    s_waitcnt vmcnt(4)
    v_cvt_f32_i32 v28, v12
    v_cvt_f32_i32 v29, v13
    v_cvt_f32_i32 v30, v14
    v_cvt_f32_i32 v31, v15
    s_add_u32 s70, s70, 64
    s_mul_i32 s71, s70, 49152
    buffer_load_dwordx4 v[12:15], v1, s[28:31], s71 offen offset:0 nt
    v_fmac_f32_dpp v80, v94, v28 row_newbcast:6 row_mask:0xf bank_mask:0xf
    v_fmac_f32_dpp v81, v94, v29 row_newbcast:6 row_mask:0xf bank_mask:0xf
    v_fmac_f32_dpp v82, v94, v30 row_newbcast:6 row_mask:0xf bank_mask:0xf
    v_fmac_f32_dpp v83, v94, v31 row_newbcast:6 row_mask:0xf bank_mask:0xf
    s_waitcnt vmcnt(4)
    v_cvt_f32_i32 v24, v16
    v_cvt_f32_i32 v25, v17
    v_cvt_f32_i32 v26, v18
    v_cvt_f32_i32 v27, v19
    buffer_load_dwordx4 v[16:19], v1, s[28:31], s71 offen offset:256 nt
    v_fmac_f32_dpp v84, v94, v24 row_newbcast:6 row_mask:0xf bank_mask:0xf
    v_fmac_f32_dpp v85, v94, v25 row_newbcast:6 row_mask:0xf bank_mask:0xf
    v_fmac_f32_dpp v86, v94, v26 row_newbcast:6 row_mask:0xf bank_mask:0xf
    v_fmac_f32_dpp v87, v94, v27 row_newbcast:6 row_mask:0xf bank_mask:0xf
    s_waitcnt vmcnt(4)
    v_cvt_f32_i32 v28, v20
    v_cvt_f32_i32 v29, v21
    v_cvt_f32_i32 v30, v22
    v_cvt_f32_i32 v31, v23
    buffer_load_dwordx4 v[20:23], v1, s[28:31], s71 offen offset:512 nt
    v_fmac_f32_dpp v76, v94, v28 row_newbcast:14 row_mask:0xf bank_mask:0xf
    v_fmac_f32_dpp v77, v94, v29 row_newbcast:14 row_mask:0xf bank_mask:0xf
    v_fmac_f32_dpp v78, v94, v30 row_newbcast:14 row_mask:0xf bank_mask:0xf
    v_fmac_f32_dpp v79, v94, v31 row_newbcast:14 row_mask:0xf bank_mask:0xf
    s_waitcnt vmcnt(4)
    v_cvt_f32_i32 v24, v4
    v_cvt_f32_i32 v25, v5
    v_cvt_f32_i32 v26, v6
    v_cvt_f32_i32 v27, v7
    s_add_u32 s71, s71, 3072
    buffer_load_dwordx4 v[4:7], v1, s[28:31], s71 offen offset:0 nt
    v_fmac_f32_dpp v80, v94, v24 row_newbcast:14 row_mask:0xf bank_mask:0xf
    v_fmac_f32_dpp v81, v94, v25 row_newbcast:14 row_mask:0xf bank_mask:0xf
    v_fmac_f32_dpp v82, v94, v26 row_newbcast:14 row_mask:0xf bank_mask:0xf
    v_fmac_f32_dpp v83, v94, v27 row_newbcast:14 row_mask:0xf bank_mask:0xf
    s_waitcnt vmcnt(4)
    v_cvt_f32_i32 v28, v8
    v_cvt_f32_i32 v29, v9
    v_cvt_f32_i32 v30, v10
    v_cvt_f32_i32 v31, v11
    buffer_load_dwordx4 v[8:11], v1, s[28:31], s71 offen offset:256 nt
    v_fmac_f32_dpp v84, v94, v28 row_newbcast:14 row_mask:0xf bank_mask:0xf
    v_fmac_f32_dpp v85, v94, v29 row_newbcast:14 row_mask:0xf bank_mask:0xf
    v_fmac_f32_dpp v86, v94, v30 row_newbcast:14 row_mask:0xf bank_mask:0xf
    v_fmac_f32_dpp v87, v94, v31 row_newbcast:14 row_mask:0xf bank_mask:0xf
    s_waitcnt vmcnt(4)
    v_cvt_f32_i32 v24, v12
    v_cvt_f32_i32 v25, v13
    v_cvt_f32_i32 v26, v14
    v_cvt_f32_i32 v27, v15
    buffer_load_dwordx4 v[12:15], v1, s[28:31], s71 offen offset:512 nt
    v_fmac_f32_dpp v76, v94, v24 row_newbcast:1 row_mask:0xf bank_mask:0xf
    v_fmac_f32_dpp v77, v94, v25 row_newbcast:1 row_mask:0xf bank_mask:0xf
    v_fmac_f32_dpp v78, v94, v26 row_newbcast:1 row_mask:0xf bank_mask:0xf
    v_fmac_f32_dpp v79, v94, v27 row_newbcast:1 row_mask:0xf bank_mask:0xf
    s_waitcnt vmcnt(4)
    v_cvt_f32_i32 v28, v16
    v_cvt_f32_i32 v29, v17
    v_cvt_f32_i32 v30, v18
    v_cvt_f32_i32 v31, v19
    s_add_u32 s71, s71, 3072
    buffer_load_dwordx4 v[16:19], v1, s[28:31], s71 offen offset:0 nt
    v_fmac_f32_dpp v80, v94, v28 row_newbcast:1 row_mask:0xf bank_mask:0xf
    v_fmac_f32_dpp v81, v94, v29 row_newbcast:1 row_mask:0xf bank_mask:0xf
    v_fmac_f32_dpp v82, v94, v30 row_newbcast:1 row_mask:0xf bank_mask:0xf
    v_fmac_f32_dpp v83, v94, v31 row_newbcast:1 row_mask:0xf bank_mask:0xf
    s_waitcnt vmcnt(4)
    v_cvt_f32_i32 v24, v20
    v_cvt_f32_i32 v25, v21
    v_cvt_f32_i32 v26, v22
    v_cvt_f32_i32 v27, v23
    buffer_load_dwordx4 v[20:23], v1, s[28:31], s71 offen offset:256 nt
    v_fmac_f32_dpp v84, v94, v24 row_newbcast:1 row_mask:0xf bank_mask:0xf
    v_fmac_f32_dpp v85, v94, v25 row_newbcast:1 row_mask:0xf bank_mask:0xf
    v_fmac_f32_dpp v86, v94, v26 row_newbcast:1 row_mask:0xf bank_mask:0xf
    v_fmac_f32_dpp v87, v94, v27 row_newbcast:1 row_mask:0xf bank_mask:0xf
    s_waitcnt vmcnt(4)
    v_cvt_f32_i32 v28, v4
    v_cvt_f32_i32 v29, v5
    v_cvt_f32_i32 v30, v6
    v_cvt_f32_i32 v31, v7
    buffer_load_dwordx4 v[4:7], v1, s[28:31], s71 offen offset:512 nt
    v_fmac_f32_dpp v76, v94, v28 row_newbcast:9 row_mask:0xf bank_mask:0xf
    v_fmac_f32_dpp v77, v94, v29 row_newbcast:9 row_mask:0xf bank_mask:0xf
    v_fmac_f32_dpp v78, v94, v30 row_newbcast:9 row_mask:0xf bank_mask:0xf
    v_fmac_f32_dpp v79, v94, v31 row_newbcast:9 row_mask:0xf bank_mask:0xf
    s_waitcnt vmcnt(4)
    v_cvt_f32_i32 v24, v8
    v_cvt_f32_i32 v25, v9
    v_cvt_f32_i32 v26, v10
    v_cvt_f32_i32 v27, v11
    s_add_u32 s71, s71, 3072
    buffer_load_dwordx4 v[8:11], v1, s[28:31], s71 offen offset:0 nt
    v_fmac_f32_dpp v80, v94, v24 row_newbcast:9 row_mask:0xf bank_mask:0xf
    v_fmac_f32_dpp v81, v94, v25 row_newbcast:9 row_mask:0xf bank_mask:0xf
    v_fmac_f32_dpp v82, v94, v26 row_newbcast:9 row_mask:0xf bank_mask:0xf
    v_fmac_f32_dpp v83, v94, v27 row_newbcast:9 row_mask:0xf bank_mask:0xf
    s_waitcnt vmcnt(4)
    v_cvt_f32_i32 v28, v12
    v_cvt_f32_i32 v29, v13
    v_cvt_f32_i32 v30, v14
    v_cvt_f32_i32 v31, v15
    buffer_load_dwordx4 v[12:15], v1, s[28:31], s71 offen offset:256 nt
    v_fmac_f32_dpp v84, v94, v28 row_newbcast:9 row_mask:0xf bank_mask:0xf
    v_fmac_f32_dpp v85, v94, v29 row_newbcast:9 row_mask:0xf bank_mask:0xf
    v_fmac_f32_dpp v86, v94, v30 row_newbcast:9 row_mask:0xf bank_mask:0xf
    v_fmac_f32_dpp v87, v94, v31 row_newbcast:9 row_mask:0xf bank_mask:0xf
    s_waitcnt vmcnt(4)
    v_cvt_f32_i32 v24, v16
    v_cvt_f32_i32 v25, v17
    v_cvt_f32_i32 v26, v18
    v_cvt_f32_i32 v27, v19
    buffer_load_dwordx4 v[16:19], v1, s[28:31], s71 offen offset:512 nt
    v_fmac_f32_dpp v76, v94, v24 row_newbcast:5 row_mask:0xf bank_mask:0xf
    v_fmac_f32_dpp v77, v94, v25 row_newbcast:5 row_mask:0xf bank_mask:0xf
    v_fmac_f32_dpp v78, v94, v26 row_newbcast:5 row_mask:0xf bank_mask:0xf
    v_fmac_f32_dpp v79, v94, v27 row_newbcast:5 row_mask:0xf bank_mask:0xf
    s_waitcnt vmcnt(4)
    v_cvt_f32_i32 v28, v20
    v_cvt_f32_i32 v29, v21
    v_cvt_f32_i32 v30, v22
    v_cvt_f32_i32 v31, v23
    s_add_u32 s70, s70, 64
    s_mul_i32 s71, s70, 49152
    buffer_load_dwordx4 v[20:23], v1, s[28:31], s71 offen offset:0 nt
    v_fmac_f32_dpp v80, v94, v28 row_newbcast:5 row_mask:0xf bank_mask:0xf
    v_fmac_f32_dpp v81, v94, v29 row_newbcast:5 row_mask:0xf bank_mask:0xf
    v_fmac_f32_dpp v82, v94, v30 row_newbcast:5 row_mask:0xf bank_mask:0xf
    v_fmac_f32_dpp v83, v94, v31 row_newbcast:5 row_mask:0xf bank_mask:0xf
    s_waitcnt vmcnt(4)
    v_cvt_f32_i32 v24, v4
    v_cvt_f32_i32 v25, v5
    v_cvt_f32_i32 v26, v6
    v_cvt_f32_i32 v27, v7
    buffer_load_dwordx4 v[4:7], v1, s[28:31], s71 offen offset:256 nt
    v_fmac_f32_dpp v84, v94, v24 row_newbcast:5 row_mask:0xf bank_mask:0xf
    v_fmac_f32_dpp v85, v94, v25 row_newbcast:5 row_mask:0xf bank_mask:0xf
    v_fmac_f32_dpp v86, v94, v26 row_newbcast:5 row_mask:0xf bank_mask:0xf
    v_fmac_f32_dpp v87, v94, v27 row_newbcast:5 row_mask:0xf bank_mask:0xf
    s_waitcnt vmcnt(4)
    v_cvt_f32_i32 v28, v8
    v_cvt_f32_i32 v29, v9
    v_cvt_f32_i32 v30, v10
    v_cvt_f32_i32 v31, v11
    buffer_load_dwordx4 v[8:11], v1, s[28:31], s71 offen offset:512 nt
    v_fmac_f32_dpp v76, v94, v28 row_newbcast:13 row_mask:0xf bank_mask:0xf
    v_fmac_f32_dpp v77, v94, v29 row_newbcast:13 row_mask:0xf bank_mask:0xf
    v_fmac_f32_dpp v78, v94, v30 row_newbcast:13 row_mask:0xf bank_mask:0xf
    v_fmac_f32_dpp v79, v94, v31 row_newbcast:13 row_mask:0xf bank_mask:0xf
    s_waitcnt vmcnt(4)
    v_cvt_f32_i32 v24, v12
    v_cvt_f32_i32 v25, v13
    v_cvt_f32_i32 v26, v14
    v_cvt_f32_i32 v27, v15
    s_add_u32 s71, s71, 3072
    buffer_load_dwordx4 v[12:15], v1, s[28:31], s71 offen offset:0 nt
    v_fmac_f32_dpp v80, v94, v24 row_newbcast:13 row_mask:0xf bank_mask:0xf
    v_fmac_f32_dpp v81, v94, v25 row_newbcast:13 row_mask:0xf bank_mask:0xf
    v_fmac_f32_dpp v82, v94, v26 row_newbcast:13 row_mask:0xf bank_mask:0xf
    v_fmac_f32_dpp v83, v94, v27 row_newbcast:13 row_mask:0xf bank_mask:0xf
    s_waitcnt vmcnt(4)
    v_cvt_f32_i32 v28, v16
    v_cvt_f32_i32 v29, v17
    v_cvt_f32_i32 v30, v18
    v_cvt_f32_i32 v31, v19
    buffer_load_dwordx4 v[16:19], v1, s[28:31], s71 offen offset:256 nt
    v_fmac_f32_dpp v84, v94, v28 row_newbcast:13 row_mask:0xf bank_mask:0xf
    v_fmac_f32_dpp v85, v94, v29 row_newbcast:13 row_mask:0xf bank_mask:0xf
    v_fmac_f32_dpp v86, v94, v30 row_newbcast:13 row_mask:0xf bank_mask:0xf
    v_fmac_f32_dpp v87, v94, v31 row_newbcast:13 row_mask:0xf bank_mask:0xf
    s_waitcnt vmcnt(4)
    v_cvt_f32_i32 v24, v20
    v_cvt_f32_i32 v25, v21
    v_cvt_f32_i32 v26, v22
    v_cvt_f32_i32 v27, v23
    buffer_load_dwordx4 v[20:23], v1, s[28:31], s71 offen offset:512 nt
    v_fmac_f32_dpp v76, v94, v24 row_newbcast:3 row_mask:0xf bank_mask:0xf
    v_fmac_f32_dpp v77, v94, v25 row_newbcast:3 row_mask:0xf bank_mask:0xf
    v_fmac_f32_dpp v78, v94, v26 row_newbcast:3 row_mask:0xf bank_mask:0xf
    v_fmac_f32_dpp v79, v94, v27 row_newbcast:3 row_mask:0xf bank_mask:0xf
    s_waitcnt vmcnt(4)
    v_cvt_f32_i32 v28, v4
    v_cvt_f32_i32 v29, v5
    v_cvt_f32_i32 v30, v6
    v_cvt_f32_i32 v31, v7
    s_add_u32 s71, s71, 3072
    buffer_load_dwordx4 v[4:7], v1, s[28:31], s71 offen offset:0 nt
    v_fmac_f32_dpp v80, v94, v28 row_newbcast:3 row_mask:0xf bank_mask:0xf
    v_fmac_f32_dpp v81, v94, v29 row_newbcast:3 row_mask:0xf bank_mask:0xf
    v_fmac_f32_dpp v82, v94, v30 row_newbcast:3 row_mask:0xf bank_mask:0xf
    v_fmac_f32_dpp v83, v94, v31 row_newbcast:3 row_mask:0xf bank_mask:0xf
    s_waitcnt vmcnt(4)
    v_cvt_f32_i32 v24, v8
    v_cvt_f32_i32 v25, v9
    v_cvt_f32_i32 v26, v10
    v_cvt_f32_i32 v27, v11
    buffer_load_dwordx4 v[8:11], v1, s[28:31], s71 offen offset:256 nt
    v_fmac_f32_dpp v84, v94, v24 row_newbcast:3 row_mask:0xf bank_mask:0xf
    v_fmac_f32_dpp v85, v94, v25 row_newbcast:3 row_mask:0xf bank_mask:0xf
    v_fmac_f32_dpp v86, v94, v26 row_newbcast:3 row_mask:0xf bank_mask:0xf
    v_fmac_f32_dpp v87, v94, v27 row_newbcast:3 row_mask:0xf bank_mask:0xf
    s_waitcnt vmcnt(4)
    v_cvt_f32_i32 v28, v12
    v_cvt_f32_i32 v29, v13
    v_cvt_f32_i32 v30, v14
    v_cvt_f32_i32 v31, v15
    buffer_load_dwordx4 v[12:15], v1, s[28:31], s71 offen offset:512 nt
    v_fmac_f32_dpp v76, v94, v28 row_newbcast:11 row_mask:0xf bank_mask:0xf
    v_fmac_f32_dpp v77, v94, v29 row_newbcast:11 row_mask:0xf bank_mask:0xf
    v_fmac_f32_dpp v78, v94, v30 row_newbcast:11 row_mask:0xf bank_mask:0xf
    v_fmac_f32_dpp v79, v94, v31 row_newbcast:11 row_mask:0xf bank_mask:0xf
    s_waitcnt vmcnt(4)
    v_cvt_f32_i32 v24, v16
    v_cvt_f32_i32 v25, v17
    v_cvt_f32_i32 v26, v18
    v_cvt_f32_i32 v27, v19
    s_add_u32 s71, s71, 3072
    buffer_load_dwordx4 v[16:19], v1, s[28:31], s71 offen offset:0 nt
    v_fmac_f32_dpp v80, v94, v24 row_newbcast:11 row_mask:0xf bank_mask:0xf
    v_fmac_f32_dpp v81, v94, v25 row_newbcast:11 row_mask:0xf bank_mask:0xf
    v_fmac_f32_dpp v82, v94, v26 row_newbcast:11 row_mask:0xf bank_mask:0xf
    v_fmac_f32_dpp v83, v94, v27 row_newbcast:11 row_mask:0xf bank_mask:0xf
    s_waitcnt vmcnt(4)
    v_cvt_f32_i32 v28, v20
    v_cvt_f32_i32 v29, v21
    v_cvt_f32_i32 v30, v22
    v_cvt_f32_i32 v31, v23
    buffer_load_dwordx4 v[20:23], v1, s[28:31], s71 offen offset:256 nt
    v_fmac_f32_dpp v84, v94, v28 row_newbcast:11 row_mask:0xf bank_mask:0xf
    v_fmac_f32_dpp v85, v94, v29 row_newbcast:11 row_mask:0xf bank_mask:0xf
    v_fmac_f32_dpp v86, v94, v30 row_newbcast:11 row_mask:0xf bank_mask:0xf
    v_fmac_f32_dpp v87, v94, v31 row_newbcast:11 row_mask:0xf bank_mask:0xf
    s_waitcnt vmcnt(4)
    v_cvt_f32_i32 v24, v4
    v_cvt_f32_i32 v25, v5
    v_cvt_f32_i32 v26, v6
    v_cvt_f32_i32 v27, v7
    buffer_load_dwordx4 v[4:7], v1, s[28:31], s71 offen offset:512 nt
    v_fmac_f32_dpp v76, v94, v24 row_newbcast:7 row_mask:0xf bank_mask:0xf
    v_fmac_f32_dpp v77, v94, v25 row_newbcast:7 row_mask:0xf bank_mask:0xf
    v_fmac_f32_dpp v78, v94, v26 row_newbcast:7 row_mask:0xf bank_mask:0xf
    v_fmac_f32_dpp v79, v94, v27 row_newbcast:7 row_mask:0xf bank_mask:0xf
    s_waitcnt vmcnt(4)
    v_cvt_f32_i32 v28, v8
    v_cvt_f32_i32 v29, v9
    v_cvt_f32_i32 v30, v10
    v_cvt_f32_i32 v31, v11
    v_fmac_f32_dpp v80, v94, v28 row_newbcast:7 row_mask:0xf bank_mask:0xf
    v_fmac_f32_dpp v81, v94, v29 row_newbcast:7 row_mask:0xf bank_mask:0xf
    v_fmac_f32_dpp v82, v94, v30 row_newbcast:7 row_mask:0xf bank_mask:0xf
    v_fmac_f32_dpp v83, v94, v31 row_newbcast:7 row_mask:0xf bank_mask:0xf
    s_waitcnt vmcnt(3)
    v_cvt_f32_i32 v24, v12
    v_cvt_f32_i32 v25, v13
    v_cvt_f32_i32 v26, v14
    v_cvt_f32_i32 v27, v15
    v_fmac_f32_dpp v84, v94, v24 row_newbcast:7 row_mask:0xf bank_mask:0xf
    v_fmac_f32_dpp v85, v94, v25 row_newbcast:7 row_mask:0xf bank_mask:0xf
    v_fmac_f32_dpp v86, v94, v26 row_newbcast:7 row_mask:0xf bank_mask:0xf
    v_fmac_f32_dpp v87, v94, v27 row_newbcast:7 row_mask:0xf bank_mask:0xf
    s_waitcnt vmcnt(2)
    v_cvt_f32_i32 v28, v16
    v_cvt_f32_i32 v29, v17
    v_cvt_f32_i32 v30, v18
    v_cvt_f32_i32 v31, v19
    v_fmac_f32_dpp v76, v94, v28 row_newbcast:15 row_mask:0xf bank_mask:0xf
    v_fmac_f32_dpp v77, v94, v29 row_newbcast:15 row_mask:0xf bank_mask:0xf
    v_fmac_f32_dpp v78, v94, v30 row_newbcast:15 row_mask:0xf bank_mask:0xf
    v_fmac_f32_dpp v79, v94, v31 row_newbcast:15 row_mask:0xf bank_mask:0xf
    s_waitcnt vmcnt(1)
    v_cvt_f32_i32 v24, v20
    v_cvt_f32_i32 v25, v21
    v_cvt_f32_i32 v26, v22
    v_cvt_f32_i32 v27, v23
    v_fmac_f32_dpp v80, v94, v24 row_newbcast:15 row_mask:0xf bank_mask:0xf
    v_fmac_f32_dpp v81, v94, v25 row_newbcast:15 row_mask:0xf bank_mask:0xf
    v_fmac_f32_dpp v82, v94, v26 row_newbcast:15 row_mask:0xf bank_mask:0xf
    v_fmac_f32_dpp v83, v94, v27 row_newbcast:15 row_mask:0xf bank_mask:0xf
    s_waitcnt vmcnt(0)
    v_cvt_f32_i32 v28, v4
    v_cvt_f32_i32 v29, v5
    v_cvt_f32_i32 v30, v6
    v_cvt_f32_i32 v31, v7
    v_fmac_f32_dpp v84, v94, v28 row_newbcast:15 row_mask:0xf bank_mask:0xf
    v_fmac_f32_dpp v85, v94, v29 row_newbcast:15 row_mask:0xf bank_mask:0xf
    v_fmac_f32_dpp v86, v94, v30 row_newbcast:15 row_mask:0xf bank_mask:0xf
    v_fmac_f32_dpp v87, v94, v31 row_newbcast:15 row_mask:0xf bank_mask:0xf
    s_sub_u32 s77, s77, 1
    s_cmp_lg_u32 s77, 0
    s_cbranch_scc1 L_nofl11
    s_nop 0
    v_add_f32_dpp v90, v90, v90 row_ror:8 row_mask:0xf bank_mask:0xf
    v_add_f32_dpp v91, v91, v91 row_ror:8 row_mask:0xf bank_mask:0xf
    s_nop 0
    v_add_f32_dpp v90, v90, v90 row_ror:4 row_mask:0xf bank_mask:0xf
    v_add_f32_dpp v91, v91, v91 row_ror:4 row_mask:0xf bank_mask:0xf
    s_nop 0
    v_add_f32_dpp v90, v90, v90 row_ror:2 row_mask:0xf bank_mask:0xf
    v_add_f32_dpp v91, v91, v91 row_ror:2 row_mask:0xf bank_mask:0xf
    s_nop 0
    v_add_f32_dpp v90, v90, v90 row_ror:1 row_mask:0xf bank_mask:0xf
    v_add_f32_dpp v91, v91, v91 row_ror:1 row_mask:0xf bank_mask:0xf
    v_mov_b32 v102, v89
    v_mov_b32 v103, v89
    s_nop 1
    v_permlane32_swap_b32 v102, v103
    s_nop 1
    v_max_f32 v102, v102, v103
    v_mov_b32 v103, v102
    s_nop 1
    v_permlane16_swap_b32 v102, v103
    s_nop 1
    v_max_f32 v102, v102, v103
    v_sub_f32 v103, v89, v102
    v_exp_f32 v103, v103
    v_mov_b32 v89, v102
    v_mul_f32 v90, v90, v103
    v_mul_f32 v91, v91, v103
    v_fma_f32 v76, v76, v103, -v91
    v_fma_f32 v77, v77, v103, -v91
    v_fma_f32 v78, v78, v103, -v91
    v_fma_f32 v79, v79, v103, -v91
    v_fma_f32 v80, v80, v103, -v91
    v_fma_f32 v81, v81, v103, -v91
    v_fma_f32 v82, v82, v103, -v91
    v_fma_f32 v83, v83, v103, -v91
    v_fma_f32 v84, v84, v103, -v91
    v_fma_f32 v85, v85, v103, -v91
    v_fma_f32 v86, v86, v103, -v91
    v_fma_f32 v87, v87, v103, -v91
    v_mov_b32 v102, v90
    s_nop 1
    v_permlane32_swap_b32 v90, v102
    v_permlane32_swap_b32 v76, v78
    v_permlane32_swap_b32 v77, v79
    v_permlane32_swap_b32 v80, v82
    v_permlane32_swap_b32 v81, v83
    v_permlane32_swap_b32 v84, v86
    v_permlane32_swap_b32 v85, v87
    s_nop 1
    v_add_f32 v90, v90, v102
    v_add_f32 v76, v76, v78
    v_add_f32 v77, v77, v79
    v_add_f32 v80, v80, v82
    v_add_f32 v81, v81, v83
    v_add_f32 v84, v84, v86
    v_add_f32 v85, v85, v87
    v_mov_b32 v102, v90
    s_nop 1
    v_permlane16_swap_b32 v90, v102
    v_permlane16_swap_b32 v76, v77
    v_permlane16_swap_b32 v80, v81
    v_permlane16_swap_b32 v84, v85
    s_nop 1
    v_add_f32 v90, v90, v102
    v_add_f32 v76, v76, v77
    v_add_f32 v80, v80, v81
    v_add_f32 v84, v84, v85
    ds_write_b32 v106, v76 offset:16640
    ds_write_b32 v106, v80 offset:16896
    ds_write_b32 v106, v84 offset:17152
    ds_write_b32 v107, v89 offset:17408
    ds_write_b32 v107, v90 offset:17412
    s_waitcnt lgkmcnt(0)
    s_mov_b64 exec, 1
    ds_add_u32 v108, v109
    s_mov_b64 exec, -1
    v_add_u32 v106, 4096, v106
    v_add_u32 v107, 4096, v107
    v_add_u32 v108, 4, v108
    v_mov_b32 v89, 0xf149f2ca
    v_mov_b32 v90, 0
    v_mov_b32 v91, 0
    v_mov_b32 v76, 0
    v_mov_b32 v77, 0
    v_mov_b32 v78, 0
    v_mov_b32 v79, 0
    v_mov_b32 v80, 0
    v_mov_b32 v81, 0
    v_mov_b32 v82, 0
    v_mov_b32 v83, 0
    v_mov_b32 v84, 0
    v_mov_b32 v85, 0
    v_mov_b32 v86, 0
    v_mov_b32 v87, 0
    s_mov_b32 s77, 2
L_nofl11:
    s_endpgm
L_service:
    v_lshlrev_b32 v6, 2, v0
    v_mov_b32 v3, 0
    ds_write_b32 v6, v3 offset:16384
    v_lshlrev_b32 v2, 4, v0
    v_mul_u32_u24 v1, 12, v0
    v_mov_b32 v4, 0
    v_mov_b32 v5, 16384
    v_lshlrev_b32 v11, 11, v0
    s_memrealtime s[80:81]
    s_lshr_b32 s70, s92, 3
    s_add_u32 s82, s70, s79
    s_xor_b32 s82, s82, s92
    s_and_b32 s82, s82, 7
    s_cmp_eq_u32 s82, 0
    s_cselect_b32 s70, s70, -2
    s_add_u32 s70, s70, 1
    s_mov_b32 s71, 0
    s_waitcnt lgkmcnt(0)
    s_barrier
    s_mov_b32 s52, s22
    s_and_b32 s53, s23, 0xffff
    s_mov_b32 s54, 4194304
    s_mov_b32 s55, 0x00020000
    s_mov_b32 s56, s18
    s_and_b32 s57, s19, 0xffff
    s_mov_b32 s58, 12288
    s_mov_b32 s59, 0x00020000
    s_mov_b32 s60, s20
    s_and_b32 s61, s21, 0xffff
    s_mov_b32 s62, 256
    s_mov_b32 s63, 0x00020000
    s_max_u32 s69, s80, 1
    s_cmp_lg_u32 s2, 0
    s_cbranch_scc1 L_gettag
    v_mov_b32 v6, s69
    s_mov_b64 exec, 1
    buffer_store_dword v6, v3, s[60:63], 0 offen sc0 sc1
    s_mov_b64 exec, -1
    s_branch L_poll
L_gettag:
    ds_read_b32 v6, v5
    s_waitcnt lgkmcnt(0)
    v_readfirstlane_b32 s80, v6
    s_cmp_eq_u32 s80, 0
    s_cbranch_scc1 L_gettag
L_gettag2:
    buffer_load_dword v6, v3, s[60:63], 0 offen sc0 sc1
    s_waitcnt vmcnt(0)
    v_readfirstlane_b32 s69, v6
    s_cmp_eq_u32 s69, 0
    s_cbranch_scc1 L_gettag2
L_poll:
    ds_read_b32 v6, v5
    s_waitcnt lgkmcnt(0)
    v_readfirstlane_b32 s80, v6
    s_cmp_lg_u32 s80, 4
    s_cbranch_scc1 L_poll
    ds_read_b64 v[20:21], v4 offset:17408
    ds_read_b64 v[22:23], v4 offset:18432
    ds_read_b64 v[24:25], v4 offset:19456
    ds_read_b64 v[26:27], v4 offset:20480
    ds_read_b32 v28, v1 offset:16640
    ds_read_b32 v29, v1 offset:16644
    ds_read_b32 v30, v1 offset:16648
    ds_read_b32 v32, v1 offset:17664
    ds_read_b32 v33, v1 offset:17668
    ds_read_b32 v34, v1 offset:17672
    ds_read_b32 v36, v1 offset:18688
    ds_read_b32 v37, v1 offset:18692
    ds_read_b32 v38, v1 offset:18696
    ds_read_b32 v40, v1 offset:19712
    ds_read_b32 v41, v1 offset:19716
    ds_read_b32 v42, v1 offset:19720
    s_lshl_b32 s80, s79, 6
    s_add_u32 s80, s80, s92
    s_lshl_b32 s80, s80, 11
    v_mov_b32 v15, s69
    v_mov_b32 v18, s69
    v_mov_b32 v19, s69
    s_waitcnt lgkmcnt(0)
    v_mov_b32 v16, v20
    v_max_f32 v16, v16, v22
    v_max_f32 v16, v16, v24
    v_max_f32 v16, v16, v26
    v_sub_f32 v20, v20, v16
    v_sub_f32 v22, v22, v16
    v_sub_f32 v24, v24, v16
    v_sub_f32 v26, v26, v16
    v_exp_f32 v20, v20
    v_exp_f32 v22, v22
    v_exp_f32 v24, v24
    v_exp_f32 v26, v26
    s_nop 0
    v_mul_f32 v17, v20, v21
    v_mul_f32 v12, v20, v28
    v_mul_f32 v13, v20, v29
    v_mul_f32 v14, v20, v30
    v_fmac_f32 v17, v22, v23
    v_fmac_f32 v12, v22, v32
    v_fmac_f32 v13, v22, v33
    v_fmac_f32 v14, v22, v34
    v_fmac_f32 v17, v24, v25
    v_fmac_f32 v12, v24, v36
    v_fmac_f32 v13, v24, v37
    v_fmac_f32 v14, v24, v38
    v_fmac_f32 v17, v26, v27
    v_fmac_f32 v12, v26, v40
    v_fmac_f32 v13, v26, v41
    v_fmac_f32 v14, v26, v42
    buffer_store_dwordx4 v[12:15], v2, s[52:55], s80 offen sc0 sc1
    s_mov_b64 exec, 1
    buffer_store_dwordx4 v[16:19], v3, s[52:55], s80 offen offset:1024 sc0 sc1
    s_mov_b64 exec, -1
    v_add_u32 v1, 4096, v1
    v_add_u32 v4, 4096, v4
    v_add_u32 v5, 4, v5
L_chk:
    s_cmp_lg_u32 s71, s70
    s_cbranch_scc1 L_next
L_comb:
    s_sub_u32 s82, s79, 4
    s_lshl_b32 s80, s82, 17
    s_mov_b32 s81, s80
    buffer_load_dwordx4 v[20:23], v11, s[52:55], s81 offen offset:1024 sc0 sc1
    s_mov_b64 exec, -1
    s_waitcnt vmcnt(0)
    v_xor_b32 v10, s69, v22
    v_cmp_ne_u32 vcc, 0, v10
    s_cmp_lg_u64 vcc, 0
    s_cbranch_scc1 L_comb
    buffer_load_dwordx4 v[28:31], v2, s[52:55], s80 offen offset:0 sc0 sc1
    buffer_load_dwordx4 v[32:35], v2, s[52:55], s80 offen offset:2048 sc0 sc1
    s_add_u32 s80, s80, 4096
    buffer_load_dwordx4 v[36:39], v2, s[52:55], s80 offen offset:0 sc0 sc1
    buffer_load_dwordx4 v[40:43], v2, s[52:55], s80 offen offset:2048 sc0 sc1
    s_add_u32 s80, s80, 4096
    buffer_load_dwordx4 v[44:47], v2, s[52:55], s80 offen offset:0 sc0 sc1
    buffer_load_dwordx4 v[48:51], v2, s[52:55], s80 offen offset:2048 sc0 sc1
    s_add_u32 s80, s80, 4096
    buffer_load_dwordx4 v[52:55], v2, s[52:55], s80 offen offset:0 sc0 sc1
    buffer_load_dwordx4 v[56:59], v2, s[52:55], s80 offen offset:2048 sc0 sc1
    s_add_u32 s80, s80, 4096
    buffer_load_dwordx4 v[60:63], v2, s[52:55], s80 offen offset:0 sc0 sc1
    buffer_load_dwordx4 v[64:67], v2, s[52:55], s80 offen offset:2048 sc0 sc1
    s_add_u32 s80, s80, 4096
    buffer_load_dwordx4 v[68:71], v2, s[52:55], s80 offen offset:0 sc0 sc1
    buffer_load_dwordx4 v[72:75], v2, s[52:55], s80 offen offset:2048 sc0 sc1
    s_add_u32 s80, s80, 4096
    buffer_load_dwordx4 v[76:79], v2, s[52:55], s80 offen offset:0 sc0 sc1
    buffer_load_dwordx4 v[80:83], v2, s[52:55], s80 offen offset:2048 sc0 sc1
    s_add_u32 s80, s80, 4096
    buffer_load_dwordx4 v[84:87], v2, s[52:55], s80 offen offset:0 sc0 sc1
    buffer_load_dwordx4 v[88:91], v2, s[52:55], s80 offen offset:2048 sc0 sc1
    s_add_u32 s80, s80, 4096
    buffer_load_dwordx4 v[92:95], v2, s[52:55], s80 offen offset:0 sc0 sc1
    buffer_load_dwordx4 v[96:99], v2, s[52:55], s80 offen offset:2048 sc0 sc1
    s_add_u32 s80, s80, 4096
    buffer_load_dwordx4 v[100:103], v2, s[52:55], s80 offen offset:0 sc0 sc1
    buffer_load_dwordx4 v[104:107], v2, s[52:55], s80 offen offset:2048 sc0 sc1
    s_add_u32 s80, s80, 4096
    buffer_load_dwordx4 v[108:111], v2, s[52:55], s80 offen offset:0 sc0 sc1
    buffer_load_dwordx4 v[112:115], v2, s[52:55], s80 offen offset:2048 sc0 sc1
    s_add_u32 s80, s80, 4096
    buffer_load_dwordx4 v[116:119], v2, s[52:55], s80 offen offset:0 sc0 sc1
    buffer_load_dwordx4 v[120:123], v2, s[52:55], s80 offen offset:2048 sc0 sc1
    s_add_u32 s80, s80, 4096
    buffer_load_dwordx4 v[124:127], v2, s[52:55], s80 offen offset:0 sc0 sc1
    buffer_load_dwordx4 v[128:131], v2, s[52:55], s80 offen offset:2048 sc0 sc1
    s_add_u32 s80, s80, 4096
    buffer_load_dwordx4 v[132:135], v2, s[52:55], s80 offen offset:0 sc0 sc1
    buffer_load_dwordx4 v[136:139], v2, s[52:55], s80 offen offset:2048 sc0 sc1
    s_add_u32 s80, s80, 4096
    buffer_load_dwordx4 v[140:143], v2, s[52:55], s80 offen offset:0 sc0 sc1
    buffer_load_dwordx4 v[144:147], v2, s[52:55], s80 offen offset:2048 sc0 sc1
    s_add_u32 s80, s80, 4096
    buffer_load_dwordx4 v[148:151], v2, s[52:55], s80 offen offset:0 sc0 sc1
    buffer_load_dwordx4 v[152:155], v2, s[52:55], s80 offen offset:2048 sc0 sc1
    v_mov_b32 v8, v20
    s_nop 1
    v_max_f32_dpp v8, v8, v8 row_ror:8 row_mask:0xf bank_mask:0xf
    s_nop 1
    v_max_f32_dpp v8, v8, v8 row_ror:4 row_mask:0xf bank_mask:0xf
    s_nop 1
    v_max_f32_dpp v8, v8, v8 row_ror:2 row_mask:0xf bank_mask:0xf
    s_nop 1
    v_max_f32_dpp v8, v8, v8 row_ror:1 row_mask:0xf bank_mask:0xf
    v_mov_b32 v6, v8
    s_nop 1
    v_permlane32_swap_b32 v8, v6
    s_nop 1
    v_max_f32 v8, v8, v6
    v_mov_b32 v6, v8
    s_nop 1
    v_permlane16_swap_b32 v8, v6
    s_nop 1
    v_max_f32 v8, v8, v6
    v_sub_f32 v20, v20, v8
    v_exp_f32 v20, v20
    s_nop 0
    v_mul_f32 v9, v20, v21
    s_nop 1
    v_add_f32_dpp v9, v9, v9 row_ror:8 row_mask:0xf bank_mask:0xf
    s_nop 1
    v_add_f32_dpp v9, v9, v9 row_ror:4 row_mask:0xf bank_mask:0xf
    s_nop 1
    v_add_f32_dpp v9, v9, v9 row_ror:2 row_mask:0xf bank_mask:0xf
    s_nop 1
    v_add_f32_dpp v9, v9, v9 row_ror:1 row_mask:0xf bank_mask:0xf
    v_mov_b32 v6, v9
    s_nop 1
    v_permlane32_swap_b32 v9, v6
    s_nop 1
    v_add_f32 v9, v9, v6
    v_mov_b32 v6, v9
    s_nop 1
    v_permlane16_swap_b32 v9, v6
    s_nop 1
    v_add_f32 v9, v9, v6
    v_mov_b32 v12, 0
    v_mov_b32 v13, 0
    v_mov_b32 v14, 0
    v_rcp_f32 v9, v9
    v_readlane_b32 s84, v20, 0
    v_readlane_b32 s85, v20, 1
    v_readlane_b32 s86, v20, 2
    v_readlane_b32 s87, v20, 3
    v_readlane_b32 s88, v20, 4
    v_readlane_b32 s89, v20, 5
    v_readlane_b32 s90, v20, 6
    v_readlane_b32 s91, v20, 7
    s_waitcnt vmcnt(24)
    v_xor_b32 v6, s69, v31
    v_fmac_f32 v12, s84, v28
    v_fmac_f32 v13, s84, v29
    v_fmac_f32 v14, s84, v30
    v_or_b32 v10, v10, v6
    v_xor_b32 v6, s69, v35
    v_fmac_f32 v12, s85, v32
    v_fmac_f32 v13, s85, v33
    v_fmac_f32 v14, s85, v34
    v_or_b32 v10, v10, v6
    v_xor_b32 v6, s69, v39
    v_fmac_f32 v12, s86, v36
    v_fmac_f32 v13, s86, v37
    v_fmac_f32 v14, s86, v38
    v_or_b32 v10, v10, v6
    v_xor_b32 v6, s69, v43
    v_fmac_f32 v12, s87, v40
    v_fmac_f32 v13, s87, v41
    v_fmac_f32 v14, s87, v42
    v_or_b32 v10, v10, v6
    v_xor_b32 v6, s69, v47
    v_fmac_f32 v12, s88, v44
    v_fmac_f32 v13, s88, v45
    v_fmac_f32 v14, s88, v46
    v_or_b32 v10, v10, v6
    v_xor_b32 v6, s69, v51
    v_fmac_f32 v12, s89, v48
    v_fmac_f32 v13, s89, v49
    v_fmac_f32 v14, s89, v50
    v_or_b32 v10, v10, v6
    v_xor_b32 v6, s69, v55
    v_fmac_f32 v12, s90, v52
    v_fmac_f32 v13, s90, v53
    v_fmac_f32 v14, s90, v54
    v_or_b32 v10, v10, v6
    v_xor_b32 v6, s69, v59
    v_fmac_f32 v12, s91, v56
    v_fmac_f32 v13, s91, v57
    v_fmac_f32 v14, s91, v58
    v_or_b32 v10, v10, v6
    s_add_u32 s80, s80, 4096
    buffer_load_dwordx4 v[28:31], v2, s[52:55], s80 offen offset:0 sc0 sc1
    buffer_load_dwordx4 v[32:35], v2, s[52:55], s80 offen offset:2048 sc0 sc1
    s_add_u32 s80, s80, 4096
    buffer_load_dwordx4 v[36:39], v2, s[52:55], s80 offen offset:0 sc0 sc1
    buffer_load_dwordx4 v[40:43], v2, s[52:55], s80 offen offset:2048 sc0 sc1
    s_add_u32 s80, s80, 4096
    buffer_load_dwordx4 v[44:47], v2, s[52:55], s80 offen offset:0 sc0 sc1
    buffer_load_dwordx4 v[48:51], v2, s[52:55], s80 offen offset:2048 sc0 sc1
    s_add_u32 s80, s80, 4096
    buffer_load_dwordx4 v[52:55], v2, s[52:55], s80 offen offset:0 sc0 sc1
    buffer_load_dwordx4 v[56:59], v2, s[52:55], s80 offen offset:2048 sc0 sc1
    v_readlane_b32 s84, v20, 8
    v_readlane_b32 s85, v20, 9
    v_readlane_b32 s86, v20, 10
    v_readlane_b32 s87, v20, 11
    v_readlane_b32 s88, v20, 12
    v_readlane_b32 s89, v20, 13
    v_readlane_b32 s90, v20, 14
    v_readlane_b32 s91, v20, 15
    s_waitcnt vmcnt(24)
    v_xor_b32 v6, s69, v63
    v_fmac_f32 v12, s84, v60
    v_fmac_f32 v13, s84, v61
    v_fmac_f32 v14, s84, v62
    v_or_b32 v10, v10, v6
    v_xor_b32 v6, s69, v67
    v_fmac_f32 v12, s85, v64
    v_fmac_f32 v13, s85, v65
    v_fmac_f32 v14, s85, v66
    v_or_b32 v10, v10, v6
    v_xor_b32 v6, s69, v71
    v_fmac_f32 v12, s86, v68
    v_fmac_f32 v13, s86, v69
    v_fmac_f32 v14, s86, v70
    v_or_b32 v10, v10, v6
    v_xor_b32 v6, s69, v75
    v_fmac_f32 v12, s87, v72
    v_fmac_f32 v13, s87, v73
    v_fmac_f32 v14, s87, v74
    v_or_b32 v10, v10, v6
    v_xor_b32 v6, s69, v79
    v_fmac_f32 v12, s88, v76
    v_fmac_f32 v13, s88, v77
    v_fmac_f32 v14, s88, v78
    v_or_b32 v10, v10, v6
    v_xor_b32 v6, s69, v83
    v_fmac_f32 v12, s89, v80
    v_fmac_f32 v13, s89, v81
    v_fmac_f32 v14, s89, v82
    v_or_b32 v10, v10, v6
    v_xor_b32 v6, s69, v87
    v_fmac_f32 v12, s90, v84
    v_fmac_f32 v13, s90, v85
    v_fmac_f32 v14, s90, v86
    v_or_b32 v10, v10, v6
    v_xor_b32 v6, s69, v91
    v_fmac_f32 v12, s91, v88
    v_fmac_f32 v13, s91, v89
    v_fmac_f32 v14, s91, v90
    v_or_b32 v10, v10, v6
    s_add_u32 s80, s80, 4096
    buffer_load_dwordx4 v[60:63], v2, s[52:55], s80 offen offset:0 sc0 sc1
    buffer_load_dwordx4 v[64:67], v2, s[52:55], s80 offen offset:2048 sc0 sc1
    s_add_u32 s80, s80, 4096
    buffer_load_dwordx4 v[68:71], v2, s[52:55], s80 offen offset:0 sc0 sc1
    buffer_load_dwordx4 v[72:75], v2, s[52:55], s80 offen offset:2048 sc0 sc1
    s_add_u32 s80, s80, 4096
    buffer_load_dwordx4 v[76:79], v2, s[52:55], s80 offen offset:0 sc0 sc1
    buffer_load_dwordx4 v[80:83], v2, s[52:55], s80 offen offset:2048 sc0 sc1
    s_add_u32 s80, s80, 4096
    buffer_load_dwordx4 v[84:87], v2, s[52:55], s80 offen offset:0 sc0 sc1
    buffer_load_dwordx4 v[88:91], v2, s[52:55], s80 offen offset:2048 sc0 sc1
    v_readlane_b32 s84, v20, 16
    v_readlane_b32 s85, v20, 17
    v_readlane_b32 s86, v20, 18
    v_readlane_b32 s87, v20, 19
    v_readlane_b32 s88, v20, 20
    v_readlane_b32 s89, v20, 21
    v_readlane_b32 s90, v20, 22
    v_readlane_b32 s91, v20, 23
    s_waitcnt vmcnt(24)
    v_xor_b32 v6, s69, v95
    v_fmac_f32 v12, s84, v92
    v_fmac_f32 v13, s84, v93
    v_fmac_f32 v14, s84, v94
    v_or_b32 v10, v10, v6
    v_xor_b32 v6, s69, v99
    v_fmac_f32 v12, s85, v96
    v_fmac_f32 v13, s85, v97
    v_fmac_f32 v14, s85, v98
    v_or_b32 v10, v10, v6
    v_xor_b32 v6, s69, v103
    v_fmac_f32 v12, s86, v100
    v_fmac_f32 v13, s86, v101
    v_fmac_f32 v14, s86, v102
    v_or_b32 v10, v10, v6
    v_xor_b32 v6, s69, v107
    v_fmac_f32 v12, s87, v104
    v_fmac_f32 v13, s87, v105
    v_fmac_f32 v14, s87, v106
    v_or_b32 v10, v10, v6
    v_xor_b32 v6, s69, v111
    v_fmac_f32 v12, s88, v108
    v_fmac_f32 v13, s88, v109
    v_fmac_f32 v14, s88, v110
    v_or_b32 v10, v10, v6
    v_xor_b32 v6, s69, v115
    v_fmac_f32 v12, s89, v112
    v_fmac_f32 v13, s89, v113
    v_fmac_f32 v14, s89, v114
    v_or_b32 v10, v10, v6
    v_xor_b32 v6, s69, v119
    v_fmac_f32 v12, s90, v116
    v_fmac_f32 v13, s90, v117
    v_fmac_f32 v14, s90, v118
    v_or_b32 v10, v10, v6
    v_xor_b32 v6, s69, v123
    v_fmac_f32 v12, s91, v120
    v_fmac_f32 v13, s91, v121
    v_fmac_f32 v14, s91, v122
    v_or_b32 v10, v10, v6
    s_add_u32 s80, s80, 4096
    buffer_load_dwordx4 v[92:95], v2, s[52:55], s80 offen offset:0 sc0 sc1
    buffer_load_dwordx4 v[96:99], v2, s[52:55], s80 offen offset:2048 sc0 sc1
    s_add_u32 s80, s80, 4096
    buffer_load_dwordx4 v[100:103], v2, s[52:55], s80 offen offset:0 sc0 sc1
    buffer_load_dwordx4 v[104:107], v2, s[52:55], s80 offen offset:2048 sc0 sc1
    s_add_u32 s80, s80, 4096
    buffer_load_dwordx4 v[108:111], v2, s[52:55], s80 offen offset:0 sc0 sc1
    buffer_load_dwordx4 v[112:115], v2, s[52:55], s80 offen offset:2048 sc0 sc1
    s_add_u32 s80, s80, 4096
    buffer_load_dwordx4 v[116:119], v2, s[52:55], s80 offen offset:0 sc0 sc1
    buffer_load_dwordx4 v[120:123], v2, s[52:55], s80 offen offset:2048 sc0 sc1
    v_readlane_b32 s84, v20, 24
    v_readlane_b32 s85, v20, 25
    v_readlane_b32 s86, v20, 26
    v_readlane_b32 s87, v20, 27
    v_readlane_b32 s88, v20, 28
    v_readlane_b32 s89, v20, 29
    v_readlane_b32 s90, v20, 30
    v_readlane_b32 s91, v20, 31
    s_waitcnt vmcnt(24)
    v_xor_b32 v6, s69, v127
    v_fmac_f32 v12, s84, v124
    v_fmac_f32 v13, s84, v125
    v_fmac_f32 v14, s84, v126
    v_or_b32 v10, v10, v6
    v_xor_b32 v6, s69, v131
    v_fmac_f32 v12, s85, v128
    v_fmac_f32 v13, s85, v129
    v_fmac_f32 v14, s85, v130
    v_or_b32 v10, v10, v6
    v_xor_b32 v6, s69, v135
    v_fmac_f32 v12, s86, v132
    v_fmac_f32 v13, s86, v133
    v_fmac_f32 v14, s86, v134
    v_or_b32 v10, v10, v6
    v_xor_b32 v6, s69, v139
    v_fmac_f32 v12, s87, v136
    v_fmac_f32 v13, s87, v137
    v_fmac_f32 v14, s87, v138
    v_or_b32 v10, v10, v6
    v_xor_b32 v6, s69, v143
    v_fmac_f32 v12, s88, v140
    v_fmac_f32 v13, s88, v141
    v_fmac_f32 v14, s88, v142
    v_or_b32 v10, v10, v6
    v_xor_b32 v6, s69, v147
    v_fmac_f32 v12, s89, v144
    v_fmac_f32 v13, s89, v145
    v_fmac_f32 v14, s89, v146
    v_or_b32 v10, v10, v6
    v_xor_b32 v6, s69, v151
    v_fmac_f32 v12, s90, v148
    v_fmac_f32 v13, s90, v149
    v_fmac_f32 v14, s90, v150
    v_or_b32 v10, v10, v6
    v_xor_b32 v6, s69, v155
    v_fmac_f32 v12, s91, v152
    v_fmac_f32 v13, s91, v153
    v_fmac_f32 v14, s91, v154
    v_or_b32 v10, v10, v6
    s_add_u32 s80, s80, 4096
    buffer_load_dwordx4 v[124:127], v2, s[52:55], s80 offen offset:0 sc0 sc1
    buffer_load_dwordx4 v[128:131], v2, s[52:55], s80 offen offset:2048 sc0 sc1
    s_add_u32 s80, s80, 4096
    buffer_load_dwordx4 v[132:135], v2, s[52:55], s80 offen offset:0 sc0 sc1
    buffer_load_dwordx4 v[136:139], v2, s[52:55], s80 offen offset:2048 sc0 sc1
    s_add_u32 s80, s80, 4096
    buffer_load_dwordx4 v[140:143], v2, s[52:55], s80 offen offset:0 sc0 sc1
    buffer_load_dwordx4 v[144:147], v2, s[52:55], s80 offen offset:2048 sc0 sc1
    s_add_u32 s80, s80, 4096
    buffer_load_dwordx4 v[148:151], v2, s[52:55], s80 offen offset:0 sc0 sc1
    buffer_load_dwordx4 v[152:155], v2, s[52:55], s80 offen offset:2048 sc0 sc1
    v_readlane_b32 s84, v20, 32
    v_readlane_b32 s85, v20, 33
    v_readlane_b32 s86, v20, 34
    v_readlane_b32 s87, v20, 35
    v_readlane_b32 s88, v20, 36
    v_readlane_b32 s89, v20, 37
    v_readlane_b32 s90, v20, 38
    v_readlane_b32 s91, v20, 39
    s_waitcnt vmcnt(24)
    v_xor_b32 v6, s69, v31
    v_fmac_f32 v12, s84, v28
    v_fmac_f32 v13, s84, v29
    v_fmac_f32 v14, s84, v30
    v_or_b32 v10, v10, v6
    v_xor_b32 v6, s69, v35
    v_fmac_f32 v12, s85, v32
    v_fmac_f32 v13, s85, v33
    v_fmac_f32 v14, s85, v34
    v_or_b32 v10, v10, v6
    v_xor_b32 v6, s69, v39
    v_fmac_f32 v12, s86, v36
    v_fmac_f32 v13, s86, v37
    v_fmac_f32 v14, s86, v38
    v_or_b32 v10, v10, v6
    v_xor_b32 v6, s69, v43
    v_fmac_f32 v12, s87, v40
    v_fmac_f32 v13, s87, v41
    v_fmac_f32 v14, s87, v42
    v_or_b32 v10, v10, v6
    v_xor_b32 v6, s69, v47
    v_fmac_f32 v12, s88, v44
    v_fmac_f32 v13, s88, v45
    v_fmac_f32 v14, s88, v46
    v_or_b32 v10, v10, v6
    v_xor_b32 v6, s69, v51
    v_fmac_f32 v12, s89, v48
    v_fmac_f32 v13, s89, v49
    v_fmac_f32 v14, s89, v50
    v_or_b32 v10, v10, v6
    v_xor_b32 v6, s69, v55
    v_fmac_f32 v12, s90, v52
    v_fmac_f32 v13, s90, v53
    v_fmac_f32 v14, s90, v54
    v_or_b32 v10, v10, v6
    v_xor_b32 v6, s69, v59
    v_fmac_f32 v12, s91, v56
    v_fmac_f32 v13, s91, v57
    v_fmac_f32 v14, s91, v58
    v_or_b32 v10, v10, v6
    v_readlane_b32 s84, v20, 40
    v_readlane_b32 s85, v20, 41
    v_readlane_b32 s86, v20, 42
    v_readlane_b32 s87, v20, 43
    v_readlane_b32 s88, v20, 44
    v_readlane_b32 s89, v20, 45
    v_readlane_b32 s90, v20, 46
    v_readlane_b32 s91, v20, 47
    s_waitcnt vmcnt(16)
    v_xor_b32 v6, s69, v63
    v_fmac_f32 v12, s84, v60
    v_fmac_f32 v13, s84, v61
    v_fmac_f32 v14, s84, v62
    v_or_b32 v10, v10, v6
    v_xor_b32 v6, s69, v67
    v_fmac_f32 v12, s85, v64
    v_fmac_f32 v13, s85, v65
    v_fmac_f32 v14, s85, v66
    v_or_b32 v10, v10, v6
    v_xor_b32 v6, s69, v71
    v_fmac_f32 v12, s86, v68
    v_fmac_f32 v13, s86, v69
    v_fmac_f32 v14, s86, v70
    v_or_b32 v10, v10, v6
    v_xor_b32 v6, s69, v75
    v_fmac_f32 v12, s87, v72
    v_fmac_f32 v13, s87, v73
    v_fmac_f32 v14, s87, v74
    v_or_b32 v10, v10, v6
    v_xor_b32 v6, s69, v79
    v_fmac_f32 v12, s88, v76
    v_fmac_f32 v13, s88, v77
    v_fmac_f32 v14, s88, v78
    v_or_b32 v10, v10, v6
    v_xor_b32 v6, s69, v83
    v_fmac_f32 v12, s89, v80
    v_fmac_f32 v13, s89, v81
    v_fmac_f32 v14, s89, v82
    v_or_b32 v10, v10, v6
    v_xor_b32 v6, s69, v87
    v_fmac_f32 v12, s90, v84
    v_fmac_f32 v13, s90, v85
    v_fmac_f32 v14, s90, v86
    v_or_b32 v10, v10, v6
    v_xor_b32 v6, s69, v91
    v_fmac_f32 v12, s91, v88
    v_fmac_f32 v13, s91, v89
    v_fmac_f32 v14, s91, v90
    v_or_b32 v10, v10, v6
    v_readlane_b32 s84, v20, 48
    v_readlane_b32 s85, v20, 49
    v_readlane_b32 s86, v20, 50
    v_readlane_b32 s87, v20, 51
    v_readlane_b32 s88, v20, 52
    v_readlane_b32 s89, v20, 53
    v_readlane_b32 s90, v20, 54
    v_readlane_b32 s91, v20, 55
    s_waitcnt vmcnt(8)
    v_xor_b32 v6, s69, v95
    v_fmac_f32 v12, s84, v92
    v_fmac_f32 v13, s84, v93
    v_fmac_f32 v14, s84, v94
    v_or_b32 v10, v10, v6
    v_xor_b32 v6, s69, v99
    v_fmac_f32 v12, s85, v96
    v_fmac_f32 v13, s85, v97
    v_fmac_f32 v14, s85, v98
    v_or_b32 v10, v10, v6
    v_xor_b32 v6, s69, v103
    v_fmac_f32 v12, s86, v100
    v_fmac_f32 v13, s86, v101
    v_fmac_f32 v14, s86, v102
    v_or_b32 v10, v10, v6
    v_xor_b32 v6, s69, v107
    v_fmac_f32 v12, s87, v104
    v_fmac_f32 v13, s87, v105
    v_fmac_f32 v14, s87, v106
    v_or_b32 v10, v10, v6
    v_xor_b32 v6, s69, v111
    v_fmac_f32 v12, s88, v108
    v_fmac_f32 v13, s88, v109
    v_fmac_f32 v14, s88, v110
    v_or_b32 v10, v10, v6
    v_xor_b32 v6, s69, v115
    v_fmac_f32 v12, s89, v112
    v_fmac_f32 v13, s89, v113
    v_fmac_f32 v14, s89, v114
    v_or_b32 v10, v10, v6
    v_xor_b32 v6, s69, v119
    v_fmac_f32 v12, s90, v116
    v_fmac_f32 v13, s90, v117
    v_fmac_f32 v14, s90, v118
    v_or_b32 v10, v10, v6
    v_xor_b32 v6, s69, v123
    v_fmac_f32 v12, s91, v120
    v_fmac_f32 v13, s91, v121
    v_fmac_f32 v14, s91, v122
    v_or_b32 v10, v10, v6
    v_readlane_b32 s84, v20, 56
    v_readlane_b32 s85, v20, 57
    v_readlane_b32 s86, v20, 58
    v_readlane_b32 s87, v20, 59
    v_readlane_b32 s88, v20, 60
    v_readlane_b32 s89, v20, 61
    v_readlane_b32 s90, v20, 62
    v_readlane_b32 s91, v20, 63
    s_waitcnt vmcnt(0)
    v_xor_b32 v6, s69, v127
    v_fmac_f32 v12, s84, v124
    v_fmac_f32 v13, s84, v125
    v_fmac_f32 v14, s84, v126
    v_or_b32 v10, v10, v6
    v_xor_b32 v6, s69, v131
    v_fmac_f32 v12, s85, v128
    v_fmac_f32 v13, s85, v129
    v_fmac_f32 v14, s85, v130
    v_or_b32 v10, v10, v6
    v_xor_b32 v6, s69, v135
    v_fmac_f32 v12, s86, v132
    v_fmac_f32 v13, s86, v133
    v_fmac_f32 v14, s86, v134
    v_or_b32 v10, v10, v6
    v_xor_b32 v6, s69, v139
    v_fmac_f32 v12, s87, v136
    v_fmac_f32 v13, s87, v137
    v_fmac_f32 v14, s87, v138
    v_or_b32 v10, v10, v6
    v_xor_b32 v6, s69, v143
    v_fmac_f32 v12, s88, v140
    v_fmac_f32 v13, s88, v141
    v_fmac_f32 v14, s88, v142
    v_or_b32 v10, v10, v6
    v_xor_b32 v6, s69, v147
    v_fmac_f32 v12, s89, v144
    v_fmac_f32 v13, s89, v145
    v_fmac_f32 v14, s89, v146
    v_or_b32 v10, v10, v6
    v_xor_b32 v6, s69, v151
    v_fmac_f32 v12, s90, v148
    v_fmac_f32 v13, s90, v149
    v_fmac_f32 v14, s90, v150
    v_or_b32 v10, v10, v6
    v_xor_b32 v6, s69, v155
    v_fmac_f32 v12, s91, v152
    v_fmac_f32 v13, s91, v153
    v_fmac_f32 v14, s91, v154
    v_or_b32 v10, v10, v6
    v_cmp_ne_u32 vcc, 0, v10
    s_cmp_lg_u64 vcc, 0
    s_cbranch_scc1 L_comb
    v_mul_f32 v12, v12, v9
    v_mul_f32 v13, v13, v9
    v_mul_f32 v14, v14, v9
    s_mul_i32 s80, s82, 384
    v_mul_u32_u24 v6, 6, v0
    v_cvt_pk_bf16_f32 v12, v12, v12
    v_cvt_pk_bf16_f32 v13, v13, v13
    v_cvt_pk_bf16_f32 v14, v14, v14
    buffer_store_short v12, v6, s[56:59], s80 offen offset:0
    buffer_store_short v13, v6, s[56:59], s80 offen offset:2
    buffer_store_short v14, v6, s[56:59], s80 offen offset:4
L_next:
    s_add_u32 s79, s79, 4
    s_add_u32 s71, s71, 1
    s_cmp_lt_u32 s71, 8
    s_cbranch_scc1 L_poll
    s_cmp_eq_u32 s71, 8
    s_cbranch_scc1 L_chk
L_end:
    s_endpgm
.section .rodata,"a"
.p2align 6
.amdhsa_kernel standalone__kv_cache_quant_int4_int2_kv_with_per_channel_or_per_token_scales__decode_kernel
  .amdhsa_next_free_vgpr 156
  .amdhsa_next_free_sgpr 102
  .amdhsa_accum_offset 156
  .amdhsa_group_segment_fixed_size 0
  .amdhsa_kernarg_size 80
  .amdhsa_user_sgpr_count 2
  .amdhsa_user_sgpr_kernarg_segment_ptr 1
  .amdhsa_system_sgpr_workgroup_id_x 1
.end_amdhsa_kernel
```

```asm
; @launch grid=(256,1,1) block=(192,1,1) lds=98304
.amdgcn_target "amdgcn-amd-amdhsa--gfx950"
.text
.globl standalone__kv_cache_quant_int4_int2_kv_with_per_channel_or_per_token_scales__decode_kernel
.p2align 8
.type standalone__kv_cache_quant_int4_int2_kv_with_per_channel_or_per_token_scales__decode_kernel,@function
standalone__kv_cache_quant_int4_int2_kv_with_per_channel_or_per_token_scales__decode_kernel:
    s_cmp_ge_u32 s2, 256
    s_cbranch_scc1 L_end
    s_load_dwordx16 s[4:19], s[0:1], 0
    s_load_dwordx4 s[20:23], s[0:1], 64
    v_lshrrev_b32 v179, 6, v0
    v_and_b32 v0, 63, v0
    v_readfirstlane_b32 s68, v179
    s_lshr_b32 s79, s2, 6
    s_and_b32 s92, s2, 63
    s_cmp_eq_u32 s68, 1
    s_cbranch_scc1 L_service
    s_cmp_eq_u32 s68, 2
    s_cbranch_scc1 L_ticket
    s_setprio 1
    v_and_b32 v185, 15, v0
    v_lshrrev_b32 v184, 4, v0
    v_mul_u32_u24 v1, 768, v184
    v_lshl_add_u32 v1, v185, 4, v1
    v_mul_u32_u24 v180, 49152, v179
    v_add_u32 v1, v1, v180
    v_lshlrev_b32 v2, 3, v185
    v_bfrev_b32 v181, v185
    v_lshrrev_b32 v181, 28, v181
    v_and_b32 v181, 15, v181
    v_lshrrev_b32 v182, 4, v181
    v_and_b32 v181, 15, v181
    v_mul_u32_u24 v3, 4096, v182
    v_mul_u32_u24 v181, 4, v181
    v_add_u32 v3, v3, v181
    v_mul_u32_u24 v181, 64, v179
    v_add3_u32 v3, v3, v181, v184
    v_lshlrev_b32 v3, 1, v3
    v_mul_u32_u24 v186, 16384, v179
    v_lshl_add_u32 v186, v0, 2, v186
    v_add_u32 v186, 8960, v186
    v_mov_b32 v187, v186
    v_lshlrev_b32 v189, 10, v179
    v_lshlrev_b32 v188, 2, v184
    v_lshl_add_u32 v188, v185, 4, v188
    v_add_u32 v188, v188, v189
    v_mov_b32 v190, 0
    v_mov_b32 v191, 1
    v_lshlrev_b32 v174, 9, v179
    v_lshl_add_u32 v174, v0, 3, v174
    v_mov_b32 v175, 1
    v_mov_b32 v176, 260
    s_add_u32 s94, s79, 28
    s_lshl_b32 s94, s94, 9
    s_and_b32 s80, s92, 56
    s_add_u32 s94, s94, s80
    s_add_u32 s94, s94, 0
    s_lshl_b32 s69, s79, 9
    s_add_u32 s69, s69, s92
    s_mov_b32 s64, 0xcccccccc
    s_mov_b32 s65, 0xcccccccc
    s_mov_b32 s66, 0xaaaaaaaa
    s_mov_b32 s67, 0xaaaaaaaa
    s_mov_b32 s78, 0x3dd53b95
    s_waitcnt lgkmcnt(0)
    s_mov_b32 s24, s6
    s_and_b32 s25, s7, 0xffff
    s_mov_b32 s26, 805306368
    s_mov_b32 s27, 0x00020000
    s_mov_b32 s48, s4
    s_and_b32 s49, s5, 0xffff
    s_mov_b32 s50, 12288
    s_mov_b32 s51, 0x00020000
    s_mov_b32 s32, s10
    s_and_b32 s33, s11, 0xffff
    s_mov_b32 s34, 6291456
    s_mov_b32 s35, 0x00020000
    s_mov_b32 s36, s12
    s_and_b32 s37, s13, 0xffff
    s_mov_b32 s38, 6291456
    s_mov_b32 s39, 0x00020000
    s_mov_b32 s70, s69
    s_mov_b32 s75, 8
    s_lshr_b32 s74, s70, 9
    s_mul_i32 s74, s74, 384
    buffer_load_dwordx2 v[144:145], v2, s[48:51], s74 offen offset:0
    buffer_load_dwordx2 v[146:147], v2, s[48:51], s74 offen offset:128
    buffer_load_dwordx2 v[148:149], v2, s[48:51], s74 offen offset:256
    s_mul_i32 s71, s70, 49152
    s_mul_i32 s72, s70, 384
    buffer_load_dwordx2 v[132:133], v2, s[32:35], s72 offen offset:0
    buffer_load_dwordx2 v[134:135], v2, s[32:35], s72 offen offset:128
    buffer_load_dwordx2 v[136:137], v2, s[32:35], s72 offen offset:256
    buffer_load_dwordx2 v[138:139], v2, s[36:39], s72 offen offset:0
    buffer_load_dwordx2 v[140:141], v2, s[36:39], s72 offen offset:128
    buffer_load_dwordx2 v[142:143], v2, s[36:39], s72 offen offset:256
    buffer_load_dwordx4 v[4:7], v1, s[24:27], s71 offen offset:0 nt
    buffer_load_dwordx4 v[8:11], v1, s[24:27], s71 offen offset:256 nt
    buffer_load_dwordx4 v[12:15], v1, s[24:27], s71 offen offset:512 nt
    s_add_u32 s71, s71, 3072
    buffer_load_dwordx4 v[16:19], v1, s[24:27], s71 offen offset:0 nt
    buffer_load_dwordx4 v[20:23], v1, s[24:27], s71 offen offset:256 nt
    buffer_load_dwordx4 v[24:27], v1, s[24:27], s71 offen offset:512 nt
    s_add_u32 s71, s71, 3072
    buffer_load_dwordx4 v[28:31], v1, s[24:27], s71 offen offset:0 nt
    buffer_load_dwordx4 v[32:35], v1, s[24:27], s71 offen offset:256 nt
    buffer_load_dwordx4 v[36:39], v1, s[24:27], s71 offen offset:512 nt
    s_add_u32 s71, s71, 3072
    buffer_load_dwordx4 v[40:43], v1, s[24:27], s71 offen offset:0 nt
    buffer_load_dwordx4 v[44:47], v1, s[24:27], s71 offen offset:256 nt
    buffer_load_dwordx4 v[48:51], v1, s[24:27], s71 offen offset:512 nt
    s_add_u32 s71, s71, 3072
    buffer_load_dwordx4 v[52:55], v1, s[24:27], s71 offen offset:0 nt
    buffer_load_dwordx4 v[56:59], v1, s[24:27], s71 offen offset:256 nt
    buffer_load_dwordx4 v[60:63], v1, s[24:27], s71 offen offset:512 nt
    s_add_u32 s71, s71, 3072
    buffer_load_dwordx4 v[64:67], v1, s[24:27], s71 offen offset:0 nt
    buffer_load_dwordx4 v[68:71], v1, s[24:27], s71 offen offset:256 nt
    buffer_load_dwordx4 v[72:75], v1, s[24:27], s71 offen offset:512 nt
    s_add_u32 s71, s71, 3072
    buffer_load_dwordx4 v[76:79], v1, s[24:27], s71 offen offset:0 nt
    buffer_load_dwordx4 v[80:83], v1, s[24:27], s71 offen offset:256 nt
    buffer_load_dwordx4 v[84:87], v1, s[24:27], s71 offen offset:512 nt
    s_add_u32 s71, s71, 3072
    buffer_load_dwordx4 v[88:91], v1, s[24:27], s71 offen offset:0 nt
    buffer_load_dwordx4 v[92:95], v1, s[24:27], s71 offen offset:256 nt
    s_mov_b32 s28, s8
    s_and_b32 s29, s9, 0xffff
    s_mov_b32 s30, 805306368
    s_mov_b32 s31, 0x00020000
    s_mov_b32 s40, s14
    s_and_b32 s41, s15, 0xffff
    s_mov_b32 s42, 2097152
    s_mov_b32 s43, 0x00020000
    s_mov_b32 s44, s16
    s_and_b32 s45, s17, 0xffff
    s_mov_b32 s46, 2097152
    s_mov_b32 s47, 0x00020000
    s_mov_b32 s52, s22
    s_and_b32 s53, s23, 0xffff
    s_mov_b32 s54, 17825792
    s_mov_b32 s55, 0x00020000
    s_mov_b32 s77, 8
    v_mov_b32 v165, 0xf149f2ca
    v_mov_b32 v166, 0
    v_mov_b32 v167, 0
    v_mov_b32 v152, 0
    v_mov_b32 v153, 0
    v_mov_b32 v154, 0
    v_mov_b32 v155, 0
    v_mov_b32 v156, 0
    v_mov_b32 v157, 0
    v_mov_b32 v158, 0
    v_mov_b32 v159, 0
    v_mov_b32 v160, 0
    v_mov_b32 v161, 0
    v_mov_b32 v162, 0
    v_mov_b32 v163, 0
    s_barrier
    s_mov_b32 s76, 63
L_loop0:
    s_waitcnt vmcnt(29)
    v_lshlrev_b32 v108, 16, v144
    v_and_b32 v109, 0xffff0000, v144
    v_lshlrev_b32 v110, 16, v145
    v_and_b32 v111, 0xffff0000, v145
    v_lshlrev_b32 v112, 16, v146
    v_and_b32 v113, 0xffff0000, v146
    v_lshlrev_b32 v114, 16, v147
    v_and_b32 v115, 0xffff0000, v147
    v_lshlrev_b32 v116, 16, v148
    v_and_b32 v117, 0xffff0000, v148
    v_lshlrev_b32 v118, 16, v149
    v_and_b32 v119, 0xffff0000, v149
    v_mul_f32 v108, s78, v108
    v_mul_f32 v109, s78, v109
    v_mul_f32 v110, s78, v110
    v_mul_f32 v111, s78, v111
    v_mul_f32 v112, s78, v112
    v_mul_f32 v113, s78, v113
    v_mul_f32 v114, s78, v114
    v_mul_f32 v115, s78, v115
    v_mul_f32 v116, s78, v116
    v_mul_f32 v117, s78, v117
    v_mul_f32 v118, s78, v118
    v_mul_f32 v119, s78, v119
    s_waitcnt vmcnt(23)
    v_lshlrev_b32 v184, 16, v132
    v_and_b32 v185, 0xffff0000, v132
    v_mul_f32 v120, v184, v108
    v_mul_f32 v121, v185, v109
    v_lshlrev_b32 v184, 16, v138
    v_and_b32 v185, 0xffff0000, v138
    v_mul_f32 v164, v120, v184
    v_fmac_f32 v164, v121, v185
    v_lshlrev_b32 v184, 16, v133
    v_and_b32 v185, 0xffff0000, v133
    v_mul_f32 v122, v184, v110
    v_mul_f32 v123, v185, v111
    v_lshlrev_b32 v184, 16, v139
    v_and_b32 v185, 0xffff0000, v139
    v_fmac_f32 v164, v122, v184
    v_fmac_f32 v164, v123, v185
    v_lshlrev_b32 v184, 16, v134
    v_and_b32 v185, 0xffff0000, v134
    v_mul_f32 v124, v184, v112
    v_mul_f32 v125, v185, v113
    v_lshlrev_b32 v184, 16, v140
    v_and_b32 v185, 0xffff0000, v140
    v_fmac_f32 v164, v124, v184
    v_fmac_f32 v164, v125, v185
    v_lshlrev_b32 v184, 16, v135
    v_and_b32 v185, 0xffff0000, v135
    v_mul_f32 v126, v184, v114
    v_mul_f32 v127, v185, v115
    v_lshlrev_b32 v184, 16, v141
    v_and_b32 v185, 0xffff0000, v141
    v_fmac_f32 v164, v126, v184
    v_fmac_f32 v164, v127, v185
    v_lshlrev_b32 v184, 16, v136
    v_and_b32 v185, 0xffff0000, v136
    v_mul_f32 v128, v184, v116
    v_mul_f32 v129, v185, v117
    v_lshlrev_b32 v184, 16, v142
    v_and_b32 v185, 0xffff0000, v142
    v_fmac_f32 v164, v128, v184
    v_fmac_f32 v164, v129, v185
    v_lshlrev_b32 v184, 16, v137
    v_and_b32 v185, 0xffff0000, v137
    v_mul_f32 v130, v184, v118
    v_mul_f32 v131, v185, v119
    v_lshlrev_b32 v184, 16, v143
    v_and_b32 v185, 0xffff0000, v143
    v_fmac_f32 v164, v130, v184
    v_fmac_f32 v164, v131, v185
    s_waitcnt vmcnt(22)
    v_cvt_f32_i32 v100, v4
    v_cvt_f32_i32 v101, v5
    v_cvt_f32_i32 v102, v6
    v_cvt_f32_i32 v103, v7
    buffer_load_dwordx4 v[96:99], v1, s[24:27], s71 offen offset:512 nt
    v_fma_f32 v178, v120, v100, -v164
    v_fmac_f32 v178, v121, v101
    v_fmac_f32 v178, v122, v102
    v_fmac_f32 v178, v123, v103
    s_waitcnt vmcnt(22)
    v_cvt_f32_i32 v104, v8
    v_cvt_f32_i32 v105, v9
    v_cvt_f32_i32 v106, v10
    v_cvt_f32_i32 v107, v11
    s_add_u32 s71, s71, 3072
    buffer_load_dwordx4 v[4:7], v1, s[24:27], s71 offen offset:0 nt
    v_fmac_f32 v178, v124, v104
    v_fmac_f32 v178, v125, v105
    v_fmac_f32 v178, v126, v106
    v_fmac_f32 v178, v127, v107
    s_waitcnt vmcnt(22)
    v_cvt_f32_i32 v100, v12
    v_cvt_f32_i32 v101, v13
    v_cvt_f32_i32 v102, v14
    v_cvt_f32_i32 v103, v15
    buffer_load_dwordx4 v[8:11], v1, s[24:27], s71 offen offset:256 nt
    v_fmac_f32 v178, v128, v100
    v_fmac_f32 v178, v129, v101
    v_fmac_f32 v178, v130, v102
    v_fmac_f32 v178, v131, v103
    s_nop 1
    v_add_f32_dpp v179, v178, v178 row_ror:8 row_mask:0xf bank_mask:0x3
    s_waitcnt vmcnt(22)
    v_cvt_f32_i32 v104, v16
    v_cvt_f32_i32 v105, v17
    v_cvt_f32_i32 v106, v18
    v_cvt_f32_i32 v107, v19
    buffer_load_dwordx4 v[12:15], v1, s[24:27], s71 offen offset:512 nt
    v_fma_f32 v178, v120, v104, -v164
    v_fmac_f32 v178, v121, v105
    v_fmac_f32 v178, v122, v106
    v_fmac_f32 v178, v123, v107
    s_waitcnt vmcnt(22)
    v_cvt_f32_i32 v100, v20
    v_cvt_f32_i32 v101, v21
    v_cvt_f32_i32 v102, v22
    v_cvt_f32_i32 v103, v23
    s_add_u32 s71, s71, 3072
    buffer_load_dwordx4 v[16:19], v1, s[24:27], s71 offen offset:0 nt
    v_fmac_f32 v178, v124, v100
    v_fmac_f32 v178, v125, v101
    v_fmac_f32 v178, v126, v102
    v_fmac_f32 v178, v127, v103
    s_waitcnt vmcnt(22)
    v_cvt_f32_i32 v104, v24
    v_cvt_f32_i32 v105, v25
    v_cvt_f32_i32 v106, v26
    v_cvt_f32_i32 v107, v27
    buffer_load_dwordx4 v[20:23], v1, s[24:27], s71 offen offset:256 nt
    v_fmac_f32 v178, v128, v104
    v_fmac_f32 v178, v129, v105
    v_fmac_f32 v178, v130, v106
    v_fmac_f32 v178, v131, v107
    s_nop 1
    v_add_f32_dpp v179, v178, v178 row_ror:8 row_mask:0xf bank_mask:0xc
    s_nop 1
    v_add_f32_dpp v180, v179, v179 row_shl:4 row_mask:0xf bank_mask:0x5
    s_waitcnt vmcnt(22)
    v_cvt_f32_i32 v100, v28
    v_cvt_f32_i32 v101, v29
    v_cvt_f32_i32 v102, v30
    v_cvt_f32_i32 v103, v31
    buffer_load_dwordx4 v[24:27], v1, s[24:27], s71 offen offset:512 nt
    v_fma_f32 v178, v120, v100, -v164
    v_fmac_f32 v178, v121, v101
    v_fmac_f32 v178, v122, v102
    v_fmac_f32 v178, v123, v103
    s_waitcnt vmcnt(22)
    v_cvt_f32_i32 v104, v32
    v_cvt_f32_i32 v105, v33
    v_cvt_f32_i32 v106, v34
    v_cvt_f32_i32 v107, v35
    s_add_u32 s71, s71, 3072
    buffer_load_dwordx4 v[28:31], v1, s[24:27], s71 offen offset:0 nt
    v_fmac_f32 v178, v124, v104
    v_fmac_f32 v178, v125, v105
    v_fmac_f32 v178, v126, v106
    v_fmac_f32 v178, v127, v107
    s_waitcnt vmcnt(22)
    v_cvt_f32_i32 v100, v36
    v_cvt_f32_i32 v101, v37
    v_cvt_f32_i32 v102, v38
    v_cvt_f32_i32 v103, v39
    buffer_load_dwordx4 v[32:35], v1, s[24:27], s71 offen offset:256 nt
    v_fmac_f32 v178, v128, v100
    v_fmac_f32 v178, v129, v101
    v_fmac_f32 v178, v130, v102
    v_fmac_f32 v178, v131, v103
    s_nop 1
    v_add_f32_dpp v179, v178, v178 row_ror:8 row_mask:0xf bank_mask:0x3
    s_waitcnt vmcnt(22)
    v_cvt_f32_i32 v104, v40
    v_cvt_f32_i32 v105, v41
    v_cvt_f32_i32 v106, v42
    v_cvt_f32_i32 v107, v43
    buffer_load_dwordx4 v[36:39], v1, s[24:27], s71 offen offset:512 nt
    v_fma_f32 v178, v120, v104, -v164
    v_fmac_f32 v178, v121, v105
    v_fmac_f32 v178, v122, v106
    v_fmac_f32 v178, v123, v107
    s_waitcnt vmcnt(22)
    v_cvt_f32_i32 v100, v44
    v_cvt_f32_i32 v101, v45
    v_cvt_f32_i32 v102, v46
    v_cvt_f32_i32 v103, v47
    s_add_u32 s71, s71, 3072
    buffer_load_dwordx4 v[40:43], v1, s[24:27], s71 offen offset:0 nt
    v_fmac_f32 v178, v124, v100
    v_fmac_f32 v178, v125, v101
    v_fmac_f32 v178, v126, v102
    v_fmac_f32 v178, v127, v103
    s_waitcnt vmcnt(22)
    v_cvt_f32_i32 v104, v48
    v_cvt_f32_i32 v105, v49
    v_cvt_f32_i32 v106, v50
    v_cvt_f32_i32 v107, v51
    buffer_load_dwordx4 v[44:47], v1, s[24:27], s71 offen offset:256 nt
    v_fmac_f32 v178, v128, v104
    v_fmac_f32 v178, v129, v105
    v_fmac_f32 v178, v130, v106
    v_fmac_f32 v178, v131, v107
    s_nop 1
    v_add_f32_dpp v179, v178, v178 row_ror:8 row_mask:0xf bank_mask:0xc
    s_nop 1
    v_add_f32_dpp v180, v179, v179 row_shr:4 row_mask:0xf bank_mask:0xa
    s_nop 1
    v_add_f32_dpp v181, v180, v180 quad_perm:[2,3,0,1] row_mask:0xf bank_mask:0xf
    s_waitcnt vmcnt(22)
    v_cvt_f32_i32 v100, v52
    v_cvt_f32_i32 v101, v53
    v_cvt_f32_i32 v102, v54
    v_cvt_f32_i32 v103, v55
    buffer_load_dwordx4 v[48:51], v1, s[24:27], s71 offen offset:512 nt
    v_fma_f32 v178, v120, v100, -v164
    v_fmac_f32 v178, v121, v101
    v_fmac_f32 v178, v122, v102
    v_fmac_f32 v178, v123, v103
    s_waitcnt vmcnt(22)
    v_cvt_f32_i32 v104, v56
    v_cvt_f32_i32 v105, v57
    v_cvt_f32_i32 v106, v58
    v_cvt_f32_i32 v107, v59
    s_add_u32 s71, s71, 3072
    buffer_load_dwordx4 v[52:55], v1, s[24:27], s71 offen offset:0 nt
    v_fmac_f32 v178, v124, v104
    v_fmac_f32 v178, v125, v105
    v_fmac_f32 v178, v126, v106
    v_fmac_f32 v178, v127, v107
    s_waitcnt vmcnt(22)
    v_cvt_f32_i32 v100, v60
    v_cvt_f32_i32 v101, v61
    v_cvt_f32_i32 v102, v62
    v_cvt_f32_i32 v103, v63
    buffer_load_dwordx4 v[56:59], v1, s[24:27], s71 offen offset:256 nt
    v_fmac_f32 v178, v128, v100
    v_fmac_f32 v178, v129, v101
    v_fmac_f32 v178, v130, v102
    v_fmac_f32 v178, v131, v103
    s_nop 1
    v_add_f32_dpp v179, v178, v178 row_ror:8 row_mask:0xf bank_mask:0x3
    s_waitcnt vmcnt(22)
    v_cvt_f32_i32 v104, v64
    v_cvt_f32_i32 v105, v65
    v_cvt_f32_i32 v106, v66
    v_cvt_f32_i32 v107, v67
    buffer_load_dwordx4 v[60:63], v1, s[24:27], s71 offen offset:512 nt
    v_fma_f32 v178, v120, v104, -v164
    v_fmac_f32 v178, v121, v105
    v_fmac_f32 v178, v122, v106
    v_fmac_f32 v178, v123, v107
    s_waitcnt vmcnt(22)
    v_cvt_f32_i32 v100, v68
    v_cvt_f32_i32 v101, v69
    v_cvt_f32_i32 v102, v70
    v_cvt_f32_i32 v103, v71
    s_add_u32 s71, s71, 3072
    buffer_load_dwordx4 v[64:67], v1, s[24:27], s71 offen offset:0 nt
    v_fmac_f32 v178, v124, v100
    v_fmac_f32 v178, v125, v101
    v_fmac_f32 v178, v126, v102
    v_fmac_f32 v178, v127, v103
    s_waitcnt vmcnt(22)
    v_cvt_f32_i32 v104, v72
    v_cvt_f32_i32 v105, v73
    v_cvt_f32_i32 v106, v74
    v_cvt_f32_i32 v107, v75
    buffer_load_dwordx4 v[68:71], v1, s[24:27], s71 offen offset:256 nt
    v_fmac_f32 v178, v128, v104
    v_fmac_f32 v178, v129, v105
    v_fmac_f32 v178, v130, v106
    v_fmac_f32 v178, v131, v107
    s_nop 1
    v_add_f32_dpp v179, v178, v178 row_ror:8 row_mask:0xf bank_mask:0xc
    s_nop 1
    v_add_f32_dpp v180, v179, v179 row_shl:4 row_mask:0xf bank_mask:0x5
    s_waitcnt vmcnt(22)
    v_cvt_f32_i32 v100, v76
    v_cvt_f32_i32 v101, v77
    v_cvt_f32_i32 v102, v78
    v_cvt_f32_i32 v103, v79
    buffer_load_dwordx4 v[72:75], v1, s[24:27], s71 offen offset:512 nt
    v_fma_f32 v178, v120, v100, -v164
    v_fmac_f32 v178, v121, v101
    v_fmac_f32 v178, v122, v102
    v_fmac_f32 v178, v123, v103
    s_waitcnt vmcnt(22)
    v_cvt_f32_i32 v104, v80
    v_cvt_f32_i32 v105, v81
    v_cvt_f32_i32 v106, v82
    v_cvt_f32_i32 v107, v83
    s_add_u32 s71, s71, 3072
    buffer_load_dwordx4 v[76:79], v1, s[24:27], s71 offen offset:0 nt
    v_fmac_f32 v178, v124, v104
    v_fmac_f32 v178, v125, v105
    v_fmac_f32 v178, v126, v106
    v_fmac_f32 v178, v127, v107
    s_waitcnt vmcnt(22)
    v_cvt_f32_i32 v100, v84
    v_cvt_f32_i32 v101, v85
    v_cvt_f32_i32 v102, v86
    v_cvt_f32_i32 v103, v87
    buffer_load_dwordx4 v[80:83], v1, s[24:27], s71 offen offset:256 nt
    v_fmac_f32 v178, v128, v100
    v_fmac_f32 v178, v129, v101
    v_fmac_f32 v178, v130, v102
    v_fmac_f32 v178, v131, v103
    s_nop 1
    v_add_f32_dpp v179, v178, v178 row_ror:8 row_mask:0xf bank_mask:0x3
    s_waitcnt vmcnt(22)
    v_cvt_f32_i32 v104, v88
    v_cvt_f32_i32 v105, v89
    v_cvt_f32_i32 v106, v90
    v_cvt_f32_i32 v107, v91
    buffer_load_dwordx4 v[84:87], v1, s[24:27], s71 offen offset:512 nt
    v_fma_f32 v178, v120, v104, -v164
    v_fmac_f32 v178, v121, v105
    v_fmac_f32 v178, v122, v106
    v_fmac_f32 v178, v123, v107
    s_waitcnt vmcnt(22)
    v_cvt_f32_i32 v100, v92
    v_cvt_f32_i32 v101, v93
    v_cvt_f32_i32 v102, v94
    v_cvt_f32_i32 v103, v95
    s_add_u32 s71, s71, 3072
    buffer_load_dwordx4 v[88:91], v1, s[24:27], s71 offen offset:0 nt
    v_fmac_f32 v178, v124, v100
    v_fmac_f32 v178, v125, v101
    v_fmac_f32 v178, v126, v102
    v_fmac_f32 v178, v127, v103
    s_waitcnt vmcnt(22)
    v_cvt_f32_i32 v104, v96
    v_cvt_f32_i32 v105, v97
    v_cvt_f32_i32 v106, v98
    v_cvt_f32_i32 v107, v99
    buffer_load_dwordx4 v[92:95], v1, s[24:27], s71 offen offset:256 nt
    v_fmac_f32 v178, v128, v104
    v_fmac_f32 v178, v129, v105
    v_fmac_f32 v178, v130, v106
    v_fmac_f32 v178, v131, v107
    s_nop 1
    v_add_f32_dpp v179, v178, v178 row_ror:8 row_mask:0xf bank_mask:0xc
    s_nop 1
    v_add_f32_dpp v180, v179, v179 row_shr:4 row_mask:0xf bank_mask:0xa
    s_nop 1
    v_add_f32_dpp v182, v180, v180 quad_perm:[2,3,0,1] row_mask:0xf bank_mask:0xf
    v_cndmask_b32 v182, v181, v182, s[64:65]
    s_nop 1
    v_add_f32_dpp v183, v182, v182 quad_perm:[1,0,3,2] row_mask:0xf bank_mask:0xf
    s_waitcnt vmcnt(22)
    v_cvt_f32_i32 v100, v4
    v_cvt_f32_i32 v101, v5
    v_cvt_f32_i32 v102, v6
    v_cvt_f32_i32 v103, v7
    buffer_load_dwordx4 v[96:99], v1, s[24:27], s71 offen offset:512 nt
    v_fma_f32 v178, v120, v100, -v164
    v_fmac_f32 v178, v121, v101
    v_fmac_f32 v178, v122, v102
    v_fmac_f32 v178, v123, v103
    s_waitcnt vmcnt(22)
    v_cvt_f32_i32 v104, v8
    v_cvt_f32_i32 v105, v9
    v_cvt_f32_i32 v106, v10
    v_cvt_f32_i32 v107, v11
    s_add_u32 s70, s70, 64
    s_sub_u32 s75, s75, 1
    s_cmp_eq_u32 s75, 0
    s_cselect_b32 s80, 1536, 0
    s_cselect_b32 s75, 8, s75
    s_add_u32 s70, s70, s80
    s_lshr_b32 s74, s70, 9
    s_mul_i32 s74, s74, 384
    buffer_load_dwordx2 v[144:145], v2, s[48:51], s74 offen offset:0
    buffer_load_dwordx2 v[146:147], v2, s[48:51], s74 offen offset:128
    buffer_load_dwordx2 v[148:149], v2, s[48:51], s74 offen offset:256
    s_mul_i32 s71, s70, 49152
    s_mul_i32 s72, s70, 384
    buffer_load_dwordx2 v[132:133], v2, s[32:35], s72 offen offset:0
    buffer_load_dwordx2 v[134:135], v2, s[32:35], s72 offen offset:128
    buffer_load_dwordx2 v[136:137], v2, s[32:35], s72 offen offset:256
    buffer_load_dwordx2 v[138:139], v2, s[36:39], s72 offen offset:0
    buffer_load_dwordx2 v[140:141], v2, s[36:39], s72 offen offset:128
    buffer_load_dwordx2 v[142:143], v2, s[36:39], s72 offen offset:256
    buffer_load_dwordx4 v[4:7], v1, s[24:27], s71 offen offset:0 nt
    v_fmac_f32 v178, v124, v104
    v_fmac_f32 v178, v125, v105
    v_fmac_f32 v178, v126, v106
    v_fmac_f32 v178, v127, v107
    s_waitcnt vmcnt(31)
    v_cvt_f32_i32 v100, v12
    v_cvt_f32_i32 v101, v13
    v_cvt_f32_i32 v102, v14
    v_cvt_f32_i32 v103, v15
    buffer_load_dwordx4 v[8:11], v1, s[24:27], s71 offen offset:256 nt
    v_fmac_f32 v178, v128, v100
    v_fmac_f32 v178, v129, v101
    v_fmac_f32 v178, v130, v102
    v_fmac_f32 v178, v131, v103
    s_nop 1
    v_add_f32_dpp v179, v178, v178 row_ror:8 row_mask:0xf bank_mask:0x3
    s_waitcnt vmcnt(31)
    v_cvt_f32_i32 v104, v16
    v_cvt_f32_i32 v105, v17
    v_cvt_f32_i32 v106, v18
    v_cvt_f32_i32 v107, v19
    buffer_load_dwordx4 v[12:15], v1, s[24:27], s71 offen offset:512 nt
    v_fma_f32 v178, v120, v104, -v164
    v_fmac_f32 v178, v121, v105
    v_fmac_f32 v178, v122, v106
    v_fmac_f32 v178, v123, v107
    s_waitcnt vmcnt(31)
    v_cvt_f32_i32 v100, v20
    v_cvt_f32_i32 v101, v21
    v_cvt_f32_i32 v102, v22
    v_cvt_f32_i32 v103, v23
    s_add_u32 s71, s71, 3072
    buffer_load_dwordx4 v[16:19], v1, s[24:27], s71 offen offset:0 nt
    v_fmac_f32 v178, v124, v100
    v_fmac_f32 v178, v125, v101
    v_fmac_f32 v178, v126, v102
    v_fmac_f32 v178, v127, v103
    s_waitcnt vmcnt(31)
    v_cvt_f32_i32 v104, v24
    v_cvt_f32_i32 v105, v25
    v_cvt_f32_i32 v106, v26
    v_cvt_f32_i32 v107, v27
    buffer_load_dwordx4 v[20:23], v1, s[24:27], s71 offen offset:256 nt
    v_fmac_f32 v178, v128, v104
    v_fmac_f32 v178, v129, v105
    v_fmac_f32 v178, v130, v106
    v_fmac_f32 v178, v131, v107
    s_nop 1
    v_add_f32_dpp v179, v178, v178 row_ror:8 row_mask:0xf bank_mask:0xc
    s_nop 1
    v_add_f32_dpp v180, v179, v179 row_shl:4 row_mask:0xf bank_mask:0x5
    s_waitcnt vmcnt(31)
    v_cvt_f32_i32 v100, v28
    v_cvt_f32_i32 v101, v29
    v_cvt_f32_i32 v102, v30
    v_cvt_f32_i32 v103, v31
    buffer_load_dwordx4 v[24:27], v1, s[24:27], s71 offen offset:512 nt
    v_fma_f32 v178, v120, v100, -v164
    v_fmac_f32 v178, v121, v101
    v_fmac_f32 v178, v122, v102
    v_fmac_f32 v178, v123, v103
    s_waitcnt vmcnt(31)
    v_cvt_f32_i32 v104, v32
    v_cvt_f32_i32 v105, v33
    v_cvt_f32_i32 v106, v34
    v_cvt_f32_i32 v107, v35
    s_add_u32 s71, s71, 3072
    buffer_load_dwordx4 v[28:31], v1, s[24:27], s71 offen offset:0 nt
    v_fmac_f32 v178, v124, v104
    v_fmac_f32 v178, v125, v105
    v_fmac_f32 v178, v126, v106
    v_fmac_f32 v178, v127, v107
    s_waitcnt vmcnt(31)
    v_cvt_f32_i32 v100, v36
    v_cvt_f32_i32 v101, v37
    v_cvt_f32_i32 v102, v38
    v_cvt_f32_i32 v103, v39
    buffer_load_dwordx4 v[32:35], v1, s[24:27], s71 offen offset:256 nt
    v_fmac_f32 v178, v128, v100
    v_fmac_f32 v178, v129, v101
    v_fmac_f32 v178, v130, v102
    v_fmac_f32 v178, v131, v103
    s_nop 1
    v_add_f32_dpp v179, v178, v178 row_ror:8 row_mask:0xf bank_mask:0x3
    s_waitcnt vmcnt(31)
    v_cvt_f32_i32 v104, v40
    v_cvt_f32_i32 v105, v41
    v_cvt_f32_i32 v106, v42
    v_cvt_f32_i32 v107, v43
    buffer_load_dwordx4 v[36:39], v1, s[24:27], s71 offen offset:512 nt
    v_fma_f32 v178, v120, v104, -v164
    v_fmac_f32 v178, v121, v105
    v_fmac_f32 v178, v122, v106
    v_fmac_f32 v178, v123, v107
    s_waitcnt vmcnt(31)
    v_cvt_f32_i32 v100, v44
    v_cvt_f32_i32 v101, v45
    v_cvt_f32_i32 v102, v46
    v_cvt_f32_i32 v103, v47
    s_add_u32 s71, s71, 3072
    buffer_load_dwordx4 v[40:43], v1, s[24:27], s71 offen offset:0 nt
    v_fmac_f32 v178, v124, v100
    v_fmac_f32 v178, v125, v101
    v_fmac_f32 v178, v126, v102
    v_fmac_f32 v178, v127, v103
    s_waitcnt vmcnt(31)
    v_cvt_f32_i32 v104, v48
    v_cvt_f32_i32 v105, v49
    v_cvt_f32_i32 v106, v50
    v_cvt_f32_i32 v107, v51
    buffer_load_dwordx4 v[44:47], v1, s[24:27], s71 offen offset:256 nt
    v_fmac_f32 v178, v128, v104
    v_fmac_f32 v178, v129, v105
    v_fmac_f32 v178, v130, v106
    v_fmac_f32 v178, v131, v107
    s_nop 1
    v_add_f32_dpp v179, v178, v178 row_ror:8 row_mask:0xf bank_mask:0xc
    s_nop 1
    v_add_f32_dpp v180, v179, v179 row_shr:4 row_mask:0xf bank_mask:0xa
    s_nop 1
    v_add_f32_dpp v181, v180, v180 quad_perm:[2,3,0,1] row_mask:0xf bank_mask:0xf
    s_waitcnt vmcnt(31)
    v_cvt_f32_i32 v100, v52
    v_cvt_f32_i32 v101, v53
    v_cvt_f32_i32 v102, v54
    v_cvt_f32_i32 v103, v55
    buffer_load_dwordx4 v[48:51], v1, s[24:27], s71 offen offset:512 nt
    v_fma_f32 v178, v120, v100, -v164
    v_fmac_f32 v178, v121, v101
    v_fmac_f32 v178, v122, v102
    v_fmac_f32 v178, v123, v103
    s_waitcnt vmcnt(31)
    v_cvt_f32_i32 v104, v56
    v_cvt_f32_i32 v105, v57
    v_cvt_f32_i32 v106, v58
    v_cvt_f32_i32 v107, v59
    s_add_u32 s71, s71, 3072
    buffer_load_dwordx4 v[52:55], v1, s[24:27], s71 offen offset:0 nt
    v_fmac_f32 v178, v124, v104
    v_fmac_f32 v178, v125, v105
    v_fmac_f32 v178, v126, v106
    v_fmac_f32 v178, v127, v107
    s_waitcnt vmcnt(31)
    v_cvt_f32_i32 v100, v60
    v_cvt_f32_i32 v101, v61
    v_cvt_f32_i32 v102, v62
    v_cvt_f32_i32 v103, v63
    buffer_load_dwordx4 v[56:59], v1, s[24:27], s71 offen offset:256 nt
    v_fmac_f32 v178, v128, v100
    v_fmac_f32 v178, v129, v101
    v_fmac_f32 v178, v130, v102
    v_fmac_f32 v178, v131, v103
    s_nop 1
    v_add_f32_dpp v179, v178, v178 row_ror:8 row_mask:0xf bank_mask:0x3
    s_waitcnt vmcnt(31)
    v_cvt_f32_i32 v104, v64
    v_cvt_f32_i32 v105, v65
    v_cvt_f32_i32 v106, v66
    v_cvt_f32_i32 v107, v67
    buffer_load_dwordx4 v[60:63], v1, s[24:27], s71 offen offset:512 nt
    v_fma_f32 v178, v120, v104, -v164
    v_fmac_f32 v178, v121, v105
    v_fmac_f32 v178, v122, v106
    v_fmac_f32 v178, v123, v107
    s_waitcnt vmcnt(31)
    v_cvt_f32_i32 v100, v68
    v_cvt_f32_i32 v101, v69
    v_cvt_f32_i32 v102, v70
    v_cvt_f32_i32 v103, v71
    s_add_u32 s71, s71, 3072
    buffer_load_dwordx4 v[64:67], v1, s[24:27], s71 offen offset:0 nt
    v_fmac_f32 v178, v124, v100
    v_fmac_f32 v178, v125, v101
    v_fmac_f32 v178, v126, v102
    v_fmac_f32 v178, v127, v103
    s_waitcnt vmcnt(31)
    v_cvt_f32_i32 v104, v72
    v_cvt_f32_i32 v105, v73
    v_cvt_f32_i32 v106, v74
    v_cvt_f32_i32 v107, v75
    buffer_load_dwordx4 v[68:71], v1, s[24:27], s71 offen offset:256 nt
    v_fmac_f32 v178, v128, v104
    v_fmac_f32 v178, v129, v105
    v_fmac_f32 v178, v130, v106
    v_fmac_f32 v178, v131, v107
    s_nop 1
    v_add_f32_dpp v179, v178, v178 row_ror:8 row_mask:0xf bank_mask:0xc
    s_nop 1
    v_add_f32_dpp v180, v179, v179 row_shl:4 row_mask:0xf bank_mask:0x5
    s_waitcnt vmcnt(31)
    v_cvt_f32_i32 v100, v76
    v_cvt_f32_i32 v101, v77
    v_cvt_f32_i32 v102, v78
    v_cvt_f32_i32 v103, v79
    buffer_load_dwordx4 v[72:75], v1, s[24:27], s71 offen offset:512 nt
    v_fma_f32 v178, v120, v100, -v164
    v_fmac_f32 v178, v121, v101
    v_fmac_f32 v178, v122, v102
    v_fmac_f32 v178, v123, v103
    s_waitcnt vmcnt(31)
    v_cvt_f32_i32 v104, v80
    v_cvt_f32_i32 v105, v81
    v_cvt_f32_i32 v106, v82
    v_cvt_f32_i32 v107, v83
    s_add_u32 s71, s71, 3072
    buffer_load_dwordx4 v[76:79], v1, s[24:27], s71 offen offset:0 nt
    v_fmac_f32 v178, v124, v104
    v_fmac_f32 v178, v125, v105
    v_fmac_f32 v178, v126, v106
    v_fmac_f32 v178, v127, v107
    s_waitcnt vmcnt(31)
    v_cvt_f32_i32 v100, v84
    v_cvt_f32_i32 v101, v85
    v_cvt_f32_i32 v102, v86
    v_cvt_f32_i32 v103, v87
    buffer_load_dwordx4 v[80:83], v1, s[24:27], s71 offen offset:256 nt
    v_fmac_f32 v178, v128, v100
    v_fmac_f32 v178, v129, v101
    v_fmac_f32 v178, v130, v102
    v_fmac_f32 v178, v131, v103
    s_nop 1
    v_add_f32_dpp v179, v178, v178 row_ror:8 row_mask:0xf bank_mask:0x3
    s_waitcnt vmcnt(31)
    v_cvt_f32_i32 v104, v88
    v_cvt_f32_i32 v105, v89
    v_cvt_f32_i32 v106, v90
    v_cvt_f32_i32 v107, v91
    buffer_load_dwordx4 v[84:87], v1, s[24:27], s71 offen offset:512 nt
    v_fma_f32 v178, v120, v104, -v164
    v_fmac_f32 v178, v121, v105
    v_fmac_f32 v178, v122, v106
    v_fmac_f32 v178, v123, v107
    s_waitcnt vmcnt(31)
    v_cvt_f32_i32 v100, v92
    v_cvt_f32_i32 v101, v93
    v_cvt_f32_i32 v102, v94
    v_cvt_f32_i32 v103, v95
    s_add_u32 s71, s71, 3072
    buffer_load_dwordx4 v[88:91], v1, s[24:27], s71 offen offset:0 nt
    v_fmac_f32 v178, v124, v100
    v_fmac_f32 v178, v125, v101
    v_fmac_f32 v178, v126, v102
    v_fmac_f32 v178, v127, v103
    s_waitcnt vmcnt(31)
    v_cvt_f32_i32 v104, v96
    v_cvt_f32_i32 v105, v97
    v_cvt_f32_i32 v106, v98
    v_cvt_f32_i32 v107, v99
    buffer_load_dwordx4 v[92:95], v1, s[24:27], s71 offen offset:256 nt
    v_fmac_f32 v178, v128, v104
    v_fmac_f32 v178, v129, v105
    v_fmac_f32 v178, v130, v106
    v_fmac_f32 v178, v131, v107
    s_nop 1
    v_add_f32_dpp v179, v178, v178 row_ror:8 row_mask:0xf bank_mask:0xc
    s_nop 1
    v_add_f32_dpp v180, v179, v179 row_shr:4 row_mask:0xf bank_mask:0xa
    s_nop 1
    v_add_f32_dpp v182, v180, v180 quad_perm:[2,3,0,1] row_mask:0xf bank_mask:0xf
    v_cndmask_b32 v182, v181, v182, s[64:65]
    s_nop 1
    v_add_f32_dpp v181, v182, v182 quad_perm:[1,0,3,2] row_mask:0xf bank_mask:0xf
    v_cndmask_b32 v183, v183, v181, s[66:67]
    ds_write_b32 v186, v183
    v_add_u32 v186, 256, v186
    s_sub_u32 s76, s76, 1
    s_cmp_lg_u32 s76, 0
    s_cbranch_scc1 L_loop0
    s_waitcnt vmcnt(29)
    v_lshlrev_b32 v108, 16, v144
    v_and_b32 v109, 0xffff0000, v144
    v_lshlrev_b32 v110, 16, v145
    v_and_b32 v111, 0xffff0000, v145
    v_lshlrev_b32 v112, 16, v146
    v_and_b32 v113, 0xffff0000, v146
    v_lshlrev_b32 v114, 16, v147
    v_and_b32 v115, 0xffff0000, v147
    v_lshlrev_b32 v116, 16, v148
    v_and_b32 v117, 0xffff0000, v148
    v_lshlrev_b32 v118, 16, v149
    v_and_b32 v119, 0xffff0000, v149
    v_mul_f32 v108, s78, v108
    v_mul_f32 v109, s78, v109
    v_mul_f32 v110, s78, v110
    v_mul_f32 v111, s78, v111
    v_mul_f32 v112, s78, v112
    v_mul_f32 v113, s78, v113
    v_mul_f32 v114, s78, v114
    v_mul_f32 v115, s78, v115
    v_mul_f32 v116, s78, v116
    v_mul_f32 v117, s78, v117
    v_mul_f32 v118, s78, v118
    v_mul_f32 v119, s78, v119
    s_waitcnt vmcnt(23)
    v_lshlrev_b32 v184, 16, v132
    v_and_b32 v185, 0xffff0000, v132
    v_mul_f32 v120, v184, v108
    v_mul_f32 v121, v185, v109
    v_lshlrev_b32 v184, 16, v138
    v_and_b32 v185, 0xffff0000, v138
    v_mul_f32 v164, v120, v184
    v_fmac_f32 v164, v121, v185
    v_lshlrev_b32 v184, 16, v133
    v_and_b32 v185, 0xffff0000, v133
    v_mul_f32 v122, v184, v110
    v_mul_f32 v123, v185, v111
    v_lshlrev_b32 v184, 16, v139
    v_and_b32 v185, 0xffff0000, v139
    v_fmac_f32 v164, v122, v184
    v_fmac_f32 v164, v123, v185
    v_lshlrev_b32 v184, 16, v134
    v_and_b32 v185, 0xffff0000, v134
    v_mul_f32 v124, v184, v112
    v_mul_f32 v125, v185, v113
    v_lshlrev_b32 v184, 16, v140
    v_and_b32 v185, 0xffff0000, v140
    v_fmac_f32 v164, v124, v184
    v_fmac_f32 v164, v125, v185
    v_lshlrev_b32 v184, 16, v135
    v_and_b32 v185, 0xffff0000, v135
    v_mul_f32 v126, v184, v114
    v_mul_f32 v127, v185, v115
    v_lshlrev_b32 v184, 16, v141
    v_and_b32 v185, 0xffff0000, v141
    v_fmac_f32 v164, v126, v184
    v_fmac_f32 v164, v127, v185
    v_lshlrev_b32 v184, 16, v136
    v_and_b32 v185, 0xffff0000, v136
    v_mul_f32 v128, v184, v116
    v_mul_f32 v129, v185, v117
    v_lshlrev_b32 v184, 16, v142
    v_and_b32 v185, 0xffff0000, v142
    v_fmac_f32 v164, v128, v184
    v_fmac_f32 v164, v129, v185
    v_lshlrev_b32 v184, 16, v137
    v_and_b32 v185, 0xffff0000, v137
    v_mul_f32 v130, v184, v118
    v_mul_f32 v131, v185, v119
    v_lshlrev_b32 v184, 16, v143
    v_and_b32 v185, 0xffff0000, v143
    v_fmac_f32 v164, v130, v184
    v_fmac_f32 v164, v131, v185
    s_waitcnt vmcnt(22)
    v_cvt_f32_i32 v100, v4
    v_cvt_f32_i32 v101, v5
    v_cvt_f32_i32 v102, v6
    v_cvt_f32_i32 v103, v7
    buffer_load_dwordx4 v[96:99], v1, s[24:27], s71 offen offset:512 nt
    v_fma_f32 v178, v120, v100, -v164
    v_fmac_f32 v178, v121, v101
    v_fmac_f32 v178, v122, v102
    v_fmac_f32 v178, v123, v103
    s_waitcnt vmcnt(22)
    v_cvt_f32_i32 v104, v8
    v_cvt_f32_i32 v105, v9
    v_cvt_f32_i32 v106, v10
    v_cvt_f32_i32 v107, v11
    s_add_u32 s71, s71, 3072
    buffer_load_dwordx4 v[4:7], v1, s[24:27], s71 offen offset:0 nt
    v_fmac_f32 v178, v124, v104
    v_fmac_f32 v178, v125, v105
    v_fmac_f32 v178, v126, v106
    v_fmac_f32 v178, v127, v107
    s_waitcnt vmcnt(22)
    v_cvt_f32_i32 v100, v12
    v_cvt_f32_i32 v101, v13
    v_cvt_f32_i32 v102, v14
    v_cvt_f32_i32 v103, v15
    buffer_load_dwordx4 v[8:11], v1, s[24:27], s71 offen offset:256 nt
    v_fmac_f32 v178, v128, v100
    v_fmac_f32 v178, v129, v101
    v_fmac_f32 v178, v130, v102
    v_fmac_f32 v178, v131, v103
    s_nop 1
    v_add_f32_dpp v179, v178, v178 row_ror:8 row_mask:0xf bank_mask:0x3
    s_waitcnt vmcnt(22)
    v_cvt_f32_i32 v104, v16
    v_cvt_f32_i32 v105, v17
    v_cvt_f32_i32 v106, v18
    v_cvt_f32_i32 v107, v19
    buffer_load_dwordx4 v[12:15], v1, s[24:27], s71 offen offset:512 nt
    v_fma_f32 v178, v120, v104, -v164
    v_fmac_f32 v178, v121, v105
    v_fmac_f32 v178, v122, v106
    v_fmac_f32 v178, v123, v107
    s_waitcnt vmcnt(22)
    v_cvt_f32_i32 v100, v20
    v_cvt_f32_i32 v101, v21
    v_cvt_f32_i32 v102, v22
    v_cvt_f32_i32 v103, v23
    s_add_u32 s71, s71, 3072
    buffer_load_dwordx4 v[16:19], v1, s[24:27], s71 offen offset:0 nt
    v_fmac_f32 v178, v124, v100
    v_fmac_f32 v178, v125, v101
    v_fmac_f32 v178, v126, v102
    v_fmac_f32 v178, v127, v103
    s_waitcnt vmcnt(22)
    v_cvt_f32_i32 v104, v24
    v_cvt_f32_i32 v105, v25
    v_cvt_f32_i32 v106, v26
    v_cvt_f32_i32 v107, v27
    buffer_load_dwordx4 v[20:23], v1, s[24:27], s71 offen offset:256 nt
    v_fmac_f32 v178, v128, v104
    v_fmac_f32 v178, v129, v105
    v_fmac_f32 v178, v130, v106
    v_fmac_f32 v178, v131, v107
    s_nop 1
    v_add_f32_dpp v179, v178, v178 row_ror:8 row_mask:0xf bank_mask:0xc
    s_nop 1
    v_add_f32_dpp v180, v179, v179 row_shl:4 row_mask:0xf bank_mask:0x5
    s_waitcnt vmcnt(22)
    v_cvt_f32_i32 v100, v28
    v_cvt_f32_i32 v101, v29
    v_cvt_f32_i32 v102, v30
    v_cvt_f32_i32 v103, v31
    buffer_load_dwordx4 v[24:27], v1, s[24:27], s71 offen offset:512 nt
    v_fma_f32 v178, v120, v100, -v164
    v_fmac_f32 v178, v121, v101
    v_fmac_f32 v178, v122, v102
    v_fmac_f32 v178, v123, v103
    s_waitcnt vmcnt(22)
    v_cvt_f32_i32 v104, v32
    v_cvt_f32_i32 v105, v33
    v_cvt_f32_i32 v106, v34
    v_cvt_f32_i32 v107, v35
    s_add_u32 s71, s71, 3072
    buffer_load_dwordx4 v[28:31], v1, s[24:27], s71 offen offset:0 nt
    v_fmac_f32 v178, v124, v104
    v_fmac_f32 v178, v125, v105
    v_fmac_f32 v178, v126, v106
    v_fmac_f32 v178, v127, v107
    s_waitcnt vmcnt(22)
    v_cvt_f32_i32 v100, v36
    v_cvt_f32_i32 v101, v37
    v_cvt_f32_i32 v102, v38
    v_cvt_f32_i32 v103, v39
    buffer_load_dwordx4 v[32:35], v1, s[24:27], s71 offen offset:256 nt
    v_fmac_f32 v178, v128, v100
    v_fmac_f32 v178, v129, v101
    v_fmac_f32 v178, v130, v102
    v_fmac_f32 v178, v131, v103
    s_nop 1
    v_add_f32_dpp v179, v178, v178 row_ror:8 row_mask:0xf bank_mask:0x3
    s_waitcnt vmcnt(22)
    v_cvt_f32_i32 v104, v40
    v_cvt_f32_i32 v105, v41
    v_cvt_f32_i32 v106, v42
    v_cvt_f32_i32 v107, v43
    buffer_load_dwordx4 v[36:39], v1, s[24:27], s71 offen offset:512 nt
    v_fma_f32 v178, v120, v104, -v164
    v_fmac_f32 v178, v121, v105
    v_fmac_f32 v178, v122, v106
    v_fmac_f32 v178, v123, v107
    s_waitcnt vmcnt(22)
    v_cvt_f32_i32 v100, v44
    v_cvt_f32_i32 v101, v45
    v_cvt_f32_i32 v102, v46
    v_cvt_f32_i32 v103, v47
    s_add_u32 s71, s71, 3072
    buffer_load_dwordx4 v[40:43], v1, s[24:27], s71 offen offset:0 nt
    v_fmac_f32 v178, v124, v100
    v_fmac_f32 v178, v125, v101
    v_fmac_f32 v178, v126, v102
    v_fmac_f32 v178, v127, v103
    s_waitcnt vmcnt(22)
    v_cvt_f32_i32 v104, v48
    v_cvt_f32_i32 v105, v49
    v_cvt_f32_i32 v106, v50
    v_cvt_f32_i32 v107, v51
    buffer_load_dwordx4 v[44:47], v1, s[24:27], s71 offen offset:256 nt
    v_fmac_f32 v178, v128, v104
    v_fmac_f32 v178, v129, v105
    v_fmac_f32 v178, v130, v106
    v_fmac_f32 v178, v131, v107
    s_nop 1
    v_add_f32_dpp v179, v178, v178 row_ror:8 row_mask:0xf bank_mask:0xc
    s_nop 1
    v_add_f32_dpp v180, v179, v179 row_shr:4 row_mask:0xf bank_mask:0xa
    s_nop 1
    v_add_f32_dpp v181, v180, v180 quad_perm:[2,3,0,1] row_mask:0xf bank_mask:0xf
    s_waitcnt vmcnt(22)
    v_cvt_f32_i32 v100, v52
    v_cvt_f32_i32 v101, v53
    v_cvt_f32_i32 v102, v54
    v_cvt_f32_i32 v103, v55
    buffer_load_dwordx4 v[48:51], v1, s[24:27], s71 offen offset:512 nt
    v_fma_f32 v178, v120, v100, -v164
    v_fmac_f32 v178, v121, v101
    v_fmac_f32 v178, v122, v102
    v_fmac_f32 v178, v123, v103
    s_waitcnt vmcnt(22)
    v_cvt_f32_i32 v104, v56
    v_cvt_f32_i32 v105, v57
    v_cvt_f32_i32 v106, v58
    v_cvt_f32_i32 v107, v59
    s_add_u32 s71, s71, 3072
    buffer_load_dwordx4 v[52:55], v1, s[24:27], s71 offen offset:0 nt
    v_fmac_f32 v178, v124, v104
    v_fmac_f32 v178, v125, v105
    v_fmac_f32 v178, v126, v106
    v_fmac_f32 v178, v127, v107
    s_waitcnt vmcnt(22)
    v_cvt_f32_i32 v100, v60
    v_cvt_f32_i32 v101, v61
    v_cvt_f32_i32 v102, v62
    v_cvt_f32_i32 v103, v63
    buffer_load_dwordx4 v[56:59], v1, s[24:27], s71 offen offset:256 nt
    v_fmac_f32 v178, v128, v100
    v_fmac_f32 v178, v129, v101
    v_fmac_f32 v178, v130, v102
    v_fmac_f32 v178, v131, v103
    s_nop 1
    v_add_f32_dpp v179, v178, v178 row_ror:8 row_mask:0xf bank_mask:0x3
    s_waitcnt vmcnt(22)
    v_cvt_f32_i32 v104, v64
    v_cvt_f32_i32 v105, v65
    v_cvt_f32_i32 v106, v66
    v_cvt_f32_i32 v107, v67
    buffer_load_dwordx4 v[60:63], v1, s[24:27], s71 offen offset:512 nt
    v_fma_f32 v178, v120, v104, -v164
    v_fmac_f32 v178, v121, v105
    v_fmac_f32 v178, v122, v106
    v_fmac_f32 v178, v123, v107
    s_waitcnt vmcnt(22)
    v_cvt_f32_i32 v100, v68
    v_cvt_f32_i32 v101, v69
    v_cvt_f32_i32 v102, v70
    v_cvt_f32_i32 v103, v71
    s_add_u32 s71, s71, 3072
    buffer_load_dwordx4 v[64:67], v1, s[24:27], s71 offen offset:0 nt
    v_fmac_f32 v178, v124, v100
    v_fmac_f32 v178, v125, v101
    v_fmac_f32 v178, v126, v102
    v_fmac_f32 v178, v127, v103
    s_waitcnt vmcnt(22)
    v_cvt_f32_i32 v104, v72
    v_cvt_f32_i32 v105, v73
    v_cvt_f32_i32 v106, v74
    v_cvt_f32_i32 v107, v75
    buffer_load_dwordx4 v[68:71], v1, s[24:27], s71 offen offset:256 nt
    v_fmac_f32 v178, v128, v104
    v_fmac_f32 v178, v129, v105
    v_fmac_f32 v178, v130, v106
    v_fmac_f32 v178, v131, v107
    s_nop 1
    v_add_f32_dpp v179, v178, v178 row_ror:8 row_mask:0xf bank_mask:0xc
    s_nop 1
    v_add_f32_dpp v180, v179, v179 row_shl:4 row_mask:0xf bank_mask:0x5
    s_waitcnt vmcnt(22)
    v_cvt_f32_i32 v100, v76
    v_cvt_f32_i32 v101, v77
    v_cvt_f32_i32 v102, v78
    v_cvt_f32_i32 v103, v79
    buffer_load_dwordx4 v[72:75], v1, s[24:27], s71 offen offset:512 nt
    v_fma_f32 v178, v120, v100, -v164
    v_fmac_f32 v178, v121, v101
    v_fmac_f32 v178, v122, v102
    v_fmac_f32 v178, v123, v103
    s_waitcnt vmcnt(22)
    v_cvt_f32_i32 v104, v80
    v_cvt_f32_i32 v105, v81
    v_cvt_f32_i32 v106, v82
    v_cvt_f32_i32 v107, v83
    s_add_u32 s71, s71, 3072
    buffer_load_dwordx4 v[76:79], v1, s[24:27], s71 offen offset:0 nt
    v_fmac_f32 v178, v124, v104
    v_fmac_f32 v178, v125, v105
    v_fmac_f32 v178, v126, v106
    v_fmac_f32 v178, v127, v107
    s_waitcnt vmcnt(22)
    v_cvt_f32_i32 v100, v84
    v_cvt_f32_i32 v101, v85
    v_cvt_f32_i32 v102, v86
    v_cvt_f32_i32 v103, v87
    buffer_load_dwordx4 v[80:83], v1, s[24:27], s71 offen offset:256 nt
    v_fmac_f32 v178, v128, v100
    v_fmac_f32 v178, v129, v101
    v_fmac_f32 v178, v130, v102
    v_fmac_f32 v178, v131, v103
    s_nop 1
    v_add_f32_dpp v179, v178, v178 row_ror:8 row_mask:0xf bank_mask:0x3
    s_waitcnt vmcnt(22)
    v_cvt_f32_i32 v104, v88
    v_cvt_f32_i32 v105, v89
    v_cvt_f32_i32 v106, v90
    v_cvt_f32_i32 v107, v91
    buffer_load_dwordx4 v[84:87], v1, s[24:27], s71 offen offset:512 nt
    v_fma_f32 v178, v120, v104, -v164
    v_fmac_f32 v178, v121, v105
    v_fmac_f32 v178, v122, v106
    v_fmac_f32 v178, v123, v107
    s_waitcnt vmcnt(22)
    v_cvt_f32_i32 v100, v92
    v_cvt_f32_i32 v101, v93
    v_cvt_f32_i32 v102, v94
    v_cvt_f32_i32 v103, v95
    s_add_u32 s71, s71, 3072
    buffer_load_dwordx4 v[88:91], v1, s[24:27], s71 offen offset:0 nt
    v_fmac_f32 v178, v124, v100
    v_fmac_f32 v178, v125, v101
    v_fmac_f32 v178, v126, v102
    v_fmac_f32 v178, v127, v103
    s_waitcnt vmcnt(22)
    v_cvt_f32_i32 v104, v96
    v_cvt_f32_i32 v105, v97
    v_cvt_f32_i32 v106, v98
    v_cvt_f32_i32 v107, v99
    buffer_load_dwordx4 v[92:95], v1, s[24:27], s71 offen offset:256 nt
    v_fmac_f32 v178, v128, v104
    v_fmac_f32 v178, v129, v105
    v_fmac_f32 v178, v130, v106
    v_fmac_f32 v178, v131, v107
    s_nop 1
    v_add_f32_dpp v179, v178, v178 row_ror:8 row_mask:0xf bank_mask:0xc
    s_nop 1
    v_add_f32_dpp v180, v179, v179 row_shr:4 row_mask:0xf bank_mask:0xa
    s_nop 1
    v_add_f32_dpp v182, v180, v180 quad_perm:[2,3,0,1] row_mask:0xf bank_mask:0xf
    v_cndmask_b32 v182, v181, v182, s[64:65]
    s_nop 1
    v_add_f32_dpp v183, v182, v182 quad_perm:[1,0,3,2] row_mask:0xf bank_mask:0xf
    s_waitcnt vmcnt(22)
    v_cvt_f32_i32 v100, v4
    v_cvt_f32_i32 v101, v5
    v_cvt_f32_i32 v102, v6
    v_cvt_f32_i32 v103, v7
    buffer_load_dwordx4 v[96:99], v1, s[24:27], s71 offen offset:512 nt
    v_fma_f32 v178, v120, v100, -v164
    v_fmac_f32 v178, v121, v101
    v_fmac_f32 v178, v122, v102
    v_fmac_f32 v178, v123, v103
    s_waitcnt vmcnt(22)
    v_cvt_f32_i32 v104, v8
    v_cvt_f32_i32 v105, v9
    v_cvt_f32_i32 v106, v10
    v_cvt_f32_i32 v107, v11
    s_mov_b32 s70, s69
    s_mov_b32 s75, 8
    s_lshl_b32 s73, s70, 7
    buffer_load_ushort v168, v3, s[40:43], s73 offen
    buffer_load_ushort v169, v3, s[44:47], s73 offen
    s_mul_i32 s71, s70, 49152
    buffer_load_dwordx4 v[4:7], v1, s[28:31], s71 offen offset:0 nt
    v_fmac_f32 v178, v124, v104
    v_fmac_f32 v178, v125, v105
    v_fmac_f32 v178, v126, v106
    v_fmac_f32 v178, v127, v107
    s_waitcnt vmcnt(24)
    v_cvt_f32_i32 v100, v12
    v_cvt_f32_i32 v101, v13
    v_cvt_f32_i32 v102, v14
    v_cvt_f32_i32 v103, v15
    buffer_load_dwordx4 v[8:11], v1, s[28:31], s71 offen offset:256 nt
    v_fmac_f32 v178, v128, v100
    v_fmac_f32 v178, v129, v101
    v_fmac_f32 v178, v130, v102
    v_fmac_f32 v178, v131, v103
    s_nop 1
    v_add_f32_dpp v179, v178, v178 row_ror:8 row_mask:0xf bank_mask:0x3
    s_waitcnt vmcnt(24)
    v_cvt_f32_i32 v104, v16
    v_cvt_f32_i32 v105, v17
    v_cvt_f32_i32 v106, v18
    v_cvt_f32_i32 v107, v19
    buffer_load_dwordx4 v[12:15], v1, s[28:31], s71 offen offset:512 nt
    v_fma_f32 v178, v120, v104, -v164
    v_fmac_f32 v178, v121, v105
    v_fmac_f32 v178, v122, v106
    v_fmac_f32 v178, v123, v107
    s_waitcnt vmcnt(24)
    v_cvt_f32_i32 v100, v20
    v_cvt_f32_i32 v101, v21
    v_cvt_f32_i32 v102, v22
    v_cvt_f32_i32 v103, v23
    s_add_u32 s71, s71, 3072
    buffer_load_dwordx4 v[16:19], v1, s[28:31], s71 offen offset:0 nt
    v_fmac_f32 v178, v124, v100
    v_fmac_f32 v178, v125, v101
    v_fmac_f32 v178, v126, v102
    v_fmac_f32 v178, v127, v103
    s_waitcnt vmcnt(24)
    v_cvt_f32_i32 v104, v24
    v_cvt_f32_i32 v105, v25
    v_cvt_f32_i32 v106, v26
    v_cvt_f32_i32 v107, v27
    buffer_load_dwordx4 v[20:23], v1, s[28:31], s71 offen offset:256 nt
    v_fmac_f32 v178, v128, v104
    v_fmac_f32 v178, v129, v105
    v_fmac_f32 v178, v130, v106
    v_fmac_f32 v178, v131, v107
    s_nop 1
    v_add_f32_dpp v179, v178, v178 row_ror:8 row_mask:0xf bank_mask:0xc
    s_nop 1
    v_add_f32_dpp v180, v179, v179 row_shl:4 row_mask:0xf bank_mask:0x5
    s_waitcnt vmcnt(24)
    v_cvt_f32_i32 v100, v28
    v_cvt_f32_i32 v101, v29
    v_cvt_f32_i32 v102, v30
    v_cvt_f32_i32 v103, v31
    buffer_load_dwordx4 v[24:27], v1, s[28:31], s71 offen offset:512 nt
    v_fma_f32 v178, v120, v100, -v164
    v_fmac_f32 v178, v121, v101
    v_fmac_f32 v178, v122, v102
    v_fmac_f32 v178, v123, v103
    s_waitcnt vmcnt(24)
    v_cvt_f32_i32 v104, v32
    v_cvt_f32_i32 v105, v33
    v_cvt_f32_i32 v106, v34
    v_cvt_f32_i32 v107, v35
    s_add_u32 s71, s71, 3072
    buffer_load_dwordx4 v[28:31], v1, s[28:31], s71 offen offset:0 nt
    v_fmac_f32 v178, v124, v104
    v_fmac_f32 v178, v125, v105
    v_fmac_f32 v178, v126, v106
    v_fmac_f32 v178, v127, v107
    s_waitcnt vmcnt(24)
    v_cvt_f32_i32 v100, v36
    v_cvt_f32_i32 v101, v37
    v_cvt_f32_i32 v102, v38
    v_cvt_f32_i32 v103, v39
    buffer_load_dwordx4 v[32:35], v1, s[28:31], s71 offen offset:256 nt
    v_fmac_f32 v178, v128, v100
    v_fmac_f32 v178, v129, v101
    v_fmac_f32 v178, v130, v102
    v_fmac_f32 v178, v131, v103
    s_nop 1
    v_add_f32_dpp v179, v178, v178 row_ror:8 row_mask:0xf bank_mask:0x3
    s_waitcnt vmcnt(24)
    v_cvt_f32_i32 v104, v40
    v_cvt_f32_i32 v105, v41
    v_cvt_f32_i32 v106, v42
    v_cvt_f32_i32 v107, v43
    buffer_load_dwordx4 v[36:39], v1, s[28:31], s71 offen offset:512 nt
    v_fma_f32 v178, v120, v104, -v164
    v_fmac_f32 v178, v121, v105
    v_fmac_f32 v178, v122, v106
    v_fmac_f32 v178, v123, v107
    s_waitcnt vmcnt(24)
    v_cvt_f32_i32 v100, v44
    v_cvt_f32_i32 v101, v45
    v_cvt_f32_i32 v102, v46
    v_cvt_f32_i32 v103, v47
    s_add_u32 s71, s71, 3072
    buffer_load_dwordx4 v[40:43], v1, s[28:31], s71 offen offset:0 nt
    v_fmac_f32 v178, v124, v100
    v_fmac_f32 v178, v125, v101
    v_fmac_f32 v178, v126, v102
    v_fmac_f32 v178, v127, v103
    s_waitcnt vmcnt(24)
    v_cvt_f32_i32 v104, v48
    v_cvt_f32_i32 v105, v49
    v_cvt_f32_i32 v106, v50
    v_cvt_f32_i32 v107, v51
    buffer_load_dwordx4 v[44:47], v1, s[28:31], s71 offen offset:256 nt
    v_fmac_f32 v178, v128, v104
    v_fmac_f32 v178, v129, v105
    v_fmac_f32 v178, v130, v106
    v_fmac_f32 v178, v131, v107
    s_nop 1
    v_add_f32_dpp v179, v178, v178 row_ror:8 row_mask:0xf bank_mask:0xc
    s_nop 1
    v_add_f32_dpp v180, v179, v179 row_shr:4 row_mask:0xf bank_mask:0xa
    s_nop 1
    v_add_f32_dpp v181, v180, v180 quad_perm:[2,3,0,1] row_mask:0xf bank_mask:0xf
    s_waitcnt vmcnt(24)
    v_cvt_f32_i32 v100, v52
    v_cvt_f32_i32 v101, v53
    v_cvt_f32_i32 v102, v54
    v_cvt_f32_i32 v103, v55
    buffer_load_dwordx4 v[48:51], v1, s[28:31], s71 offen offset:512 nt
    v_fma_f32 v178, v120, v100, -v164
    v_fmac_f32 v178, v121, v101
    v_fmac_f32 v178, v122, v102
    v_fmac_f32 v178, v123, v103
    s_waitcnt vmcnt(24)
    v_cvt_f32_i32 v104, v56
    v_cvt_f32_i32 v105, v57
    v_cvt_f32_i32 v106, v58
    v_cvt_f32_i32 v107, v59
    s_add_u32 s71, s71, 3072
    buffer_load_dwordx4 v[52:55], v1, s[28:31], s71 offen offset:0 nt
    v_fmac_f32 v178, v124, v104
    v_fmac_f32 v178, v125, v105
    v_fmac_f32 v178, v126, v106
    v_fmac_f32 v178, v127, v107
    s_waitcnt vmcnt(24)
    v_cvt_f32_i32 v100, v60
    v_cvt_f32_i32 v101, v61
    v_cvt_f32_i32 v102, v62
    v_cvt_f32_i32 v103, v63
    buffer_load_dwordx4 v[56:59], v1, s[28:31], s71 offen offset:256 nt
    v_fmac_f32 v178, v128, v100
    v_fmac_f32 v178, v129, v101
    v_fmac_f32 v178, v130, v102
    v_fmac_f32 v178, v131, v103
    s_nop 1
    v_add_f32_dpp v179, v178, v178 row_ror:8 row_mask:0xf bank_mask:0x3
    s_waitcnt vmcnt(24)
    v_cvt_f32_i32 v104, v64
    v_cvt_f32_i32 v105, v65
    v_cvt_f32_i32 v106, v66
    v_cvt_f32_i32 v107, v67
    buffer_load_dwordx4 v[60:63], v1, s[28:31], s71 offen offset:512 nt
    v_fma_f32 v178, v120, v104, -v164
    v_fmac_f32 v178, v121, v105
    v_fmac_f32 v178, v122, v106
    v_fmac_f32 v178, v123, v107
    s_waitcnt vmcnt(24)
    v_cvt_f32_i32 v100, v68
    v_cvt_f32_i32 v101, v69
    v_cvt_f32_i32 v102, v70
    v_cvt_f32_i32 v103, v71
    s_add_u32 s71, s71, 3072
    buffer_load_dwordx4 v[64:67], v1, s[28:31], s71 offen offset:0 nt
    v_fmac_f32 v178, v124, v100
    v_fmac_f32 v178, v125, v101
    v_fmac_f32 v178, v126, v102
    v_fmac_f32 v178, v127, v103
    s_waitcnt vmcnt(24)
    v_cvt_f32_i32 v104, v72
    v_cvt_f32_i32 v105, v73
    v_cvt_f32_i32 v106, v74
    v_cvt_f32_i32 v107, v75
    buffer_load_dwordx4 v[68:71], v1, s[28:31], s71 offen offset:256 nt
    v_fmac_f32 v178, v128, v104
    v_fmac_f32 v178, v129, v105
    v_fmac_f32 v178, v130, v106
    v_fmac_f32 v178, v131, v107
    s_nop 1
    v_add_f32_dpp v179, v178, v178 row_ror:8 row_mask:0xf bank_mask:0xc
    s_nop 1
    v_add_f32_dpp v180, v179, v179 row_shl:4 row_mask:0xf bank_mask:0x5
    s_waitcnt vmcnt(24)
    v_cvt_f32_i32 v100, v76
    v_cvt_f32_i32 v101, v77
    v_cvt_f32_i32 v102, v78
    v_cvt_f32_i32 v103, v79
    buffer_load_dwordx4 v[72:75], v1, s[28:31], s71 offen offset:512 nt
    v_fma_f32 v178, v120, v100, -v164
    v_fmac_f32 v178, v121, v101
    v_fmac_f32 v178, v122, v102
    v_fmac_f32 v178, v123, v103
    s_waitcnt vmcnt(24)
    v_cvt_f32_i32 v104, v80
    v_cvt_f32_i32 v105, v81
    v_cvt_f32_i32 v106, v82
    v_cvt_f32_i32 v107, v83
    s_add_u32 s71, s71, 3072
    buffer_load_dwordx4 v[76:79], v1, s[28:31], s71 offen offset:0 nt
    v_fmac_f32 v178, v124, v104
    v_fmac_f32 v178, v125, v105
    v_fmac_f32 v178, v126, v106
    v_fmac_f32 v178, v127, v107
    s_waitcnt vmcnt(24)
    v_cvt_f32_i32 v100, v84
    v_cvt_f32_i32 v101, v85
    v_cvt_f32_i32 v102, v86
    v_cvt_f32_i32 v103, v87
    buffer_load_dwordx4 v[80:83], v1, s[28:31], s71 offen offset:256 nt
    v_fmac_f32 v178, v128, v100
    v_fmac_f32 v178, v129, v101
    v_fmac_f32 v178, v130, v102
    v_fmac_f32 v178, v131, v103
    s_nop 1
    v_add_f32_dpp v179, v178, v178 row_ror:8 row_mask:0xf bank_mask:0x3
    s_waitcnt vmcnt(24)
    v_cvt_f32_i32 v104, v88
    v_cvt_f32_i32 v105, v89
    v_cvt_f32_i32 v106, v90
    v_cvt_f32_i32 v107, v91
    buffer_load_dwordx4 v[84:87], v1, s[28:31], s71 offen offset:512 nt
    v_fma_f32 v178, v120, v104, -v164
    v_fmac_f32 v178, v121, v105
    v_fmac_f32 v178, v122, v106
    v_fmac_f32 v178, v123, v107
    s_waitcnt vmcnt(24)
    v_cvt_f32_i32 v100, v92
    v_cvt_f32_i32 v101, v93
    v_cvt_f32_i32 v102, v94
    v_cvt_f32_i32 v103, v95
    s_add_u32 s71, s71, 3072
    buffer_load_dwordx4 v[88:91], v1, s[28:31], s71 offen offset:0 nt
    v_fmac_f32 v178, v124, v100
    v_fmac_f32 v178, v125, v101
    v_fmac_f32 v178, v126, v102
    v_fmac_f32 v178, v127, v103
    s_waitcnt vmcnt(24)
    v_cvt_f32_i32 v104, v96
    v_cvt_f32_i32 v105, v97
    v_cvt_f32_i32 v106, v98
    v_cvt_f32_i32 v107, v99
    buffer_load_dwordx4 v[92:95], v1, s[28:31], s71 offen offset:256 nt
    v_fmac_f32 v178, v128, v104
    v_fmac_f32 v178, v129, v105
    v_fmac_f32 v178, v130, v106
    v_fmac_f32 v178, v131, v107
    s_nop 1
    v_add_f32_dpp v179, v178, v178 row_ror:8 row_mask:0xf bank_mask:0xc
    s_nop 1
    v_add_f32_dpp v180, v179, v179 row_shr:4 row_mask:0xf bank_mask:0xa
    s_nop 1
    v_add_f32_dpp v182, v180, v180 quad_perm:[2,3,0,1] row_mask:0xf bank_mask:0xf
    v_cndmask_b32 v182, v181, v182, s[64:65]
    s_nop 1
    v_add_f32_dpp v181, v182, v182 quad_perm:[1,0,3,2] row_mask:0xf bank_mask:0xf
    v_cndmask_b32 v183, v183, v181, s[66:67]
    ds_write_b32 v186, v183
    v_add_u32 v186, 256, v186
    s_mov_b64 exec, 1
    ds_add_u32 v191, v191 offset:127
    s_mov_b64 exec, -1
    ds_read_b32 v172, v187
    v_add_u32 v187, 256, v187
    s_mov_b32 s76, 55
L_loop1:
    s_waitcnt vmcnt(23)
    v_lshlrev_b32 v168, 16, v168
    v_lshlrev_b32 v169, 16, v169
    s_waitcnt lgkmcnt(0)
    v_max_f32_dpp v184, v172, v172 row_ror:8 row_mask:0xf bank_mask:0xf
    s_nop 1
    v_max_f32_dpp v184, v184, v184 row_ror:4 row_mask:0xf bank_mask:0xf
    s_nop 1
    v_max_f32_dpp v184, v184, v184 row_ror:2 row_mask:0xf bank_mask:0xf
    s_nop 1
    v_max_f32_dpp v184, v184, v184 row_ror:1 row_mask:0xf bank_mask:0xf
    v_max_f32 v184, v184, v165
    v_sub_f32 v185, v165, v184
    v_sub_f32 v170, v172, v184
    v_exp_f32 v185, v185
    v_exp_f32 v170, v170
    v_mov_b32 v165, v184
    v_fma_f32 v166, v166, v185, v170
    v_mul_f32 v170, v170, v168
    v_mul_f32 v167, v167, v185
    v_fmac_f32 v167, v170, v169
    ds_read_b32 v172, v187
    v_add_u32 v187, 256, v187
    v_mul_f32 v152, v152, v185
    v_mul_f32 v153, v153, v185
    v_mul_f32 v154, v154, v185
    v_mul_f32 v155, v155, v185
    v_mul_f32 v156, v156, v185
    v_mul_f32 v157, v157, v185
    v_mul_f32 v158, v158, v185
    v_mul_f32 v159, v159, v185
    v_mul_f32 v160, v160, v185
    v_mul_f32 v161, v161, v185
    v_mul_f32 v162, v162, v185
    v_mul_f32 v163, v163, v185
    s_waitcnt vmcnt(22)
    v_cvt_f32_i32 v100, v4
    v_cvt_f32_i32 v101, v5
    v_cvt_f32_i32 v102, v6
    v_cvt_f32_i32 v103, v7
    buffer_load_dwordx4 v[96:99], v1, s[28:31], s71 offen offset:512 nt
    v_fmac_f32_dpp v152, v170, v100 row_newbcast:0 row_mask:0xf bank_mask:0xf
    v_fmac_f32_dpp v153, v170, v101 row_newbcast:0 row_mask:0xf bank_mask:0xf
    v_fmac_f32_dpp v154, v170, v102 row_newbcast:0 row_mask:0xf bank_mask:0xf
    v_fmac_f32_dpp v155, v170, v103 row_newbcast:0 row_mask:0xf bank_mask:0xf
    s_waitcnt vmcnt(22)
    v_cvt_f32_i32 v104, v8
    v_cvt_f32_i32 v105, v9
    v_cvt_f32_i32 v106, v10
    v_cvt_f32_i32 v107, v11
    s_add_u32 s71, s71, 3072
    buffer_load_dwordx4 v[4:7], v1, s[28:31], s71 offen offset:0 nt
    v_fmac_f32_dpp v156, v170, v104 row_newbcast:0 row_mask:0xf bank_mask:0xf
    v_fmac_f32_dpp v157, v170, v105 row_newbcast:0 row_mask:0xf bank_mask:0xf
    v_fmac_f32_dpp v158, v170, v106 row_newbcast:0 row_mask:0xf bank_mask:0xf
    v_fmac_f32_dpp v159, v170, v107 row_newbcast:0 row_mask:0xf bank_mask:0xf
    s_waitcnt vmcnt(22)
    v_cvt_f32_i32 v100, v12
    v_cvt_f32_i32 v101, v13
    v_cvt_f32_i32 v102, v14
    v_cvt_f32_i32 v103, v15
    buffer_load_dwordx4 v[8:11], v1, s[28:31], s71 offen offset:256 nt
    v_fmac_f32_dpp v160, v170, v100 row_newbcast:0 row_mask:0xf bank_mask:0xf
    v_fmac_f32_dpp v161, v170, v101 row_newbcast:0 row_mask:0xf bank_mask:0xf
    v_fmac_f32_dpp v162, v170, v102 row_newbcast:0 row_mask:0xf bank_mask:0xf
    v_fmac_f32_dpp v163, v170, v103 row_newbcast:0 row_mask:0xf bank_mask:0xf
    s_waitcnt vmcnt(22)
    v_cvt_f32_i32 v104, v16
    v_cvt_f32_i32 v105, v17
    v_cvt_f32_i32 v106, v18
    v_cvt_f32_i32 v107, v19
    buffer_load_dwordx4 v[12:15], v1, s[28:31], s71 offen offset:512 nt
    v_fmac_f32_dpp v152, v170, v104 row_newbcast:8 row_mask:0xf bank_mask:0xf
    v_fmac_f32_dpp v153, v170, v105 row_newbcast:8 row_mask:0xf bank_mask:0xf
    v_fmac_f32_dpp v154, v170, v106 row_newbcast:8 row_mask:0xf bank_mask:0xf
    v_fmac_f32_dpp v155, v170, v107 row_newbcast:8 row_mask:0xf bank_mask:0xf
    s_waitcnt vmcnt(22)
    v_cvt_f32_i32 v100, v20
    v_cvt_f32_i32 v101, v21
    v_cvt_f32_i32 v102, v22
    v_cvt_f32_i32 v103, v23
    s_add_u32 s71, s71, 3072
    buffer_load_dwordx4 v[16:19], v1, s[28:31], s71 offen offset:0 nt
    v_fmac_f32_dpp v156, v170, v100 row_newbcast:8 row_mask:0xf bank_mask:0xf
    v_fmac_f32_dpp v157, v170, v101 row_newbcast:8 row_mask:0xf bank_mask:0xf
    v_fmac_f32_dpp v158, v170, v102 row_newbcast:8 row_mask:0xf bank_mask:0xf
    v_fmac_f32_dpp v159, v170, v103 row_newbcast:8 row_mask:0xf bank_mask:0xf
    s_waitcnt vmcnt(22)
    v_cvt_f32_i32 v104, v24
    v_cvt_f32_i32 v105, v25
    v_cvt_f32_i32 v106, v26
    v_cvt_f32_i32 v107, v27
    buffer_load_dwordx4 v[20:23], v1, s[28:31], s71 offen offset:256 nt
    v_fmac_f32_dpp v160, v170, v104 row_newbcast:8 row_mask:0xf bank_mask:0xf
    v_fmac_f32_dpp v161, v170, v105 row_newbcast:8 row_mask:0xf bank_mask:0xf
    v_fmac_f32_dpp v162, v170, v106 row_newbcast:8 row_mask:0xf bank_mask:0xf
    v_fmac_f32_dpp v163, v170, v107 row_newbcast:8 row_mask:0xf bank_mask:0xf
    s_waitcnt vmcnt(22)
    v_cvt_f32_i32 v100, v28
    v_cvt_f32_i32 v101, v29
    v_cvt_f32_i32 v102, v30
    v_cvt_f32_i32 v103, v31
    buffer_load_dwordx4 v[24:27], v1, s[28:31], s71 offen offset:512 nt
    v_fmac_f32_dpp v152, v170, v100 row_newbcast:4 row_mask:0xf bank_mask:0xf
    v_fmac_f32_dpp v153, v170, v101 row_newbcast:4 row_mask:0xf bank_mask:0xf
    v_fmac_f32_dpp v154, v170, v102 row_newbcast:4 row_mask:0xf bank_mask:0xf
    v_fmac_f32_dpp v155, v170, v103 row_newbcast:4 row_mask:0xf bank_mask:0xf
    s_waitcnt vmcnt(22)
    v_cvt_f32_i32 v104, v32
    v_cvt_f32_i32 v105, v33
    v_cvt_f32_i32 v106, v34
    v_cvt_f32_i32 v107, v35
    s_add_u32 s71, s71, 3072
    buffer_load_dwordx4 v[28:31], v1, s[28:31], s71 offen offset:0 nt
    v_fmac_f32_dpp v156, v170, v104 row_newbcast:4 row_mask:0xf bank_mask:0xf
    v_fmac_f32_dpp v157, v170, v105 row_newbcast:4 row_mask:0xf bank_mask:0xf
    v_fmac_f32_dpp v158, v170, v106 row_newbcast:4 row_mask:0xf bank_mask:0xf
    v_fmac_f32_dpp v159, v170, v107 row_newbcast:4 row_mask:0xf bank_mask:0xf
    s_waitcnt vmcnt(22)
    v_cvt_f32_i32 v100, v36
    v_cvt_f32_i32 v101, v37
    v_cvt_f32_i32 v102, v38
    v_cvt_f32_i32 v103, v39
    buffer_load_dwordx4 v[32:35], v1, s[28:31], s71 offen offset:256 nt
    v_fmac_f32_dpp v160, v170, v100 row_newbcast:4 row_mask:0xf bank_mask:0xf
    v_fmac_f32_dpp v161, v170, v101 row_newbcast:4 row_mask:0xf bank_mask:0xf
    v_fmac_f32_dpp v162, v170, v102 row_newbcast:4 row_mask:0xf bank_mask:0xf
    v_fmac_f32_dpp v163, v170, v103 row_newbcast:4 row_mask:0xf bank_mask:0xf
    s_waitcnt vmcnt(22)
    v_cvt_f32_i32 v104, v40
    v_cvt_f32_i32 v105, v41
    v_cvt_f32_i32 v106, v42
    v_cvt_f32_i32 v107, v43
    buffer_load_dwordx4 v[36:39], v1, s[28:31], s71 offen offset:512 nt
    v_fmac_f32_dpp v152, v170, v104 row_newbcast:12 row_mask:0xf bank_mask:0xf
    v_fmac_f32_dpp v153, v170, v105 row_newbcast:12 row_mask:0xf bank_mask:0xf
    v_fmac_f32_dpp v154, v170, v106 row_newbcast:12 row_mask:0xf bank_mask:0xf
    v_fmac_f32_dpp v155, v170, v107 row_newbcast:12 row_mask:0xf bank_mask:0xf
    s_waitcnt vmcnt(22)
    v_cvt_f32_i32 v100, v44
    v_cvt_f32_i32 v101, v45
    v_cvt_f32_i32 v102, v46
    v_cvt_f32_i32 v103, v47
    s_add_u32 s71, s71, 3072
    buffer_load_dwordx4 v[40:43], v1, s[28:31], s71 offen offset:0 nt
    v_fmac_f32_dpp v156, v170, v100 row_newbcast:12 row_mask:0xf bank_mask:0xf
    v_fmac_f32_dpp v157, v170, v101 row_newbcast:12 row_mask:0xf bank_mask:0xf
    v_fmac_f32_dpp v158, v170, v102 row_newbcast:12 row_mask:0xf bank_mask:0xf
    v_fmac_f32_dpp v159, v170, v103 row_newbcast:12 row_mask:0xf bank_mask:0xf
    s_waitcnt vmcnt(22)
    v_cvt_f32_i32 v104, v48
    v_cvt_f32_i32 v105, v49
    v_cvt_f32_i32 v106, v50
    v_cvt_f32_i32 v107, v51
    buffer_load_dwordx4 v[44:47], v1, s[28:31], s71 offen offset:256 nt
    v_fmac_f32_dpp v160, v170, v104 row_newbcast:12 row_mask:0xf bank_mask:0xf
    v_fmac_f32_dpp v161, v170, v105 row_newbcast:12 row_mask:0xf bank_mask:0xf
    v_fmac_f32_dpp v162, v170, v106 row_newbcast:12 row_mask:0xf bank_mask:0xf
    v_fmac_f32_dpp v163, v170, v107 row_newbcast:12 row_mask:0xf bank_mask:0xf
    s_waitcnt vmcnt(22)
    v_cvt_f32_i32 v100, v52
    v_cvt_f32_i32 v101, v53
    v_cvt_f32_i32 v102, v54
    v_cvt_f32_i32 v103, v55
    buffer_load_dwordx4 v[48:51], v1, s[28:31], s71 offen offset:512 nt
    v_fmac_f32_dpp v152, v170, v100 row_newbcast:2 row_mask:0xf bank_mask:0xf
    v_fmac_f32_dpp v153, v170, v101 row_newbcast:2 row_mask:0xf bank_mask:0xf
    v_fmac_f32_dpp v154, v170, v102 row_newbcast:2 row_mask:0xf bank_mask:0xf
    v_fmac_f32_dpp v155, v170, v103 row_newbcast:2 row_mask:0xf bank_mask:0xf
    s_waitcnt vmcnt(22)
    v_cvt_f32_i32 v104, v56
    v_cvt_f32_i32 v105, v57
    v_cvt_f32_i32 v106, v58
    v_cvt_f32_i32 v107, v59
    s_add_u32 s71, s71, 3072
    buffer_load_dwordx4 v[52:55], v1, s[28:31], s71 offen offset:0 nt
    v_fmac_f32_dpp v156, v170, v104 row_newbcast:2 row_mask:0xf bank_mask:0xf
    v_fmac_f32_dpp v157, v170, v105 row_newbcast:2 row_mask:0xf bank_mask:0xf
    v_fmac_f32_dpp v158, v170, v106 row_newbcast:2 row_mask:0xf bank_mask:0xf
    v_fmac_f32_dpp v159, v170, v107 row_newbcast:2 row_mask:0xf bank_mask:0xf
    s_waitcnt vmcnt(22)
    v_cvt_f32_i32 v100, v60
    v_cvt_f32_i32 v101, v61
    v_cvt_f32_i32 v102, v62
    v_cvt_f32_i32 v103, v63
    buffer_load_dwordx4 v[56:59], v1, s[28:31], s71 offen offset:256 nt
    v_fmac_f32_dpp v160, v170, v100 row_newbcast:2 row_mask:0xf bank_mask:0xf
    v_fmac_f32_dpp v161, v170, v101 row_newbcast:2 row_mask:0xf bank_mask:0xf
    v_fmac_f32_dpp v162, v170, v102 row_newbcast:2 row_mask:0xf bank_mask:0xf
    v_fmac_f32_dpp v163, v170, v103 row_newbcast:2 row_mask:0xf bank_mask:0xf
    s_waitcnt vmcnt(22)
    v_cvt_f32_i32 v104, v64
    v_cvt_f32_i32 v105, v65
    v_cvt_f32_i32 v106, v66
    v_cvt_f32_i32 v107, v67
    buffer_load_dwordx4 v[60:63], v1, s[28:31], s71 offen offset:512 nt
    v_fmac_f32_dpp v152, v170, v104 row_newbcast:10 row_mask:0xf bank_mask:0xf
    v_fmac_f32_dpp v153, v170, v105 row_newbcast:10 row_mask:0xf bank_mask:0xf
    v_fmac_f32_dpp v154, v170, v106 row_newbcast:10 row_mask:0xf bank_mask:0xf
    v_fmac_f32_dpp v155, v170, v107 row_newbcast:10 row_mask:0xf bank_mask:0xf
    s_waitcnt vmcnt(22)
    v_cvt_f32_i32 v100, v68
    v_cvt_f32_i32 v101, v69
    v_cvt_f32_i32 v102, v70
    v_cvt_f32_i32 v103, v71
    s_add_u32 s71, s71, 3072
    buffer_load_dwordx4 v[64:67], v1, s[28:31], s71 offen offset:0 nt
    v_fmac_f32_dpp v156, v170, v100 row_newbcast:10 row_mask:0xf bank_mask:0xf
    v_fmac_f32_dpp v157, v170, v101 row_newbcast:10 row_mask:0xf bank_mask:0xf
    v_fmac_f32_dpp v158, v170, v102 row_newbcast:10 row_mask:0xf bank_mask:0xf
    v_fmac_f32_dpp v159, v170, v103 row_newbcast:10 row_mask:0xf bank_mask:0xf
    s_waitcnt vmcnt(22)
    v_cvt_f32_i32 v104, v72
    v_cvt_f32_i32 v105, v73
    v_cvt_f32_i32 v106, v74
    v_cvt_f32_i32 v107, v75
    buffer_load_dwordx4 v[68:71], v1, s[28:31], s71 offen offset:256 nt
    v_fmac_f32_dpp v160, v170, v104 row_newbcast:10 row_mask:0xf bank_mask:0xf
    v_fmac_f32_dpp v161, v170, v105 row_newbcast:10 row_mask:0xf bank_mask:0xf
    v_fmac_f32_dpp v162, v170, v106 row_newbcast:10 row_mask:0xf bank_mask:0xf
    v_fmac_f32_dpp v163, v170, v107 row_newbcast:10 row_mask:0xf bank_mask:0xf
    s_waitcnt vmcnt(22)
    v_cvt_f32_i32 v100, v76
    v_cvt_f32_i32 v101, v77
    v_cvt_f32_i32 v102, v78
    v_cvt_f32_i32 v103, v79
    buffer_load_dwordx4 v[72:75], v1, s[28:31], s71 offen offset:512 nt
    v_fmac_f32_dpp v152, v170, v100 row_newbcast:6 row_mask:0xf bank_mask:0xf
    v_fmac_f32_dpp v153, v170, v101 row_newbcast:6 row_mask:0xf bank_mask:0xf
    v_fmac_f32_dpp v154, v170, v102 row_newbcast:6 row_mask:0xf bank_mask:0xf
    v_fmac_f32_dpp v155, v170, v103 row_newbcast:6 row_mask:0xf bank_mask:0xf
    s_waitcnt vmcnt(22)
    v_cvt_f32_i32 v104, v80
    v_cvt_f32_i32 v105, v81
    v_cvt_f32_i32 v106, v82
    v_cvt_f32_i32 v107, v83
    s_add_u32 s71, s71, 3072
    buffer_load_dwordx4 v[76:79], v1, s[28:31], s71 offen offset:0 nt
    v_fmac_f32_dpp v156, v170, v104 row_newbcast:6 row_mask:0xf bank_mask:0xf
    v_fmac_f32_dpp v157, v170, v105 row_newbcast:6 row_mask:0xf bank_mask:0xf
    v_fmac_f32_dpp v158, v170, v106 row_newbcast:6 row_mask:0xf bank_mask:0xf
    v_fmac_f32_dpp v159, v170, v107 row_newbcast:6 row_mask:0xf bank_mask:0xf
    s_waitcnt vmcnt(22)
    v_cvt_f32_i32 v100, v84
    v_cvt_f32_i32 v101, v85
    v_cvt_f32_i32 v102, v86
    v_cvt_f32_i32 v103, v87
    buffer_load_dwordx4 v[80:83], v1, s[28:31], s71 offen offset:256 nt
    v_fmac_f32_dpp v160, v170, v100 row_newbcast:6 row_mask:0xf bank_mask:0xf
    v_fmac_f32_dpp v161, v170, v101 row_newbcast:6 row_mask:0xf bank_mask:0xf
    v_fmac_f32_dpp v162, v170, v102 row_newbcast:6 row_mask:0xf bank_mask:0xf
    v_fmac_f32_dpp v163, v170, v103 row_newbcast:6 row_mask:0xf bank_mask:0xf
    s_waitcnt vmcnt(22)
    v_cvt_f32_i32 v104, v88
    v_cvt_f32_i32 v105, v89
    v_cvt_f32_i32 v106, v90
    v_cvt_f32_i32 v107, v91
    buffer_load_dwordx4 v[84:87], v1, s[28:31], s71 offen offset:512 nt
    v_fmac_f32_dpp v152, v170, v104 row_newbcast:14 row_mask:0xf bank_mask:0xf
    v_fmac_f32_dpp v153, v170, v105 row_newbcast:14 row_mask:0xf bank_mask:0xf
    v_fmac_f32_dpp v154, v170, v106 row_newbcast:14 row_mask:0xf bank_mask:0xf
    v_fmac_f32_dpp v155, v170, v107 row_newbcast:14 row_mask:0xf bank_mask:0xf
    s_waitcnt vmcnt(22)
    v_cvt_f32_i32 v100, v92
    v_cvt_f32_i32 v101, v93
    v_cvt_f32_i32 v102, v94
    v_cvt_f32_i32 v103, v95
    s_add_u32 s71, s71, 3072
    buffer_load_dwordx4 v[88:91], v1, s[28:31], s71 offen offset:0 nt
    v_fmac_f32_dpp v156, v170, v100 row_newbcast:14 row_mask:0xf bank_mask:0xf
    v_fmac_f32_dpp v157, v170, v101 row_newbcast:14 row_mask:0xf bank_mask:0xf
    v_fmac_f32_dpp v158, v170, v102 row_newbcast:14 row_mask:0xf bank_mask:0xf
    v_fmac_f32_dpp v159, v170, v103 row_newbcast:14 row_mask:0xf bank_mask:0xf
    s_waitcnt vmcnt(22)
    v_cvt_f32_i32 v104, v96
    v_cvt_f32_i32 v105, v97
    v_cvt_f32_i32 v106, v98
    v_cvt_f32_i32 v107, v99
    buffer_load_dwordx4 v[92:95], v1, s[28:31], s71 offen offset:256 nt
    v_fmac_f32_dpp v160, v170, v104 row_newbcast:14 row_mask:0xf bank_mask:0xf
    v_fmac_f32_dpp v161, v170, v105 row_newbcast:14 row_mask:0xf bank_mask:0xf
    v_fmac_f32_dpp v162, v170, v106 row_newbcast:14 row_mask:0xf bank_mask:0xf
    v_fmac_f32_dpp v163, v170, v107 row_newbcast:14 row_mask:0xf bank_mask:0xf
    s_waitcnt vmcnt(22)
    v_cvt_f32_i32 v100, v4
    v_cvt_f32_i32 v101, v5
    v_cvt_f32_i32 v102, v6
    v_cvt_f32_i32 v103, v7
    buffer_load_dwordx4 v[96:99], v1, s[28:31], s71 offen offset:512 nt
    v_fmac_f32_dpp v152, v170, v100 row_newbcast:1 row_mask:0xf bank_mask:0xf
    v_fmac_f32_dpp v153, v170, v101 row_newbcast:1 row_mask:0xf bank_mask:0xf
    v_fmac_f32_dpp v154, v170, v102 row_newbcast:1 row_mask:0xf bank_mask:0xf
    v_fmac_f32_dpp v155, v170, v103 row_newbcast:1 row_mask:0xf bank_mask:0xf
    s_waitcnt vmcnt(22)
    v_cvt_f32_i32 v104, v8
    v_cvt_f32_i32 v105, v9
    v_cvt_f32_i32 v106, v10
    v_cvt_f32_i32 v107, v11
    s_add_u32 s70, s70, 64
    s_sub_u32 s75, s75, 1
    s_cmp_eq_u32 s75, 0
    s_cselect_b32 s80, 1536, 0
    s_cselect_b32 s75, 8, s75
    s_add_u32 s70, s70, s80
    s_lshl_b32 s73, s70, 7
    buffer_load_ushort v168, v3, s[40:43], s73 offen
    buffer_load_ushort v169, v3, s[44:47], s73 offen
    s_mul_i32 s71, s70, 49152
    buffer_load_dwordx4 v[4:7], v1, s[28:31], s71 offen offset:0 nt
    v_fmac_f32_dpp v156, v170, v104 row_newbcast:1 row_mask:0xf bank_mask:0xf
    v_fmac_f32_dpp v157, v170, v105 row_newbcast:1 row_mask:0xf bank_mask:0xf
    v_fmac_f32_dpp v158, v170, v106 row_newbcast:1 row_mask:0xf bank_mask:0xf
    v_fmac_f32_dpp v159, v170, v107 row_newbcast:1 row_mask:0xf bank_mask:0xf
    s_waitcnt vmcnt(24)
    v_cvt_f32_i32 v100, v12
    v_cvt_f32_i32 v101, v13
    v_cvt_f32_i32 v102, v14
    v_cvt_f32_i32 v103, v15
    buffer_load_dwordx4 v[8:11], v1, s[28:31], s71 offen offset:256 nt
    v_fmac_f32_dpp v160, v170, v100 row_newbcast:1 row_mask:0xf bank_mask:0xf
    v_fmac_f32_dpp v161, v170, v101 row_newbcast:1 row_mask:0xf bank_mask:0xf
    v_fmac_f32_dpp v162, v170, v102 row_newbcast:1 row_mask:0xf bank_mask:0xf
    v_fmac_f32_dpp v163, v170, v103 row_newbcast:1 row_mask:0xf bank_mask:0xf
    s_waitcnt vmcnt(24)
    v_cvt_f32_i32 v104, v16
    v_cvt_f32_i32 v105, v17
    v_cvt_f32_i32 v106, v18
    v_cvt_f32_i32 v107, v19
    buffer_load_dwordx4 v[12:15], v1, s[28:31], s71 offen offset:512 nt
    v_fmac_f32_dpp v152, v170, v104 row_newbcast:9 row_mask:0xf bank_mask:0xf
    v_fmac_f32_dpp v153, v170, v105 row_newbcast:9 row_mask:0xf bank_mask:0xf
    v_fmac_f32_dpp v154, v170, v106 row_newbcast:9 row_mask:0xf bank_mask:0xf
    v_fmac_f32_dpp v155, v170, v107 row_newbcast:9 row_mask:0xf bank_mask:0xf
    s_waitcnt vmcnt(24)
    v_cvt_f32_i32 v100, v20
    v_cvt_f32_i32 v101, v21
    v_cvt_f32_i32 v102, v22
    v_cvt_f32_i32 v103, v23
    s_add_u32 s71, s71, 3072
    buffer_load_dwordx4 v[16:19], v1, s[28:31], s71 offen offset:0 nt
    v_fmac_f32_dpp v156, v170, v100 row_newbcast:9 row_mask:0xf bank_mask:0xf
    v_fmac_f32_dpp v157, v170, v101 row_newbcast:9 row_mask:0xf bank_mask:0xf
    v_fmac_f32_dpp v158, v170, v102 row_newbcast:9 row_mask:0xf bank_mask:0xf
    v_fmac_f32_dpp v159, v170, v103 row_newbcast:9 row_mask:0xf bank_mask:0xf
    s_waitcnt vmcnt(24)
    v_cvt_f32_i32 v104, v24
    v_cvt_f32_i32 v105, v25
    v_cvt_f32_i32 v106, v26
    v_cvt_f32_i32 v107, v27
    buffer_load_dwordx4 v[20:23], v1, s[28:31], s71 offen offset:256 nt
    v_fmac_f32_dpp v160, v170, v104 row_newbcast:9 row_mask:0xf bank_mask:0xf
    v_fmac_f32_dpp v161, v170, v105 row_newbcast:9 row_mask:0xf bank_mask:0xf
    v_fmac_f32_dpp v162, v170, v106 row_newbcast:9 row_mask:0xf bank_mask:0xf
    v_fmac_f32_dpp v163, v170, v107 row_newbcast:9 row_mask:0xf bank_mask:0xf
    s_waitcnt vmcnt(24)
    v_cvt_f32_i32 v100, v28
    v_cvt_f32_i32 v101, v29
    v_cvt_f32_i32 v102, v30
    v_cvt_f32_i32 v103, v31
    buffer_load_dwordx4 v[24:27], v1, s[28:31], s71 offen offset:512 nt
    v_fmac_f32_dpp v152, v170, v100 row_newbcast:5 row_mask:0xf bank_mask:0xf
    v_fmac_f32_dpp v153, v170, v101 row_newbcast:5 row_mask:0xf bank_mask:0xf
    v_fmac_f32_dpp v154, v170, v102 row_newbcast:5 row_mask:0xf bank_mask:0xf
    v_fmac_f32_dpp v155, v170, v103 row_newbcast:5 row_mask:0xf bank_mask:0xf
    s_waitcnt vmcnt(24)
    v_cvt_f32_i32 v104, v32
    v_cvt_f32_i32 v105, v33
    v_cvt_f32_i32 v106, v34
    v_cvt_f32_i32 v107, v35
    s_add_u32 s71, s71, 3072
    buffer_load_dwordx4 v[28:31], v1, s[28:31], s71 offen offset:0 nt
    v_fmac_f32_dpp v156, v170, v104 row_newbcast:5 row_mask:0xf bank_mask:0xf
    v_fmac_f32_dpp v157, v170, v105 row_newbcast:5 row_mask:0xf bank_mask:0xf
    v_fmac_f32_dpp v158, v170, v106 row_newbcast:5 row_mask:0xf bank_mask:0xf
    v_fmac_f32_dpp v159, v170, v107 row_newbcast:5 row_mask:0xf bank_mask:0xf
    s_waitcnt vmcnt(24)
    v_cvt_f32_i32 v100, v36
    v_cvt_f32_i32 v101, v37
    v_cvt_f32_i32 v102, v38
    v_cvt_f32_i32 v103, v39
    buffer_load_dwordx4 v[32:35], v1, s[28:31], s71 offen offset:256 nt
    v_fmac_f32_dpp v160, v170, v100 row_newbcast:5 row_mask:0xf bank_mask:0xf
    v_fmac_f32_dpp v161, v170, v101 row_newbcast:5 row_mask:0xf bank_mask:0xf
    v_fmac_f32_dpp v162, v170, v102 row_newbcast:5 row_mask:0xf bank_mask:0xf
    v_fmac_f32_dpp v163, v170, v103 row_newbcast:5 row_mask:0xf bank_mask:0xf
    s_waitcnt vmcnt(24)
    v_cvt_f32_i32 v104, v40
    v_cvt_f32_i32 v105, v41
    v_cvt_f32_i32 v106, v42
    v_cvt_f32_i32 v107, v43
    buffer_load_dwordx4 v[36:39], v1, s[28:31], s71 offen offset:512 nt
    v_fmac_f32_dpp v152, v170, v104 row_newbcast:13 row_mask:0xf bank_mask:0xf
    v_fmac_f32_dpp v153, v170, v105 row_newbcast:13 row_mask:0xf bank_mask:0xf
    v_fmac_f32_dpp v154, v170, v106 row_newbcast:13 row_mask:0xf bank_mask:0xf
    v_fmac_f32_dpp v155, v170, v107 row_newbcast:13 row_mask:0xf bank_mask:0xf
    s_waitcnt vmcnt(24)
    v_cvt_f32_i32 v100, v44
    v_cvt_f32_i32 v101, v45
    v_cvt_f32_i32 v102, v46
    v_cvt_f32_i32 v103, v47
    s_add_u32 s71, s71, 3072
    buffer_load_dwordx4 v[40:43], v1, s[28:31], s71 offen offset:0 nt
    v_fmac_f32_dpp v156, v170, v100 row_newbcast:13 row_mask:0xf bank_mask:0xf
    v_fmac_f32_dpp v157, v170, v101 row_newbcast:13 row_mask:0xf bank_mask:0xf
    v_fmac_f32_dpp v158, v170, v102 row_newbcast:13 row_mask:0xf bank_mask:0xf
    v_fmac_f32_dpp v159, v170, v103 row_newbcast:13 row_mask:0xf bank_mask:0xf
    s_waitcnt vmcnt(24)
    v_cvt_f32_i32 v104, v48
    v_cvt_f32_i32 v105, v49
    v_cvt_f32_i32 v106, v50
    v_cvt_f32_i32 v107, v51
    buffer_load_dwordx4 v[44:47], v1, s[28:31], s71 offen offset:256 nt
    v_fmac_f32_dpp v160, v170, v104 row_newbcast:13 row_mask:0xf bank_mask:0xf
    v_fmac_f32_dpp v161, v170, v105 row_newbcast:13 row_mask:0xf bank_mask:0xf
    v_fmac_f32_dpp v162, v170, v106 row_newbcast:13 row_mask:0xf bank_mask:0xf
    v_fmac_f32_dpp v163, v170, v107 row_newbcast:13 row_mask:0xf bank_mask:0xf
    s_waitcnt vmcnt(24)
    v_cvt_f32_i32 v100, v52
    v_cvt_f32_i32 v101, v53
    v_cvt_f32_i32 v102, v54
    v_cvt_f32_i32 v103, v55
    buffer_load_dwordx4 v[48:51], v1, s[28:31], s71 offen offset:512 nt
    v_fmac_f32_dpp v152, v170, v100 row_newbcast:3 row_mask:0xf bank_mask:0xf
    v_fmac_f32_dpp v153, v170, v101 row_newbcast:3 row_mask:0xf bank_mask:0xf
    v_fmac_f32_dpp v154, v170, v102 row_newbcast:3 row_mask:0xf bank_mask:0xf
    v_fmac_f32_dpp v155, v170, v103 row_newbcast:3 row_mask:0xf bank_mask:0xf
    s_waitcnt vmcnt(24)
    v_cvt_f32_i32 v104, v56
    v_cvt_f32_i32 v105, v57
    v_cvt_f32_i32 v106, v58
    v_cvt_f32_i32 v107, v59
    s_add_u32 s71, s71, 3072
    buffer_load_dwordx4 v[52:55], v1, s[28:31], s71 offen offset:0 nt
    v_fmac_f32_dpp v156, v170, v104 row_newbcast:3 row_mask:0xf bank_mask:0xf
    v_fmac_f32_dpp v157, v170, v105 row_newbcast:3 row_mask:0xf bank_mask:0xf
    v_fmac_f32_dpp v158, v170, v106 row_newbcast:3 row_mask:0xf bank_mask:0xf
    v_fmac_f32_dpp v159, v170, v107 row_newbcast:3 row_mask:0xf bank_mask:0xf
    s_waitcnt vmcnt(24)
    v_cvt_f32_i32 v100, v60
    v_cvt_f32_i32 v101, v61
    v_cvt_f32_i32 v102, v62
    v_cvt_f32_i32 v103, v63
    buffer_load_dwordx4 v[56:59], v1, s[28:31], s71 offen offset:256 nt
    v_fmac_f32_dpp v160, v170, v100 row_newbcast:3 row_mask:0xf bank_mask:0xf
    v_fmac_f32_dpp v161, v170, v101 row_newbcast:3 row_mask:0xf bank_mask:0xf
    v_fmac_f32_dpp v162, v170, v102 row_newbcast:3 row_mask:0xf bank_mask:0xf
    v_fmac_f32_dpp v163, v170, v103 row_newbcast:3 row_mask:0xf bank_mask:0xf
    s_waitcnt vmcnt(24)
    v_cvt_f32_i32 v104, v64
    v_cvt_f32_i32 v105, v65
    v_cvt_f32_i32 v106, v66
    v_cvt_f32_i32 v107, v67
    buffer_load_dwordx4 v[60:63], v1, s[28:31], s71 offen offset:512 nt
    v_fmac_f32_dpp v152, v170, v104 row_newbcast:11 row_mask:0xf bank_mask:0xf
    v_fmac_f32_dpp v153, v170, v105 row_newbcast:11 row_mask:0xf bank_mask:0xf
    v_fmac_f32_dpp v154, v170, v106 row_newbcast:11 row_mask:0xf bank_mask:0xf
    v_fmac_f32_dpp v155, v170, v107 row_newbcast:11 row_mask:0xf bank_mask:0xf
    s_waitcnt vmcnt(24)
    v_cvt_f32_i32 v100, v68
    v_cvt_f32_i32 v101, v69
    v_cvt_f32_i32 v102, v70
    v_cvt_f32_i32 v103, v71
    s_add_u32 s71, s71, 3072
    buffer_load_dwordx4 v[64:67], v1, s[28:31], s71 offen offset:0 nt
    v_fmac_f32_dpp v156, v170, v100 row_newbcast:11 row_mask:0xf bank_mask:0xf
    v_fmac_f32_dpp v157, v170, v101 row_newbcast:11 row_mask:0xf bank_mask:0xf
    v_fmac_f32_dpp v158, v170, v102 row_newbcast:11 row_mask:0xf bank_mask:0xf
    v_fmac_f32_dpp v159, v170, v103 row_newbcast:11 row_mask:0xf bank_mask:0xf
    s_waitcnt vmcnt(24)
    v_cvt_f32_i32 v104, v72
    v_cvt_f32_i32 v105, v73
    v_cvt_f32_i32 v106, v74
    v_cvt_f32_i32 v107, v75
    buffer_load_dwordx4 v[68:71], v1, s[28:31], s71 offen offset:256 nt
    v_fmac_f32_dpp v160, v170, v104 row_newbcast:11 row_mask:0xf bank_mask:0xf
    v_fmac_f32_dpp v161, v170, v105 row_newbcast:11 row_mask:0xf bank_mask:0xf
    v_fmac_f32_dpp v162, v170, v106 row_newbcast:11 row_mask:0xf bank_mask:0xf
    v_fmac_f32_dpp v163, v170, v107 row_newbcast:11 row_mask:0xf bank_mask:0xf
    s_waitcnt vmcnt(24)
    v_cvt_f32_i32 v100, v76
    v_cvt_f32_i32 v101, v77
    v_cvt_f32_i32 v102, v78
    v_cvt_f32_i32 v103, v79
    buffer_load_dwordx4 v[72:75], v1, s[28:31], s71 offen offset:512 nt
    v_fmac_f32_dpp v152, v170, v100 row_newbcast:7 row_mask:0xf bank_mask:0xf
    v_fmac_f32_dpp v153, v170, v101 row_newbcast:7 row_mask:0xf bank_mask:0xf
    v_fmac_f32_dpp v154, v170, v102 row_newbcast:7 row_mask:0xf bank_mask:0xf
    v_fmac_f32_dpp v155, v170, v103 row_newbcast:7 row_mask:0xf bank_mask:0xf
    s_waitcnt vmcnt(24)
    v_cvt_f32_i32 v104, v80
    v_cvt_f32_i32 v105, v81
    v_cvt_f32_i32 v106, v82
    v_cvt_f32_i32 v107, v83
    s_add_u32 s71, s71, 3072
    buffer_load_dwordx4 v[76:79], v1, s[28:31], s71 offen offset:0 nt
    v_fmac_f32_dpp v156, v170, v104 row_newbcast:7 row_mask:0xf bank_mask:0xf
    v_fmac_f32_dpp v157, v170, v105 row_newbcast:7 row_mask:0xf bank_mask:0xf
    v_fmac_f32_dpp v158, v170, v106 row_newbcast:7 row_mask:0xf bank_mask:0xf
    v_fmac_f32_dpp v159, v170, v107 row_newbcast:7 row_mask:0xf bank_mask:0xf
    s_waitcnt vmcnt(24)
    v_cvt_f32_i32 v100, v84
    v_cvt_f32_i32 v101, v85
    v_cvt_f32_i32 v102, v86
    v_cvt_f32_i32 v103, v87
    buffer_load_dwordx4 v[80:83], v1, s[28:31], s71 offen offset:256 nt
    v_fmac_f32_dpp v160, v170, v100 row_newbcast:7 row_mask:0xf bank_mask:0xf
    v_fmac_f32_dpp v161, v170, v101 row_newbcast:7 row_mask:0xf bank_mask:0xf
    v_fmac_f32_dpp v162, v170, v102 row_newbcast:7 row_mask:0xf bank_mask:0xf
    v_fmac_f32_dpp v163, v170, v103 row_newbcast:7 row_mask:0xf bank_mask:0xf
    s_waitcnt vmcnt(24)
    v_cvt_f32_i32 v104, v88
    v_cvt_f32_i32 v105, v89
    v_cvt_f32_i32 v106, v90
    v_cvt_f32_i32 v107, v91
    buffer_load_dwordx4 v[84:87], v1, s[28:31], s71 offen offset:512 nt
    v_fmac_f32_dpp v152, v170, v104 row_newbcast:15 row_mask:0xf bank_mask:0xf
    v_fmac_f32_dpp v153, v170, v105 row_newbcast:15 row_mask:0xf bank_mask:0xf
    v_fmac_f32_dpp v154, v170, v106 row_newbcast:15 row_mask:0xf bank_mask:0xf
    v_fmac_f32_dpp v155, v170, v107 row_newbcast:15 row_mask:0xf bank_mask:0xf
    s_waitcnt vmcnt(24)
    v_cvt_f32_i32 v100, v92
    v_cvt_f32_i32 v101, v93
    v_cvt_f32_i32 v102, v94
    v_cvt_f32_i32 v103, v95
    s_add_u32 s71, s71, 3072
    buffer_load_dwordx4 v[88:91], v1, s[28:31], s71 offen offset:0 nt
    v_fmac_f32_dpp v156, v170, v100 row_newbcast:15 row_mask:0xf bank_mask:0xf
    v_fmac_f32_dpp v157, v170, v101 row_newbcast:15 row_mask:0xf bank_mask:0xf
    v_fmac_f32_dpp v158, v170, v102 row_newbcast:15 row_mask:0xf bank_mask:0xf
    v_fmac_f32_dpp v159, v170, v103 row_newbcast:15 row_mask:0xf bank_mask:0xf
    s_waitcnt vmcnt(24)
    v_cvt_f32_i32 v104, v96
    v_cvt_f32_i32 v105, v97
    v_cvt_f32_i32 v106, v98
    v_cvt_f32_i32 v107, v99
    buffer_load_dwordx4 v[92:95], v1, s[28:31], s71 offen offset:256 nt
    v_fmac_f32_dpp v160, v170, v104 row_newbcast:15 row_mask:0xf bank_mask:0xf
    v_fmac_f32_dpp v161, v170, v105 row_newbcast:15 row_mask:0xf bank_mask:0xf
    v_fmac_f32_dpp v162, v170, v106 row_newbcast:15 row_mask:0xf bank_mask:0xf
    v_fmac_f32_dpp v163, v170, v107 row_newbcast:15 row_mask:0xf bank_mask:0xf
    s_sub_u32 s77, s77, 1
    s_cmp_lg_u32 s77, 0
    s_cbranch_scc1 L_nofl2
    s_nop 0
    v_add_f32_dpp v166, v166, v166 row_ror:8 row_mask:0xf bank_mask:0xf
    v_add_f32_dpp v167, v167, v167 row_ror:8 row_mask:0xf bank_mask:0xf
    s_nop 0
    v_add_f32_dpp v166, v166, v166 row_ror:4 row_mask:0xf bank_mask:0xf
    v_add_f32_dpp v167, v167, v167 row_ror:4 row_mask:0xf bank_mask:0xf
    s_nop 0
    v_add_f32_dpp v166, v166, v166 row_ror:2 row_mask:0xf bank_mask:0xf
    v_add_f32_dpp v167, v167, v167 row_ror:2 row_mask:0xf bank_mask:0xf
    s_nop 0
    v_add_f32_dpp v166, v166, v166 row_ror:1 row_mask:0xf bank_mask:0xf
    v_add_f32_dpp v167, v167, v167 row_ror:1 row_mask:0xf bank_mask:0xf
    v_mov_b32 v184, v165
    v_mov_b32 v185, v165
    s_nop 1
    v_permlane32_swap_b32 v184, v185
    s_nop 1
    v_max_f32 v184, v184, v185
    v_mov_b32 v185, v184
    s_nop 1
    v_permlane16_swap_b32 v184, v185
    s_nop 1
    v_max_f32 v184, v184, v185
    v_sub_f32 v185, v165, v184
    v_exp_f32 v185, v185
    v_mov_b32 v165, v184
    v_mul_f32 v166, v166, v185
    v_mul_f32 v167, v167, v185
    v_fma_f32 v152, v152, v185, -v167
    v_fma_f32 v153, v153, v185, -v167
    v_fma_f32 v154, v154, v185, -v167
    v_fma_f32 v155, v155, v185, -v167
    v_fma_f32 v156, v156, v185, -v167
    v_fma_f32 v157, v157, v185, -v167
    v_fma_f32 v158, v158, v185, -v167
    v_fma_f32 v159, v159, v185, -v167
    v_fma_f32 v160, v160, v185, -v167
    v_fma_f32 v161, v161, v185, -v167
    v_fma_f32 v162, v162, v185, -v167
    v_fma_f32 v163, v163, v185, -v167
    v_mov_b32 v184, v166
    s_nop 1
    v_permlane32_swap_b32 v166, v184
    v_permlane32_swap_b32 v152, v154
    v_permlane32_swap_b32 v153, v155
    v_permlane32_swap_b32 v156, v158
    v_permlane32_swap_b32 v157, v159
    v_permlane32_swap_b32 v160, v162
    v_permlane32_swap_b32 v161, v163
    s_nop 1
    v_add_f32 v166, v166, v184
    v_add_f32 v152, v152, v154
    v_add_f32 v153, v153, v155
    v_add_f32 v156, v156, v158
    v_add_f32 v157, v157, v159
    v_add_f32 v160, v160, v162
    v_add_f32 v161, v161, v163
    v_mov_b32 v184, v166
    s_nop 1
    v_permlane16_swap_b32 v166, v184
    v_permlane16_swap_b32 v152, v153
    v_permlane16_swap_b32 v156, v157
    v_permlane16_swap_b32 v160, v161
    s_nop 1
    v_add_f32 v166, v166, v184
    v_add_f32 v152, v152, v153
    v_add_f32 v156, v156, v157
    v_add_f32 v160, v160, v161
    ds_write_b32 v188, v152 offset:768
    ds_write_b32 v188, v156 offset:1024
    ds_write_b32 v188, v160 offset:1280
    ds_write_b32 v189, v165 offset:1536
    ds_write_b32 v189, v166 offset:1540
    s_waitcnt lgkmcnt(0)
    s_mov_b64 exec, 1
    ds_add_u32 v190, v191
    s_mov_b64 exec, -1
    v_add_u32 v188, 1024, v188
    v_add_u32 v189, 1024, v189
    v_add_u32 v190, 4, v190
    v_mov_b32 v165, 0xf149f2ca
    v_mov_b32 v166, 0
    v_mov_b32 v167, 0
    v_mov_b32 v152, 0
    v_mov_b32 v153, 0
    v_mov_b32 v154, 0
    v_mov_b32 v155, 0
    v_mov_b32 v156, 0
    v_mov_b32 v157, 0
    v_mov_b32 v158, 0
    v_mov_b32 v159, 0
    v_mov_b32 v160, 0
    v_mov_b32 v161, 0
    v_mov_b32 v162, 0
    v_mov_b32 v163, 0
    s_mov_b32 s77, 8
L_nofl2:
    s_sub_u32 s76, s76, 1
    s_cmp_lg_u32 s76, 0
    s_cbranch_scc1 L_loop1
    s_waitcnt vmcnt(23)
    v_lshlrev_b32 v168, 16, v168
    v_lshlrev_b32 v169, 16, v169
    s_waitcnt lgkmcnt(0)
    v_max_f32_dpp v184, v172, v172 row_ror:8 row_mask:0xf bank_mask:0xf
    s_nop 1
    v_max_f32_dpp v184, v184, v184 row_ror:4 row_mask:0xf bank_mask:0xf
    s_nop 1
    v_max_f32_dpp v184, v184, v184 row_ror:2 row_mask:0xf bank_mask:0xf
    s_nop 1
    v_max_f32_dpp v184, v184, v184 row_ror:1 row_mask:0xf bank_mask:0xf
    v_max_f32 v184, v184, v165
    v_sub_f32 v185, v165, v184
    v_sub_f32 v170, v172, v184
    v_exp_f32 v185, v185
    v_exp_f32 v170, v170
    v_mov_b32 v165, v184
    v_fma_f32 v166, v166, v185, v170
    v_mul_f32 v170, v170, v168
    v_mul_f32 v167, v167, v185
    v_fmac_f32 v167, v170, v169
    v_mul_f32 v152, v152, v185
    v_mul_f32 v153, v153, v185
    v_mul_f32 v154, v154, v185
    v_mul_f32 v155, v155, v185
    v_mul_f32 v156, v156, v185
    v_mul_f32 v157, v157, v185
    v_mul_f32 v158, v158, v185
    v_mul_f32 v159, v159, v185
    v_mul_f32 v160, v160, v185
    v_mul_f32 v161, v161, v185
    v_mul_f32 v162, v162, v185
    v_mul_f32 v163, v163, v185
    s_waitcnt vmcnt(22)
    v_cvt_f32_i32 v100, v4
    v_cvt_f32_i32 v101, v5
    v_cvt_f32_i32 v102, v6
    v_cvt_f32_i32 v103, v7
    buffer_load_dwordx4 v[96:99], v1, s[28:31], s71 offen offset:512 nt
    v_fmac_f32_dpp v152, v170, v100 row_newbcast:0 row_mask:0xf bank_mask:0xf
    v_fmac_f32_dpp v153, v170, v101 row_newbcast:0 row_mask:0xf bank_mask:0xf
    v_fmac_f32_dpp v154, v170, v102 row_newbcast:0 row_mask:0xf bank_mask:0xf
    v_fmac_f32_dpp v155, v170, v103 row_newbcast:0 row_mask:0xf bank_mask:0xf
    s_waitcnt vmcnt(22)
    v_cvt_f32_i32 v104, v8
    v_cvt_f32_i32 v105, v9
    v_cvt_f32_i32 v106, v10
    v_cvt_f32_i32 v107, v11
    s_add_u32 s71, s71, 3072
    buffer_load_dwordx4 v[4:7], v1, s[28:31], s71 offen offset:0 nt
    v_fmac_f32_dpp v156, v170, v104 row_newbcast:0 row_mask:0xf bank_mask:0xf
    v_fmac_f32_dpp v157, v170, v105 row_newbcast:0 row_mask:0xf bank_mask:0xf
    v_fmac_f32_dpp v158, v170, v106 row_newbcast:0 row_mask:0xf bank_mask:0xf
    v_fmac_f32_dpp v159, v170, v107 row_newbcast:0 row_mask:0xf bank_mask:0xf
    s_waitcnt vmcnt(22)
    v_cvt_f32_i32 v100, v12
    v_cvt_f32_i32 v101, v13
    v_cvt_f32_i32 v102, v14
    v_cvt_f32_i32 v103, v15
    buffer_load_dwordx4 v[8:11], v1, s[28:31], s71 offen offset:256 nt
    v_fmac_f32_dpp v160, v170, v100 row_newbcast:0 row_mask:0xf bank_mask:0xf
    v_fmac_f32_dpp v161, v170, v101 row_newbcast:0 row_mask:0xf bank_mask:0xf
    v_fmac_f32_dpp v162, v170, v102 row_newbcast:0 row_mask:0xf bank_mask:0xf
    v_fmac_f32_dpp v163, v170, v103 row_newbcast:0 row_mask:0xf bank_mask:0xf
    s_waitcnt vmcnt(22)
    v_cvt_f32_i32 v104, v16
    v_cvt_f32_i32 v105, v17
    v_cvt_f32_i32 v106, v18
    v_cvt_f32_i32 v107, v19
    buffer_load_dwordx4 v[12:15], v1, s[28:31], s71 offen offset:512 nt
    v_fmac_f32_dpp v152, v170, v104 row_newbcast:8 row_mask:0xf bank_mask:0xf
    v_fmac_f32_dpp v153, v170, v105 row_newbcast:8 row_mask:0xf bank_mask:0xf
    v_fmac_f32_dpp v154, v170, v106 row_newbcast:8 row_mask:0xf bank_mask:0xf
    v_fmac_f32_dpp v155, v170, v107 row_newbcast:8 row_mask:0xf bank_mask:0xf
    s_waitcnt vmcnt(22)
    v_cvt_f32_i32 v100, v20
    v_cvt_f32_i32 v101, v21
    v_cvt_f32_i32 v102, v22
    v_cvt_f32_i32 v103, v23
    s_add_u32 s71, s71, 3072
    buffer_load_dwordx4 v[16:19], v1, s[28:31], s71 offen offset:0 nt
    v_fmac_f32_dpp v156, v170, v100 row_newbcast:8 row_mask:0xf bank_mask:0xf
    v_fmac_f32_dpp v157, v170, v101 row_newbcast:8 row_mask:0xf bank_mask:0xf
    v_fmac_f32_dpp v158, v170, v102 row_newbcast:8 row_mask:0xf bank_mask:0xf
    v_fmac_f32_dpp v159, v170, v103 row_newbcast:8 row_mask:0xf bank_mask:0xf
    s_waitcnt vmcnt(22)
    v_cvt_f32_i32 v104, v24
    v_cvt_f32_i32 v105, v25
    v_cvt_f32_i32 v106, v26
    v_cvt_f32_i32 v107, v27
    buffer_load_dwordx4 v[20:23], v1, s[28:31], s71 offen offset:256 nt
    v_fmac_f32_dpp v160, v170, v104 row_newbcast:8 row_mask:0xf bank_mask:0xf
    v_fmac_f32_dpp v161, v170, v105 row_newbcast:8 row_mask:0xf bank_mask:0xf
    v_fmac_f32_dpp v162, v170, v106 row_newbcast:8 row_mask:0xf bank_mask:0xf
    v_fmac_f32_dpp v163, v170, v107 row_newbcast:8 row_mask:0xf bank_mask:0xf
    s_waitcnt vmcnt(22)
    v_cvt_f32_i32 v100, v28
    v_cvt_f32_i32 v101, v29
    v_cvt_f32_i32 v102, v30
    v_cvt_f32_i32 v103, v31
    buffer_load_dwordx4 v[24:27], v1, s[28:31], s71 offen offset:512 nt
    v_fmac_f32_dpp v152, v170, v100 row_newbcast:4 row_mask:0xf bank_mask:0xf
    v_fmac_f32_dpp v153, v170, v101 row_newbcast:4 row_mask:0xf bank_mask:0xf
    v_fmac_f32_dpp v154, v170, v102 row_newbcast:4 row_mask:0xf bank_mask:0xf
    v_fmac_f32_dpp v155, v170, v103 row_newbcast:4 row_mask:0xf bank_mask:0xf
    s_waitcnt vmcnt(22)
    v_cvt_f32_i32 v104, v32
    v_cvt_f32_i32 v105, v33
    v_cvt_f32_i32 v106, v34
    v_cvt_f32_i32 v107, v35
    s_add_u32 s71, s71, 3072
    buffer_load_dwordx4 v[28:31], v1, s[28:31], s71 offen offset:0 nt
    v_fmac_f32_dpp v156, v170, v104 row_newbcast:4 row_mask:0xf bank_mask:0xf
    v_fmac_f32_dpp v157, v170, v105 row_newbcast:4 row_mask:0xf bank_mask:0xf
    v_fmac_f32_dpp v158, v170, v106 row_newbcast:4 row_mask:0xf bank_mask:0xf
    v_fmac_f32_dpp v159, v170, v107 row_newbcast:4 row_mask:0xf bank_mask:0xf
    s_waitcnt vmcnt(22)
    v_cvt_f32_i32 v100, v36
    v_cvt_f32_i32 v101, v37
    v_cvt_f32_i32 v102, v38
    v_cvt_f32_i32 v103, v39
    buffer_load_dwordx4 v[32:35], v1, s[28:31], s71 offen offset:256 nt
    v_fmac_f32_dpp v160, v170, v100 row_newbcast:4 row_mask:0xf bank_mask:0xf
    v_fmac_f32_dpp v161, v170, v101 row_newbcast:4 row_mask:0xf bank_mask:0xf
    v_fmac_f32_dpp v162, v170, v102 row_newbcast:4 row_mask:0xf bank_mask:0xf
    v_fmac_f32_dpp v163, v170, v103 row_newbcast:4 row_mask:0xf bank_mask:0xf
    s_waitcnt vmcnt(22)
    v_cvt_f32_i32 v104, v40
    v_cvt_f32_i32 v105, v41
    v_cvt_f32_i32 v106, v42
    v_cvt_f32_i32 v107, v43
    buffer_load_dwordx4 v[36:39], v1, s[28:31], s71 offen offset:512 nt
    v_fmac_f32_dpp v152, v170, v104 row_newbcast:12 row_mask:0xf bank_mask:0xf
    v_fmac_f32_dpp v153, v170, v105 row_newbcast:12 row_mask:0xf bank_mask:0xf
    v_fmac_f32_dpp v154, v170, v106 row_newbcast:12 row_mask:0xf bank_mask:0xf
    v_fmac_f32_dpp v155, v170, v107 row_newbcast:12 row_mask:0xf bank_mask:0xf
    s_waitcnt vmcnt(22)
    v_cvt_f32_i32 v100, v44
    v_cvt_f32_i32 v101, v45
    v_cvt_f32_i32 v102, v46
    v_cvt_f32_i32 v103, v47
    s_add_u32 s71, s71, 3072
    buffer_load_dwordx4 v[40:43], v1, s[28:31], s71 offen offset:0 nt
    v_fmac_f32_dpp v156, v170, v100 row_newbcast:12 row_mask:0xf bank_mask:0xf
    v_fmac_f32_dpp v157, v170, v101 row_newbcast:12 row_mask:0xf bank_mask:0xf
    v_fmac_f32_dpp v158, v170, v102 row_newbcast:12 row_mask:0xf bank_mask:0xf
    v_fmac_f32_dpp v159, v170, v103 row_newbcast:12 row_mask:0xf bank_mask:0xf
    s_waitcnt vmcnt(22)
    v_cvt_f32_i32 v104, v48
    v_cvt_f32_i32 v105, v49
    v_cvt_f32_i32 v106, v50
    v_cvt_f32_i32 v107, v51
    buffer_load_dwordx4 v[44:47], v1, s[28:31], s71 offen offset:256 nt
    v_fmac_f32_dpp v160, v170, v104 row_newbcast:12 row_mask:0xf bank_mask:0xf
    v_fmac_f32_dpp v161, v170, v105 row_newbcast:12 row_mask:0xf bank_mask:0xf
    v_fmac_f32_dpp v162, v170, v106 row_newbcast:12 row_mask:0xf bank_mask:0xf
    v_fmac_f32_dpp v163, v170, v107 row_newbcast:12 row_mask:0xf bank_mask:0xf
    s_waitcnt vmcnt(22)
    v_cvt_f32_i32 v100, v52
    v_cvt_f32_i32 v101, v53
    v_cvt_f32_i32 v102, v54
    v_cvt_f32_i32 v103, v55
    buffer_load_dwordx4 v[48:51], v1, s[28:31], s71 offen offset:512 nt
    v_fmac_f32_dpp v152, v170, v100 row_newbcast:2 row_mask:0xf bank_mask:0xf
    v_fmac_f32_dpp v153, v170, v101 row_newbcast:2 row_mask:0xf bank_mask:0xf
    v_fmac_f32_dpp v154, v170, v102 row_newbcast:2 row_mask:0xf bank_mask:0xf
    v_fmac_f32_dpp v155, v170, v103 row_newbcast:2 row_mask:0xf bank_mask:0xf
    s_waitcnt vmcnt(22)
    v_cvt_f32_i32 v104, v56
    v_cvt_f32_i32 v105, v57
    v_cvt_f32_i32 v106, v58
    v_cvt_f32_i32 v107, v59
    s_add_u32 s71, s71, 3072
    buffer_load_dwordx4 v[52:55], v1, s[28:31], s71 offen offset:0 nt
    v_fmac_f32_dpp v156, v170, v104 row_newbcast:2 row_mask:0xf bank_mask:0xf
    v_fmac_f32_dpp v157, v170, v105 row_newbcast:2 row_mask:0xf bank_mask:0xf
    v_fmac_f32_dpp v158, v170, v106 row_newbcast:2 row_mask:0xf bank_mask:0xf
    v_fmac_f32_dpp v159, v170, v107 row_newbcast:2 row_mask:0xf bank_mask:0xf
    s_waitcnt vmcnt(22)
    v_cvt_f32_i32 v100, v60
    v_cvt_f32_i32 v101, v61
    v_cvt_f32_i32 v102, v62
    v_cvt_f32_i32 v103, v63
    buffer_load_dwordx4 v[56:59], v1, s[28:31], s71 offen offset:256 nt
    v_fmac_f32_dpp v160, v170, v100 row_newbcast:2 row_mask:0xf bank_mask:0xf
    v_fmac_f32_dpp v161, v170, v101 row_newbcast:2 row_mask:0xf bank_mask:0xf
    v_fmac_f32_dpp v162, v170, v102 row_newbcast:2 row_mask:0xf bank_mask:0xf
    v_fmac_f32_dpp v163, v170, v103 row_newbcast:2 row_mask:0xf bank_mask:0xf
    s_waitcnt vmcnt(22)
    v_cvt_f32_i32 v104, v64
    v_cvt_f32_i32 v105, v65
    v_cvt_f32_i32 v106, v66
    v_cvt_f32_i32 v107, v67
    buffer_load_dwordx4 v[60:63], v1, s[28:31], s71 offen offset:512 nt
    v_fmac_f32_dpp v152, v170, v104 row_newbcast:10 row_mask:0xf bank_mask:0xf
    v_fmac_f32_dpp v153, v170, v105 row_newbcast:10 row_mask:0xf bank_mask:0xf
    v_fmac_f32_dpp v154, v170, v106 row_newbcast:10 row_mask:0xf bank_mask:0xf
    v_fmac_f32_dpp v155, v170, v107 row_newbcast:10 row_mask:0xf bank_mask:0xf
    s_waitcnt vmcnt(22)
    v_cvt_f32_i32 v100, v68
    v_cvt_f32_i32 v101, v69
    v_cvt_f32_i32 v102, v70
    v_cvt_f32_i32 v103, v71
    s_add_u32 s71, s71, 3072
    buffer_load_dwordx4 v[64:67], v1, s[28:31], s71 offen offset:0 nt
    v_fmac_f32_dpp v156, v170, v100 row_newbcast:10 row_mask:0xf bank_mask:0xf
    v_fmac_f32_dpp v157, v170, v101 row_newbcast:10 row_mask:0xf bank_mask:0xf
    v_fmac_f32_dpp v158, v170, v102 row_newbcast:10 row_mask:0xf bank_mask:0xf
    v_fmac_f32_dpp v159, v170, v103 row_newbcast:10 row_mask:0xf bank_mask:0xf
    s_waitcnt vmcnt(22)
    v_cvt_f32_i32 v104, v72
    v_cvt_f32_i32 v105, v73
    v_cvt_f32_i32 v106, v74
    v_cvt_f32_i32 v107, v75
    buffer_load_dwordx4 v[68:71], v1, s[28:31], s71 offen offset:256 nt
    v_fmac_f32_dpp v160, v170, v104 row_newbcast:10 row_mask:0xf bank_mask:0xf
    v_fmac_f32_dpp v161, v170, v105 row_newbcast:10 row_mask:0xf bank_mask:0xf
    v_fmac_f32_dpp v162, v170, v106 row_newbcast:10 row_mask:0xf bank_mask:0xf
    v_fmac_f32_dpp v163, v170, v107 row_newbcast:10 row_mask:0xf bank_mask:0xf
    s_waitcnt vmcnt(22)
    v_cvt_f32_i32 v100, v76
    v_cvt_f32_i32 v101, v77
    v_cvt_f32_i32 v102, v78
    v_cvt_f32_i32 v103, v79
    buffer_load_dwordx4 v[72:75], v1, s[28:31], s71 offen offset:512 nt
    v_fmac_f32_dpp v152, v170, v100 row_newbcast:6 row_mask:0xf bank_mask:0xf
    v_fmac_f32_dpp v153, v170, v101 row_newbcast:6 row_mask:0xf bank_mask:0xf
    v_fmac_f32_dpp v154, v170, v102 row_newbcast:6 row_mask:0xf bank_mask:0xf
    v_fmac_f32_dpp v155, v170, v103 row_newbcast:6 row_mask:0xf bank_mask:0xf
    s_waitcnt vmcnt(22)
    v_cvt_f32_i32 v104, v80
    v_cvt_f32_i32 v105, v81
    v_cvt_f32_i32 v106, v82
    v_cvt_f32_i32 v107, v83
    s_add_u32 s71, s71, 3072
    buffer_load_dwordx4 v[76:79], v1, s[28:31], s71 offen offset:0 nt
    v_fmac_f32_dpp v156, v170, v104 row_newbcast:6 row_mask:0xf bank_mask:0xf
    v_fmac_f32_dpp v157, v170, v105 row_newbcast:6 row_mask:0xf bank_mask:0xf
    v_fmac_f32_dpp v158, v170, v106 row_newbcast:6 row_mask:0xf bank_mask:0xf
    v_fmac_f32_dpp v159, v170, v107 row_newbcast:6 row_mask:0xf bank_mask:0xf
    s_waitcnt vmcnt(22)
    v_cvt_f32_i32 v100, v84
    v_cvt_f32_i32 v101, v85
    v_cvt_f32_i32 v102, v86
    v_cvt_f32_i32 v103, v87
    buffer_load_dwordx4 v[80:83], v1, s[28:31], s71 offen offset:256 nt
    v_fmac_f32_dpp v160, v170, v100 row_newbcast:6 row_mask:0xf bank_mask:0xf
    v_fmac_f32_dpp v161, v170, v101 row_newbcast:6 row_mask:0xf bank_mask:0xf
    v_fmac_f32_dpp v162, v170, v102 row_newbcast:6 row_mask:0xf bank_mask:0xf
    v_fmac_f32_dpp v163, v170, v103 row_newbcast:6 row_mask:0xf bank_mask:0xf
    s_waitcnt vmcnt(22)
    v_cvt_f32_i32 v104, v88
    v_cvt_f32_i32 v105, v89
    v_cvt_f32_i32 v106, v90
    v_cvt_f32_i32 v107, v91
    buffer_load_dwordx4 v[84:87], v1, s[28:31], s71 offen offset:512 nt
    v_fmac_f32_dpp v152, v170, v104 row_newbcast:14 row_mask:0xf bank_mask:0xf
    v_fmac_f32_dpp v153, v170, v105 row_newbcast:14 row_mask:0xf bank_mask:0xf
    v_fmac_f32_dpp v154, v170, v106 row_newbcast:14 row_mask:0xf bank_mask:0xf
    v_fmac_f32_dpp v155, v170, v107 row_newbcast:14 row_mask:0xf bank_mask:0xf
    s_waitcnt vmcnt(22)
    v_cvt_f32_i32 v100, v92
    v_cvt_f32_i32 v101, v93
    v_cvt_f32_i32 v102, v94
    v_cvt_f32_i32 v103, v95
    s_add_u32 s71, s71, 3072
    buffer_load_dwordx4 v[88:91], v1, s[28:31], s71 offen offset:0 nt
    v_fmac_f32_dpp v156, v170, v100 row_newbcast:14 row_mask:0xf bank_mask:0xf
    v_fmac_f32_dpp v157, v170, v101 row_newbcast:14 row_mask:0xf bank_mask:0xf
    v_fmac_f32_dpp v158, v170, v102 row_newbcast:14 row_mask:0xf bank_mask:0xf
    v_fmac_f32_dpp v159, v170, v103 row_newbcast:14 row_mask:0xf bank_mask:0xf
    s_waitcnt vmcnt(22)
    v_cvt_f32_i32 v104, v96
    v_cvt_f32_i32 v105, v97
    v_cvt_f32_i32 v106, v98
    v_cvt_f32_i32 v107, v99
    buffer_load_dwordx4 v[92:95], v1, s[28:31], s71 offen offset:256 nt
    v_fmac_f32_dpp v160, v170, v104 row_newbcast:14 row_mask:0xf bank_mask:0xf
    v_fmac_f32_dpp v161, v170, v105 row_newbcast:14 row_mask:0xf bank_mask:0xf
    v_fmac_f32_dpp v162, v170, v106 row_newbcast:14 row_mask:0xf bank_mask:0xf
    v_fmac_f32_dpp v163, v170, v107 row_newbcast:14 row_mask:0xf bank_mask:0xf
    s_waitcnt vmcnt(22)
    v_cvt_f32_i32 v100, v4
    v_cvt_f32_i32 v101, v5
    v_cvt_f32_i32 v102, v6
    v_cvt_f32_i32 v103, v7
    buffer_load_dwordx4 v[96:99], v1, s[28:31], s71 offen offset:512 nt
    v_fmac_f32_dpp v152, v170, v100 row_newbcast:1 row_mask:0xf bank_mask:0xf
    v_fmac_f32_dpp v153, v170, v101 row_newbcast:1 row_mask:0xf bank_mask:0xf
    v_fmac_f32_dpp v154, v170, v102 row_newbcast:1 row_mask:0xf bank_mask:0xf
    v_fmac_f32_dpp v155, v170, v103 row_newbcast:1 row_mask:0xf bank_mask:0xf
L_tagw:
    ds_read_b32 v177, v191 offset:135
    s_waitcnt lgkmcnt(0)
    v_readfirstlane_b32 s93, v177
    s_cmp_eq_u32 s93, 0
    s_cbranch_scc1 L_tagw
    s_and_b32 s80, s2, 7
    s_lshr_b32 s81, s80, 3
    s_and_b32 s80, s80, 7
    s_mul_i32 s70, s81, 64
    s_add_u32 s70, s70, s80
    s_add_u32 s70, s70, s94
    s_and_b32 s95, s2, 0xf8
    s_add_u32 s95, s95, s80
    s_mul_i32 s95, s95, 8
    s_add_u32 s95, s95, s81
    s_mul_i32 s95, s95, 512
    s_add_u32 s95, s95, 8388608
    s_waitcnt vmcnt(22)
    v_cvt_f32_i32 v104, v8
    v_cvt_f32_i32 v105, v9
    v_cvt_f32_i32 v106, v10
    v_cvt_f32_i32 v107, v11
    s_lshl_b32 s73, s70, 7
    buffer_load_dwordx2 v[172:173], v174, s[52:55], s95 offen sc0 sc1
    buffer_load_ushort v168, v3, s[40:43], s73 offen
    buffer_load_ushort v169, v3, s[44:47], s73 offen
    s_mul_i32 s71, s70, 49152
    buffer_load_dwordx4 v[4:7], v1, s[28:31], s71 offen offset:0 nt
    v_fmac_f32_dpp v156, v170, v104 row_newbcast:1 row_mask:0xf bank_mask:0xf
    v_fmac_f32_dpp v157, v170, v105 row_newbcast:1 row_mask:0xf bank_mask:0xf
    v_fmac_f32_dpp v158, v170, v106 row_newbcast:1 row_mask:0xf bank_mask:0xf
    v_fmac_f32_dpp v159, v170, v107 row_newbcast:1 row_mask:0xf bank_mask:0xf
    s_waitcnt vmcnt(25)
    v_cvt_f32_i32 v100, v12
    v_cvt_f32_i32 v101, v13
    v_cvt_f32_i32 v102, v14
    v_cvt_f32_i32 v103, v15
    buffer_load_dwordx4 v[8:11], v1, s[28:31], s71 offen offset:256 nt
    v_fmac_f32_dpp v160, v170, v100 row_newbcast:1 row_mask:0xf bank_mask:0xf
    v_fmac_f32_dpp v161, v170, v101 row_newbcast:1 row_mask:0xf bank_mask:0xf
    v_fmac_f32_dpp v162, v170, v102 row_newbcast:1 row_mask:0xf bank_mask:0xf
    v_fmac_f32_dpp v163, v170, v103 row_newbcast:1 row_mask:0xf bank_mask:0xf
    s_waitcnt vmcnt(25)
    v_cvt_f32_i32 v104, v16
    v_cvt_f32_i32 v105, v17
    v_cvt_f32_i32 v106, v18
    v_cvt_f32_i32 v107, v19
    buffer_load_dwordx4 v[12:15], v1, s[28:31], s71 offen offset:512 nt
    v_fmac_f32_dpp v152, v170, v104 row_newbcast:9 row_mask:0xf bank_mask:0xf
    v_fmac_f32_dpp v153, v170, v105 row_newbcast:9 row_mask:0xf bank_mask:0xf
    v_fmac_f32_dpp v154, v170, v106 row_newbcast:9 row_mask:0xf bank_mask:0xf
    v_fmac_f32_dpp v155, v170, v107 row_newbcast:9 row_mask:0xf bank_mask:0xf
    s_waitcnt vmcnt(25)
    v_cvt_f32_i32 v100, v20
    v_cvt_f32_i32 v101, v21
    v_cvt_f32_i32 v102, v22
    v_cvt_f32_i32 v103, v23
    s_add_u32 s71, s71, 3072
    buffer_load_dwordx4 v[16:19], v1, s[28:31], s71 offen offset:0 nt
    v_fmac_f32_dpp v156, v170, v100 row_newbcast:9 row_mask:0xf bank_mask:0xf
    v_fmac_f32_dpp v157, v170, v101 row_newbcast:9 row_mask:0xf bank_mask:0xf
    v_fmac_f32_dpp v158, v170, v102 row_newbcast:9 row_mask:0xf bank_mask:0xf
    v_fmac_f32_dpp v159, v170, v103 row_newbcast:9 row_mask:0xf bank_mask:0xf
    s_waitcnt vmcnt(25)
    v_cvt_f32_i32 v104, v24
    v_cvt_f32_i32 v105, v25
    v_cvt_f32_i32 v106, v26
    v_cvt_f32_i32 v107, v27
    buffer_load_dwordx4 v[20:23], v1, s[28:31], s71 offen offset:256 nt
    v_fmac_f32_dpp v160, v170, v104 row_newbcast:9 row_mask:0xf bank_mask:0xf
    v_fmac_f32_dpp v161, v170, v105 row_newbcast:9 row_mask:0xf bank_mask:0xf
    v_fmac_f32_dpp v162, v170, v106 row_newbcast:9 row_mask:0xf bank_mask:0xf
    v_fmac_f32_dpp v163, v170, v107 row_newbcast:9 row_mask:0xf bank_mask:0xf
    s_waitcnt vmcnt(25)
    v_cvt_f32_i32 v100, v28
    v_cvt_f32_i32 v101, v29
    v_cvt_f32_i32 v102, v30
    v_cvt_f32_i32 v103, v31
    buffer_load_dwordx4 v[24:27], v1, s[28:31], s71 offen offset:512 nt
    v_fmac_f32_dpp v152, v170, v100 row_newbcast:5 row_mask:0xf bank_mask:0xf
    v_fmac_f32_dpp v153, v170, v101 row_newbcast:5 row_mask:0xf bank_mask:0xf
    v_fmac_f32_dpp v154, v170, v102 row_newbcast:5 row_mask:0xf bank_mask:0xf
    v_fmac_f32_dpp v155, v170, v103 row_newbcast:5 row_mask:0xf bank_mask:0xf
    s_waitcnt vmcnt(25)
    v_cvt_f32_i32 v104, v32
    v_cvt_f32_i32 v105, v33
    v_cvt_f32_i32 v106, v34
    v_cvt_f32_i32 v107, v35
    s_add_u32 s71, s71, 3072
    buffer_load_dwordx4 v[28:31], v1, s[28:31], s71 offen offset:0 nt
    v_fmac_f32_dpp v156, v170, v104 row_newbcast:5 row_mask:0xf bank_mask:0xf
    v_fmac_f32_dpp v157, v170, v105 row_newbcast:5 row_mask:0xf bank_mask:0xf
    v_fmac_f32_dpp v158, v170, v106 row_newbcast:5 row_mask:0xf bank_mask:0xf
    v_fmac_f32_dpp v159, v170, v107 row_newbcast:5 row_mask:0xf bank_mask:0xf
    s_waitcnt vmcnt(25)
    v_cvt_f32_i32 v100, v36
    v_cvt_f32_i32 v101, v37
    v_cvt_f32_i32 v102, v38
    v_cvt_f32_i32 v103, v39
    buffer_load_dwordx4 v[32:35], v1, s[28:31], s71 offen offset:256 nt
    v_fmac_f32_dpp v160, v170, v100 row_newbcast:5 row_mask:0xf bank_mask:0xf
    v_fmac_f32_dpp v161, v170, v101 row_newbcast:5 row_mask:0xf bank_mask:0xf
    v_fmac_f32_dpp v162, v170, v102 row_newbcast:5 row_mask:0xf bank_mask:0xf
    v_fmac_f32_dpp v163, v170, v103 row_newbcast:5 row_mask:0xf bank_mask:0xf
    s_waitcnt vmcnt(25)
    v_cvt_f32_i32 v104, v40
    v_cvt_f32_i32 v105, v41
    v_cvt_f32_i32 v106, v42
    v_cvt_f32_i32 v107, v43
    buffer_load_dwordx4 v[36:39], v1, s[28:31], s71 offen offset:512 nt
    v_fmac_f32_dpp v152, v170, v104 row_newbcast:13 row_mask:0xf bank_mask:0xf
    v_fmac_f32_dpp v153, v170, v105 row_newbcast:13 row_mask:0xf bank_mask:0xf
    v_fmac_f32_dpp v154, v170, v106 row_newbcast:13 row_mask:0xf bank_mask:0xf
    v_fmac_f32_dpp v155, v170, v107 row_newbcast:13 row_mask:0xf bank_mask:0xf
    s_waitcnt vmcnt(25)
    v_cvt_f32_i32 v100, v44
    v_cvt_f32_i32 v101, v45
    v_cvt_f32_i32 v102, v46
    v_cvt_f32_i32 v103, v47
    s_add_u32 s71, s71, 3072
    buffer_load_dwordx4 v[40:43], v1, s[28:31], s71 offen offset:0 nt
    v_fmac_f32_dpp v156, v170, v100 row_newbcast:13 row_mask:0xf bank_mask:0xf
    v_fmac_f32_dpp v157, v170, v101 row_newbcast:13 row_mask:0xf bank_mask:0xf
    v_fmac_f32_dpp v158, v170, v102 row_newbcast:13 row_mask:0xf bank_mask:0xf
    v_fmac_f32_dpp v159, v170, v103 row_newbcast:13 row_mask:0xf bank_mask:0xf
    s_waitcnt vmcnt(25)
    v_cvt_f32_i32 v104, v48
    v_cvt_f32_i32 v105, v49
    v_cvt_f32_i32 v106, v50
    v_cvt_f32_i32 v107, v51
    buffer_load_dwordx4 v[44:47], v1, s[28:31], s71 offen offset:256 nt
    v_fmac_f32_dpp v160, v170, v104 row_newbcast:13 row_mask:0xf bank_mask:0xf
    v_fmac_f32_dpp v161, v170, v105 row_newbcast:13 row_mask:0xf bank_mask:0xf
    v_fmac_f32_dpp v162, v170, v106 row_newbcast:13 row_mask:0xf bank_mask:0xf
    v_fmac_f32_dpp v163, v170, v107 row_newbcast:13 row_mask:0xf bank_mask:0xf
    s_waitcnt vmcnt(25)
    v_cvt_f32_i32 v100, v52
    v_cvt_f32_i32 v101, v53
    v_cvt_f32_i32 v102, v54
    v_cvt_f32_i32 v103, v55
    buffer_load_dwordx4 v[48:51], v1, s[28:31], s71 offen offset:512 nt
    v_fmac_f32_dpp v152, v170, v100 row_newbcast:3 row_mask:0xf bank_mask:0xf
    v_fmac_f32_dpp v153, v170, v101 row_newbcast:3 row_mask:0xf bank_mask:0xf
    v_fmac_f32_dpp v154, v170, v102 row_newbcast:3 row_mask:0xf bank_mask:0xf
    v_fmac_f32_dpp v155, v170, v103 row_newbcast:3 row_mask:0xf bank_mask:0xf
    s_waitcnt vmcnt(25)
    v_cvt_f32_i32 v104, v56
    v_cvt_f32_i32 v105, v57
    v_cvt_f32_i32 v106, v58
    v_cvt_f32_i32 v107, v59
    s_add_u32 s71, s71, 3072
    buffer_load_dwordx4 v[52:55], v1, s[28:31], s71 offen offset:0 nt
    v_fmac_f32_dpp v156, v170, v104 row_newbcast:3 row_mask:0xf bank_mask:0xf
    v_fmac_f32_dpp v157, v170, v105 row_newbcast:3 row_mask:0xf bank_mask:0xf
    v_fmac_f32_dpp v158, v170, v106 row_newbcast:3 row_mask:0xf bank_mask:0xf
    v_fmac_f32_dpp v159, v170, v107 row_newbcast:3 row_mask:0xf bank_mask:0xf
    s_waitcnt vmcnt(25)
    v_cvt_f32_i32 v100, v60
    v_cvt_f32_i32 v101, v61
    v_cvt_f32_i32 v102, v62
    v_cvt_f32_i32 v103, v63
    buffer_load_dwordx4 v[56:59], v1, s[28:31], s71 offen offset:256 nt
    v_fmac_f32_dpp v160, v170, v100 row_newbcast:3 row_mask:0xf bank_mask:0xf
    v_fmac_f32_dpp v161, v170, v101 row_newbcast:3 row_mask:0xf bank_mask:0xf
    v_fmac_f32_dpp v162, v170, v102 row_newbcast:3 row_mask:0xf bank_mask:0xf
    v_fmac_f32_dpp v163, v170, v103 row_newbcast:3 row_mask:0xf bank_mask:0xf
    s_waitcnt vmcnt(25)
    v_cvt_f32_i32 v104, v64
    v_cvt_f32_i32 v105, v65
    v_cvt_f32_i32 v106, v66
    v_cvt_f32_i32 v107, v67
    buffer_load_dwordx4 v[60:63], v1, s[28:31], s71 offen offset:512 nt
    v_fmac_f32_dpp v152, v170, v104 row_newbcast:11 row_mask:0xf bank_mask:0xf
    v_fmac_f32_dpp v153, v170, v105 row_newbcast:11 row_mask:0xf bank_mask:0xf
    v_fmac_f32_dpp v154, v170, v106 row_newbcast:11 row_mask:0xf bank_mask:0xf
    v_fmac_f32_dpp v155, v170, v107 row_newbcast:11 row_mask:0xf bank_mask:0xf
    s_waitcnt vmcnt(25)
    v_cvt_f32_i32 v100, v68
    v_cvt_f32_i32 v101, v69
    v_cvt_f32_i32 v102, v70
    v_cvt_f32_i32 v103, v71
    s_add_u32 s71, s71, 3072
    buffer_load_dwordx4 v[64:67], v1, s[28:31], s71 offen offset:0 nt
    v_fmac_f32_dpp v156, v170, v100 row_newbcast:11 row_mask:0xf bank_mask:0xf
    v_fmac_f32_dpp v157, v170, v101 row_newbcast:11 row_mask:0xf bank_mask:0xf
    v_fmac_f32_dpp v158, v170, v102 row_newbcast:11 row_mask:0xf bank_mask:0xf
    v_fmac_f32_dpp v159, v170, v103 row_newbcast:11 row_mask:0xf bank_mask:0xf
    s_waitcnt vmcnt(25)
    v_cvt_f32_i32 v104, v72
    v_cvt_f32_i32 v105, v73
    v_cvt_f32_i32 v106, v74
    v_cvt_f32_i32 v107, v75
    buffer_load_dwordx4 v[68:71], v1, s[28:31], s71 offen offset:256 nt
    v_fmac_f32_dpp v160, v170, v104 row_newbcast:11 row_mask:0xf bank_mask:0xf
    v_fmac_f32_dpp v161, v170, v105 row_newbcast:11 row_mask:0xf bank_mask:0xf
    v_fmac_f32_dpp v162, v170, v106 row_newbcast:11 row_mask:0xf bank_mask:0xf
    v_fmac_f32_dpp v163, v170, v107 row_newbcast:11 row_mask:0xf bank_mask:0xf
    s_waitcnt vmcnt(25)
    v_cvt_f32_i32 v100, v76
    v_cvt_f32_i32 v101, v77
    v_cvt_f32_i32 v102, v78
    v_cvt_f32_i32 v103, v79
    buffer_load_dwordx4 v[72:75], v1, s[28:31], s71 offen offset:512 nt
    v_fmac_f32_dpp v152, v170, v100 row_newbcast:7 row_mask:0xf bank_mask:0xf
    v_fmac_f32_dpp v153, v170, v101 row_newbcast:7 row_mask:0xf bank_mask:0xf
    v_fmac_f32_dpp v154, v170, v102 row_newbcast:7 row_mask:0xf bank_mask:0xf
    v_fmac_f32_dpp v155, v170, v103 row_newbcast:7 row_mask:0xf bank_mask:0xf
    s_waitcnt vmcnt(25)
    v_cvt_f32_i32 v104, v80
    v_cvt_f32_i32 v105, v81
    v_cvt_f32_i32 v106, v82
    v_cvt_f32_i32 v107, v83
    s_add_u32 s71, s71, 3072
    buffer_load_dwordx4 v[76:79], v1, s[28:31], s71 offen offset:0 nt
    v_fmac_f32_dpp v156, v170, v104 row_newbcast:7 row_mask:0xf bank_mask:0xf
    v_fmac_f32_dpp v157, v170, v105 row_newbcast:7 row_mask:0xf bank_mask:0xf
    v_fmac_f32_dpp v158, v170, v106 row_newbcast:7 row_mask:0xf bank_mask:0xf
    v_fmac_f32_dpp v159, v170, v107 row_newbcast:7 row_mask:0xf bank_mask:0xf
    s_waitcnt vmcnt(25)
    v_cvt_f32_i32 v100, v84
    v_cvt_f32_i32 v101, v85
    v_cvt_f32_i32 v102, v86
    v_cvt_f32_i32 v103, v87
    buffer_load_dwordx4 v[80:83], v1, s[28:31], s71 offen offset:256 nt
    v_fmac_f32_dpp v160, v170, v100 row_newbcast:7 row_mask:0xf bank_mask:0xf
    v_fmac_f32_dpp v161, v170, v101 row_newbcast:7 row_mask:0xf bank_mask:0xf
    v_fmac_f32_dpp v162, v170, v102 row_newbcast:7 row_mask:0xf bank_mask:0xf
    v_fmac_f32_dpp v163, v170, v103 row_newbcast:7 row_mask:0xf bank_mask:0xf
    s_waitcnt vmcnt(25)
    v_cvt_f32_i32 v104, v88
    v_cvt_f32_i32 v105, v89
    v_cvt_f32_i32 v106, v90
    v_cvt_f32_i32 v107, v91
    buffer_load_dwordx4 v[84:87], v1, s[28:31], s71 offen offset:512 nt
    v_fmac_f32_dpp v152, v170, v104 row_newbcast:15 row_mask:0xf bank_mask:0xf
    v_fmac_f32_dpp v153, v170, v105 row_newbcast:15 row_mask:0xf bank_mask:0xf
    v_fmac_f32_dpp v154, v170, v106 row_newbcast:15 row_mask:0xf bank_mask:0xf
    v_fmac_f32_dpp v155, v170, v107 row_newbcast:15 row_mask:0xf bank_mask:0xf
    s_waitcnt vmcnt(25)
    v_cvt_f32_i32 v100, v92
    v_cvt_f32_i32 v101, v93
    v_cvt_f32_i32 v102, v94
    v_cvt_f32_i32 v103, v95
    s_add_u32 s71, s71, 3072
    buffer_load_dwordx4 v[88:91], v1, s[28:31], s71 offen offset:0 nt
    v_fmac_f32_dpp v156, v170, v100 row_newbcast:15 row_mask:0xf bank_mask:0xf
    v_fmac_f32_dpp v157, v170, v101 row_newbcast:15 row_mask:0xf bank_mask:0xf
    v_fmac_f32_dpp v158, v170, v102 row_newbcast:15 row_mask:0xf bank_mask:0xf
    v_fmac_f32_dpp v159, v170, v103 row_newbcast:15 row_mask:0xf bank_mask:0xf
    s_waitcnt vmcnt(25)
    v_cvt_f32_i32 v104, v96
    v_cvt_f32_i32 v105, v97
    v_cvt_f32_i32 v106, v98
    v_cvt_f32_i32 v107, v99
    buffer_load_dwordx4 v[92:95], v1, s[28:31], s71 offen offset:256 nt
    v_fmac_f32_dpp v160, v170, v104 row_newbcast:15 row_mask:0xf bank_mask:0xf
    v_fmac_f32_dpp v161, v170, v105 row_newbcast:15 row_mask:0xf bank_mask:0xf
    v_fmac_f32_dpp v162, v170, v106 row_newbcast:15 row_mask:0xf bank_mask:0xf
    v_fmac_f32_dpp v163, v170, v107 row_newbcast:15 row_mask:0xf bank_mask:0xf
    s_sub_u32 s77, s77, 1
    s_cmp_lg_u32 s77, 0
    s_cbranch_scc1 L_nofl3
    s_nop 0
    v_add_f32_dpp v166, v166, v166 row_ror:8 row_mask:0xf bank_mask:0xf
    v_add_f32_dpp v167, v167, v167 row_ror:8 row_mask:0xf bank_mask:0xf
    s_nop 0
    v_add_f32_dpp v166, v166, v166 row_ror:4 row_mask:0xf bank_mask:0xf
    v_add_f32_dpp v167, v167, v167 row_ror:4 row_mask:0xf bank_mask:0xf
    s_nop 0
    v_add_f32_dpp v166, v166, v166 row_ror:2 row_mask:0xf bank_mask:0xf
    v_add_f32_dpp v167, v167, v167 row_ror:2 row_mask:0xf bank_mask:0xf
    s_nop 0
    v_add_f32_dpp v166, v166, v166 row_ror:1 row_mask:0xf bank_mask:0xf
    v_add_f32_dpp v167, v167, v167 row_ror:1 row_mask:0xf bank_mask:0xf
    v_mov_b32 v184, v165
    v_mov_b32 v185, v165
    s_nop 1
    v_permlane32_swap_b32 v184, v185
    s_nop 1
    v_max_f32 v184, v184, v185
    v_mov_b32 v185, v184
    s_nop 1
    v_permlane16_swap_b32 v184, v185
    s_nop 1
    v_max_f32 v184, v184, v185
    v_sub_f32 v185, v165, v184
    v_exp_f32 v185, v185
    v_mov_b32 v165, v184
    v_mul_f32 v166, v166, v185
    v_mul_f32 v167, v167, v185
    v_fma_f32 v152, v152, v185, -v167
    v_fma_f32 v153, v153, v185, -v167
    v_fma_f32 v154, v154, v185, -v167
    v_fma_f32 v155, v155, v185, -v167
    v_fma_f32 v156, v156, v185, -v167
    v_fma_f32 v157, v157, v185, -v167
    v_fma_f32 v158, v158, v185, -v167
    v_fma_f32 v159, v159, v185, -v167
    v_fma_f32 v160, v160, v185, -v167
    v_fma_f32 v161, v161, v185, -v167
    v_fma_f32 v162, v162, v185, -v167
    v_fma_f32 v163, v163, v185, -v167
    v_mov_b32 v184, v166
    s_nop 1
    v_permlane32_swap_b32 v166, v184
    v_permlane32_swap_b32 v152, v154
    v_permlane32_swap_b32 v153, v155
    v_permlane32_swap_b32 v156, v158
    v_permlane32_swap_b32 v157, v159
    v_permlane32_swap_b32 v160, v162
    v_permlane32_swap_b32 v161, v163
    s_nop 1
    v_add_f32 v166, v166, v184
    v_add_f32 v152, v152, v154
    v_add_f32 v153, v153, v155
    v_add_f32 v156, v156, v158
    v_add_f32 v157, v157, v159
    v_add_f32 v160, v160, v162
    v_add_f32 v161, v161, v163
    v_mov_b32 v184, v166
    s_nop 1
    v_permlane16_swap_b32 v166, v184
    v_permlane16_swap_b32 v152, v153
    v_permlane16_swap_b32 v156, v157
    v_permlane16_swap_b32 v160, v161
    s_nop 1
    v_add_f32 v166, v166, v184
    v_add_f32 v152, v152, v153
    v_add_f32 v156, v156, v157
    v_add_f32 v160, v160, v161
    ds_write_b32 v188, v152 offset:768
    ds_write_b32 v188, v156 offset:1024
    ds_write_b32 v188, v160 offset:1280
    ds_write_b32 v189, v165 offset:1536
    ds_write_b32 v189, v166 offset:1540
    s_waitcnt lgkmcnt(0)
    s_mov_b64 exec, 1
    ds_add_u32 v190, v191
    s_mov_b64 exec, -1
    v_add_u32 v188, 1024, v188
    v_add_u32 v189, 1024, v189
    v_add_u32 v190, 4, v190
    v_mov_b32 v165, 0xf149f2ca
    v_mov_b32 v166, 0
    v_mov_b32 v167, 0
    v_mov_b32 v152, 0
    v_mov_b32 v153, 0
    v_mov_b32 v154, 0
    v_mov_b32 v155, 0
    v_mov_b32 v156, 0
    v_mov_b32 v157, 0
    v_mov_b32 v158, 0
    v_mov_b32 v159, 0
    v_mov_b32 v160, 0
    v_mov_b32 v161, 0
    v_mov_b32 v162, 0
    v_mov_b32 v163, 0
    s_mov_b32 s77, 8
L_nofl3:
L_dloop:
    s_waitcnt vmcnt(23)
    v_lshlrev_b32 v168, 16, v168
    v_lshlrev_b32 v169, 16, v169
L_lgchk0:
    v_cmp_ne_u32 vcc, s93, v173
    s_cmp_lg_u64 vcc, 0
    s_cbranch_scc1 L_lgretry0
    v_max_f32_dpp v184, v172, v172 row_ror:8 row_mask:0xf bank_mask:0xf
    s_nop 1
    v_max_f32_dpp v184, v184, v184 row_ror:4 row_mask:0xf bank_mask:0xf
    s_nop 1
    v_max_f32_dpp v184, v184, v184 row_ror:2 row_mask:0xf bank_mask:0xf
    s_nop 1
    v_max_f32_dpp v184, v184, v184 row_ror:1 row_mask:0xf bank_mask:0xf
    v_max_f32 v184, v184, v165
    v_sub_f32 v185, v165, v184
    v_sub_f32 v170, v172, v184
    v_exp_f32 v185, v185
    v_exp_f32 v170, v170
    v_mov_b32 v165, v184
    v_fma_f32 v166, v166, v185, v170
    v_mul_f32 v170, v170, v168
    v_mul_f32 v167, v167, v185
    v_fmac_f32 v167, v170, v169
    v_mul_f32 v152, v152, v185
    v_mul_f32 v153, v153, v185
    v_mul_f32 v154, v154, v185
    v_mul_f32 v155, v155, v185
    v_mul_f32 v156, v156, v185
    v_mul_f32 v157, v157, v185
    v_mul_f32 v158, v158, v185
    v_mul_f32 v159, v159, v185
    v_mul_f32 v160, v160, v185
    v_mul_f32 v161, v161, v185
    v_mul_f32 v162, v162, v185
    v_mul_f32 v163, v163, v185
    s_waitcnt vmcnt(22)
    v_cvt_f32_i32 v100, v4
    v_cvt_f32_i32 v101, v5
    v_cvt_f32_i32 v102, v6
    v_cvt_f32_i32 v103, v7
    buffer_load_dwordx4 v[96:99], v1, s[28:31], s71 offen offset:512 nt
    v_fmac_f32_dpp v152, v170, v100 row_newbcast:0 row_mask:0xf bank_mask:0xf
    v_fmac_f32_dpp v153, v170, v101 row_newbcast:0 row_mask:0xf bank_mask:0xf
    v_fmac_f32_dpp v154, v170, v102 row_newbcast:0 row_mask:0xf bank_mask:0xf
    v_fmac_f32_dpp v155, v170, v103 row_newbcast:0 row_mask:0xf bank_mask:0xf
    s_waitcnt vmcnt(22)
    v_cvt_f32_i32 v104, v8
    v_cvt_f32_i32 v105, v9
    v_cvt_f32_i32 v106, v10
    v_cvt_f32_i32 v107, v11
    s_add_u32 s71, s71, 3072
    buffer_load_dwordx4 v[4:7], v1, s[28:31], s71 offen offset:0 nt
    v_fmac_f32_dpp v156, v170, v104 row_newbcast:0 row_mask:0xf bank_mask:0xf
    v_fmac_f32_dpp v157, v170, v105 row_newbcast:0 row_mask:0xf bank_mask:0xf
    v_fmac_f32_dpp v158, v170, v106 row_newbcast:0 row_mask:0xf bank_mask:0xf
    v_fmac_f32_dpp v159, v170, v107 row_newbcast:0 row_mask:0xf bank_mask:0xf
    s_waitcnt vmcnt(22)
    v_cvt_f32_i32 v100, v12
    v_cvt_f32_i32 v101, v13
    v_cvt_f32_i32 v102, v14
    v_cvt_f32_i32 v103, v15
    buffer_load_dwordx4 v[8:11], v1, s[28:31], s71 offen offset:256 nt
    v_fmac_f32_dpp v160, v170, v100 row_newbcast:0 row_mask:0xf bank_mask:0xf
    v_fmac_f32_dpp v161, v170, v101 row_newbcast:0 row_mask:0xf bank_mask:0xf
    v_fmac_f32_dpp v162, v170, v102 row_newbcast:0 row_mask:0xf bank_mask:0xf
    v_fmac_f32_dpp v163, v170, v103 row_newbcast:0 row_mask:0xf bank_mask:0xf
    s_waitcnt vmcnt(22)
    v_cvt_f32_i32 v104, v16
    v_cvt_f32_i32 v105, v17
    v_cvt_f32_i32 v106, v18
    v_cvt_f32_i32 v107, v19
    buffer_load_dwordx4 v[12:15], v1, s[28:31], s71 offen offset:512 nt
    v_fmac_f32_dpp v152, v170, v104 row_newbcast:8 row_mask:0xf bank_mask:0xf
    v_fmac_f32_dpp v153, v170, v105 row_newbcast:8 row_mask:0xf bank_mask:0xf
    v_fmac_f32_dpp v154, v170, v106 row_newbcast:8 row_mask:0xf bank_mask:0xf
    v_fmac_f32_dpp v155, v170, v107 row_newbcast:8 row_mask:0xf bank_mask:0xf
    s_mov_b64 exec, 1
    ds_max_u32 v191, v175 offset:131
    s_mov_b64 exec, -1
    v_add_u32 v175, 1, v175
    s_waitcnt vmcnt(22)
    v_cvt_f32_i32 v100, v20
    v_cvt_f32_i32 v101, v21
    v_cvt_f32_i32 v102, v22
    v_cvt_f32_i32 v103, v23
    s_add_u32 s71, s71, 3072
    buffer_load_dwordx4 v[16:19], v1, s[28:31], s71 offen offset:0 nt
    v_fmac_f32_dpp v156, v170, v100 row_newbcast:8 row_mask:0xf bank_mask:0xf
    v_fmac_f32_dpp v157, v170, v101 row_newbcast:8 row_mask:0xf bank_mask:0xf
    v_fmac_f32_dpp v158, v170, v102 row_newbcast:8 row_mask:0xf bank_mask:0xf
    v_fmac_f32_dpp v159, v170, v103 row_newbcast:8 row_mask:0xf bank_mask:0xf
    s_waitcnt vmcnt(22)
    v_cvt_f32_i32 v104, v24
    v_cvt_f32_i32 v105, v25
    v_cvt_f32_i32 v106, v26
    v_cvt_f32_i32 v107, v27
    buffer_load_dwordx4 v[20:23], v1, s[28:31], s71 offen offset:256 nt
    v_fmac_f32_dpp v160, v170, v104 row_newbcast:8 row_mask:0xf bank_mask:0xf
    v_fmac_f32_dpp v161, v170, v105 row_newbcast:8 row_mask:0xf bank_mask:0xf
    v_fmac_f32_dpp v162, v170, v106 row_newbcast:8 row_mask:0xf bank_mask:0xf
    v_fmac_f32_dpp v163, v170, v107 row_newbcast:8 row_mask:0xf bank_mask:0xf
    s_waitcnt vmcnt(22)
    v_cvt_f32_i32 v100, v28
    v_cvt_f32_i32 v101, v29
    v_cvt_f32_i32 v102, v30
    v_cvt_f32_i32 v103, v31
    buffer_load_dwordx4 v[24:27], v1, s[28:31], s71 offen offset:512 nt
    v_fmac_f32_dpp v152, v170, v100 row_newbcast:4 row_mask:0xf bank_mask:0xf
    v_fmac_f32_dpp v153, v170, v101 row_newbcast:4 row_mask:0xf bank_mask:0xf
    v_fmac_f32_dpp v154, v170, v102 row_newbcast:4 row_mask:0xf bank_mask:0xf
    v_fmac_f32_dpp v155, v170, v103 row_newbcast:4 row_mask:0xf bank_mask:0xf
    s_waitcnt vmcnt(22)
    v_cvt_f32_i32 v104, v32
    v_cvt_f32_i32 v105, v33
    v_cvt_f32_i32 v106, v34
    v_cvt_f32_i32 v107, v35
    s_add_u32 s71, s71, 3072
    buffer_load_dwordx4 v[28:31], v1, s[28:31], s71 offen offset:0 nt
    v_fmac_f32_dpp v156, v170, v104 row_newbcast:4 row_mask:0xf bank_mask:0xf
    v_fmac_f32_dpp v157, v170, v105 row_newbcast:4 row_mask:0xf bank_mask:0xf
    v_fmac_f32_dpp v158, v170, v106 row_newbcast:4 row_mask:0xf bank_mask:0xf
    v_fmac_f32_dpp v159, v170, v107 row_newbcast:4 row_mask:0xf bank_mask:0xf
    s_waitcnt vmcnt(22)
    v_cvt_f32_i32 v100, v36
    v_cvt_f32_i32 v101, v37
    v_cvt_f32_i32 v102, v38
    v_cvt_f32_i32 v103, v39
    buffer_load_dwordx4 v[32:35], v1, s[28:31], s71 offen offset:256 nt
    v_fmac_f32_dpp v160, v170, v100 row_newbcast:4 row_mask:0xf bank_mask:0xf
    v_fmac_f32_dpp v161, v170, v101 row_newbcast:4 row_mask:0xf bank_mask:0xf
    v_fmac_f32_dpp v162, v170, v102 row_newbcast:4 row_mask:0xf bank_mask:0xf
    v_fmac_f32_dpp v163, v170, v103 row_newbcast:4 row_mask:0xf bank_mask:0xf
    s_waitcnt vmcnt(22)
    v_cvt_f32_i32 v104, v40
    v_cvt_f32_i32 v105, v41
    v_cvt_f32_i32 v106, v42
    v_cvt_f32_i32 v107, v43
    buffer_load_dwordx4 v[36:39], v1, s[28:31], s71 offen offset:512 nt
    v_fmac_f32_dpp v152, v170, v104 row_newbcast:12 row_mask:0xf bank_mask:0xf
    v_fmac_f32_dpp v153, v170, v105 row_newbcast:12 row_mask:0xf bank_mask:0xf
    v_fmac_f32_dpp v154, v170, v106 row_newbcast:12 row_mask:0xf bank_mask:0xf
    v_fmac_f32_dpp v155, v170, v107 row_newbcast:12 row_mask:0xf bank_mask:0xf
    s_waitcnt vmcnt(22)
    v_cvt_f32_i32 v100, v44
    v_cvt_f32_i32 v101, v45
    v_cvt_f32_i32 v102, v46
    v_cvt_f32_i32 v103, v47
    s_add_u32 s71, s71, 3072
    buffer_load_dwordx4 v[40:43], v1, s[28:31], s71 offen offset:0 nt
    v_fmac_f32_dpp v156, v170, v100 row_newbcast:12 row_mask:0xf bank_mask:0xf
    v_fmac_f32_dpp v157, v170, v101 row_newbcast:12 row_mask:0xf bank_mask:0xf
    v_fmac_f32_dpp v158, v170, v102 row_newbcast:12 row_mask:0xf bank_mask:0xf
    v_fmac_f32_dpp v159, v170, v103 row_newbcast:12 row_mask:0xf bank_mask:0xf
    s_waitcnt vmcnt(22)
    v_cvt_f32_i32 v104, v48
    v_cvt_f32_i32 v105, v49
    v_cvt_f32_i32 v106, v50
    v_cvt_f32_i32 v107, v51
    buffer_load_dwordx4 v[44:47], v1, s[28:31], s71 offen offset:256 nt
    v_fmac_f32_dpp v160, v170, v104 row_newbcast:12 row_mask:0xf bank_mask:0xf
    v_fmac_f32_dpp v161, v170, v105 row_newbcast:12 row_mask:0xf bank_mask:0xf
    v_fmac_f32_dpp v162, v170, v106 row_newbcast:12 row_mask:0xf bank_mask:0xf
    v_fmac_f32_dpp v163, v170, v107 row_newbcast:12 row_mask:0xf bank_mask:0xf
    s_waitcnt vmcnt(22)
    v_cvt_f32_i32 v100, v52
    v_cvt_f32_i32 v101, v53
    v_cvt_f32_i32 v102, v54
    v_cvt_f32_i32 v103, v55
    buffer_load_dwordx4 v[48:51], v1, s[28:31], s71 offen offset:512 nt
    v_fmac_f32_dpp v152, v170, v100 row_newbcast:2 row_mask:0xf bank_mask:0xf
    v_fmac_f32_dpp v153, v170, v101 row_newbcast:2 row_mask:0xf bank_mask:0xf
    v_fmac_f32_dpp v154, v170, v102 row_newbcast:2 row_mask:0xf bank_mask:0xf
    v_fmac_f32_dpp v155, v170, v103 row_newbcast:2 row_mask:0xf bank_mask:0xf
    s_waitcnt vmcnt(22)
    v_cvt_f32_i32 v104, v56
    v_cvt_f32_i32 v105, v57
    v_cvt_f32_i32 v106, v58
    v_cvt_f32_i32 v107, v59
    s_add_u32 s71, s71, 3072
    buffer_load_dwordx4 v[52:55], v1, s[28:31], s71 offen offset:0 nt
    v_fmac_f32_dpp v156, v170, v104 row_newbcast:2 row_mask:0xf bank_mask:0xf
    v_fmac_f32_dpp v157, v170, v105 row_newbcast:2 row_mask:0xf bank_mask:0xf
    v_fmac_f32_dpp v158, v170, v106 row_newbcast:2 row_mask:0xf bank_mask:0xf
    v_fmac_f32_dpp v159, v170, v107 row_newbcast:2 row_mask:0xf bank_mask:0xf
    s_waitcnt vmcnt(22)
    v_cvt_f32_i32 v100, v60
    v_cvt_f32_i32 v101, v61
    v_cvt_f32_i32 v102, v62
    v_cvt_f32_i32 v103, v63
    buffer_load_dwordx4 v[56:59], v1, s[28:31], s71 offen offset:256 nt
    v_fmac_f32_dpp v160, v170, v100 row_newbcast:2 row_mask:0xf bank_mask:0xf
    v_fmac_f32_dpp v161, v170, v101 row_newbcast:2 row_mask:0xf bank_mask:0xf
    v_fmac_f32_dpp v162, v170, v102 row_newbcast:2 row_mask:0xf bank_mask:0xf
    v_fmac_f32_dpp v163, v170, v103 row_newbcast:2 row_mask:0xf bank_mask:0xf
    s_waitcnt vmcnt(22)
    v_cvt_f32_i32 v104, v64
    v_cvt_f32_i32 v105, v65
    v_cvt_f32_i32 v106, v66
    v_cvt_f32_i32 v107, v67
    buffer_load_dwordx4 v[60:63], v1, s[28:31], s71 offen offset:512 nt
    v_fmac_f32_dpp v152, v170, v104 row_newbcast:10 row_mask:0xf bank_mask:0xf
    v_fmac_f32_dpp v153, v170, v105 row_newbcast:10 row_mask:0xf bank_mask:0xf
    v_fmac_f32_dpp v154, v170, v106 row_newbcast:10 row_mask:0xf bank_mask:0xf
    v_fmac_f32_dpp v155, v170, v107 row_newbcast:10 row_mask:0xf bank_mask:0xf
    s_waitcnt vmcnt(22)
    v_cvt_f32_i32 v100, v68
    v_cvt_f32_i32 v101, v69
    v_cvt_f32_i32 v102, v70
    v_cvt_f32_i32 v103, v71
    s_add_u32 s71, s71, 3072
    buffer_load_dwordx4 v[64:67], v1, s[28:31], s71 offen offset:0 nt
    v_fmac_f32_dpp v156, v170, v100 row_newbcast:10 row_mask:0xf bank_mask:0xf
    v_fmac_f32_dpp v157, v170, v101 row_newbcast:10 row_mask:0xf bank_mask:0xf
    v_fmac_f32_dpp v158, v170, v102 row_newbcast:10 row_mask:0xf bank_mask:0xf
    v_fmac_f32_dpp v159, v170, v103 row_newbcast:10 row_mask:0xf bank_mask:0xf
    s_waitcnt vmcnt(22)
    v_cvt_f32_i32 v104, v72
    v_cvt_f32_i32 v105, v73
    v_cvt_f32_i32 v106, v74
    v_cvt_f32_i32 v107, v75
    buffer_load_dwordx4 v[68:71], v1, s[28:31], s71 offen offset:256 nt
    v_fmac_f32_dpp v160, v170, v104 row_newbcast:10 row_mask:0xf bank_mask:0xf
    v_fmac_f32_dpp v161, v170, v105 row_newbcast:10 row_mask:0xf bank_mask:0xf
    v_fmac_f32_dpp v162, v170, v106 row_newbcast:10 row_mask:0xf bank_mask:0xf
    v_fmac_f32_dpp v163, v170, v107 row_newbcast:10 row_mask:0xf bank_mask:0xf
    s_waitcnt vmcnt(22)
    v_cvt_f32_i32 v100, v76
    v_cvt_f32_i32 v101, v77
    v_cvt_f32_i32 v102, v78
    v_cvt_f32_i32 v103, v79
    buffer_load_dwordx4 v[72:75], v1, s[28:31], s71 offen offset:512 nt
    v_fmac_f32_dpp v152, v170, v100 row_newbcast:6 row_mask:0xf bank_mask:0xf
    v_fmac_f32_dpp v153, v170, v101 row_newbcast:6 row_mask:0xf bank_mask:0xf
    v_fmac_f32_dpp v154, v170, v102 row_newbcast:6 row_mask:0xf bank_mask:0xf
    v_fmac_f32_dpp v155, v170, v103 row_newbcast:6 row_mask:0xf bank_mask:0xf
    s_waitcnt vmcnt(22)
    v_cvt_f32_i32 v104, v80
    v_cvt_f32_i32 v105, v81
    v_cvt_f32_i32 v106, v82
    v_cvt_f32_i32 v107, v83
    s_add_u32 s71, s71, 3072
    buffer_load_dwordx4 v[76:79], v1, s[28:31], s71 offen offset:0 nt
    v_fmac_f32_dpp v156, v170, v104 row_newbcast:6 row_mask:0xf bank_mask:0xf
    v_fmac_f32_dpp v157, v170, v105 row_newbcast:6 row_mask:0xf bank_mask:0xf
    v_fmac_f32_dpp v158, v170, v106 row_newbcast:6 row_mask:0xf bank_mask:0xf
    v_fmac_f32_dpp v159, v170, v107 row_newbcast:6 row_mask:0xf bank_mask:0xf
    s_waitcnt vmcnt(22)
    v_cvt_f32_i32 v100, v84
    v_cvt_f32_i32 v101, v85
    v_cvt_f32_i32 v102, v86
    v_cvt_f32_i32 v103, v87
    buffer_load_dwordx4 v[80:83], v1, s[28:31], s71 offen offset:256 nt
    v_fmac_f32_dpp v160, v170, v100 row_newbcast:6 row_mask:0xf bank_mask:0xf
    v_fmac_f32_dpp v161, v170, v101 row_newbcast:6 row_mask:0xf bank_mask:0xf
    v_fmac_f32_dpp v162, v170, v102 row_newbcast:6 row_mask:0xf bank_mask:0xf
    v_fmac_f32_dpp v163, v170, v103 row_newbcast:6 row_mask:0xf bank_mask:0xf
    s_waitcnt vmcnt(22)
    v_cvt_f32_i32 v104, v88
    v_cvt_f32_i32 v105, v89
    v_cvt_f32_i32 v106, v90
    v_cvt_f32_i32 v107, v91
    buffer_load_dwordx4 v[84:87], v1, s[28:31], s71 offen offset:512 nt
    v_fmac_f32_dpp v152, v170, v104 row_newbcast:14 row_mask:0xf bank_mask:0xf
    v_fmac_f32_dpp v153, v170, v105 row_newbcast:14 row_mask:0xf bank_mask:0xf
    v_fmac_f32_dpp v154, v170, v106 row_newbcast:14 row_mask:0xf bank_mask:0xf
    v_fmac_f32_dpp v155, v170, v107 row_newbcast:14 row_mask:0xf bank_mask:0xf
    s_waitcnt vmcnt(22)
    v_cvt_f32_i32 v100, v92
    v_cvt_f32_i32 v101, v93
    v_cvt_f32_i32 v102, v94
    v_cvt_f32_i32 v103, v95
    s_add_u32 s71, s71, 3072
    buffer_load_dwordx4 v[88:91], v1, s[28:31], s71 offen offset:0 nt
    v_fmac_f32_dpp v156, v170, v100 row_newbcast:14 row_mask:0xf bank_mask:0xf
    v_fmac_f32_dpp v157, v170, v101 row_newbcast:14 row_mask:0xf bank_mask:0xf
    v_fmac_f32_dpp v158, v170, v102 row_newbcast:14 row_mask:0xf bank_mask:0xf
    v_fmac_f32_dpp v159, v170, v103 row_newbcast:14 row_mask:0xf bank_mask:0xf
    ds_read_b32 v177, v176
    s_waitcnt vmcnt(22)
    v_cvt_f32_i32 v104, v96
    v_cvt_f32_i32 v105, v97
    v_cvt_f32_i32 v106, v98
    v_cvt_f32_i32 v107, v99
    buffer_load_dwordx4 v[92:95], v1, s[28:31], s71 offen offset:256 nt
    v_fmac_f32_dpp v160, v170, v104 row_newbcast:14 row_mask:0xf bank_mask:0xf
    v_fmac_f32_dpp v161, v170, v105 row_newbcast:14 row_mask:0xf bank_mask:0xf
    v_fmac_f32_dpp v162, v170, v106 row_newbcast:14 row_mask:0xf bank_mask:0xf
    v_fmac_f32_dpp v163, v170, v107 row_newbcast:14 row_mask:0xf bank_mask:0xf
    s_waitcnt vmcnt(22)
    v_cvt_f32_i32 v100, v4
    v_cvt_f32_i32 v101, v5
    v_cvt_f32_i32 v102, v6
    v_cvt_f32_i32 v103, v7
    buffer_load_dwordx4 v[96:99], v1, s[28:31], s71 offen offset:512 nt
    v_fmac_f32_dpp v152, v170, v100 row_newbcast:1 row_mask:0xf bank_mask:0xf
    v_fmac_f32_dpp v153, v170, v101 row_newbcast:1 row_mask:0xf bank_mask:0xf
    v_fmac_f32_dpp v154, v170, v102 row_newbcast:1 row_mask:0xf bank_mask:0xf
    v_fmac_f32_dpp v155, v170, v103 row_newbcast:1 row_mask:0xf bank_mask:0xf
    s_waitcnt lgkmcnt(0)
    v_readfirstlane_b32 s80, v177
    s_cmp_lg_u32 s80, -1
    s_cbranch_scc1 L_tkok0
L_tkw0:
    ds_read_b32 v177, v176
    s_waitcnt lgkmcnt(0)
    v_readfirstlane_b32 s80, v177
    s_cmp_eq_u32 s80, -1
    s_cbranch_scc1 L_tkw0
L_tkok0:
    v_add_u32 v176, 4, v176
    s_cmp_ge_u32 s80, 64
    s_cbranch_scc1 L_dtail0
    s_lshr_b32 s81, s80, 3
    s_and_b32 s80, s80, 7
    s_mul_i32 s70, s81, 64
    s_add_u32 s70, s70, s80
    s_add_u32 s70, s70, s94
    s_and_b32 s95, s2, 0xf8
    s_add_u32 s95, s95, s80
    s_mul_i32 s95, s95, 8
    s_add_u32 s95, s95, s81
    s_mul_i32 s95, s95, 512
    s_add_u32 s95, s95, 8388608
    s_waitcnt vmcnt(22)
    v_cvt_f32_i32 v104, v8
    v_cvt_f32_i32 v105, v9
    v_cvt_f32_i32 v106, v10
    v_cvt_f32_i32 v107, v11
    s_lshl_b32 s73, s70, 7
    buffer_load_dwordx2 v[172:173], v174, s[52:55], s95 offen sc0 sc1
    buffer_load_ushort v168, v3, s[40:43], s73 offen
    buffer_load_ushort v169, v3, s[44:47], s73 offen
    s_mul_i32 s71, s70, 49152
    buffer_load_dwordx4 v[4:7], v1, s[28:31], s71 offen offset:0 nt
    v_fmac_f32_dpp v156, v170, v104 row_newbcast:1 row_mask:0xf bank_mask:0xf
    v_fmac_f32_dpp v157, v170, v105 row_newbcast:1 row_mask:0xf bank_mask:0xf
    v_fmac_f32_dpp v158, v170, v106 row_newbcast:1 row_mask:0xf bank_mask:0xf
    v_fmac_f32_dpp v159, v170, v107 row_newbcast:1 row_mask:0xf bank_mask:0xf
    s_waitcnt vmcnt(25)
    v_cvt_f32_i32 v100, v12
    v_cvt_f32_i32 v101, v13
    v_cvt_f32_i32 v102, v14
    v_cvt_f32_i32 v103, v15
    buffer_load_dwordx4 v[8:11], v1, s[28:31], s71 offen offset:256 nt
    v_fmac_f32_dpp v160, v170, v100 row_newbcast:1 row_mask:0xf bank_mask:0xf
    v_fmac_f32_dpp v161, v170, v101 row_newbcast:1 row_mask:0xf bank_mask:0xf
    v_fmac_f32_dpp v162, v170, v102 row_newbcast:1 row_mask:0xf bank_mask:0xf
    v_fmac_f32_dpp v163, v170, v103 row_newbcast:1 row_mask:0xf bank_mask:0xf
    s_waitcnt vmcnt(25)
    v_cvt_f32_i32 v104, v16
    v_cvt_f32_i32 v105, v17
    v_cvt_f32_i32 v106, v18
    v_cvt_f32_i32 v107, v19
    buffer_load_dwordx4 v[12:15], v1, s[28:31], s71 offen offset:512 nt
    v_fmac_f32_dpp v152, v170, v104 row_newbcast:9 row_mask:0xf bank_mask:0xf
    v_fmac_f32_dpp v153, v170, v105 row_newbcast:9 row_mask:0xf bank_mask:0xf
    v_fmac_f32_dpp v154, v170, v106 row_newbcast:9 row_mask:0xf bank_mask:0xf
    v_fmac_f32_dpp v155, v170, v107 row_newbcast:9 row_mask:0xf bank_mask:0xf
    s_waitcnt vmcnt(25)
    v_cvt_f32_i32 v100, v20
    v_cvt_f32_i32 v101, v21
    v_cvt_f32_i32 v102, v22
    v_cvt_f32_i32 v103, v23
    s_add_u32 s71, s71, 3072
    buffer_load_dwordx4 v[16:19], v1, s[28:31], s71 offen offset:0 nt
    v_fmac_f32_dpp v156, v170, v100 row_newbcast:9 row_mask:0xf bank_mask:0xf
    v_fmac_f32_dpp v157, v170, v101 row_newbcast:9 row_mask:0xf bank_mask:0xf
    v_fmac_f32_dpp v158, v170, v102 row_newbcast:9 row_mask:0xf bank_mask:0xf
    v_fmac_f32_dpp v159, v170, v103 row_newbcast:9 row_mask:0xf bank_mask:0xf
    s_waitcnt vmcnt(25)
    v_cvt_f32_i32 v104, v24
    v_cvt_f32_i32 v105, v25
    v_cvt_f32_i32 v106, v26
    v_cvt_f32_i32 v107, v27
    buffer_load_dwordx4 v[20:23], v1, s[28:31], s71 offen offset:256 nt
    v_fmac_f32_dpp v160, v170, v104 row_newbcast:9 row_mask:0xf bank_mask:0xf
    v_fmac_f32_dpp v161, v170, v105 row_newbcast:9 row_mask:0xf bank_mask:0xf
    v_fmac_f32_dpp v162, v170, v106 row_newbcast:9 row_mask:0xf bank_mask:0xf
    v_fmac_f32_dpp v163, v170, v107 row_newbcast:9 row_mask:0xf bank_mask:0xf
    s_waitcnt vmcnt(25)
    v_cvt_f32_i32 v100, v28
    v_cvt_f32_i32 v101, v29
    v_cvt_f32_i32 v102, v30
    v_cvt_f32_i32 v103, v31
    buffer_load_dwordx4 v[24:27], v1, s[28:31], s71 offen offset:512 nt
    v_fmac_f32_dpp v152, v170, v100 row_newbcast:5 row_mask:0xf bank_mask:0xf
    v_fmac_f32_dpp v153, v170, v101 row_newbcast:5 row_mask:0xf bank_mask:0xf
    v_fmac_f32_dpp v154, v170, v102 row_newbcast:5 row_mask:0xf bank_mask:0xf
    v_fmac_f32_dpp v155, v170, v103 row_newbcast:5 row_mask:0xf bank_mask:0xf
    s_waitcnt vmcnt(25)
    v_cvt_f32_i32 v104, v32
    v_cvt_f32_i32 v105, v33
    v_cvt_f32_i32 v106, v34
    v_cvt_f32_i32 v107, v35
    s_add_u32 s71, s71, 3072
    buffer_load_dwordx4 v[28:31], v1, s[28:31], s71 offen offset:0 nt
    v_fmac_f32_dpp v156, v170, v104 row_newbcast:5 row_mask:0xf bank_mask:0xf
    v_fmac_f32_dpp v157, v170, v105 row_newbcast:5 row_mask:0xf bank_mask:0xf
    v_fmac_f32_dpp v158, v170, v106 row_newbcast:5 row_mask:0xf bank_mask:0xf
    v_fmac_f32_dpp v159, v170, v107 row_newbcast:5 row_mask:0xf bank_mask:0xf
    s_waitcnt vmcnt(25)
    v_cvt_f32_i32 v100, v36
    v_cvt_f32_i32 v101, v37
    v_cvt_f32_i32 v102, v38
    v_cvt_f32_i32 v103, v39
    buffer_load_dwordx4 v[32:35], v1, s[28:31], s71 offen offset:256 nt
    v_fmac_f32_dpp v160, v170, v100 row_newbcast:5 row_mask:0xf bank_mask:0xf
    v_fmac_f32_dpp v161, v170, v101 row_newbcast:5 row_mask:0xf bank_mask:0xf
    v_fmac_f32_dpp v162, v170, v102 row_newbcast:5 row_mask:0xf bank_mask:0xf
    v_fmac_f32_dpp v163, v170, v103 row_newbcast:5 row_mask:0xf bank_mask:0xf
    s_waitcnt vmcnt(25)
    v_cvt_f32_i32 v104, v40
    v_cvt_f32_i32 v105, v41
    v_cvt_f32_i32 v106, v42
    v_cvt_f32_i32 v107, v43
    buffer_load_dwordx4 v[36:39], v1, s[28:31], s71 offen offset:512 nt
    v_fmac_f32_dpp v152, v170, v104 row_newbcast:13 row_mask:0xf bank_mask:0xf
    v_fmac_f32_dpp v153, v170, v105 row_newbcast:13 row_mask:0xf bank_mask:0xf
    v_fmac_f32_dpp v154, v170, v106 row_newbcast:13 row_mask:0xf bank_mask:0xf
    v_fmac_f32_dpp v155, v170, v107 row_newbcast:13 row_mask:0xf bank_mask:0xf
    s_waitcnt vmcnt(25)
    v_cvt_f32_i32 v100, v44
    v_cvt_f32_i32 v101, v45
    v_cvt_f32_i32 v102, v46
    v_cvt_f32_i32 v103, v47
    s_add_u32 s71, s71, 3072
    buffer_load_dwordx4 v[40:43], v1, s[28:31], s71 offen offset:0 nt
    v_fmac_f32_dpp v156, v170, v100 row_newbcast:13 row_mask:0xf bank_mask:0xf
    v_fmac_f32_dpp v157, v170, v101 row_newbcast:13 row_mask:0xf bank_mask:0xf
    v_fmac_f32_dpp v158, v170, v102 row_newbcast:13 row_mask:0xf bank_mask:0xf
    v_fmac_f32_dpp v159, v170, v103 row_newbcast:13 row_mask:0xf bank_mask:0xf
    s_waitcnt vmcnt(25)
    v_cvt_f32_i32 v104, v48
    v_cvt_f32_i32 v105, v49
    v_cvt_f32_i32 v106, v50
    v_cvt_f32_i32 v107, v51
    buffer_load_dwordx4 v[44:47], v1, s[28:31], s71 offen offset:256 nt
    v_fmac_f32_dpp v160, v170, v104 row_newbcast:13 row_mask:0xf bank_mask:0xf
    v_fmac_f32_dpp v161, v170, v105 row_newbcast:13 row_mask:0xf bank_mask:0xf
    v_fmac_f32_dpp v162, v170, v106 row_newbcast:13 row_mask:0xf bank_mask:0xf
    v_fmac_f32_dpp v163, v170, v107 row_newbcast:13 row_mask:0xf bank_mask:0xf
    s_waitcnt vmcnt(25)
    v_cvt_f32_i32 v100, v52
    v_cvt_f32_i32 v101, v53
    v_cvt_f32_i32 v102, v54
    v_cvt_f32_i32 v103, v55
    buffer_load_dwordx4 v[48:51], v1, s[28:31], s71 offen offset:512 nt
    v_fmac_f32_dpp v152, v170, v100 row_newbcast:3 row_mask:0xf bank_mask:0xf
    v_fmac_f32_dpp v153, v170, v101 row_newbcast:3 row_mask:0xf bank_mask:0xf
    v_fmac_f32_dpp v154, v170, v102 row_newbcast:3 row_mask:0xf bank_mask:0xf
    v_fmac_f32_dpp v155, v170, v103 row_newbcast:3 row_mask:0xf bank_mask:0xf
    s_waitcnt vmcnt(25)
    v_cvt_f32_i32 v104, v56
    v_cvt_f32_i32 v105, v57
    v_cvt_f32_i32 v106, v58
    v_cvt_f32_i32 v107, v59
    s_add_u32 s71, s71, 3072
    buffer_load_dwordx4 v[52:55], v1, s[28:31], s71 offen offset:0 nt
    v_fmac_f32_dpp v156, v170, v104 row_newbcast:3 row_mask:0xf bank_mask:0xf
    v_fmac_f32_dpp v157, v170, v105 row_newbcast:3 row_mask:0xf bank_mask:0xf
    v_fmac_f32_dpp v158, v170, v106 row_newbcast:3 row_mask:0xf bank_mask:0xf
    v_fmac_f32_dpp v159, v170, v107 row_newbcast:3 row_mask:0xf bank_mask:0xf
    s_waitcnt vmcnt(25)
    v_cvt_f32_i32 v100, v60
    v_cvt_f32_i32 v101, v61
    v_cvt_f32_i32 v102, v62
    v_cvt_f32_i32 v103, v63
    buffer_load_dwordx4 v[56:59], v1, s[28:31], s71 offen offset:256 nt
    v_fmac_f32_dpp v160, v170, v100 row_newbcast:3 row_mask:0xf bank_mask:0xf
    v_fmac_f32_dpp v161, v170, v101 row_newbcast:3 row_mask:0xf bank_mask:0xf
    v_fmac_f32_dpp v162, v170, v102 row_newbcast:3 row_mask:0xf bank_mask:0xf
    v_fmac_f32_dpp v163, v170, v103 row_newbcast:3 row_mask:0xf bank_mask:0xf
    s_waitcnt vmcnt(25)
    v_cvt_f32_i32 v104, v64
    v_cvt_f32_i32 v105, v65
    v_cvt_f32_i32 v106, v66
    v_cvt_f32_i32 v107, v67
    buffer_load_dwordx4 v[60:63], v1, s[28:31], s71 offen offset:512 nt
    v_fmac_f32_dpp v152, v170, v104 row_newbcast:11 row_mask:0xf bank_mask:0xf
    v_fmac_f32_dpp v153, v170, v105 row_newbcast:11 row_mask:0xf bank_mask:0xf
    v_fmac_f32_dpp v154, v170, v106 row_newbcast:11 row_mask:0xf bank_mask:0xf
    v_fmac_f32_dpp v155, v170, v107 row_newbcast:11 row_mask:0xf bank_mask:0xf
    s_waitcnt vmcnt(25)
    v_cvt_f32_i32 v100, v68
    v_cvt_f32_i32 v101, v69
    v_cvt_f32_i32 v102, v70
    v_cvt_f32_i32 v103, v71
    s_add_u32 s71, s71, 3072
    buffer_load_dwordx4 v[64:67], v1, s[28:31], s71 offen offset:0 nt
    v_fmac_f32_dpp v156, v170, v100 row_newbcast:11 row_mask:0xf bank_mask:0xf
    v_fmac_f32_dpp v157, v170, v101 row_newbcast:11 row_mask:0xf bank_mask:0xf
    v_fmac_f32_dpp v158, v170, v102 row_newbcast:11 row_mask:0xf bank_mask:0xf
    v_fmac_f32_dpp v159, v170, v103 row_newbcast:11 row_mask:0xf bank_mask:0xf
    s_waitcnt vmcnt(25)
    v_cvt_f32_i32 v104, v72
    v_cvt_f32_i32 v105, v73
    v_cvt_f32_i32 v106, v74
    v_cvt_f32_i32 v107, v75
    buffer_load_dwordx4 v[68:71], v1, s[28:31], s71 offen offset:256 nt
    v_fmac_f32_dpp v160, v170, v104 row_newbcast:11 row_mask:0xf bank_mask:0xf
    v_fmac_f32_dpp v161, v170, v105 row_newbcast:11 row_mask:0xf bank_mask:0xf
    v_fmac_f32_dpp v162, v170, v106 row_newbcast:11 row_mask:0xf bank_mask:0xf
    v_fmac_f32_dpp v163, v170, v107 row_newbcast:11 row_mask:0xf bank_mask:0xf
    s_waitcnt vmcnt(25)
    v_cvt_f32_i32 v100, v76
    v_cvt_f32_i32 v101, v77
    v_cvt_f32_i32 v102, v78
    v_cvt_f32_i32 v103, v79
    buffer_load_dwordx4 v[72:75], v1, s[28:31], s71 offen offset:512 nt
    v_fmac_f32_dpp v152, v170, v100 row_newbcast:7 row_mask:0xf bank_mask:0xf
    v_fmac_f32_dpp v153, v170, v101 row_newbcast:7 row_mask:0xf bank_mask:0xf
    v_fmac_f32_dpp v154, v170, v102 row_newbcast:7 row_mask:0xf bank_mask:0xf
    v_fmac_f32_dpp v155, v170, v103 row_newbcast:7 row_mask:0xf bank_mask:0xf
    s_waitcnt vmcnt(25)
    v_cvt_f32_i32 v104, v80
    v_cvt_f32_i32 v105, v81
    v_cvt_f32_i32 v106, v82
    v_cvt_f32_i32 v107, v83
    s_add_u32 s71, s71, 3072
    buffer_load_dwordx4 v[76:79], v1, s[28:31], s71 offen offset:0 nt
    v_fmac_f32_dpp v156, v170, v104 row_newbcast:7 row_mask:0xf bank_mask:0xf
    v_fmac_f32_dpp v157, v170, v105 row_newbcast:7 row_mask:0xf bank_mask:0xf
    v_fmac_f32_dpp v158, v170, v106 row_newbcast:7 row_mask:0xf bank_mask:0xf
    v_fmac_f32_dpp v159, v170, v107 row_newbcast:7 row_mask:0xf bank_mask:0xf
    s_waitcnt vmcnt(25)
    v_cvt_f32_i32 v100, v84
    v_cvt_f32_i32 v101, v85
    v_cvt_f32_i32 v102, v86
    v_cvt_f32_i32 v103, v87
    buffer_load_dwordx4 v[80:83], v1, s[28:31], s71 offen offset:256 nt
    v_fmac_f32_dpp v160, v170, v100 row_newbcast:7 row_mask:0xf bank_mask:0xf
    v_fmac_f32_dpp v161, v170, v101 row_newbcast:7 row_mask:0xf bank_mask:0xf
    v_fmac_f32_dpp v162, v170, v102 row_newbcast:7 row_mask:0xf bank_mask:0xf
    v_fmac_f32_dpp v163, v170, v103 row_newbcast:7 row_mask:0xf bank_mask:0xf
    s_waitcnt vmcnt(25)
    v_cvt_f32_i32 v104, v88
    v_cvt_f32_i32 v105, v89
    v_cvt_f32_i32 v106, v90
    v_cvt_f32_i32 v107, v91
    buffer_load_dwordx4 v[84:87], v1, s[28:31], s71 offen offset:512 nt
    v_fmac_f32_dpp v152, v170, v104 row_newbcast:15 row_mask:0xf bank_mask:0xf
    v_fmac_f32_dpp v153, v170, v105 row_newbcast:15 row_mask:0xf bank_mask:0xf
    v_fmac_f32_dpp v154, v170, v106 row_newbcast:15 row_mask:0xf bank_mask:0xf
    v_fmac_f32_dpp v155, v170, v107 row_newbcast:15 row_mask:0xf bank_mask:0xf
    s_waitcnt vmcnt(25)
    v_cvt_f32_i32 v100, v92
    v_cvt_f32_i32 v101, v93
    v_cvt_f32_i32 v102, v94
    v_cvt_f32_i32 v103, v95
    s_add_u32 s71, s71, 3072
    buffer_load_dwordx4 v[88:91], v1, s[28:31], s71 offen offset:0 nt
    v_fmac_f32_dpp v156, v170, v100 row_newbcast:15 row_mask:0xf bank_mask:0xf
    v_fmac_f32_dpp v157, v170, v101 row_newbcast:15 row_mask:0xf bank_mask:0xf
    v_fmac_f32_dpp v158, v170, v102 row_newbcast:15 row_mask:0xf bank_mask:0xf
    v_fmac_f32_dpp v159, v170, v103 row_newbcast:15 row_mask:0xf bank_mask:0xf
    s_waitcnt vmcnt(25)
    v_cvt_f32_i32 v104, v96
    v_cvt_f32_i32 v105, v97
    v_cvt_f32_i32 v106, v98
    v_cvt_f32_i32 v107, v99
    buffer_load_dwordx4 v[92:95], v1, s[28:31], s71 offen offset:256 nt
    v_fmac_f32_dpp v160, v170, v104 row_newbcast:15 row_mask:0xf bank_mask:0xf
    v_fmac_f32_dpp v161, v170, v105 row_newbcast:15 row_mask:0xf bank_mask:0xf
    v_fmac_f32_dpp v162, v170, v106 row_newbcast:15 row_mask:0xf bank_mask:0xf
    v_fmac_f32_dpp v163, v170, v107 row_newbcast:15 row_mask:0xf bank_mask:0xf
    s_branch L_dloop
L_lgretry0:
    buffer_load_dwordx2 v[172:173], v174, s[52:55], s95 offen sc0 sc1
    s_waitcnt vmcnt(0)
    s_branch L_lgchk0
L_dtail0:
    s_waitcnt vmcnt(22)
    v_cvt_f32_i32 v104, v8
    v_cvt_f32_i32 v105, v9
    v_cvt_f32_i32 v106, v10
    v_cvt_f32_i32 v107, v11
    v_fmac_f32_dpp v156, v170, v104 row_newbcast:1 row_mask:0xf bank_mask:0xf
    v_fmac_f32_dpp v157, v170, v105 row_newbcast:1 row_mask:0xf bank_mask:0xf
    v_fmac_f32_dpp v158, v170, v106 row_newbcast:1 row_mask:0xf bank_mask:0xf
    v_fmac_f32_dpp v159, v170, v107 row_newbcast:1 row_mask:0xf bank_mask:0xf
    s_waitcnt vmcnt(21)
    v_cvt_f32_i32 v100, v12
    v_cvt_f32_i32 v101, v13
    v_cvt_f32_i32 v102, v14
    v_cvt_f32_i32 v103, v15
    v_fmac_f32_dpp v160, v170, v100 row_newbcast:1 row_mask:0xf bank_mask:0xf
    v_fmac_f32_dpp v161, v170, v101 row_newbcast:1 row_mask:0xf bank_mask:0xf
    v_fmac_f32_dpp v162, v170, v102 row_newbcast:1 row_mask:0xf bank_mask:0xf
    v_fmac_f32_dpp v163, v170, v103 row_newbcast:1 row_mask:0xf bank_mask:0xf
    s_waitcnt vmcnt(20)
    v_cvt_f32_i32 v104, v16
    v_cvt_f32_i32 v105, v17
    v_cvt_f32_i32 v106, v18
    v_cvt_f32_i32 v107, v19
    v_fmac_f32_dpp v152, v170, v104 row_newbcast:9 row_mask:0xf bank_mask:0xf
    v_fmac_f32_dpp v153, v170, v105 row_newbcast:9 row_mask:0xf bank_mask:0xf
    v_fmac_f32_dpp v154, v170, v106 row_newbcast:9 row_mask:0xf bank_mask:0xf
    v_fmac_f32_dpp v155, v170, v107 row_newbcast:9 row_mask:0xf bank_mask:0xf
    s_waitcnt vmcnt(19)
    v_cvt_f32_i32 v100, v20
    v_cvt_f32_i32 v101, v21
    v_cvt_f32_i32 v102, v22
    v_cvt_f32_i32 v103, v23
    v_fmac_f32_dpp v156, v170, v100 row_newbcast:9 row_mask:0xf bank_mask:0xf
    v_fmac_f32_dpp v157, v170, v101 row_newbcast:9 row_mask:0xf bank_mask:0xf
    v_fmac_f32_dpp v158, v170, v102 row_newbcast:9 row_mask:0xf bank_mask:0xf
    v_fmac_f32_dpp v159, v170, v103 row_newbcast:9 row_mask:0xf bank_mask:0xf
    s_waitcnt vmcnt(18)
    v_cvt_f32_i32 v104, v24
    v_cvt_f32_i32 v105, v25
    v_cvt_f32_i32 v106, v26
    v_cvt_f32_i32 v107, v27
    v_fmac_f32_dpp v160, v170, v104 row_newbcast:9 row_mask:0xf bank_mask:0xf
    v_fmac_f32_dpp v161, v170, v105 row_newbcast:9 row_mask:0xf bank_mask:0xf
    v_fmac_f32_dpp v162, v170, v106 row_newbcast:9 row_mask:0xf bank_mask:0xf
    v_fmac_f32_dpp v163, v170, v107 row_newbcast:9 row_mask:0xf bank_mask:0xf
    s_waitcnt vmcnt(17)
    v_cvt_f32_i32 v100, v28
    v_cvt_f32_i32 v101, v29
    v_cvt_f32_i32 v102, v30
    v_cvt_f32_i32 v103, v31
    v_fmac_f32_dpp v152, v170, v100 row_newbcast:5 row_mask:0xf bank_mask:0xf
    v_fmac_f32_dpp v153, v170, v101 row_newbcast:5 row_mask:0xf bank_mask:0xf
    v_fmac_f32_dpp v154, v170, v102 row_newbcast:5 row_mask:0xf bank_mask:0xf
    v_fmac_f32_dpp v155, v170, v103 row_newbcast:5 row_mask:0xf bank_mask:0xf
    s_waitcnt vmcnt(16)
    v_cvt_f32_i32 v104, v32
    v_cvt_f32_i32 v105, v33
    v_cvt_f32_i32 v106, v34
    v_cvt_f32_i32 v107, v35
    v_fmac_f32_dpp v156, v170, v104 row_newbcast:5 row_mask:0xf bank_mask:0xf
    v_fmac_f32_dpp v157, v170, v105 row_newbcast:5 row_mask:0xf bank_mask:0xf
    v_fmac_f32_dpp v158, v170, v106 row_newbcast:5 row_mask:0xf bank_mask:0xf
    v_fmac_f32_dpp v159, v170, v107 row_newbcast:5 row_mask:0xf bank_mask:0xf
    s_waitcnt vmcnt(15)
    v_cvt_f32_i32 v100, v36
    v_cvt_f32_i32 v101, v37
    v_cvt_f32_i32 v102, v38
    v_cvt_f32_i32 v103, v39
    v_fmac_f32_dpp v160, v170, v100 row_newbcast:5 row_mask:0xf bank_mask:0xf
    v_fmac_f32_dpp v161, v170, v101 row_newbcast:5 row_mask:0xf bank_mask:0xf
    v_fmac_f32_dpp v162, v170, v102 row_newbcast:5 row_mask:0xf bank_mask:0xf
    v_fmac_f32_dpp v163, v170, v103 row_newbcast:5 row_mask:0xf bank_mask:0xf
    s_waitcnt vmcnt(14)
    v_cvt_f32_i32 v104, v40
    v_cvt_f32_i32 v105, v41
    v_cvt_f32_i32 v106, v42
    v_cvt_f32_i32 v107, v43
    v_fmac_f32_dpp v152, v170, v104 row_newbcast:13 row_mask:0xf bank_mask:0xf
    v_fmac_f32_dpp v153, v170, v105 row_newbcast:13 row_mask:0xf bank_mask:0xf
    v_fmac_f32_dpp v154, v170, v106 row_newbcast:13 row_mask:0xf bank_mask:0xf
    v_fmac_f32_dpp v155, v170, v107 row_newbcast:13 row_mask:0xf bank_mask:0xf
    s_waitcnt vmcnt(13)
    v_cvt_f32_i32 v100, v44
    v_cvt_f32_i32 v101, v45
    v_cvt_f32_i32 v102, v46
    v_cvt_f32_i32 v103, v47
    v_fmac_f32_dpp v156, v170, v100 row_newbcast:13 row_mask:0xf bank_mask:0xf
    v_fmac_f32_dpp v157, v170, v101 row_newbcast:13 row_mask:0xf bank_mask:0xf
    v_fmac_f32_dpp v158, v170, v102 row_newbcast:13 row_mask:0xf bank_mask:0xf
    v_fmac_f32_dpp v159, v170, v103 row_newbcast:13 row_mask:0xf bank_mask:0xf
    s_waitcnt vmcnt(12)
    v_cvt_f32_i32 v104, v48
    v_cvt_f32_i32 v105, v49
    v_cvt_f32_i32 v106, v50
    v_cvt_f32_i32 v107, v51
    v_fmac_f32_dpp v160, v170, v104 row_newbcast:13 row_mask:0xf bank_mask:0xf
    v_fmac_f32_dpp v161, v170, v105 row_newbcast:13 row_mask:0xf bank_mask:0xf
    v_fmac_f32_dpp v162, v170, v106 row_newbcast:13 row_mask:0xf bank_mask:0xf
    v_fmac_f32_dpp v163, v170, v107 row_newbcast:13 row_mask:0xf bank_mask:0xf
    s_waitcnt vmcnt(11)
    v_cvt_f32_i32 v100, v52
    v_cvt_f32_i32 v101, v53
    v_cvt_f32_i32 v102, v54
    v_cvt_f32_i32 v103, v55
    v_fmac_f32_dpp v152, v170, v100 row_newbcast:3 row_mask:0xf bank_mask:0xf
    v_fmac_f32_dpp v153, v170, v101 row_newbcast:3 row_mask:0xf bank_mask:0xf
    v_fmac_f32_dpp v154, v170, v102 row_newbcast:3 row_mask:0xf bank_mask:0xf
    v_fmac_f32_dpp v155, v170, v103 row_newbcast:3 row_mask:0xf bank_mask:0xf
    s_waitcnt vmcnt(10)
    v_cvt_f32_i32 v104, v56
    v_cvt_f32_i32 v105, v57
    v_cvt_f32_i32 v106, v58
    v_cvt_f32_i32 v107, v59
    v_fmac_f32_dpp v156, v170, v104 row_newbcast:3 row_mask:0xf bank_mask:0xf
    v_fmac_f32_dpp v157, v170, v105 row_newbcast:3 row_mask:0xf bank_mask:0xf
    v_fmac_f32_dpp v158, v170, v106 row_newbcast:3 row_mask:0xf bank_mask:0xf
    v_fmac_f32_dpp v159, v170, v107 row_newbcast:3 row_mask:0xf bank_mask:0xf
    s_waitcnt vmcnt(9)
    v_cvt_f32_i32 v100, v60
    v_cvt_f32_i32 v101, v61
    v_cvt_f32_i32 v102, v62
    v_cvt_f32_i32 v103, v63
    v_fmac_f32_dpp v160, v170, v100 row_newbcast:3 row_mask:0xf bank_mask:0xf
    v_fmac_f32_dpp v161, v170, v101 row_newbcast:3 row_mask:0xf bank_mask:0xf
    v_fmac_f32_dpp v162, v170, v102 row_newbcast:3 row_mask:0xf bank_mask:0xf
    v_fmac_f32_dpp v163, v170, v103 row_newbcast:3 row_mask:0xf bank_mask:0xf
    s_waitcnt vmcnt(8)
    v_cvt_f32_i32 v104, v64
    v_cvt_f32_i32 v105, v65
    v_cvt_f32_i32 v106, v66
    v_cvt_f32_i32 v107, v67
    v_fmac_f32_dpp v152, v170, v104 row_newbcast:11 row_mask:0xf bank_mask:0xf
    v_fmac_f32_dpp v153, v170, v105 row_newbcast:11 row_mask:0xf bank_mask:0xf
    v_fmac_f32_dpp v154, v170, v106 row_newbcast:11 row_mask:0xf bank_mask:0xf
    v_fmac_f32_dpp v155, v170, v107 row_newbcast:11 row_mask:0xf bank_mask:0xf
    s_waitcnt vmcnt(7)
    v_cvt_f32_i32 v100, v68
    v_cvt_f32_i32 v101, v69
    v_cvt_f32_i32 v102, v70
    v_cvt_f32_i32 v103, v71
    v_fmac_f32_dpp v156, v170, v100 row_newbcast:11 row_mask:0xf bank_mask:0xf
    v_fmac_f32_dpp v157, v170, v101 row_newbcast:11 row_mask:0xf bank_mask:0xf
    v_fmac_f32_dpp v158, v170, v102 row_newbcast:11 row_mask:0xf bank_mask:0xf
    v_fmac_f32_dpp v159, v170, v103 row_newbcast:11 row_mask:0xf bank_mask:0xf
    s_waitcnt vmcnt(6)
    v_cvt_f32_i32 v104, v72
    v_cvt_f32_i32 v105, v73
    v_cvt_f32_i32 v106, v74
    v_cvt_f32_i32 v107, v75
    v_fmac_f32_dpp v160, v170, v104 row_newbcast:11 row_mask:0xf bank_mask:0xf
    v_fmac_f32_dpp v161, v170, v105 row_newbcast:11 row_mask:0xf bank_mask:0xf
    v_fmac_f32_dpp v162, v170, v106 row_newbcast:11 row_mask:0xf bank_mask:0xf
    v_fmac_f32_dpp v163, v170, v107 row_newbcast:11 row_mask:0xf bank_mask:0xf
    s_waitcnt vmcnt(5)
    v_cvt_f32_i32 v100, v76
    v_cvt_f32_i32 v101, v77
    v_cvt_f32_i32 v102, v78
    v_cvt_f32_i32 v103, v79
    v_fmac_f32_dpp v152, v170, v100 row_newbcast:7 row_mask:0xf bank_mask:0xf
    v_fmac_f32_dpp v153, v170, v101 row_newbcast:7 row_mask:0xf bank_mask:0xf
    v_fmac_f32_dpp v154, v170, v102 row_newbcast:7 row_mask:0xf bank_mask:0xf
    v_fmac_f32_dpp v155, v170, v103 row_newbcast:7 row_mask:0xf bank_mask:0xf
    s_waitcnt vmcnt(4)
    v_cvt_f32_i32 v104, v80
    v_cvt_f32_i32 v105, v81
    v_cvt_f32_i32 v106, v82
    v_cvt_f32_i32 v107, v83
    v_fmac_f32_dpp v156, v170, v104 row_newbcast:7 row_mask:0xf bank_mask:0xf
    v_fmac_f32_dpp v157, v170, v105 row_newbcast:7 row_mask:0xf bank_mask:0xf
    v_fmac_f32_dpp v158, v170, v106 row_newbcast:7 row_mask:0xf bank_mask:0xf
    v_fmac_f32_dpp v159, v170, v107 row_newbcast:7 row_mask:0xf bank_mask:0xf
    s_waitcnt vmcnt(3)
    v_cvt_f32_i32 v100, v84
    v_cvt_f32_i32 v101, v85
    v_cvt_f32_i32 v102, v86
    v_cvt_f32_i32 v103, v87
    v_fmac_f32_dpp v160, v170, v100 row_newbcast:7 row_mask:0xf bank_mask:0xf
    v_fmac_f32_dpp v161, v170, v101 row_newbcast:7 row_mask:0xf bank_mask:0xf
    v_fmac_f32_dpp v162, v170, v102 row_newbcast:7 row_mask:0xf bank_mask:0xf
    v_fmac_f32_dpp v163, v170, v103 row_newbcast:7 row_mask:0xf bank_mask:0xf
    s_waitcnt vmcnt(2)
    v_cvt_f32_i32 v104, v88
    v_cvt_f32_i32 v105, v89
    v_cvt_f32_i32 v106, v90
    v_cvt_f32_i32 v107, v91
    v_fmac_f32_dpp v152, v170, v104 row_newbcast:15 row_mask:0xf bank_mask:0xf
    v_fmac_f32_dpp v153, v170, v105 row_newbcast:15 row_mask:0xf bank_mask:0xf
    v_fmac_f32_dpp v154, v170, v106 row_newbcast:15 row_mask:0xf bank_mask:0xf
    v_fmac_f32_dpp v155, v170, v107 row_newbcast:15 row_mask:0xf bank_mask:0xf
    s_waitcnt vmcnt(1)
    v_cvt_f32_i32 v100, v92
    v_cvt_f32_i32 v101, v93
    v_cvt_f32_i32 v102, v94
    v_cvt_f32_i32 v103, v95
    v_fmac_f32_dpp v156, v170, v100 row_newbcast:15 row_mask:0xf bank_mask:0xf
    v_fmac_f32_dpp v157, v170, v101 row_newbcast:15 row_mask:0xf bank_mask:0xf
    v_fmac_f32_dpp v158, v170, v102 row_newbcast:15 row_mask:0xf bank_mask:0xf
    v_fmac_f32_dpp v159, v170, v103 row_newbcast:15 row_mask:0xf bank_mask:0xf
    s_waitcnt vmcnt(0)
    v_cvt_f32_i32 v104, v96
    v_cvt_f32_i32 v105, v97
    v_cvt_f32_i32 v106, v98
    v_cvt_f32_i32 v107, v99
    v_fmac_f32_dpp v160, v170, v104 row_newbcast:15 row_mask:0xf bank_mask:0xf
    v_fmac_f32_dpp v161, v170, v105 row_newbcast:15 row_mask:0xf bank_mask:0xf
    v_fmac_f32_dpp v162, v170, v106 row_newbcast:15 row_mask:0xf bank_mask:0xf
    v_fmac_f32_dpp v163, v170, v107 row_newbcast:15 row_mask:0xf bank_mask:0xf
L_dfin:
    s_nop 0
    v_add_f32_dpp v166, v166, v166 row_ror:8 row_mask:0xf bank_mask:0xf
    v_add_f32_dpp v167, v167, v167 row_ror:8 row_mask:0xf bank_mask:0xf
    s_nop 0
    v_add_f32_dpp v166, v166, v166 row_ror:4 row_mask:0xf bank_mask:0xf
    v_add_f32_dpp v167, v167, v167 row_ror:4 row_mask:0xf bank_mask:0xf
    s_nop 0
    v_add_f32_dpp v166, v166, v166 row_ror:2 row_mask:0xf bank_mask:0xf
    v_add_f32_dpp v167, v167, v167 row_ror:2 row_mask:0xf bank_mask:0xf
    s_nop 0
    v_add_f32_dpp v166, v166, v166 row_ror:1 row_mask:0xf bank_mask:0xf
    v_add_f32_dpp v167, v167, v167 row_ror:1 row_mask:0xf bank_mask:0xf
    v_mov_b32 v184, v165
    v_mov_b32 v185, v165
    s_nop 1
    v_permlane32_swap_b32 v184, v185
    s_nop 1
    v_max_f32 v184, v184, v185
    v_mov_b32 v185, v184
    s_nop 1
    v_permlane16_swap_b32 v184, v185
    s_nop 1
    v_max_f32 v184, v184, v185
    v_sub_f32 v185, v165, v184
    v_exp_f32 v185, v185
    v_mov_b32 v165, v184
    v_mul_f32 v166, v166, v185
    v_mul_f32 v167, v167, v185
    v_fma_f32 v152, v152, v185, -v167
    v_fma_f32 v153, v153, v185, -v167
    v_fma_f32 v154, v154, v185, -v167
    v_fma_f32 v155, v155, v185, -v167
    v_fma_f32 v156, v156, v185, -v167
    v_fma_f32 v157, v157, v185, -v167
    v_fma_f32 v158, v158, v185, -v167
    v_fma_f32 v159, v159, v185, -v167
    v_fma_f32 v160, v160, v185, -v167
    v_fma_f32 v161, v161, v185, -v167
    v_fma_f32 v162, v162, v185, -v167
    v_fma_f32 v163, v163, v185, -v167
    v_mov_b32 v184, v166
    s_nop 1
    v_permlane32_swap_b32 v166, v184
    v_permlane32_swap_b32 v152, v154
    v_permlane32_swap_b32 v153, v155
    v_permlane32_swap_b32 v156, v158
    v_permlane32_swap_b32 v157, v159
    v_permlane32_swap_b32 v160, v162
    v_permlane32_swap_b32 v161, v163
    s_nop 1
    v_add_f32 v166, v166, v184
    v_add_f32 v152, v152, v154
    v_add_f32 v153, v153, v155
    v_add_f32 v156, v156, v158
    v_add_f32 v157, v157, v159
    v_add_f32 v160, v160, v162
    v_add_f32 v161, v161, v163
    v_mov_b32 v184, v166
    s_nop 1
    v_permlane16_swap_b32 v166, v184
    v_permlane16_swap_b32 v152, v153
    v_permlane16_swap_b32 v156, v157
    v_permlane16_swap_b32 v160, v161
    s_nop 1
    v_add_f32 v166, v166, v184
    v_add_f32 v152, v152, v153
    v_add_f32 v156, v156, v157
    v_add_f32 v160, v160, v161
    ds_write_b32 v188, v152 offset:768
    ds_write_b32 v188, v156 offset:1024
    ds_write_b32 v188, v160 offset:1280
    ds_write_b32 v189, v165 offset:1536
    ds_write_b32 v189, v166 offset:1540
    s_waitcnt lgkmcnt(0)
    s_mov_b64 exec, 1
    ds_add_u32 v190, v191
    s_mov_b64 exec, -1
    v_add_u32 v188, 1024, v188
    v_add_u32 v189, 1024, v189
    v_add_u32 v190, 4, v190
    v_mov_b32 v165, 0xf149f2ca
    v_mov_b32 v166, 0
    v_mov_b32 v167, 0
    v_mov_b32 v152, 0
    v_mov_b32 v153, 0
    v_mov_b32 v154, 0
    v_mov_b32 v155, 0
    v_mov_b32 v156, 0
    v_mov_b32 v157, 0
    v_mov_b32 v158, 0
    v_mov_b32 v159, 0
    v_mov_b32 v160, 0
    v_mov_b32 v161, 0
    v_mov_b32 v162, 0
    v_mov_b32 v163, 0
    s_endpgm
L_service:
    v_lshlrev_b32 v6, 2, v0
    v_mov_b32 v3, 0
    ds_write_b32 v6, v3 offset:0
    v_lshlrev_b32 v2, 4, v0
    v_mul_u32_u24 v1, 12, v0
    v_mov_b32 v4, 0
    v_mov_b32 v5, 0
    v_lshlrev_b32 v11, 11, v0
    s_lshr_b32 s70, s92, 3
    s_add_u32 s82, s70, s79
    s_xor_b32 s82, s82, s92
    s_and_b32 s82, s82, 7
    s_cmp_eq_u32 s82, 0
    s_cselect_b32 s70, s70, -2
    s_add_u32 s70, s70, 1
    s_mov_b32 s71, 0
    s_waitcnt lgkmcnt(0)
    s_barrier
    s_mov_b32 s52, s22
    s_and_b32 s53, s23, 0xffff
    s_mov_b32 s54, 17825792
    s_mov_b32 s55, 0x00020000
    s_mov_b32 s56, s18
    s_and_b32 s57, s19, 0xffff
    s_mov_b32 s58, 12288
    s_mov_b32 s59, 0x00020000
L_gettag:
    ds_read_b32 v6, v3 offset:136
    s_waitcnt lgkmcnt(0)
    v_readfirstlane_b32 s69, v6
    s_cmp_eq_u32 s69, 0
    s_cbranch_scc1 L_gettag
L_poll:
    ds_read_b32 v6, v5
    s_waitcnt lgkmcnt(0)
    v_readfirstlane_b32 s80, v6
    s_cmp_lg_u32 s80, 1
    s_cbranch_scc1 L_poll
    ds_read_b64 v[20:21], v4 offset:1536
    ds_read_b32 v24, v1 offset:768
    ds_read_b32 v25, v1 offset:772
    ds_read_b32 v26, v1 offset:776
    s_lshl_b32 s80, s79, 6
    s_add_u32 s80, s80, s92
    s_lshl_b32 s80, s80, 11
    v_mov_b32 v15, s69
    v_mov_b32 v18, s69
    v_mov_b32 v19, s69
    s_waitcnt lgkmcnt(0)
    v_mov_b32 v16, v20
    v_sub_f32 v20, v20, v16
    v_exp_f32 v20, v20
    s_nop 0
    v_mul_f32 v17, v20, v21
    v_mul_f32 v12, v20, v24
    v_mul_f32 v13, v20, v25
    v_mul_f32 v14, v20, v26
    buffer_store_dwordx4 v[12:15], v2, s[52:55], s80 offen sc0 sc1
    s_mov_b64 exec, 1
    buffer_store_dwordx4 v[16:19], v3, s[52:55], s80 offen offset:1024 sc0 sc1
    s_mov_b64 exec, -1
    v_add_u32 v1, 1024, v1
    v_add_u32 v4, 1024, v4
    v_add_u32 v5, 4, v5
L_chk:
    s_cmp_lg_u32 s71, s70
    s_cbranch_scc1 L_next
L_comb:
    s_sub_u32 s82, s79, 4
    s_lshl_b32 s80, s82, 17
    s_mov_b32 s81, s80
    buffer_load_dwordx4 v[20:23], v11, s[52:55], s81 offen offset:1024 sc0 sc1
    s_mov_b64 exec, -1
    s_waitcnt vmcnt(0)
    v_xor_b32 v10, s69, v22
    v_cmp_ne_u32 vcc, 0, v10
    s_cmp_lg_u64 vcc, 0
    s_cbranch_scc1 L_comb
    buffer_load_dwordx4 v[24:27], v2, s[52:55], s80 offen offset:0 sc0 sc1
    buffer_load_dwordx4 v[28:31], v2, s[52:55], s80 offen offset:2048 sc0 sc1
    s_add_u32 s80, s80, 4096
    buffer_load_dwordx4 v[32:35], v2, s[52:55], s80 offen offset:0 sc0 sc1
    buffer_load_dwordx4 v[36:39], v2, s[52:55], s80 offen offset:2048 sc0 sc1
    s_add_u32 s80, s80, 4096
    buffer_load_dwordx4 v[40:43], v2, s[52:55], s80 offen offset:0 sc0 sc1
    buffer_load_dwordx4 v[44:47], v2, s[52:55], s80 offen offset:2048 sc0 sc1
    s_add_u32 s80, s80, 4096
    buffer_load_dwordx4 v[48:51], v2, s[52:55], s80 offen offset:0 sc0 sc1
    buffer_load_dwordx4 v[52:55], v2, s[52:55], s80 offen offset:2048 sc0 sc1
    s_add_u32 s80, s80, 4096
    buffer_load_dwordx4 v[56:59], v2, s[52:55], s80 offen offset:0 sc0 sc1
    buffer_load_dwordx4 v[60:63], v2, s[52:55], s80 offen offset:2048 sc0 sc1
    s_add_u32 s80, s80, 4096
    buffer_load_dwordx4 v[64:67], v2, s[52:55], s80 offen offset:0 sc0 sc1
    buffer_load_dwordx4 v[68:71], v2, s[52:55], s80 offen offset:2048 sc0 sc1
    s_add_u32 s80, s80, 4096
    buffer_load_dwordx4 v[72:75], v2, s[52:55], s80 offen offset:0 sc0 sc1
    buffer_load_dwordx4 v[76:79], v2, s[52:55], s80 offen offset:2048 sc0 sc1
    s_add_u32 s80, s80, 4096
    buffer_load_dwordx4 v[80:83], v2, s[52:55], s80 offen offset:0 sc0 sc1
    buffer_load_dwordx4 v[84:87], v2, s[52:55], s80 offen offset:2048 sc0 sc1
    s_add_u32 s80, s80, 4096
    buffer_load_dwordx4 v[88:91], v2, s[52:55], s80 offen offset:0 sc0 sc1
    buffer_load_dwordx4 v[92:95], v2, s[52:55], s80 offen offset:2048 sc0 sc1
    s_add_u32 s80, s80, 4096
    buffer_load_dwordx4 v[96:99], v2, s[52:55], s80 offen offset:0 sc0 sc1
    buffer_load_dwordx4 v[100:103], v2, s[52:55], s80 offen offset:2048 sc0 sc1
    s_add_u32 s80, s80, 4096
    buffer_load_dwordx4 v[104:107], v2, s[52:55], s80 offen offset:0 sc0 sc1
    buffer_load_dwordx4 v[108:111], v2, s[52:55], s80 offen offset:2048 sc0 sc1
    s_add_u32 s80, s80, 4096
    buffer_load_dwordx4 v[112:115], v2, s[52:55], s80 offen offset:0 sc0 sc1
    buffer_load_dwordx4 v[116:119], v2, s[52:55], s80 offen offset:2048 sc0 sc1
    s_add_u32 s80, s80, 4096
    buffer_load_dwordx4 v[120:123], v2, s[52:55], s80 offen offset:0 sc0 sc1
    buffer_load_dwordx4 v[124:127], v2, s[52:55], s80 offen offset:2048 sc0 sc1
    s_add_u32 s80, s80, 4096
    buffer_load_dwordx4 v[128:131], v2, s[52:55], s80 offen offset:0 sc0 sc1
    buffer_load_dwordx4 v[132:135], v2, s[52:55], s80 offen offset:2048 sc0 sc1
    s_add_u32 s80, s80, 4096
    buffer_load_dwordx4 v[136:139], v2, s[52:55], s80 offen offset:0 sc0 sc1
    buffer_load_dwordx4 v[140:143], v2, s[52:55], s80 offen offset:2048 sc0 sc1
    s_add_u32 s80, s80, 4096
    buffer_load_dwordx4 v[144:147], v2, s[52:55], s80 offen offset:0 sc0 sc1
    buffer_load_dwordx4 v[148:151], v2, s[52:55], s80 offen offset:2048 sc0 sc1
    v_mov_b32 v8, v20
    s_nop 1
    v_max_f32_dpp v8, v8, v8 row_ror:8 row_mask:0xf bank_mask:0xf
    s_nop 1
    v_max_f32_dpp v8, v8, v8 row_ror:4 row_mask:0xf bank_mask:0xf
    s_nop 1
    v_max_f32_dpp v8, v8, v8 row_ror:2 row_mask:0xf bank_mask:0xf
    s_nop 1
    v_max_f32_dpp v8, v8, v8 row_ror:1 row_mask:0xf bank_mask:0xf
    v_mov_b32 v6, v8
    s_nop 1
    v_permlane32_swap_b32 v8, v6
    s_nop 1
    v_max_f32 v8, v8, v6
    v_mov_b32 v6, v8
    s_nop 1
    v_permlane16_swap_b32 v8, v6
    s_nop 1
    v_max_f32 v8, v8, v6
    v_sub_f32 v20, v20, v8
    v_exp_f32 v20, v20
    s_nop 0
    v_mul_f32 v9, v20, v21
    s_nop 1
    v_add_f32_dpp v9, v9, v9 row_ror:8 row_mask:0xf bank_mask:0xf
    s_nop 1
    v_add_f32_dpp v9, v9, v9 row_ror:4 row_mask:0xf bank_mask:0xf
    s_nop 1
    v_add_f32_dpp v9, v9, v9 row_ror:2 row_mask:0xf bank_mask:0xf
    s_nop 1
    v_add_f32_dpp v9, v9, v9 row_ror:1 row_mask:0xf bank_mask:0xf
    v_mov_b32 v6, v9
    s_nop 1
    v_permlane32_swap_b32 v9, v6
    s_nop 1
    v_add_f32 v9, v9, v6
    v_mov_b32 v6, v9
    s_nop 1
    v_permlane16_swap_b32 v9, v6
    s_nop 1
    v_add_f32 v9, v9, v6
    v_mov_b32 v12, 0
    v_mov_b32 v13, 0
    v_mov_b32 v14, 0
    v_rcp_f32 v9, v9
    v_readlane_b32 s84, v20, 0
    v_readlane_b32 s85, v20, 1
    v_readlane_b32 s86, v20, 2
    v_readlane_b32 s87, v20, 3
    v_readlane_b32 s88, v20, 4
    v_readlane_b32 s89, v20, 5
    v_readlane_b32 s90, v20, 6
    v_readlane_b32 s91, v20, 7
    s_waitcnt vmcnt(24)
    v_xor_b32 v6, s69, v27
    v_fmac_f32 v12, s84, v24
    v_fmac_f32 v13, s84, v25
    v_fmac_f32 v14, s84, v26
    v_or_b32 v10, v10, v6
    v_xor_b32 v6, s69, v31
    v_fmac_f32 v12, s85, v28
    v_fmac_f32 v13, s85, v29
    v_fmac_f32 v14, s85, v30
    v_or_b32 v10, v10, v6
    v_xor_b32 v6, s69, v35
    v_fmac_f32 v12, s86, v32
    v_fmac_f32 v13, s86, v33
    v_fmac_f32 v14, s86, v34
    v_or_b32 v10, v10, v6
    v_xor_b32 v6, s69, v39
    v_fmac_f32 v12, s87, v36
    v_fmac_f32 v13, s87, v37
    v_fmac_f32 v14, s87, v38
    v_or_b32 v10, v10, v6
    v_xor_b32 v6, s69, v43
    v_fmac_f32 v12, s88, v40
    v_fmac_f32 v13, s88, v41
    v_fmac_f32 v14, s88, v42
    v_or_b32 v10, v10, v6
    v_xor_b32 v6, s69, v47
    v_fmac_f32 v12, s89, v44
    v_fmac_f32 v13, s89, v45
    v_fmac_f32 v14, s89, v46
    v_or_b32 v10, v10, v6
    v_xor_b32 v6, s69, v51
    v_fmac_f32 v12, s90, v48
    v_fmac_f32 v13, s90, v49
    v_fmac_f32 v14, s90, v50
    v_or_b32 v10, v10, v6
    v_xor_b32 v6, s69, v55
    v_fmac_f32 v12, s91, v52
    v_fmac_f32 v13, s91, v53
    v_fmac_f32 v14, s91, v54
    v_or_b32 v10, v10, v6
    s_add_u32 s80, s80, 4096
    buffer_load_dwordx4 v[24:27], v2, s[52:55], s80 offen offset:0 sc0 sc1
    buffer_load_dwordx4 v[28:31], v2, s[52:55], s80 offen offset:2048 sc0 sc1
    s_add_u32 s80, s80, 4096
    buffer_load_dwordx4 v[32:35], v2, s[52:55], s80 offen offset:0 sc0 sc1
    buffer_load_dwordx4 v[36:39], v2, s[52:55], s80 offen offset:2048 sc0 sc1
    s_add_u32 s80, s80, 4096
    buffer_load_dwordx4 v[40:43], v2, s[52:55], s80 offen offset:0 sc0 sc1
    buffer_load_dwordx4 v[44:47], v2, s[52:55], s80 offen offset:2048 sc0 sc1
    s_add_u32 s80, s80, 4096
    buffer_load_dwordx4 v[48:51], v2, s[52:55], s80 offen offset:0 sc0 sc1
    buffer_load_dwordx4 v[52:55], v2, s[52:55], s80 offen offset:2048 sc0 sc1
    v_readlane_b32 s84, v20, 8
    v_readlane_b32 s85, v20, 9
    v_readlane_b32 s86, v20, 10
    v_readlane_b32 s87, v20, 11
    v_readlane_b32 s88, v20, 12
    v_readlane_b32 s89, v20, 13
    v_readlane_b32 s90, v20, 14
    v_readlane_b32 s91, v20, 15
    s_waitcnt vmcnt(24)
    v_xor_b32 v6, s69, v59
    v_fmac_f32 v12, s84, v56
    v_fmac_f32 v13, s84, v57
    v_fmac_f32 v14, s84, v58
    v_or_b32 v10, v10, v6
    v_xor_b32 v6, s69, v63
    v_fmac_f32 v12, s85, v60
    v_fmac_f32 v13, s85, v61
    v_fmac_f32 v14, s85, v62
    v_or_b32 v10, v10, v6
    v_xor_b32 v6, s69, v67
    v_fmac_f32 v12, s86, v64
    v_fmac_f32 v13, s86, v65
    v_fmac_f32 v14, s86, v66
    v_or_b32 v10, v10, v6
    v_xor_b32 v6, s69, v71
    v_fmac_f32 v12, s87, v68
    v_fmac_f32 v13, s87, v69
    v_fmac_f32 v14, s87, v70
    v_or_b32 v10, v10, v6
    v_xor_b32 v6, s69, v75
    v_fmac_f32 v12, s88, v72
    v_fmac_f32 v13, s88, v73
    v_fmac_f32 v14, s88, v74
    v_or_b32 v10, v10, v6
    v_xor_b32 v6, s69, v79
    v_fmac_f32 v12, s89, v76
    v_fmac_f32 v13, s89, v77
    v_fmac_f32 v14, s89, v78
    v_or_b32 v10, v10, v6
    v_xor_b32 v6, s69, v83
    v_fmac_f32 v12, s90, v80
    v_fmac_f32 v13, s90, v81
    v_fmac_f32 v14, s90, v82
    v_or_b32 v10, v10, v6
    v_xor_b32 v6, s69, v87
    v_fmac_f32 v12, s91, v84
    v_fmac_f32 v13, s91, v85
    v_fmac_f32 v14, s91, v86
    v_or_b32 v10, v10, v6
    s_add_u32 s80, s80, 4096
    buffer_load_dwordx4 v[56:59], v2, s[52:55], s80 offen offset:0 sc0 sc1
    buffer_load_dwordx4 v[60:63], v2, s[52:55], s80 offen offset:2048 sc0 sc1
    s_add_u32 s80, s80, 4096
    buffer_load_dwordx4 v[64:67], v2, s[52:55], s80 offen offset:0 sc0 sc1
    buffer_load_dwordx4 v[68:71], v2, s[52:55], s80 offen offset:2048 sc0 sc1
    s_add_u32 s80, s80, 4096
    buffer_load_dwordx4 v[72:75], v2, s[52:55], s80 offen offset:0 sc0 sc1
    buffer_load_dwordx4 v[76:79], v2, s[52:55], s80 offen offset:2048 sc0 sc1
    s_add_u32 s80, s80, 4096
    buffer_load_dwordx4 v[80:83], v2, s[52:55], s80 offen offset:0 sc0 sc1
    buffer_load_dwordx4 v[84:87], v2, s[52:55], s80 offen offset:2048 sc0 sc1
    v_readlane_b32 s84, v20, 16
    v_readlane_b32 s85, v20, 17
    v_readlane_b32 s86, v20, 18
    v_readlane_b32 s87, v20, 19
    v_readlane_b32 s88, v20, 20
    v_readlane_b32 s89, v20, 21
    v_readlane_b32 s90, v20, 22
    v_readlane_b32 s91, v20, 23
    s_waitcnt vmcnt(24)
    v_xor_b32 v6, s69, v91
    v_fmac_f32 v12, s84, v88
    v_fmac_f32 v13, s84, v89
    v_fmac_f32 v14, s84, v90
    v_or_b32 v10, v10, v6
    v_xor_b32 v6, s69, v95
    v_fmac_f32 v12, s85, v92
    v_fmac_f32 v13, s85, v93
    v_fmac_f32 v14, s85, v94
    v_or_b32 v10, v10, v6
    v_xor_b32 v6, s69, v99
    v_fmac_f32 v12, s86, v96
    v_fmac_f32 v13, s86, v97
    v_fmac_f32 v14, s86, v98
    v_or_b32 v10, v10, v6
    v_xor_b32 v6, s69, v103
    v_fmac_f32 v12, s87, v100
    v_fmac_f32 v13, s87, v101
    v_fmac_f32 v14, s87, v102
    v_or_b32 v10, v10, v6
    v_xor_b32 v6, s69, v107
    v_fmac_f32 v12, s88, v104
    v_fmac_f32 v13, s88, v105
    v_fmac_f32 v14, s88, v106
    v_or_b32 v10, v10, v6
    v_xor_b32 v6, s69, v111
    v_fmac_f32 v12, s89, v108
    v_fmac_f32 v13, s89, v109
    v_fmac_f32 v14, s89, v110
    v_or_b32 v10, v10, v6
    v_xor_b32 v6, s69, v115
    v_fmac_f32 v12, s90, v112
    v_fmac_f32 v13, s90, v113
    v_fmac_f32 v14, s90, v114
    v_or_b32 v10, v10, v6
    v_xor_b32 v6, s69, v119
    v_fmac_f32 v12, s91, v116
    v_fmac_f32 v13, s91, v117
    v_fmac_f32 v14, s91, v118
    v_or_b32 v10, v10, v6
    s_add_u32 s80, s80, 4096
    buffer_load_dwordx4 v[88:91], v2, s[52:55], s80 offen offset:0 sc0 sc1
    buffer_load_dwordx4 v[92:95], v2, s[52:55], s80 offen offset:2048 sc0 sc1
    s_add_u32 s80, s80, 4096
    buffer_load_dwordx4 v[96:99], v2, s[52:55], s80 offen offset:0 sc0 sc1
    buffer_load_dwordx4 v[100:103], v2, s[52:55], s80 offen offset:2048 sc0 sc1
    s_add_u32 s80, s80, 4096
    buffer_load_dwordx4 v[104:107], v2, s[52:55], s80 offen offset:0 sc0 sc1
    buffer_load_dwordx4 v[108:111], v2, s[52:55], s80 offen offset:2048 sc0 sc1
    s_add_u32 s80, s80, 4096
    buffer_load_dwordx4 v[112:115], v2, s[52:55], s80 offen offset:0 sc0 sc1
    buffer_load_dwordx4 v[116:119], v2, s[52:55], s80 offen offset:2048 sc0 sc1
    v_readlane_b32 s84, v20, 24
    v_readlane_b32 s85, v20, 25
    v_readlane_b32 s86, v20, 26
    v_readlane_b32 s87, v20, 27
    v_readlane_b32 s88, v20, 28
    v_readlane_b32 s89, v20, 29
    v_readlane_b32 s90, v20, 30
    v_readlane_b32 s91, v20, 31
    s_waitcnt vmcnt(24)
    v_xor_b32 v6, s69, v123
    v_fmac_f32 v12, s84, v120
    v_fmac_f32 v13, s84, v121
    v_fmac_f32 v14, s84, v122
    v_or_b32 v10, v10, v6
    v_xor_b32 v6, s69, v127
    v_fmac_f32 v12, s85, v124
    v_fmac_f32 v13, s85, v125
    v_fmac_f32 v14, s85, v126
    v_or_b32 v10, v10, v6
    v_xor_b32 v6, s69, v131
    v_fmac_f32 v12, s86, v128
    v_fmac_f32 v13, s86, v129
    v_fmac_f32 v14, s86, v130
    v_or_b32 v10, v10, v6
    v_xor_b32 v6, s69, v135
    v_fmac_f32 v12, s87, v132
    v_fmac_f32 v13, s87, v133
    v_fmac_f32 v14, s87, v134
    v_or_b32 v10, v10, v6
    v_xor_b32 v6, s69, v139
    v_fmac_f32 v12, s88, v136
    v_fmac_f32 v13, s88, v137
    v_fmac_f32 v14, s88, v138
    v_or_b32 v10, v10, v6
    v_xor_b32 v6, s69, v143
    v_fmac_f32 v12, s89, v140
    v_fmac_f32 v13, s89, v141
    v_fmac_f32 v14, s89, v142
    v_or_b32 v10, v10, v6
    v_xor_b32 v6, s69, v147
    v_fmac_f32 v12, s90, v144
    v_fmac_f32 v13, s90, v145
    v_fmac_f32 v14, s90, v146
    v_or_b32 v10, v10, v6
    v_xor_b32 v6, s69, v151
    v_fmac_f32 v12, s91, v148
    v_fmac_f32 v13, s91, v149
    v_fmac_f32 v14, s91, v150
    v_or_b32 v10, v10, v6
    s_add_u32 s80, s80, 4096
    buffer_load_dwordx4 v[120:123], v2, s[52:55], s80 offen offset:0 sc0 sc1
    buffer_load_dwordx4 v[124:127], v2, s[52:55], s80 offen offset:2048 sc0 sc1
    s_add_u32 s80, s80, 4096
    buffer_load_dwordx4 v[128:131], v2, s[52:55], s80 offen offset:0 sc0 sc1
    buffer_load_dwordx4 v[132:135], v2, s[52:55], s80 offen offset:2048 sc0 sc1
    s_add_u32 s80, s80, 4096
    buffer_load_dwordx4 v[136:139], v2, s[52:55], s80 offen offset:0 sc0 sc1
    buffer_load_dwordx4 v[140:143], v2, s[52:55], s80 offen offset:2048 sc0 sc1
    s_add_u32 s80, s80, 4096
    buffer_load_dwordx4 v[144:147], v2, s[52:55], s80 offen offset:0 sc0 sc1
    buffer_load_dwordx4 v[148:151], v2, s[52:55], s80 offen offset:2048 sc0 sc1
    v_readlane_b32 s84, v20, 32
    v_readlane_b32 s85, v20, 33
    v_readlane_b32 s86, v20, 34
    v_readlane_b32 s87, v20, 35
    v_readlane_b32 s88, v20, 36
    v_readlane_b32 s89, v20, 37
    v_readlane_b32 s90, v20, 38
    v_readlane_b32 s91, v20, 39
    s_waitcnt vmcnt(24)
    v_xor_b32 v6, s69, v27
    v_fmac_f32 v12, s84, v24
    v_fmac_f32 v13, s84, v25
    v_fmac_f32 v14, s84, v26
    v_or_b32 v10, v10, v6
    v_xor_b32 v6, s69, v31
    v_fmac_f32 v12, s85, v28
    v_fmac_f32 v13, s85, v29
    v_fmac_f32 v14, s85, v30
    v_or_b32 v10, v10, v6
    v_xor_b32 v6, s69, v35
    v_fmac_f32 v12, s86, v32
    v_fmac_f32 v13, s86, v33
    v_fmac_f32 v14, s86, v34
    v_or_b32 v10, v10, v6
    v_xor_b32 v6, s69, v39
    v_fmac_f32 v12, s87, v36
    v_fmac_f32 v13, s87, v37
    v_fmac_f32 v14, s87, v38
    v_or_b32 v10, v10, v6
    v_xor_b32 v6, s69, v43
    v_fmac_f32 v12, s88, v40
    v_fmac_f32 v13, s88, v41
    v_fmac_f32 v14, s88, v42
    v_or_b32 v10, v10, v6
    v_xor_b32 v6, s69, v47
    v_fmac_f32 v12, s89, v44
    v_fmac_f32 v13, s89, v45
    v_fmac_f32 v14, s89, v46
    v_or_b32 v10, v10, v6
    v_xor_b32 v6, s69, v51
    v_fmac_f32 v12, s90, v48
    v_fmac_f32 v13, s90, v49
    v_fmac_f32 v14, s90, v50
    v_or_b32 v10, v10, v6
    v_xor_b32 v6, s69, v55
    v_fmac_f32 v12, s91, v52
    v_fmac_f32 v13, s91, v53
    v_fmac_f32 v14, s91, v54
    v_or_b32 v10, v10, v6
    v_readlane_b32 s84, v20, 40
    v_readlane_b32 s85, v20, 41
    v_readlane_b32 s86, v20, 42
    v_readlane_b32 s87, v20, 43
    v_readlane_b32 s88, v20, 44
    v_readlane_b32 s89, v20, 45
    v_readlane_b32 s90, v20, 46
    v_readlane_b32 s91, v20, 47
    s_waitcnt vmcnt(16)
    v_xor_b32 v6, s69, v59
    v_fmac_f32 v12, s84, v56
    v_fmac_f32 v13, s84, v57
    v_fmac_f32 v14, s84, v58
    v_or_b32 v10, v10, v6
    v_xor_b32 v6, s69, v63
    v_fmac_f32 v12, s85, v60
    v_fmac_f32 v13, s85, v61
    v_fmac_f32 v14, s85, v62
    v_or_b32 v10, v10, v6
    v_xor_b32 v6, s69, v67
    v_fmac_f32 v12, s86, v64
    v_fmac_f32 v13, s86, v65
    v_fmac_f32 v14, s86, v66
    v_or_b32 v10, v10, v6
    v_xor_b32 v6, s69, v71
    v_fmac_f32 v12, s87, v68
    v_fmac_f32 v13, s87, v69
    v_fmac_f32 v14, s87, v70
    v_or_b32 v10, v10, v6
    v_xor_b32 v6, s69, v75
    v_fmac_f32 v12, s88, v72
    v_fmac_f32 v13, s88, v73
    v_fmac_f32 v14, s88, v74
    v_or_b32 v10, v10, v6
    v_xor_b32 v6, s69, v79
    v_fmac_f32 v12, s89, v76
    v_fmac_f32 v13, s89, v77
    v_fmac_f32 v14, s89, v78
    v_or_b32 v10, v10, v6
    v_xor_b32 v6, s69, v83
    v_fmac_f32 v12, s90, v80
    v_fmac_f32 v13, s90, v81
    v_fmac_f32 v14, s90, v82
    v_or_b32 v10, v10, v6
    v_xor_b32 v6, s69, v87
    v_fmac_f32 v12, s91, v84
    v_fmac_f32 v13, s91, v85
    v_fmac_f32 v14, s91, v86
    v_or_b32 v10, v10, v6
    v_readlane_b32 s84, v20, 48
    v_readlane_b32 s85, v20, 49
    v_readlane_b32 s86, v20, 50
    v_readlane_b32 s87, v20, 51
    v_readlane_b32 s88, v20, 52
    v_readlane_b32 s89, v20, 53
    v_readlane_b32 s90, v20, 54
    v_readlane_b32 s91, v20, 55
    s_waitcnt vmcnt(8)
    v_xor_b32 v6, s69, v91
    v_fmac_f32 v12, s84, v88
    v_fmac_f32 v13, s84, v89
    v_fmac_f32 v14, s84, v90
    v_or_b32 v10, v10, v6
    v_xor_b32 v6, s69, v95
    v_fmac_f32 v12, s85, v92
    v_fmac_f32 v13, s85, v93
    v_fmac_f32 v14, s85, v94
    v_or_b32 v10, v10, v6
    v_xor_b32 v6, s69, v99
    v_fmac_f32 v12, s86, v96
    v_fmac_f32 v13, s86, v97
    v_fmac_f32 v14, s86, v98
    v_or_b32 v10, v10, v6
    v_xor_b32 v6, s69, v103
    v_fmac_f32 v12, s87, v100
    v_fmac_f32 v13, s87, v101
    v_fmac_f32 v14, s87, v102
    v_or_b32 v10, v10, v6
    v_xor_b32 v6, s69, v107
    v_fmac_f32 v12, s88, v104
    v_fmac_f32 v13, s88, v105
    v_fmac_f32 v14, s88, v106
    v_or_b32 v10, v10, v6
    v_xor_b32 v6, s69, v111
    v_fmac_f32 v12, s89, v108
    v_fmac_f32 v13, s89, v109
    v_fmac_f32 v14, s89, v110
    v_or_b32 v10, v10, v6
    v_xor_b32 v6, s69, v115
    v_fmac_f32 v12, s90, v112
    v_fmac_f32 v13, s90, v113
    v_fmac_f32 v14, s90, v114
    v_or_b32 v10, v10, v6
    v_xor_b32 v6, s69, v119
    v_fmac_f32 v12, s91, v116
    v_fmac_f32 v13, s91, v117
    v_fmac_f32 v14, s91, v118
    v_or_b32 v10, v10, v6
    v_readlane_b32 s84, v20, 56
    v_readlane_b32 s85, v20, 57
    v_readlane_b32 s86, v20, 58
    v_readlane_b32 s87, v20, 59
    v_readlane_b32 s88, v20, 60
    v_readlane_b32 s89, v20, 61
    v_readlane_b32 s90, v20, 62
    v_readlane_b32 s91, v20, 63
    s_waitcnt vmcnt(0)
    v_xor_b32 v6, s69, v123
    v_fmac_f32 v12, s84, v120
    v_fmac_f32 v13, s84, v121
    v_fmac_f32 v14, s84, v122
    v_or_b32 v10, v10, v6
    v_xor_b32 v6, s69, v127
    v_fmac_f32 v12, s85, v124
    v_fmac_f32 v13, s85, v125
    v_fmac_f32 v14, s85, v126
    v_or_b32 v10, v10, v6
    v_xor_b32 v6, s69, v131
    v_fmac_f32 v12, s86, v128
    v_fmac_f32 v13, s86, v129
    v_fmac_f32 v14, s86, v130
    v_or_b32 v10, v10, v6
    v_xor_b32 v6, s69, v135
    v_fmac_f32 v12, s87, v132
    v_fmac_f32 v13, s87, v133
    v_fmac_f32 v14, s87, v134
    v_or_b32 v10, v10, v6
    v_xor_b32 v6, s69, v139
    v_fmac_f32 v12, s88, v136
    v_fmac_f32 v13, s88, v137
    v_fmac_f32 v14, s88, v138
    v_or_b32 v10, v10, v6
    v_xor_b32 v6, s69, v143
    v_fmac_f32 v12, s89, v140
    v_fmac_f32 v13, s89, v141
    v_fmac_f32 v14, s89, v142
    v_or_b32 v10, v10, v6
    v_xor_b32 v6, s69, v147
    v_fmac_f32 v12, s90, v144
    v_fmac_f32 v13, s90, v145
    v_fmac_f32 v14, s90, v146
    v_or_b32 v10, v10, v6
    v_xor_b32 v6, s69, v151
    v_fmac_f32 v12, s91, v148
    v_fmac_f32 v13, s91, v149
    v_fmac_f32 v14, s91, v150
    v_or_b32 v10, v10, v6
    v_cmp_ne_u32 vcc, 0, v10
    s_cmp_lg_u64 vcc, 0
    s_cbranch_scc1 L_comb
    v_mul_f32 v12, v12, v9
    v_mul_f32 v13, v13, v9
    v_mul_f32 v14, v14, v9
    s_mul_i32 s80, s82, 384
    v_mul_u32_u24 v6, 6, v0
    v_cvt_pk_bf16_f32 v12, v12, v12
    v_cvt_pk_bf16_f32 v13, v13, v13
    v_cvt_pk_bf16_f32 v14, v14, v14
    buffer_store_short v12, v6, s[56:59], s80 offen offset:0
    buffer_store_short v13, v6, s[56:59], s80 offen offset:2
    buffer_store_short v14, v6, s[56:59], s80 offen offset:4
L_next:
    s_add_u32 s79, s79, 4
    s_add_u32 s71, s71, 1
    s_cmp_lt_u32 s71, 8
    s_cbranch_scc1 L_poll
    s_cmp_eq_u32 s71, 8
    s_cbranch_scc1 L_chk
L_end:
    s_endpgm
L_ticket:
    v_lshlrev_b32 v1, 2, v0
    v_mov_b32 v2, 0
    v_mov_b32 v3, -1
    ds_write_b32 v1, v3 offset:256
    ds_write_b32 v1, v3 offset:512
    v_lshlrev_b32 v4, 3, v0
    s_memrealtime s[80:81]
    s_waitcnt lgkmcnt(0)
    s_barrier
    s_mov_b32 s52, s22
    s_and_b32 s53, s23, 0xffff
    s_mov_b32 s54, 17825792
    s_mov_b32 s55, 0x00020000
    s_mov_b32 s60, s20
    s_and_b32 s61, s21, 0xffff
    s_mov_b32 s62, 256
    s_mov_b32 s63, 0x00020000
    s_max_u32 s69, s80, 1
    s_cmp_lg_u32 s2, 0
    s_cbranch_scc1 L_kd
    v_lshlrev_b32 v5, 8, v0
    s_mov_b32 s80, 12582912
    s_mov_b32 exec_hi, 0
    buffer_store_dword v2, v5, s[52:55], s80 offen sc0 sc1
    v_mov_b32 v3, s69
    s_mov_b64 exec, 1
    s_waitcnt vmcnt(0)
    buffer_store_dword v3, v2, s[60:63], 0 offen sc0 sc1
    s_mov_b64 exec, -1
L_kd:
    ds_read_b32 v3, v2 offset:128
    s_waitcnt lgkmcnt(0)
    v_readfirstlane_b32 s80, v3
    s_cmp_lg_u32 s80, 1
    s_cbranch_scc1 L_kd
    v_add_u32 v1, 23296, v1
    ds_read_b32 v6, v1 offset:0
    ds_read_b32 v8, v1 offset:256
    ds_read_b32 v10, v1 offset:512
    ds_read_b32 v12, v1 offset:768
    ds_read_b32 v14, v1 offset:1024
    ds_read_b32 v16, v1 offset:1280
    ds_read_b32 v18, v1 offset:1536
    ds_read_b32 v20, v1 offset:1792
L_tg:
    buffer_load_dword v3, v2, s[60:63], 0 offen sc0 sc1
    s_waitcnt vmcnt(0)
    v_readfirstlane_b32 s69, v3
    s_cmp_eq_u32 s69, 0
    s_cbranch_scc1 L_tg
    ds_write_b32 v2, v3 offset:136
    s_mul_i32 s80, s2, 4096
    s_add_u32 s80, s80, 8388608
    v_mov_b32 v7, s69
    v_mov_b32 v9, s69
    v_mov_b32 v11, s69
    v_mov_b32 v13, s69
    v_mov_b32 v15, s69
    v_mov_b32 v17, s69
    v_mov_b32 v19, s69
    v_mov_b32 v21, s69
    s_waitcnt lgkmcnt(0)
    buffer_store_dwordx2 v[6:7], v4, s[52:55], s80 offen offset:0 sc0 sc1
    buffer_store_dwordx2 v[8:9], v4, s[52:55], s80 offen offset:512 sc0 sc1
    buffer_store_dwordx2 v[10:11], v4, s[52:55], s80 offen offset:1024 sc0 sc1
    buffer_store_dwordx2 v[12:13], v4, s[52:55], s80 offen offset:1536 sc0 sc1
    buffer_store_dwordx2 v[14:15], v4, s[52:55], s80 offen offset:2048 sc0 sc1
    buffer_store_dwordx2 v[16:17], v4, s[52:55], s80 offen offset:2560 sc0 sc1
    buffer_store_dwordx2 v[18:19], v4, s[52:55], s80 offen offset:3072 sc0 sc1
    buffer_store_dwordx2 v[20:21], v4, s[52:55], s80 offen offset:3584 sc0 sc1
    s_lshr_b32 s82, s2, 3
    s_lshl_b32 s82, s82, 8
    s_add_u32 s82, s82, 12582912
    s_mov_b32 s70, 1
    v_mov_b32 v5, 260
    s_mov_b64 exec, 1
L_rq:
    ds_read_b32 v3, v2 offset:132
    s_waitcnt lgkmcnt(0)
    v_readfirstlane_b32 s80, v3
    s_cmp_lt_u32 s80, s70
    s_cbranch_scc1 L_rq
    v_mov_b32 v3, 1
    buffer_atomic_add v3, v2, s[52:55], s82 offen sc0 sc1
    s_waitcnt vmcnt(0)
    v_add_u32 v3, 8, v3
    ds_write_b32 v5, v3
    v_readfirstlane_b32 s80, v3
    v_add_u32 v5, 4, v5
    s_add_u32 s70, s70, 1
    s_cmp_lt_u32 s80, 64
    s_cbranch_scc1 L_rq
    s_endpgm
.section .rodata,"a"
.p2align 6
.amdhsa_kernel standalone__kv_cache_quant_int4_int2_kv_with_per_channel_or_per_token_scales__decode_kernel
  .amdhsa_next_free_vgpr 192
  .amdhsa_next_free_sgpr 102
  .amdhsa_accum_offset 192
  .amdhsa_group_segment_fixed_size 0
  .amdhsa_kernarg_size 80
  .amdhsa_user_sgpr_count 2
  .amdhsa_user_sgpr_kernarg_segment_ptr 1
  .amdhsa_system_sgpr_workgroup_id_x 1
.end_amdhsa_kernel
```

```asm
; @launch grid=(256,1,1) block=(192,1,1) lds=98304
.amdgcn_target "amdgcn-amd-amdhsa--gfx950"
.text
.globl standalone__kv_cache_quant_int4_int2_kv_with_per_channel_or_per_token_scales__decode_kernel
.p2align 8
.type standalone__kv_cache_quant_int4_int2_kv_with_per_channel_or_per_token_scales__decode_kernel,@function
standalone__kv_cache_quant_int4_int2_kv_with_per_channel_or_per_token_scales__decode_kernel:
    s_cmp_ge_u32 s2, 256
    s_cbranch_scc1 L_end
    s_load_dwordx16 s[4:19], s[0:1], 0
    s_load_dwordx4 s[20:23], s[0:1], 64
    v_lshrrev_b32 v177, 6, v0
    v_and_b32 v0, 63, v0
    v_readfirstlane_b32 s68, v177
    s_lshr_b32 s79, s2, 6
    s_and_b32 s92, s2, 63
    s_mov_b32 s66, 0xaaaaaaaa
    s_mov_b32 s67, 0xaaaaaaaa
    s_cmp_eq_u32 s68, 1
    s_cbranch_scc1 L_service
    s_cmp_eq_u32 s68, 2
    s_cbranch_scc1 L_ticket
    s_setprio 1
    v_and_b32 v183, 15, v0
    v_lshrrev_b32 v182, 4, v0
    v_mul_u32_u24 v1, 768, v182
    v_lshl_add_u32 v1, v183, 4, v1
    v_lshlrev_b32 v2, 3, v183
    v_bfrev_b32 v179, v183
    v_lshrrev_b32 v179, 28, v179
    v_lshl_add_u32 v3, v179, 2, v182
    v_lshlrev_b32 v3, 1, v3
    v_lshlrev_b32 v184, 2, v0
    v_add_u32 v184, 8960, v184
    v_mov_b32 v185, v184
    v_lshlrev_b32 v186, 4, v0
    v_mov_b32 v187, 0
    v_mov_b32 v188, 1
    v_lshlrev_b32 v172, 2, v0
    v_mov_b32 v173, 1
    v_mov_b32 v174, 260
    s_mul_i32 s58, s79, 0
    s_and_b32 s94, s92, 0x1f8
    s_add_u32 s94, s94, s58
    s_add_u32 s94, s94, 192
    s_add_u32 s58, s58, s92
    s_and_b32 s58, s58, 511
    s_add_u32 s59, s79, 28
    s_lshl_b32 s59, s59, 9
    s_lshl_b32 s69, s79, 9
    s_mov_b32 s64, 0xcccccccc
    s_mov_b32 s65, 0xcccccccc
    s_mov_b32 s78, 0x3dd53b95
    s_waitcnt lgkmcnt(0)
    s_mov_b32 s24, s6
    s_and_b32 s25, s7, 0xffff
    s_mov_b32 s26, 805306368
    s_mov_b32 s27, 0x00020000
    s_mov_b32 s48, s4
    s_and_b32 s49, s5, 0xffff
    s_mov_b32 s50, 12288
    s_mov_b32 s51, 0x00020000
    s_mov_b32 s32, s10
    s_and_b32 s33, s11, 0xffff
    s_mov_b32 s34, 6291456
    s_mov_b32 s35, 0x00020000
    s_mov_b32 s36, s12
    s_and_b32 s37, s13, 0xffff
    s_mov_b32 s38, 6291456
    s_mov_b32 s39, 0x00020000
    s_mov_b32 s57, s69
    s_mov_b32 s56, s58
    s_mov_b32 s75, 8
    s_add_u32 s70, s57, s56
    s_lshr_b32 s74, s70, 9
    s_mul_i32 s74, s74, 384
    buffer_load_dwordx2 v[144:145], v2, s[48:51], s74 offen offset:0
    buffer_load_dwordx2 v[146:147], v2, s[48:51], s74 offen offset:128
    buffer_load_dwordx2 v[148:149], v2, s[48:51], s74 offen offset:256
    s_mul_i32 s71, s70, 49152
    s_mul_i32 s72, s70, 384
    buffer_load_dwordx2 v[132:133], v2, s[32:35], s72 offen offset:0
    buffer_load_dwordx2 v[134:135], v2, s[32:35], s72 offen offset:128
    buffer_load_dwordx2 v[136:137], v2, s[32:35], s72 offen offset:256
    buffer_load_dwordx2 v[138:139], v2, s[36:39], s72 offen offset:0
    buffer_load_dwordx2 v[140:141], v2, s[36:39], s72 offen offset:128
    buffer_load_dwordx2 v[142:143], v2, s[36:39], s72 offen offset:256
    buffer_load_dwordx4 v[4:7], v1, s[24:27], s71 offen offset:0 nt
    buffer_load_dwordx4 v[8:11], v1, s[24:27], s71 offen offset:256 nt
    buffer_load_dwordx4 v[12:15], v1, s[24:27], s71 offen offset:512 nt
    s_add_u32 s71, s71, 3072
    buffer_load_dwordx4 v[16:19], v1, s[24:27], s71 offen offset:0 nt
    buffer_load_dwordx4 v[20:23], v1, s[24:27], s71 offen offset:256 nt
    buffer_load_dwordx4 v[24:27], v1, s[24:27], s71 offen offset:512 nt
    s_add_u32 s71, s71, 3072
    buffer_load_dwordx4 v[28:31], v1, s[24:27], s71 offen offset:0 nt
    buffer_load_dwordx4 v[32:35], v1, s[24:27], s71 offen offset:256 nt
    buffer_load_dwordx4 v[36:39], v1, s[24:27], s71 offen offset:512 nt
    s_add_u32 s71, s71, 3072
    buffer_load_dwordx4 v[40:43], v1, s[24:27], s71 offen offset:0 nt
    buffer_load_dwordx4 v[44:47], v1, s[24:27], s71 offen offset:256 nt
    buffer_load_dwordx4 v[48:51], v1, s[24:27], s71 offen offset:512 nt
    s_add_u32 s71, s71, 3072
    buffer_load_dwordx4 v[52:55], v1, s[24:27], s71 offen offset:0 nt
    buffer_load_dwordx4 v[56:59], v1, s[24:27], s71 offen offset:256 nt
    buffer_load_dwordx4 v[60:63], v1, s[24:27], s71 offen offset:512 nt
    s_add_u32 s71, s71, 3072
    buffer_load_dwordx4 v[64:67], v1, s[24:27], s71 offen offset:0 nt
    buffer_load_dwordx4 v[68:71], v1, s[24:27], s71 offen offset:256 nt
    buffer_load_dwordx4 v[72:75], v1, s[24:27], s71 offen offset:512 nt
    s_add_u32 s71, s71, 3072
    buffer_load_dwordx4 v[76:79], v1, s[24:27], s71 offen offset:0 nt
    buffer_load_dwordx4 v[80:83], v1, s[24:27], s71 offen offset:256 nt
    buffer_load_dwordx4 v[84:87], v1, s[24:27], s71 offen offset:512 nt
    s_add_u32 s71, s71, 3072
    buffer_load_dwordx4 v[88:91], v1, s[24:27], s71 offen offset:0 nt
    buffer_load_dwordx4 v[92:95], v1, s[24:27], s71 offen offset:256 nt
    s_mov_b32 s28, s8
    s_and_b32 s29, s9, 0xffff
    s_mov_b32 s30, 805306368
    s_mov_b32 s31, 0x00020000
    s_mov_b32 s40, s14
    s_and_b32 s41, s15, 0xffff
    s_mov_b32 s42, 2097152
    s_mov_b32 s43, 0x00020000
    s_mov_b32 s44, s16
    s_and_b32 s45, s17, 0xffff
    s_mov_b32 s46, 2097152
    s_mov_b32 s47, 0x00020000
    s_mov_b32 s52, s22
    s_and_b32 s53, s23, 0xffff
    s_mov_b32 s54, 25165824
    s_mov_b32 s55, 0x00020000
    s_mov_b32 s77, 8
    v_mov_b32 v165, 0xf149f2ca
    v_mov_b32 v166, 0
    v_mov_b32 v167, 0
    v_mov_b32 v152, 0
    v_mov_b32 v153, 0
    v_mov_b32 v154, 0
    v_mov_b32 v155, 0
    v_mov_b32 v156, 0
    v_mov_b32 v157, 0
    v_mov_b32 v158, 0
    v_mov_b32 v159, 0
    v_mov_b32 v160, 0
    v_mov_b32 v161, 0
    v_mov_b32 v162, 0
    v_mov_b32 v163, 0
    s_barrier
    s_mov_b32 s76, 63
L_loop0:
    s_waitcnt vmcnt(29)
    v_lshlrev_b32 v108, 16, v144
    v_and_b32 v109, 0xffff0000, v144
    v_lshlrev_b32 v110, 16, v145
    v_and_b32 v111, 0xffff0000, v145
    v_lshlrev_b32 v112, 16, v146
    v_and_b32 v113, 0xffff0000, v146
    v_lshlrev_b32 v114, 16, v147
    v_and_b32 v115, 0xffff0000, v147
    v_lshlrev_b32 v116, 16, v148
    v_and_b32 v117, 0xffff0000, v148
    v_lshlrev_b32 v118, 16, v149
    v_and_b32 v119, 0xffff0000, v149
    v_mul_f32 v108, s78, v108
    v_mul_f32 v109, s78, v109
    v_mul_f32 v110, s78, v110
    v_mul_f32 v111, s78, v111
    v_mul_f32 v112, s78, v112
    v_mul_f32 v113, s78, v113
    v_mul_f32 v114, s78, v114
    v_mul_f32 v115, s78, v115
    v_mul_f32 v116, s78, v116
    v_mul_f32 v117, s78, v117
    v_mul_f32 v118, s78, v118
    v_mul_f32 v119, s78, v119
    s_waitcnt vmcnt(23)
    v_lshlrev_b32 v182, 16, v132
    v_and_b32 v183, 0xffff0000, v132
    v_mul_f32 v120, v182, v108
    v_mul_f32 v121, v183, v109
    v_lshlrev_b32 v182, 16, v138
    v_and_b32 v183, 0xffff0000, v138
    v_mul_f32 v164, v120, v182
    v_fmac_f32 v164, v121, v183
    v_lshlrev_b32 v182, 16, v133
    v_and_b32 v183, 0xffff0000, v133
    v_mul_f32 v122, v182, v110
    v_mul_f32 v123, v183, v111
    v_lshlrev_b32 v182, 16, v139
    v_and_b32 v183, 0xffff0000, v139
    v_fmac_f32 v164, v122, v182
    v_fmac_f32 v164, v123, v183
    v_lshlrev_b32 v182, 16, v134
    v_and_b32 v183, 0xffff0000, v134
    v_mul_f32 v124, v182, v112
    v_mul_f32 v125, v183, v113
    v_lshlrev_b32 v182, 16, v140
    v_and_b32 v183, 0xffff0000, v140
    v_fmac_f32 v164, v124, v182
    v_fmac_f32 v164, v125, v183
    v_lshlrev_b32 v182, 16, v135
    v_and_b32 v183, 0xffff0000, v135
    v_mul_f32 v126, v182, v114
    v_mul_f32 v127, v183, v115
    v_lshlrev_b32 v182, 16, v141
    v_and_b32 v183, 0xffff0000, v141
    v_fmac_f32 v164, v126, v182
    v_fmac_f32 v164, v127, v183
    v_lshlrev_b32 v182, 16, v136
    v_and_b32 v183, 0xffff0000, v136
    v_mul_f32 v128, v182, v116
    v_mul_f32 v129, v183, v117
    v_lshlrev_b32 v182, 16, v142
    v_and_b32 v183, 0xffff0000, v142
    v_fmac_f32 v164, v128, v182
    v_fmac_f32 v164, v129, v183
    v_lshlrev_b32 v182, 16, v137
    v_and_b32 v183, 0xffff0000, v137
    v_mul_f32 v130, v182, v118
    v_mul_f32 v131, v183, v119
    v_lshlrev_b32 v182, 16, v143
    v_and_b32 v183, 0xffff0000, v143
    v_fmac_f32 v164, v130, v182
    v_fmac_f32 v164, v131, v183
    s_waitcnt vmcnt(22)
    v_cvt_f32_i32 v100, v4
    v_cvt_f32_i32 v101, v5
    v_cvt_f32_i32 v102, v6
    v_cvt_f32_i32 v103, v7
    buffer_load_dwordx4 v[96:99], v1, s[24:27], s71 offen offset:512 nt
    v_fma_f32 v176, v120, v100, -v164
    v_fmac_f32 v176, v121, v101
    v_fmac_f32 v176, v122, v102
    v_fmac_f32 v176, v123, v103
    s_waitcnt vmcnt(22)
    v_cvt_f32_i32 v104, v8
    v_cvt_f32_i32 v105, v9
    v_cvt_f32_i32 v106, v10
    v_cvt_f32_i32 v107, v11
    s_add_u32 s71, s71, 3072
    buffer_load_dwordx4 v[4:7], v1, s[24:27], s71 offen offset:0 nt
    v_fmac_f32 v176, v124, v104
    v_fmac_f32 v176, v125, v105
    v_fmac_f32 v176, v126, v106
    v_fmac_f32 v176, v127, v107
    s_waitcnt vmcnt(22)
    v_cvt_f32_i32 v100, v12
    v_cvt_f32_i32 v101, v13
    v_cvt_f32_i32 v102, v14
    v_cvt_f32_i32 v103, v15
    buffer_load_dwordx4 v[8:11], v1, s[24:27], s71 offen offset:256 nt
    v_fmac_f32 v176, v128, v100
    v_fmac_f32 v176, v129, v101
    v_fmac_f32 v176, v130, v102
    v_fmac_f32 v176, v131, v103
    s_nop 1
    v_add_f32_dpp v177, v176, v176 row_ror:8 row_mask:0xf bank_mask:0x3
    s_waitcnt vmcnt(22)
    v_cvt_f32_i32 v104, v16
    v_cvt_f32_i32 v105, v17
    v_cvt_f32_i32 v106, v18
    v_cvt_f32_i32 v107, v19
    buffer_load_dwordx4 v[12:15], v1, s[24:27], s71 offen offset:512 nt
    v_fma_f32 v176, v120, v104, -v164
    v_fmac_f32 v176, v121, v105
    v_fmac_f32 v176, v122, v106
    v_fmac_f32 v176, v123, v107
    s_waitcnt vmcnt(22)
    v_cvt_f32_i32 v100, v20
    v_cvt_f32_i32 v101, v21
    v_cvt_f32_i32 v102, v22
    v_cvt_f32_i32 v103, v23
    s_add_u32 s71, s71, 3072
    buffer_load_dwordx4 v[16:19], v1, s[24:27], s71 offen offset:0 nt
    v_fmac_f32 v176, v124, v100
    v_fmac_f32 v176, v125, v101
    v_fmac_f32 v176, v126, v102
    v_fmac_f32 v176, v127, v103
    s_waitcnt vmcnt(22)
    v_cvt_f32_i32 v104, v24
    v_cvt_f32_i32 v105, v25
    v_cvt_f32_i32 v106, v26
    v_cvt_f32_i32 v107, v27
    buffer_load_dwordx4 v[20:23], v1, s[24:27], s71 offen offset:256 nt
    v_fmac_f32 v176, v128, v104
    v_fmac_f32 v176, v129, v105
    v_fmac_f32 v176, v130, v106
    v_fmac_f32 v176, v131, v107
    s_nop 1
    v_add_f32_dpp v177, v176, v176 row_ror:8 row_mask:0xf bank_mask:0xc
    s_nop 1
    v_add_f32_dpp v178, v177, v177 row_shl:4 row_mask:0xf bank_mask:0x5
    s_waitcnt vmcnt(22)
    v_cvt_f32_i32 v100, v28
    v_cvt_f32_i32 v101, v29
    v_cvt_f32_i32 v102, v30
    v_cvt_f32_i32 v103, v31
    buffer_load_dwordx4 v[24:27], v1, s[24:27], s71 offen offset:512 nt
    v_fma_f32 v176, v120, v100, -v164
    v_fmac_f32 v176, v121, v101
    v_fmac_f32 v176, v122, v102
    v_fmac_f32 v176, v123, v103
    s_waitcnt vmcnt(22)
    v_cvt_f32_i32 v104, v32
    v_cvt_f32_i32 v105, v33
    v_cvt_f32_i32 v106, v34
    v_cvt_f32_i32 v107, v35
    s_add_u32 s71, s71, 3072
    buffer_load_dwordx4 v[28:31], v1, s[24:27], s71 offen offset:0 nt
    v_fmac_f32 v176, v124, v104
    v_fmac_f32 v176, v125, v105
    v_fmac_f32 v176, v126, v106
    v_fmac_f32 v176, v127, v107
    s_waitcnt vmcnt(22)
    v_cvt_f32_i32 v100, v36
    v_cvt_f32_i32 v101, v37
    v_cvt_f32_i32 v102, v38
    v_cvt_f32_i32 v103, v39
    buffer_load_dwordx4 v[32:35], v1, s[24:27], s71 offen offset:256 nt
    v_fmac_f32 v176, v128, v100
    v_fmac_f32 v176, v129, v101
    v_fmac_f32 v176, v130, v102
    v_fmac_f32 v176, v131, v103
    s_nop 1
    v_add_f32_dpp v177, v176, v176 row_ror:8 row_mask:0xf bank_mask:0x3
    s_waitcnt vmcnt(22)
    v_cvt_f32_i32 v104, v40
    v_cvt_f32_i32 v105, v41
    v_cvt_f32_i32 v106, v42
    v_cvt_f32_i32 v107, v43
    buffer_load_dwordx4 v[36:39], v1, s[24:27], s71 offen offset:512 nt
    v_fma_f32 v176, v120, v104, -v164
    v_fmac_f32 v176, v121, v105
    v_fmac_f32 v176, v122, v106
    v_fmac_f32 v176, v123, v107
    s_waitcnt vmcnt(22)
    v_cvt_f32_i32 v100, v44
    v_cvt_f32_i32 v101, v45
    v_cvt_f32_i32 v102, v46
    v_cvt_f32_i32 v103, v47
    s_add_u32 s71, s71, 3072
    buffer_load_dwordx4 v[40:43], v1, s[24:27], s71 offen offset:0 nt
    v_fmac_f32 v176, v124, v100
    v_fmac_f32 v176, v125, v101
    v_fmac_f32 v176, v126, v102
    v_fmac_f32 v176, v127, v103
    s_waitcnt vmcnt(22)
    v_cvt_f32_i32 v104, v48
    v_cvt_f32_i32 v105, v49
    v_cvt_f32_i32 v106, v50
    v_cvt_f32_i32 v107, v51
    buffer_load_dwordx4 v[44:47], v1, s[24:27], s71 offen offset:256 nt
    v_fmac_f32 v176, v128, v104
    v_fmac_f32 v176, v129, v105
    v_fmac_f32 v176, v130, v106
    v_fmac_f32 v176, v131, v107
    s_nop 1
    v_add_f32_dpp v177, v176, v176 row_ror:8 row_mask:0xf bank_mask:0xc
    s_nop 1
    v_add_f32_dpp v178, v177, v177 row_shr:4 row_mask:0xf bank_mask:0xa
    s_nop 1
    v_add_f32_dpp v179, v178, v178 quad_perm:[2,3,0,1] row_mask:0xf bank_mask:0xf
    s_waitcnt vmcnt(22)
    v_cvt_f32_i32 v100, v52
    v_cvt_f32_i32 v101, v53
    v_cvt_f32_i32 v102, v54
    v_cvt_f32_i32 v103, v55
    buffer_load_dwordx4 v[48:51], v1, s[24:27], s71 offen offset:512 nt
    v_fma_f32 v176, v120, v100, -v164
    v_fmac_f32 v176, v121, v101
    v_fmac_f32 v176, v122, v102
    v_fmac_f32 v176, v123, v103
    s_waitcnt vmcnt(22)
    v_cvt_f32_i32 v104, v56
    v_cvt_f32_i32 v105, v57
    v_cvt_f32_i32 v106, v58
    v_cvt_f32_i32 v107, v59
    s_add_u32 s71, s71, 3072
    buffer_load_dwordx4 v[52:55], v1, s[24:27], s71 offen offset:0 nt
    v_fmac_f32 v176, v124, v104
    v_fmac_f32 v176, v125, v105
    v_fmac_f32 v176, v126, v106
    v_fmac_f32 v176, v127, v107
    s_waitcnt vmcnt(22)
    v_cvt_f32_i32 v100, v60
    v_cvt_f32_i32 v101, v61
    v_cvt_f32_i32 v102, v62
    v_cvt_f32_i32 v103, v63
    buffer_load_dwordx4 v[56:59], v1, s[24:27], s71 offen offset:256 nt
    v_fmac_f32 v176, v128, v100
    v_fmac_f32 v176, v129, v101
    v_fmac_f32 v176, v130, v102
    v_fmac_f32 v176, v131, v103
    s_nop 1
    v_add_f32_dpp v177, v176, v176 row_ror:8 row_mask:0xf bank_mask:0x3
    s_waitcnt vmcnt(22)
    v_cvt_f32_i32 v104, v64
    v_cvt_f32_i32 v105, v65
    v_cvt_f32_i32 v106, v66
    v_cvt_f32_i32 v107, v67
    buffer_load_dwordx4 v[60:63], v1, s[24:27], s71 offen offset:512 nt
    v_fma_f32 v176, v120, v104, -v164
    v_fmac_f32 v176, v121, v105
    v_fmac_f32 v176, v122, v106
    v_fmac_f32 v176, v123, v107
    s_waitcnt vmcnt(22)
    v_cvt_f32_i32 v100, v68
    v_cvt_f32_i32 v101, v69
    v_cvt_f32_i32 v102, v70
    v_cvt_f32_i32 v103, v71
    s_add_u32 s71, s71, 3072
    buffer_load_dwordx4 v[64:67], v1, s[24:27], s71 offen offset:0 nt
    v_fmac_f32 v176, v124, v100
    v_fmac_f32 v176, v125, v101
    v_fmac_f32 v176, v126, v102
    v_fmac_f32 v176, v127, v103
    s_waitcnt vmcnt(22)
    v_cvt_f32_i32 v104, v72
    v_cvt_f32_i32 v105, v73
    v_cvt_f32_i32 v106, v74
    v_cvt_f32_i32 v107, v75
    buffer_load_dwordx4 v[68:71], v1, s[24:27], s71 offen offset:256 nt
    v_fmac_f32 v176, v128, v104
    v_fmac_f32 v176, v129, v105
    v_fmac_f32 v176, v130, v106
    v_fmac_f32 v176, v131, v107
    s_nop 1
    v_add_f32_dpp v177, v176, v176 row_ror:8 row_mask:0xf bank_mask:0xc
    s_nop 1
    v_add_f32_dpp v178, v177, v177 row_shl:4 row_mask:0xf bank_mask:0x5
    s_waitcnt vmcnt(22)
    v_cvt_f32_i32 v100, v76
    v_cvt_f32_i32 v101, v77
    v_cvt_f32_i32 v102, v78
    v_cvt_f32_i32 v103, v79
    buffer_load_dwordx4 v[72:75], v1, s[24:27], s71 offen offset:512 nt
    v_fma_f32 v176, v120, v100, -v164
    v_fmac_f32 v176, v121, v101
    v_fmac_f32 v176, v122, v102
    v_fmac_f32 v176, v123, v103
    s_waitcnt vmcnt(22)
    v_cvt_f32_i32 v104, v80
    v_cvt_f32_i32 v105, v81
    v_cvt_f32_i32 v106, v82
    v_cvt_f32_i32 v107, v83
    s_add_u32 s71, s71, 3072
    buffer_load_dwordx4 v[76:79], v1, s[24:27], s71 offen offset:0 nt
    v_fmac_f32 v176, v124, v104
    v_fmac_f32 v176, v125, v105
    v_fmac_f32 v176, v126, v106
    v_fmac_f32 v176, v127, v107
    s_waitcnt vmcnt(22)
    v_cvt_f32_i32 v100, v84
    v_cvt_f32_i32 v101, v85
    v_cvt_f32_i32 v102, v86
    v_cvt_f32_i32 v103, v87
    buffer_load_dwordx4 v[80:83], v1, s[24:27], s71 offen offset:256 nt
    v_fmac_f32 v176, v128, v100
    v_fmac_f32 v176, v129, v101
    v_fmac_f32 v176, v130, v102
    v_fmac_f32 v176, v131, v103
    s_nop 1
    v_add_f32_dpp v177, v176, v176 row_ror:8 row_mask:0xf bank_mask:0x3
    s_waitcnt vmcnt(22)
    v_cvt_f32_i32 v104, v88
    v_cvt_f32_i32 v105, v89
    v_cvt_f32_i32 v106, v90
    v_cvt_f32_i32 v107, v91
    buffer_load_dwordx4 v[84:87], v1, s[24:27], s71 offen offset:512 nt
    v_fma_f32 v176, v120, v104, -v164
    v_fmac_f32 v176, v121, v105
    v_fmac_f32 v176, v122, v106
    v_fmac_f32 v176, v123, v107
    s_waitcnt vmcnt(22)
    v_cvt_f32_i32 v100, v92
    v_cvt_f32_i32 v101, v93
    v_cvt_f32_i32 v102, v94
    v_cvt_f32_i32 v103, v95
    s_add_u32 s71, s71, 3072
    buffer_load_dwordx4 v[88:91], v1, s[24:27], s71 offen offset:0 nt
    v_fmac_f32 v176, v124, v100
    v_fmac_f32 v176, v125, v101
    v_fmac_f32 v176, v126, v102
    v_fmac_f32 v176, v127, v103
    s_waitcnt vmcnt(22)
    v_cvt_f32_i32 v104, v96
    v_cvt_f32_i32 v105, v97
    v_cvt_f32_i32 v106, v98
    v_cvt_f32_i32 v107, v99
    buffer_load_dwordx4 v[92:95], v1, s[24:27], s71 offen offset:256 nt
    v_fmac_f32 v176, v128, v104
    v_fmac_f32 v176, v129, v105
    v_fmac_f32 v176, v130, v106
    v_fmac_f32 v176, v131, v107
    s_nop 1
    v_add_f32_dpp v177, v176, v176 row_ror:8 row_mask:0xf bank_mask:0xc
    s_nop 1
    v_add_f32_dpp v178, v177, v177 row_shr:4 row_mask:0xf bank_mask:0xa
    s_nop 1
    v_add_f32_dpp v180, v178, v178 quad_perm:[2,3,0,1] row_mask:0xf bank_mask:0xf
    v_cndmask_b32 v180, v179, v180, s[64:65]
    s_nop 1
    v_add_f32_dpp v181, v180, v180 quad_perm:[1,0,3,2] row_mask:0xf bank_mask:0xf
    s_waitcnt vmcnt(22)
    v_cvt_f32_i32 v100, v4
    v_cvt_f32_i32 v101, v5
    v_cvt_f32_i32 v102, v6
    v_cvt_f32_i32 v103, v7
    buffer_load_dwordx4 v[96:99], v1, s[24:27], s71 offen offset:512 nt
    v_fma_f32 v176, v120, v100, -v164
    v_fmac_f32 v176, v121, v101
    v_fmac_f32 v176, v122, v102
    v_fmac_f32 v176, v123, v103
    s_waitcnt vmcnt(22)
    v_cvt_f32_i32 v104, v8
    v_cvt_f32_i32 v105, v9
    v_cvt_f32_i32 v106, v10
    v_cvt_f32_i32 v107, v11
    s_add_u32 s56, s56, 64
    s_and_b32 s56, s56, 511
    s_sub_u32 s75, s75, 1
    s_cmp_eq_u32 s75, 0
    s_cselect_b32 s80, 2048, 0
    s_cselect_b32 s75, 8, s75
    s_add_u32 s57, s57, s80
    s_add_u32 s70, s57, s56
    s_lshr_b32 s74, s70, 9
    s_mul_i32 s74, s74, 384
    buffer_load_dwordx2 v[144:145], v2, s[48:51], s74 offen offset:0
    buffer_load_dwordx2 v[146:147], v2, s[48:51], s74 offen offset:128
    buffer_load_dwordx2 v[148:149], v2, s[48:51], s74 offen offset:256
    s_mul_i32 s71, s70, 49152
    s_mul_i32 s72, s70, 384
    buffer_load_dwordx2 v[132:133], v2, s[32:35], s72 offen offset:0
    buffer_load_dwordx2 v[134:135], v2, s[32:35], s72 offen offset:128
    buffer_load_dwordx2 v[136:137], v2, s[32:35], s72 offen offset:256
    buffer_load_dwordx2 v[138:139], v2, s[36:39], s72 offen offset:0
    buffer_load_dwordx2 v[140:141], v2, s[36:39], s72 offen offset:128
    buffer_load_dwordx2 v[142:143], v2, s[36:39], s72 offen offset:256
    buffer_load_dwordx4 v[4:7], v1, s[24:27], s71 offen offset:0 nt
    v_fmac_f32 v176, v124, v104
    v_fmac_f32 v176, v125, v105
    v_fmac_f32 v176, v126, v106
    v_fmac_f32 v176, v127, v107
    s_waitcnt vmcnt(31)
    v_cvt_f32_i32 v100, v12
    v_cvt_f32_i32 v101, v13
    v_cvt_f32_i32 v102, v14
    v_cvt_f32_i32 v103, v15
    buffer_load_dwordx4 v[8:11], v1, s[24:27], s71 offen offset:256 nt
    v_fmac_f32 v176, v128, v100
    v_fmac_f32 v176, v129, v101
    v_fmac_f32 v176, v130, v102
    v_fmac_f32 v176, v131, v103
    s_nop 1
    v_add_f32_dpp v177, v176, v176 row_ror:8 row_mask:0xf bank_mask:0x3
    s_waitcnt vmcnt(31)
    v_cvt_f32_i32 v104, v16
    v_cvt_f32_i32 v105, v17
    v_cvt_f32_i32 v106, v18
    v_cvt_f32_i32 v107, v19
    buffer_load_dwordx4 v[12:15], v1, s[24:27], s71 offen offset:512 nt
    v_fma_f32 v176, v120, v104, -v164
    v_fmac_f32 v176, v121, v105
    v_fmac_f32 v176, v122, v106
    v_fmac_f32 v176, v123, v107
    s_waitcnt vmcnt(31)
    v_cvt_f32_i32 v100, v20
    v_cvt_f32_i32 v101, v21
    v_cvt_f32_i32 v102, v22
    v_cvt_f32_i32 v103, v23
    s_add_u32 s71, s71, 3072
    buffer_load_dwordx4 v[16:19], v1, s[24:27], s71 offen offset:0 nt
    v_fmac_f32 v176, v124, v100
    v_fmac_f32 v176, v125, v101
    v_fmac_f32 v176, v126, v102
    v_fmac_f32 v176, v127, v103
    s_waitcnt vmcnt(31)
    v_cvt_f32_i32 v104, v24
    v_cvt_f32_i32 v105, v25
    v_cvt_f32_i32 v106, v26
    v_cvt_f32_i32 v107, v27
    buffer_load_dwordx4 v[20:23], v1, s[24:27], s71 offen offset:256 nt
    v_fmac_f32 v176, v128, v104
    v_fmac_f32 v176, v129, v105
    v_fmac_f32 v176, v130, v106
    v_fmac_f32 v176, v131, v107
    s_nop 1
    v_add_f32_dpp v177, v176, v176 row_ror:8 row_mask:0xf bank_mask:0xc
    s_nop 1
    v_add_f32_dpp v178, v177, v177 row_shl:4 row_mask:0xf bank_mask:0x5
    s_waitcnt vmcnt(31)
    v_cvt_f32_i32 v100, v28
    v_cvt_f32_i32 v101, v29
    v_cvt_f32_i32 v102, v30
    v_cvt_f32_i32 v103, v31
    buffer_load_dwordx4 v[24:27], v1, s[24:27], s71 offen offset:512 nt
    v_fma_f32 v176, v120, v100, -v164
    v_fmac_f32 v176, v121, v101
    v_fmac_f32 v176, v122, v102
    v_fmac_f32 v176, v123, v103
    s_waitcnt vmcnt(31)
    v_cvt_f32_i32 v104, v32
    v_cvt_f32_i32 v105, v33
    v_cvt_f32_i32 v106, v34
    v_cvt_f32_i32 v107, v35
    s_add_u32 s71, s71, 3072
    buffer_load_dwordx4 v[28:31], v1, s[24:27], s71 offen offset:0 nt
    v_fmac_f32 v176, v124, v104
    v_fmac_f32 v176, v125, v105
    v_fmac_f32 v176, v126, v106
    v_fmac_f32 v176, v127, v107
    s_waitcnt vmcnt(31)
    v_cvt_f32_i32 v100, v36
    v_cvt_f32_i32 v101, v37
    v_cvt_f32_i32 v102, v38
    v_cvt_f32_i32 v103, v39
    buffer_load_dwordx4 v[32:35], v1, s[24:27], s71 offen offset:256 nt
    v_fmac_f32 v176, v128, v100
    v_fmac_f32 v176, v129, v101
    v_fmac_f32 v176, v130, v102
    v_fmac_f32 v176, v131, v103
    s_nop 1
    v_add_f32_dpp v177, v176, v176 row_ror:8 row_mask:0xf bank_mask:0x3
    s_waitcnt vmcnt(31)
    v_cvt_f32_i32 v104, v40
    v_cvt_f32_i32 v105, v41
    v_cvt_f32_i32 v106, v42
    v_cvt_f32_i32 v107, v43
    buffer_load_dwordx4 v[36:39], v1, s[24:27], s71 offen offset:512 nt
    v_fma_f32 v176, v120, v104, -v164
    v_fmac_f32 v176, v121, v105
    v_fmac_f32 v176, v122, v106
    v_fmac_f32 v176, v123, v107
    s_waitcnt vmcnt(31)
    v_cvt_f32_i32 v100, v44
    v_cvt_f32_i32 v101, v45
    v_cvt_f32_i32 v102, v46
    v_cvt_f32_i32 v103, v47
    s_add_u32 s71, s71, 3072
    buffer_load_dwordx4 v[40:43], v1, s[24:27], s71 offen offset:0 nt
    v_fmac_f32 v176, v124, v100
    v_fmac_f32 v176, v125, v101
    v_fmac_f32 v176, v126, v102
    v_fmac_f32 v176, v127, v103
    s_waitcnt vmcnt(31)
    v_cvt_f32_i32 v104, v48
    v_cvt_f32_i32 v105, v49
    v_cvt_f32_i32 v106, v50
    v_cvt_f32_i32 v107, v51
    buffer_load_dwordx4 v[44:47], v1, s[24:27], s71 offen offset:256 nt
    v_fmac_f32 v176, v128, v104
    v_fmac_f32 v176, v129, v105
    v_fmac_f32 v176, v130, v106
    v_fmac_f32 v176, v131, v107
    s_nop 1
    v_add_f32_dpp v177, v176, v176 row_ror:8 row_mask:0xf bank_mask:0xc
    s_nop 1
    v_add_f32_dpp v178, v177, v177 row_shr:4 row_mask:0xf bank_mask:0xa
    s_nop 1
    v_add_f32_dpp v179, v178, v178 quad_perm:[2,3,0,1] row_mask:0xf bank_mask:0xf
    s_waitcnt vmcnt(31)
    v_cvt_f32_i32 v100, v52
    v_cvt_f32_i32 v101, v53
    v_cvt_f32_i32 v102, v54
    v_cvt_f32_i32 v103, v55
    buffer_load_dwordx4 v[48:51], v1, s[24:27], s71 offen offset:512 nt
    v_fma_f32 v176, v120, v100, -v164
    v_fmac_f32 v176, v121, v101
    v_fmac_f32 v176, v122, v102
    v_fmac_f32 v176, v123, v103
    s_waitcnt vmcnt(31)
    v_cvt_f32_i32 v104, v56
    v_cvt_f32_i32 v105, v57
    v_cvt_f32_i32 v106, v58
    v_cvt_f32_i32 v107, v59
    s_add_u32 s71, s71, 3072
    buffer_load_dwordx4 v[52:55], v1, s[24:27], s71 offen offset:0 nt
    v_fmac_f32 v176, v124, v104
    v_fmac_f32 v176, v125, v105
    v_fmac_f32 v176, v126, v106
    v_fmac_f32 v176, v127, v107
    s_waitcnt vmcnt(31)
    v_cvt_f32_i32 v100, v60
    v_cvt_f32_i32 v101, v61
    v_cvt_f32_i32 v102, v62
    v_cvt_f32_i32 v103, v63
    buffer_load_dwordx4 v[56:59], v1, s[24:27], s71 offen offset:256 nt
    v_fmac_f32 v176, v128, v100
    v_fmac_f32 v176, v129, v101
    v_fmac_f32 v176, v130, v102
    v_fmac_f32 v176, v131, v103
    s_nop 1
    v_add_f32_dpp v177, v176, v176 row_ror:8 row_mask:0xf bank_mask:0x3
    s_waitcnt vmcnt(31)
    v_cvt_f32_i32 v104, v64
    v_cvt_f32_i32 v105, v65
    v_cvt_f32_i32 v106, v66
    v_cvt_f32_i32 v107, v67
    buffer_load_dwordx4 v[60:63], v1, s[24:27], s71 offen offset:512 nt
    v_fma_f32 v176, v120, v104, -v164
    v_fmac_f32 v176, v121, v105
    v_fmac_f32 v176, v122, v106
    v_fmac_f32 v176, v123, v107
    s_waitcnt vmcnt(31)
    v_cvt_f32_i32 v100, v68
    v_cvt_f32_i32 v101, v69
    v_cvt_f32_i32 v102, v70
    v_cvt_f32_i32 v103, v71
    s_add_u32 s71, s71, 3072
    buffer_load_dwordx4 v[64:67], v1, s[24:27], s71 offen offset:0 nt
    v_fmac_f32 v176, v124, v100
    v_fmac_f32 v176, v125, v101
    v_fmac_f32 v176, v126, v102
    v_fmac_f32 v176, v127, v103
    s_waitcnt vmcnt(31)
    v_cvt_f32_i32 v104, v72
    v_cvt_f32_i32 v105, v73
    v_cvt_f32_i32 v106, v74
    v_cvt_f32_i32 v107, v75
    buffer_load_dwordx4 v[68:71], v1, s[24:27], s71 offen offset:256 nt
    v_fmac_f32 v176, v128, v104
    v_fmac_f32 v176, v129, v105
    v_fmac_f32 v176, v130, v106
    v_fmac_f32 v176, v131, v107
    s_nop 1
    v_add_f32_dpp v177, v176, v176 row_ror:8 row_mask:0xf bank_mask:0xc
    s_nop 1
    v_add_f32_dpp v178, v177, v177 row_shl:4 row_mask:0xf bank_mask:0x5
    s_waitcnt vmcnt(31)
    v_cvt_f32_i32 v100, v76
    v_cvt_f32_i32 v101, v77
    v_cvt_f32_i32 v102, v78
    v_cvt_f32_i32 v103, v79
    buffer_load_dwordx4 v[72:75], v1, s[24:27], s71 offen offset:512 nt
    v_fma_f32 v176, v120, v100, -v164
    v_fmac_f32 v176, v121, v101
    v_fmac_f32 v176, v122, v102
    v_fmac_f32 v176, v123, v103
    s_waitcnt vmcnt(31)
    v_cvt_f32_i32 v104, v80
    v_cvt_f32_i32 v105, v81
    v_cvt_f32_i32 v106, v82
    v_cvt_f32_i32 v107, v83
    s_add_u32 s71, s71, 3072
    buffer_load_dwordx4 v[76:79], v1, s[24:27], s71 offen offset:0 nt
    v_fmac_f32 v176, v124, v104
    v_fmac_f32 v176, v125, v105
    v_fmac_f32 v176, v126, v106
    v_fmac_f32 v176, v127, v107
    s_waitcnt vmcnt(31)
    v_cvt_f32_i32 v100, v84
    v_cvt_f32_i32 v101, v85
    v_cvt_f32_i32 v102, v86
    v_cvt_f32_i32 v103, v87
    buffer_load_dwordx4 v[80:83], v1, s[24:27], s71 offen offset:256 nt
    v_fmac_f32 v176, v128, v100
    v_fmac_f32 v176, v129, v101
    v_fmac_f32 v176, v130, v102
    v_fmac_f32 v176, v131, v103
    s_nop 1
    v_add_f32_dpp v177, v176, v176 row_ror:8 row_mask:0xf bank_mask:0x3
    s_waitcnt vmcnt(31)
    v_cvt_f32_i32 v104, v88
    v_cvt_f32_i32 v105, v89
    v_cvt_f32_i32 v106, v90
    v_cvt_f32_i32 v107, v91
    buffer_load_dwordx4 v[84:87], v1, s[24:27], s71 offen offset:512 nt
    v_fma_f32 v176, v120, v104, -v164
    v_fmac_f32 v176, v121, v105
    v_fmac_f32 v176, v122, v106
    v_fmac_f32 v176, v123, v107
    s_waitcnt vmcnt(31)
    v_cvt_f32_i32 v100, v92
    v_cvt_f32_i32 v101, v93
    v_cvt_f32_i32 v102, v94
    v_cvt_f32_i32 v103, v95
    s_add_u32 s71, s71, 3072
    buffer_load_dwordx4 v[88:91], v1, s[24:27], s71 offen offset:0 nt
    v_fmac_f32 v176, v124, v100
    v_fmac_f32 v176, v125, v101
    v_fmac_f32 v176, v126, v102
    v_fmac_f32 v176, v127, v103
    s_waitcnt vmcnt(31)
    v_cvt_f32_i32 v104, v96
    v_cvt_f32_i32 v105, v97
    v_cvt_f32_i32 v106, v98
    v_cvt_f32_i32 v107, v99
    buffer_load_dwordx4 v[92:95], v1, s[24:27], s71 offen offset:256 nt
    v_fmac_f32 v176, v128, v104
    v_fmac_f32 v176, v129, v105
    v_fmac_f32 v176, v130, v106
    v_fmac_f32 v176, v131, v107
    s_nop 1
    v_add_f32_dpp v177, v176, v176 row_ror:8 row_mask:0xf bank_mask:0xc
    s_nop 1
    v_add_f32_dpp v178, v177, v177 row_shr:4 row_mask:0xf bank_mask:0xa
    s_nop 1
    v_add_f32_dpp v180, v178, v178 quad_perm:[2,3,0,1] row_mask:0xf bank_mask:0xf
    v_cndmask_b32 v180, v179, v180, s[64:65]
    s_nop 1
    v_add_f32_dpp v179, v180, v180 quad_perm:[1,0,3,2] row_mask:0xf bank_mask:0xf
    v_cndmask_b32 v181, v181, v179, s[66:67]
    ds_write_b32 v184, v181
    v_add_u32 v184, 256, v184
    s_sub_u32 s76, s76, 1
    s_cmp_lg_u32 s76, 0
    s_cbranch_scc1 L_loop0
    s_waitcnt vmcnt(29)
    v_lshlrev_b32 v108, 16, v144
    v_and_b32 v109, 0xffff0000, v144
    v_lshlrev_b32 v110, 16, v145
    v_and_b32 v111, 0xffff0000, v145
    v_lshlrev_b32 v112, 16, v146
    v_and_b32 v113, 0xffff0000, v146
    v_lshlrev_b32 v114, 16, v147
    v_and_b32 v115, 0xffff0000, v147
    v_lshlrev_b32 v116, 16, v148
    v_and_b32 v117, 0xffff0000, v148
    v_lshlrev_b32 v118, 16, v149
    v_and_b32 v119, 0xffff0000, v149
    v_mul_f32 v108, s78, v108
    v_mul_f32 v109, s78, v109
    v_mul_f32 v110, s78, v110
    v_mul_f32 v111, s78, v111
    v_mul_f32 v112, s78, v112
    v_mul_f32 v113, s78, v113
    v_mul_f32 v114, s78, v114
    v_mul_f32 v115, s78, v115
    v_mul_f32 v116, s78, v116
    v_mul_f32 v117, s78, v117
    v_mul_f32 v118, s78, v118
    v_mul_f32 v119, s78, v119
    s_waitcnt vmcnt(23)
    v_lshlrev_b32 v182, 16, v132
    v_and_b32 v183, 0xffff0000, v132
    v_mul_f32 v120, v182, v108
    v_mul_f32 v121, v183, v109
    v_lshlrev_b32 v182, 16, v138
    v_and_b32 v183, 0xffff0000, v138
    v_mul_f32 v164, v120, v182
    v_fmac_f32 v164, v121, v183
    v_lshlrev_b32 v182, 16, v133
    v_and_b32 v183, 0xffff0000, v133
    v_mul_f32 v122, v182, v110
    v_mul_f32 v123, v183, v111
    v_lshlrev_b32 v182, 16, v139
    v_and_b32 v183, 0xffff0000, v139
    v_fmac_f32 v164, v122, v182
    v_fmac_f32 v164, v123, v183
    v_lshlrev_b32 v182, 16, v134
    v_and_b32 v183, 0xffff0000, v134
    v_mul_f32 v124, v182, v112
    v_mul_f32 v125, v183, v113
    v_lshlrev_b32 v182, 16, v140
    v_and_b32 v183, 0xffff0000, v140
    v_fmac_f32 v164, v124, v182
    v_fmac_f32 v164, v125, v183
    v_lshlrev_b32 v182, 16, v135
    v_and_b32 v183, 0xffff0000, v135
    v_mul_f32 v126, v182, v114
    v_mul_f32 v127, v183, v115
    v_lshlrev_b32 v182, 16, v141
    v_and_b32 v183, 0xffff0000, v141
    v_fmac_f32 v164, v126, v182
    v_fmac_f32 v164, v127, v183
    v_lshlrev_b32 v182, 16, v136
    v_and_b32 v183, 0xffff0000, v136
    v_mul_f32 v128, v182, v116
    v_mul_f32 v129, v183, v117
    v_lshlrev_b32 v182, 16, v142
    v_and_b32 v183, 0xffff0000, v142
    v_fmac_f32 v164, v128, v182
    v_fmac_f32 v164, v129, v183
    v_lshlrev_b32 v182, 16, v137
    v_and_b32 v183, 0xffff0000, v137
    v_mul_f32 v130, v182, v118
    v_mul_f32 v131, v183, v119
    v_lshlrev_b32 v182, 16, v143
    v_and_b32 v183, 0xffff0000, v143
    v_fmac_f32 v164, v130, v182
    v_fmac_f32 v164, v131, v183
    s_waitcnt vmcnt(22)
    v_cvt_f32_i32 v100, v4
    v_cvt_f32_i32 v101, v5
    v_cvt_f32_i32 v102, v6
    v_cvt_f32_i32 v103, v7
    buffer_load_dwordx4 v[96:99], v1, s[24:27], s71 offen offset:512 nt
    v_fma_f32 v176, v120, v100, -v164
    v_fmac_f32 v176, v121, v101
    v_fmac_f32 v176, v122, v102
    v_fmac_f32 v176, v123, v103
    s_waitcnt vmcnt(22)
    v_cvt_f32_i32 v104, v8
    v_cvt_f32_i32 v105, v9
    v_cvt_f32_i32 v106, v10
    v_cvt_f32_i32 v107, v11
    s_add_u32 s71, s71, 3072
    buffer_load_dwordx4 v[4:7], v1, s[24:27], s71 offen offset:0 nt
    v_fmac_f32 v176, v124, v104
    v_fmac_f32 v176, v125, v105
    v_fmac_f32 v176, v126, v106
    v_fmac_f32 v176, v127, v107
    s_waitcnt vmcnt(22)
    v_cvt_f32_i32 v100, v12
    v_cvt_f32_i32 v101, v13
    v_cvt_f32_i32 v102, v14
    v_cvt_f32_i32 v103, v15
    buffer_load_dwordx4 v[8:11], v1, s[24:27], s71 offen offset:256 nt
    v_fmac_f32 v176, v128, v100
    v_fmac_f32 v176, v129, v101
    v_fmac_f32 v176, v130, v102
    v_fmac_f32 v176, v131, v103
    s_nop 1
    v_add_f32_dpp v177, v176, v176 row_ror:8 row_mask:0xf bank_mask:0x3
    s_waitcnt vmcnt(22)
    v_cvt_f32_i32 v104, v16
    v_cvt_f32_i32 v105, v17
    v_cvt_f32_i32 v106, v18
    v_cvt_f32_i32 v107, v19
    buffer_load_dwordx4 v[12:15], v1, s[24:27], s71 offen offset:512 nt
    v_fma_f32 v176, v120, v104, -v164
    v_fmac_f32 v176, v121, v105
    v_fmac_f32 v176, v122, v106
    v_fmac_f32 v176, v123, v107
    s_waitcnt vmcnt(22)
    v_cvt_f32_i32 v100, v20
    v_cvt_f32_i32 v101, v21
    v_cvt_f32_i32 v102, v22
    v_cvt_f32_i32 v103, v23
    s_add_u32 s71, s71, 3072
    buffer_load_dwordx4 v[16:19], v1, s[24:27], s71 offen offset:0 nt
    v_fmac_f32 v176, v124, v100
    v_fmac_f32 v176, v125, v101
    v_fmac_f32 v176, v126, v102
    v_fmac_f32 v176, v127, v103
    s_waitcnt vmcnt(22)
    v_cvt_f32_i32 v104, v24
    v_cvt_f32_i32 v105, v25
    v_cvt_f32_i32 v106, v26
    v_cvt_f32_i32 v107, v27
    buffer_load_dwordx4 v[20:23], v1, s[24:27], s71 offen offset:256 nt
    v_fmac_f32 v176, v128, v104
    v_fmac_f32 v176, v129, v105
    v_fmac_f32 v176, v130, v106
    v_fmac_f32 v176, v131, v107
    s_nop 1
    v_add_f32_dpp v177, v176, v176 row_ror:8 row_mask:0xf bank_mask:0xc
    s_nop 1
    v_add_f32_dpp v178, v177, v177 row_shl:4 row_mask:0xf bank_mask:0x5
    s_waitcnt vmcnt(22)
    v_cvt_f32_i32 v100, v28
    v_cvt_f32_i32 v101, v29
    v_cvt_f32_i32 v102, v30
    v_cvt_f32_i32 v103, v31
    buffer_load_dwordx4 v[24:27], v1, s[24:27], s71 offen offset:512 nt
    v_fma_f32 v176, v120, v100, -v164
    v_fmac_f32 v176, v121, v101
    v_fmac_f32 v176, v122, v102
    v_fmac_f32 v176, v123, v103
    s_waitcnt vmcnt(22)
    v_cvt_f32_i32 v104, v32
    v_cvt_f32_i32 v105, v33
    v_cvt_f32_i32 v106, v34
    v_cvt_f32_i32 v107, v35
    s_add_u32 s71, s71, 3072
    buffer_load_dwordx4 v[28:31], v1, s[24:27], s71 offen offset:0 nt
    v_fmac_f32 v176, v124, v104
    v_fmac_f32 v176, v125, v105
    v_fmac_f32 v176, v126, v106
    v_fmac_f32 v176, v127, v107
    s_waitcnt vmcnt(22)
    v_cvt_f32_i32 v100, v36
    v_cvt_f32_i32 v101, v37
    v_cvt_f32_i32 v102, v38
    v_cvt_f32_i32 v103, v39
    buffer_load_dwordx4 v[32:35], v1, s[24:27], s71 offen offset:256 nt
    v_fmac_f32 v176, v128, v100
    v_fmac_f32 v176, v129, v101
    v_fmac_f32 v176, v130, v102
    v_fmac_f32 v176, v131, v103
    s_nop 1
    v_add_f32_dpp v177, v176, v176 row_ror:8 row_mask:0xf bank_mask:0x3
    s_waitcnt vmcnt(22)
    v_cvt_f32_i32 v104, v40
    v_cvt_f32_i32 v105, v41
    v_cvt_f32_i32 v106, v42
    v_cvt_f32_i32 v107, v43
    buffer_load_dwordx4 v[36:39], v1, s[24:27], s71 offen offset:512 nt
    v_fma_f32 v176, v120, v104, -v164
    v_fmac_f32 v176, v121, v105
    v_fmac_f32 v176, v122, v106
    v_fmac_f32 v176, v123, v107
    s_waitcnt vmcnt(22)
    v_cvt_f32_i32 v100, v44
    v_cvt_f32_i32 v101, v45
    v_cvt_f32_i32 v102, v46
    v_cvt_f32_i32 v103, v47
    s_add_u32 s71, s71, 3072
    buffer_load_dwordx4 v[40:43], v1, s[24:27], s71 offen offset:0 nt
    v_fmac_f32 v176, v124, v100
    v_fmac_f32 v176, v125, v101
    v_fmac_f32 v176, v126, v102
    v_fmac_f32 v176, v127, v103
    s_waitcnt vmcnt(22)
    v_cvt_f32_i32 v104, v48
    v_cvt_f32_i32 v105, v49
    v_cvt_f32_i32 v106, v50
    v_cvt_f32_i32 v107, v51
    buffer_load_dwordx4 v[44:47], v1, s[24:27], s71 offen offset:256 nt
    v_fmac_f32 v176, v128, v104
    v_fmac_f32 v176, v129, v105
    v_fmac_f32 v176, v130, v106
    v_fmac_f32 v176, v131, v107
    s_nop 1
    v_add_f32_dpp v177, v176, v176 row_ror:8 row_mask:0xf bank_mask:0xc
    s_nop 1
    v_add_f32_dpp v178, v177, v177 row_shr:4 row_mask:0xf bank_mask:0xa
    s_nop 1
    v_add_f32_dpp v179, v178, v178 quad_perm:[2,3,0,1] row_mask:0xf bank_mask:0xf
    s_waitcnt vmcnt(22)
    v_cvt_f32_i32 v100, v52
    v_cvt_f32_i32 v101, v53
    v_cvt_f32_i32 v102, v54
    v_cvt_f32_i32 v103, v55
    buffer_load_dwordx4 v[48:51], v1, s[24:27], s71 offen offset:512 nt
    v_fma_f32 v176, v120, v100, -v164
    v_fmac_f32 v176, v121, v101
    v_fmac_f32 v176, v122, v102
    v_fmac_f32 v176, v123, v103
    s_waitcnt vmcnt(22)
    v_cvt_f32_i32 v104, v56
    v_cvt_f32_i32 v105, v57
    v_cvt_f32_i32 v106, v58
    v_cvt_f32_i32 v107, v59
    s_add_u32 s71, s71, 3072
    buffer_load_dwordx4 v[52:55], v1, s[24:27], s71 offen offset:0 nt
    v_fmac_f32 v176, v124, v104
    v_fmac_f32 v176, v125, v105
    v_fmac_f32 v176, v126, v106
    v_fmac_f32 v176, v127, v107
    s_waitcnt vmcnt(22)
    v_cvt_f32_i32 v100, v60
    v_cvt_f32_i32 v101, v61
    v_cvt_f32_i32 v102, v62
    v_cvt_f32_i32 v103, v63
    buffer_load_dwordx4 v[56:59], v1, s[24:27], s71 offen offset:256 nt
    v_fmac_f32 v176, v128, v100
    v_fmac_f32 v176, v129, v101
    v_fmac_f32 v176, v130, v102
    v_fmac_f32 v176, v131, v103
    s_nop 1
    v_add_f32_dpp v177, v176, v176 row_ror:8 row_mask:0xf bank_mask:0x3
    s_waitcnt vmcnt(22)
    v_cvt_f32_i32 v104, v64
    v_cvt_f32_i32 v105, v65
    v_cvt_f32_i32 v106, v66
    v_cvt_f32_i32 v107, v67
    buffer_load_dwordx4 v[60:63], v1, s[24:27], s71 offen offset:512 nt
    v_fma_f32 v176, v120, v104, -v164
    v_fmac_f32 v176, v121, v105
    v_fmac_f32 v176, v122, v106
    v_fmac_f32 v176, v123, v107
    s_waitcnt vmcnt(22)
    v_cvt_f32_i32 v100, v68
    v_cvt_f32_i32 v101, v69
    v_cvt_f32_i32 v102, v70
    v_cvt_f32_i32 v103, v71
    s_add_u32 s71, s71, 3072
    buffer_load_dwordx4 v[64:67], v1, s[24:27], s71 offen offset:0 nt
    v_fmac_f32 v176, v124, v100
    v_fmac_f32 v176, v125, v101
    v_fmac_f32 v176, v126, v102
    v_fmac_f32 v176, v127, v103
    s_waitcnt vmcnt(22)
    v_cvt_f32_i32 v104, v72
    v_cvt_f32_i32 v105, v73
    v_cvt_f32_i32 v106, v74
    v_cvt_f32_i32 v107, v75
    buffer_load_dwordx4 v[68:71], v1, s[24:27], s71 offen offset:256 nt
    v_fmac_f32 v176, v128, v104
    v_fmac_f32 v176, v129, v105
    v_fmac_f32 v176, v130, v106
    v_fmac_f32 v176, v131, v107
    s_nop 1
    v_add_f32_dpp v177, v176, v176 row_ror:8 row_mask:0xf bank_mask:0xc
    s_nop 1
    v_add_f32_dpp v178, v177, v177 row_shl:4 row_mask:0xf bank_mask:0x5
    s_waitcnt vmcnt(22)
    v_cvt_f32_i32 v100, v76
    v_cvt_f32_i32 v101, v77
    v_cvt_f32_i32 v102, v78
    v_cvt_f32_i32 v103, v79
    buffer_load_dwordx4 v[72:75], v1, s[24:27], s71 offen offset:512 nt
    v_fma_f32 v176, v120, v100, -v164
    v_fmac_f32 v176, v121, v101
    v_fmac_f32 v176, v122, v102
    v_fmac_f32 v176, v123, v103
    s_waitcnt vmcnt(22)
    v_cvt_f32_i32 v104, v80
    v_cvt_f32_i32 v105, v81
    v_cvt_f32_i32 v106, v82
    v_cvt_f32_i32 v107, v83
    s_add_u32 s71, s71, 3072
    buffer_load_dwordx4 v[76:79], v1, s[24:27], s71 offen offset:0 nt
    v_fmac_f32 v176, v124, v104
    v_fmac_f32 v176, v125, v105
    v_fmac_f32 v176, v126, v106
    v_fmac_f32 v176, v127, v107
    s_waitcnt vmcnt(22)
    v_cvt_f32_i32 v100, v84
    v_cvt_f32_i32 v101, v85
    v_cvt_f32_i32 v102, v86
    v_cvt_f32_i32 v103, v87
    buffer_load_dwordx4 v[80:83], v1, s[24:27], s71 offen offset:256 nt
    v_fmac_f32 v176, v128, v100
    v_fmac_f32 v176, v129, v101
    v_fmac_f32 v176, v130, v102
    v_fmac_f32 v176, v131, v103
    s_nop 1
    v_add_f32_dpp v177, v176, v176 row_ror:8 row_mask:0xf bank_mask:0x3
    s_waitcnt vmcnt(22)
    v_cvt_f32_i32 v104, v88
    v_cvt_f32_i32 v105, v89
    v_cvt_f32_i32 v106, v90
    v_cvt_f32_i32 v107, v91
    buffer_load_dwordx4 v[84:87], v1, s[24:27], s71 offen offset:512 nt
    v_fma_f32 v176, v120, v104, -v164
    v_fmac_f32 v176, v121, v105
    v_fmac_f32 v176, v122, v106
    v_fmac_f32 v176, v123, v107
    s_waitcnt vmcnt(22)
    v_cvt_f32_i32 v100, v92
    v_cvt_f32_i32 v101, v93
    v_cvt_f32_i32 v102, v94
    v_cvt_f32_i32 v103, v95
    s_add_u32 s71, s71, 3072
    buffer_load_dwordx4 v[88:91], v1, s[24:27], s71 offen offset:0 nt
    v_fmac_f32 v176, v124, v100
    v_fmac_f32 v176, v125, v101
    v_fmac_f32 v176, v126, v102
    v_fmac_f32 v176, v127, v103
    s_waitcnt vmcnt(22)
    v_cvt_f32_i32 v104, v96
    v_cvt_f32_i32 v105, v97
    v_cvt_f32_i32 v106, v98
    v_cvt_f32_i32 v107, v99
    buffer_load_dwordx4 v[92:95], v1, s[24:27], s71 offen offset:256 nt
    v_fmac_f32 v176, v128, v104
    v_fmac_f32 v176, v129, v105
    v_fmac_f32 v176, v130, v106
    v_fmac_f32 v176, v131, v107
    s_nop 1
    v_add_f32_dpp v177, v176, v176 row_ror:8 row_mask:0xf bank_mask:0xc
    s_nop 1
    v_add_f32_dpp v178, v177, v177 row_shr:4 row_mask:0xf bank_mask:0xa
    s_nop 1
    v_add_f32_dpp v180, v178, v178 quad_perm:[2,3,0,1] row_mask:0xf bank_mask:0xf
    v_cndmask_b32 v180, v179, v180, s[64:65]
    s_nop 1
    v_add_f32_dpp v181, v180, v180 quad_perm:[1,0,3,2] row_mask:0xf bank_mask:0xf
    s_waitcnt vmcnt(22)
    v_cvt_f32_i32 v100, v4
    v_cvt_f32_i32 v101, v5
    v_cvt_f32_i32 v102, v6
    v_cvt_f32_i32 v103, v7
    buffer_load_dwordx4 v[96:99], v1, s[24:27], s71 offen offset:512 nt
    v_fma_f32 v176, v120, v100, -v164
    v_fmac_f32 v176, v121, v101
    v_fmac_f32 v176, v122, v102
    v_fmac_f32 v176, v123, v103
    s_waitcnt vmcnt(22)
    v_cvt_f32_i32 v104, v8
    v_cvt_f32_i32 v105, v9
    v_cvt_f32_i32 v106, v10
    v_cvt_f32_i32 v107, v11
    s_mov_b32 s57, s69
    s_mov_b32 s56, s58
    s_mov_b32 s75, 8
    s_add_u32 s70, s57, s56
    s_lshl_b32 s73, s70, 7
    buffer_load_ushort v168, v3, s[40:43], s73 offen
    buffer_load_ushort v169, v3, s[44:47], s73 offen
    s_mul_i32 s71, s70, 49152
    buffer_load_dwordx4 v[4:7], v1, s[28:31], s71 offen offset:0 nt
    v_fmac_f32 v176, v124, v104
    v_fmac_f32 v176, v125, v105
    v_fmac_f32 v176, v126, v106
    v_fmac_f32 v176, v127, v107
    s_waitcnt vmcnt(24)
    v_cvt_f32_i32 v100, v12
    v_cvt_f32_i32 v101, v13
    v_cvt_f32_i32 v102, v14
    v_cvt_f32_i32 v103, v15
    buffer_load_dwordx4 v[8:11], v1, s[28:31], s71 offen offset:256 nt
    v_fmac_f32 v176, v128, v100
    v_fmac_f32 v176, v129, v101
    v_fmac_f32 v176, v130, v102
    v_fmac_f32 v176, v131, v103
    s_nop 1
    v_add_f32_dpp v177, v176, v176 row_ror:8 row_mask:0xf bank_mask:0x3
    s_waitcnt vmcnt(24)
    v_cvt_f32_i32 v104, v16
    v_cvt_f32_i32 v105, v17
    v_cvt_f32_i32 v106, v18
    v_cvt_f32_i32 v107, v19
    buffer_load_dwordx4 v[12:15], v1, s[28:31], s71 offen offset:512 nt
    v_fma_f32 v176, v120, v104, -v164
    v_fmac_f32 v176, v121, v105
    v_fmac_f32 v176, v122, v106
    v_fmac_f32 v176, v123, v107
    s_waitcnt vmcnt(24)
    v_cvt_f32_i32 v100, v20
    v_cvt_f32_i32 v101, v21
    v_cvt_f32_i32 v102, v22
    v_cvt_f32_i32 v103, v23
    s_add_u32 s71, s71, 3072
    buffer_load_dwordx4 v[16:19], v1, s[28:31], s71 offen offset:0 nt
    v_fmac_f32 v176, v124, v100
    v_fmac_f32 v176, v125, v101
    v_fmac_f32 v176, v126, v102
    v_fmac_f32 v176, v127, v103
    s_waitcnt vmcnt(24)
    v_cvt_f32_i32 v104, v24
    v_cvt_f32_i32 v105, v25
    v_cvt_f32_i32 v106, v26
    v_cvt_f32_i32 v107, v27
    buffer_load_dwordx4 v[20:23], v1, s[28:31], s71 offen offset:256 nt
    v_fmac_f32 v176, v128, v104
    v_fmac_f32 v176, v129, v105
    v_fmac_f32 v176, v130, v106
    v_fmac_f32 v176, v131, v107
    s_nop 1
    v_add_f32_dpp v177, v176, v176 row_ror:8 row_mask:0xf bank_mask:0xc
    s_nop 1
    v_add_f32_dpp v178, v177, v177 row_shl:4 row_mask:0xf bank_mask:0x5
    s_waitcnt vmcnt(24)
    v_cvt_f32_i32 v100, v28
    v_cvt_f32_i32 v101, v29
    v_cvt_f32_i32 v102, v30
    v_cvt_f32_i32 v103, v31
    buffer_load_dwordx4 v[24:27], v1, s[28:31], s71 offen offset:512 nt
    v_fma_f32 v176, v120, v100, -v164
    v_fmac_f32 v176, v121, v101
    v_fmac_f32 v176, v122, v102
    v_fmac_f32 v176, v123, v103
    s_waitcnt vmcnt(24)
    v_cvt_f32_i32 v104, v32
    v_cvt_f32_i32 v105, v33
    v_cvt_f32_i32 v106, v34
    v_cvt_f32_i32 v107, v35
    s_add_u32 s71, s71, 3072
    buffer_load_dwordx4 v[28:31], v1, s[28:31], s71 offen offset:0 nt
    v_fmac_f32 v176, v124, v104
    v_fmac_f32 v176, v125, v105
    v_fmac_f32 v176, v126, v106
    v_fmac_f32 v176, v127, v107
    s_waitcnt vmcnt(24)
    v_cvt_f32_i32 v100, v36
    v_cvt_f32_i32 v101, v37
    v_cvt_f32_i32 v102, v38
    v_cvt_f32_i32 v103, v39
    buffer_load_dwordx4 v[32:35], v1, s[28:31], s71 offen offset:256 nt
    v_fmac_f32 v176, v128, v100
    v_fmac_f32 v176, v129, v101
    v_fmac_f32 v176, v130, v102
    v_fmac_f32 v176, v131, v103
    s_nop 1
    v_add_f32_dpp v177, v176, v176 row_ror:8 row_mask:0xf bank_mask:0x3
    s_waitcnt vmcnt(24)
    v_cvt_f32_i32 v104, v40
    v_cvt_f32_i32 v105, v41
    v_cvt_f32_i32 v106, v42
    v_cvt_f32_i32 v107, v43
    buffer_load_dwordx4 v[36:39], v1, s[28:31], s71 offen offset:512 nt
    v_fma_f32 v176, v120, v104, -v164
    v_fmac_f32 v176, v121, v105
    v_fmac_f32 v176, v122, v106
    v_fmac_f32 v176, v123, v107
    s_waitcnt vmcnt(24)
    v_cvt_f32_i32 v100, v44
    v_cvt_f32_i32 v101, v45
    v_cvt_f32_i32 v102, v46
    v_cvt_f32_i32 v103, v47
    s_add_u32 s71, s71, 3072
    buffer_load_dwordx4 v[40:43], v1, s[28:31], s71 offen offset:0 nt
    v_fmac_f32 v176, v124, v100
    v_fmac_f32 v176, v125, v101
    v_fmac_f32 v176, v126, v102
    v_fmac_f32 v176, v127, v103
    s_waitcnt vmcnt(24)
    v_cvt_f32_i32 v104, v48
    v_cvt_f32_i32 v105, v49
    v_cvt_f32_i32 v106, v50
    v_cvt_f32_i32 v107, v51
    buffer_load_dwordx4 v[44:47], v1, s[28:31], s71 offen offset:256 nt
    v_fmac_f32 v176, v128, v104
    v_fmac_f32 v176, v129, v105
    v_fmac_f32 v176, v130, v106
    v_fmac_f32 v176, v131, v107
    s_nop 1
    v_add_f32_dpp v177, v176, v176 row_ror:8 row_mask:0xf bank_mask:0xc
    s_nop 1
    v_add_f32_dpp v178, v177, v177 row_shr:4 row_mask:0xf bank_mask:0xa
    s_nop 1
    v_add_f32_dpp v179, v178, v178 quad_perm:[2,3,0,1] row_mask:0xf bank_mask:0xf
    s_waitcnt vmcnt(24)
    v_cvt_f32_i32 v100, v52
    v_cvt_f32_i32 v101, v53
    v_cvt_f32_i32 v102, v54
    v_cvt_f32_i32 v103, v55
    buffer_load_dwordx4 v[48:51], v1, s[28:31], s71 offen offset:512 nt
    v_fma_f32 v176, v120, v100, -v164
    v_fmac_f32 v176, v121, v101
    v_fmac_f32 v176, v122, v102
    v_fmac_f32 v176, v123, v103
    s_waitcnt vmcnt(24)
    v_cvt_f32_i32 v104, v56
    v_cvt_f32_i32 v105, v57
    v_cvt_f32_i32 v106, v58
    v_cvt_f32_i32 v107, v59
    s_add_u32 s71, s71, 3072
    buffer_load_dwordx4 v[52:55], v1, s[28:31], s71 offen offset:0 nt
    v_fmac_f32 v176, v124, v104
    v_fmac_f32 v176, v125, v105
    v_fmac_f32 v176, v126, v106
    v_fmac_f32 v176, v127, v107
    s_waitcnt vmcnt(24)
    v_cvt_f32_i32 v100, v60
    v_cvt_f32_i32 v101, v61
    v_cvt_f32_i32 v102, v62
    v_cvt_f32_i32 v103, v63
    buffer_load_dwordx4 v[56:59], v1, s[28:31], s71 offen offset:256 nt
    v_fmac_f32 v176, v128, v100
    v_fmac_f32 v176, v129, v101
    v_fmac_f32 v176, v130, v102
    v_fmac_f32 v176, v131, v103
    s_nop 1
    v_add_f32_dpp v177, v176, v176 row_ror:8 row_mask:0xf bank_mask:0x3
    s_waitcnt vmcnt(24)
    v_cvt_f32_i32 v104, v64
    v_cvt_f32_i32 v105, v65
    v_cvt_f32_i32 v106, v66
    v_cvt_f32_i32 v107, v67
    buffer_load_dwordx4 v[60:63], v1, s[28:31], s71 offen offset:512 nt
    v_fma_f32 v176, v120, v104, -v164
    v_fmac_f32 v176, v121, v105
    v_fmac_f32 v176, v122, v106
    v_fmac_f32 v176, v123, v107
    s_waitcnt vmcnt(24)
    v_cvt_f32_i32 v100, v68
    v_cvt_f32_i32 v101, v69
    v_cvt_f32_i32 v102, v70
    v_cvt_f32_i32 v103, v71
    s_add_u32 s71, s71, 3072
    buffer_load_dwordx4 v[64:67], v1, s[28:31], s71 offen offset:0 nt
    v_fmac_f32 v176, v124, v100
    v_fmac_f32 v176, v125, v101
    v_fmac_f32 v176, v126, v102
    v_fmac_f32 v176, v127, v103
    s_waitcnt vmcnt(24)
    v_cvt_f32_i32 v104, v72
    v_cvt_f32_i32 v105, v73
    v_cvt_f32_i32 v106, v74
    v_cvt_f32_i32 v107, v75
    buffer_load_dwordx4 v[68:71], v1, s[28:31], s71 offen offset:256 nt
    v_fmac_f32 v176, v128, v104
    v_fmac_f32 v176, v129, v105
    v_fmac_f32 v176, v130, v106
    v_fmac_f32 v176, v131, v107
    s_nop 1
    v_add_f32_dpp v177, v176, v176 row_ror:8 row_mask:0xf bank_mask:0xc
    s_nop 1
    v_add_f32_dpp v178, v177, v177 row_shl:4 row_mask:0xf bank_mask:0x5
    s_waitcnt vmcnt(24)
    v_cvt_f32_i32 v100, v76
    v_cvt_f32_i32 v101, v77
    v_cvt_f32_i32 v102, v78
    v_cvt_f32_i32 v103, v79
    buffer_load_dwordx4 v[72:75], v1, s[28:31], s71 offen offset:512 nt
    v_fma_f32 v176, v120, v100, -v164
    v_fmac_f32 v176, v121, v101
    v_fmac_f32 v176, v122, v102
    v_fmac_f32 v176, v123, v103
    s_waitcnt vmcnt(24)
    v_cvt_f32_i32 v104, v80
    v_cvt_f32_i32 v105, v81
    v_cvt_f32_i32 v106, v82
    v_cvt_f32_i32 v107, v83
    s_add_u32 s71, s71, 3072
    buffer_load_dwordx4 v[76:79], v1, s[28:31], s71 offen offset:0 nt
    v_fmac_f32 v176, v124, v104
    v_fmac_f32 v176, v125, v105
    v_fmac_f32 v176, v126, v106
    v_fmac_f32 v176, v127, v107
    s_waitcnt vmcnt(24)
    v_cvt_f32_i32 v100, v84
    v_cvt_f32_i32 v101, v85
    v_cvt_f32_i32 v102, v86
    v_cvt_f32_i32 v103, v87
    buffer_load_dwordx4 v[80:83], v1, s[28:31], s71 offen offset:256 nt
    v_fmac_f32 v176, v128, v100
    v_fmac_f32 v176, v129, v101
    v_fmac_f32 v176, v130, v102
    v_fmac_f32 v176, v131, v103
    s_nop 1
    v_add_f32_dpp v177, v176, v176 row_ror:8 row_mask:0xf bank_mask:0x3
    s_waitcnt vmcnt(24)
    v_cvt_f32_i32 v104, v88
    v_cvt_f32_i32 v105, v89
    v_cvt_f32_i32 v106, v90
    v_cvt_f32_i32 v107, v91
    buffer_load_dwordx4 v[84:87], v1, s[28:31], s71 offen offset:512 nt
    v_fma_f32 v176, v120, v104, -v164
    v_fmac_f32 v176, v121, v105
    v_fmac_f32 v176, v122, v106
    v_fmac_f32 v176, v123, v107
    s_waitcnt vmcnt(24)
    v_cvt_f32_i32 v100, v92
    v_cvt_f32_i32 v101, v93
    v_cvt_f32_i32 v102, v94
    v_cvt_f32_i32 v103, v95
    s_add_u32 s71, s71, 3072
    buffer_load_dwordx4 v[88:91], v1, s[28:31], s71 offen offset:0 nt
    v_fmac_f32 v176, v124, v100
    v_fmac_f32 v176, v125, v101
    v_fmac_f32 v176, v126, v102
    v_fmac_f32 v176, v127, v103
    s_waitcnt vmcnt(24)
    v_cvt_f32_i32 v104, v96
    v_cvt_f32_i32 v105, v97
    v_cvt_f32_i32 v106, v98
    v_cvt_f32_i32 v107, v99
    buffer_load_dwordx4 v[92:95], v1, s[28:31], s71 offen offset:256 nt
    v_fmac_f32 v176, v128, v104
    v_fmac_f32 v176, v129, v105
    v_fmac_f32 v176, v130, v106
    v_fmac_f32 v176, v131, v107
    s_nop 1
    v_add_f32_dpp v177, v176, v176 row_ror:8 row_mask:0xf bank_mask:0xc
    s_nop 1
    v_add_f32_dpp v178, v177, v177 row_shr:4 row_mask:0xf bank_mask:0xa
    s_nop 1
    v_add_f32_dpp v180, v178, v178 quad_perm:[2,3,0,1] row_mask:0xf bank_mask:0xf
    v_cndmask_b32 v180, v179, v180, s[64:65]
    s_nop 1
    v_add_f32_dpp v179, v180, v180 quad_perm:[1,0,3,2] row_mask:0xf bank_mask:0xf
    v_cndmask_b32 v181, v181, v179, s[66:67]
    ds_write_b32 v184, v181
    v_add_u32 v184, 256, v184
    s_mov_b64 exec, 1
    ds_add_u32 v188, v188 offset:127
    s_mov_b64 exec, -1
    ds_read_b32 v171, v185
    v_add_u32 v185, 256, v185
    s_mov_b32 s76, 58
L_loop1:
    s_waitcnt vmcnt(23)
    v_lshlrev_b32 v168, 16, v168
    v_lshlrev_b32 v169, 16, v169
    s_waitcnt lgkmcnt(0)
    v_max_f32_dpp v182, v171, v171 row_ror:8 row_mask:0xf bank_mask:0xf
    s_nop 1
    v_max_f32_dpp v182, v182, v182 row_ror:4 row_mask:0xf bank_mask:0xf
    s_nop 1
    v_max_f32_dpp v182, v182, v182 row_ror:2 row_mask:0xf bank_mask:0xf
    s_nop 1
    v_max_f32_dpp v182, v182, v182 row_ror:1 row_mask:0xf bank_mask:0xf
    v_max_f32 v182, v182, v165
    v_sub_f32 v183, v165, v182
    v_sub_f32 v170, v171, v182
    v_exp_f32 v183, v183
    v_exp_f32 v170, v170
    v_mov_b32 v165, v182
    v_fma_f32 v166, v166, v183, v170
    v_mul_f32 v170, v170, v168
    v_mul_f32 v167, v167, v183
    v_fmac_f32 v167, v170, v169
    ds_read_b32 v171, v185
    v_add_u32 v185, 256, v185
    v_mul_f32 v152, v152, v183
    v_mul_f32 v153, v153, v183
    v_mul_f32 v154, v154, v183
    v_mul_f32 v155, v155, v183
    v_mul_f32 v156, v156, v183
    v_mul_f32 v157, v157, v183
    v_mul_f32 v158, v158, v183
    v_mul_f32 v159, v159, v183
    v_mul_f32 v160, v160, v183
    v_mul_f32 v161, v161, v183
    v_mul_f32 v162, v162, v183
    v_mul_f32 v163, v163, v183
    s_waitcnt vmcnt(22)
    v_cvt_f32_i32 v100, v4
    v_cvt_f32_i32 v101, v5
    v_cvt_f32_i32 v102, v6
    v_cvt_f32_i32 v103, v7
    buffer_load_dwordx4 v[96:99], v1, s[28:31], s71 offen offset:512 nt
    v_fmac_f32_dpp v152, v170, v100 row_newbcast:0 row_mask:0xf bank_mask:0xf
    v_fmac_f32_dpp v153, v170, v101 row_newbcast:0 row_mask:0xf bank_mask:0xf
    v_fmac_f32_dpp v154, v170, v102 row_newbcast:0 row_mask:0xf bank_mask:0xf
    v_fmac_f32_dpp v155, v170, v103 row_newbcast:0 row_mask:0xf bank_mask:0xf
    s_waitcnt vmcnt(22)
    v_cvt_f32_i32 v104, v8
    v_cvt_f32_i32 v105, v9
    v_cvt_f32_i32 v106, v10
    v_cvt_f32_i32 v107, v11
    s_add_u32 s71, s71, 3072
    buffer_load_dwordx4 v[4:7], v1, s[28:31], s71 offen offset:0 nt
    v_fmac_f32_dpp v156, v170, v104 row_newbcast:0 row_mask:0xf bank_mask:0xf
    v_fmac_f32_dpp v157, v170, v105 row_newbcast:0 row_mask:0xf bank_mask:0xf
    v_fmac_f32_dpp v158, v170, v106 row_newbcast:0 row_mask:0xf bank_mask:0xf
    v_fmac_f32_dpp v159, v170, v107 row_newbcast:0 row_mask:0xf bank_mask:0xf
    s_waitcnt vmcnt(22)
    v_cvt_f32_i32 v100, v12
    v_cvt_f32_i32 v101, v13
    v_cvt_f32_i32 v102, v14
    v_cvt_f32_i32 v103, v15
    buffer_load_dwordx4 v[8:11], v1, s[28:31], s71 offen offset:256 nt
    v_fmac_f32_dpp v160, v170, v100 row_newbcast:0 row_mask:0xf bank_mask:0xf
    v_fmac_f32_dpp v161, v170, v101 row_newbcast:0 row_mask:0xf bank_mask:0xf
    v_fmac_f32_dpp v162, v170, v102 row_newbcast:0 row_mask:0xf bank_mask:0xf
    v_fmac_f32_dpp v163, v170, v103 row_newbcast:0 row_mask:0xf bank_mask:0xf
    s_waitcnt vmcnt(22)
    v_cvt_f32_i32 v104, v16
    v_cvt_f32_i32 v105, v17
    v_cvt_f32_i32 v106, v18
    v_cvt_f32_i32 v107, v19
    buffer_load_dwordx4 v[12:15], v1, s[28:31], s71 offen offset:512 nt
    v_fmac_f32_dpp v152, v170, v104 row_newbcast:8 row_mask:0xf bank_mask:0xf
    v_fmac_f32_dpp v153, v170, v105 row_newbcast:8 row_mask:0xf bank_mask:0xf
    v_fmac_f32_dpp v154, v170, v106 row_newbcast:8 row_mask:0xf bank_mask:0xf
    v_fmac_f32_dpp v155, v170, v107 row_newbcast:8 row_mask:0xf bank_mask:0xf
    s_waitcnt vmcnt(22)
    v_cvt_f32_i32 v100, v20
    v_cvt_f32_i32 v101, v21
    v_cvt_f32_i32 v102, v22
    v_cvt_f32_i32 v103, v23
    s_add_u32 s71, s71, 3072
    buffer_load_dwordx4 v[16:19], v1, s[28:31], s71 offen offset:0 nt
    v_fmac_f32_dpp v156, v170, v100 row_newbcast:8 row_mask:0xf bank_mask:0xf
    v_fmac_f32_dpp v157, v170, v101 row_newbcast:8 row_mask:0xf bank_mask:0xf
    v_fmac_f32_dpp v158, v170, v102 row_newbcast:8 row_mask:0xf bank_mask:0xf
    v_fmac_f32_dpp v159, v170, v103 row_newbcast:8 row_mask:0xf bank_mask:0xf
    s_waitcnt vmcnt(22)
    v_cvt_f32_i32 v104, v24
    v_cvt_f32_i32 v105, v25
    v_cvt_f32_i32 v106, v26
    v_cvt_f32_i32 v107, v27
    buffer_load_dwordx4 v[20:23], v1, s[28:31], s71 offen offset:256 nt
    v_fmac_f32_dpp v160, v170, v104 row_newbcast:8 row_mask:0xf bank_mask:0xf
    v_fmac_f32_dpp v161, v170, v105 row_newbcast:8 row_mask:0xf bank_mask:0xf
    v_fmac_f32_dpp v162, v170, v106 row_newbcast:8 row_mask:0xf bank_mask:0xf
    v_fmac_f32_dpp v163, v170, v107 row_newbcast:8 row_mask:0xf bank_mask:0xf
    s_waitcnt vmcnt(22)
    v_cvt_f32_i32 v100, v28
    v_cvt_f32_i32 v101, v29
    v_cvt_f32_i32 v102, v30
    v_cvt_f32_i32 v103, v31
    buffer_load_dwordx4 v[24:27], v1, s[28:31], s71 offen offset:512 nt
    v_fmac_f32_dpp v152, v170, v100 row_newbcast:4 row_mask:0xf bank_mask:0xf
    v_fmac_f32_dpp v153, v170, v101 row_newbcast:4 row_mask:0xf bank_mask:0xf
    v_fmac_f32_dpp v154, v170, v102 row_newbcast:4 row_mask:0xf bank_mask:0xf
    v_fmac_f32_dpp v155, v170, v103 row_newbcast:4 row_mask:0xf bank_mask:0xf
    s_waitcnt vmcnt(22)
    v_cvt_f32_i32 v104, v32
    v_cvt_f32_i32 v105, v33
    v_cvt_f32_i32 v106, v34
    v_cvt_f32_i32 v107, v35
    s_add_u32 s71, s71, 3072
    buffer_load_dwordx4 v[28:31], v1, s[28:31], s71 offen offset:0 nt
    v_fmac_f32_dpp v156, v170, v104 row_newbcast:4 row_mask:0xf bank_mask:0xf
    v_fmac_f32_dpp v157, v170, v105 row_newbcast:4 row_mask:0xf bank_mask:0xf
    v_fmac_f32_dpp v158, v170, v106 row_newbcast:4 row_mask:0xf bank_mask:0xf
    v_fmac_f32_dpp v159, v170, v107 row_newbcast:4 row_mask:0xf bank_mask:0xf
    s_waitcnt vmcnt(22)
    v_cvt_f32_i32 v100, v36
    v_cvt_f32_i32 v101, v37
    v_cvt_f32_i32 v102, v38
    v_cvt_f32_i32 v103, v39
    buffer_load_dwordx4 v[32:35], v1, s[28:31], s71 offen offset:256 nt
    v_fmac_f32_dpp v160, v170, v100 row_newbcast:4 row_mask:0xf bank_mask:0xf
    v_fmac_f32_dpp v161, v170, v101 row_newbcast:4 row_mask:0xf bank_mask:0xf
    v_fmac_f32_dpp v162, v170, v102 row_newbcast:4 row_mask:0xf bank_mask:0xf
    v_fmac_f32_dpp v163, v170, v103 row_newbcast:4 row_mask:0xf bank_mask:0xf
    s_waitcnt vmcnt(22)
    v_cvt_f32_i32 v104, v40
    v_cvt_f32_i32 v105, v41
    v_cvt_f32_i32 v106, v42
    v_cvt_f32_i32 v107, v43
    buffer_load_dwordx4 v[36:39], v1, s[28:31], s71 offen offset:512 nt
    v_fmac_f32_dpp v152, v170, v104 row_newbcast:12 row_mask:0xf bank_mask:0xf
    v_fmac_f32_dpp v153, v170, v105 row_newbcast:12 row_mask:0xf bank_mask:0xf
    v_fmac_f32_dpp v154, v170, v106 row_newbcast:12 row_mask:0xf bank_mask:0xf
    v_fmac_f32_dpp v155, v170, v107 row_newbcast:12 row_mask:0xf bank_mask:0xf
    s_waitcnt vmcnt(22)
    v_cvt_f32_i32 v100, v44
    v_cvt_f32_i32 v101, v45
    v_cvt_f32_i32 v102, v46
    v_cvt_f32_i32 v103, v47
    s_add_u32 s71, s71, 3072
    buffer_load_dwordx4 v[40:43], v1, s[28:31], s71 offen offset:0 nt
    v_fmac_f32_dpp v156, v170, v100 row_newbcast:12 row_mask:0xf bank_mask:0xf
    v_fmac_f32_dpp v157, v170, v101 row_newbcast:12 row_mask:0xf bank_mask:0xf
    v_fmac_f32_dpp v158, v170, v102 row_newbcast:12 row_mask:0xf bank_mask:0xf
    v_fmac_f32_dpp v159, v170, v103 row_newbcast:12 row_mask:0xf bank_mask:0xf
    s_waitcnt vmcnt(22)
    v_cvt_f32_i32 v104, v48
    v_cvt_f32_i32 v105, v49
    v_cvt_f32_i32 v106, v50
    v_cvt_f32_i32 v107, v51
    buffer_load_dwordx4 v[44:47], v1, s[28:31], s71 offen offset:256 nt
    v_fmac_f32_dpp v160, v170, v104 row_newbcast:12 row_mask:0xf bank_mask:0xf
    v_fmac_f32_dpp v161, v170, v105 row_newbcast:12 row_mask:0xf bank_mask:0xf
    v_fmac_f32_dpp v162, v170, v106 row_newbcast:12 row_mask:0xf bank_mask:0xf
    v_fmac_f32_dpp v163, v170, v107 row_newbcast:12 row_mask:0xf bank_mask:0xf
    s_waitcnt vmcnt(22)
    v_cvt_f32_i32 v100, v52
    v_cvt_f32_i32 v101, v53
    v_cvt_f32_i32 v102, v54
    v_cvt_f32_i32 v103, v55
    buffer_load_dwordx4 v[48:51], v1, s[28:31], s71 offen offset:512 nt
    v_fmac_f32_dpp v152, v170, v100 row_newbcast:2 row_mask:0xf bank_mask:0xf
    v_fmac_f32_dpp v153, v170, v101 row_newbcast:2 row_mask:0xf bank_mask:0xf
    v_fmac_f32_dpp v154, v170, v102 row_newbcast:2 row_mask:0xf bank_mask:0xf
    v_fmac_f32_dpp v155, v170, v103 row_newbcast:2 row_mask:0xf bank_mask:0xf
    s_waitcnt vmcnt(22)
    v_cvt_f32_i32 v104, v56
    v_cvt_f32_i32 v105, v57
    v_cvt_f32_i32 v106, v58
    v_cvt_f32_i32 v107, v59
    s_add_u32 s71, s71, 3072
    buffer_load_dwordx4 v[52:55], v1, s[28:31], s71 offen offset:0 nt
    v_fmac_f32_dpp v156, v170, v104 row_newbcast:2 row_mask:0xf bank_mask:0xf
    v_fmac_f32_dpp v157, v170, v105 row_newbcast:2 row_mask:0xf bank_mask:0xf
    v_fmac_f32_dpp v158, v170, v106 row_newbcast:2 row_mask:0xf bank_mask:0xf
    v_fmac_f32_dpp v159, v170, v107 row_newbcast:2 row_mask:0xf bank_mask:0xf
    s_waitcnt vmcnt(22)
    v_cvt_f32_i32 v100, v60
    v_cvt_f32_i32 v101, v61
    v_cvt_f32_i32 v102, v62
    v_cvt_f32_i32 v103, v63
    buffer_load_dwordx4 v[56:59], v1, s[28:31], s71 offen offset:256 nt
    v_fmac_f32_dpp v160, v170, v100 row_newbcast:2 row_mask:0xf bank_mask:0xf
    v_fmac_f32_dpp v161, v170, v101 row_newbcast:2 row_mask:0xf bank_mask:0xf
    v_fmac_f32_dpp v162, v170, v102 row_newbcast:2 row_mask:0xf bank_mask:0xf
    v_fmac_f32_dpp v163, v170, v103 row_newbcast:2 row_mask:0xf bank_mask:0xf
    s_waitcnt vmcnt(22)
    v_cvt_f32_i32 v104, v64
    v_cvt_f32_i32 v105, v65
    v_cvt_f32_i32 v106, v66
    v_cvt_f32_i32 v107, v67
    buffer_load_dwordx4 v[60:63], v1, s[28:31], s71 offen offset:512 nt
    v_fmac_f32_dpp v152, v170, v104 row_newbcast:10 row_mask:0xf bank_mask:0xf
    v_fmac_f32_dpp v153, v170, v105 row_newbcast:10 row_mask:0xf bank_mask:0xf
    v_fmac_f32_dpp v154, v170, v106 row_newbcast:10 row_mask:0xf bank_mask:0xf
    v_fmac_f32_dpp v155, v170, v107 row_newbcast:10 row_mask:0xf bank_mask:0xf
    s_waitcnt vmcnt(22)
    v_cvt_f32_i32 v100, v68
    v_cvt_f32_i32 v101, v69
    v_cvt_f32_i32 v102, v70
    v_cvt_f32_i32 v103, v71
    s_add_u32 s71, s71, 3072
    buffer_load_dwordx4 v[64:67], v1, s[28:31], s71 offen offset:0 nt
    v_fmac_f32_dpp v156, v170, v100 row_newbcast:10 row_mask:0xf bank_mask:0xf
    v_fmac_f32_dpp v157, v170, v101 row_newbcast:10 row_mask:0xf bank_mask:0xf
    v_fmac_f32_dpp v158, v170, v102 row_newbcast:10 row_mask:0xf bank_mask:0xf
    v_fmac_f32_dpp v159, v170, v103 row_newbcast:10 row_mask:0xf bank_mask:0xf
    s_waitcnt vmcnt(22)
    v_cvt_f32_i32 v104, v72
    v_cvt_f32_i32 v105, v73
    v_cvt_f32_i32 v106, v74
    v_cvt_f32_i32 v107, v75
    buffer_load_dwordx4 v[68:71], v1, s[28:31], s71 offen offset:256 nt
    v_fmac_f32_dpp v160, v170, v104 row_newbcast:10 row_mask:0xf bank_mask:0xf
    v_fmac_f32_dpp v161, v170, v105 row_newbcast:10 row_mask:0xf bank_mask:0xf
    v_fmac_f32_dpp v162, v170, v106 row_newbcast:10 row_mask:0xf bank_mask:0xf
    v_fmac_f32_dpp v163, v170, v107 row_newbcast:10 row_mask:0xf bank_mask:0xf
    s_waitcnt vmcnt(22)
    v_cvt_f32_i32 v100, v76
    v_cvt_f32_i32 v101, v77
    v_cvt_f32_i32 v102, v78
    v_cvt_f32_i32 v103, v79
    buffer_load_dwordx4 v[72:75], v1, s[28:31], s71 offen offset:512 nt
    v_fmac_f32_dpp v152, v170, v100 row_newbcast:6 row_mask:0xf bank_mask:0xf
    v_fmac_f32_dpp v153, v170, v101 row_newbcast:6 row_mask:0xf bank_mask:0xf
    v_fmac_f32_dpp v154, v170, v102 row_newbcast:6 row_mask:0xf bank_mask:0xf
    v_fmac_f32_dpp v155, v170, v103 row_newbcast:6 row_mask:0xf bank_mask:0xf
    s_waitcnt vmcnt(22)
    v_cvt_f32_i32 v104, v80
    v_cvt_f32_i32 v105, v81
    v_cvt_f32_i32 v106, v82
    v_cvt_f32_i32 v107, v83
    s_add_u32 s71, s71, 3072
    buffer_load_dwordx4 v[76:79], v1, s[28:31], s71 offen offset:0 nt
    v_fmac_f32_dpp v156, v170, v104 row_newbcast:6 row_mask:0xf bank_mask:0xf
    v_fmac_f32_dpp v157, v170, v105 row_newbcast:6 row_mask:0xf bank_mask:0xf
    v_fmac_f32_dpp v158, v170, v106 row_newbcast:6 row_mask:0xf bank_mask:0xf
    v_fmac_f32_dpp v159, v170, v107 row_newbcast:6 row_mask:0xf bank_mask:0xf
    s_waitcnt vmcnt(22)
    v_cvt_f32_i32 v100, v84
    v_cvt_f32_i32 v101, v85
    v_cvt_f32_i32 v102, v86
    v_cvt_f32_i32 v103, v87
    buffer_load_dwordx4 v[80:83], v1, s[28:31], s71 offen offset:256 nt
    v_fmac_f32_dpp v160, v170, v100 row_newbcast:6 row_mask:0xf bank_mask:0xf
    v_fmac_f32_dpp v161, v170, v101 row_newbcast:6 row_mask:0xf bank_mask:0xf
    v_fmac_f32_dpp v162, v170, v102 row_newbcast:6 row_mask:0xf bank_mask:0xf
    v_fmac_f32_dpp v163, v170, v103 row_newbcast:6 row_mask:0xf bank_mask:0xf
    s_waitcnt vmcnt(22)
    v_cvt_f32_i32 v104, v88
    v_cvt_f32_i32 v105, v89
    v_cvt_f32_i32 v106, v90
    v_cvt_f32_i32 v107, v91
    buffer_load_dwordx4 v[84:87], v1, s[28:31], s71 offen offset:512 nt
    v_fmac_f32_dpp v152, v170, v104 row_newbcast:14 row_mask:0xf bank_mask:0xf
    v_fmac_f32_dpp v153, v170, v105 row_newbcast:14 row_mask:0xf bank_mask:0xf
    v_fmac_f32_dpp v154, v170, v106 row_newbcast:14 row_mask:0xf bank_mask:0xf
    v_fmac_f32_dpp v155, v170, v107 row_newbcast:14 row_mask:0xf bank_mask:0xf
    s_waitcnt vmcnt(22)
    v_cvt_f32_i32 v100, v92
    v_cvt_f32_i32 v101, v93
    v_cvt_f32_i32 v102, v94
    v_cvt_f32_i32 v103, v95
    s_add_u32 s71, s71, 3072
    buffer_load_dwordx4 v[88:91], v1, s[28:31], s71 offen offset:0 nt
    v_fmac_f32_dpp v156, v170, v100 row_newbcast:14 row_mask:0xf bank_mask:0xf
    v_fmac_f32_dpp v157, v170, v101 row_newbcast:14 row_mask:0xf bank_mask:0xf
    v_fmac_f32_dpp v158, v170, v102 row_newbcast:14 row_mask:0xf bank_mask:0xf
    v_fmac_f32_dpp v159, v170, v103 row_newbcast:14 row_mask:0xf bank_mask:0xf
    s_waitcnt vmcnt(22)
    v_cvt_f32_i32 v104, v96
    v_cvt_f32_i32 v105, v97
    v_cvt_f32_i32 v106, v98
    v_cvt_f32_i32 v107, v99
    buffer_load_dwordx4 v[92:95], v1, s[28:31], s71 offen offset:256 nt
    v_fmac_f32_dpp v160, v170, v104 row_newbcast:14 row_mask:0xf bank_mask:0xf
    v_fmac_f32_dpp v161, v170, v105 row_newbcast:14 row_mask:0xf bank_mask:0xf
    v_fmac_f32_dpp v162, v170, v106 row_newbcast:14 row_mask:0xf bank_mask:0xf
    v_fmac_f32_dpp v163, v170, v107 row_newbcast:14 row_mask:0xf bank_mask:0xf
    s_waitcnt vmcnt(22)
    v_cvt_f32_i32 v100, v4
    v_cvt_f32_i32 v101, v5
    v_cvt_f32_i32 v102, v6
    v_cvt_f32_i32 v103, v7
    buffer_load_dwordx4 v[96:99], v1, s[28:31], s71 offen offset:512 nt
    v_fmac_f32_dpp v152, v170, v100 row_newbcast:1 row_mask:0xf bank_mask:0xf
    v_fmac_f32_dpp v153, v170, v101 row_newbcast:1 row_mask:0xf bank_mask:0xf
    v_fmac_f32_dpp v154, v170, v102 row_newbcast:1 row_mask:0xf bank_mask:0xf
    v_fmac_f32_dpp v155, v170, v103 row_newbcast:1 row_mask:0xf bank_mask:0xf
    s_waitcnt vmcnt(22)
    v_cvt_f32_i32 v104, v8
    v_cvt_f32_i32 v105, v9
    v_cvt_f32_i32 v106, v10
    v_cvt_f32_i32 v107, v11
    s_add_u32 s56, s56, 64
    s_and_b32 s56, s56, 511
    s_sub_u32 s75, s75, 1
    s_cmp_eq_u32 s75, 0
    s_cselect_b32 s80, 2048, 0
    s_cselect_b32 s75, 8, s75
    s_add_u32 s57, s57, s80
    s_add_u32 s70, s57, s56
    s_lshl_b32 s73, s70, 7
    buffer_load_ushort v168, v3, s[40:43], s73 offen
    buffer_load_ushort v169, v3, s[44:47], s73 offen
    s_mul_i32 s71, s70, 49152
    buffer_load_dwordx4 v[4:7], v1, s[28:31], s71 offen offset:0 nt
    v_fmac_f32_dpp v156, v170, v104 row_newbcast:1 row_mask:0xf bank_mask:0xf
    v_fmac_f32_dpp v157, v170, v105 row_newbcast:1 row_mask:0xf bank_mask:0xf
    v_fmac_f32_dpp v158, v170, v106 row_newbcast:1 row_mask:0xf bank_mask:0xf
    v_fmac_f32_dpp v159, v170, v107 row_newbcast:1 row_mask:0xf bank_mask:0xf
    s_waitcnt vmcnt(24)
    v_cvt_f32_i32 v100, v12
    v_cvt_f32_i32 v101, v13
    v_cvt_f32_i32 v102, v14
    v_cvt_f32_i32 v103, v15
    buffer_load_dwordx4 v[8:11], v1, s[28:31], s71 offen offset:256 nt
    v_fmac_f32_dpp v160, v170, v100 row_newbcast:1 row_mask:0xf bank_mask:0xf
    v_fmac_f32_dpp v161, v170, v101 row_newbcast:1 row_mask:0xf bank_mask:0xf
    v_fmac_f32_dpp v162, v170, v102 row_newbcast:1 row_mask:0xf bank_mask:0xf
    v_fmac_f32_dpp v163, v170, v103 row_newbcast:1 row_mask:0xf bank_mask:0xf
    s_waitcnt vmcnt(24)
    v_cvt_f32_i32 v104, v16
    v_cvt_f32_i32 v105, v17
    v_cvt_f32_i32 v106, v18
    v_cvt_f32_i32 v107, v19
    buffer_load_dwordx4 v[12:15], v1, s[28:31], s71 offen offset:512 nt
    v_fmac_f32_dpp v152, v170, v104 row_newbcast:9 row_mask:0xf bank_mask:0xf
    v_fmac_f32_dpp v153, v170, v105 row_newbcast:9 row_mask:0xf bank_mask:0xf
    v_fmac_f32_dpp v154, v170, v106 row_newbcast:9 row_mask:0xf bank_mask:0xf
    v_fmac_f32_dpp v155, v170, v107 row_newbcast:9 row_mask:0xf bank_mask:0xf
    s_waitcnt vmcnt(24)
    v_cvt_f32_i32 v100, v20
    v_cvt_f32_i32 v101, v21
    v_cvt_f32_i32 v102, v22
    v_cvt_f32_i32 v103, v23
    s_add_u32 s71, s71, 3072
    buffer_load_dwordx4 v[16:19], v1, s[28:31], s71 offen offset:0 nt
    v_fmac_f32_dpp v156, v170, v100 row_newbcast:9 row_mask:0xf bank_mask:0xf
    v_fmac_f32_dpp v157, v170, v101 row_newbcast:9 row_mask:0xf bank_mask:0xf
    v_fmac_f32_dpp v158, v170, v102 row_newbcast:9 row_mask:0xf bank_mask:0xf
    v_fmac_f32_dpp v159, v170, v103 row_newbcast:9 row_mask:0xf bank_mask:0xf
    s_waitcnt vmcnt(24)
    v_cvt_f32_i32 v104, v24
    v_cvt_f32_i32 v105, v25
    v_cvt_f32_i32 v106, v26
    v_cvt_f32_i32 v107, v27
    buffer_load_dwordx4 v[20:23], v1, s[28:31], s71 offen offset:256 nt
    v_fmac_f32_dpp v160, v170, v104 row_newbcast:9 row_mask:0xf bank_mask:0xf
    v_fmac_f32_dpp v161, v170, v105 row_newbcast:9 row_mask:0xf bank_mask:0xf
    v_fmac_f32_dpp v162, v170, v106 row_newbcast:9 row_mask:0xf bank_mask:0xf
    v_fmac_f32_dpp v163, v170, v107 row_newbcast:9 row_mask:0xf bank_mask:0xf
    s_waitcnt vmcnt(24)
    v_cvt_f32_i32 v100, v28
    v_cvt_f32_i32 v101, v29
    v_cvt_f32_i32 v102, v30
    v_cvt_f32_i32 v103, v31
    buffer_load_dwordx4 v[24:27], v1, s[28:31], s71 offen offset:512 nt
    v_fmac_f32_dpp v152, v170, v100 row_newbcast:5 row_mask:0xf bank_mask:0xf
    v_fmac_f32_dpp v153, v170, v101 row_newbcast:5 row_mask:0xf bank_mask:0xf
    v_fmac_f32_dpp v154, v170, v102 row_newbcast:5 row_mask:0xf bank_mask:0xf
    v_fmac_f32_dpp v155, v170, v103 row_newbcast:5 row_mask:0xf bank_mask:0xf
    s_waitcnt vmcnt(24)
    v_cvt_f32_i32 v104, v32
    v_cvt_f32_i32 v105, v33
    v_cvt_f32_i32 v106, v34
    v_cvt_f32_i32 v107, v35
    s_add_u32 s71, s71, 3072
    buffer_load_dwordx4 v[28:31], v1, s[28:31], s71 offen offset:0 nt
    v_fmac_f32_dpp v156, v170, v104 row_newbcast:5 row_mask:0xf bank_mask:0xf
    v_fmac_f32_dpp v157, v170, v105 row_newbcast:5 row_mask:0xf bank_mask:0xf
    v_fmac_f32_dpp v158, v170, v106 row_newbcast:5 row_mask:0xf bank_mask:0xf
    v_fmac_f32_dpp v159, v170, v107 row_newbcast:5 row_mask:0xf bank_mask:0xf
    s_waitcnt vmcnt(24)
    v_cvt_f32_i32 v100, v36
    v_cvt_f32_i32 v101, v37
    v_cvt_f32_i32 v102, v38
    v_cvt_f32_i32 v103, v39
    buffer_load_dwordx4 v[32:35], v1, s[28:31], s71 offen offset:256 nt
    v_fmac_f32_dpp v160, v170, v100 row_newbcast:5 row_mask:0xf bank_mask:0xf
    v_fmac_f32_dpp v161, v170, v101 row_newbcast:5 row_mask:0xf bank_mask:0xf
    v_fmac_f32_dpp v162, v170, v102 row_newbcast:5 row_mask:0xf bank_mask:0xf
    v_fmac_f32_dpp v163, v170, v103 row_newbcast:5 row_mask:0xf bank_mask:0xf
    s_waitcnt vmcnt(24)
    v_cvt_f32_i32 v104, v40
    v_cvt_f32_i32 v105, v41
    v_cvt_f32_i32 v106, v42
    v_cvt_f32_i32 v107, v43
    buffer_load_dwordx4 v[36:39], v1, s[28:31], s71 offen offset:512 nt
    v_fmac_f32_dpp v152, v170, v104 row_newbcast:13 row_mask:0xf bank_mask:0xf
    v_fmac_f32_dpp v153, v170, v105 row_newbcast:13 row_mask:0xf bank_mask:0xf
    v_fmac_f32_dpp v154, v170, v106 row_newbcast:13 row_mask:0xf bank_mask:0xf
    v_fmac_f32_dpp v155, v170, v107 row_newbcast:13 row_mask:0xf bank_mask:0xf
    s_waitcnt vmcnt(24)
    v_cvt_f32_i32 v100, v44
    v_cvt_f32_i32 v101, v45
    v_cvt_f32_i32 v102, v46
    v_cvt_f32_i32 v103, v47
    s_add_u32 s71, s71, 3072
    buffer_load_dwordx4 v[40:43], v1, s[28:31], s71 offen offset:0 nt
    v_fmac_f32_dpp v156, v170, v100 row_newbcast:13 row_mask:0xf bank_mask:0xf
    v_fmac_f32_dpp v157, v170, v101 row_newbcast:13 row_mask:0xf bank_mask:0xf
    v_fmac_f32_dpp v158, v170, v102 row_newbcast:13 row_mask:0xf bank_mask:0xf
    v_fmac_f32_dpp v159, v170, v103 row_newbcast:13 row_mask:0xf bank_mask:0xf
    s_waitcnt vmcnt(24)
    v_cvt_f32_i32 v104, v48
    v_cvt_f32_i32 v105, v49
    v_cvt_f32_i32 v106, v50
    v_cvt_f32_i32 v107, v51
    buffer_load_dwordx4 v[44:47], v1, s[28:31], s71 offen offset:256 nt
    v_fmac_f32_dpp v160, v170, v104 row_newbcast:13 row_mask:0xf bank_mask:0xf
    v_fmac_f32_dpp v161, v170, v105 row_newbcast:13 row_mask:0xf bank_mask:0xf
    v_fmac_f32_dpp v162, v170, v106 row_newbcast:13 row_mask:0xf bank_mask:0xf
    v_fmac_f32_dpp v163, v170, v107 row_newbcast:13 row_mask:0xf bank_mask:0xf
    s_waitcnt vmcnt(24)
    v_cvt_f32_i32 v100, v52
    v_cvt_f32_i32 v101, v53
    v_cvt_f32_i32 v102, v54
    v_cvt_f32_i32 v103, v55
    buffer_load_dwordx4 v[48:51], v1, s[28:31], s71 offen offset:512 nt
    v_fmac_f32_dpp v152, v170, v100 row_newbcast:3 row_mask:0xf bank_mask:0xf
    v_fmac_f32_dpp v153, v170, v101 row_newbcast:3 row_mask:0xf bank_mask:0xf
    v_fmac_f32_dpp v154, v170, v102 row_newbcast:3 row_mask:0xf bank_mask:0xf
    v_fmac_f32_dpp v155, v170, v103 row_newbcast:3 row_mask:0xf bank_mask:0xf
    s_waitcnt vmcnt(24)
    v_cvt_f32_i32 v104, v56
    v_cvt_f32_i32 v105, v57
    v_cvt_f32_i32 v106, v58
    v_cvt_f32_i32 v107, v59
    s_add_u32 s71, s71, 3072
    buffer_load_dwordx4 v[52:55], v1, s[28:31], s71 offen offset:0 nt
    v_fmac_f32_dpp v156, v170, v104 row_newbcast:3 row_mask:0xf bank_mask:0xf
    v_fmac_f32_dpp v157, v170, v105 row_newbcast:3 row_mask:0xf bank_mask:0xf
    v_fmac_f32_dpp v158, v170, v106 row_newbcast:3 row_mask:0xf bank_mask:0xf
    v_fmac_f32_dpp v159, v170, v107 row_newbcast:3 row_mask:0xf bank_mask:0xf
    s_waitcnt vmcnt(24)
    v_cvt_f32_i32 v100, v60
    v_cvt_f32_i32 v101, v61
    v_cvt_f32_i32 v102, v62
    v_cvt_f32_i32 v103, v63
    buffer_load_dwordx4 v[56:59], v1, s[28:31], s71 offen offset:256 nt
    v_fmac_f32_dpp v160, v170, v100 row_newbcast:3 row_mask:0xf bank_mask:0xf
    v_fmac_f32_dpp v161, v170, v101 row_newbcast:3 row_mask:0xf bank_mask:0xf
    v_fmac_f32_dpp v162, v170, v102 row_newbcast:3 row_mask:0xf bank_mask:0xf
    v_fmac_f32_dpp v163, v170, v103 row_newbcast:3 row_mask:0xf bank_mask:0xf
    s_waitcnt vmcnt(24)
    v_cvt_f32_i32 v104, v64
    v_cvt_f32_i32 v105, v65
    v_cvt_f32_i32 v106, v66
    v_cvt_f32_i32 v107, v67
    buffer_load_dwordx4 v[60:63], v1, s[28:31], s71 offen offset:512 nt
    v_fmac_f32_dpp v152, v170, v104 row_newbcast:11 row_mask:0xf bank_mask:0xf
    v_fmac_f32_dpp v153, v170, v105 row_newbcast:11 row_mask:0xf bank_mask:0xf
    v_fmac_f32_dpp v154, v170, v106 row_newbcast:11 row_mask:0xf bank_mask:0xf
    v_fmac_f32_dpp v155, v170, v107 row_newbcast:11 row_mask:0xf bank_mask:0xf
    s_waitcnt vmcnt(24)
    v_cvt_f32_i32 v100, v68
    v_cvt_f32_i32 v101, v69
    v_cvt_f32_i32 v102, v70
    v_cvt_f32_i32 v103, v71
    s_add_u32 s71, s71, 3072
    buffer_load_dwordx4 v[64:67], v1, s[28:31], s71 offen offset:0 nt
    v_fmac_f32_dpp v156, v170, v100 row_newbcast:11 row_mask:0xf bank_mask:0xf
    v_fmac_f32_dpp v157, v170, v101 row_newbcast:11 row_mask:0xf bank_mask:0xf
    v_fmac_f32_dpp v158, v170, v102 row_newbcast:11 row_mask:0xf bank_mask:0xf
    v_fmac_f32_dpp v159, v170, v103 row_newbcast:11 row_mask:0xf bank_mask:0xf
    s_waitcnt vmcnt(24)
    v_cvt_f32_i32 v104, v72
    v_cvt_f32_i32 v105, v73
    v_cvt_f32_i32 v106, v74
    v_cvt_f32_i32 v107, v75
    buffer_load_dwordx4 v[68:71], v1, s[28:31], s71 offen offset:256 nt
    v_fmac_f32_dpp v160, v170, v104 row_newbcast:11 row_mask:0xf bank_mask:0xf
    v_fmac_f32_dpp v161, v170, v105 row_newbcast:11 row_mask:0xf bank_mask:0xf
    v_fmac_f32_dpp v162, v170, v106 row_newbcast:11 row_mask:0xf bank_mask:0xf
    v_fmac_f32_dpp v163, v170, v107 row_newbcast:11 row_mask:0xf bank_mask:0xf
    s_waitcnt vmcnt(24)
    v_cvt_f32_i32 v100, v76
    v_cvt_f32_i32 v101, v77
    v_cvt_f32_i32 v102, v78
    v_cvt_f32_i32 v103, v79
    buffer_load_dwordx4 v[72:75], v1, s[28:31], s71 offen offset:512 nt
    v_fmac_f32_dpp v152, v170, v100 row_newbcast:7 row_mask:0xf bank_mask:0xf
    v_fmac_f32_dpp v153, v170, v101 row_newbcast:7 row_mask:0xf bank_mask:0xf
    v_fmac_f32_dpp v154, v170, v102 row_newbcast:7 row_mask:0xf bank_mask:0xf
    v_fmac_f32_dpp v155, v170, v103 row_newbcast:7 row_mask:0xf bank_mask:0xf
    s_waitcnt vmcnt(24)
    v_cvt_f32_i32 v104, v80
    v_cvt_f32_i32 v105, v81
    v_cvt_f32_i32 v106, v82
    v_cvt_f32_i32 v107, v83
    s_add_u32 s71, s71, 3072
    buffer_load_dwordx4 v[76:79], v1, s[28:31], s71 offen offset:0 nt
    v_fmac_f32_dpp v156, v170, v104 row_newbcast:7 row_mask:0xf bank_mask:0xf
    v_fmac_f32_dpp v157, v170, v105 row_newbcast:7 row_mask:0xf bank_mask:0xf
    v_fmac_f32_dpp v158, v170, v106 row_newbcast:7 row_mask:0xf bank_mask:0xf
    v_fmac_f32_dpp v159, v170, v107 row_newbcast:7 row_mask:0xf bank_mask:0xf
    s_waitcnt vmcnt(24)
    v_cvt_f32_i32 v100, v84
    v_cvt_f32_i32 v101, v85
    v_cvt_f32_i32 v102, v86
    v_cvt_f32_i32 v103, v87
    buffer_load_dwordx4 v[80:83], v1, s[28:31], s71 offen offset:256 nt
    v_fmac_f32_dpp v160, v170, v100 row_newbcast:7 row_mask:0xf bank_mask:0xf
    v_fmac_f32_dpp v161, v170, v101 row_newbcast:7 row_mask:0xf bank_mask:0xf
    v_fmac_f32_dpp v162, v170, v102 row_newbcast:7 row_mask:0xf bank_mask:0xf
    v_fmac_f32_dpp v163, v170, v103 row_newbcast:7 row_mask:0xf bank_mask:0xf
    s_waitcnt vmcnt(24)
    v_cvt_f32_i32 v104, v88
    v_cvt_f32_i32 v105, v89
    v_cvt_f32_i32 v106, v90
    v_cvt_f32_i32 v107, v91
    buffer_load_dwordx4 v[84:87], v1, s[28:31], s71 offen offset:512 nt
    v_fmac_f32_dpp v152, v170, v104 row_newbcast:15 row_mask:0xf bank_mask:0xf
    v_fmac_f32_dpp v153, v170, v105 row_newbcast:15 row_mask:0xf bank_mask:0xf
    v_fmac_f32_dpp v154, v170, v106 row_newbcast:15 row_mask:0xf bank_mask:0xf
    v_fmac_f32_dpp v155, v170, v107 row_newbcast:15 row_mask:0xf bank_mask:0xf
    s_waitcnt vmcnt(24)
    v_cvt_f32_i32 v100, v92
    v_cvt_f32_i32 v101, v93
    v_cvt_f32_i32 v102, v94
    v_cvt_f32_i32 v103, v95
    s_add_u32 s71, s71, 3072
    buffer_load_dwordx4 v[88:91], v1, s[28:31], s71 offen offset:0 nt
    v_fmac_f32_dpp v156, v170, v100 row_newbcast:15 row_mask:0xf bank_mask:0xf
    v_fmac_f32_dpp v157, v170, v101 row_newbcast:15 row_mask:0xf bank_mask:0xf
    v_fmac_f32_dpp v158, v170, v102 row_newbcast:15 row_mask:0xf bank_mask:0xf
    v_fmac_f32_dpp v159, v170, v103 row_newbcast:15 row_mask:0xf bank_mask:0xf
    s_waitcnt vmcnt(24)
    v_cvt_f32_i32 v104, v96
    v_cvt_f32_i32 v105, v97
    v_cvt_f32_i32 v106, v98
    v_cvt_f32_i32 v107, v99
    buffer_load_dwordx4 v[92:95], v1, s[28:31], s71 offen offset:256 nt
    v_fmac_f32_dpp v160, v170, v104 row_newbcast:15 row_mask:0xf bank_mask:0xf
    v_fmac_f32_dpp v161, v170, v105 row_newbcast:15 row_mask:0xf bank_mask:0xf
    v_fmac_f32_dpp v162, v170, v106 row_newbcast:15 row_mask:0xf bank_mask:0xf
    v_fmac_f32_dpp v163, v170, v107 row_newbcast:15 row_mask:0xf bank_mask:0xf
    s_sub_u32 s77, s77, 1
    s_cmp_lg_u32 s77, 0
    s_cbranch_scc1 L_nofl2
    s_nop 0
    v_add_f32_dpp v166, v166, v166 row_ror:8 row_mask:0xf bank_mask:0xf
    v_add_f32_dpp v167, v167, v167 row_ror:8 row_mask:0xf bank_mask:0xf
    s_nop 0
    v_add_f32_dpp v166, v166, v166 row_ror:4 row_mask:0xf bank_mask:0xf
    v_add_f32_dpp v167, v167, v167 row_ror:4 row_mask:0xf bank_mask:0xf
    s_nop 0
    v_add_f32_dpp v166, v166, v166 row_ror:2 row_mask:0xf bank_mask:0xf
    v_add_f32_dpp v167, v167, v167 row_ror:2 row_mask:0xf bank_mask:0xf
    s_nop 0
    v_add_f32_dpp v166, v166, v166 row_ror:1 row_mask:0xf bank_mask:0xf
    v_add_f32_dpp v167, v167, v167 row_ror:1 row_mask:0xf bank_mask:0xf
    v_mov_b32 v182, v165
    v_mov_b32 v183, v165
    s_nop 1
    v_permlane32_swap_b32 v182, v183
    s_nop 1
    v_max_f32 v182, v182, v183
    v_mov_b32 v183, v182
    s_nop 1
    v_permlane16_swap_b32 v182, v183
    s_nop 1
    v_max_f32 v182, v182, v183
    v_sub_f32 v183, v165, v182
    v_exp_f32 v183, v183
    v_mov_b32 v104, v182
    v_mul_f32 v166, v166, v183
    v_mul_f32 v167, v167, v183
    v_fma_f32 v152, v152, v183, -v167
    v_fma_f32 v153, v153, v183, -v167
    v_fma_f32 v154, v154, v183, -v167
    v_fma_f32 v155, v155, v183, -v167
    v_fma_f32 v156, v156, v183, -v167
    v_fma_f32 v157, v157, v183, -v167
    v_fma_f32 v158, v158, v183, -v167
    v_fma_f32 v159, v159, v183, -v167
    v_fma_f32 v160, v160, v183, -v167
    v_fma_f32 v161, v161, v183, -v167
    v_fma_f32 v162, v162, v183, -v167
    v_fma_f32 v163, v163, v183, -v167
    v_mov_b32 v182, v166
    s_nop 1
    v_permlane32_swap_b32 v166, v182
    v_permlane32_swap_b32 v152, v154
    v_permlane32_swap_b32 v153, v155
    v_permlane32_swap_b32 v156, v158
    v_permlane32_swap_b32 v157, v159
    v_permlane32_swap_b32 v160, v162
    v_permlane32_swap_b32 v161, v163
    s_nop 1
    v_add_f32 v166, v166, v182
    v_add_f32 v152, v152, v154
    v_add_f32 v153, v153, v155
    v_add_f32 v156, v156, v158
    v_add_f32 v157, v157, v159
    v_add_f32 v160, v160, v162
    v_add_f32 v161, v161, v163
    v_mov_b32 v182, v166
    s_nop 1
    v_permlane16_swap_b32 v166, v182
    v_permlane16_swap_b32 v152, v153
    v_permlane16_swap_b32 v156, v157
    v_permlane16_swap_b32 v160, v161
    s_nop 1
    v_add_f32 v105, v166, v182
    v_add_f32 v100, v152, v153
    v_add_f32 v101, v156, v157
    v_add_f32 v102, v160, v161
    v_cndmask_b32 v103, v104, v105, s[66:67]
    ds_write_b128 v186, v[100:103] offset:768
    v_mov_b32 v165, 0xf149f2ca
    v_mov_b32 v166, 0
    v_mov_b32 v167, 0
    v_mov_b32 v152, 0
    v_mov_b32 v153, 0
    v_mov_b32 v154, 0
    v_mov_b32 v155, 0
    v_mov_b32 v156, 0
    v_mov_b32 v157, 0
    v_mov_b32 v158, 0
    v_mov_b32 v159, 0
    v_mov_b32 v160, 0
    v_mov_b32 v161, 0
    v_mov_b32 v162, 0
    v_mov_b32 v163, 0
    s_waitcnt lgkmcnt(0)
    s_mov_b64 exec, 1
    ds_add_u32 v187, v188
    s_mov_b64 exec, -1
    v_add_u32 v186, 1024, v186
    v_add_u32 v187, 4, v187
    s_mov_b32 s77, 8
L_nofl2:
    s_sub_u32 s76, s76, 1
    s_cmp_lg_u32 s76, 0
    s_cbranch_scc1 L_loop1
    s_waitcnt vmcnt(23)
    v_lshlrev_b32 v168, 16, v168
    v_lshlrev_b32 v169, 16, v169
    s_waitcnt lgkmcnt(0)
    v_max_f32_dpp v182, v171, v171 row_ror:8 row_mask:0xf bank_mask:0xf
    s_nop 1
    v_max_f32_dpp v182, v182, v182 row_ror:4 row_mask:0xf bank_mask:0xf
    s_nop 1
    v_max_f32_dpp v182, v182, v182 row_ror:2 row_mask:0xf bank_mask:0xf
    s_nop 1
    v_max_f32_dpp v182, v182, v182 row_ror:1 row_mask:0xf bank_mask:0xf
    v_max_f32 v182, v182, v165
    v_sub_f32 v183, v165, v182
    v_sub_f32 v170, v171, v182
    v_exp_f32 v183, v183
    v_exp_f32 v170, v170
    v_mov_b32 v165, v182
    v_fma_f32 v166, v166, v183, v170
    v_mul_f32 v170, v170, v168
    v_mul_f32 v167, v167, v183
    v_fmac_f32 v167, v170, v169
    v_mul_f32 v152, v152, v183
    v_mul_f32 v153, v153, v183
    v_mul_f32 v154, v154, v183
    v_mul_f32 v155, v155, v183
    v_mul_f32 v156, v156, v183
    v_mul_f32 v157, v157, v183
    v_mul_f32 v158, v158, v183
    v_mul_f32 v159, v159, v183
    v_mul_f32 v160, v160, v183
    v_mul_f32 v161, v161, v183
    v_mul_f32 v162, v162, v183
    v_mul_f32 v163, v163, v183
    s_waitcnt vmcnt(22)
    v_cvt_f32_i32 v100, v4
    v_cvt_f32_i32 v101, v5
    v_cvt_f32_i32 v102, v6
    v_cvt_f32_i32 v103, v7
    buffer_load_dwordx4 v[96:99], v1, s[28:31], s71 offen offset:512 nt
    v_fmac_f32_dpp v152, v170, v100 row_newbcast:0 row_mask:0xf bank_mask:0xf
    v_fmac_f32_dpp v153, v170, v101 row_newbcast:0 row_mask:0xf bank_mask:0xf
    v_fmac_f32_dpp v154, v170, v102 row_newbcast:0 row_mask:0xf bank_mask:0xf
    v_fmac_f32_dpp v155, v170, v103 row_newbcast:0 row_mask:0xf bank_mask:0xf
    s_waitcnt vmcnt(22)
    v_cvt_f32_i32 v104, v8
    v_cvt_f32_i32 v105, v9
    v_cvt_f32_i32 v106, v10
    v_cvt_f32_i32 v107, v11
    s_add_u32 s71, s71, 3072
    buffer_load_dwordx4 v[4:7], v1, s[28:31], s71 offen offset:0 nt
    v_fmac_f32_dpp v156, v170, v104 row_newbcast:0 row_mask:0xf bank_mask:0xf
    v_fmac_f32_dpp v157, v170, v105 row_newbcast:0 row_mask:0xf bank_mask:0xf
    v_fmac_f32_dpp v158, v170, v106 row_newbcast:0 row_mask:0xf bank_mask:0xf
    v_fmac_f32_dpp v159, v170, v107 row_newbcast:0 row_mask:0xf bank_mask:0xf
    s_waitcnt vmcnt(22)
    v_cvt_f32_i32 v100, v12
    v_cvt_f32_i32 v101, v13
    v_cvt_f32_i32 v102, v14
    v_cvt_f32_i32 v103, v15
    buffer_load_dwordx4 v[8:11], v1, s[28:31], s71 offen offset:256 nt
    v_fmac_f32_dpp v160, v170, v100 row_newbcast:0 row_mask:0xf bank_mask:0xf
    v_fmac_f32_dpp v161, v170, v101 row_newbcast:0 row_mask:0xf bank_mask:0xf
    v_fmac_f32_dpp v162, v170, v102 row_newbcast:0 row_mask:0xf bank_mask:0xf
    v_fmac_f32_dpp v163, v170, v103 row_newbcast:0 row_mask:0xf bank_mask:0xf
    s_waitcnt vmcnt(22)
    v_cvt_f32_i32 v104, v16
    v_cvt_f32_i32 v105, v17
    v_cvt_f32_i32 v106, v18
    v_cvt_f32_i32 v107, v19
    buffer_load_dwordx4 v[12:15], v1, s[28:31], s71 offen offset:512 nt
    v_fmac_f32_dpp v152, v170, v104 row_newbcast:8 row_mask:0xf bank_mask:0xf
    v_fmac_f32_dpp v153, v170, v105 row_newbcast:8 row_mask:0xf bank_mask:0xf
    v_fmac_f32_dpp v154, v170, v106 row_newbcast:8 row_mask:0xf bank_mask:0xf
    v_fmac_f32_dpp v155, v170, v107 row_newbcast:8 row_mask:0xf bank_mask:0xf
    s_waitcnt vmcnt(22)
    v_cvt_f32_i32 v100, v20
    v_cvt_f32_i32 v101, v21
    v_cvt_f32_i32 v102, v22
    v_cvt_f32_i32 v103, v23
    s_add_u32 s71, s71, 3072
    buffer_load_dwordx4 v[16:19], v1, s[28:31], s71 offen offset:0 nt
    v_fmac_f32_dpp v156, v170, v100 row_newbcast:8 row_mask:0xf bank_mask:0xf
    v_fmac_f32_dpp v157, v170, v101 row_newbcast:8 row_mask:0xf bank_mask:0xf
    v_fmac_f32_dpp v158, v170, v102 row_newbcast:8 row_mask:0xf bank_mask:0xf
    v_fmac_f32_dpp v159, v170, v103 row_newbcast:8 row_mask:0xf bank_mask:0xf
    s_waitcnt vmcnt(22)
    v_cvt_f32_i32 v104, v24
    v_cvt_f32_i32 v105, v25
    v_cvt_f32_i32 v106, v26
    v_cvt_f32_i32 v107, v27
    buffer_load_dwordx4 v[20:23], v1, s[28:31], s71 offen offset:256 nt
    v_fmac_f32_dpp v160, v170, v104 row_newbcast:8 row_mask:0xf bank_mask:0xf
    v_fmac_f32_dpp v161, v170, v105 row_newbcast:8 row_mask:0xf bank_mask:0xf
    v_fmac_f32_dpp v162, v170, v106 row_newbcast:8 row_mask:0xf bank_mask:0xf
    v_fmac_f32_dpp v163, v170, v107 row_newbcast:8 row_mask:0xf bank_mask:0xf
    s_waitcnt vmcnt(22)
    v_cvt_f32_i32 v100, v28
    v_cvt_f32_i32 v101, v29
    v_cvt_f32_i32 v102, v30
    v_cvt_f32_i32 v103, v31
    buffer_load_dwordx4 v[24:27], v1, s[28:31], s71 offen offset:512 nt
    v_fmac_f32_dpp v152, v170, v100 row_newbcast:4 row_mask:0xf bank_mask:0xf
    v_fmac_f32_dpp v153, v170, v101 row_newbcast:4 row_mask:0xf bank_mask:0xf
    v_fmac_f32_dpp v154, v170, v102 row_newbcast:4 row_mask:0xf bank_mask:0xf
    v_fmac_f32_dpp v155, v170, v103 row_newbcast:4 row_mask:0xf bank_mask:0xf
    s_waitcnt vmcnt(22)
    v_cvt_f32_i32 v104, v32
    v_cvt_f32_i32 v105, v33
    v_cvt_f32_i32 v106, v34
    v_cvt_f32_i32 v107, v35
    s_add_u32 s71, s71, 3072
    buffer_load_dwordx4 v[28:31], v1, s[28:31], s71 offen offset:0 nt
    v_fmac_f32_dpp v156, v170, v104 row_newbcast:4 row_mask:0xf bank_mask:0xf
    v_fmac_f32_dpp v157, v170, v105 row_newbcast:4 row_mask:0xf bank_mask:0xf
    v_fmac_f32_dpp v158, v170, v106 row_newbcast:4 row_mask:0xf bank_mask:0xf
    v_fmac_f32_dpp v159, v170, v107 row_newbcast:4 row_mask:0xf bank_mask:0xf
    s_waitcnt vmcnt(22)
    v_cvt_f32_i32 v100, v36
    v_cvt_f32_i32 v101, v37
    v_cvt_f32_i32 v102, v38
    v_cvt_f32_i32 v103, v39
    buffer_load_dwordx4 v[32:35], v1, s[28:31], s71 offen offset:256 nt
    v_fmac_f32_dpp v160, v170, v100 row_newbcast:4 row_mask:0xf bank_mask:0xf
    v_fmac_f32_dpp v161, v170, v101 row_newbcast:4 row_mask:0xf bank_mask:0xf
    v_fmac_f32_dpp v162, v170, v102 row_newbcast:4 row_mask:0xf bank_mask:0xf
    v_fmac_f32_dpp v163, v170, v103 row_newbcast:4 row_mask:0xf bank_mask:0xf
    s_waitcnt vmcnt(22)
    v_cvt_f32_i32 v104, v40
    v_cvt_f32_i32 v105, v41
    v_cvt_f32_i32 v106, v42
    v_cvt_f32_i32 v107, v43
    buffer_load_dwordx4 v[36:39], v1, s[28:31], s71 offen offset:512 nt
    v_fmac_f32_dpp v152, v170, v104 row_newbcast:12 row_mask:0xf bank_mask:0xf
    v_fmac_f32_dpp v153, v170, v105 row_newbcast:12 row_mask:0xf bank_mask:0xf
    v_fmac_f32_dpp v154, v170, v106 row_newbcast:12 row_mask:0xf bank_mask:0xf
    v_fmac_f32_dpp v155, v170, v107 row_newbcast:12 row_mask:0xf bank_mask:0xf
    s_waitcnt vmcnt(22)
    v_cvt_f32_i32 v100, v44
    v_cvt_f32_i32 v101, v45
    v_cvt_f32_i32 v102, v46
    v_cvt_f32_i32 v103, v47
    s_add_u32 s71, s71, 3072
    buffer_load_dwordx4 v[40:43], v1, s[28:31], s71 offen offset:0 nt
    v_fmac_f32_dpp v156, v170, v100 row_newbcast:12 row_mask:0xf bank_mask:0xf
    v_fmac_f32_dpp v157, v170, v101 row_newbcast:12 row_mask:0xf bank_mask:0xf
    v_fmac_f32_dpp v158, v170, v102 row_newbcast:12 row_mask:0xf bank_mask:0xf
    v_fmac_f32_dpp v159, v170, v103 row_newbcast:12 row_mask:0xf bank_mask:0xf
    s_waitcnt vmcnt(22)
    v_cvt_f32_i32 v104, v48
    v_cvt_f32_i32 v105, v49
    v_cvt_f32_i32 v106, v50
    v_cvt_f32_i32 v107, v51
    buffer_load_dwordx4 v[44:47], v1, s[28:31], s71 offen offset:256 nt
    v_fmac_f32_dpp v160, v170, v104 row_newbcast:12 row_mask:0xf bank_mask:0xf
    v_fmac_f32_dpp v161, v170, v105 row_newbcast:12 row_mask:0xf bank_mask:0xf
    v_fmac_f32_dpp v162, v170, v106 row_newbcast:12 row_mask:0xf bank_mask:0xf
    v_fmac_f32_dpp v163, v170, v107 row_newbcast:12 row_mask:0xf bank_mask:0xf
    s_waitcnt vmcnt(22)
    v_cvt_f32_i32 v100, v52
    v_cvt_f32_i32 v101, v53
    v_cvt_f32_i32 v102, v54
    v_cvt_f32_i32 v103, v55
    buffer_load_dwordx4 v[48:51], v1, s[28:31], s71 offen offset:512 nt
    v_fmac_f32_dpp v152, v170, v100 row_newbcast:2 row_mask:0xf bank_mask:0xf
    v_fmac_f32_dpp v153, v170, v101 row_newbcast:2 row_mask:0xf bank_mask:0xf
    v_fmac_f32_dpp v154, v170, v102 row_newbcast:2 row_mask:0xf bank_mask:0xf
    v_fmac_f32_dpp v155, v170, v103 row_newbcast:2 row_mask:0xf bank_mask:0xf
    s_waitcnt vmcnt(22)
    v_cvt_f32_i32 v104, v56
    v_cvt_f32_i32 v105, v57
    v_cvt_f32_i32 v106, v58
    v_cvt_f32_i32 v107, v59
    s_add_u32 s71, s71, 3072
    buffer_load_dwordx4 v[52:55], v1, s[28:31], s71 offen offset:0 nt
    v_fmac_f32_dpp v156, v170, v104 row_newbcast:2 row_mask:0xf bank_mask:0xf
    v_fmac_f32_dpp v157, v170, v105 row_newbcast:2 row_mask:0xf bank_mask:0xf
    v_fmac_f32_dpp v158, v170, v106 row_newbcast:2 row_mask:0xf bank_mask:0xf
    v_fmac_f32_dpp v159, v170, v107 row_newbcast:2 row_mask:0xf bank_mask:0xf
    s_waitcnt vmcnt(22)
    v_cvt_f32_i32 v100, v60
    v_cvt_f32_i32 v101, v61
    v_cvt_f32_i32 v102, v62
    v_cvt_f32_i32 v103, v63
    buffer_load_dwordx4 v[56:59], v1, s[28:31], s71 offen offset:256 nt
    v_fmac_f32_dpp v160, v170, v100 row_newbcast:2 row_mask:0xf bank_mask:0xf
    v_fmac_f32_dpp v161, v170, v101 row_newbcast:2 row_mask:0xf bank_mask:0xf
    v_fmac_f32_dpp v162, v170, v102 row_newbcast:2 row_mask:0xf bank_mask:0xf
    v_fmac_f32_dpp v163, v170, v103 row_newbcast:2 row_mask:0xf bank_mask:0xf
    s_waitcnt vmcnt(22)
    v_cvt_f32_i32 v104, v64
    v_cvt_f32_i32 v105, v65
    v_cvt_f32_i32 v106, v66
    v_cvt_f32_i32 v107, v67
    buffer_load_dwordx4 v[60:63], v1, s[28:31], s71 offen offset:512 nt
    v_fmac_f32_dpp v152, v170, v104 row_newbcast:10 row_mask:0xf bank_mask:0xf
    v_fmac_f32_dpp v153, v170, v105 row_newbcast:10 row_mask:0xf bank_mask:0xf
    v_fmac_f32_dpp v154, v170, v106 row_newbcast:10 row_mask:0xf bank_mask:0xf
    v_fmac_f32_dpp v155, v170, v107 row_newbcast:10 row_mask:0xf bank_mask:0xf
    s_waitcnt vmcnt(22)
    v_cvt_f32_i32 v100, v68
    v_cvt_f32_i32 v101, v69
    v_cvt_f32_i32 v102, v70
    v_cvt_f32_i32 v103, v71
    s_add_u32 s71, s71, 3072
    buffer_load_dwordx4 v[64:67], v1, s[28:31], s71 offen offset:0 nt
    v_fmac_f32_dpp v156, v170, v100 row_newbcast:10 row_mask:0xf bank_mask:0xf
    v_fmac_f32_dpp v157, v170, v101 row_newbcast:10 row_mask:0xf bank_mask:0xf
    v_fmac_f32_dpp v158, v170, v102 row_newbcast:10 row_mask:0xf bank_mask:0xf
    v_fmac_f32_dpp v159, v170, v103 row_newbcast:10 row_mask:0xf bank_mask:0xf
    s_waitcnt vmcnt(22)
    v_cvt_f32_i32 v104, v72
    v_cvt_f32_i32 v105, v73
    v_cvt_f32_i32 v106, v74
    v_cvt_f32_i32 v107, v75
    buffer_load_dwordx4 v[68:71], v1, s[28:31], s71 offen offset:256 nt
    v_fmac_f32_dpp v160, v170, v104 row_newbcast:10 row_mask:0xf bank_mask:0xf
    v_fmac_f32_dpp v161, v170, v105 row_newbcast:10 row_mask:0xf bank_mask:0xf
    v_fmac_f32_dpp v162, v170, v106 row_newbcast:10 row_mask:0xf bank_mask:0xf
    v_fmac_f32_dpp v163, v170, v107 row_newbcast:10 row_mask:0xf bank_mask:0xf
    s_waitcnt vmcnt(22)
    v_cvt_f32_i32 v100, v76
    v_cvt_f32_i32 v101, v77
    v_cvt_f32_i32 v102, v78
    v_cvt_f32_i32 v103, v79
    buffer_load_dwordx4 v[72:75], v1, s[28:31], s71 offen offset:512 nt
    v_fmac_f32_dpp v152, v170, v100 row_newbcast:6 row_mask:0xf bank_mask:0xf
    v_fmac_f32_dpp v153, v170, v101 row_newbcast:6 row_mask:0xf bank_mask:0xf
    v_fmac_f32_dpp v154, v170, v102 row_newbcast:6 row_mask:0xf bank_mask:0xf
    v_fmac_f32_dpp v155, v170, v103 row_newbcast:6 row_mask:0xf bank_mask:0xf
    s_waitcnt vmcnt(22)
    v_cvt_f32_i32 v104, v80
    v_cvt_f32_i32 v105, v81
    v_cvt_f32_i32 v106, v82
    v_cvt_f32_i32 v107, v83
    s_add_u32 s71, s71, 3072
    buffer_load_dwordx4 v[76:79], v1, s[28:31], s71 offen offset:0 nt
    v_fmac_f32_dpp v156, v170, v104 row_newbcast:6 row_mask:0xf bank_mask:0xf
    v_fmac_f32_dpp v157, v170, v105 row_newbcast:6 row_mask:0xf bank_mask:0xf
    v_fmac_f32_dpp v158, v170, v106 row_newbcast:6 row_mask:0xf bank_mask:0xf
    v_fmac_f32_dpp v159, v170, v107 row_newbcast:6 row_mask:0xf bank_mask:0xf
    s_waitcnt vmcnt(22)
    v_cvt_f32_i32 v100, v84
    v_cvt_f32_i32 v101, v85
    v_cvt_f32_i32 v102, v86
    v_cvt_f32_i32 v103, v87
    buffer_load_dwordx4 v[80:83], v1, s[28:31], s71 offen offset:256 nt
    v_fmac_f32_dpp v160, v170, v100 row_newbcast:6 row_mask:0xf bank_mask:0xf
    v_fmac_f32_dpp v161, v170, v101 row_newbcast:6 row_mask:0xf bank_mask:0xf
    v_fmac_f32_dpp v162, v170, v102 row_newbcast:6 row_mask:0xf bank_mask:0xf
    v_fmac_f32_dpp v163, v170, v103 row_newbcast:6 row_mask:0xf bank_mask:0xf
    s_waitcnt vmcnt(22)
    v_cvt_f32_i32 v104, v88
    v_cvt_f32_i32 v105, v89
    v_cvt_f32_i32 v106, v90
    v_cvt_f32_i32 v107, v91
    buffer_load_dwordx4 v[84:87], v1, s[28:31], s71 offen offset:512 nt
    v_fmac_f32_dpp v152, v170, v104 row_newbcast:14 row_mask:0xf bank_mask:0xf
    v_fmac_f32_dpp v153, v170, v105 row_newbcast:14 row_mask:0xf bank_mask:0xf
    v_fmac_f32_dpp v154, v170, v106 row_newbcast:14 row_mask:0xf bank_mask:0xf
    v_fmac_f32_dpp v155, v170, v107 row_newbcast:14 row_mask:0xf bank_mask:0xf
    s_waitcnt vmcnt(22)
    v_cvt_f32_i32 v100, v92
    v_cvt_f32_i32 v101, v93
    v_cvt_f32_i32 v102, v94
    v_cvt_f32_i32 v103, v95
    s_add_u32 s71, s71, 3072
    buffer_load_dwordx4 v[88:91], v1, s[28:31], s71 offen offset:0 nt
    v_fmac_f32_dpp v156, v170, v100 row_newbcast:14 row_mask:0xf bank_mask:0xf
    v_fmac_f32_dpp v157, v170, v101 row_newbcast:14 row_mask:0xf bank_mask:0xf
    v_fmac_f32_dpp v158, v170, v102 row_newbcast:14 row_mask:0xf bank_mask:0xf
    v_fmac_f32_dpp v159, v170, v103 row_newbcast:14 row_mask:0xf bank_mask:0xf
    s_waitcnt vmcnt(22)
    v_cvt_f32_i32 v104, v96
    v_cvt_f32_i32 v105, v97
    v_cvt_f32_i32 v106, v98
    v_cvt_f32_i32 v107, v99
    buffer_load_dwordx4 v[92:95], v1, s[28:31], s71 offen offset:256 nt
    v_fmac_f32_dpp v160, v170, v104 row_newbcast:14 row_mask:0xf bank_mask:0xf
    v_fmac_f32_dpp v161, v170, v105 row_newbcast:14 row_mask:0xf bank_mask:0xf
    v_fmac_f32_dpp v162, v170, v106 row_newbcast:14 row_mask:0xf bank_mask:0xf
    v_fmac_f32_dpp v163, v170, v107 row_newbcast:14 row_mask:0xf bank_mask:0xf
    s_waitcnt vmcnt(22)
    v_cvt_f32_i32 v100, v4
    v_cvt_f32_i32 v101, v5
    v_cvt_f32_i32 v102, v6
    v_cvt_f32_i32 v103, v7
    buffer_load_dwordx4 v[96:99], v1, s[28:31], s71 offen offset:512 nt
    v_fmac_f32_dpp v152, v170, v100 row_newbcast:1 row_mask:0xf bank_mask:0xf
    v_fmac_f32_dpp v153, v170, v101 row_newbcast:1 row_mask:0xf bank_mask:0xf
    v_fmac_f32_dpp v154, v170, v102 row_newbcast:1 row_mask:0xf bank_mask:0xf
    v_fmac_f32_dpp v155, v170, v103 row_newbcast:1 row_mask:0xf bank_mask:0xf
L_tagw:
    ds_read_b32 v175, v188 offset:139
    s_waitcnt lgkmcnt(0)
    v_readfirstlane_b32 s93, v175
    s_cmp_eq_u32 s93, 0
    s_cbranch_scc1 L_tagw
    s_and_b32 s80, s2, 7
    s_lshr_b32 s81, s80, 3
    s_and_b32 s80, s80, 7
    s_mul_i32 s56, s81, 64
    s_add_u32 s56, s56, s80
    s_add_u32 s56, s56, s94
    s_and_b32 s56, s56, 511
    s_mov_b32 s57, s59
    s_add_u32 s70, s57, s56
    s_and_b32 s95, s2, 0xf8
    s_add_u32 s95, s95, s80
    s_lshl_b32 s95, s95, 3
    s_add_u32 s95, s95, s81
    s_lshl_b32 s95, s95, 8
    s_add_u32 s95, s95, 18874368
    s_waitcnt vmcnt(22)
    v_cvt_f32_i32 v104, v8
    v_cvt_f32_i32 v105, v9
    v_cvt_f32_i32 v106, v10
    v_cvt_f32_i32 v107, v11
    s_lshl_b32 s73, s70, 7
    buffer_load_dword v171, v172, s[52:55], s95 offen sc0 sc1
    buffer_load_ushort v168, v3, s[40:43], s73 offen
    buffer_load_ushort v169, v3, s[44:47], s73 offen
    s_mul_i32 s71, s70, 49152
    buffer_load_dwordx4 v[4:7], v1, s[28:31], s71 offen offset:0 nt
    v_fmac_f32_dpp v156, v170, v104 row_newbcast:1 row_mask:0xf bank_mask:0xf
    v_fmac_f32_dpp v157, v170, v105 row_newbcast:1 row_mask:0xf bank_mask:0xf
    v_fmac_f32_dpp v158, v170, v106 row_newbcast:1 row_mask:0xf bank_mask:0xf
    v_fmac_f32_dpp v159, v170, v107 row_newbcast:1 row_mask:0xf bank_mask:0xf
    s_waitcnt vmcnt(25)
    v_cvt_f32_i32 v100, v12
    v_cvt_f32_i32 v101, v13
    v_cvt_f32_i32 v102, v14
    v_cvt_f32_i32 v103, v15
    buffer_load_dwordx4 v[8:11], v1, s[28:31], s71 offen offset:256 nt
    v_fmac_f32_dpp v160, v170, v100 row_newbcast:1 row_mask:0xf bank_mask:0xf
    v_fmac_f32_dpp v161, v170, v101 row_newbcast:1 row_mask:0xf bank_mask:0xf
    v_fmac_f32_dpp v162, v170, v102 row_newbcast:1 row_mask:0xf bank_mask:0xf
    v_fmac_f32_dpp v163, v170, v103 row_newbcast:1 row_mask:0xf bank_mask:0xf
    s_waitcnt vmcnt(25)
    v_cvt_f32_i32 v104, v16
    v_cvt_f32_i32 v105, v17
    v_cvt_f32_i32 v106, v18
    v_cvt_f32_i32 v107, v19
    buffer_load_dwordx4 v[12:15], v1, s[28:31], s71 offen offset:512 nt
    v_fmac_f32_dpp v152, v170, v104 row_newbcast:9 row_mask:0xf bank_mask:0xf
    v_fmac_f32_dpp v153, v170, v105 row_newbcast:9 row_mask:0xf bank_mask:0xf
    v_fmac_f32_dpp v154, v170, v106 row_newbcast:9 row_mask:0xf bank_mask:0xf
    v_fmac_f32_dpp v155, v170, v107 row_newbcast:9 row_mask:0xf bank_mask:0xf
    s_waitcnt vmcnt(25)
    v_cvt_f32_i32 v100, v20
    v_cvt_f32_i32 v101, v21
    v_cvt_f32_i32 v102, v22
    v_cvt_f32_i32 v103, v23
    s_add_u32 s71, s71, 3072
    buffer_load_dwordx4 v[16:19], v1, s[28:31], s71 offen offset:0 nt
    v_fmac_f32_dpp v156, v170, v100 row_newbcast:9 row_mask:0xf bank_mask:0xf
    v_fmac_f32_dpp v157, v170, v101 row_newbcast:9 row_mask:0xf bank_mask:0xf
    v_fmac_f32_dpp v158, v170, v102 row_newbcast:9 row_mask:0xf bank_mask:0xf
    v_fmac_f32_dpp v159, v170, v103 row_newbcast:9 row_mask:0xf bank_mask:0xf
    s_waitcnt vmcnt(25)
    v_cvt_f32_i32 v104, v24
    v_cvt_f32_i32 v105, v25
    v_cvt_f32_i32 v106, v26
    v_cvt_f32_i32 v107, v27
    buffer_load_dwordx4 v[20:23], v1, s[28:31], s71 offen offset:256 nt
    v_fmac_f32_dpp v160, v170, v104 row_newbcast:9 row_mask:0xf bank_mask:0xf
    v_fmac_f32_dpp v161, v170, v105 row_newbcast:9 row_mask:0xf bank_mask:0xf
    v_fmac_f32_dpp v162, v170, v106 row_newbcast:9 row_mask:0xf bank_mask:0xf
    v_fmac_f32_dpp v163, v170, v107 row_newbcast:9 row_mask:0xf bank_mask:0xf
    s_waitcnt vmcnt(25)
    v_cvt_f32_i32 v100, v28
    v_cvt_f32_i32 v101, v29
    v_cvt_f32_i32 v102, v30
    v_cvt_f32_i32 v103, v31
    buffer_load_dwordx4 v[24:27], v1, s[28:31], s71 offen offset:512 nt
    v_fmac_f32_dpp v152, v170, v100 row_newbcast:5 row_mask:0xf bank_mask:0xf
    v_fmac_f32_dpp v153, v170, v101 row_newbcast:5 row_mask:0xf bank_mask:0xf
    v_fmac_f32_dpp v154, v170, v102 row_newbcast:5 row_mask:0xf bank_mask:0xf
    v_fmac_f32_dpp v155, v170, v103 row_newbcast:5 row_mask:0xf bank_mask:0xf
    s_waitcnt vmcnt(25)
    v_cvt_f32_i32 v104, v32
    v_cvt_f32_i32 v105, v33
    v_cvt_f32_i32 v106, v34
    v_cvt_f32_i32 v107, v35
    s_add_u32 s71, s71, 3072
    buffer_load_dwordx4 v[28:31], v1, s[28:31], s71 offen offset:0 nt
    v_fmac_f32_dpp v156, v170, v104 row_newbcast:5 row_mask:0xf bank_mask:0xf
    v_fmac_f32_dpp v157, v170, v105 row_newbcast:5 row_mask:0xf bank_mask:0xf
    v_fmac_f32_dpp v158, v170, v106 row_newbcast:5 row_mask:0xf bank_mask:0xf
    v_fmac_f32_dpp v159, v170, v107 row_newbcast:5 row_mask:0xf bank_mask:0xf
    s_waitcnt vmcnt(25)
    v_cvt_f32_i32 v100, v36
    v_cvt_f32_i32 v101, v37
    v_cvt_f32_i32 v102, v38
    v_cvt_f32_i32 v103, v39
    buffer_load_dwordx4 v[32:35], v1, s[28:31], s71 offen offset:256 nt
    v_fmac_f32_dpp v160, v170, v100 row_newbcast:5 row_mask:0xf bank_mask:0xf
    v_fmac_f32_dpp v161, v170, v101 row_newbcast:5 row_mask:0xf bank_mask:0xf
    v_fmac_f32_dpp v162, v170, v102 row_newbcast:5 row_mask:0xf bank_mask:0xf
    v_fmac_f32_dpp v163, v170, v103 row_newbcast:5 row_mask:0xf bank_mask:0xf
    s_waitcnt vmcnt(25)
    v_cvt_f32_i32 v104, v40
    v_cvt_f32_i32 v105, v41
    v_cvt_f32_i32 v106, v42
    v_cvt_f32_i32 v107, v43
    buffer_load_dwordx4 v[36:39], v1, s[28:31], s71 offen offset:512 nt
    v_fmac_f32_dpp v152, v170, v104 row_newbcast:13 row_mask:0xf bank_mask:0xf
    v_fmac_f32_dpp v153, v170, v105 row_newbcast:13 row_mask:0xf bank_mask:0xf
    v_fmac_f32_dpp v154, v170, v106 row_newbcast:13 row_mask:0xf bank_mask:0xf
    v_fmac_f32_dpp v155, v170, v107 row_newbcast:13 row_mask:0xf bank_mask:0xf
    s_waitcnt vmcnt(25)
    v_cvt_f32_i32 v100, v44
    v_cvt_f32_i32 v101, v45
    v_cvt_f32_i32 v102, v46
    v_cvt_f32_i32 v103, v47
    s_add_u32 s71, s71, 3072
    buffer_load_dwordx4 v[40:43], v1, s[28:31], s71 offen offset:0 nt
    v_fmac_f32_dpp v156, v170, v100 row_newbcast:13 row_mask:0xf bank_mask:0xf
    v_fmac_f32_dpp v157, v170, v101 row_newbcast:13 row_mask:0xf bank_mask:0xf
    v_fmac_f32_dpp v158, v170, v102 row_newbcast:13 row_mask:0xf bank_mask:0xf
    v_fmac_f32_dpp v159, v170, v103 row_newbcast:13 row_mask:0xf bank_mask:0xf
    s_waitcnt vmcnt(25)
    v_cvt_f32_i32 v104, v48
    v_cvt_f32_i32 v105, v49
    v_cvt_f32_i32 v106, v50
    v_cvt_f32_i32 v107, v51
    buffer_load_dwordx4 v[44:47], v1, s[28:31], s71 offen offset:256 nt
    v_fmac_f32_dpp v160, v170, v104 row_newbcast:13 row_mask:0xf bank_mask:0xf
    v_fmac_f32_dpp v161, v170, v105 row_newbcast:13 row_mask:0xf bank_mask:0xf
    v_fmac_f32_dpp v162, v170, v106 row_newbcast:13 row_mask:0xf bank_mask:0xf
    v_fmac_f32_dpp v163, v170, v107 row_newbcast:13 row_mask:0xf bank_mask:0xf
    s_waitcnt vmcnt(25)
    v_cvt_f32_i32 v100, v52
    v_cvt_f32_i32 v101, v53
    v_cvt_f32_i32 v102, v54
    v_cvt_f32_i32 v103, v55
    buffer_load_dwordx4 v[48:51], v1, s[28:31], s71 offen offset:512 nt
    v_fmac_f32_dpp v152, v170, v100 row_newbcast:3 row_mask:0xf bank_mask:0xf
    v_fmac_f32_dpp v153, v170, v101 row_newbcast:3 row_mask:0xf bank_mask:0xf
    v_fmac_f32_dpp v154, v170, v102 row_newbcast:3 row_mask:0xf bank_mask:0xf
    v_fmac_f32_dpp v155, v170, v103 row_newbcast:3 row_mask:0xf bank_mask:0xf
    s_waitcnt vmcnt(25)
    v_cvt_f32_i32 v104, v56
    v_cvt_f32_i32 v105, v57
    v_cvt_f32_i32 v106, v58
    v_cvt_f32_i32 v107, v59
    s_add_u32 s71, s71, 3072
    buffer_load_dwordx4 v[52:55], v1, s[28:31], s71 offen offset:0 nt
    v_fmac_f32_dpp v156, v170, v104 row_newbcast:3 row_mask:0xf bank_mask:0xf
    v_fmac_f32_dpp v157, v170, v105 row_newbcast:3 row_mask:0xf bank_mask:0xf
    v_fmac_f32_dpp v158, v170, v106 row_newbcast:3 row_mask:0xf bank_mask:0xf
    v_fmac_f32_dpp v159, v170, v107 row_newbcast:3 row_mask:0xf bank_mask:0xf
    s_waitcnt vmcnt(25)
    v_cvt_f32_i32 v100, v60
    v_cvt_f32_i32 v101, v61
    v_cvt_f32_i32 v102, v62
    v_cvt_f32_i32 v103, v63
    buffer_load_dwordx4 v[56:59], v1, s[28:31], s71 offen offset:256 nt
    v_fmac_f32_dpp v160, v170, v100 row_newbcast:3 row_mask:0xf bank_mask:0xf
    v_fmac_f32_dpp v161, v170, v101 row_newbcast:3 row_mask:0xf bank_mask:0xf
    v_fmac_f32_dpp v162, v170, v102 row_newbcast:3 row_mask:0xf bank_mask:0xf
    v_fmac_f32_dpp v163, v170, v103 row_newbcast:3 row_mask:0xf bank_mask:0xf
    s_waitcnt vmcnt(25)
    v_cvt_f32_i32 v104, v64
    v_cvt_f32_i32 v105, v65
    v_cvt_f32_i32 v106, v66
    v_cvt_f32_i32 v107, v67
    buffer_load_dwordx4 v[60:63], v1, s[28:31], s71 offen offset:512 nt
    v_fmac_f32_dpp v152, v170, v104 row_newbcast:11 row_mask:0xf bank_mask:0xf
    v_fmac_f32_dpp v153, v170, v105 row_newbcast:11 row_mask:0xf bank_mask:0xf
    v_fmac_f32_dpp v154, v170, v106 row_newbcast:11 row_mask:0xf bank_mask:0xf
    v_fmac_f32_dpp v155, v170, v107 row_newbcast:11 row_mask:0xf bank_mask:0xf
    s_waitcnt vmcnt(25)
    v_cvt_f32_i32 v100, v68
    v_cvt_f32_i32 v101, v69
    v_cvt_f32_i32 v102, v70
    v_cvt_f32_i32 v103, v71
    s_add_u32 s71, s71, 3072
    buffer_load_dwordx4 v[64:67], v1, s[28:31], s71 offen offset:0 nt
    v_fmac_f32_dpp v156, v170, v100 row_newbcast:11 row_mask:0xf bank_mask:0xf
    v_fmac_f32_dpp v157, v170, v101 row_newbcast:11 row_mask:0xf bank_mask:0xf
    v_fmac_f32_dpp v158, v170, v102 row_newbcast:11 row_mask:0xf bank_mask:0xf
    v_fmac_f32_dpp v159, v170, v103 row_newbcast:11 row_mask:0xf bank_mask:0xf
    s_waitcnt vmcnt(25)
    v_cvt_f32_i32 v104, v72
    v_cvt_f32_i32 v105, v73
    v_cvt_f32_i32 v106, v74
    v_cvt_f32_i32 v107, v75
    buffer_load_dwordx4 v[68:71], v1, s[28:31], s71 offen offset:256 nt
    v_fmac_f32_dpp v160, v170, v104 row_newbcast:11 row_mask:0xf bank_mask:0xf
    v_fmac_f32_dpp v161, v170, v105 row_newbcast:11 row_mask:0xf bank_mask:0xf
    v_fmac_f32_dpp v162, v170, v106 row_newbcast:11 row_mask:0xf bank_mask:0xf
    v_fmac_f32_dpp v163, v170, v107 row_newbcast:11 row_mask:0xf bank_mask:0xf
    s_waitcnt vmcnt(25)
    v_cvt_f32_i32 v100, v76
    v_cvt_f32_i32 v101, v77
    v_cvt_f32_i32 v102, v78
    v_cvt_f32_i32 v103, v79
    buffer_load_dwordx4 v[72:75], v1, s[28:31], s71 offen offset:512 nt
    v_fmac_f32_dpp v152, v170, v100 row_newbcast:7 row_mask:0xf bank_mask:0xf
    v_fmac_f32_dpp v153, v170, v101 row_newbcast:7 row_mask:0xf bank_mask:0xf
    v_fmac_f32_dpp v154, v170, v102 row_newbcast:7 row_mask:0xf bank_mask:0xf
    v_fmac_f32_dpp v155, v170, v103 row_newbcast:7 row_mask:0xf bank_mask:0xf
    s_waitcnt vmcnt(25)
    v_cvt_f32_i32 v104, v80
    v_cvt_f32_i32 v105, v81
    v_cvt_f32_i32 v106, v82
    v_cvt_f32_i32 v107, v83
    s_add_u32 s71, s71, 3072
    buffer_load_dwordx4 v[76:79], v1, s[28:31], s71 offen offset:0 nt
    v_fmac_f32_dpp v156, v170, v104 row_newbcast:7 row_mask:0xf bank_mask:0xf
    v_fmac_f32_dpp v157, v170, v105 row_newbcast:7 row_mask:0xf bank_mask:0xf
    v_fmac_f32_dpp v158, v170, v106 row_newbcast:7 row_mask:0xf bank_mask:0xf
    v_fmac_f32_dpp v159, v170, v107 row_newbcast:7 row_mask:0xf bank_mask:0xf
    s_waitcnt vmcnt(25)
    v_cvt_f32_i32 v100, v84
    v_cvt_f32_i32 v101, v85
    v_cvt_f32_i32 v102, v86
    v_cvt_f32_i32 v103, v87
    buffer_load_dwordx4 v[80:83], v1, s[28:31], s71 offen offset:256 nt
    v_fmac_f32_dpp v160, v170, v100 row_newbcast:7 row_mask:0xf bank_mask:0xf
    v_fmac_f32_dpp v161, v170, v101 row_newbcast:7 row_mask:0xf bank_mask:0xf
    v_fmac_f32_dpp v162, v170, v102 row_newbcast:7 row_mask:0xf bank_mask:0xf
    v_fmac_f32_dpp v163, v170, v103 row_newbcast:7 row_mask:0xf bank_mask:0xf
    s_waitcnt vmcnt(25)
    v_cvt_f32_i32 v104, v88
    v_cvt_f32_i32 v105, v89
    v_cvt_f32_i32 v106, v90
    v_cvt_f32_i32 v107, v91
    buffer_load_dwordx4 v[84:87], v1, s[28:31], s71 offen offset:512 nt
    v_fmac_f32_dpp v152, v170, v104 row_newbcast:15 row_mask:0xf bank_mask:0xf
    v_fmac_f32_dpp v153, v170, v105 row_newbcast:15 row_mask:0xf bank_mask:0xf
    v_fmac_f32_dpp v154, v170, v106 row_newbcast:15 row_mask:0xf bank_mask:0xf
    v_fmac_f32_dpp v155, v170, v107 row_newbcast:15 row_mask:0xf bank_mask:0xf
    s_waitcnt vmcnt(25)
    v_cvt_f32_i32 v100, v92
    v_cvt_f32_i32 v101, v93
    v_cvt_f32_i32 v102, v94
    v_cvt_f32_i32 v103, v95
    s_add_u32 s71, s71, 3072
    buffer_load_dwordx4 v[88:91], v1, s[28:31], s71 offen offset:0 nt
    v_fmac_f32_dpp v156, v170, v100 row_newbcast:15 row_mask:0xf bank_mask:0xf
    v_fmac_f32_dpp v157, v170, v101 row_newbcast:15 row_mask:0xf bank_mask:0xf
    v_fmac_f32_dpp v158, v170, v102 row_newbcast:15 row_mask:0xf bank_mask:0xf
    v_fmac_f32_dpp v159, v170, v103 row_newbcast:15 row_mask:0xf bank_mask:0xf
    s_waitcnt vmcnt(25)
    v_cvt_f32_i32 v104, v96
    v_cvt_f32_i32 v105, v97
    v_cvt_f32_i32 v106, v98
    v_cvt_f32_i32 v107, v99
    buffer_load_dwordx4 v[92:95], v1, s[28:31], s71 offen offset:256 nt
    v_fmac_f32_dpp v160, v170, v104 row_newbcast:15 row_mask:0xf bank_mask:0xf
    v_fmac_f32_dpp v161, v170, v105 row_newbcast:15 row_mask:0xf bank_mask:0xf
    v_fmac_f32_dpp v162, v170, v106 row_newbcast:15 row_mask:0xf bank_mask:0xf
    v_fmac_f32_dpp v163, v170, v107 row_newbcast:15 row_mask:0xf bank_mask:0xf
    s_sub_u32 s77, s77, 1
    s_cmp_lg_u32 s77, 0
    s_cbranch_scc1 L_nofl3
    s_nop 0
    v_add_f32_dpp v166, v166, v166 row_ror:8 row_mask:0xf bank_mask:0xf
    v_add_f32_dpp v167, v167, v167 row_ror:8 row_mask:0xf bank_mask:0xf
    s_nop 0
    v_add_f32_dpp v166, v166, v166 row_ror:4 row_mask:0xf bank_mask:0xf
    v_add_f32_dpp v167, v167, v167 row_ror:4 row_mask:0xf bank_mask:0xf
    s_nop 0
    v_add_f32_dpp v166, v166, v166 row_ror:2 row_mask:0xf bank_mask:0xf
    v_add_f32_dpp v167, v167, v167 row_ror:2 row_mask:0xf bank_mask:0xf
    s_nop 0
    v_add_f32_dpp v166, v166, v166 row_ror:1 row_mask:0xf bank_mask:0xf
    v_add_f32_dpp v167, v167, v167 row_ror:1 row_mask:0xf bank_mask:0xf
    v_mov_b32 v182, v165
    v_mov_b32 v183, v165
    s_nop 1
    v_permlane32_swap_b32 v182, v183
    s_nop 1
    v_max_f32 v182, v182, v183
    v_mov_b32 v183, v182
    s_nop 1
    v_permlane16_swap_b32 v182, v183
    s_nop 1
    v_max_f32 v182, v182, v183
    v_sub_f32 v183, v165, v182
    v_exp_f32 v183, v183
    v_mov_b32 v104, v182
    v_mul_f32 v166, v166, v183
    v_mul_f32 v167, v167, v183
    v_fma_f32 v152, v152, v183, -v167
    v_fma_f32 v153, v153, v183, -v167
    v_fma_f32 v154, v154, v183, -v167
    v_fma_f32 v155, v155, v183, -v167
    v_fma_f32 v156, v156, v183, -v167
    v_fma_f32 v157, v157, v183, -v167
    v_fma_f32 v158, v158, v183, -v167
    v_fma_f32 v159, v159, v183, -v167
    v_fma_f32 v160, v160, v183, -v167
    v_fma_f32 v161, v161, v183, -v167
    v_fma_f32 v162, v162, v183, -v167
    v_fma_f32 v163, v163, v183, -v167
    v_mov_b32 v182, v166
    s_nop 1
    v_permlane32_swap_b32 v166, v182
    v_permlane32_swap_b32 v152, v154
    v_permlane32_swap_b32 v153, v155
    v_permlane32_swap_b32 v156, v158
    v_permlane32_swap_b32 v157, v159
    v_permlane32_swap_b32 v160, v162
    v_permlane32_swap_b32 v161, v163
    s_nop 1
    v_add_f32 v166, v166, v182
    v_add_f32 v152, v152, v154
    v_add_f32 v153, v153, v155
    v_add_f32 v156, v156, v158
    v_add_f32 v157, v157, v159
    v_add_f32 v160, v160, v162
    v_add_f32 v161, v161, v163
    v_mov_b32 v182, v166
    s_nop 1
    v_permlane16_swap_b32 v166, v182
    v_permlane16_swap_b32 v152, v153
    v_permlane16_swap_b32 v156, v157
    v_permlane16_swap_b32 v160, v161
    s_nop 1
    v_add_f32 v105, v166, v182
    v_add_f32 v100, v152, v153
    v_add_f32 v101, v156, v157
    v_add_f32 v102, v160, v161
    v_cndmask_b32 v103, v104, v105, s[66:67]
    ds_write_b128 v186, v[100:103] offset:768
    v_mov_b32 v165, 0xf149f2ca
    v_mov_b32 v166, 0
    v_mov_b32 v167, 0
    v_mov_b32 v152, 0
    v_mov_b32 v153, 0
    v_mov_b32 v154, 0
    v_mov_b32 v155, 0
    v_mov_b32 v156, 0
    v_mov_b32 v157, 0
    v_mov_b32 v158, 0
    v_mov_b32 v159, 0
    v_mov_b32 v160, 0
    v_mov_b32 v161, 0
    v_mov_b32 v162, 0
    v_mov_b32 v163, 0
    s_waitcnt lgkmcnt(0)
    s_mov_b64 exec, 1
    ds_add_u32 v187, v188
    s_mov_b64 exec, -1
    v_add_u32 v186, 1024, v186
    v_add_u32 v187, 4, v187
    s_mov_b32 s77, 8
L_nofl3:
L_dloop:
    s_waitcnt vmcnt(23)
    v_lshlrev_b32 v168, 16, v168
    v_lshlrev_b32 v169, 16, v169
    v_max_f32_dpp v182, v171, v171 row_ror:8 row_mask:0xf bank_mask:0xf
    s_nop 1
    v_max_f32_dpp v182, v182, v182 row_ror:4 row_mask:0xf bank_mask:0xf
    s_nop 1
    v_max_f32_dpp v182, v182, v182 row_ror:2 row_mask:0xf bank_mask:0xf
    s_nop 1
    v_max_f32_dpp v182, v182, v182 row_ror:1 row_mask:0xf bank_mask:0xf
    v_max_f32 v182, v182, v165
    v_sub_f32 v183, v165, v182
    v_sub_f32 v170, v171, v182
    v_exp_f32 v183, v183
    v_exp_f32 v170, v170
    v_mov_b32 v165, v182
    v_fma_f32 v166, v166, v183, v170
    v_mul_f32 v170, v170, v168
    v_mul_f32 v167, v167, v183
    v_fmac_f32 v167, v170, v169
    v_mul_f32 v152, v152, v183
    v_mul_f32 v153, v153, v183
    v_mul_f32 v154, v154, v183
    v_mul_f32 v155, v155, v183
    v_mul_f32 v156, v156, v183
    v_mul_f32 v157, v157, v183
    v_mul_f32 v158, v158, v183
    v_mul_f32 v159, v159, v183
    v_mul_f32 v160, v160, v183
    v_mul_f32 v161, v161, v183
    v_mul_f32 v162, v162, v183
    v_mul_f32 v163, v163, v183
    s_waitcnt vmcnt(22)
    v_cvt_f32_i32 v100, v4
    v_cvt_f32_i32 v101, v5
    v_cvt_f32_i32 v102, v6
    v_cvt_f32_i32 v103, v7
    buffer_load_dwordx4 v[96:99], v1, s[28:31], s71 offen offset:512 nt
    v_fmac_f32_dpp v152, v170, v100 row_newbcast:0 row_mask:0xf bank_mask:0xf
    v_fmac_f32_dpp v153, v170, v101 row_newbcast:0 row_mask:0xf bank_mask:0xf
    v_fmac_f32_dpp v154, v170, v102 row_newbcast:0 row_mask:0xf bank_mask:0xf
    v_fmac_f32_dpp v155, v170, v103 row_newbcast:0 row_mask:0xf bank_mask:0xf
    s_waitcnt vmcnt(22)
    v_cvt_f32_i32 v104, v8
    v_cvt_f32_i32 v105, v9
    v_cvt_f32_i32 v106, v10
    v_cvt_f32_i32 v107, v11
    s_add_u32 s71, s71, 3072
    buffer_load_dwordx4 v[4:7], v1, s[28:31], s71 offen offset:0 nt
    v_fmac_f32_dpp v156, v170, v104 row_newbcast:0 row_mask:0xf bank_mask:0xf
    v_fmac_f32_dpp v157, v170, v105 row_newbcast:0 row_mask:0xf bank_mask:0xf
    v_fmac_f32_dpp v158, v170, v106 row_newbcast:0 row_mask:0xf bank_mask:0xf
    v_fmac_f32_dpp v159, v170, v107 row_newbcast:0 row_mask:0xf bank_mask:0xf
    s_waitcnt vmcnt(22)
    v_cvt_f32_i32 v100, v12
    v_cvt_f32_i32 v101, v13
    v_cvt_f32_i32 v102, v14
    v_cvt_f32_i32 v103, v15
    buffer_load_dwordx4 v[8:11], v1, s[28:31], s71 offen offset:256 nt
    v_fmac_f32_dpp v160, v170, v100 row_newbcast:0 row_mask:0xf bank_mask:0xf
    v_fmac_f32_dpp v161, v170, v101 row_newbcast:0 row_mask:0xf bank_mask:0xf
    v_fmac_f32_dpp v162, v170, v102 row_newbcast:0 row_mask:0xf bank_mask:0xf
    v_fmac_f32_dpp v163, v170, v103 row_newbcast:0 row_mask:0xf bank_mask:0xf
    s_waitcnt vmcnt(22)
    v_cvt_f32_i32 v104, v16
    v_cvt_f32_i32 v105, v17
    v_cvt_f32_i32 v106, v18
    v_cvt_f32_i32 v107, v19
    buffer_load_dwordx4 v[12:15], v1, s[28:31], s71 offen offset:512 nt
    v_fmac_f32_dpp v152, v170, v104 row_newbcast:8 row_mask:0xf bank_mask:0xf
    v_fmac_f32_dpp v153, v170, v105 row_newbcast:8 row_mask:0xf bank_mask:0xf
    v_fmac_f32_dpp v154, v170, v106 row_newbcast:8 row_mask:0xf bank_mask:0xf
    v_fmac_f32_dpp v155, v170, v107 row_newbcast:8 row_mask:0xf bank_mask:0xf
    s_mov_b64 exec, 1
    ds_max_u32 v188, v173 offset:131
    s_mov_b64 exec, -1
    v_add_u32 v173, 1, v173
    s_waitcnt vmcnt(22)
    v_cvt_f32_i32 v100, v20
    v_cvt_f32_i32 v101, v21
    v_cvt_f32_i32 v102, v22
    v_cvt_f32_i32 v103, v23
    s_add_u32 s71, s71, 3072
    buffer_load_dwordx4 v[16:19], v1, s[28:31], s71 offen offset:0 nt
    v_fmac_f32_dpp v156, v170, v100 row_newbcast:8 row_mask:0xf bank_mask:0xf
    v_fmac_f32_dpp v157, v170, v101 row_newbcast:8 row_mask:0xf bank_mask:0xf
    v_fmac_f32_dpp v158, v170, v102 row_newbcast:8 row_mask:0xf bank_mask:0xf
    v_fmac_f32_dpp v159, v170, v103 row_newbcast:8 row_mask:0xf bank_mask:0xf
    s_waitcnt vmcnt(22)
    v_cvt_f32_i32 v104, v24
    v_cvt_f32_i32 v105, v25
    v_cvt_f32_i32 v106, v26
    v_cvt_f32_i32 v107, v27
    buffer_load_dwordx4 v[20:23], v1, s[28:31], s71 offen offset:256 nt
    v_fmac_f32_dpp v160, v170, v104 row_newbcast:8 row_mask:0xf bank_mask:0xf
    v_fmac_f32_dpp v161, v170, v105 row_newbcast:8 row_mask:0xf bank_mask:0xf
    v_fmac_f32_dpp v162, v170, v106 row_newbcast:8 row_mask:0xf bank_mask:0xf
    v_fmac_f32_dpp v163, v170, v107 row_newbcast:8 row_mask:0xf bank_mask:0xf
    s_waitcnt vmcnt(22)
    v_cvt_f32_i32 v100, v28
    v_cvt_f32_i32 v101, v29
    v_cvt_f32_i32 v102, v30
    v_cvt_f32_i32 v103, v31
    buffer_load_dwordx4 v[24:27], v1, s[28:31], s71 offen offset:512 nt
    v_fmac_f32_dpp v152, v170, v100 row_newbcast:4 row_mask:0xf bank_mask:0xf
    v_fmac_f32_dpp v153, v170, v101 row_newbcast:4 row_mask:0xf bank_mask:0xf
    v_fmac_f32_dpp v154, v170, v102 row_newbcast:4 row_mask:0xf bank_mask:0xf
    v_fmac_f32_dpp v155, v170, v103 row_newbcast:4 row_mask:0xf bank_mask:0xf
    s_waitcnt vmcnt(22)
    v_cvt_f32_i32 v104, v32
    v_cvt_f32_i32 v105, v33
    v_cvt_f32_i32 v106, v34
    v_cvt_f32_i32 v107, v35
    s_add_u32 s71, s71, 3072
    buffer_load_dwordx4 v[28:31], v1, s[28:31], s71 offen offset:0 nt
    v_fmac_f32_dpp v156, v170, v104 row_newbcast:4 row_mask:0xf bank_mask:0xf
    v_fmac_f32_dpp v157, v170, v105 row_newbcast:4 row_mask:0xf bank_mask:0xf
    v_fmac_f32_dpp v158, v170, v106 row_newbcast:4 row_mask:0xf bank_mask:0xf
    v_fmac_f32_dpp v159, v170, v107 row_newbcast:4 row_mask:0xf bank_mask:0xf
    s_waitcnt vmcnt(22)
    v_cvt_f32_i32 v100, v36
    v_cvt_f32_i32 v101, v37
    v_cvt_f32_i32 v102, v38
    v_cvt_f32_i32 v103, v39
    buffer_load_dwordx4 v[32:35], v1, s[28:31], s71 offen offset:256 nt
    v_fmac_f32_dpp v160, v170, v100 row_newbcast:4 row_mask:0xf bank_mask:0xf
    v_fmac_f32_dpp v161, v170, v101 row_newbcast:4 row_mask:0xf bank_mask:0xf
    v_fmac_f32_dpp v162, v170, v102 row_newbcast:4 row_mask:0xf bank_mask:0xf
    v_fmac_f32_dpp v163, v170, v103 row_newbcast:4 row_mask:0xf bank_mask:0xf
    s_waitcnt vmcnt(22)
    v_cvt_f32_i32 v104, v40
    v_cvt_f32_i32 v105, v41
    v_cvt_f32_i32 v106, v42
    v_cvt_f32_i32 v107, v43
    buffer_load_dwordx4 v[36:39], v1, s[28:31], s71 offen offset:512 nt
    v_fmac_f32_dpp v152, v170, v104 row_newbcast:12 row_mask:0xf bank_mask:0xf
    v_fmac_f32_dpp v153, v170, v105 row_newbcast:12 row_mask:0xf bank_mask:0xf
    v_fmac_f32_dpp v154, v170, v106 row_newbcast:12 row_mask:0xf bank_mask:0xf
    v_fmac_f32_dpp v155, v170, v107 row_newbcast:12 row_mask:0xf bank_mask:0xf
    s_waitcnt vmcnt(22)
    v_cvt_f32_i32 v100, v44
    v_cvt_f32_i32 v101, v45
    v_cvt_f32_i32 v102, v46
    v_cvt_f32_i32 v103, v47
    s_add_u32 s71, s71, 3072
    buffer_load_dwordx4 v[40:43], v1, s[28:31], s71 offen offset:0 nt
    v_fmac_f32_dpp v156, v170, v100 row_newbcast:12 row_mask:0xf bank_mask:0xf
    v_fmac_f32_dpp v157, v170, v101 row_newbcast:12 row_mask:0xf bank_mask:0xf
    v_fmac_f32_dpp v158, v170, v102 row_newbcast:12 row_mask:0xf bank_mask:0xf
    v_fmac_f32_dpp v159, v170, v103 row_newbcast:12 row_mask:0xf bank_mask:0xf
    s_waitcnt vmcnt(22)
    v_cvt_f32_i32 v104, v48
    v_cvt_f32_i32 v105, v49
    v_cvt_f32_i32 v106, v50
    v_cvt_f32_i32 v107, v51
    buffer_load_dwordx4 v[44:47], v1, s[28:31], s71 offen offset:256 nt
    v_fmac_f32_dpp v160, v170, v104 row_newbcast:12 row_mask:0xf bank_mask:0xf
    v_fmac_f32_dpp v161, v170, v105 row_newbcast:12 row_mask:0xf bank_mask:0xf
    v_fmac_f32_dpp v162, v170, v106 row_newbcast:12 row_mask:0xf bank_mask:0xf
    v_fmac_f32_dpp v163, v170, v107 row_newbcast:12 row_mask:0xf bank_mask:0xf
    s_waitcnt vmcnt(22)
    v_cvt_f32_i32 v100, v52
    v_cvt_f32_i32 v101, v53
    v_cvt_f32_i32 v102, v54
    v_cvt_f32_i32 v103, v55
    buffer_load_dwordx4 v[48:51], v1, s[28:31], s71 offen offset:512 nt
    v_fmac_f32_dpp v152, v170, v100 row_newbcast:2 row_mask:0xf bank_mask:0xf
    v_fmac_f32_dpp v153, v170, v101 row_newbcast:2 row_mask:0xf bank_mask:0xf
    v_fmac_f32_dpp v154, v170, v102 row_newbcast:2 row_mask:0xf bank_mask:0xf
    v_fmac_f32_dpp v155, v170, v103 row_newbcast:2 row_mask:0xf bank_mask:0xf
    s_waitcnt vmcnt(22)
    v_cvt_f32_i32 v104, v56
    v_cvt_f32_i32 v105, v57
    v_cvt_f32_i32 v106, v58
    v_cvt_f32_i32 v107, v59
    s_add_u32 s71, s71, 3072
    buffer_load_dwordx4 v[52:55], v1, s[28:31], s71 offen offset:0 nt
    v_fmac_f32_dpp v156, v170, v104 row_newbcast:2 row_mask:0xf bank_mask:0xf
    v_fmac_f32_dpp v157, v170, v105 row_newbcast:2 row_mask:0xf bank_mask:0xf
    v_fmac_f32_dpp v158, v170, v106 row_newbcast:2 row_mask:0xf bank_mask:0xf
    v_fmac_f32_dpp v159, v170, v107 row_newbcast:2 row_mask:0xf bank_mask:0xf
    s_waitcnt vmcnt(22)
    v_cvt_f32_i32 v100, v60
    v_cvt_f32_i32 v101, v61
    v_cvt_f32_i32 v102, v62
    v_cvt_f32_i32 v103, v63
    buffer_load_dwordx4 v[56:59], v1, s[28:31], s71 offen offset:256 nt
    v_fmac_f32_dpp v160, v170, v100 row_newbcast:2 row_mask:0xf bank_mask:0xf
    v_fmac_f32_dpp v161, v170, v101 row_newbcast:2 row_mask:0xf bank_mask:0xf
    v_fmac_f32_dpp v162, v170, v102 row_newbcast:2 row_mask:0xf bank_mask:0xf
    v_fmac_f32_dpp v163, v170, v103 row_newbcast:2 row_mask:0xf bank_mask:0xf
    s_waitcnt vmcnt(22)
    v_cvt_f32_i32 v104, v64
    v_cvt_f32_i32 v105, v65
    v_cvt_f32_i32 v106, v66
    v_cvt_f32_i32 v107, v67
    buffer_load_dwordx4 v[60:63], v1, s[28:31], s71 offen offset:512 nt
    v_fmac_f32_dpp v152, v170, v104 row_newbcast:10 row_mask:0xf bank_mask:0xf
    v_fmac_f32_dpp v153, v170, v105 row_newbcast:10 row_mask:0xf bank_mask:0xf
    v_fmac_f32_dpp v154, v170, v106 row_newbcast:10 row_mask:0xf bank_mask:0xf
    v_fmac_f32_dpp v155, v170, v107 row_newbcast:10 row_mask:0xf bank_mask:0xf
    s_waitcnt vmcnt(22)
    v_cvt_f32_i32 v100, v68
    v_cvt_f32_i32 v101, v69
    v_cvt_f32_i32 v102, v70
    v_cvt_f32_i32 v103, v71
    s_add_u32 s71, s71, 3072
    buffer_load_dwordx4 v[64:67], v1, s[28:31], s71 offen offset:0 nt
    v_fmac_f32_dpp v156, v170, v100 row_newbcast:10 row_mask:0xf bank_mask:0xf
    v_fmac_f32_dpp v157, v170, v101 row_newbcast:10 row_mask:0xf bank_mask:0xf
    v_fmac_f32_dpp v158, v170, v102 row_newbcast:10 row_mask:0xf bank_mask:0xf
    v_fmac_f32_dpp v159, v170, v103 row_newbcast:10 row_mask:0xf bank_mask:0xf
    s_waitcnt vmcnt(22)
    v_cvt_f32_i32 v104, v72
    v_cvt_f32_i32 v105, v73
    v_cvt_f32_i32 v106, v74
    v_cvt_f32_i32 v107, v75
    buffer_load_dwordx4 v[68:71], v1, s[28:31], s71 offen offset:256 nt
    v_fmac_f32_dpp v160, v170, v104 row_newbcast:10 row_mask:0xf bank_mask:0xf
    v_fmac_f32_dpp v161, v170, v105 row_newbcast:10 row_mask:0xf bank_mask:0xf
    v_fmac_f32_dpp v162, v170, v106 row_newbcast:10 row_mask:0xf bank_mask:0xf
    v_fmac_f32_dpp v163, v170, v107 row_newbcast:10 row_mask:0xf bank_mask:0xf
    s_waitcnt vmcnt(22)
    v_cvt_f32_i32 v100, v76
    v_cvt_f32_i32 v101, v77
    v_cvt_f32_i32 v102, v78
    v_cvt_f32_i32 v103, v79
    buffer_load_dwordx4 v[72:75], v1, s[28:31], s71 offen offset:512 nt
    v_fmac_f32_dpp v152, v170, v100 row_newbcast:6 row_mask:0xf bank_mask:0xf
    v_fmac_f32_dpp v153, v170, v101 row_newbcast:6 row_mask:0xf bank_mask:0xf
    v_fmac_f32_dpp v154, v170, v102 row_newbcast:6 row_mask:0xf bank_mask:0xf
    v_fmac_f32_dpp v155, v170, v103 row_newbcast:6 row_mask:0xf bank_mask:0xf
    s_waitcnt vmcnt(22)
    v_cvt_f32_i32 v104, v80
    v_cvt_f32_i32 v105, v81
    v_cvt_f32_i32 v106, v82
    v_cvt_f32_i32 v107, v83
    s_add_u32 s71, s71, 3072
    buffer_load_dwordx4 v[76:79], v1, s[28:31], s71 offen offset:0 nt
    v_fmac_f32_dpp v156, v170, v104 row_newbcast:6 row_mask:0xf bank_mask:0xf
    v_fmac_f32_dpp v157, v170, v105 row_newbcast:6 row_mask:0xf bank_mask:0xf
    v_fmac_f32_dpp v158, v170, v106 row_newbcast:6 row_mask:0xf bank_mask:0xf
    v_fmac_f32_dpp v159, v170, v107 row_newbcast:6 row_mask:0xf bank_mask:0xf
    s_waitcnt vmcnt(22)
    v_cvt_f32_i32 v100, v84
    v_cvt_f32_i32 v101, v85
    v_cvt_f32_i32 v102, v86
    v_cvt_f32_i32 v103, v87
    buffer_load_dwordx4 v[80:83], v1, s[28:31], s71 offen offset:256 nt
    v_fmac_f32_dpp v160, v170, v100 row_newbcast:6 row_mask:0xf bank_mask:0xf
    v_fmac_f32_dpp v161, v170, v101 row_newbcast:6 row_mask:0xf bank_mask:0xf
    v_fmac_f32_dpp v162, v170, v102 row_newbcast:6 row_mask:0xf bank_mask:0xf
    v_fmac_f32_dpp v163, v170, v103 row_newbcast:6 row_mask:0xf bank_mask:0xf
    s_waitcnt vmcnt(22)
    v_cvt_f32_i32 v104, v88
    v_cvt_f32_i32 v105, v89
    v_cvt_f32_i32 v106, v90
    v_cvt_f32_i32 v107, v91
    buffer_load_dwordx4 v[84:87], v1, s[28:31], s71 offen offset:512 nt
    v_fmac_f32_dpp v152, v170, v104 row_newbcast:14 row_mask:0xf bank_mask:0xf
    v_fmac_f32_dpp v153, v170, v105 row_newbcast:14 row_mask:0xf bank_mask:0xf
    v_fmac_f32_dpp v154, v170, v106 row_newbcast:14 row_mask:0xf bank_mask:0xf
    v_fmac_f32_dpp v155, v170, v107 row_newbcast:14 row_mask:0xf bank_mask:0xf
    s_waitcnt vmcnt(22)
    v_cvt_f32_i32 v100, v92
    v_cvt_f32_i32 v101, v93
    v_cvt_f32_i32 v102, v94
    v_cvt_f32_i32 v103, v95
    s_add_u32 s71, s71, 3072
    buffer_load_dwordx4 v[88:91], v1, s[28:31], s71 offen offset:0 nt
    v_fmac_f32_dpp v156, v170, v100 row_newbcast:14 row_mask:0xf bank_mask:0xf
    v_fmac_f32_dpp v157, v170, v101 row_newbcast:14 row_mask:0xf bank_mask:0xf
    v_fmac_f32_dpp v158, v170, v102 row_newbcast:14 row_mask:0xf bank_mask:0xf
    v_fmac_f32_dpp v159, v170, v103 row_newbcast:14 row_mask:0xf bank_mask:0xf
    ds_read_b32 v175, v174
    s_waitcnt vmcnt(22)
    v_cvt_f32_i32 v104, v96
    v_cvt_f32_i32 v105, v97
    v_cvt_f32_i32 v106, v98
    v_cvt_f32_i32 v107, v99
    buffer_load_dwordx4 v[92:95], v1, s[28:31], s71 offen offset:256 nt
    v_fmac_f32_dpp v160, v170, v104 row_newbcast:14 row_mask:0xf bank_mask:0xf
    v_fmac_f32_dpp v161, v170, v105 row_newbcast:14 row_mask:0xf bank_mask:0xf
    v_fmac_f32_dpp v162, v170, v106 row_newbcast:14 row_mask:0xf bank_mask:0xf
    v_fmac_f32_dpp v163, v170, v107 row_newbcast:14 row_mask:0xf bank_mask:0xf
    s_waitcnt vmcnt(22)
    v_cvt_f32_i32 v100, v4
    v_cvt_f32_i32 v101, v5
    v_cvt_f32_i32 v102, v6
    v_cvt_f32_i32 v103, v7
    buffer_load_dwordx4 v[96:99], v1, s[28:31], s71 offen offset:512 nt
    v_fmac_f32_dpp v152, v170, v100 row_newbcast:1 row_mask:0xf bank_mask:0xf
    v_fmac_f32_dpp v153, v170, v101 row_newbcast:1 row_mask:0xf bank_mask:0xf
    v_fmac_f32_dpp v154, v170, v102 row_newbcast:1 row_mask:0xf bank_mask:0xf
    v_fmac_f32_dpp v155, v170, v103 row_newbcast:1 row_mask:0xf bank_mask:0xf
    s_waitcnt lgkmcnt(0)
    v_readfirstlane_b32 s80, v175
    s_cmp_lg_u32 s80, -1
    s_cbranch_scc1 L_tkok
L_tkw:
    ds_read_b32 v175, v174
    s_waitcnt lgkmcnt(0)
    v_readfirstlane_b32 s80, v175
    s_cmp_eq_u32 s80, -1
    s_cbranch_scc1 L_tkw
L_tkok:
    v_add_u32 v174, 4, v174
    s_cmp_ge_u32 s80, 40
    s_cbranch_scc1 L_dtail
    s_lshr_b32 s81, s80, 3
    s_and_b32 s80, s80, 7
    s_mul_i32 s56, s81, 64
    s_add_u32 s56, s56, s80
    s_add_u32 s56, s56, s94
    s_and_b32 s56, s56, 511
    s_mov_b32 s57, s59
    s_add_u32 s70, s57, s56
    s_and_b32 s95, s2, 0xf8
    s_add_u32 s95, s95, s80
    s_lshl_b32 s95, s95, 3
    s_add_u32 s95, s95, s81
    s_lshl_b32 s95, s95, 8
    s_add_u32 s95, s95, 18874368
    s_waitcnt vmcnt(22)
    v_cvt_f32_i32 v104, v8
    v_cvt_f32_i32 v105, v9
    v_cvt_f32_i32 v106, v10
    v_cvt_f32_i32 v107, v11
    s_lshl_b32 s73, s70, 7
    buffer_load_dword v171, v172, s[52:55], s95 offen sc0 sc1
    buffer_load_ushort v168, v3, s[40:43], s73 offen
    buffer_load_ushort v169, v3, s[44:47], s73 offen
    s_mul_i32 s71, s70, 49152
    buffer_load_dwordx4 v[4:7], v1, s[28:31], s71 offen offset:0 nt
    v_fmac_f32_dpp v156, v170, v104 row_newbcast:1 row_mask:0xf bank_mask:0xf
    v_fmac_f32_dpp v157, v170, v105 row_newbcast:1 row_mask:0xf bank_mask:0xf
    v_fmac_f32_dpp v158, v170, v106 row_newbcast:1 row_mask:0xf bank_mask:0xf
    v_fmac_f32_dpp v159, v170, v107 row_newbcast:1 row_mask:0xf bank_mask:0xf
    s_waitcnt vmcnt(25)
    v_cvt_f32_i32 v100, v12
    v_cvt_f32_i32 v101, v13
    v_cvt_f32_i32 v102, v14
    v_cvt_f32_i32 v103, v15
    buffer_load_dwordx4 v[8:11], v1, s[28:31], s71 offen offset:256 nt
    v_fmac_f32_dpp v160, v170, v100 row_newbcast:1 row_mask:0xf bank_mask:0xf
    v_fmac_f32_dpp v161, v170, v101 row_newbcast:1 row_mask:0xf bank_mask:0xf
    v_fmac_f32_dpp v162, v170, v102 row_newbcast:1 row_mask:0xf bank_mask:0xf
    v_fmac_f32_dpp v163, v170, v103 row_newbcast:1 row_mask:0xf bank_mask:0xf
    s_waitcnt vmcnt(25)
    v_cvt_f32_i32 v104, v16
    v_cvt_f32_i32 v105, v17
    v_cvt_f32_i32 v106, v18
    v_cvt_f32_i32 v107, v19
    buffer_load_dwordx4 v[12:15], v1, s[28:31], s71 offen offset:512 nt
    v_fmac_f32_dpp v152, v170, v104 row_newbcast:9 row_mask:0xf bank_mask:0xf
    v_fmac_f32_dpp v153, v170, v105 row_newbcast:9 row_mask:0xf bank_mask:0xf
    v_fmac_f32_dpp v154, v170, v106 row_newbcast:9 row_mask:0xf bank_mask:0xf
    v_fmac_f32_dpp v155, v170, v107 row_newbcast:9 row_mask:0xf bank_mask:0xf
    s_waitcnt vmcnt(25)
    v_cvt_f32_i32 v100, v20
    v_cvt_f32_i32 v101, v21
    v_cvt_f32_i32 v102, v22
    v_cvt_f32_i32 v103, v23
    s_add_u32 s71, s71, 3072
    buffer_load_dwordx4 v[16:19], v1, s[28:31], s71 offen offset:0 nt
    v_fmac_f32_dpp v156, v170, v100 row_newbcast:9 row_mask:0xf bank_mask:0xf
    v_fmac_f32_dpp v157, v170, v101 row_newbcast:9 row_mask:0xf bank_mask:0xf
    v_fmac_f32_dpp v158, v170, v102 row_newbcast:9 row_mask:0xf bank_mask:0xf
    v_fmac_f32_dpp v159, v170, v103 row_newbcast:9 row_mask:0xf bank_mask:0xf
    s_waitcnt vmcnt(25)
    v_cvt_f32_i32 v104, v24
    v_cvt_f32_i32 v105, v25
    v_cvt_f32_i32 v106, v26
    v_cvt_f32_i32 v107, v27
    buffer_load_dwordx4 v[20:23], v1, s[28:31], s71 offen offset:256 nt
    v_fmac_f32_dpp v160, v170, v104 row_newbcast:9 row_mask:0xf bank_mask:0xf
    v_fmac_f32_dpp v161, v170, v105 row_newbcast:9 row_mask:0xf bank_mask:0xf
    v_fmac_f32_dpp v162, v170, v106 row_newbcast:9 row_mask:0xf bank_mask:0xf
    v_fmac_f32_dpp v163, v170, v107 row_newbcast:9 row_mask:0xf bank_mask:0xf
    s_waitcnt vmcnt(25)
    v_cvt_f32_i32 v100, v28
    v_cvt_f32_i32 v101, v29
    v_cvt_f32_i32 v102, v30
    v_cvt_f32_i32 v103, v31
    buffer_load_dwordx4 v[24:27], v1, s[28:31], s71 offen offset:512 nt
    v_fmac_f32_dpp v152, v170, v100 row_newbcast:5 row_mask:0xf bank_mask:0xf
    v_fmac_f32_dpp v153, v170, v101 row_newbcast:5 row_mask:0xf bank_mask:0xf
    v_fmac_f32_dpp v154, v170, v102 row_newbcast:5 row_mask:0xf bank_mask:0xf
    v_fmac_f32_dpp v155, v170, v103 row_newbcast:5 row_mask:0xf bank_mask:0xf
    s_waitcnt vmcnt(25)
    v_cvt_f32_i32 v104, v32
    v_cvt_f32_i32 v105, v33
    v_cvt_f32_i32 v106, v34
    v_cvt_f32_i32 v107, v35
    s_add_u32 s71, s71, 3072
    buffer_load_dwordx4 v[28:31], v1, s[28:31], s71 offen offset:0 nt
    v_fmac_f32_dpp v156, v170, v104 row_newbcast:5 row_mask:0xf bank_mask:0xf
    v_fmac_f32_dpp v157, v170, v105 row_newbcast:5 row_mask:0xf bank_mask:0xf
    v_fmac_f32_dpp v158, v170, v106 row_newbcast:5 row_mask:0xf bank_mask:0xf
    v_fmac_f32_dpp v159, v170, v107 row_newbcast:5 row_mask:0xf bank_mask:0xf
    s_waitcnt vmcnt(25)
    v_cvt_f32_i32 v100, v36
    v_cvt_f32_i32 v101, v37
    v_cvt_f32_i32 v102, v38
    v_cvt_f32_i32 v103, v39
    buffer_load_dwordx4 v[32:35], v1, s[28:31], s71 offen offset:256 nt
    v_fmac_f32_dpp v160, v170, v100 row_newbcast:5 row_mask:0xf bank_mask:0xf
    v_fmac_f32_dpp v161, v170, v101 row_newbcast:5 row_mask:0xf bank_mask:0xf
    v_fmac_f32_dpp v162, v170, v102 row_newbcast:5 row_mask:0xf bank_mask:0xf
    v_fmac_f32_dpp v163, v170, v103 row_newbcast:5 row_mask:0xf bank_mask:0xf
    s_waitcnt vmcnt(25)
    v_cvt_f32_i32 v104, v40
    v_cvt_f32_i32 v105, v41
    v_cvt_f32_i32 v106, v42
    v_cvt_f32_i32 v107, v43
    buffer_load_dwordx4 v[36:39], v1, s[28:31], s71 offen offset:512 nt
    v_fmac_f32_dpp v152, v170, v104 row_newbcast:13 row_mask:0xf bank_mask:0xf
    v_fmac_f32_dpp v153, v170, v105 row_newbcast:13 row_mask:0xf bank_mask:0xf
    v_fmac_f32_dpp v154, v170, v106 row_newbcast:13 row_mask:0xf bank_mask:0xf
    v_fmac_f32_dpp v155, v170, v107 row_newbcast:13 row_mask:0xf bank_mask:0xf
    s_waitcnt vmcnt(25)
    v_cvt_f32_i32 v100, v44
    v_cvt_f32_i32 v101, v45
    v_cvt_f32_i32 v102, v46
    v_cvt_f32_i32 v103, v47
    s_add_u32 s71, s71, 3072
    buffer_load_dwordx4 v[40:43], v1, s[28:31], s71 offen offset:0 nt
    v_fmac_f32_dpp v156, v170, v100 row_newbcast:13 row_mask:0xf bank_mask:0xf
    v_fmac_f32_dpp v157, v170, v101 row_newbcast:13 row_mask:0xf bank_mask:0xf
    v_fmac_f32_dpp v158, v170, v102 row_newbcast:13 row_mask:0xf bank_mask:0xf
    v_fmac_f32_dpp v159, v170, v103 row_newbcast:13 row_mask:0xf bank_mask:0xf
    s_waitcnt vmcnt(25)
    v_cvt_f32_i32 v104, v48
    v_cvt_f32_i32 v105, v49
    v_cvt_f32_i32 v106, v50
    v_cvt_f32_i32 v107, v51
    buffer_load_dwordx4 v[44:47], v1, s[28:31], s71 offen offset:256 nt
    v_fmac_f32_dpp v160, v170, v104 row_newbcast:13 row_mask:0xf bank_mask:0xf
    v_fmac_f32_dpp v161, v170, v105 row_newbcast:13 row_mask:0xf bank_mask:0xf
    v_fmac_f32_dpp v162, v170, v106 row_newbcast:13 row_mask:0xf bank_mask:0xf
    v_fmac_f32_dpp v163, v170, v107 row_newbcast:13 row_mask:0xf bank_mask:0xf
    s_waitcnt vmcnt(25)
    v_cvt_f32_i32 v100, v52
    v_cvt_f32_i32 v101, v53
    v_cvt_f32_i32 v102, v54
    v_cvt_f32_i32 v103, v55
    buffer_load_dwordx4 v[48:51], v1, s[28:31], s71 offen offset:512 nt
    v_fmac_f32_dpp v152, v170, v100 row_newbcast:3 row_mask:0xf bank_mask:0xf
    v_fmac_f32_dpp v153, v170, v101 row_newbcast:3 row_mask:0xf bank_mask:0xf
    v_fmac_f32_dpp v154, v170, v102 row_newbcast:3 row_mask:0xf bank_mask:0xf
    v_fmac_f32_dpp v155, v170, v103 row_newbcast:3 row_mask:0xf bank_mask:0xf
    s_waitcnt vmcnt(25)
    v_cvt_f32_i32 v104, v56
    v_cvt_f32_i32 v105, v57
    v_cvt_f32_i32 v106, v58
    v_cvt_f32_i32 v107, v59
    s_add_u32 s71, s71, 3072
    buffer_load_dwordx4 v[52:55], v1, s[28:31], s71 offen offset:0 nt
    v_fmac_f32_dpp v156, v170, v104 row_newbcast:3 row_mask:0xf bank_mask:0xf
    v_fmac_f32_dpp v157, v170, v105 row_newbcast:3 row_mask:0xf bank_mask:0xf
    v_fmac_f32_dpp v158, v170, v106 row_newbcast:3 row_mask:0xf bank_mask:0xf
    v_fmac_f32_dpp v159, v170, v107 row_newbcast:3 row_mask:0xf bank_mask:0xf
    s_waitcnt vmcnt(25)
    v_cvt_f32_i32 v100, v60
    v_cvt_f32_i32 v101, v61
    v_cvt_f32_i32 v102, v62
    v_cvt_f32_i32 v103, v63
    buffer_load_dwordx4 v[56:59], v1, s[28:31], s71 offen offset:256 nt
    v_fmac_f32_dpp v160, v170, v100 row_newbcast:3 row_mask:0xf bank_mask:0xf
    v_fmac_f32_dpp v161, v170, v101 row_newbcast:3 row_mask:0xf bank_mask:0xf
    v_fmac_f32_dpp v162, v170, v102 row_newbcast:3 row_mask:0xf bank_mask:0xf
    v_fmac_f32_dpp v163, v170, v103 row_newbcast:3 row_mask:0xf bank_mask:0xf
    s_waitcnt vmcnt(25)
    v_cvt_f32_i32 v104, v64
    v_cvt_f32_i32 v105, v65
    v_cvt_f32_i32 v106, v66
    v_cvt_f32_i32 v107, v67
    buffer_load_dwordx4 v[60:63], v1, s[28:31], s71 offen offset:512 nt
    v_fmac_f32_dpp v152, v170, v104 row_newbcast:11 row_mask:0xf bank_mask:0xf
    v_fmac_f32_dpp v153, v170, v105 row_newbcast:11 row_mask:0xf bank_mask:0xf
    v_fmac_f32_dpp v154, v170, v106 row_newbcast:11 row_mask:0xf bank_mask:0xf
    v_fmac_f32_dpp v155, v170, v107 row_newbcast:11 row_mask:0xf bank_mask:0xf
    s_waitcnt vmcnt(25)
    v_cvt_f32_i32 v100, v68
    v_cvt_f32_i32 v101, v69
    v_cvt_f32_i32 v102, v70
    v_cvt_f32_i32 v103, v71
    s_add_u32 s71, s71, 3072
    buffer_load_dwordx4 v[64:67], v1, s[28:31], s71 offen offset:0 nt
    v_fmac_f32_dpp v156, v170, v100 row_newbcast:11 row_mask:0xf bank_mask:0xf
    v_fmac_f32_dpp v157, v170, v101 row_newbcast:11 row_mask:0xf bank_mask:0xf
    v_fmac_f32_dpp v158, v170, v102 row_newbcast:11 row_mask:0xf bank_mask:0xf
    v_fmac_f32_dpp v159, v170, v103 row_newbcast:11 row_mask:0xf bank_mask:0xf
    s_waitcnt vmcnt(25)
    v_cvt_f32_i32 v104, v72
    v_cvt_f32_i32 v105, v73
    v_cvt_f32_i32 v106, v74
    v_cvt_f32_i32 v107, v75
    buffer_load_dwordx4 v[68:71], v1, s[28:31], s71 offen offset:256 nt
    v_fmac_f32_dpp v160, v170, v104 row_newbcast:11 row_mask:0xf bank_mask:0xf
    v_fmac_f32_dpp v161, v170, v105 row_newbcast:11 row_mask:0xf bank_mask:0xf
    v_fmac_f32_dpp v162, v170, v106 row_newbcast:11 row_mask:0xf bank_mask:0xf
    v_fmac_f32_dpp v163, v170, v107 row_newbcast:11 row_mask:0xf bank_mask:0xf
    s_waitcnt vmcnt(25)
    v_cvt_f32_i32 v100, v76
    v_cvt_f32_i32 v101, v77
    v_cvt_f32_i32 v102, v78
    v_cvt_f32_i32 v103, v79
    buffer_load_dwordx4 v[72:75], v1, s[28:31], s71 offen offset:512 nt
    v_fmac_f32_dpp v152, v170, v100 row_newbcast:7 row_mask:0xf bank_mask:0xf
    v_fmac_f32_dpp v153, v170, v101 row_newbcast:7 row_mask:0xf bank_mask:0xf
    v_fmac_f32_dpp v154, v170, v102 row_newbcast:7 row_mask:0xf bank_mask:0xf
    v_fmac_f32_dpp v155, v170, v103 row_newbcast:7 row_mask:0xf bank_mask:0xf
    s_waitcnt vmcnt(25)
    v_cvt_f32_i32 v104, v80
    v_cvt_f32_i32 v105, v81
    v_cvt_f32_i32 v106, v82
    v_cvt_f32_i32 v107, v83
    s_add_u32 s71, s71, 3072
    buffer_load_dwordx4 v[76:79], v1, s[28:31], s71 offen offset:0 nt
    v_fmac_f32_dpp v156, v170, v104 row_newbcast:7 row_mask:0xf bank_mask:0xf
    v_fmac_f32_dpp v157, v170, v105 row_newbcast:7 row_mask:0xf bank_mask:0xf
    v_fmac_f32_dpp v158, v170, v106 row_newbcast:7 row_mask:0xf bank_mask:0xf
    v_fmac_f32_dpp v159, v170, v107 row_newbcast:7 row_mask:0xf bank_mask:0xf
    s_waitcnt vmcnt(25)
    v_cvt_f32_i32 v100, v84
    v_cvt_f32_i32 v101, v85
    v_cvt_f32_i32 v102, v86
    v_cvt_f32_i32 v103, v87
    buffer_load_dwordx4 v[80:83], v1, s[28:31], s71 offen offset:256 nt
    v_fmac_f32_dpp v160, v170, v100 row_newbcast:7 row_mask:0xf bank_mask:0xf
    v_fmac_f32_dpp v161, v170, v101 row_newbcast:7 row_mask:0xf bank_mask:0xf
    v_fmac_f32_dpp v162, v170, v102 row_newbcast:7 row_mask:0xf bank_mask:0xf
    v_fmac_f32_dpp v163, v170, v103 row_newbcast:7 row_mask:0xf bank_mask:0xf
    s_waitcnt vmcnt(25)
    v_cvt_f32_i32 v104, v88
    v_cvt_f32_i32 v105, v89
    v_cvt_f32_i32 v106, v90
    v_cvt_f32_i32 v107, v91
    buffer_load_dwordx4 v[84:87], v1, s[28:31], s71 offen offset:512 nt
    v_fmac_f32_dpp v152, v170, v104 row_newbcast:15 row_mask:0xf bank_mask:0xf
    v_fmac_f32_dpp v153, v170, v105 row_newbcast:15 row_mask:0xf bank_mask:0xf
    v_fmac_f32_dpp v154, v170, v106 row_newbcast:15 row_mask:0xf bank_mask:0xf
    v_fmac_f32_dpp v155, v170, v107 row_newbcast:15 row_mask:0xf bank_mask:0xf
    s_waitcnt vmcnt(25)
    v_cvt_f32_i32 v100, v92
    v_cvt_f32_i32 v101, v93
    v_cvt_f32_i32 v102, v94
    v_cvt_f32_i32 v103, v95
    s_add_u32 s71, s71, 3072
    buffer_load_dwordx4 v[88:91], v1, s[28:31], s71 offen offset:0 nt
    v_fmac_f32_dpp v156, v170, v100 row_newbcast:15 row_mask:0xf bank_mask:0xf
    v_fmac_f32_dpp v157, v170, v101 row_newbcast:15 row_mask:0xf bank_mask:0xf
    v_fmac_f32_dpp v158, v170, v102 row_newbcast:15 row_mask:0xf bank_mask:0xf
    v_fmac_f32_dpp v159, v170, v103 row_newbcast:15 row_mask:0xf bank_mask:0xf
    s_waitcnt vmcnt(25)
    v_cvt_f32_i32 v104, v96
    v_cvt_f32_i32 v105, v97
    v_cvt_f32_i32 v106, v98
    v_cvt_f32_i32 v107, v99
    buffer_load_dwordx4 v[92:95], v1, s[28:31], s71 offen offset:256 nt
    v_fmac_f32_dpp v160, v170, v104 row_newbcast:15 row_mask:0xf bank_mask:0xf
    v_fmac_f32_dpp v161, v170, v105 row_newbcast:15 row_mask:0xf bank_mask:0xf
    v_fmac_f32_dpp v162, v170, v106 row_newbcast:15 row_mask:0xf bank_mask:0xf
    v_fmac_f32_dpp v163, v170, v107 row_newbcast:15 row_mask:0xf bank_mask:0xf
    s_branch L_dloop
L_dtail:
    ds_write_b32 v188, v188 offset:143
    s_waitcnt vmcnt(22)
    v_cvt_f32_i32 v104, v8
    v_cvt_f32_i32 v105, v9
    v_cvt_f32_i32 v106, v10
    v_cvt_f32_i32 v107, v11
    v_fmac_f32_dpp v156, v170, v104 row_newbcast:1 row_mask:0xf bank_mask:0xf
    v_fmac_f32_dpp v157, v170, v105 row_newbcast:1 row_mask:0xf bank_mask:0xf
    v_fmac_f32_dpp v158, v170, v106 row_newbcast:1 row_mask:0xf bank_mask:0xf
    v_fmac_f32_dpp v159, v170, v107 row_newbcast:1 row_mask:0xf bank_mask:0xf
    s_waitcnt vmcnt(21)
    v_cvt_f32_i32 v100, v12
    v_cvt_f32_i32 v101, v13
    v_cvt_f32_i32 v102, v14
    v_cvt_f32_i32 v103, v15
    v_fmac_f32_dpp v160, v170, v100 row_newbcast:1 row_mask:0xf bank_mask:0xf
    v_fmac_f32_dpp v161, v170, v101 row_newbcast:1 row_mask:0xf bank_mask:0xf
    v_fmac_f32_dpp v162, v170, v102 row_newbcast:1 row_mask:0xf bank_mask:0xf
    v_fmac_f32_dpp v163, v170, v103 row_newbcast:1 row_mask:0xf bank_mask:0xf
    s_waitcnt vmcnt(20)
    v_cvt_f32_i32 v104, v16
    v_cvt_f32_i32 v105, v17
    v_cvt_f32_i32 v106, v18
    v_cvt_f32_i32 v107, v19
    v_fmac_f32_dpp v152, v170, v104 row_newbcast:9 row_mask:0xf bank_mask:0xf
    v_fmac_f32_dpp v153, v170, v105 row_newbcast:9 row_mask:0xf bank_mask:0xf
    v_fmac_f32_dpp v154, v170, v106 row_newbcast:9 row_mask:0xf bank_mask:0xf
    v_fmac_f32_dpp v155, v170, v107 row_newbcast:9 row_mask:0xf bank_mask:0xf
    s_waitcnt vmcnt(19)
    v_cvt_f32_i32 v100, v20
    v_cvt_f32_i32 v101, v21
    v_cvt_f32_i32 v102, v22
    v_cvt_f32_i32 v103, v23
    v_fmac_f32_dpp v156, v170, v100 row_newbcast:9 row_mask:0xf bank_mask:0xf
    v_fmac_f32_dpp v157, v170, v101 row_newbcast:9 row_mask:0xf bank_mask:0xf
    v_fmac_f32_dpp v158, v170, v102 row_newbcast:9 row_mask:0xf bank_mask:0xf
    v_fmac_f32_dpp v159, v170, v103 row_newbcast:9 row_mask:0xf bank_mask:0xf
    s_waitcnt vmcnt(18)
    v_cvt_f32_i32 v104, v24
    v_cvt_f32_i32 v105, v25
    v_cvt_f32_i32 v106, v26
    v_cvt_f32_i32 v107, v27
    v_fmac_f32_dpp v160, v170, v104 row_newbcast:9 row_mask:0xf bank_mask:0xf
    v_fmac_f32_dpp v161, v170, v105 row_newbcast:9 row_mask:0xf bank_mask:0xf
    v_fmac_f32_dpp v162, v170, v106 row_newbcast:9 row_mask:0xf bank_mask:0xf
    v_fmac_f32_dpp v163, v170, v107 row_newbcast:9 row_mask:0xf bank_mask:0xf
    s_waitcnt vmcnt(17)
    v_cvt_f32_i32 v100, v28
    v_cvt_f32_i32 v101, v29
    v_cvt_f32_i32 v102, v30
    v_cvt_f32_i32 v103, v31
    v_fmac_f32_dpp v152, v170, v100 row_newbcast:5 row_mask:0xf bank_mask:0xf
    v_fmac_f32_dpp v153, v170, v101 row_newbcast:5 row_mask:0xf bank_mask:0xf
    v_fmac_f32_dpp v154, v170, v102 row_newbcast:5 row_mask:0xf bank_mask:0xf
    v_fmac_f32_dpp v155, v170, v103 row_newbcast:5 row_mask:0xf bank_mask:0xf
    s_waitcnt vmcnt(16)
    v_cvt_f32_i32 v104, v32
    v_cvt_f32_i32 v105, v33
    v_cvt_f32_i32 v106, v34
    v_cvt_f32_i32 v107, v35
    v_fmac_f32_dpp v156, v170, v104 row_newbcast:5 row_mask:0xf bank_mask:0xf
    v_fmac_f32_dpp v157, v170, v105 row_newbcast:5 row_mask:0xf bank_mask:0xf
    v_fmac_f32_dpp v158, v170, v106 row_newbcast:5 row_mask:0xf bank_mask:0xf
    v_fmac_f32_dpp v159, v170, v107 row_newbcast:5 row_mask:0xf bank_mask:0xf
    s_waitcnt vmcnt(15)
    v_cvt_f32_i32 v100, v36
    v_cvt_f32_i32 v101, v37
    v_cvt_f32_i32 v102, v38
    v_cvt_f32_i32 v103, v39
    v_fmac_f32_dpp v160, v170, v100 row_newbcast:5 row_mask:0xf bank_mask:0xf
    v_fmac_f32_dpp v161, v170, v101 row_newbcast:5 row_mask:0xf bank_mask:0xf
    v_fmac_f32_dpp v162, v170, v102 row_newbcast:5 row_mask:0xf bank_mask:0xf
    v_fmac_f32_dpp v163, v170, v103 row_newbcast:5 row_mask:0xf bank_mask:0xf
    s_waitcnt vmcnt(14)
    v_cvt_f32_i32 v104, v40
    v_cvt_f32_i32 v105, v41
    v_cvt_f32_i32 v106, v42
    v_cvt_f32_i32 v107, v43
    v_fmac_f32_dpp v152, v170, v104 row_newbcast:13 row_mask:0xf bank_mask:0xf
    v_fmac_f32_dpp v153, v170, v105 row_newbcast:13 row_mask:0xf bank_mask:0xf
    v_fmac_f32_dpp v154, v170, v106 row_newbcast:13 row_mask:0xf bank_mask:0xf
    v_fmac_f32_dpp v155, v170, v107 row_newbcast:13 row_mask:0xf bank_mask:0xf
    s_waitcnt vmcnt(13)
    v_cvt_f32_i32 v100, v44
    v_cvt_f32_i32 v101, v45
    v_cvt_f32_i32 v102, v46
    v_cvt_f32_i32 v103, v47
    v_fmac_f32_dpp v156, v170, v100 row_newbcast:13 row_mask:0xf bank_mask:0xf
    v_fmac_f32_dpp v157, v170, v101 row_newbcast:13 row_mask:0xf bank_mask:0xf
    v_fmac_f32_dpp v158, v170, v102 row_newbcast:13 row_mask:0xf bank_mask:0xf
    v_fmac_f32_dpp v159, v170, v103 row_newbcast:13 row_mask:0xf bank_mask:0xf
    s_waitcnt vmcnt(12)
    v_cvt_f32_i32 v104, v48
    v_cvt_f32_i32 v105, v49
    v_cvt_f32_i32 v106, v50
    v_cvt_f32_i32 v107, v51
    v_fmac_f32_dpp v160, v170, v104 row_newbcast:13 row_mask:0xf bank_mask:0xf
    v_fmac_f32_dpp v161, v170, v105 row_newbcast:13 row_mask:0xf bank_mask:0xf
    v_fmac_f32_dpp v162, v170, v106 row_newbcast:13 row_mask:0xf bank_mask:0xf
    v_fmac_f32_dpp v163, v170, v107 row_newbcast:13 row_mask:0xf bank_mask:0xf
    s_waitcnt vmcnt(11)
    v_cvt_f32_i32 v100, v52
    v_cvt_f32_i32 v101, v53
    v_cvt_f32_i32 v102, v54
    v_cvt_f32_i32 v103, v55
    v_fmac_f32_dpp v152, v170, v100 row_newbcast:3 row_mask:0xf bank_mask:0xf
    v_fmac_f32_dpp v153, v170, v101 row_newbcast:3 row_mask:0xf bank_mask:0xf
    v_fmac_f32_dpp v154, v170, v102 row_newbcast:3 row_mask:0xf bank_mask:0xf
    v_fmac_f32_dpp v155, v170, v103 row_newbcast:3 row_mask:0xf bank_mask:0xf
    s_waitcnt vmcnt(10)
    v_cvt_f32_i32 v104, v56
    v_cvt_f32_i32 v105, v57
    v_cvt_f32_i32 v106, v58
    v_cvt_f32_i32 v107, v59
    v_fmac_f32_dpp v156, v170, v104 row_newbcast:3 row_mask:0xf bank_mask:0xf
    v_fmac_f32_dpp v157, v170, v105 row_newbcast:3 row_mask:0xf bank_mask:0xf
    v_fmac_f32_dpp v158, v170, v106 row_newbcast:3 row_mask:0xf bank_mask:0xf
    v_fmac_f32_dpp v159, v170, v107 row_newbcast:3 row_mask:0xf bank_mask:0xf
    s_waitcnt vmcnt(9)
    v_cvt_f32_i32 v100, v60
    v_cvt_f32_i32 v101, v61
    v_cvt_f32_i32 v102, v62
    v_cvt_f32_i32 v103, v63
    v_fmac_f32_dpp v160, v170, v100 row_newbcast:3 row_mask:0xf bank_mask:0xf
    v_fmac_f32_dpp v161, v170, v101 row_newbcast:3 row_mask:0xf bank_mask:0xf
    v_fmac_f32_dpp v162, v170, v102 row_newbcast:3 row_mask:0xf bank_mask:0xf
    v_fmac_f32_dpp v163, v170, v103 row_newbcast:3 row_mask:0xf bank_mask:0xf
    s_waitcnt vmcnt(8)
    v_cvt_f32_i32 v104, v64
    v_cvt_f32_i32 v105, v65
    v_cvt_f32_i32 v106, v66
    v_cvt_f32_i32 v107, v67
    v_fmac_f32_dpp v152, v170, v104 row_newbcast:11 row_mask:0xf bank_mask:0xf
    v_fmac_f32_dpp v153, v170, v105 row_newbcast:11 row_mask:0xf bank_mask:0xf
    v_fmac_f32_dpp v154, v170, v106 row_newbcast:11 row_mask:0xf bank_mask:0xf
    v_fmac_f32_dpp v155, v170, v107 row_newbcast:11 row_mask:0xf bank_mask:0xf
    s_waitcnt vmcnt(7)
    v_cvt_f32_i32 v100, v68
    v_cvt_f32_i32 v101, v69
    v_cvt_f32_i32 v102, v70
    v_cvt_f32_i32 v103, v71
    v_fmac_f32_dpp v156, v170, v100 row_newbcast:11 row_mask:0xf bank_mask:0xf
    v_fmac_f32_dpp v157, v170, v101 row_newbcast:11 row_mask:0xf bank_mask:0xf
    v_fmac_f32_dpp v158, v170, v102 row_newbcast:11 row_mask:0xf bank_mask:0xf
    v_fmac_f32_dpp v159, v170, v103 row_newbcast:11 row_mask:0xf bank_mask:0xf
    s_waitcnt vmcnt(6)
    v_cvt_f32_i32 v104, v72
    v_cvt_f32_i32 v105, v73
    v_cvt_f32_i32 v106, v74
    v_cvt_f32_i32 v107, v75
    v_fmac_f32_dpp v160, v170, v104 row_newbcast:11 row_mask:0xf bank_mask:0xf
    v_fmac_f32_dpp v161, v170, v105 row_newbcast:11 row_mask:0xf bank_mask:0xf
    v_fmac_f32_dpp v162, v170, v106 row_newbcast:11 row_mask:0xf bank_mask:0xf
    v_fmac_f32_dpp v163, v170, v107 row_newbcast:11 row_mask:0xf bank_mask:0xf
    s_waitcnt vmcnt(5)
    v_cvt_f32_i32 v100, v76
    v_cvt_f32_i32 v101, v77
    v_cvt_f32_i32 v102, v78
    v_cvt_f32_i32 v103, v79
    v_fmac_f32_dpp v152, v170, v100 row_newbcast:7 row_mask:0xf bank_mask:0xf
    v_fmac_f32_dpp v153, v170, v101 row_newbcast:7 row_mask:0xf bank_mask:0xf
    v_fmac_f32_dpp v154, v170, v102 row_newbcast:7 row_mask:0xf bank_mask:0xf
    v_fmac_f32_dpp v155, v170, v103 row_newbcast:7 row_mask:0xf bank_mask:0xf
    s_waitcnt vmcnt(4)
    v_cvt_f32_i32 v104, v80
    v_cvt_f32_i32 v105, v81
    v_cvt_f32_i32 v106, v82
    v_cvt_f32_i32 v107, v83
    v_fmac_f32_dpp v156, v170, v104 row_newbcast:7 row_mask:0xf bank_mask:0xf
    v_fmac_f32_dpp v157, v170, v105 row_newbcast:7 row_mask:0xf bank_mask:0xf
    v_fmac_f32_dpp v158, v170, v106 row_newbcast:7 row_mask:0xf bank_mask:0xf
    v_fmac_f32_dpp v159, v170, v107 row_newbcast:7 row_mask:0xf bank_mask:0xf
    s_waitcnt vmcnt(3)
    v_cvt_f32_i32 v100, v84
    v_cvt_f32_i32 v101, v85
    v_cvt_f32_i32 v102, v86
    v_cvt_f32_i32 v103, v87
    v_fmac_f32_dpp v160, v170, v100 row_newbcast:7 row_mask:0xf bank_mask:0xf
    v_fmac_f32_dpp v161, v170, v101 row_newbcast:7 row_mask:0xf bank_mask:0xf
    v_fmac_f32_dpp v162, v170, v102 row_newbcast:7 row_mask:0xf bank_mask:0xf
    v_fmac_f32_dpp v163, v170, v103 row_newbcast:7 row_mask:0xf bank_mask:0xf
    s_waitcnt vmcnt(2)
    v_cvt_f32_i32 v104, v88
    v_cvt_f32_i32 v105, v89
    v_cvt_f32_i32 v106, v90
    v_cvt_f32_i32 v107, v91
    v_fmac_f32_dpp v152, v170, v104 row_newbcast:15 row_mask:0xf bank_mask:0xf
    v_fmac_f32_dpp v153, v170, v105 row_newbcast:15 row_mask:0xf bank_mask:0xf
    v_fmac_f32_dpp v154, v170, v106 row_newbcast:15 row_mask:0xf bank_mask:0xf
    v_fmac_f32_dpp v155, v170, v107 row_newbcast:15 row_mask:0xf bank_mask:0xf
    s_waitcnt vmcnt(1)
    v_cvt_f32_i32 v100, v92
    v_cvt_f32_i32 v101, v93
    v_cvt_f32_i32 v102, v94
    v_cvt_f32_i32 v103, v95
    v_fmac_f32_dpp v156, v170, v100 row_newbcast:15 row_mask:0xf bank_mask:0xf
    v_fmac_f32_dpp v157, v170, v101 row_newbcast:15 row_mask:0xf bank_mask:0xf
    v_fmac_f32_dpp v158, v170, v102 row_newbcast:15 row_mask:0xf bank_mask:0xf
    v_fmac_f32_dpp v159, v170, v103 row_newbcast:15 row_mask:0xf bank_mask:0xf
    s_waitcnt vmcnt(0)
    v_cvt_f32_i32 v104, v96
    v_cvt_f32_i32 v105, v97
    v_cvt_f32_i32 v106, v98
    v_cvt_f32_i32 v107, v99
    v_fmac_f32_dpp v160, v170, v104 row_newbcast:15 row_mask:0xf bank_mask:0xf
    v_fmac_f32_dpp v161, v170, v105 row_newbcast:15 row_mask:0xf bank_mask:0xf
    v_fmac_f32_dpp v162, v170, v106 row_newbcast:15 row_mask:0xf bank_mask:0xf
    v_fmac_f32_dpp v163, v170, v107 row_newbcast:15 row_mask:0xf bank_mask:0xf
    s_nop 0
    v_add_f32_dpp v166, v166, v166 row_ror:8 row_mask:0xf bank_mask:0xf
    v_add_f32_dpp v167, v167, v167 row_ror:8 row_mask:0xf bank_mask:0xf
    s_nop 0
    v_add_f32_dpp v166, v166, v166 row_ror:4 row_mask:0xf bank_mask:0xf
    v_add_f32_dpp v167, v167, v167 row_ror:4 row_mask:0xf bank_mask:0xf
    s_nop 0
    v_add_f32_dpp v166, v166, v166 row_ror:2 row_mask:0xf bank_mask:0xf
    v_add_f32_dpp v167, v167, v167 row_ror:2 row_mask:0xf bank_mask:0xf
    s_nop 0
    v_add_f32_dpp v166, v166, v166 row_ror:1 row_mask:0xf bank_mask:0xf
    v_add_f32_dpp v167, v167, v167 row_ror:1 row_mask:0xf bank_mask:0xf
    v_mov_b32 v182, v165
    v_mov_b32 v183, v165
    s_nop 1
    v_permlane32_swap_b32 v182, v183
    s_nop 1
    v_max_f32 v182, v182, v183
    v_mov_b32 v183, v182
    s_nop 1
    v_permlane16_swap_b32 v182, v183
    s_nop 1
    v_max_f32 v182, v182, v183
    v_sub_f32 v183, v165, v182
    v_exp_f32 v183, v183
    v_mov_b32 v104, v182
    v_mul_f32 v166, v166, v183
    v_mul_f32 v167, v167, v183
    v_fma_f32 v152, v152, v183, -v167
    v_fma_f32 v153, v153, v183, -v167
    v_fma_f32 v154, v154, v183, -v167
    v_fma_f32 v155, v155, v183, -v167
    v_fma_f32 v156, v156, v183, -v167
    v_fma_f32 v157, v157, v183, -v167
    v_fma_f32 v158, v158, v183, -v167
    v_fma_f32 v159, v159, v183, -v167
    v_fma_f32 v160, v160, v183, -v167
    v_fma_f32 v161, v161, v183, -v167
    v_fma_f32 v162, v162, v183, -v167
    v_fma_f32 v163, v163, v183, -v167
    v_mov_b32 v182, v166
    s_nop 1
    v_permlane32_swap_b32 v166, v182
    v_permlane32_swap_b32 v152, v154
    v_permlane32_swap_b32 v153, v155
    v_permlane32_swap_b32 v156, v158
    v_permlane32_swap_b32 v157, v159
    v_permlane32_swap_b32 v160, v162
    v_permlane32_swap_b32 v161, v163
    s_nop 1
    v_add_f32 v166, v166, v182
    v_add_f32 v152, v152, v154
    v_add_f32 v153, v153, v155
    v_add_f32 v156, v156, v158
    v_add_f32 v157, v157, v159
    v_add_f32 v160, v160, v162
    v_add_f32 v161, v161, v163
    v_mov_b32 v182, v166
    s_nop 1
    v_permlane16_swap_b32 v166, v182
    v_permlane16_swap_b32 v152, v153
    v_permlane16_swap_b32 v156, v157
    v_permlane16_swap_b32 v160, v161
    s_nop 1
    v_add_f32 v105, v166, v182
    v_add_f32 v100, v152, v153
    v_add_f32 v101, v156, v157
    v_add_f32 v102, v160, v161
    v_mov_b32 v103, s93
    v_mov_b32 v106, s93
    v_mov_b32 v107, s93
    v_lshlrev_b32 v183, 4, v0
    s_lshl_b32 s80, s2, 11
    buffer_store_dwordx4 v[100:103], v183, s[52:55], s80 offen offset:0 sc0 sc1
    s_mov_b64 exec, 1
    buffer_store_dwordx4 v[104:107], v183, s[52:55], s80 offen offset:1024 sc0 sc1
    s_mov_b64 exec, -1
    s_endpgm
L_service:
    v_lshlrev_b32 v5, 2, v0
    v_mov_b32 v3, 0
    ds_write_b32 v5, v3 offset:0
    v_lshlrev_b32 v1, 4, v0
    v_mov_b32 v2, v1
    v_lshlrev_b32 v28, 11, v0
    v_mov_b32 v4, 0
    v_mov_b32 v9, 0xf149f2ca
    v_cndmask_b32 v9, v9, v3, s[66:67]
    v_and_b32 v5, 15, v0
    v_lshrrev_b32 v6, 4, v0
    v_lshl_add_u32 v10, v5, 2, v6
    v_lshlrev_b32 v10, 1, v10
    s_getreg_b32 s72, hwreg(HW_REG_XCC_ID)
    s_and_b32 s72, s72, 15
    s_lshl_b32 s77, s2, 11
    s_add_u32 s77, s77, 2097152
    s_lshl_b32 s94, s79, 17
    s_add_u32 s94, s94, 2097152
    s_mov_b32 s71, 0
    s_mov_b32 s76, 0
    s_mov_b32 s95, 0
    s_waitcnt lgkmcnt(0)
    s_barrier
    s_mov_b32 s52, s22
    s_and_b32 s53, s23, 0xffff
    s_mov_b32 s54, 25165824
    s_mov_b32 s55, 0x00020000
    s_mov_b32 s56, s18
    s_and_b32 s57, s19, 0xffff
    s_mov_b32 s58, 12288
    s_mov_b32 s59, 0x00020000
L_poll:
    ds_read_b32 v5, v4
    s_waitcnt lgkmcnt(0)
    v_readfirstlane_b32 s80, v5
    s_cmp_eq_u32 s80, 0
    s_cbranch_scc1 L_poll
    ds_read_b128 v[12:15], v2 offset:768
    s_cmp_lg_u32 s71, 0
    s_cbranch_scc1 L_guard
L_tag:
    ds_read_b32 v5, v3 offset:136
    s_waitcnt lgkmcnt(0)
    v_readfirstlane_b32 s69, v5
    s_cmp_eq_u32 s69, 0
    s_cbranch_scc1 L_tag
    s_lshl_b32 s81, s79, 17
L_reg:
    buffer_load_dwordx2 v[16:17], v28, s[52:55], s81 offen offset:1536 sc0 sc1
    s_waitcnt vmcnt(0)
    v_cmp_ne_u32 vcc, s69, v17
    s_cmp_lg_u64 vcc, 0
    s_cbranch_scc1 L_reg
    ds_write_b32 v3, v17 offset:140
    s_mov_b32 s95, s69
    v_cmp_eq_u32 s[86:87], s72, v16
    v_lshlrev_b32 v7, v16, 1
    s_nop 1
    v_or_b32_dpp v7, v7, v7 row_ror:8 row_mask:0xf bank_mask:0xf
    s_nop 1
    v_or_b32_dpp v7, v7, v7 row_ror:4 row_mask:0xf bank_mask:0xf
    s_nop 1
    v_or_b32_dpp v7, v7, v7 row_ror:2 row_mask:0xf bank_mask:0xf
    s_nop 1
    v_or_b32_dpp v7, v7, v7 row_ror:1 row_mask:0xf bank_mask:0xf
    v_mov_b32 v5, v7
    s_nop 1
    v_permlane32_swap_b32 v7, v5
    s_nop 1
    v_or_b32 v7, v7, v5
    v_mov_b32 v5, v7
    s_nop 1
    v_permlane16_swap_b32 v7, v5
    s_nop 1
    v_or_b32 v7, v7, v5
    s_bcnt1_i32_b64 s70, s[86:87]
    s_bfm_b64 s[84:85], s92, 0
    s_and_b64 s[84:85], s[84:85], s[86:87]
    s_bcnt1_i32_b64 s73, s[84:85]
    v_readfirstlane_b32 s88, v7
    s_mov_b32 s89, 0
    s_branch L_dep
L_guard:
    v_mov_b32 v17, s69
    s_mov_b64 exec, s[86:87]
    buffer_load_dwordx2 v[16:17], v28, s[52:55], s94 offen offset:1024 sc0 sc1
    s_mov_b64 exec, -1
    s_waitcnt vmcnt(0)
    v_cmp_eq_u32 vcc, s95, v17
    s_cmp_eq_u64 vcc, 0
    s_cbranch_scc1 L_guard
L_dep:
    s_add_u32 s71, s71, 1
    s_add_u32 s95, s95, 1
    s_waitcnt lgkmcnt(0)
    buffer_store_dwordx4 v[12:15], v1, s[52:55], s77 offen
    v_mov_b32 v6, s95
    s_mov_b64 exec, 1
    s_waitcnt vmcnt(0)
    buffer_store_dword v6, v3, s[52:55], s77 offen offset:1024
    s_mov_b64 exec, -1
    s_cmp_lg_u32 s76, s73
    s_cbranch_scc1 L_next
L_all:
    v_mov_b32 v16, s95
    s_mov_b64 exec, s[86:87]
    buffer_load_dword v16, v28, s[52:55], s94 offen offset:1024 sc0 sc1
    s_mov_b64 exec, -1
    s_waitcnt vmcnt(0)
    v_cmp_ne_u32 vcc, s95, v16
    s_cmp_lg_u64 vcc, 0
    s_cbranch_scc1 L_all
    s_mov_b32 s74, 0
    s_mov_b32 s75, s94
    s_mov_b64 s[84:85], s[86:87]
L_merge:
    v_mov_b32 v7, 0xf149f2ca
    v_mov_b32 v8, 0
    v_mov_b32 v12, 0
    v_mov_b32 v13, 0
    v_mov_b32 v14, 0
L_chunk:
    v_mov_b32 v48, 0
    v_mov_b32 v49, 0
    v_mov_b32 v50, 0
    v_mov_b32 v51, v9
    v_mov_b32 v52, 0
    v_mov_b32 v53, 0
    v_mov_b32 v54, 0
    v_mov_b32 v55, v9
    v_mov_b32 v56, 0
    v_mov_b32 v57, 0
    v_mov_b32 v58, 0
    v_mov_b32 v59, v9
    v_mov_b32 v60, 0
    v_mov_b32 v61, 0
    v_mov_b32 v62, 0
    v_mov_b32 v63, v9
    v_mov_b32 v64, 0
    v_mov_b32 v65, 0
    v_mov_b32 v66, 0
    v_mov_b32 v67, v9
    v_mov_b32 v68, 0
    v_mov_b32 v69, 0
    v_mov_b32 v70, 0
    v_mov_b32 v71, v9
    v_mov_b32 v72, 0
    v_mov_b32 v73, 0
    v_mov_b32 v74, 0
    v_mov_b32 v75, v9
    v_mov_b32 v76, 0
    v_mov_b32 v77, 0
    v_mov_b32 v78, 0
    v_mov_b32 v79, v9
    s_ff1_i32_b64 s80, s[84:85]
    s_bitset0_b64 s[84:85], s80
    s_lshl_b32 s81, s80, 11
    s_add_u32 s81, s81, s75
    s_cmp_ge_i32 s80, 0
    s_cselect_b64 exec, -1, 0
    buffer_load_dwordx4 v[48:51], v1, s[52:55], s81 offen sc0 sc1
    s_ff1_i32_b64 s80, s[84:85]
    s_bitset0_b64 s[84:85], s80
    s_lshl_b32 s81, s80, 11
    s_add_u32 s81, s81, s75
    s_cmp_ge_i32 s80, 0
    s_cselect_b64 exec, -1, 0
    buffer_load_dwordx4 v[52:55], v1, s[52:55], s81 offen sc0 sc1
    s_ff1_i32_b64 s80, s[84:85]
    s_bitset0_b64 s[84:85], s80
    s_lshl_b32 s81, s80, 11
    s_add_u32 s81, s81, s75
    s_cmp_ge_i32 s80, 0
    s_cselect_b64 exec, -1, 0
    buffer_load_dwordx4 v[56:59], v1, s[52:55], s81 offen sc0 sc1
    s_ff1_i32_b64 s80, s[84:85]
    s_bitset0_b64 s[84:85], s80
    s_lshl_b32 s81, s80, 11
    s_add_u32 s81, s81, s75
    s_cmp_ge_i32 s80, 0
    s_cselect_b64 exec, -1, 0
    buffer_load_dwordx4 v[60:63], v1, s[52:55], s81 offen sc0 sc1
    s_ff1_i32_b64 s80, s[84:85]
    s_bitset0_b64 s[84:85], s80
    s_lshl_b32 s81, s80, 11
    s_add_u32 s81, s81, s75
    s_cmp_ge_i32 s80, 0
    s_cselect_b64 exec, -1, 0
    buffer_load_dwordx4 v[64:67], v1, s[52:55], s81 offen sc0 sc1
    s_ff1_i32_b64 s80, s[84:85]
    s_bitset0_b64 s[84:85], s80
    s_lshl_b32 s81, s80, 11
    s_add_u32 s81, s81, s75
    s_cmp_ge_i32 s80, 0
    s_cselect_b64 exec, -1, 0
    buffer_load_dwordx4 v[68:71], v1, s[52:55], s81 offen sc0 sc1
    s_ff1_i32_b64 s80, s[84:85]
    s_bitset0_b64 s[84:85], s80
    s_lshl_b32 s81, s80, 11
    s_add_u32 s81, s81, s75
    s_cmp_ge_i32 s80, 0
    s_cselect_b64 exec, -1, 0
    buffer_load_dwordx4 v[72:75], v1, s[52:55], s81 offen sc0 sc1
    s_ff1_i32_b64 s80, s[84:85]
    s_bitset0_b64 s[84:85], s80
    s_lshl_b32 s81, s80, 11
    s_add_u32 s81, s81, s75
    s_cmp_ge_i32 s80, 0
    s_cselect_b64 exec, -1, 0
    buffer_load_dwordx4 v[76:79], v1, s[52:55], s81 offen sc0 sc1
    s_mov_b64 exec, -1
    s_waitcnt vmcnt(0)
    v_max3_f32 v5, v51, v55, v59
    v_max3_f32 v5, v5, v63, v67
    v_max3_f32 v5, v5, v71, v75
    v_max_f32 v5, v5, v79
    s_nop 1
    v_max_f32_dpp v6, v5, v7 quad_perm:[0,0,2,2] row_mask:0xf bank_mask:0xf
    v_sub_f32 v5, v7, v6
    v_exp_f32 v5, v5
    v_sub_f32_dpp v20, v51, v6 quad_perm:[0,0,2,2] row_mask:0xf bank_mask:0xf
    v_sub_f32_dpp v21, v55, v6 quad_perm:[0,0,2,2] row_mask:0xf bank_mask:0xf
    v_sub_f32_dpp v22, v59, v6 quad_perm:[0,0,2,2] row_mask:0xf bank_mask:0xf
    v_sub_f32_dpp v23, v63, v6 quad_perm:[0,0,2,2] row_mask:0xf bank_mask:0xf
    v_sub_f32_dpp v24, v67, v6 quad_perm:[0,0,2,2] row_mask:0xf bank_mask:0xf
    v_sub_f32_dpp v25, v71, v6 quad_perm:[0,0,2,2] row_mask:0xf bank_mask:0xf
    v_sub_f32_dpp v26, v75, v6 quad_perm:[0,0,2,2] row_mask:0xf bank_mask:0xf
    v_sub_f32_dpp v27, v79, v6 quad_perm:[0,0,2,2] row_mask:0xf bank_mask:0xf
    v_exp_f32 v20, v20
    v_exp_f32 v21, v21
    v_exp_f32 v22, v22
    v_exp_f32 v23, v23
    v_exp_f32 v24, v24
    v_exp_f32 v25, v25
    v_exp_f32 v26, v26
    v_exp_f32 v27, v27
    v_mov_b32 v7, v6
    v_mul_f32 v8, v8, v5
    v_mul_f32 v12, v12, v5
    v_mul_f32 v13, v13, v5
    v_mul_f32 v14, v14, v5
    v_fmac_f32 v12, v20, v48
    v_fmac_f32 v13, v20, v49
    v_fmac_f32 v14, v20, v50
    v_fmac_f32 v8, v20, v51
    v_fmac_f32 v12, v21, v52
    v_fmac_f32 v13, v21, v53
    v_fmac_f32 v14, v21, v54
    v_fmac_f32 v8, v21, v55
    v_fmac_f32 v12, v22, v56
    v_fmac_f32 v13, v22, v57
    v_fmac_f32 v14, v22, v58
    v_fmac_f32 v8, v22, v59
    v_fmac_f32 v12, v23, v60
    v_fmac_f32 v13, v23, v61
    v_fmac_f32 v14, v23, v62
    v_fmac_f32 v8, v23, v63
    v_fmac_f32 v12, v24, v64
    v_fmac_f32 v13, v24, v65
    v_fmac_f32 v14, v24, v66
    v_fmac_f32 v8, v24, v67
    v_fmac_f32 v12, v25, v68
    v_fmac_f32 v13, v25, v69
    v_fmac_f32 v14, v25, v70
    v_fmac_f32 v8, v25, v71
    v_fmac_f32 v12, v26, v72
    v_fmac_f32 v13, v26, v73
    v_fmac_f32 v14, v26, v74
    v_fmac_f32 v8, v26, v75
    v_fmac_f32 v12, v27, v76
    v_fmac_f32 v13, v27, v77
    v_fmac_f32 v14, v27, v78
    v_fmac_f32 v8, v27, v79
    s_cmp_lg_u64 s[84:85], 0
    s_cbranch_scc1 L_chunk
    s_cmp_lg_u32 s74, 0
    s_cbranch_scc1 L_fin
    v_cndmask_b32 v15, v7, v8, s[66:67]
    v_mov_b32 v5, s95
    v_mov_b32 v6, s70
    s_lshl_b32 s75, s79, 15
    s_add_u32 s75, s75, 1048576
    s_lshl_b32 s80, s72, 11
    s_add_u32 s80, s80, s75
    buffer_store_dwordx4 v[12:15], v1, s[52:55], s80 offen sc0 sc1
    s_mov_b64 exec, 1
    buffer_store_dword v5, v3, s[52:55], s77 offen offset:1028
    s_lshl_b32 s80, s79, 8
    s_add_u32 s80, s80, 23076864
    s_waitcnt vmcnt(0)
    buffer_atomic_add v6, v3, s[52:55], s80 offen sc0 sc1
    s_waitcnt vmcnt(0)
    s_mov_b64 exec, -1
    v_readfirstlane_b32 s80, v6
    s_add_u32 s80, s80, s70
    s_cmp_lg_u32 s80, 64
    s_cbranch_scc1 L_next
    s_mov_b32 s74, 1
    s_mov_b64 s[84:85], s[88:89]
    s_branch L_merge
L_fin:
    s_nop 1
    v_mov_b32_dpp v5, v8 quad_perm:[1,1,3,3] row_mask:0xf bank_mask:0xf
    v_rcp_f32 v5, v5
    s_mul_i32 s80, s79, 384
    v_mul_f32 v12, v12, v5
    v_mul_f32 v13, v13, v5
    v_mul_f32 v14, v14, v5
    v_cvt_pk_bf16_f32 v12, v12, v12
    v_cvt_pk_bf16_f32 v13, v13, v13
    v_cvt_pk_bf16_f32 v14, v14, v14
    buffer_store_short v12, v10, s[56:59], s80 offen offset:0
    buffer_store_short v13, v10, s[56:59], s80 offen offset:128
    buffer_store_short v14, v10, s[56:59], s80 offen offset:256
L_next:
    v_add_u32 v2, 1024, v2
    v_add_u32 v4, 4, v4
    s_add_u32 s79, s79, 4
    s_add_u32 s76, s76, 1
    s_cmp_eq_u32 s76, s70
    s_cselect_b32 s76, 0, s76
    s_cmp_lt_u32 s71, 7
    s_cbranch_scc1 L_poll
    s_lshr_b32 s78, s92, 4
    s_lshr_b32 s81, s2, 6
    s_mul_i32 s80, s78, 5
    s_mul_i32 s82, s81, 3
    s_add_u32 s80, s80, s82
    s_add_u32 s80, s80, 1
    s_xor_b32 s80, s80, s92
    s_and_b32 s80, s80, 15
    s_cbranch_scc1 L_end
    s_lshl_b32 s75, s81, 17
    v_and_b32 v5, 15, v0
    v_lshrrev_b32 v6, 4, v0
    v_lshlrev_b32 v28, 11, v6
    v_lshl_add_u32 v44, v5, 13, v28
    v_lshl_add_u32 v28, v5, 4, v28
    s_lshl_b32 s80, s78, 8
    v_add_u32 v28, s80, v28
    v_add_u32 v29, 8192, v28
    v_add_u32 v30, 16384, v28
    v_add_u32 v31, 24576, v28
    v_add_u32 v32, 32768, v28
    v_add_u32 v33, 40960, v28
    v_add_u32 v34, 49152, v28
    v_add_u32 v35, 57344, v28
    v_add_u32 v36, 65536, v28
    v_add_u32 v37, 73728, v28
    v_add_u32 v38, 81920, v28
    v_add_u32 v39, 90112, v28
    v_add_u32 v40, 98304, v28
    v_add_u32 v41, 106496, v28
    v_add_u32 v42, 114688, v28
    v_add_u32 v43, 122880, v28
    v_mov_b32 v51, 0
    v_mov_b32 v55, 0
    v_mov_b32 v59, 0
    v_mov_b32 v63, 0
    v_mov_b32 v67, 0
    v_mov_b32 v71, 0
    v_mov_b32 v75, 0
    v_mov_b32 v79, 0
    v_mov_b32 v83, 0
    v_mov_b32 v87, 0
    v_mov_b32 v91, 0
    v_mov_b32 v95, 0
    v_mov_b32 v99, 0
    v_mov_b32 v103, 0
    v_mov_b32 v107, 0
    v_mov_b32 v111, 0
    v_mov_b32 v19, 0
    v_lshlrev_b32 v10, 3, v5
    s_lshl_b32 s80, s78, 1
    s_mul_i32 s78, s79, 384
    s_add_u32 s78, s78, s80
L_dt:
    ds_read_b32 v5, v3 offset:144
    s_waitcnt lgkmcnt(0)
    v_readfirstlane_b32 s80, v5
    s_cmp_eq_u32 s80, 0
    s_cbranch_scc1 L_dt
L_pp:
    v_cmp_ne_u32 s[24:25], s69, v51
    v_cmp_ne_u32 s[26:27], s69, v55
    v_cmp_ne_u32 s[28:29], s69, v59
    v_cmp_ne_u32 s[30:31], s69, v63
    v_cmp_ne_u32 s[32:33], s69, v67
    v_cmp_ne_u32 s[34:35], s69, v71
    v_cmp_ne_u32 s[36:37], s69, v75
    v_cmp_ne_u32 s[38:39], s69, v79
    v_cmp_ne_u32 s[40:41], s69, v83
    v_cmp_ne_u32 s[42:43], s69, v87
    v_cmp_ne_u32 s[44:45], s69, v91
    v_cmp_ne_u32 s[46:47], s69, v95
    v_cmp_ne_u32 s[48:49], s69, v99
    v_cmp_ne_u32 s[50:51], s69, v103
    v_cmp_ne_u32 s[4:5], s69, v107
    v_cmp_ne_u32 s[6:7], s69, v111
    v_cmp_ne_u32 s[8:9], s69, v19
    s_or_b64 s[90:91], s[24:25], s[26:27]
    s_or_b64 s[90:91], s[90:91], s[28:29]
    s_or_b64 s[90:91], s[90:91], s[30:31]
    s_or_b64 s[90:91], s[90:91], s[32:33]
    s_or_b64 s[90:91], s[90:91], s[34:35]
    s_or_b64 s[90:91], s[90:91], s[36:37]
    s_or_b64 s[90:91], s[90:91], s[38:39]
    s_or_b64 s[90:91], s[90:91], s[40:41]
    s_or_b64 s[90:91], s[90:91], s[42:43]
    s_or_b64 s[90:91], s[90:91], s[44:45]
    s_or_b64 s[90:91], s[90:91], s[46:47]
    s_or_b64 s[90:91], s[90:91], s[48:49]
    s_or_b64 s[90:91], s[90:91], s[50:51]
    s_or_b64 s[90:91], s[90:91], s[4:5]
    s_or_b64 s[90:91], s[90:91], s[6:7]
    s_or_b64 s[90:91], s[90:91], s[8:9]
    s_cbranch_scc0 L_pd
    s_mov_b64 exec, s[8:9]
    buffer_load_dwordx4 v[16:19], v44, s[52:55], s75 offen offset:1024 sc0 sc1
    s_mov_b64 exec, s[24:25]
    buffer_load_dwordx4 v[48:51], v28, s[52:55], s75 offen offset:0 sc0 sc1
    s_mov_b64 exec, s[26:27]
    buffer_load_dwordx4 v[52:55], v29, s[52:55], s75 offen offset:0 sc0 sc1
    s_mov_b64 exec, s[28:29]
    buffer_load_dwordx4 v[56:59], v30, s[52:55], s75 offen offset:0 sc0 sc1
    s_mov_b64 exec, s[30:31]
    buffer_load_dwordx4 v[60:63], v31, s[52:55], s75 offen offset:0 sc0 sc1
    s_mov_b64 exec, s[32:33]
    buffer_load_dwordx4 v[64:67], v32, s[52:55], s75 offen offset:0 sc0 sc1
    s_mov_b64 exec, s[34:35]
    buffer_load_dwordx4 v[68:71], v33, s[52:55], s75 offen offset:0 sc0 sc1
    s_mov_b64 exec, s[36:37]
    buffer_load_dwordx4 v[72:75], v34, s[52:55], s75 offen offset:0 sc0 sc1
    s_mov_b64 exec, s[38:39]
    buffer_load_dwordx4 v[76:79], v35, s[52:55], s75 offen offset:0 sc0 sc1
    s_mov_b64 exec, s[40:41]
    buffer_load_dwordx4 v[80:83], v36, s[52:55], s75 offen offset:0 sc0 sc1
    s_mov_b64 exec, s[42:43]
    buffer_load_dwordx4 v[84:87], v37, s[52:55], s75 offen offset:0 sc0 sc1
    s_mov_b64 exec, s[44:45]
    buffer_load_dwordx4 v[88:91], v38, s[52:55], s75 offen offset:0 sc0 sc1
    s_mov_b64 exec, s[46:47]
    buffer_load_dwordx4 v[92:95], v39, s[52:55], s75 offen offset:0 sc0 sc1
    s_mov_b64 exec, s[48:49]
    buffer_load_dwordx4 v[96:99], v40, s[52:55], s75 offen offset:0 sc0 sc1
    s_mov_b64 exec, s[50:51]
    buffer_load_dwordx4 v[100:103], v41, s[52:55], s75 offen offset:0 sc0 sc1
    s_mov_b64 exec, s[4:5]
    buffer_load_dwordx4 v[104:107], v42, s[52:55], s75 offen offset:0 sc0 sc1
    s_mov_b64 exec, s[6:7]
    buffer_load_dwordx4 v[108:111], v43, s[52:55], s75 offen offset:0 sc0 sc1
    s_mov_b64 exec, -1
    s_waitcnt vmcnt(0)
    s_branch L_pp
L_pd:
    v_mov_b32 v7, v16
    s_nop 1
    v_max_f32_dpp v7, v7, v7 row_ror:8 row_mask:0xf bank_mask:0xf
    s_nop 1
    v_max_f32_dpp v7, v7, v7 row_ror:4 row_mask:0xf bank_mask:0xf
    s_nop 1
    v_max_f32_dpp v7, v7, v7 row_ror:2 row_mask:0xf bank_mask:0xf
    s_nop 1
    v_max_f32_dpp v7, v7, v7 row_ror:1 row_mask:0xf bank_mask:0xf
    v_mov_b32 v5, v7
    s_nop 1
    v_permlane32_swap_b32 v7, v5
    s_nop 1
    v_max_f32 v7, v7, v5
    v_mov_b32 v5, v7
    s_nop 1
    v_permlane16_swap_b32 v7, v5
    s_nop 1
    v_max_f32 v7, v7, v5
    v_sub_f32 v6, v16, v7
    v_exp_f32 v6, v6
    v_mov_b32 v12, 0
    v_mov_b32 v13, 0
    v_mov_b32 v14, 0
    v_mul_f32 v8, v6, v17
    v_fmac_f32_dpp v12, v6, v48 row_newbcast:0 row_mask:0xf bank_mask:0xf
    v_fmac_f32_dpp v13, v6, v49 row_newbcast:0 row_mask:0xf bank_mask:0xf
    v_fmac_f32_dpp v14, v6, v50 row_newbcast:0 row_mask:0xf bank_mask:0xf
    v_fmac_f32_dpp v12, v6, v52 row_newbcast:1 row_mask:0xf bank_mask:0xf
    v_fmac_f32_dpp v13, v6, v53 row_newbcast:1 row_mask:0xf bank_mask:0xf
    v_fmac_f32_dpp v14, v6, v54 row_newbcast:1 row_mask:0xf bank_mask:0xf
    v_fmac_f32_dpp v12, v6, v56 row_newbcast:2 row_mask:0xf bank_mask:0xf
    v_fmac_f32_dpp v13, v6, v57 row_newbcast:2 row_mask:0xf bank_mask:0xf
    v_fmac_f32_dpp v14, v6, v58 row_newbcast:2 row_mask:0xf bank_mask:0xf
    v_fmac_f32_dpp v12, v6, v60 row_newbcast:3 row_mask:0xf bank_mask:0xf
    v_fmac_f32_dpp v13, v6, v61 row_newbcast:3 row_mask:0xf bank_mask:0xf
    v_fmac_f32_dpp v14, v6, v62 row_newbcast:3 row_mask:0xf bank_mask:0xf
    v_fmac_f32_dpp v12, v6, v64 row_newbcast:4 row_mask:0xf bank_mask:0xf
    v_fmac_f32_dpp v13, v6, v65 row_newbcast:4 row_mask:0xf bank_mask:0xf
    v_fmac_f32_dpp v14, v6, v66 row_newbcast:4 row_mask:0xf bank_mask:0xf
    v_fmac_f32_dpp v12, v6, v68 row_newbcast:5 row_mask:0xf bank_mask:0xf
    v_fmac_f32_dpp v13, v6, v69 row_newbcast:5 row_mask:0xf bank_mask:0xf
    v_fmac_f32_dpp v14, v6, v70 row_newbcast:5 row_mask:0xf bank_mask:0xf
    v_fmac_f32_dpp v12, v6, v72 row_newbcast:6 row_mask:0xf bank_mask:0xf
    v_fmac_f32_dpp v13, v6, v73 row_newbcast:6 row_mask:0xf bank_mask:0xf
    v_fmac_f32_dpp v14, v6, v74 row_newbcast:6 row_mask:0xf bank_mask:0xf
    v_fmac_f32_dpp v12, v6, v76 row_newbcast:7 row_mask:0xf bank_mask:0xf
    v_fmac_f32_dpp v13, v6, v77 row_newbcast:7 row_mask:0xf bank_mask:0xf
    v_fmac_f32_dpp v14, v6, v78 row_newbcast:7 row_mask:0xf bank_mask:0xf
    v_fmac_f32_dpp v12, v6, v80 row_newbcast:8 row_mask:0xf bank_mask:0xf
    v_fmac_f32_dpp v13, v6, v81 row_newbcast:8 row_mask:0xf bank_mask:0xf
    v_fmac_f32_dpp v14, v6, v82 row_newbcast:8 row_mask:0xf bank_mask:0xf
    v_fmac_f32_dpp v12, v6, v84 row_newbcast:9 row_mask:0xf bank_mask:0xf
    v_fmac_f32_dpp v13, v6, v85 row_newbcast:9 row_mask:0xf bank_mask:0xf
    v_fmac_f32_dpp v14, v6, v86 row_newbcast:9 row_mask:0xf bank_mask:0xf
    v_fmac_f32_dpp v12, v6, v88 row_newbcast:10 row_mask:0xf bank_mask:0xf
    v_fmac_f32_dpp v13, v6, v89 row_newbcast:10 row_mask:0xf bank_mask:0xf
    v_fmac_f32_dpp v14, v6, v90 row_newbcast:10 row_mask:0xf bank_mask:0xf
    v_fmac_f32_dpp v12, v6, v92 row_newbcast:11 row_mask:0xf bank_mask:0xf
    v_fmac_f32_dpp v13, v6, v93 row_newbcast:11 row_mask:0xf bank_mask:0xf
    v_fmac_f32_dpp v14, v6, v94 row_newbcast:11 row_mask:0xf bank_mask:0xf
    v_fmac_f32_dpp v12, v6, v96 row_newbcast:12 row_mask:0xf bank_mask:0xf
    v_fmac_f32_dpp v13, v6, v97 row_newbcast:12 row_mask:0xf bank_mask:0xf
    v_fmac_f32_dpp v14, v6, v98 row_newbcast:12 row_mask:0xf bank_mask:0xf
    v_fmac_f32_dpp v12, v6, v100 row_newbcast:13 row_mask:0xf bank_mask:0xf
    v_fmac_f32_dpp v13, v6, v101 row_newbcast:13 row_mask:0xf bank_mask:0xf
    v_fmac_f32_dpp v14, v6, v102 row_newbcast:13 row_mask:0xf bank_mask:0xf
    v_fmac_f32_dpp v12, v6, v104 row_newbcast:14 row_mask:0xf bank_mask:0xf
    v_fmac_f32_dpp v13, v6, v105 row_newbcast:14 row_mask:0xf bank_mask:0xf
    v_fmac_f32_dpp v14, v6, v106 row_newbcast:14 row_mask:0xf bank_mask:0xf
    v_fmac_f32_dpp v12, v6, v108 row_newbcast:15 row_mask:0xf bank_mask:0xf
    v_fmac_f32_dpp v13, v6, v109 row_newbcast:15 row_mask:0xf bank_mask:0xf
    v_fmac_f32_dpp v14, v6, v110 row_newbcast:15 row_mask:0xf bank_mask:0xf
    s_nop 1
    v_add_f32_dpp v8, v8, v8 row_ror:8 row_mask:0xf bank_mask:0xf
    s_nop 1
    v_add_f32_dpp v8, v8, v8 row_ror:4 row_mask:0xf bank_mask:0xf
    s_nop 1
    v_add_f32_dpp v8, v8, v8 row_ror:2 row_mask:0xf bank_mask:0xf
    s_nop 1
    v_add_f32_dpp v8, v8, v8 row_ror:1 row_mask:0xf bank_mask:0xf
    v_mov_b32 v5, v8
    s_nop 1
    v_permlane32_swap_b32 v8, v5
    s_nop 1
    v_add_f32 v8, v8, v5
    v_mov_b32 v5, v8
    s_nop 1
    v_permlane16_swap_b32 v8, v5
    s_nop 1
    v_add_f32 v8, v8, v5
    v_rcp_f32 v8, v8
    v_mov_b32 v20, v12
    v_mov_b32 v21, v13
    v_mov_b32 v22, v14
    s_nop 1
    v_permlane32_swap_b32 v12, v20
    v_permlane32_swap_b32 v13, v21
    v_permlane32_swap_b32 v14, v22
    s_nop 1
    v_add_f32 v12, v12, v20
    v_add_f32 v13, v13, v21
    v_add_f32 v14, v14, v22
    v_mov_b32 v20, v12
    v_mov_b32 v21, v13
    v_mov_b32 v22, v14
    s_nop 1
    v_permlane16_swap_b32 v12, v20
    v_permlane16_swap_b32 v13, v21
    v_permlane16_swap_b32 v14, v22
    s_nop 1
    v_add_f32 v12, v12, v20
    v_add_f32 v13, v13, v21
    v_add_f32 v14, v14, v22
    v_mul_f32 v12, v12, v8
    v_mul_f32 v13, v13, v8
    v_mul_f32 v14, v14, v8
    v_cvt_pk_bf16_f32 v12, v12, v12
    v_cvt_pk_bf16_f32 v13, v13, v13
    v_cvt_pk_bf16_f32 v14, v14, v14
    s_mov_b64 exec, 0xffff
    buffer_store_short v12, v10, s[56:59], s78 offen offset:0
    buffer_store_short v13, v10, s[56:59], s78 offen offset:128
    buffer_store_short v14, v10, s[56:59], s78 offen offset:256
L_end:
    s_endpgm
L_ticket:
    v_lshlrev_b32 v1, 2, v0
    v_mov_b32 v2, 0
    v_mov_b32 v3, -1
    ds_write_b32 v1, v3 offset:256
    ds_write_b32 v1, v3 offset:512
    v_lshlrev_b32 v4, 4, v0
    s_memrealtime s[80:81]
    s_waitcnt lgkmcnt(0)
    s_barrier
    s_mov_b32 s52, s22
    s_and_b32 s53, s23, 0xffff
    s_mov_b32 s54, 25165824
    s_mov_b32 s55, 0x00020000
    s_mov_b32 s60, s20
    s_and_b32 s61, s21, 0xffff
    s_mov_b32 s62, 256
    s_mov_b32 s63, 0x00020000
    s_max_u32 s69, s80, 1
    s_cmp_lg_u32 s2, 0
    s_cbranch_scc1 L_kd
    v_lshlrev_b32 v5, 8, v0
    s_mov_b32 s80, 23068672
    buffer_store_dword v2, v5, s[52:55], s80 offen sc0 sc1
    v_mov_b32 v3, s69
    s_mov_b64 exec, 1
    s_waitcnt vmcnt(0)
    buffer_store_dword v3, v2, s[60:63], 0 offen sc0 sc1
    s_mov_b64 exec, -1
L_kd:
    ds_read_b32 v3, v2 offset:128
    s_waitcnt lgkmcnt(0)
    v_readfirstlane_b32 s80, v3
    s_cmp_eq_u32 s80, 0
    s_cbranch_scc1 L_kd
    ds_read_b128 v[8:11], v4 offset:24064
    ds_read_b128 v[12:15], v4 offset:25088
    s_lshl_b32 s80, s2, 11
    s_add_u32 s80, s80, 18874368
    s_waitcnt lgkmcnt(0)
    buffer_store_dwordx4 v[8:11], v4, s[52:55], s80 offen offset:0 sc0 sc1
    s_bfm_b64 exec, 16, 0
    buffer_store_dwordx4 v[12:15], v4, s[52:55], s80 offen offset:1024 sc0 sc1
    s_mov_b64 exec, -1
L_tg:
    buffer_load_dword v3, v2, s[60:63], 0 offen sc0 sc1
    s_waitcnt vmcnt(0)
    v_readfirstlane_b32 s69, v3
    s_cmp_eq_u32 s69, 0
    s_cbranch_scc1 L_tg
    ds_write_b32 v2, v3 offset:136
    s_getreg_b32 s81, hwreg(HW_REG_XCC_ID)
    s_and_b32 s81, s81, 15
    v_mov_b32 v16, s81
    v_mov_b32 v17, s69
    s_lshl_b32 s80, s2, 11
    s_mov_b64 exec, 1
    buffer_store_dwordx2 v[16:17], v2, s[52:55], s80 offen offset:1536 sc0 sc1
    s_lshr_b32 s82, s2, 3
    s_lshl_b32 s82, s82, 8
    s_add_u32 s82, s82, 23068672
    s_mov_b32 s70, 1
    v_mov_b32 v5, 260
L_rq:
    ds_read_b32 v3, v2 offset:132
    s_waitcnt lgkmcnt(0)
    v_readfirstlane_b32 s80, v3
    s_cmp_lt_u32 s80, s70
    s_cbranch_scc1 L_rq
    v_mov_b32 v3, 1
    buffer_atomic_add v3, v2, s[52:55], s82 offen sc0 sc1
    s_waitcnt vmcnt(0)
    v_add_u32 v3, 8, v3
    ds_write_b32 v5, v3
    v_readfirstlane_b32 s80, v3
    v_add_u32 v5, 4, v5
    s_add_u32 s70, s70, 1
    s_cmp_lt_u32 s80, 40
    s_cbranch_scc1 L_rq
    s_endpgm
.section .rodata,"a"
.p2align 6
.amdhsa_kernel standalone__kv_cache_quant_int4_int2_kv_with_per_channel_or_per_token_scales__decode_kernel
  .amdhsa_next_free_vgpr 189
  .amdhsa_next_free_sgpr 102
  .amdhsa_accum_offset 192
  .amdhsa_group_segment_fixed_size 0
  .amdhsa_kernarg_size 80
  .amdhsa_user_sgpr_count 2
  .amdhsa_user_sgpr_kernarg_segment_ptr 1
  .amdhsa_system_sgpr_workgroup_id_x 1
.end_amdhsa_kernel
```

```asm
; @launch grid=(256,1,1) block=(192,1,1) lds=98304
.amdgcn_target "amdgcn-amd-amdhsa--gfx950"
.text
.globl standalone__kv_cache_quant_int4_int2_kv_with_per_channel_or_per_token_scales__decode_kernel
.p2align 8
.type standalone__kv_cache_quant_int4_int2_kv_with_per_channel_or_per_token_scales__decode_kernel,@function
standalone__kv_cache_quant_int4_int2_kv_with_per_channel_or_per_token_scales__decode_kernel:
    s_cmp_ge_u32 s2, 256
    s_cbranch_scc1 L_end
    s_load_dwordx16 s[4:19], s[0:1], 0
    s_load_dwordx4 s[20:23], s[0:1], 64
    v_lshrrev_b32 v177, 6, v0
    v_and_b32 v0, 63, v0
    v_readfirstlane_b32 s68, v177
    s_lshr_b32 s79, s2, 6
    s_and_b32 s92, s2, 63
    s_mov_b32 s66, 0xaaaaaaaa
    s_mov_b32 s67, 0xaaaaaaaa
    s_cmp_eq_u32 s68, 1
    s_cbranch_scc1 L_service
    s_cmp_eq_u32 s68, 2
    s_cbranch_scc1 L_ticket
    s_setprio 1
    v_and_b32 v183, 15, v0
    v_lshrrev_b32 v182, 4, v0
    v_mul_u32_u24 v1, 768, v182
    v_lshl_add_u32 v1, v183, 4, v1
    v_lshlrev_b32 v2, 3, v183
    v_bfrev_b32 v179, v183
    v_lshrrev_b32 v179, 28, v179
    v_lshl_add_u32 v3, v179, 2, v182
    v_lshlrev_b32 v3, 1, v3
    v_lshlrev_b32 v184, 2, v0
    v_add_u32 v184, 11520, v184
    v_mov_b32 v185, v184
    v_lshlrev_b32 v186, 4, v0
    v_mov_b32 v187, 0
    v_mov_b32 v188, 1
    v_lshlrev_b32 v172, 2, v0
    v_mov_b32 v173, 1
    v_mov_b32 v174, 260
    s_mul_i32 s58, s79, 0
    s_and_b32 s94, s92, 448
    s_add_u32 s94, s94, s58
    s_add_u32 s94, s94, 128
    s_add_u32 s58, s58, s92
    s_and_b32 s58, s58, 511
    s_add_u32 s59, s79, 28
    s_lshl_b32 s59, s59, 9
    s_lshl_b32 s69, s79, 9
    s_mov_b32 s64, 0xcccccccc
    s_mov_b32 s65, 0xcccccccc
    s_mov_b32 s78, 0x3dd53b95
    s_waitcnt lgkmcnt(0)
    s_mov_b32 s24, s6
    s_and_b32 s25, s7, 0xffff
    s_mov_b32 s26, 805306368
    s_mov_b32 s27, 0x00020000
    s_mov_b32 s48, s4
    s_and_b32 s49, s5, 0xffff
    s_mov_b32 s50, 12288
    s_mov_b32 s51, 0x00020000
    s_mov_b32 s32, s10
    s_and_b32 s33, s11, 0xffff
    s_mov_b32 s34, 6291456
    s_mov_b32 s35, 0x00020000
    s_mov_b32 s36, s12
    s_and_b32 s37, s13, 0xffff
    s_mov_b32 s38, 6291456
    s_mov_b32 s39, 0x00020000
    s_mov_b32 s57, s69
    s_mov_b32 s56, s58
    s_mov_b32 s75, 8
    s_add_u32 s70, s57, s56
    s_lshr_b32 s74, s70, 9
    s_mul_i32 s74, s74, 384
    buffer_load_dwordx2 v[144:145], v2, s[48:51], s74 offen offset:0
    buffer_load_dwordx2 v[146:147], v2, s[48:51], s74 offen offset:128
    buffer_load_dwordx2 v[148:149], v2, s[48:51], s74 offen offset:256
    s_mul_i32 s71, s70, 49152
    s_mul_i32 s72, s70, 384
    buffer_load_dwordx2 v[132:133], v2, s[32:35], s72 offen offset:0
    buffer_load_dwordx2 v[134:135], v2, s[32:35], s72 offen offset:128
    buffer_load_dwordx2 v[136:137], v2, s[32:35], s72 offen offset:256
    buffer_load_dwordx2 v[138:139], v2, s[36:39], s72 offen offset:0
    buffer_load_dwordx2 v[140:141], v2, s[36:39], s72 offen offset:128
    buffer_load_dwordx2 v[142:143], v2, s[36:39], s72 offen offset:256
    buffer_load_dwordx4 v[4:7], v1, s[24:27], s71 offen offset:0 nt
    buffer_load_dwordx4 v[8:11], v1, s[24:27], s71 offen offset:256 nt
    buffer_load_dwordx4 v[12:15], v1, s[24:27], s71 offen offset:512 nt
    s_add_u32 s71, s71, 3072
    buffer_load_dwordx4 v[16:19], v1, s[24:27], s71 offen offset:0 nt
    buffer_load_dwordx4 v[20:23], v1, s[24:27], s71 offen offset:256 nt
    buffer_load_dwordx4 v[24:27], v1, s[24:27], s71 offen offset:512 nt
    s_add_u32 s71, s71, 3072
    buffer_load_dwordx4 v[28:31], v1, s[24:27], s71 offen offset:0 nt
    buffer_load_dwordx4 v[32:35], v1, s[24:27], s71 offen offset:256 nt
    buffer_load_dwordx4 v[36:39], v1, s[24:27], s71 offen offset:512 nt
    s_add_u32 s71, s71, 3072
    buffer_load_dwordx4 v[40:43], v1, s[24:27], s71 offen offset:0 nt
    buffer_load_dwordx4 v[44:47], v1, s[24:27], s71 offen offset:256 nt
    buffer_load_dwordx4 v[48:51], v1, s[24:27], s71 offen offset:512 nt
    s_add_u32 s71, s71, 3072
    buffer_load_dwordx4 v[52:55], v1, s[24:27], s71 offen offset:0 nt
    buffer_load_dwordx4 v[56:59], v1, s[24:27], s71 offen offset:256 nt
    buffer_load_dwordx4 v[60:63], v1, s[24:27], s71 offen offset:512 nt
    s_add_u32 s71, s71, 3072
    buffer_load_dwordx4 v[64:67], v1, s[24:27], s71 offen offset:0 nt
    buffer_load_dwordx4 v[68:71], v1, s[24:27], s71 offen offset:256 nt
    buffer_load_dwordx4 v[72:75], v1, s[24:27], s71 offen offset:512 nt
    s_add_u32 s71, s71, 3072
    buffer_load_dwordx4 v[76:79], v1, s[24:27], s71 offen offset:0 nt
    buffer_load_dwordx4 v[80:83], v1, s[24:27], s71 offen offset:256 nt
    buffer_load_dwordx4 v[84:87], v1, s[24:27], s71 offen offset:512 nt
    s_add_u32 s71, s71, 3072
    buffer_load_dwordx4 v[88:91], v1, s[24:27], s71 offen offset:0 nt
    buffer_load_dwordx4 v[92:95], v1, s[24:27], s71 offen offset:256 nt
    s_mov_b32 s28, s8
    s_and_b32 s29, s9, 0xffff
    s_mov_b32 s30, 805306368
    s_mov_b32 s31, 0x00020000
    s_mov_b32 s40, s14
    s_and_b32 s41, s15, 0xffff
    s_mov_b32 s42, 2097152
    s_mov_b32 s43, 0x00020000
    s_mov_b32 s44, s16
    s_and_b32 s45, s17, 0xffff
    s_mov_b32 s46, 2097152
    s_mov_b32 s47, 0x00020000
    s_mov_b32 s52, s22
    s_and_b32 s53, s23, 0xffff
    s_mov_b32 s54, 25165824
    s_mov_b32 s55, 0x00020000
    s_mov_b32 s77, 8
    v_mov_b32 v165, 0xf149f2ca
    v_mov_b32 v166, 0
    v_mov_b32 v167, 0
    v_mov_b32 v152, 0
    v_mov_b32 v153, 0
    v_mov_b32 v154, 0
    v_mov_b32 v155, 0
    v_mov_b32 v156, 0
    v_mov_b32 v157, 0
    v_mov_b32 v158, 0
    v_mov_b32 v159, 0
    v_mov_b32 v160, 0
    v_mov_b32 v161, 0
    v_mov_b32 v162, 0
    v_mov_b32 v163, 0
    s_barrier
    s_mov_b32 s76, 63
L_loop0:
    s_waitcnt vmcnt(29)
    v_lshlrev_b32 v108, 16, v144
    v_and_b32 v109, 0xffff0000, v144
    v_lshlrev_b32 v110, 16, v145
    v_and_b32 v111, 0xffff0000, v145
    v_lshlrev_b32 v112, 16, v146
    v_and_b32 v113, 0xffff0000, v146
    v_lshlrev_b32 v114, 16, v147
    v_and_b32 v115, 0xffff0000, v147
    v_lshlrev_b32 v116, 16, v148
    v_and_b32 v117, 0xffff0000, v148
    v_lshlrev_b32 v118, 16, v149
    v_and_b32 v119, 0xffff0000, v149
    v_mul_f32 v108, s78, v108
    v_mul_f32 v109, s78, v109
    v_mul_f32 v110, s78, v110
    v_mul_f32 v111, s78, v111
    v_mul_f32 v112, s78, v112
    v_mul_f32 v113, s78, v113
    v_mul_f32 v114, s78, v114
    v_mul_f32 v115, s78, v115
    v_mul_f32 v116, s78, v116
    v_mul_f32 v117, s78, v117
    v_mul_f32 v118, s78, v118
    v_mul_f32 v119, s78, v119
    s_waitcnt vmcnt(23)
    v_lshlrev_b32 v182, 16, v132
    v_and_b32 v183, 0xffff0000, v132
    v_mul_f32 v120, v182, v108
    v_mul_f32 v121, v183, v109
    v_lshlrev_b32 v182, 16, v138
    v_and_b32 v183, 0xffff0000, v138
    v_mul_f32 v164, v120, v182
    v_fmac_f32 v164, v121, v183
    v_lshlrev_b32 v182, 16, v133
    v_and_b32 v183, 0xffff0000, v133
    v_mul_f32 v122, v182, v110
    v_mul_f32 v123, v183, v111
    v_lshlrev_b32 v182, 16, v139
    v_and_b32 v183, 0xffff0000, v139
    v_fmac_f32 v164, v122, v182
    v_fmac_f32 v164, v123, v183
    v_lshlrev_b32 v182, 16, v134
    v_and_b32 v183, 0xffff0000, v134
    v_mul_f32 v124, v182, v112
    v_mul_f32 v125, v183, v113
    v_lshlrev_b32 v182, 16, v140
    v_and_b32 v183, 0xffff0000, v140
    v_fmac_f32 v164, v124, v182
    v_fmac_f32 v164, v125, v183
    v_lshlrev_b32 v182, 16, v135
    v_and_b32 v183, 0xffff0000, v135
    v_mul_f32 v126, v182, v114
    v_mul_f32 v127, v183, v115
    v_lshlrev_b32 v182, 16, v141
    v_and_b32 v183, 0xffff0000, v141
    v_fmac_f32 v164, v126, v182
    v_fmac_f32 v164, v127, v183
    v_lshlrev_b32 v182, 16, v136
    v_and_b32 v183, 0xffff0000, v136
    v_mul_f32 v128, v182, v116
    v_mul_f32 v129, v183, v117
    v_lshlrev_b32 v182, 16, v142
    v_and_b32 v183, 0xffff0000, v142
    v_fmac_f32 v164, v128, v182
    v_fmac_f32 v164, v129, v183
    v_lshlrev_b32 v182, 16, v137
    v_and_b32 v183, 0xffff0000, v137
    v_mul_f32 v130, v182, v118
    v_mul_f32 v131, v183, v119
    v_lshlrev_b32 v182, 16, v143
    v_and_b32 v183, 0xffff0000, v143
    v_fmac_f32 v164, v130, v182
    v_fmac_f32 v164, v131, v183
    s_waitcnt vmcnt(22)
    v_cvt_f32_i32 v100, v4
    v_cvt_f32_i32 v101, v5
    v_cvt_f32_i32 v102, v6
    v_cvt_f32_i32 v103, v7
    buffer_load_dwordx4 v[96:99], v1, s[24:27], s71 offen offset:512 nt
    v_fma_f32 v176, v120, v100, -v164
    v_fmac_f32 v176, v121, v101
    v_fmac_f32 v176, v122, v102
    v_fmac_f32 v176, v123, v103
    s_waitcnt vmcnt(22)
    v_cvt_f32_i32 v104, v8
    v_cvt_f32_i32 v105, v9
    v_cvt_f32_i32 v106, v10
    v_cvt_f32_i32 v107, v11
    s_add_u32 s71, s71, 3072
    buffer_load_dwordx4 v[4:7], v1, s[24:27], s71 offen offset:0 nt
    v_fmac_f32 v176, v124, v104
    v_fmac_f32 v176, v125, v105
    v_fmac_f32 v176, v126, v106
    v_fmac_f32 v176, v127, v107
    s_waitcnt vmcnt(22)
    v_cvt_f32_i32 v100, v12
    v_cvt_f32_i32 v101, v13
    v_cvt_f32_i32 v102, v14
    v_cvt_f32_i32 v103, v15
    buffer_load_dwordx4 v[8:11], v1, s[24:27], s71 offen offset:256 nt
    v_fmac_f32 v176, v128, v100
    v_fmac_f32 v176, v129, v101
    v_fmac_f32 v176, v130, v102
    v_fmac_f32 v176, v131, v103
    s_nop 1
    v_add_f32_dpp v177, v176, v176 row_ror:8 row_mask:0xf bank_mask:0x3
    s_waitcnt vmcnt(22)
    v_cvt_f32_i32 v104, v16
    v_cvt_f32_i32 v105, v17
    v_cvt_f32_i32 v106, v18
    v_cvt_f32_i32 v107, v19
    buffer_load_dwordx4 v[12:15], v1, s[24:27], s71 offen offset:512 nt
    v_fma_f32 v176, v120, v104, -v164
    v_fmac_f32 v176, v121, v105
    v_fmac_f32 v176, v122, v106
    v_fmac_f32 v176, v123, v107
    s_waitcnt vmcnt(22)
    v_cvt_f32_i32 v100, v20
    v_cvt_f32_i32 v101, v21
    v_cvt_f32_i32 v102, v22
    v_cvt_f32_i32 v103, v23
    s_add_u32 s71, s71, 3072
    buffer_load_dwordx4 v[16:19], v1, s[24:27], s71 offen offset:0 nt
    v_fmac_f32 v176, v124, v100
    v_fmac_f32 v176, v125, v101
    v_fmac_f32 v176, v126, v102
    v_fmac_f32 v176, v127, v103
    s_waitcnt vmcnt(22)
    v_cvt_f32_i32 v104, v24
    v_cvt_f32_i32 v105, v25
    v_cvt_f32_i32 v106, v26
    v_cvt_f32_i32 v107, v27
    buffer_load_dwordx4 v[20:23], v1, s[24:27], s71 offen offset:256 nt
    v_fmac_f32 v176, v128, v104
    v_fmac_f32 v176, v129, v105
    v_fmac_f32 v176, v130, v106
    v_fmac_f32 v176, v131, v107
    s_nop 1
    v_add_f32_dpp v177, v176, v176 row_ror:8 row_mask:0xf bank_mask:0xc
    s_nop 1
    v_add_f32_dpp v178, v177, v177 row_shl:4 row_mask:0xf bank_mask:0x5
    s_waitcnt vmcnt(22)
    v_cvt_f32_i32 v100, v28
    v_cvt_f32_i32 v101, v29
    v_cvt_f32_i32 v102, v30
    v_cvt_f32_i32 v103, v31
    buffer_load_dwordx4 v[24:27], v1, s[24:27], s71 offen offset:512 nt
    v_fma_f32 v176, v120, v100, -v164
    v_fmac_f32 v176, v121, v101
    v_fmac_f32 v176, v122, v102
    v_fmac_f32 v176, v123, v103
    s_waitcnt vmcnt(22)
    v_cvt_f32_i32 v104, v32
    v_cvt_f32_i32 v105, v33
    v_cvt_f32_i32 v106, v34
    v_cvt_f32_i32 v107, v35
    s_add_u32 s71, s71, 3072
    buffer_load_dwordx4 v[28:31], v1, s[24:27], s71 offen offset:0 nt
    v_fmac_f32 v176, v124, v104
    v_fmac_f32 v176, v125, v105
    v_fmac_f32 v176, v126, v106
    v_fmac_f32 v176, v127, v107
    s_waitcnt vmcnt(22)
    v_cvt_f32_i32 v100, v36
    v_cvt_f32_i32 v101, v37
    v_cvt_f32_i32 v102, v38
    v_cvt_f32_i32 v103, v39
    buffer_load_dwordx4 v[32:35], v1, s[24:27], s71 offen offset:256 nt
    v_fmac_f32 v176, v128, v100
    v_fmac_f32 v176, v129, v101
    v_fmac_f32 v176, v130, v102
    v_fmac_f32 v176, v131, v103
    s_nop 1
    v_add_f32_dpp v177, v176, v176 row_ror:8 row_mask:0xf bank_mask:0x3
    s_waitcnt vmcnt(22)
    v_cvt_f32_i32 v104, v40
    v_cvt_f32_i32 v105, v41
    v_cvt_f32_i32 v106, v42
    v_cvt_f32_i32 v107, v43
    buffer_load_dwordx4 v[36:39], v1, s[24:27], s71 offen offset:512 nt
    v_fma_f32 v176, v120, v104, -v164
    v_fmac_f32 v176, v121, v105
    v_fmac_f32 v176, v122, v106
    v_fmac_f32 v176, v123, v107
    s_waitcnt vmcnt(22)
    v_cvt_f32_i32 v100, v44
    v_cvt_f32_i32 v101, v45
    v_cvt_f32_i32 v102, v46
    v_cvt_f32_i32 v103, v47
    s_add_u32 s71, s71, 3072
    buffer_load_dwordx4 v[40:43], v1, s[24:27], s71 offen offset:0 nt
    v_fmac_f32 v176, v124, v100
    v_fmac_f32 v176, v125, v101
    v_fmac_f32 v176, v126, v102
    v_fmac_f32 v176, v127, v103
    s_waitcnt vmcnt(22)
    v_cvt_f32_i32 v104, v48
    v_cvt_f32_i32 v105, v49
    v_cvt_f32_i32 v106, v50
    v_cvt_f32_i32 v107, v51
    buffer_load_dwordx4 v[44:47], v1, s[24:27], s71 offen offset:256 nt
    v_fmac_f32 v176, v128, v104
    v_fmac_f32 v176, v129, v105
    v_fmac_f32 v176, v130, v106
    v_fmac_f32 v176, v131, v107
    s_nop 1
    v_add_f32_dpp v177, v176, v176 row_ror:8 row_mask:0xf bank_mask:0xc
    s_nop 1
    v_add_f32_dpp v178, v177, v177 row_shr:4 row_mask:0xf bank_mask:0xa
    s_nop 1
    v_add_f32_dpp v179, v178, v178 quad_perm:[2,3,0,1] row_mask:0xf bank_mask:0xf
    s_waitcnt vmcnt(22)
    v_cvt_f32_i32 v100, v52
    v_cvt_f32_i32 v101, v53
    v_cvt_f32_i32 v102, v54
    v_cvt_f32_i32 v103, v55
    buffer_load_dwordx4 v[48:51], v1, s[24:27], s71 offen offset:512 nt
    v_fma_f32 v176, v120, v100, -v164
    v_fmac_f32 v176, v121, v101
    v_fmac_f32 v176, v122, v102
    v_fmac_f32 v176, v123, v103
    s_waitcnt vmcnt(22)
    v_cvt_f32_i32 v104, v56
    v_cvt_f32_i32 v105, v57
    v_cvt_f32_i32 v106, v58
    v_cvt_f32_i32 v107, v59
    s_add_u32 s71, s71, 3072
    buffer_load_dwordx4 v[52:55], v1, s[24:27], s71 offen offset:0 nt
    v_fmac_f32 v176, v124, v104
    v_fmac_f32 v176, v125, v105
    v_fmac_f32 v176, v126, v106
    v_fmac_f32 v176, v127, v107
    s_waitcnt vmcnt(22)
    v_cvt_f32_i32 v100, v60
    v_cvt_f32_i32 v101, v61
    v_cvt_f32_i32 v102, v62
    v_cvt_f32_i32 v103, v63
    buffer_load_dwordx4 v[56:59], v1, s[24:27], s71 offen offset:256 nt
    v_fmac_f32 v176, v128, v100
    v_fmac_f32 v176, v129, v101
    v_fmac_f32 v176, v130, v102
    v_fmac_f32 v176, v131, v103
    s_nop 1
    v_add_f32_dpp v177, v176, v176 row_ror:8 row_mask:0xf bank_mask:0x3
    s_waitcnt vmcnt(22)
    v_cvt_f32_i32 v104, v64
    v_cvt_f32_i32 v105, v65
    v_cvt_f32_i32 v106, v66
    v_cvt_f32_i32 v107, v67
    buffer_load_dwordx4 v[60:63], v1, s[24:27], s71 offen offset:512 nt
    v_fma_f32 v176, v120, v104, -v164
    v_fmac_f32 v176, v121, v105
    v_fmac_f32 v176, v122, v106
    v_fmac_f32 v176, v123, v107
    s_waitcnt vmcnt(22)
    v_cvt_f32_i32 v100, v68
    v_cvt_f32_i32 v101, v69
    v_cvt_f32_i32 v102, v70
    v_cvt_f32_i32 v103, v71
    s_add_u32 s71, s71, 3072
    buffer_load_dwordx4 v[64:67], v1, s[24:27], s71 offen offset:0 nt
    v_fmac_f32 v176, v124, v100
    v_fmac_f32 v176, v125, v101
    v_fmac_f32 v176, v126, v102
    v_fmac_f32 v176, v127, v103
    s_waitcnt vmcnt(22)
    v_cvt_f32_i32 v104, v72
    v_cvt_f32_i32 v105, v73
    v_cvt_f32_i32 v106, v74
    v_cvt_f32_i32 v107, v75
    buffer_load_dwordx4 v[68:71], v1, s[24:27], s71 offen offset:256 nt
    v_fmac_f32 v176, v128, v104
    v_fmac_f32 v176, v129, v105
    v_fmac_f32 v176, v130, v106
    v_fmac_f32 v176, v131, v107
    s_nop 1
    v_add_f32_dpp v177, v176, v176 row_ror:8 row_mask:0xf bank_mask:0xc
    s_nop 1
    v_add_f32_dpp v178, v177, v177 row_shl:4 row_mask:0xf bank_mask:0x5
    s_waitcnt vmcnt(22)
    v_cvt_f32_i32 v100, v76
    v_cvt_f32_i32 v101, v77
    v_cvt_f32_i32 v102, v78
    v_cvt_f32_i32 v103, v79
    buffer_load_dwordx4 v[72:75], v1, s[24:27], s71 offen offset:512 nt
    v_fma_f32 v176, v120, v100, -v164
    v_fmac_f32 v176, v121, v101
    v_fmac_f32 v176, v122, v102
    v_fmac_f32 v176, v123, v103
    s_waitcnt vmcnt(22)
    v_cvt_f32_i32 v104, v80
    v_cvt_f32_i32 v105, v81
    v_cvt_f32_i32 v106, v82
    v_cvt_f32_i32 v107, v83
    s_add_u32 s71, s71, 3072
    buffer_load_dwordx4 v[76:79], v1, s[24:27], s71 offen offset:0 nt
    v_fmac_f32 v176, v124, v104
    v_fmac_f32 v176, v125, v105
    v_fmac_f32 v176, v126, v106
    v_fmac_f32 v176, v127, v107
    s_waitcnt vmcnt(22)
    v_cvt_f32_i32 v100, v84
    v_cvt_f32_i32 v101, v85
    v_cvt_f32_i32 v102, v86
    v_cvt_f32_i32 v103, v87
    buffer_load_dwordx4 v[80:83], v1, s[24:27], s71 offen offset:256 nt
    v_fmac_f32 v176, v128, v100
    v_fmac_f32 v176, v129, v101
    v_fmac_f32 v176, v130, v102
    v_fmac_f32 v176, v131, v103
    s_nop 1
    v_add_f32_dpp v177, v176, v176 row_ror:8 row_mask:0xf bank_mask:0x3
    s_waitcnt vmcnt(22)
    v_cvt_f32_i32 v104, v88
    v_cvt_f32_i32 v105, v89
    v_cvt_f32_i32 v106, v90
    v_cvt_f32_i32 v107, v91
    buffer_load_dwordx4 v[84:87], v1, s[24:27], s71 offen offset:512 nt
    v_fma_f32 v176, v120, v104, -v164
    v_fmac_f32 v176, v121, v105
    v_fmac_f32 v176, v122, v106
    v_fmac_f32 v176, v123, v107
    s_waitcnt vmcnt(22)
    v_cvt_f32_i32 v100, v92
    v_cvt_f32_i32 v101, v93
    v_cvt_f32_i32 v102, v94
    v_cvt_f32_i32 v103, v95
    s_add_u32 s71, s71, 3072
    buffer_load_dwordx4 v[88:91], v1, s[24:27], s71 offen offset:0 nt
    v_fmac_f32 v176, v124, v100
    v_fmac_f32 v176, v125, v101
    v_fmac_f32 v176, v126, v102
    v_fmac_f32 v176, v127, v103
    s_waitcnt vmcnt(22)
    v_cvt_f32_i32 v104, v96
    v_cvt_f32_i32 v105, v97
    v_cvt_f32_i32 v106, v98
    v_cvt_f32_i32 v107, v99
    buffer_load_dwordx4 v[92:95], v1, s[24:27], s71 offen offset:256 nt
    v_fmac_f32 v176, v128, v104
    v_fmac_f32 v176, v129, v105
    v_fmac_f32 v176, v130, v106
    v_fmac_f32 v176, v131, v107
    s_nop 1
    v_add_f32_dpp v177, v176, v176 row_ror:8 row_mask:0xf bank_mask:0xc
    s_nop 1
    v_add_f32_dpp v178, v177, v177 row_shr:4 row_mask:0xf bank_mask:0xa
    s_nop 1
    v_add_f32_dpp v180, v178, v178 quad_perm:[2,3,0,1] row_mask:0xf bank_mask:0xf
    v_cndmask_b32 v180, v179, v180, s[64:65]
    s_nop 1
    v_add_f32_dpp v181, v180, v180 quad_perm:[1,0,3,2] row_mask:0xf bank_mask:0xf
    s_waitcnt vmcnt(22)
    v_cvt_f32_i32 v100, v4
    v_cvt_f32_i32 v101, v5
    v_cvt_f32_i32 v102, v6
    v_cvt_f32_i32 v103, v7
    buffer_load_dwordx4 v[96:99], v1, s[24:27], s71 offen offset:512 nt
    v_fma_f32 v176, v120, v100, -v164
    v_fmac_f32 v176, v121, v101
    v_fmac_f32 v176, v122, v102
    v_fmac_f32 v176, v123, v103
    s_waitcnt vmcnt(22)
    v_cvt_f32_i32 v104, v8
    v_cvt_f32_i32 v105, v9
    v_cvt_f32_i32 v106, v10
    v_cvt_f32_i32 v107, v11
    s_add_u32 s56, s56, 64
    s_and_b32 s56, s56, 511
    s_sub_u32 s75, s75, 1
    s_cmp_eq_u32 s75, 0
    s_cselect_b32 s80, 2048, 0
    s_cselect_b32 s75, 8, s75
    s_add_u32 s57, s57, s80
    s_add_u32 s70, s57, s56
    s_lshr_b32 s74, s70, 9
    s_mul_i32 s74, s74, 384
    buffer_load_dwordx2 v[144:145], v2, s[48:51], s74 offen offset:0
    buffer_load_dwordx2 v[146:147], v2, s[48:51], s74 offen offset:128
    buffer_load_dwordx2 v[148:149], v2, s[48:51], s74 offen offset:256
    s_mul_i32 s71, s70, 49152
    s_mul_i32 s72, s70, 384
    buffer_load_dwordx2 v[132:133], v2, s[32:35], s72 offen offset:0
    buffer_load_dwordx2 v[134:135], v2, s[32:35], s72 offen offset:128
    buffer_load_dwordx2 v[136:137], v2, s[32:35], s72 offen offset:256
    buffer_load_dwordx2 v[138:139], v2, s[36:39], s72 offen offset:0
    buffer_load_dwordx2 v[140:141], v2, s[36:39], s72 offen offset:128
    buffer_load_dwordx2 v[142:143], v2, s[36:39], s72 offen offset:256
    buffer_load_dwordx4 v[4:7], v1, s[24:27], s71 offen offset:0 nt
    v_fmac_f32 v176, v124, v104
    v_fmac_f32 v176, v125, v105
    v_fmac_f32 v176, v126, v106
    v_fmac_f32 v176, v127, v107
    s_waitcnt vmcnt(31)
    v_cvt_f32_i32 v100, v12
    v_cvt_f32_i32 v101, v13
    v_cvt_f32_i32 v102, v14
    v_cvt_f32_i32 v103, v15
    buffer_load_dwordx4 v[8:11], v1, s[24:27], s71 offen offset:256 nt
    v_fmac_f32 v176, v128, v100
    v_fmac_f32 v176, v129, v101
    v_fmac_f32 v176, v130, v102
    v_fmac_f32 v176, v131, v103
    s_nop 1
    v_add_f32_dpp v177, v176, v176 row_ror:8 row_mask:0xf bank_mask:0x3
    s_waitcnt vmcnt(31)
    v_cvt_f32_i32 v104, v16
    v_cvt_f32_i32 v105, v17
    v_cvt_f32_i32 v106, v18
    v_cvt_f32_i32 v107, v19
    buffer_load_dwordx4 v[12:15], v1, s[24:27], s71 offen offset:512 nt
    v_fma_f32 v176, v120, v104, -v164
    v_fmac_f32 v176, v121, v105
    v_fmac_f32 v176, v122, v106
    v_fmac_f32 v176, v123, v107
    s_waitcnt vmcnt(31)
    v_cvt_f32_i32 v100, v20
    v_cvt_f32_i32 v101, v21
    v_cvt_f32_i32 v102, v22
    v_cvt_f32_i32 v103, v23
    s_add_u32 s71, s71, 3072
    buffer_load_dwordx4 v[16:19], v1, s[24:27], s71 offen offset:0 nt
    v_fmac_f32 v176, v124, v100
    v_fmac_f32 v176, v125, v101
    v_fmac_f32 v176, v126, v102
    v_fmac_f32 v176, v127, v103
    s_waitcnt vmcnt(31)
    v_cvt_f32_i32 v104, v24
    v_cvt_f32_i32 v105, v25
    v_cvt_f32_i32 v106, v26
    v_cvt_f32_i32 v107, v27
    buffer_load_dwordx4 v[20:23], v1, s[24:27], s71 offen offset:256 nt
    v_fmac_f32 v176, v128, v104
    v_fmac_f32 v176, v129, v105
    v_fmac_f32 v176, v130, v106
    v_fmac_f32 v176, v131, v107
    s_nop 1
    v_add_f32_dpp v177, v176, v176 row_ror:8 row_mask:0xf bank_mask:0xc
    s_nop 1
    v_add_f32_dpp v178, v177, v177 row_shl:4 row_mask:0xf bank_mask:0x5
    s_waitcnt vmcnt(31)
    v_cvt_f32_i32 v100, v28
    v_cvt_f32_i32 v101, v29
    v_cvt_f32_i32 v102, v30
    v_cvt_f32_i32 v103, v31
    buffer_load_dwordx4 v[24:27], v1, s[24:27], s71 offen offset:512 nt
    v_fma_f32 v176, v120, v100, -v164
    v_fmac_f32 v176, v121, v101
    v_fmac_f32 v176, v122, v102
    v_fmac_f32 v176, v123, v103
    s_waitcnt vmcnt(31)
    v_cvt_f32_i32 v104, v32
    v_cvt_f32_i32 v105, v33
    v_cvt_f32_i32 v106, v34
    v_cvt_f32_i32 v107, v35
    s_add_u32 s71, s71, 3072
    buffer_load_dwordx4 v[28:31], v1, s[24:27], s71 offen offset:0 nt
    v_fmac_f32 v176, v124, v104
    v_fmac_f32 v176, v125, v105
    v_fmac_f32 v176, v126, v106
    v_fmac_f32 v176, v127, v107
    s_waitcnt vmcnt(31)
    v_cvt_f32_i32 v100, v36
    v_cvt_f32_i32 v101, v37
    v_cvt_f32_i32 v102, v38
    v_cvt_f32_i32 v103, v39
    buffer_load_dwordx4 v[32:35], v1, s[24:27], s71 offen offset:256 nt
    v_fmac_f32 v176, v128, v100
    v_fmac_f32 v176, v129, v101
    v_fmac_f32 v176, v130, v102
    v_fmac_f32 v176, v131, v103
    s_nop 1
    v_add_f32_dpp v177, v176, v176 row_ror:8 row_mask:0xf bank_mask:0x3
    s_waitcnt vmcnt(31)
    v_cvt_f32_i32 v104, v40
    v_cvt_f32_i32 v105, v41
    v_cvt_f32_i32 v106, v42
    v_cvt_f32_i32 v107, v43
    buffer_load_dwordx4 v[36:39], v1, s[24:27], s71 offen offset:512 nt
    v_fma_f32 v176, v120, v104, -v164
    v_fmac_f32 v176, v121, v105
    v_fmac_f32 v176, v122, v106
    v_fmac_f32 v176, v123, v107
    s_waitcnt vmcnt(31)
    v_cvt_f32_i32 v100, v44
    v_cvt_f32_i32 v101, v45
    v_cvt_f32_i32 v102, v46
    v_cvt_f32_i32 v103, v47
    s_add_u32 s71, s71, 3072
    buffer_load_dwordx4 v[40:43], v1, s[24:27], s71 offen offset:0 nt
    v_fmac_f32 v176, v124, v100
    v_fmac_f32 v176, v125, v101
    v_fmac_f32 v176, v126, v102
    v_fmac_f32 v176, v127, v103
    s_waitcnt vmcnt(31)
    v_cvt_f32_i32 v104, v48
    v_cvt_f32_i32 v105, v49
    v_cvt_f32_i32 v106, v50
    v_cvt_f32_i32 v107, v51
    buffer_load_dwordx4 v[44:47], v1, s[24:27], s71 offen offset:256 nt
    v_fmac_f32 v176, v128, v104
    v_fmac_f32 v176, v129, v105
    v_fmac_f32 v176, v130, v106
    v_fmac_f32 v176, v131, v107
    s_nop 1
    v_add_f32_dpp v177, v176, v176 row_ror:8 row_mask:0xf bank_mask:0xc
    s_nop 1
    v_add_f32_dpp v178, v177, v177 row_shr:4 row_mask:0xf bank_mask:0xa
    s_nop 1
    v_add_f32_dpp v179, v178, v178 quad_perm:[2,3,0,1] row_mask:0xf bank_mask:0xf
    s_waitcnt vmcnt(31)
    v_cvt_f32_i32 v100, v52
    v_cvt_f32_i32 v101, v53
    v_cvt_f32_i32 v102, v54
    v_cvt_f32_i32 v103, v55
    buffer_load_dwordx4 v[48:51], v1, s[24:27], s71 offen offset:512 nt
    v_fma_f32 v176, v120, v100, -v164
    v_fmac_f32 v176, v121, v101
    v_fmac_f32 v176, v122, v102
    v_fmac_f32 v176, v123, v103
    s_waitcnt vmcnt(31)
    v_cvt_f32_i32 v104, v56
    v_cvt_f32_i32 v105, v57
    v_cvt_f32_i32 v106, v58
    v_cvt_f32_i32 v107, v59
    s_add_u32 s71, s71, 3072
    buffer_load_dwordx4 v[52:55], v1, s[24:27], s71 offen offset:0 nt
    v_fmac_f32 v176, v124, v104
    v_fmac_f32 v176, v125, v105
    v_fmac_f32 v176, v126, v106
    v_fmac_f32 v176, v127, v107
    s_waitcnt vmcnt(31)
    v_cvt_f32_i32 v100, v60
    v_cvt_f32_i32 v101, v61
    v_cvt_f32_i32 v102, v62
    v_cvt_f32_i32 v103, v63
    buffer_load_dwordx4 v[56:59], v1, s[24:27], s71 offen offset:256 nt
    v_fmac_f32 v176, v128, v100
    v_fmac_f32 v176, v129, v101
    v_fmac_f32 v176, v130, v102
    v_fmac_f32 v176, v131, v103
    s_nop 1
    v_add_f32_dpp v177, v176, v176 row_ror:8 row_mask:0xf bank_mask:0x3
    s_waitcnt vmcnt(31)
    v_cvt_f32_i32 v104, v64
    v_cvt_f32_i32 v105, v65
    v_cvt_f32_i32 v106, v66
    v_cvt_f32_i32 v107, v67
    buffer_load_dwordx4 v[60:63], v1, s[24:27], s71 offen offset:512 nt
    v_fma_f32 v176, v120, v104, -v164
    v_fmac_f32 v176, v121, v105
    v_fmac_f32 v176, v122, v106
    v_fmac_f32 v176, v123, v107
    s_waitcnt vmcnt(31)
    v_cvt_f32_i32 v100, v68
    v_cvt_f32_i32 v101, v69
    v_cvt_f32_i32 v102, v70
    v_cvt_f32_i32 v103, v71
    s_add_u32 s71, s71, 3072
    buffer_load_dwordx4 v[64:67], v1, s[24:27], s71 offen offset:0 nt
    v_fmac_f32 v176, v124, v100
    v_fmac_f32 v176, v125, v101
    v_fmac_f32 v176, v126, v102
    v_fmac_f32 v176, v127, v103
    s_waitcnt vmcnt(31)
    v_cvt_f32_i32 v104, v72
    v_cvt_f32_i32 v105, v73
    v_cvt_f32_i32 v106, v74
    v_cvt_f32_i32 v107, v75
    buffer_load_dwordx4 v[68:71], v1, s[24:27], s71 offen offset:256 nt
    v_fmac_f32 v176, v128, v104
    v_fmac_f32 v176, v129, v105
    v_fmac_f32 v176, v130, v106
    v_fmac_f32 v176, v131, v107
    s_nop 1
    v_add_f32_dpp v177, v176, v176 row_ror:8 row_mask:0xf bank_mask:0xc
    s_nop 1
    v_add_f32_dpp v178, v177, v177 row_shl:4 row_mask:0xf bank_mask:0x5
    s_waitcnt vmcnt(31)
    v_cvt_f32_i32 v100, v76
    v_cvt_f32_i32 v101, v77
    v_cvt_f32_i32 v102, v78
    v_cvt_f32_i32 v103, v79
    buffer_load_dwordx4 v[72:75], v1, s[24:27], s71 offen offset:512 nt
    v_fma_f32 v176, v120, v100, -v164
    v_fmac_f32 v176, v121, v101
    v_fmac_f32 v176, v122, v102
    v_fmac_f32 v176, v123, v103
    s_waitcnt vmcnt(31)
    v_cvt_f32_i32 v104, v80
    v_cvt_f32_i32 v105, v81
    v_cvt_f32_i32 v106, v82
    v_cvt_f32_i32 v107, v83
    s_add_u32 s71, s71, 3072
    buffer_load_dwordx4 v[76:79], v1, s[24:27], s71 offen offset:0 nt
    v_fmac_f32 v176, v124, v104
    v_fmac_f32 v176, v125, v105
    v_fmac_f32 v176, v126, v106
    v_fmac_f32 v176, v127, v107
    s_waitcnt vmcnt(31)
    v_cvt_f32_i32 v100, v84
    v_cvt_f32_i32 v101, v85
    v_cvt_f32_i32 v102, v86
    v_cvt_f32_i32 v103, v87
    buffer_load_dwordx4 v[80:83], v1, s[24:27], s71 offen offset:256 nt
    v_fmac_f32 v176, v128, v100
    v_fmac_f32 v176, v129, v101
    v_fmac_f32 v176, v130, v102
    v_fmac_f32 v176, v131, v103
    s_nop 1
    v_add_f32_dpp v177, v176, v176 row_ror:8 row_mask:0xf bank_mask:0x3
    s_waitcnt vmcnt(31)
    v_cvt_f32_i32 v104, v88
    v_cvt_f32_i32 v105, v89
    v_cvt_f32_i32 v106, v90
    v_cvt_f32_i32 v107, v91
    buffer_load_dwordx4 v[84:87], v1, s[24:27], s71 offen offset:512 nt
    v_fma_f32 v176, v120, v104, -v164
    v_fmac_f32 v176, v121, v105
    v_fmac_f32 v176, v122, v106
    v_fmac_f32 v176, v123, v107
    s_waitcnt vmcnt(31)
    v_cvt_f32_i32 v100, v92
    v_cvt_f32_i32 v101, v93
    v_cvt_f32_i32 v102, v94
    v_cvt_f32_i32 v103, v95
    s_add_u32 s71, s71, 3072
    buffer_load_dwordx4 v[88:91], v1, s[24:27], s71 offen offset:0 nt
    v_fmac_f32 v176, v124, v100
    v_fmac_f32 v176, v125, v101
    v_fmac_f32 v176, v126, v102
    v_fmac_f32 v176, v127, v103
    s_waitcnt vmcnt(31)
    v_cvt_f32_i32 v104, v96
    v_cvt_f32_i32 v105, v97
    v_cvt_f32_i32 v106, v98
    v_cvt_f32_i32 v107, v99
    buffer_load_dwordx4 v[92:95], v1, s[24:27], s71 offen offset:256 nt
    v_fmac_f32 v176, v128, v104
    v_fmac_f32 v176, v129, v105
    v_fmac_f32 v176, v130, v106
    v_fmac_f32 v176, v131, v107
    s_nop 1
    v_add_f32_dpp v177, v176, v176 row_ror:8 row_mask:0xf bank_mask:0xc
    s_nop 1
    v_add_f32_dpp v178, v177, v177 row_shr:4 row_mask:0xf bank_mask:0xa
    s_nop 1
    v_add_f32_dpp v180, v178, v178 quad_perm:[2,3,0,1] row_mask:0xf bank_mask:0xf
    v_cndmask_b32 v180, v179, v180, s[64:65]
    s_nop 1
    v_add_f32_dpp v179, v180, v180 quad_perm:[1,0,3,2] row_mask:0xf bank_mask:0xf
    v_cndmask_b32 v181, v181, v179, s[66:67]
    ds_write_b32 v184, v181
    v_add_u32 v184, 256, v184
    s_sub_u32 s76, s76, 1
    s_cmp_lg_u32 s76, 0
    s_cbranch_scc1 L_loop0
    s_waitcnt vmcnt(29)
    v_lshlrev_b32 v108, 16, v144
    v_and_b32 v109, 0xffff0000, v144
    v_lshlrev_b32 v110, 16, v145
    v_and_b32 v111, 0xffff0000, v145
    v_lshlrev_b32 v112, 16, v146
    v_and_b32 v113, 0xffff0000, v146
    v_lshlrev_b32 v114, 16, v147
    v_and_b32 v115, 0xffff0000, v147
    v_lshlrev_b32 v116, 16, v148
    v_and_b32 v117, 0xffff0000, v148
    v_lshlrev_b32 v118, 16, v149
    v_and_b32 v119, 0xffff0000, v149
    v_mul_f32 v108, s78, v108
    v_mul_f32 v109, s78, v109
    v_mul_f32 v110, s78, v110
    v_mul_f32 v111, s78, v111
    v_mul_f32 v112, s78, v112
    v_mul_f32 v113, s78, v113
    v_mul_f32 v114, s78, v114
    v_mul_f32 v115, s78, v115
    v_mul_f32 v116, s78, v116
    v_mul_f32 v117, s78, v117
    v_mul_f32 v118, s78, v118
    v_mul_f32 v119, s78, v119
    s_waitcnt vmcnt(23)
    v_lshlrev_b32 v182, 16, v132
    v_and_b32 v183, 0xffff0000, v132
    v_mul_f32 v120, v182, v108
    v_mul_f32 v121, v183, v109
    v_lshlrev_b32 v182, 16, v138
    v_and_b32 v183, 0xffff0000, v138
    v_mul_f32 v164, v120, v182
    v_fmac_f32 v164, v121, v183
    v_lshlrev_b32 v182, 16, v133
    v_and_b32 v183, 0xffff0000, v133
    v_mul_f32 v122, v182, v110
    v_mul_f32 v123, v183, v111
    v_lshlrev_b32 v182, 16, v139
    v_and_b32 v183, 0xffff0000, v139
    v_fmac_f32 v164, v122, v182
    v_fmac_f32 v164, v123, v183
    v_lshlrev_b32 v182, 16, v134
    v_and_b32 v183, 0xffff0000, v134
    v_mul_f32 v124, v182, v112
    v_mul_f32 v125, v183, v113
    v_lshlrev_b32 v182, 16, v140
    v_and_b32 v183, 0xffff0000, v140
    v_fmac_f32 v164, v124, v182
    v_fmac_f32 v164, v125, v183
    v_lshlrev_b32 v182, 16, v135
    v_and_b32 v183, 0xffff0000, v135
    v_mul_f32 v126, v182, v114
    v_mul_f32 v127, v183, v115
    v_lshlrev_b32 v182, 16, v141
    v_and_b32 v183, 0xffff0000, v141
    v_fmac_f32 v164, v126, v182
    v_fmac_f32 v164, v127, v183
    v_lshlrev_b32 v182, 16, v136
    v_and_b32 v183, 0xffff0000, v136
    v_mul_f32 v128, v182, v116
    v_mul_f32 v129, v183, v117
    v_lshlrev_b32 v182, 16, v142
    v_and_b32 v183, 0xffff0000, v142
    v_fmac_f32 v164, v128, v182
    v_fmac_f32 v164, v129, v183
    v_lshlrev_b32 v182, 16, v137
    v_and_b32 v183, 0xffff0000, v137
    v_mul_f32 v130, v182, v118
    v_mul_f32 v131, v183, v119
    v_lshlrev_b32 v182, 16, v143
    v_and_b32 v183, 0xffff0000, v143
    v_fmac_f32 v164, v130, v182
    v_fmac_f32 v164, v131, v183
    s_waitcnt vmcnt(22)
    v_cvt_f32_i32 v100, v4
    v_cvt_f32_i32 v101, v5
    v_cvt_f32_i32 v102, v6
    v_cvt_f32_i32 v103, v7
    buffer_load_dwordx4 v[96:99], v1, s[24:27], s71 offen offset:512 nt
    v_fma_f32 v176, v120, v100, -v164
    v_fmac_f32 v176, v121, v101
    v_fmac_f32 v176, v122, v102
    v_fmac_f32 v176, v123, v103
    s_waitcnt vmcnt(22)
    v_cvt_f32_i32 v104, v8
    v_cvt_f32_i32 v105, v9
    v_cvt_f32_i32 v106, v10
    v_cvt_f32_i32 v107, v11
    s_add_u32 s71, s71, 3072
    buffer_load_dwordx4 v[4:7], v1, s[24:27], s71 offen offset:0 nt
    v_fmac_f32 v176, v124, v104
    v_fmac_f32 v176, v125, v105
    v_fmac_f32 v176, v126, v106
    v_fmac_f32 v176, v127, v107
    s_waitcnt vmcnt(22)
    v_cvt_f32_i32 v100, v12
    v_cvt_f32_i32 v101, v13
    v_cvt_f32_i32 v102, v14
    v_cvt_f32_i32 v103, v15
    buffer_load_dwordx4 v[8:11], v1, s[24:27], s71 offen offset:256 nt
    v_fmac_f32 v176, v128, v100
    v_fmac_f32 v176, v129, v101
    v_fmac_f32 v176, v130, v102
    v_fmac_f32 v176, v131, v103
    s_nop 1
    v_add_f32_dpp v177, v176, v176 row_ror:8 row_mask:0xf bank_mask:0x3
    s_waitcnt vmcnt(22)
    v_cvt_f32_i32 v104, v16
    v_cvt_f32_i32 v105, v17
    v_cvt_f32_i32 v106, v18
    v_cvt_f32_i32 v107, v19
    buffer_load_dwordx4 v[12:15], v1, s[24:27], s71 offen offset:512 nt
    v_fma_f32 v176, v120, v104, -v164
    v_fmac_f32 v176, v121, v105
    v_fmac_f32 v176, v122, v106
    v_fmac_f32 v176, v123, v107
    s_waitcnt vmcnt(22)
    v_cvt_f32_i32 v100, v20
    v_cvt_f32_i32 v101, v21
    v_cvt_f32_i32 v102, v22
    v_cvt_f32_i32 v103, v23
    s_add_u32 s71, s71, 3072
    buffer_load_dwordx4 v[16:19], v1, s[24:27], s71 offen offset:0 nt
    v_fmac_f32 v176, v124, v100
    v_fmac_f32 v176, v125, v101
    v_fmac_f32 v176, v126, v102
    v_fmac_f32 v176, v127, v103
    s_waitcnt vmcnt(22)
    v_cvt_f32_i32 v104, v24
    v_cvt_f32_i32 v105, v25
    v_cvt_f32_i32 v106, v26
    v_cvt_f32_i32 v107, v27
    buffer_load_dwordx4 v[20:23], v1, s[24:27], s71 offen offset:256 nt
    v_fmac_f32 v176, v128, v104
    v_fmac_f32 v176, v129, v105
    v_fmac_f32 v176, v130, v106
    v_fmac_f32 v176, v131, v107
    s_nop 1
    v_add_f32_dpp v177, v176, v176 row_ror:8 row_mask:0xf bank_mask:0xc
    s_nop 1
    v_add_f32_dpp v178, v177, v177 row_shl:4 row_mask:0xf bank_mask:0x5
    s_waitcnt vmcnt(22)
    v_cvt_f32_i32 v100, v28
    v_cvt_f32_i32 v101, v29
    v_cvt_f32_i32 v102, v30
    v_cvt_f32_i32 v103, v31
    buffer_load_dwordx4 v[24:27], v1, s[24:27], s71 offen offset:512 nt
    v_fma_f32 v176, v120, v100, -v164
    v_fmac_f32 v176, v121, v101
    v_fmac_f32 v176, v122, v102
    v_fmac_f32 v176, v123, v103
    s_waitcnt vmcnt(22)
    v_cvt_f32_i32 v104, v32
    v_cvt_f32_i32 v105, v33
    v_cvt_f32_i32 v106, v34
    v_cvt_f32_i32 v107, v35
    s_add_u32 s71, s71, 3072
    buffer_load_dwordx4 v[28:31], v1, s[24:27], s71 offen offset:0 nt
    v_fmac_f32 v176, v124, v104
    v_fmac_f32 v176, v125, v105
    v_fmac_f32 v176, v126, v106
    v_fmac_f32 v176, v127, v107
    s_waitcnt vmcnt(22)
    v_cvt_f32_i32 v100, v36
    v_cvt_f32_i32 v101, v37
    v_cvt_f32_i32 v102, v38
    v_cvt_f32_i32 v103, v39
    buffer_load_dwordx4 v[32:35], v1, s[24:27], s71 offen offset:256 nt
    v_fmac_f32 v176, v128, v100
    v_fmac_f32 v176, v129, v101
    v_fmac_f32 v176, v130, v102
    v_fmac_f32 v176, v131, v103
    s_nop 1
    v_add_f32_dpp v177, v176, v176 row_ror:8 row_mask:0xf bank_mask:0x3
    s_waitcnt vmcnt(22)
    v_cvt_f32_i32 v104, v40
    v_cvt_f32_i32 v105, v41
    v_cvt_f32_i32 v106, v42
    v_cvt_f32_i32 v107, v43
    buffer_load_dwordx4 v[36:39], v1, s[24:27], s71 offen offset:512 nt
    v_fma_f32 v176, v120, v104, -v164
    v_fmac_f32 v176, v121, v105
    v_fmac_f32 v176, v122, v106
    v_fmac_f32 v176, v123, v107
    s_waitcnt vmcnt(22)
    v_cvt_f32_i32 v100, v44
    v_cvt_f32_i32 v101, v45
    v_cvt_f32_i32 v102, v46
    v_cvt_f32_i32 v103, v47
    s_add_u32 s71, s71, 3072
    buffer_load_dwordx4 v[40:43], v1, s[24:27], s71 offen offset:0 nt
    v_fmac_f32 v176, v124, v100
    v_fmac_f32 v176, v125, v101
    v_fmac_f32 v176, v126, v102
    v_fmac_f32 v176, v127, v103
    s_waitcnt vmcnt(22)
    v_cvt_f32_i32 v104, v48
    v_cvt_f32_i32 v105, v49
    v_cvt_f32_i32 v106, v50
    v_cvt_f32_i32 v107, v51
    buffer_load_dwordx4 v[44:47], v1, s[24:27], s71 offen offset:256 nt
    v_fmac_f32 v176, v128, v104
    v_fmac_f32 v176, v129, v105
    v_fmac_f32 v176, v130, v106
    v_fmac_f32 v176, v131, v107
    s_nop 1
    v_add_f32_dpp v177, v176, v176 row_ror:8 row_mask:0xf bank_mask:0xc
    s_nop 1
    v_add_f32_dpp v178, v177, v177 row_shr:4 row_mask:0xf bank_mask:0xa
    s_nop 1
    v_add_f32_dpp v179, v178, v178 quad_perm:[2,3,0,1] row_mask:0xf bank_mask:0xf
    s_waitcnt vmcnt(22)
    v_cvt_f32_i32 v100, v52
    v_cvt_f32_i32 v101, v53
    v_cvt_f32_i32 v102, v54
    v_cvt_f32_i32 v103, v55
    buffer_load_dwordx4 v[48:51], v1, s[24:27], s71 offen offset:512 nt
    v_fma_f32 v176, v120, v100, -v164
    v_fmac_f32 v176, v121, v101
    v_fmac_f32 v176, v122, v102
    v_fmac_f32 v176, v123, v103
    s_waitcnt vmcnt(22)
    v_cvt_f32_i32 v104, v56
    v_cvt_f32_i32 v105, v57
    v_cvt_f32_i32 v106, v58
    v_cvt_f32_i32 v107, v59
    s_add_u32 s71, s71, 3072
    buffer_load_dwordx4 v[52:55], v1, s[24:27], s71 offen offset:0 nt
    v_fmac_f32 v176, v124, v104
    v_fmac_f32 v176, v125, v105
    v_fmac_f32 v176, v126, v106
    v_fmac_f32 v176, v127, v107
    s_waitcnt vmcnt(22)
    v_cvt_f32_i32 v100, v60
    v_cvt_f32_i32 v101, v61
    v_cvt_f32_i32 v102, v62
    v_cvt_f32_i32 v103, v63
    buffer_load_dwordx4 v[56:59], v1, s[24:27], s71 offen offset:256 nt
    v_fmac_f32 v176, v128, v100
    v_fmac_f32 v176, v129, v101
    v_fmac_f32 v176, v130, v102
    v_fmac_f32 v176, v131, v103
    s_nop 1
    v_add_f32_dpp v177, v176, v176 row_ror:8 row_mask:0xf bank_mask:0x3
    s_waitcnt vmcnt(22)
    v_cvt_f32_i32 v104, v64
    v_cvt_f32_i32 v105, v65
    v_cvt_f32_i32 v106, v66
    v_cvt_f32_i32 v107, v67
    buffer_load_dwordx4 v[60:63], v1, s[24:27], s71 offen offset:512 nt
    v_fma_f32 v176, v120, v104, -v164
    v_fmac_f32 v176, v121, v105
    v_fmac_f32 v176, v122, v106
    v_fmac_f32 v176, v123, v107
    s_waitcnt vmcnt(22)
    v_cvt_f32_i32 v100, v68
    v_cvt_f32_i32 v101, v69
    v_cvt_f32_i32 v102, v70
    v_cvt_f32_i32 v103, v71
    s_add_u32 s71, s71, 3072
    buffer_load_dwordx4 v[64:67], v1, s[24:27], s71 offen offset:0 nt
    v_fmac_f32 v176, v124, v100
    v_fmac_f32 v176, v125, v101
    v_fmac_f32 v176, v126, v102
    v_fmac_f32 v176, v127, v103
    s_waitcnt vmcnt(22)
    v_cvt_f32_i32 v104, v72
    v_cvt_f32_i32 v105, v73
    v_cvt_f32_i32 v106, v74
    v_cvt_f32_i32 v107, v75
    buffer_load_dwordx4 v[68:71], v1, s[24:27], s71 offen offset:256 nt
    v_fmac_f32 v176, v128, v104
    v_fmac_f32 v176, v129, v105
    v_fmac_f32 v176, v130, v106
    v_fmac_f32 v176, v131, v107
    s_nop 1
    v_add_f32_dpp v177, v176, v176 row_ror:8 row_mask:0xf bank_mask:0xc
    s_nop 1
    v_add_f32_dpp v178, v177, v177 row_shl:4 row_mask:0xf bank_mask:0x5
    s_waitcnt vmcnt(22)
    v_cvt_f32_i32 v100, v76
    v_cvt_f32_i32 v101, v77
    v_cvt_f32_i32 v102, v78
    v_cvt_f32_i32 v103, v79
    buffer_load_dwordx4 v[72:75], v1, s[24:27], s71 offen offset:512 nt
    v_fma_f32 v176, v120, v100, -v164
    v_fmac_f32 v176, v121, v101
    v_fmac_f32 v176, v122, v102
    v_fmac_f32 v176, v123, v103
    s_waitcnt vmcnt(22)
    v_cvt_f32_i32 v104, v80
    v_cvt_f32_i32 v105, v81
    v_cvt_f32_i32 v106, v82
    v_cvt_f32_i32 v107, v83
    s_add_u32 s71, s71, 3072
    buffer_load_dwordx4 v[76:79], v1, s[24:27], s71 offen offset:0 nt
    v_fmac_f32 v176, v124, v104
    v_fmac_f32 v176, v125, v105
    v_fmac_f32 v176, v126, v106
    v_fmac_f32 v176, v127, v107
    s_waitcnt vmcnt(22)
    v_cvt_f32_i32 v100, v84
    v_cvt_f32_i32 v101, v85
    v_cvt_f32_i32 v102, v86
    v_cvt_f32_i32 v103, v87
    buffer_load_dwordx4 v[80:83], v1, s[24:27], s71 offen offset:256 nt
    v_fmac_f32 v176, v128, v100
    v_fmac_f32 v176, v129, v101
    v_fmac_f32 v176, v130, v102
    v_fmac_f32 v176, v131, v103
    s_nop 1
    v_add_f32_dpp v177, v176, v176 row_ror:8 row_mask:0xf bank_mask:0x3
    s_waitcnt vmcnt(22)
    v_cvt_f32_i32 v104, v88
    v_cvt_f32_i32 v105, v89
    v_cvt_f32_i32 v106, v90
    v_cvt_f32_i32 v107, v91
    buffer_load_dwordx4 v[84:87], v1, s[24:27], s71 offen offset:512 nt
    v_fma_f32 v176, v120, v104, -v164
    v_fmac_f32 v176, v121, v105
    v_fmac_f32 v176, v122, v106
    v_fmac_f32 v176, v123, v107
    s_waitcnt vmcnt(22)
    v_cvt_f32_i32 v100, v92
    v_cvt_f32_i32 v101, v93
    v_cvt_f32_i32 v102, v94
    v_cvt_f32_i32 v103, v95
    s_add_u32 s71, s71, 3072
    buffer_load_dwordx4 v[88:91], v1, s[24:27], s71 offen offset:0 nt
    v_fmac_f32 v176, v124, v100
    v_fmac_f32 v176, v125, v101
    v_fmac_f32 v176, v126, v102
    v_fmac_f32 v176, v127, v103
    s_waitcnt vmcnt(22)
    v_cvt_f32_i32 v104, v96
    v_cvt_f32_i32 v105, v97
    v_cvt_f32_i32 v106, v98
    v_cvt_f32_i32 v107, v99
    buffer_load_dwordx4 v[92:95], v1, s[24:27], s71 offen offset:256 nt
    v_fmac_f32 v176, v128, v104
    v_fmac_f32 v176, v129, v105
    v_fmac_f32 v176, v130, v106
    v_fmac_f32 v176, v131, v107
    s_nop 1
    v_add_f32_dpp v177, v176, v176 row_ror:8 row_mask:0xf bank_mask:0xc
    s_nop 1
    v_add_f32_dpp v178, v177, v177 row_shr:4 row_mask:0xf bank_mask:0xa
    s_nop 1
    v_add_f32_dpp v180, v178, v178 quad_perm:[2,3,0,1] row_mask:0xf bank_mask:0xf
    v_cndmask_b32 v180, v179, v180, s[64:65]
    s_nop 1
    v_add_f32_dpp v181, v180, v180 quad_perm:[1,0,3,2] row_mask:0xf bank_mask:0xf
    s_waitcnt vmcnt(22)
    v_cvt_f32_i32 v100, v4
    v_cvt_f32_i32 v101, v5
    v_cvt_f32_i32 v102, v6
    v_cvt_f32_i32 v103, v7
    buffer_load_dwordx4 v[96:99], v1, s[24:27], s71 offen offset:512 nt
    v_fma_f32 v176, v120, v100, -v164
    v_fmac_f32 v176, v121, v101
    v_fmac_f32 v176, v122, v102
    v_fmac_f32 v176, v123, v103
    s_waitcnt vmcnt(22)
    v_cvt_f32_i32 v104, v8
    v_cvt_f32_i32 v105, v9
    v_cvt_f32_i32 v106, v10
    v_cvt_f32_i32 v107, v11
    s_mov_b32 s57, s69
    s_mov_b32 s56, s58
    s_mov_b32 s75, 8
    s_add_u32 s70, s57, s56
    s_lshl_b32 s73, s70, 7
    buffer_load_ushort v168, v3, s[40:43], s73 offen
    buffer_load_ushort v169, v3, s[44:47], s73 offen
    s_mul_i32 s71, s70, 49152
    buffer_load_dwordx4 v[4:7], v1, s[28:31], s71 offen offset:0 nt
    v_fmac_f32 v176, v124, v104
    v_fmac_f32 v176, v125, v105
    v_fmac_f32 v176, v126, v106
    v_fmac_f32 v176, v127, v107
    s_waitcnt vmcnt(24)
    v_cvt_f32_i32 v100, v12
    v_cvt_f32_i32 v101, v13
    v_cvt_f32_i32 v102, v14
    v_cvt_f32_i32 v103, v15
    buffer_load_dwordx4 v[8:11], v1, s[28:31], s71 offen offset:256 nt
    v_fmac_f32 v176, v128, v100
    v_fmac_f32 v176, v129, v101
    v_fmac_f32 v176, v130, v102
    v_fmac_f32 v176, v131, v103
    s_nop 1
    v_add_f32_dpp v177, v176, v176 row_ror:8 row_mask:0xf bank_mask:0x3
    s_waitcnt vmcnt(24)
    v_cvt_f32_i32 v104, v16
    v_cvt_f32_i32 v105, v17
    v_cvt_f32_i32 v106, v18
    v_cvt_f32_i32 v107, v19
    buffer_load_dwordx4 v[12:15], v1, s[28:31], s71 offen offset:512 nt
    v_fma_f32 v176, v120, v104, -v164
    v_fmac_f32 v176, v121, v105
    v_fmac_f32 v176, v122, v106
    v_fmac_f32 v176, v123, v107
    s_waitcnt vmcnt(24)
    v_cvt_f32_i32 v100, v20
    v_cvt_f32_i32 v101, v21
    v_cvt_f32_i32 v102, v22
    v_cvt_f32_i32 v103, v23
    s_add_u32 s71, s71, 3072
    buffer_load_dwordx4 v[16:19], v1, s[28:31], s71 offen offset:0 nt
    v_fmac_f32 v176, v124, v100
    v_fmac_f32 v176, v125, v101
    v_fmac_f32 v176, v126, v102
    v_fmac_f32 v176, v127, v103
    s_waitcnt vmcnt(24)
    v_cvt_f32_i32 v104, v24
    v_cvt_f32_i32 v105, v25
    v_cvt_f32_i32 v106, v26
    v_cvt_f32_i32 v107, v27
    buffer_load_dwordx4 v[20:23], v1, s[28:31], s71 offen offset:256 nt
    v_fmac_f32 v176, v128, v104
    v_fmac_f32 v176, v129, v105
    v_fmac_f32 v176, v130, v106
    v_fmac_f32 v176, v131, v107
    s_nop 1
    v_add_f32_dpp v177, v176, v176 row_ror:8 row_mask:0xf bank_mask:0xc
    s_nop 1
    v_add_f32_dpp v178, v177, v177 row_shl:4 row_mask:0xf bank_mask:0x5
    s_waitcnt vmcnt(24)
    v_cvt_f32_i32 v100, v28
    v_cvt_f32_i32 v101, v29
    v_cvt_f32_i32 v102, v30
    v_cvt_f32_i32 v103, v31
    buffer_load_dwordx4 v[24:27], v1, s[28:31], s71 offen offset:512 nt
    v_fma_f32 v176, v120, v100, -v164
    v_fmac_f32 v176, v121, v101
    v_fmac_f32 v176, v122, v102
    v_fmac_f32 v176, v123, v103
    s_waitcnt vmcnt(24)
    v_cvt_f32_i32 v104, v32
    v_cvt_f32_i32 v105, v33
    v_cvt_f32_i32 v106, v34
    v_cvt_f32_i32 v107, v35
    s_add_u32 s71, s71, 3072
    buffer_load_dwordx4 v[28:31], v1, s[28:31], s71 offen offset:0 nt
    v_fmac_f32 v176, v124, v104
    v_fmac_f32 v176, v125, v105
    v_fmac_f32 v176, v126, v106
    v_fmac_f32 v176, v127, v107
    s_waitcnt vmcnt(24)
    v_cvt_f32_i32 v100, v36
    v_cvt_f32_i32 v101, v37
    v_cvt_f32_i32 v102, v38
    v_cvt_f32_i32 v103, v39
    buffer_load_dwordx4 v[32:35], v1, s[28:31], s71 offen offset:256 nt
    v_fmac_f32 v176, v128, v100
    v_fmac_f32 v176, v129, v101
    v_fmac_f32 v176, v130, v102
    v_fmac_f32 v176, v131, v103
    s_nop 1
    v_add_f32_dpp v177, v176, v176 row_ror:8 row_mask:0xf bank_mask:0x3
    s_waitcnt vmcnt(24)
    v_cvt_f32_i32 v104, v40
    v_cvt_f32_i32 v105, v41
    v_cvt_f32_i32 v106, v42
    v_cvt_f32_i32 v107, v43
    buffer_load_dwordx4 v[36:39], v1, s[28:31], s71 offen offset:512 nt
    v_fma_f32 v176, v120, v104, -v164
    v_fmac_f32 v176, v121, v105
    v_fmac_f32 v176, v122, v106
    v_fmac_f32 v176, v123, v107
    s_waitcnt vmcnt(24)
    v_cvt_f32_i32 v100, v44
    v_cvt_f32_i32 v101, v45
    v_cvt_f32_i32 v102, v46
    v_cvt_f32_i32 v103, v47
    s_add_u32 s71, s71, 3072
    buffer_load_dwordx4 v[40:43], v1, s[28:31], s71 offen offset:0 nt
    v_fmac_f32 v176, v124, v100
    v_fmac_f32 v176, v125, v101
    v_fmac_f32 v176, v126, v102
    v_fmac_f32 v176, v127, v103
    s_waitcnt vmcnt(24)
    v_cvt_f32_i32 v104, v48
    v_cvt_f32_i32 v105, v49
    v_cvt_f32_i32 v106, v50
    v_cvt_f32_i32 v107, v51
    buffer_load_dwordx4 v[44:47], v1, s[28:31], s71 offen offset:256 nt
    v_fmac_f32 v176, v128, v104
    v_fmac_f32 v176, v129, v105
    v_fmac_f32 v176, v130, v106
    v_fmac_f32 v176, v131, v107
    s_nop 1
    v_add_f32_dpp v177, v176, v176 row_ror:8 row_mask:0xf bank_mask:0xc
    s_nop 1
    v_add_f32_dpp v178, v177, v177 row_shr:4 row_mask:0xf bank_mask:0xa
    s_nop 1
    v_add_f32_dpp v179, v178, v178 quad_perm:[2,3,0,1] row_mask:0xf bank_mask:0xf
    s_waitcnt vmcnt(24)
    v_cvt_f32_i32 v100, v52
    v_cvt_f32_i32 v101, v53
    v_cvt_f32_i32 v102, v54
    v_cvt_f32_i32 v103, v55
    buffer_load_dwordx4 v[48:51], v1, s[28:31], s71 offen offset:512 nt
    v_fma_f32 v176, v120, v100, -v164
    v_fmac_f32 v176, v121, v101
    v_fmac_f32 v176, v122, v102
    v_fmac_f32 v176, v123, v103
    s_waitcnt vmcnt(24)
    v_cvt_f32_i32 v104, v56
    v_cvt_f32_i32 v105, v57
    v_cvt_f32_i32 v106, v58
    v_cvt_f32_i32 v107, v59
    s_add_u32 s71, s71, 3072
    buffer_load_dwordx4 v[52:55], v1, s[28:31], s71 offen offset:0 nt
    v_fmac_f32 v176, v124, v104
    v_fmac_f32 v176, v125, v105
    v_fmac_f32 v176, v126, v106
    v_fmac_f32 v176, v127, v107
    s_waitcnt vmcnt(24)
    v_cvt_f32_i32 v100, v60
    v_cvt_f32_i32 v101, v61
    v_cvt_f32_i32 v102, v62
    v_cvt_f32_i32 v103, v63
    buffer_load_dwordx4 v[56:59], v1, s[28:31], s71 offen offset:256 nt
    v_fmac_f32 v176, v128, v100
    v_fmac_f32 v176, v129, v101
    v_fmac_f32 v176, v130, v102
    v_fmac_f32 v176, v131, v103
    s_nop 1
    v_add_f32_dpp v177, v176, v176 row_ror:8 row_mask:0xf bank_mask:0x3
    s_waitcnt vmcnt(24)
    v_cvt_f32_i32 v104, v64
    v_cvt_f32_i32 v105, v65
    v_cvt_f32_i32 v106, v66
    v_cvt_f32_i32 v107, v67
    buffer_load_dwordx4 v[60:63], v1, s[28:31], s71 offen offset:512 nt
    v_fma_f32 v176, v120, v104, -v164
    v_fmac_f32 v176, v121, v105
    v_fmac_f32 v176, v122, v106
    v_fmac_f32 v176, v123, v107
    s_waitcnt vmcnt(24)
    v_cvt_f32_i32 v100, v68
    v_cvt_f32_i32 v101, v69
    v_cvt_f32_i32 v102, v70
    v_cvt_f32_i32 v103, v71
    s_add_u32 s71, s71, 3072
    buffer_load_dwordx4 v[64:67], v1, s[28:31], s71 offen offset:0 nt
    v_fmac_f32 v176, v124, v100
    v_fmac_f32 v176, v125, v101
    v_fmac_f32 v176, v126, v102
    v_fmac_f32 v176, v127, v103
    s_waitcnt vmcnt(24)
    v_cvt_f32_i32 v104, v72
    v_cvt_f32_i32 v105, v73
    v_cvt_f32_i32 v106, v74
    v_cvt_f32_i32 v107, v75
    buffer_load_dwordx4 v[68:71], v1, s[28:31], s71 offen offset:256 nt
    v_fmac_f32 v176, v128, v104
    v_fmac_f32 v176, v129, v105
    v_fmac_f32 v176, v130, v106
    v_fmac_f32 v176, v131, v107
    s_nop 1
    v_add_f32_dpp v177, v176, v176 row_ror:8 row_mask:0xf bank_mask:0xc
    s_nop 1
    v_add_f32_dpp v178, v177, v177 row_shl:4 row_mask:0xf bank_mask:0x5
    s_waitcnt vmcnt(24)
    v_cvt_f32_i32 v100, v76
    v_cvt_f32_i32 v101, v77
    v_cvt_f32_i32 v102, v78
    v_cvt_f32_i32 v103, v79
    buffer_load_dwordx4 v[72:75], v1, s[28:31], s71 offen offset:512 nt
    v_fma_f32 v176, v120, v100, -v164
    v_fmac_f32 v176, v121, v101
    v_fmac_f32 v176, v122, v102
    v_fmac_f32 v176, v123, v103
    s_waitcnt vmcnt(24)
    v_cvt_f32_i32 v104, v80
    v_cvt_f32_i32 v105, v81
    v_cvt_f32_i32 v106, v82
    v_cvt_f32_i32 v107, v83
    s_add_u32 s71, s71, 3072
    buffer_load_dwordx4 v[76:79], v1, s[28:31], s71 offen offset:0 nt
    v_fmac_f32 v176, v124, v104
    v_fmac_f32 v176, v125, v105
    v_fmac_f32 v176, v126, v106
    v_fmac_f32 v176, v127, v107
    s_waitcnt vmcnt(24)
    v_cvt_f32_i32 v100, v84
    v_cvt_f32_i32 v101, v85
    v_cvt_f32_i32 v102, v86
    v_cvt_f32_i32 v103, v87
    buffer_load_dwordx4 v[80:83], v1, s[28:31], s71 offen offset:256 nt
    v_fmac_f32 v176, v128, v100
    v_fmac_f32 v176, v129, v101
    v_fmac_f32 v176, v130, v102
    v_fmac_f32 v176, v131, v103
    s_nop 1
    v_add_f32_dpp v177, v176, v176 row_ror:8 row_mask:0xf bank_mask:0x3
    s_waitcnt vmcnt(24)
    v_cvt_f32_i32 v104, v88
    v_cvt_f32_i32 v105, v89
    v_cvt_f32_i32 v106, v90
    v_cvt_f32_i32 v107, v91
    buffer_load_dwordx4 v[84:87], v1, s[28:31], s71 offen offset:512 nt
    v_fma_f32 v176, v120, v104, -v164
    v_fmac_f32 v176, v121, v105
    v_fmac_f32 v176, v122, v106
    v_fmac_f32 v176, v123, v107
    s_waitcnt vmcnt(24)
    v_cvt_f32_i32 v100, v92
    v_cvt_f32_i32 v101, v93
    v_cvt_f32_i32 v102, v94
    v_cvt_f32_i32 v103, v95
    s_add_u32 s71, s71, 3072
    buffer_load_dwordx4 v[88:91], v1, s[28:31], s71 offen offset:0 nt
    v_fmac_f32 v176, v124, v100
    v_fmac_f32 v176, v125, v101
    v_fmac_f32 v176, v126, v102
    v_fmac_f32 v176, v127, v103
    s_waitcnt vmcnt(24)
    v_cvt_f32_i32 v104, v96
    v_cvt_f32_i32 v105, v97
    v_cvt_f32_i32 v106, v98
    v_cvt_f32_i32 v107, v99
    buffer_load_dwordx4 v[92:95], v1, s[28:31], s71 offen offset:256 nt
    v_fmac_f32 v176, v128, v104
    v_fmac_f32 v176, v129, v105
    v_fmac_f32 v176, v130, v106
    v_fmac_f32 v176, v131, v107
    s_nop 1
    v_add_f32_dpp v177, v176, v176 row_ror:8 row_mask:0xf bank_mask:0xc
    s_nop 1
    v_add_f32_dpp v178, v177, v177 row_shr:4 row_mask:0xf bank_mask:0xa
    s_nop 1
    v_add_f32_dpp v180, v178, v178 quad_perm:[2,3,0,1] row_mask:0xf bank_mask:0xf
    v_cndmask_b32 v180, v179, v180, s[64:65]
    s_nop 1
    v_add_f32_dpp v179, v180, v180 quad_perm:[1,0,3,2] row_mask:0xf bank_mask:0xf
    v_cndmask_b32 v181, v181, v179, s[66:67]
    ds_write_b32 v184, v181
    v_add_u32 v184, 256, v184
    s_mov_b64 exec, 1
    ds_add_u32 v188, v188 offset:127
    s_mov_b64 exec, -1
    ds_read_b32 v171, v185
    v_add_u32 v185, 256, v185
    s_mov_b32 s76, 57
L_loop1:
    s_waitcnt vmcnt(23)
    v_lshlrev_b32 v168, 16, v168
    v_lshlrev_b32 v169, 16, v169
    s_waitcnt lgkmcnt(0)
    v_max_f32_dpp v182, v171, v171 row_ror:8 row_mask:0xf bank_mask:0xf
    s_nop 1
    v_max_f32_dpp v182, v182, v182 row_ror:4 row_mask:0xf bank_mask:0xf
    s_nop 1
    v_max_f32_dpp v182, v182, v182 row_ror:2 row_mask:0xf bank_mask:0xf
    s_nop 1
    v_max_f32_dpp v182, v182, v182 row_ror:1 row_mask:0xf bank_mask:0xf
    v_max_f32 v182, v182, v165
    v_sub_f32 v183, v165, v182
    v_sub_f32 v170, v171, v182
    v_exp_f32 v183, v183
    v_exp_f32 v170, v170
    v_mov_b32 v165, v182
    v_fma_f32 v166, v166, v183, v170
    v_mul_f32 v170, v170, v168
    v_mul_f32 v167, v167, v183
    v_fmac_f32 v167, v170, v169
    ds_read_b32 v171, v185
    v_add_u32 v185, 256, v185
    v_mul_f32 v152, v152, v183
    v_mul_f32 v153, v153, v183
    v_mul_f32 v154, v154, v183
    v_mul_f32 v155, v155, v183
    v_mul_f32 v156, v156, v183
    v_mul_f32 v157, v157, v183
    v_mul_f32 v158, v158, v183
    v_mul_f32 v159, v159, v183
    v_mul_f32 v160, v160, v183
    v_mul_f32 v161, v161, v183
    v_mul_f32 v162, v162, v183
    v_mul_f32 v163, v163, v183
    s_waitcnt vmcnt(22)
    v_cvt_f32_i32 v100, v4
    v_cvt_f32_i32 v101, v5
    v_cvt_f32_i32 v102, v6
    v_cvt_f32_i32 v103, v7
    buffer_load_dwordx4 v[96:99], v1, s[28:31], s71 offen offset:512 nt
    v_fmac_f32_dpp v152, v170, v100 row_newbcast:0 row_mask:0xf bank_mask:0xf
    v_fmac_f32_dpp v153, v170, v101 row_newbcast:0 row_mask:0xf bank_mask:0xf
    v_fmac_f32_dpp v154, v170, v102 row_newbcast:0 row_mask:0xf bank_mask:0xf
    v_fmac_f32_dpp v155, v170, v103 row_newbcast:0 row_mask:0xf bank_mask:0xf
    s_waitcnt vmcnt(22)
    v_cvt_f32_i32 v104, v8
    v_cvt_f32_i32 v105, v9
    v_cvt_f32_i32 v106, v10
    v_cvt_f32_i32 v107, v11
    s_add_u32 s71, s71, 3072
    buffer_load_dwordx4 v[4:7], v1, s[28:31], s71 offen offset:0 nt
    v_fmac_f32_dpp v156, v170, v104 row_newbcast:0 row_mask:0xf bank_mask:0xf
    v_fmac_f32_dpp v157, v170, v105 row_newbcast:0 row_mask:0xf bank_mask:0xf
    v_fmac_f32_dpp v158, v170, v106 row_newbcast:0 row_mask:0xf bank_mask:0xf
    v_fmac_f32_dpp v159, v170, v107 row_newbcast:0 row_mask:0xf bank_mask:0xf
    s_waitcnt vmcnt(22)
    v_cvt_f32_i32 v100, v12
    v_cvt_f32_i32 v101, v13
    v_cvt_f32_i32 v102, v14
    v_cvt_f32_i32 v103, v15
    buffer_load_dwordx4 v[8:11], v1, s[28:31], s71 offen offset:256 nt
    v_fmac_f32_dpp v160, v170, v100 row_newbcast:0 row_mask:0xf bank_mask:0xf
    v_fmac_f32_dpp v161, v170, v101 row_newbcast:0 row_mask:0xf bank_mask:0xf
    v_fmac_f32_dpp v162, v170, v102 row_newbcast:0 row_mask:0xf bank_mask:0xf
    v_fmac_f32_dpp v163, v170, v103 row_newbcast:0 row_mask:0xf bank_mask:0xf
    s_waitcnt vmcnt(22)
    v_cvt_f32_i32 v104, v16
    v_cvt_f32_i32 v105, v17
    v_cvt_f32_i32 v106, v18
    v_cvt_f32_i32 v107, v19
    buffer_load_dwordx4 v[12:15], v1, s[28:31], s71 offen offset:512 nt
    v_fmac_f32_dpp v152, v170, v104 row_newbcast:8 row_mask:0xf bank_mask:0xf
    v_fmac_f32_dpp v153, v170, v105 row_newbcast:8 row_mask:0xf bank_mask:0xf
    v_fmac_f32_dpp v154, v170, v106 row_newbcast:8 row_mask:0xf bank_mask:0xf
    v_fmac_f32_dpp v155, v170, v107 row_newbcast:8 row_mask:0xf bank_mask:0xf
    s_waitcnt vmcnt(22)
    v_cvt_f32_i32 v100, v20
    v_cvt_f32_i32 v101, v21
    v_cvt_f32_i32 v102, v22
    v_cvt_f32_i32 v103, v23
    s_add_u32 s71, s71, 3072
    buffer_load_dwordx4 v[16:19], v1, s[28:31], s71 offen offset:0 nt
    v_fmac_f32_dpp v156, v170, v100 row_newbcast:8 row_mask:0xf bank_mask:0xf
    v_fmac_f32_dpp v157, v170, v101 row_newbcast:8 row_mask:0xf bank_mask:0xf
    v_fmac_f32_dpp v158, v170, v102 row_newbcast:8 row_mask:0xf bank_mask:0xf
    v_fmac_f32_dpp v159, v170, v103 row_newbcast:8 row_mask:0xf bank_mask:0xf
    s_waitcnt vmcnt(22)
    v_cvt_f32_i32 v104, v24
    v_cvt_f32_i32 v105, v25
    v_cvt_f32_i32 v106, v26
    v_cvt_f32_i32 v107, v27
    buffer_load_dwordx4 v[20:23], v1, s[28:31], s71 offen offset:256 nt
    v_fmac_f32_dpp v160, v170, v104 row_newbcast:8 row_mask:0xf bank_mask:0xf
    v_fmac_f32_dpp v161, v170, v105 row_newbcast:8 row_mask:0xf bank_mask:0xf
    v_fmac_f32_dpp v162, v170, v106 row_newbcast:8 row_mask:0xf bank_mask:0xf
    v_fmac_f32_dpp v163, v170, v107 row_newbcast:8 row_mask:0xf bank_mask:0xf
    s_waitcnt vmcnt(22)
    v_cvt_f32_i32 v100, v28
    v_cvt_f32_i32 v101, v29
    v_cvt_f32_i32 v102, v30
    v_cvt_f32_i32 v103, v31
    buffer_load_dwordx4 v[24:27], v1, s[28:31], s71 offen offset:512 nt
    v_fmac_f32_dpp v152, v170, v100 row_newbcast:4 row_mask:0xf bank_mask:0xf
    v_fmac_f32_dpp v153, v170, v101 row_newbcast:4 row_mask:0xf bank_mask:0xf
    v_fmac_f32_dpp v154, v170, v102 row_newbcast:4 row_mask:0xf bank_mask:0xf
    v_fmac_f32_dpp v155, v170, v103 row_newbcast:4 row_mask:0xf bank_mask:0xf
    s_waitcnt vmcnt(22)
    v_cvt_f32_i32 v104, v32
    v_cvt_f32_i32 v105, v33
    v_cvt_f32_i32 v106, v34
    v_cvt_f32_i32 v107, v35
    s_add_u32 s71, s71, 3072
    buffer_load_dwordx4 v[28:31], v1, s[28:31], s71 offen offset:0 nt
    v_fmac_f32_dpp v156, v170, v104 row_newbcast:4 row_mask:0xf bank_mask:0xf
    v_fmac_f32_dpp v157, v170, v105 row_newbcast:4 row_mask:0xf bank_mask:0xf
    v_fmac_f32_dpp v158, v170, v106 row_newbcast:4 row_mask:0xf bank_mask:0xf
    v_fmac_f32_dpp v159, v170, v107 row_newbcast:4 row_mask:0xf bank_mask:0xf
    s_waitcnt vmcnt(22)
    v_cvt_f32_i32 v100, v36
    v_cvt_f32_i32 v101, v37
    v_cvt_f32_i32 v102, v38
    v_cvt_f32_i32 v103, v39
    buffer_load_dwordx4 v[32:35], v1, s[28:31], s71 offen offset:256 nt
    v_fmac_f32_dpp v160, v170, v100 row_newbcast:4 row_mask:0xf bank_mask:0xf
    v_fmac_f32_dpp v161, v170, v101 row_newbcast:4 row_mask:0xf bank_mask:0xf
    v_fmac_f32_dpp v162, v170, v102 row_newbcast:4 row_mask:0xf bank_mask:0xf
    v_fmac_f32_dpp v163, v170, v103 row_newbcast:4 row_mask:0xf bank_mask:0xf
    s_waitcnt vmcnt(22)
    v_cvt_f32_i32 v104, v40
    v_cvt_f32_i32 v105, v41
    v_cvt_f32_i32 v106, v42
    v_cvt_f32_i32 v107, v43
    buffer_load_dwordx4 v[36:39], v1, s[28:31], s71 offen offset:512 nt
    v_fmac_f32_dpp v152, v170, v104 row_newbcast:12 row_mask:0xf bank_mask:0xf
    v_fmac_f32_dpp v153, v170, v105 row_newbcast:12 row_mask:0xf bank_mask:0xf
    v_fmac_f32_dpp v154, v170, v106 row_newbcast:12 row_mask:0xf bank_mask:0xf
    v_fmac_f32_dpp v155, v170, v107 row_newbcast:12 row_mask:0xf bank_mask:0xf
    s_waitcnt vmcnt(22)
    v_cvt_f32_i32 v100, v44
    v_cvt_f32_i32 v101, v45
    v_cvt_f32_i32 v102, v46
    v_cvt_f32_i32 v103, v47
    s_add_u32 s71, s71, 3072
    buffer_load_dwordx4 v[40:43], v1, s[28:31], s71 offen offset:0 nt
    v_fmac_f32_dpp v156, v170, v100 row_newbcast:12 row_mask:0xf bank_mask:0xf
    v_fmac_f32_dpp v157, v170, v101 row_newbcast:12 row_mask:0xf bank_mask:0xf
    v_fmac_f32_dpp v158, v170, v102 row_newbcast:12 row_mask:0xf bank_mask:0xf
    v_fmac_f32_dpp v159, v170, v103 row_newbcast:12 row_mask:0xf bank_mask:0xf
    s_waitcnt vmcnt(22)
    v_cvt_f32_i32 v104, v48
    v_cvt_f32_i32 v105, v49
    v_cvt_f32_i32 v106, v50
    v_cvt_f32_i32 v107, v51
    buffer_load_dwordx4 v[44:47], v1, s[28:31], s71 offen offset:256 nt
    v_fmac_f32_dpp v160, v170, v104 row_newbcast:12 row_mask:0xf bank_mask:0xf
    v_fmac_f32_dpp v161, v170, v105 row_newbcast:12 row_mask:0xf bank_mask:0xf
    v_fmac_f32_dpp v162, v170, v106 row_newbcast:12 row_mask:0xf bank_mask:0xf
    v_fmac_f32_dpp v163, v170, v107 row_newbcast:12 row_mask:0xf bank_mask:0xf
    s_waitcnt vmcnt(22)
    v_cvt_f32_i32 v100, v52
    v_cvt_f32_i32 v101, v53
    v_cvt_f32_i32 v102, v54
    v_cvt_f32_i32 v103, v55
    buffer_load_dwordx4 v[48:51], v1, s[28:31], s71 offen offset:512 nt
    v_fmac_f32_dpp v152, v170, v100 row_newbcast:2 row_mask:0xf bank_mask:0xf
    v_fmac_f32_dpp v153, v170, v101 row_newbcast:2 row_mask:0xf bank_mask:0xf
    v_fmac_f32_dpp v154, v170, v102 row_newbcast:2 row_mask:0xf bank_mask:0xf
    v_fmac_f32_dpp v155, v170, v103 row_newbcast:2 row_mask:0xf bank_mask:0xf
    s_waitcnt vmcnt(22)
    v_cvt_f32_i32 v104, v56
    v_cvt_f32_i32 v105, v57
    v_cvt_f32_i32 v106, v58
    v_cvt_f32_i32 v107, v59
    s_add_u32 s71, s71, 3072
    buffer_load_dwordx4 v[52:55], v1, s[28:31], s71 offen offset:0 nt
    v_fmac_f32_dpp v156, v170, v104 row_newbcast:2 row_mask:0xf bank_mask:0xf
    v_fmac_f32_dpp v157, v170, v105 row_newbcast:2 row_mask:0xf bank_mask:0xf
    v_fmac_f32_dpp v158, v170, v106 row_newbcast:2 row_mask:0xf bank_mask:0xf
    v_fmac_f32_dpp v159, v170, v107 row_newbcast:2 row_mask:0xf bank_mask:0xf
    s_waitcnt vmcnt(22)
    v_cvt_f32_i32 v100, v60
    v_cvt_f32_i32 v101, v61
    v_cvt_f32_i32 v102, v62
    v_cvt_f32_i32 v103, v63
    buffer_load_dwordx4 v[56:59], v1, s[28:31], s71 offen offset:256 nt
    v_fmac_f32_dpp v160, v170, v100 row_newbcast:2 row_mask:0xf bank_mask:0xf
    v_fmac_f32_dpp v161, v170, v101 row_newbcast:2 row_mask:0xf bank_mask:0xf
    v_fmac_f32_dpp v162, v170, v102 row_newbcast:2 row_mask:0xf bank_mask:0xf
    v_fmac_f32_dpp v163, v170, v103 row_newbcast:2 row_mask:0xf bank_mask:0xf
    s_waitcnt vmcnt(22)
    v_cvt_f32_i32 v104, v64
    v_cvt_f32_i32 v105, v65
    v_cvt_f32_i32 v106, v66
    v_cvt_f32_i32 v107, v67
    buffer_load_dwordx4 v[60:63], v1, s[28:31], s71 offen offset:512 nt
    v_fmac_f32_dpp v152, v170, v104 row_newbcast:10 row_mask:0xf bank_mask:0xf
    v_fmac_f32_dpp v153, v170, v105 row_newbcast:10 row_mask:0xf bank_mask:0xf
    v_fmac_f32_dpp v154, v170, v106 row_newbcast:10 row_mask:0xf bank_mask:0xf
    v_fmac_f32_dpp v155, v170, v107 row_newbcast:10 row_mask:0xf bank_mask:0xf
    s_waitcnt vmcnt(22)
    v_cvt_f32_i32 v100, v68
    v_cvt_f32_i32 v101, v69
    v_cvt_f32_i32 v102, v70
    v_cvt_f32_i32 v103, v71
    s_add_u32 s71, s71, 3072
    buffer_load_dwordx4 v[64:67], v1, s[28:31], s71 offen offset:0 nt
    v_fmac_f32_dpp v156, v170, v100 row_newbcast:10 row_mask:0xf bank_mask:0xf
    v_fmac_f32_dpp v157, v170, v101 row_newbcast:10 row_mask:0xf bank_mask:0xf
    v_fmac_f32_dpp v158, v170, v102 row_newbcast:10 row_mask:0xf bank_mask:0xf
    v_fmac_f32_dpp v159, v170, v103 row_newbcast:10 row_mask:0xf bank_mask:0xf
    s_waitcnt vmcnt(22)
    v_cvt_f32_i32 v104, v72
    v_cvt_f32_i32 v105, v73
    v_cvt_f32_i32 v106, v74
    v_cvt_f32_i32 v107, v75
    buffer_load_dwordx4 v[68:71], v1, s[28:31], s71 offen offset:256 nt
    v_fmac_f32_dpp v160, v170, v104 row_newbcast:10 row_mask:0xf bank_mask:0xf
    v_fmac_f32_dpp v161, v170, v105 row_newbcast:10 row_mask:0xf bank_mask:0xf
    v_fmac_f32_dpp v162, v170, v106 row_newbcast:10 row_mask:0xf bank_mask:0xf
    v_fmac_f32_dpp v163, v170, v107 row_newbcast:10 row_mask:0xf bank_mask:0xf
    s_waitcnt vmcnt(22)
    v_cvt_f32_i32 v100, v76
    v_cvt_f32_i32 v101, v77
    v_cvt_f32_i32 v102, v78
    v_cvt_f32_i32 v103, v79
    buffer_load_dwordx4 v[72:75], v1, s[28:31], s71 offen offset:512 nt
    v_fmac_f32_dpp v152, v170, v100 row_newbcast:6 row_mask:0xf bank_mask:0xf
    v_fmac_f32_dpp v153, v170, v101 row_newbcast:6 row_mask:0xf bank_mask:0xf
    v_fmac_f32_dpp v154, v170, v102 row_newbcast:6 row_mask:0xf bank_mask:0xf
    v_fmac_f32_dpp v155, v170, v103 row_newbcast:6 row_mask:0xf bank_mask:0xf
    s_waitcnt vmcnt(22)
    v_cvt_f32_i32 v104, v80
    v_cvt_f32_i32 v105, v81
    v_cvt_f32_i32 v106, v82
    v_cvt_f32_i32 v107, v83
    s_add_u32 s71, s71, 3072
    buffer_load_dwordx4 v[76:79], v1, s[28:31], s71 offen offset:0 nt
    v_fmac_f32_dpp v156, v170, v104 row_newbcast:6 row_mask:0xf bank_mask:0xf
    v_fmac_f32_dpp v157, v170, v105 row_newbcast:6 row_mask:0xf bank_mask:0xf
    v_fmac_f32_dpp v158, v170, v106 row_newbcast:6 row_mask:0xf bank_mask:0xf
    v_fmac_f32_dpp v159, v170, v107 row_newbcast:6 row_mask:0xf bank_mask:0xf
    s_waitcnt vmcnt(22)
    v_cvt_f32_i32 v100, v84
    v_cvt_f32_i32 v101, v85
    v_cvt_f32_i32 v102, v86
    v_cvt_f32_i32 v103, v87
    buffer_load_dwordx4 v[80:83], v1, s[28:31], s71 offen offset:256 nt
    v_fmac_f32_dpp v160, v170, v100 row_newbcast:6 row_mask:0xf bank_mask:0xf
    v_fmac_f32_dpp v161, v170, v101 row_newbcast:6 row_mask:0xf bank_mask:0xf
    v_fmac_f32_dpp v162, v170, v102 row_newbcast:6 row_mask:0xf bank_mask:0xf
    v_fmac_f32_dpp v163, v170, v103 row_newbcast:6 row_mask:0xf bank_mask:0xf
    s_waitcnt vmcnt(22)
    v_cvt_f32_i32 v104, v88
    v_cvt_f32_i32 v105, v89
    v_cvt_f32_i32 v106, v90
    v_cvt_f32_i32 v107, v91
    buffer_load_dwordx4 v[84:87], v1, s[28:31], s71 offen offset:512 nt
    v_fmac_f32_dpp v152, v170, v104 row_newbcast:14 row_mask:0xf bank_mask:0xf
    v_fmac_f32_dpp v153, v170, v105 row_newbcast:14 row_mask:0xf bank_mask:0xf
    v_fmac_f32_dpp v154, v170, v106 row_newbcast:14 row_mask:0xf bank_mask:0xf
    v_fmac_f32_dpp v155, v170, v107 row_newbcast:14 row_mask:0xf bank_mask:0xf
    s_waitcnt vmcnt(22)
    v_cvt_f32_i32 v100, v92
    v_cvt_f32_i32 v101, v93
    v_cvt_f32_i32 v102, v94
    v_cvt_f32_i32 v103, v95
    s_add_u32 s71, s71, 3072
    buffer_load_dwordx4 v[88:91], v1, s[28:31], s71 offen offset:0 nt
    v_fmac_f32_dpp v156, v170, v100 row_newbcast:14 row_mask:0xf bank_mask:0xf
    v_fmac_f32_dpp v157, v170, v101 row_newbcast:14 row_mask:0xf bank_mask:0xf
    v_fmac_f32_dpp v158, v170, v102 row_newbcast:14 row_mask:0xf bank_mask:0xf
    v_fmac_f32_dpp v159, v170, v103 row_newbcast:14 row_mask:0xf bank_mask:0xf
    s_waitcnt vmcnt(22)
    v_cvt_f32_i32 v104, v96
    v_cvt_f32_i32 v105, v97
    v_cvt_f32_i32 v106, v98
    v_cvt_f32_i32 v107, v99
    buffer_load_dwordx4 v[92:95], v1, s[28:31], s71 offen offset:256 nt
    v_fmac_f32_dpp v160, v170, v104 row_newbcast:14 row_mask:0xf bank_mask:0xf
    v_fmac_f32_dpp v161, v170, v105 row_newbcast:14 row_mask:0xf bank_mask:0xf
    v_fmac_f32_dpp v162, v170, v106 row_newbcast:14 row_mask:0xf bank_mask:0xf
    v_fmac_f32_dpp v163, v170, v107 row_newbcast:14 row_mask:0xf bank_mask:0xf
    s_waitcnt vmcnt(22)
    v_cvt_f32_i32 v100, v4
    v_cvt_f32_i32 v101, v5
    v_cvt_f32_i32 v102, v6
    v_cvt_f32_i32 v103, v7
    buffer_load_dwordx4 v[96:99], v1, s[28:31], s71 offen offset:512 nt
    v_fmac_f32_dpp v152, v170, v100 row_newbcast:1 row_mask:0xf bank_mask:0xf
    v_fmac_f32_dpp v153, v170, v101 row_newbcast:1 row_mask:0xf bank_mask:0xf
    v_fmac_f32_dpp v154, v170, v102 row_newbcast:1 row_mask:0xf bank_mask:0xf
    v_fmac_f32_dpp v155, v170, v103 row_newbcast:1 row_mask:0xf bank_mask:0xf
    s_waitcnt vmcnt(22)
    v_cvt_f32_i32 v104, v8
    v_cvt_f32_i32 v105, v9
    v_cvt_f32_i32 v106, v10
    v_cvt_f32_i32 v107, v11
    s_add_u32 s56, s56, 64
    s_and_b32 s56, s56, 511
    s_sub_u32 s75, s75, 1
    s_cmp_eq_u32 s75, 0
    s_cselect_b32 s80, 2048, 0
    s_cselect_b32 s75, 8, s75
    s_add_u32 s57, s57, s80
    s_add_u32 s70, s57, s56
    s_lshl_b32 s73, s70, 7
    buffer_load_ushort v168, v3, s[40:43], s73 offen
    buffer_load_ushort v169, v3, s[44:47], s73 offen
    s_mul_i32 s71, s70, 49152
    buffer_load_dwordx4 v[4:7], v1, s[28:31], s71 offen offset:0 nt
    v_fmac_f32_dpp v156, v170, v104 row_newbcast:1 row_mask:0xf bank_mask:0xf
    v_fmac_f32_dpp v157, v170, v105 row_newbcast:1 row_mask:0xf bank_mask:0xf
    v_fmac_f32_dpp v158, v170, v106 row_newbcast:1 row_mask:0xf bank_mask:0xf
    v_fmac_f32_dpp v159, v170, v107 row_newbcast:1 row_mask:0xf bank_mask:0xf
    s_waitcnt vmcnt(24)
    v_cvt_f32_i32 v100, v12
    v_cvt_f32_i32 v101, v13
    v_cvt_f32_i32 v102, v14
    v_cvt_f32_i32 v103, v15
    buffer_load_dwordx4 v[8:11], v1, s[28:31], s71 offen offset:256 nt
    v_fmac_f32_dpp v160, v170, v100 row_newbcast:1 row_mask:0xf bank_mask:0xf
    v_fmac_f32_dpp v161, v170, v101 row_newbcast:1 row_mask:0xf bank_mask:0xf
    v_fmac_f32_dpp v162, v170, v102 row_newbcast:1 row_mask:0xf bank_mask:0xf
    v_fmac_f32_dpp v163, v170, v103 row_newbcast:1 row_mask:0xf bank_mask:0xf
    s_waitcnt vmcnt(24)
    v_cvt_f32_i32 v104, v16
    v_cvt_f32_i32 v105, v17
    v_cvt_f32_i32 v106, v18
    v_cvt_f32_i32 v107, v19
    buffer_load_dwordx4 v[12:15], v1, s[28:31], s71 offen offset:512 nt
    v_fmac_f32_dpp v152, v170, v104 row_newbcast:9 row_mask:0xf bank_mask:0xf
    v_fmac_f32_dpp v153, v170, v105 row_newbcast:9 row_mask:0xf bank_mask:0xf
    v_fmac_f32_dpp v154, v170, v106 row_newbcast:9 row_mask:0xf bank_mask:0xf
    v_fmac_f32_dpp v155, v170, v107 row_newbcast:9 row_mask:0xf bank_mask:0xf
    s_waitcnt vmcnt(24)
    v_cvt_f32_i32 v100, v20
    v_cvt_f32_i32 v101, v21
    v_cvt_f32_i32 v102, v22
    v_cvt_f32_i32 v103, v23
    s_add_u32 s71, s71, 3072
    buffer_load_dwordx4 v[16:19], v1, s[28:31], s71 offen offset:0 nt
    v_fmac_f32_dpp v156, v170, v100 row_newbcast:9 row_mask:0xf bank_mask:0xf
    v_fmac_f32_dpp v157, v170, v101 row_newbcast:9 row_mask:0xf bank_mask:0xf
    v_fmac_f32_dpp v158, v170, v102 row_newbcast:9 row_mask:0xf bank_mask:0xf
    v_fmac_f32_dpp v159, v170, v103 row_newbcast:9 row_mask:0xf bank_mask:0xf
    s_waitcnt vmcnt(24)
    v_cvt_f32_i32 v104, v24
    v_cvt_f32_i32 v105, v25
    v_cvt_f32_i32 v106, v26
    v_cvt_f32_i32 v107, v27
    buffer_load_dwordx4 v[20:23], v1, s[28:31], s71 offen offset:256 nt
    v_fmac_f32_dpp v160, v170, v104 row_newbcast:9 row_mask:0xf bank_mask:0xf
    v_fmac_f32_dpp v161, v170, v105 row_newbcast:9 row_mask:0xf bank_mask:0xf
    v_fmac_f32_dpp v162, v170, v106 row_newbcast:9 row_mask:0xf bank_mask:0xf
    v_fmac_f32_dpp v163, v170, v107 row_newbcast:9 row_mask:0xf bank_mask:0xf
    s_waitcnt vmcnt(24)
    v_cvt_f32_i32 v100, v28
    v_cvt_f32_i32 v101, v29
    v_cvt_f32_i32 v102, v30
    v_cvt_f32_i32 v103, v31
    buffer_load_dwordx4 v[24:27], v1, s[28:31], s71 offen offset:512 nt
    v_fmac_f32_dpp v152, v170, v100 row_newbcast:5 row_mask:0xf bank_mask:0xf
    v_fmac_f32_dpp v153, v170, v101 row_newbcast:5 row_mask:0xf bank_mask:0xf
    v_fmac_f32_dpp v154, v170, v102 row_newbcast:5 row_mask:0xf bank_mask:0xf
    v_fmac_f32_dpp v155, v170, v103 row_newbcast:5 row_mask:0xf bank_mask:0xf
    s_waitcnt vmcnt(24)
    v_cvt_f32_i32 v104, v32
    v_cvt_f32_i32 v105, v33
    v_cvt_f32_i32 v106, v34
    v_cvt_f32_i32 v107, v35
    s_add_u32 s71, s71, 3072
    buffer_load_dwordx4 v[28:31], v1, s[28:31], s71 offen offset:0 nt
    v_fmac_f32_dpp v156, v170, v104 row_newbcast:5 row_mask:0xf bank_mask:0xf
    v_fmac_f32_dpp v157, v170, v105 row_newbcast:5 row_mask:0xf bank_mask:0xf
    v_fmac_f32_dpp v158, v170, v106 row_newbcast:5 row_mask:0xf bank_mask:0xf
    v_fmac_f32_dpp v159, v170, v107 row_newbcast:5 row_mask:0xf bank_mask:0xf
    s_waitcnt vmcnt(24)
    v_cvt_f32_i32 v100, v36
    v_cvt_f32_i32 v101, v37
    v_cvt_f32_i32 v102, v38
    v_cvt_f32_i32 v103, v39
    buffer_load_dwordx4 v[32:35], v1, s[28:31], s71 offen offset:256 nt
    v_fmac_f32_dpp v160, v170, v100 row_newbcast:5 row_mask:0xf bank_mask:0xf
    v_fmac_f32_dpp v161, v170, v101 row_newbcast:5 row_mask:0xf bank_mask:0xf
    v_fmac_f32_dpp v162, v170, v102 row_newbcast:5 row_mask:0xf bank_mask:0xf
    v_fmac_f32_dpp v163, v170, v103 row_newbcast:5 row_mask:0xf bank_mask:0xf
    s_waitcnt vmcnt(24)
    v_cvt_f32_i32 v104, v40
    v_cvt_f32_i32 v105, v41
    v_cvt_f32_i32 v106, v42
    v_cvt_f32_i32 v107, v43
    buffer_load_dwordx4 v[36:39], v1, s[28:31], s71 offen offset:512 nt
    v_fmac_f32_dpp v152, v170, v104 row_newbcast:13 row_mask:0xf bank_mask:0xf
    v_fmac_f32_dpp v153, v170, v105 row_newbcast:13 row_mask:0xf bank_mask:0xf
    v_fmac_f32_dpp v154, v170, v106 row_newbcast:13 row_mask:0xf bank_mask:0xf
    v_fmac_f32_dpp v155, v170, v107 row_newbcast:13 row_mask:0xf bank_mask:0xf
    s_waitcnt vmcnt(24)
    v_cvt_f32_i32 v100, v44
    v_cvt_f32_i32 v101, v45
    v_cvt_f32_i32 v102, v46
    v_cvt_f32_i32 v103, v47
    s_add_u32 s71, s71, 3072
    buffer_load_dwordx4 v[40:43], v1, s[28:31], s71 offen offset:0 nt
    v_fmac_f32_dpp v156, v170, v100 row_newbcast:13 row_mask:0xf bank_mask:0xf
    v_fmac_f32_dpp v157, v170, v101 row_newbcast:13 row_mask:0xf bank_mask:0xf
    v_fmac_f32_dpp v158, v170, v102 row_newbcast:13 row_mask:0xf bank_mask:0xf
    v_fmac_f32_dpp v159, v170, v103 row_newbcast:13 row_mask:0xf bank_mask:0xf
    s_waitcnt vmcnt(24)
    v_cvt_f32_i32 v104, v48
    v_cvt_f32_i32 v105, v49
    v_cvt_f32_i32 v106, v50
    v_cvt_f32_i32 v107, v51
    buffer_load_dwordx4 v[44:47], v1, s[28:31], s71 offen offset:256 nt
    v_fmac_f32_dpp v160, v170, v104 row_newbcast:13 row_mask:0xf bank_mask:0xf
    v_fmac_f32_dpp v161, v170, v105 row_newbcast:13 row_mask:0xf bank_mask:0xf
    v_fmac_f32_dpp v162, v170, v106 row_newbcast:13 row_mask:0xf bank_mask:0xf
    v_fmac_f32_dpp v163, v170, v107 row_newbcast:13 row_mask:0xf bank_mask:0xf
    s_waitcnt vmcnt(24)
    v_cvt_f32_i32 v100, v52
    v_cvt_f32_i32 v101, v53
    v_cvt_f32_i32 v102, v54
    v_cvt_f32_i32 v103, v55
    buffer_load_dwordx4 v[48:51], v1, s[28:31], s71 offen offset:512 nt
    v_fmac_f32_dpp v152, v170, v100 row_newbcast:3 row_mask:0xf bank_mask:0xf
    v_fmac_f32_dpp v153, v170, v101 row_newbcast:3 row_mask:0xf bank_mask:0xf
    v_fmac_f32_dpp v154, v170, v102 row_newbcast:3 row_mask:0xf bank_mask:0xf
    v_fmac_f32_dpp v155, v170, v103 row_newbcast:3 row_mask:0xf bank_mask:0xf
    s_waitcnt vmcnt(24)
    v_cvt_f32_i32 v104, v56
    v_cvt_f32_i32 v105, v57
    v_cvt_f32_i32 v106, v58
    v_cvt_f32_i32 v107, v59
    s_add_u32 s71, s71, 3072
    buffer_load_dwordx4 v[52:55], v1, s[28:31], s71 offen offset:0 nt
    v_fmac_f32_dpp v156, v170, v104 row_newbcast:3 row_mask:0xf bank_mask:0xf
    v_fmac_f32_dpp v157, v170, v105 row_newbcast:3 row_mask:0xf bank_mask:0xf
    v_fmac_f32_dpp v158, v170, v106 row_newbcast:3 row_mask:0xf bank_mask:0xf
    v_fmac_f32_dpp v159, v170, v107 row_newbcast:3 row_mask:0xf bank_mask:0xf
    s_waitcnt vmcnt(24)
    v_cvt_f32_i32 v100, v60
    v_cvt_f32_i32 v101, v61
    v_cvt_f32_i32 v102, v62
    v_cvt_f32_i32 v103, v63
    buffer_load_dwordx4 v[56:59], v1, s[28:31], s71 offen offset:256 nt
    v_fmac_f32_dpp v160, v170, v100 row_newbcast:3 row_mask:0xf bank_mask:0xf
    v_fmac_f32_dpp v161, v170, v101 row_newbcast:3 row_mask:0xf bank_mask:0xf
    v_fmac_f32_dpp v162, v170, v102 row_newbcast:3 row_mask:0xf bank_mask:0xf
    v_fmac_f32_dpp v163, v170, v103 row_newbcast:3 row_mask:0xf bank_mask:0xf
    s_waitcnt vmcnt(24)
    v_cvt_f32_i32 v104, v64
    v_cvt_f32_i32 v105, v65
    v_cvt_f32_i32 v106, v66
    v_cvt_f32_i32 v107, v67
    buffer_load_dwordx4 v[60:63], v1, s[28:31], s71 offen offset:512 nt
    v_fmac_f32_dpp v152, v170, v104 row_newbcast:11 row_mask:0xf bank_mask:0xf
    v_fmac_f32_dpp v153, v170, v105 row_newbcast:11 row_mask:0xf bank_mask:0xf
    v_fmac_f32_dpp v154, v170, v106 row_newbcast:11 row_mask:0xf bank_mask:0xf
    v_fmac_f32_dpp v155, v170, v107 row_newbcast:11 row_mask:0xf bank_mask:0xf
    s_waitcnt vmcnt(24)
    v_cvt_f32_i32 v100, v68
    v_cvt_f32_i32 v101, v69
    v_cvt_f32_i32 v102, v70
    v_cvt_f32_i32 v103, v71
    s_add_u32 s71, s71, 3072
    buffer_load_dwordx4 v[64:67], v1, s[28:31], s71 offen offset:0 nt
    v_fmac_f32_dpp v156, v170, v100 row_newbcast:11 row_mask:0xf bank_mask:0xf
    v_fmac_f32_dpp v157, v170, v101 row_newbcast:11 row_mask:0xf bank_mask:0xf
    v_fmac_f32_dpp v158, v170, v102 row_newbcast:11 row_mask:0xf bank_mask:0xf
    v_fmac_f32_dpp v159, v170, v103 row_newbcast:11 row_mask:0xf bank_mask:0xf
    s_waitcnt vmcnt(24)
    v_cvt_f32_i32 v104, v72
    v_cvt_f32_i32 v105, v73
    v_cvt_f32_i32 v106, v74
    v_cvt_f32_i32 v107, v75
    buffer_load_dwordx4 v[68:71], v1, s[28:31], s71 offen offset:256 nt
    v_fmac_f32_dpp v160, v170, v104 row_newbcast:11 row_mask:0xf bank_mask:0xf
    v_fmac_f32_dpp v161, v170, v105 row_newbcast:11 row_mask:0xf bank_mask:0xf
    v_fmac_f32_dpp v162, v170, v106 row_newbcast:11 row_mask:0xf bank_mask:0xf
    v_fmac_f32_dpp v163, v170, v107 row_newbcast:11 row_mask:0xf bank_mask:0xf
    s_waitcnt vmcnt(24)
    v_cvt_f32_i32 v100, v76
    v_cvt_f32_i32 v101, v77
    v_cvt_f32_i32 v102, v78
    v_cvt_f32_i32 v103, v79
    buffer_load_dwordx4 v[72:75], v1, s[28:31], s71 offen offset:512 nt
    v_fmac_f32_dpp v152, v170, v100 row_newbcast:7 row_mask:0xf bank_mask:0xf
    v_fmac_f32_dpp v153, v170, v101 row_newbcast:7 row_mask:0xf bank_mask:0xf
    v_fmac_f32_dpp v154, v170, v102 row_newbcast:7 row_mask:0xf bank_mask:0xf
    v_fmac_f32_dpp v155, v170, v103 row_newbcast:7 row_mask:0xf bank_mask:0xf
    s_waitcnt vmcnt(24)
    v_cvt_f32_i32 v104, v80
    v_cvt_f32_i32 v105, v81
    v_cvt_f32_i32 v106, v82
    v_cvt_f32_i32 v107, v83
    s_add_u32 s71, s71, 3072
    buffer_load_dwordx4 v[76:79], v1, s[28:31], s71 offen offset:0 nt
    v_fmac_f32_dpp v156, v170, v104 row_newbcast:7 row_mask:0xf bank_mask:0xf
    v_fmac_f32_dpp v157, v170, v105 row_newbcast:7 row_mask:0xf bank_mask:0xf
    v_fmac_f32_dpp v158, v170, v106 row_newbcast:7 row_mask:0xf bank_mask:0xf
    v_fmac_f32_dpp v159, v170, v107 row_newbcast:7 row_mask:0xf bank_mask:0xf
    s_waitcnt vmcnt(24)
    v_cvt_f32_i32 v100, v84
    v_cvt_f32_i32 v101, v85
    v_cvt_f32_i32 v102, v86
    v_cvt_f32_i32 v103, v87
    buffer_load_dwordx4 v[80:83], v1, s[28:31], s71 offen offset:256 nt
    v_fmac_f32_dpp v160, v170, v100 row_newbcast:7 row_mask:0xf bank_mask:0xf
    v_fmac_f32_dpp v161, v170, v101 row_newbcast:7 row_mask:0xf bank_mask:0xf
    v_fmac_f32_dpp v162, v170, v102 row_newbcast:7 row_mask:0xf bank_mask:0xf
    v_fmac_f32_dpp v163, v170, v103 row_newbcast:7 row_mask:0xf bank_mask:0xf
    s_waitcnt vmcnt(24)
    v_cvt_f32_i32 v104, v88
    v_cvt_f32_i32 v105, v89
    v_cvt_f32_i32 v106, v90
    v_cvt_f32_i32 v107, v91
    buffer_load_dwordx4 v[84:87], v1, s[28:31], s71 offen offset:512 nt
    v_fmac_f32_dpp v152, v170, v104 row_newbcast:15 row_mask:0xf bank_mask:0xf
    v_fmac_f32_dpp v153, v170, v105 row_newbcast:15 row_mask:0xf bank_mask:0xf
    v_fmac_f32_dpp v154, v170, v106 row_newbcast:15 row_mask:0xf bank_mask:0xf
    v_fmac_f32_dpp v155, v170, v107 row_newbcast:15 row_mask:0xf bank_mask:0xf
    s_waitcnt vmcnt(24)
    v_cvt_f32_i32 v100, v92
    v_cvt_f32_i32 v101, v93
    v_cvt_f32_i32 v102, v94
    v_cvt_f32_i32 v103, v95
    s_add_u32 s71, s71, 3072
    buffer_load_dwordx4 v[88:91], v1, s[28:31], s71 offen offset:0 nt
    v_fmac_f32_dpp v156, v170, v100 row_newbcast:15 row_mask:0xf bank_mask:0xf
    v_fmac_f32_dpp v157, v170, v101 row_newbcast:15 row_mask:0xf bank_mask:0xf
    v_fmac_f32_dpp v158, v170, v102 row_newbcast:15 row_mask:0xf bank_mask:0xf
    v_fmac_f32_dpp v159, v170, v103 row_newbcast:15 row_mask:0xf bank_mask:0xf
    s_waitcnt vmcnt(24)
    v_cvt_f32_i32 v104, v96
    v_cvt_f32_i32 v105, v97
    v_cvt_f32_i32 v106, v98
    v_cvt_f32_i32 v107, v99
    buffer_load_dwordx4 v[92:95], v1, s[28:31], s71 offen offset:256 nt
    v_fmac_f32_dpp v160, v170, v104 row_newbcast:15 row_mask:0xf bank_mask:0xf
    v_fmac_f32_dpp v161, v170, v105 row_newbcast:15 row_mask:0xf bank_mask:0xf
    v_fmac_f32_dpp v162, v170, v106 row_newbcast:15 row_mask:0xf bank_mask:0xf
    v_fmac_f32_dpp v163, v170, v107 row_newbcast:15 row_mask:0xf bank_mask:0xf
    s_sub_u32 s77, s77, 1
    s_cmp_lg_u32 s77, 0
    s_cbranch_scc1 L_nofl2
    s_nop 0
    v_add_f32_dpp v166, v166, v166 row_ror:8 row_mask:0xf bank_mask:0xf
    v_add_f32_dpp v167, v167, v167 row_ror:8 row_mask:0xf bank_mask:0xf
    s_nop 0
    v_add_f32_dpp v166, v166, v166 row_ror:4 row_mask:0xf bank_mask:0xf
    v_add_f32_dpp v167, v167, v167 row_ror:4 row_mask:0xf bank_mask:0xf
    s_nop 0
    v_add_f32_dpp v166, v166, v166 row_ror:2 row_mask:0xf bank_mask:0xf
    v_add_f32_dpp v167, v167, v167 row_ror:2 row_mask:0xf bank_mask:0xf
    s_nop 0
    v_add_f32_dpp v166, v166, v166 row_ror:1 row_mask:0xf bank_mask:0xf
    v_add_f32_dpp v167, v167, v167 row_ror:1 row_mask:0xf bank_mask:0xf
    v_mov_b32 v182, v165
    v_mov_b32 v183, v165
    s_nop 1
    v_permlane32_swap_b32 v182, v183
    s_nop 1
    v_max_f32 v182, v182, v183
    v_mov_b32 v183, v182
    s_nop 1
    v_permlane16_swap_b32 v182, v183
    s_nop 1
    v_max_f32 v182, v182, v183
    v_sub_f32 v183, v165, v182
    v_exp_f32 v183, v183
    v_mov_b32 v104, v182
    v_mul_f32 v166, v166, v183
    v_mul_f32 v167, v167, v183
    v_fma_f32 v152, v152, v183, -v167
    v_fma_f32 v153, v153, v183, -v167
    v_fma_f32 v154, v154, v183, -v167
    v_fma_f32 v155, v155, v183, -v167
    v_fma_f32 v156, v156, v183, -v167
    v_fma_f32 v157, v157, v183, -v167
    v_fma_f32 v158, v158, v183, -v167
    v_fma_f32 v159, v159, v183, -v167
    v_fma_f32 v160, v160, v183, -v167
    v_fma_f32 v161, v161, v183, -v167
    v_fma_f32 v162, v162, v183, -v167
    v_fma_f32 v163, v163, v183, -v167
    v_mov_b32 v182, v166
    s_nop 1
    v_permlane32_swap_b32 v166, v182
    v_permlane32_swap_b32 v152, v154
    v_permlane32_swap_b32 v153, v155
    v_permlane32_swap_b32 v156, v158
    v_permlane32_swap_b32 v157, v159
    v_permlane32_swap_b32 v160, v162
    v_permlane32_swap_b32 v161, v163
    s_nop 1
    v_add_f32 v166, v166, v182
    v_add_f32 v152, v152, v154
    v_add_f32 v153, v153, v155
    v_add_f32 v156, v156, v158
    v_add_f32 v157, v157, v159
    v_add_f32 v160, v160, v162
    v_add_f32 v161, v161, v163
    v_mov_b32 v182, v166
    s_nop 1
    v_permlane16_swap_b32 v166, v182
    v_permlane16_swap_b32 v152, v153
    v_permlane16_swap_b32 v156, v157
    v_permlane16_swap_b32 v160, v161
    s_nop 1
    v_add_f32 v105, v166, v182
    v_add_f32 v100, v152, v153
    v_add_f32 v101, v156, v157
    v_add_f32 v102, v160, v161
    v_cndmask_b32 v103, v104, v105, s[66:67]
    ds_write_b128 v186, v[100:103] offset:3328
    v_mov_b32 v165, 0xf149f2ca
    v_mov_b32 v166, 0
    v_mov_b32 v167, 0
    v_mov_b32 v152, 0
    v_mov_b32 v153, 0
    v_mov_b32 v154, 0
    v_mov_b32 v155, 0
    v_mov_b32 v156, 0
    v_mov_b32 v157, 0
    v_mov_b32 v158, 0
    v_mov_b32 v159, 0
    v_mov_b32 v160, 0
    v_mov_b32 v161, 0
    v_mov_b32 v162, 0
    v_mov_b32 v163, 0
    s_waitcnt lgkmcnt(0)
    s_mov_b64 exec, 1
    ds_add_u32 v187, v188
    s_mov_b64 exec, -1
    v_add_u32 v186, 1024, v186
    v_add_u32 v187, 4, v187
    s_mov_b32 s77, 8
L_nofl2:
    s_sub_u32 s76, s76, 1
    s_cmp_lg_u32 s76, 0
    s_cbranch_scc1 L_loop1
    s_waitcnt vmcnt(23)
    v_lshlrev_b32 v168, 16, v168
    v_lshlrev_b32 v169, 16, v169
    s_waitcnt lgkmcnt(0)
    v_max_f32_dpp v182, v171, v171 row_ror:8 row_mask:0xf bank_mask:0xf
    s_nop 1
    v_max_f32_dpp v182, v182, v182 row_ror:4 row_mask:0xf bank_mask:0xf
    s_nop 1
    v_max_f32_dpp v182, v182, v182 row_ror:2 row_mask:0xf bank_mask:0xf
    s_nop 1
    v_max_f32_dpp v182, v182, v182 row_ror:1 row_mask:0xf bank_mask:0xf
    v_max_f32 v182, v182, v165
    v_sub_f32 v183, v165, v182
    v_sub_f32 v170, v171, v182
    v_exp_f32 v183, v183
    v_exp_f32 v170, v170
    v_mov_b32 v165, v182
    v_fma_f32 v166, v166, v183, v170
    v_mul_f32 v170, v170, v168
    v_mul_f32 v167, v167, v183
    v_fmac_f32 v167, v170, v169
    v_mul_f32 v152, v152, v183
    v_mul_f32 v153, v153, v183
    v_mul_f32 v154, v154, v183
    v_mul_f32 v155, v155, v183
    v_mul_f32 v156, v156, v183
    v_mul_f32 v157, v157, v183
    v_mul_f32 v158, v158, v183
    v_mul_f32 v159, v159, v183
    v_mul_f32 v160, v160, v183
    v_mul_f32 v161, v161, v183
    v_mul_f32 v162, v162, v183
    v_mul_f32 v163, v163, v183
    s_waitcnt vmcnt(22)
    v_cvt_f32_i32 v100, v4
    v_cvt_f32_i32 v101, v5
    v_cvt_f32_i32 v102, v6
    v_cvt_f32_i32 v103, v7
    buffer_load_dwordx4 v[96:99], v1, s[28:31], s71 offen offset:512 nt
    v_fmac_f32_dpp v152, v170, v100 row_newbcast:0 row_mask:0xf bank_mask:0xf
    v_fmac_f32_dpp v153, v170, v101 row_newbcast:0 row_mask:0xf bank_mask:0xf
    v_fmac_f32_dpp v154, v170, v102 row_newbcast:0 row_mask:0xf bank_mask:0xf
    v_fmac_f32_dpp v155, v170, v103 row_newbcast:0 row_mask:0xf bank_mask:0xf
    s_waitcnt vmcnt(22)
    v_cvt_f32_i32 v104, v8
    v_cvt_f32_i32 v105, v9
    v_cvt_f32_i32 v106, v10
    v_cvt_f32_i32 v107, v11
    s_add_u32 s71, s71, 3072
    buffer_load_dwordx4 v[4:7], v1, s[28:31], s71 offen offset:0 nt
    v_fmac_f32_dpp v156, v170, v104 row_newbcast:0 row_mask:0xf bank_mask:0xf
    v_fmac_f32_dpp v157, v170, v105 row_newbcast:0 row_mask:0xf bank_mask:0xf
    v_fmac_f32_dpp v158, v170, v106 row_newbcast:0 row_mask:0xf bank_mask:0xf
    v_fmac_f32_dpp v159, v170, v107 row_newbcast:0 row_mask:0xf bank_mask:0xf
    s_waitcnt vmcnt(22)
    v_cvt_f32_i32 v100, v12
    v_cvt_f32_i32 v101, v13
    v_cvt_f32_i32 v102, v14
    v_cvt_f32_i32 v103, v15
    buffer_load_dwordx4 v[8:11], v1, s[28:31], s71 offen offset:256 nt
    v_fmac_f32_dpp v160, v170, v100 row_newbcast:0 row_mask:0xf bank_mask:0xf
    v_fmac_f32_dpp v161, v170, v101 row_newbcast:0 row_mask:0xf bank_mask:0xf
    v_fmac_f32_dpp v162, v170, v102 row_newbcast:0 row_mask:0xf bank_mask:0xf
    v_fmac_f32_dpp v163, v170, v103 row_newbcast:0 row_mask:0xf bank_mask:0xf
    s_waitcnt vmcnt(22)
    v_cvt_f32_i32 v104, v16
    v_cvt_f32_i32 v105, v17
    v_cvt_f32_i32 v106, v18
    v_cvt_f32_i32 v107, v19
    buffer_load_dwordx4 v[12:15], v1, s[28:31], s71 offen offset:512 nt
    v_fmac_f32_dpp v152, v170, v104 row_newbcast:8 row_mask:0xf bank_mask:0xf
    v_fmac_f32_dpp v153, v170, v105 row_newbcast:8 row_mask:0xf bank_mask:0xf
    v_fmac_f32_dpp v154, v170, v106 row_newbcast:8 row_mask:0xf bank_mask:0xf
    v_fmac_f32_dpp v155, v170, v107 row_newbcast:8 row_mask:0xf bank_mask:0xf
L_tagw:
    ds_read_b32 v175, v188 offset:139
    s_waitcnt lgkmcnt(0)
    v_readfirstlane_b32 s93, v175
    s_cmp_eq_u32 s93, 0
    s_cbranch_scc1 L_tagw
    s_mov_b64 exec, 1
    ds_max_u32 v188, v173 offset:131
    s_mov_b64 exec, -1
    v_add_u32 v173, 1, v173
    s_waitcnt vmcnt(22)
    v_cvt_f32_i32 v100, v20
    v_cvt_f32_i32 v101, v21
    v_cvt_f32_i32 v102, v22
    v_cvt_f32_i32 v103, v23
    s_add_u32 s71, s71, 3072
    buffer_load_dwordx4 v[16:19], v1, s[28:31], s71 offen offset:0 nt
    v_fmac_f32_dpp v156, v170, v100 row_newbcast:8 row_mask:0xf bank_mask:0xf
    v_fmac_f32_dpp v157, v170, v101 row_newbcast:8 row_mask:0xf bank_mask:0xf
    v_fmac_f32_dpp v158, v170, v102 row_newbcast:8 row_mask:0xf bank_mask:0xf
    v_fmac_f32_dpp v159, v170, v103 row_newbcast:8 row_mask:0xf bank_mask:0xf
    s_waitcnt vmcnt(22)
    v_cvt_f32_i32 v104, v24
    v_cvt_f32_i32 v105, v25
    v_cvt_f32_i32 v106, v26
    v_cvt_f32_i32 v107, v27
    buffer_load_dwordx4 v[20:23], v1, s[28:31], s71 offen offset:256 nt
    v_fmac_f32_dpp v160, v170, v104 row_newbcast:8 row_mask:0xf bank_mask:0xf
    v_fmac_f32_dpp v161, v170, v105 row_newbcast:8 row_mask:0xf bank_mask:0xf
    v_fmac_f32_dpp v162, v170, v106 row_newbcast:8 row_mask:0xf bank_mask:0xf
    v_fmac_f32_dpp v163, v170, v107 row_newbcast:8 row_mask:0xf bank_mask:0xf
    s_waitcnt vmcnt(22)
    v_cvt_f32_i32 v100, v28
    v_cvt_f32_i32 v101, v29
    v_cvt_f32_i32 v102, v30
    v_cvt_f32_i32 v103, v31
    buffer_load_dwordx4 v[24:27], v1, s[28:31], s71 offen offset:512 nt
    v_fmac_f32_dpp v152, v170, v100 row_newbcast:4 row_mask:0xf bank_mask:0xf
    v_fmac_f32_dpp v153, v170, v101 row_newbcast:4 row_mask:0xf bank_mask:0xf
    v_fmac_f32_dpp v154, v170, v102 row_newbcast:4 row_mask:0xf bank_mask:0xf
    v_fmac_f32_dpp v155, v170, v103 row_newbcast:4 row_mask:0xf bank_mask:0xf
    s_waitcnt vmcnt(22)
    v_cvt_f32_i32 v104, v32
    v_cvt_f32_i32 v105, v33
    v_cvt_f32_i32 v106, v34
    v_cvt_f32_i32 v107, v35
    s_add_u32 s71, s71, 3072
    buffer_load_dwordx4 v[28:31], v1, s[28:31], s71 offen offset:0 nt
    v_fmac_f32_dpp v156, v170, v104 row_newbcast:4 row_mask:0xf bank_mask:0xf
    v_fmac_f32_dpp v157, v170, v105 row_newbcast:4 row_mask:0xf bank_mask:0xf
    v_fmac_f32_dpp v158, v170, v106 row_newbcast:4 row_mask:0xf bank_mask:0xf
    v_fmac_f32_dpp v159, v170, v107 row_newbcast:4 row_mask:0xf bank_mask:0xf
    s_waitcnt vmcnt(22)
    v_cvt_f32_i32 v100, v36
    v_cvt_f32_i32 v101, v37
    v_cvt_f32_i32 v102, v38
    v_cvt_f32_i32 v103, v39
    buffer_load_dwordx4 v[32:35], v1, s[28:31], s71 offen offset:256 nt
    v_fmac_f32_dpp v160, v170, v100 row_newbcast:4 row_mask:0xf bank_mask:0xf
    v_fmac_f32_dpp v161, v170, v101 row_newbcast:4 row_mask:0xf bank_mask:0xf
    v_fmac_f32_dpp v162, v170, v102 row_newbcast:4 row_mask:0xf bank_mask:0xf
    v_fmac_f32_dpp v163, v170, v103 row_newbcast:4 row_mask:0xf bank_mask:0xf
    s_waitcnt vmcnt(22)
    v_cvt_f32_i32 v104, v40
    v_cvt_f32_i32 v105, v41
    v_cvt_f32_i32 v106, v42
    v_cvt_f32_i32 v107, v43
    buffer_load_dwordx4 v[36:39], v1, s[28:31], s71 offen offset:512 nt
    v_fmac_f32_dpp v152, v170, v104 row_newbcast:12 row_mask:0xf bank_mask:0xf
    v_fmac_f32_dpp v153, v170, v105 row_newbcast:12 row_mask:0xf bank_mask:0xf
    v_fmac_f32_dpp v154, v170, v106 row_newbcast:12 row_mask:0xf bank_mask:0xf
    v_fmac_f32_dpp v155, v170, v107 row_newbcast:12 row_mask:0xf bank_mask:0xf
    s_waitcnt vmcnt(22)
    v_cvt_f32_i32 v100, v44
    v_cvt_f32_i32 v101, v45
    v_cvt_f32_i32 v102, v46
    v_cvt_f32_i32 v103, v47
    s_add_u32 s71, s71, 3072
    buffer_load_dwordx4 v[40:43], v1, s[28:31], s71 offen offset:0 nt
    v_fmac_f32_dpp v156, v170, v100 row_newbcast:12 row_mask:0xf bank_mask:0xf
    v_fmac_f32_dpp v157, v170, v101 row_newbcast:12 row_mask:0xf bank_mask:0xf
    v_fmac_f32_dpp v158, v170, v102 row_newbcast:12 row_mask:0xf bank_mask:0xf
    v_fmac_f32_dpp v159, v170, v103 row_newbcast:12 row_mask:0xf bank_mask:0xf
    s_waitcnt vmcnt(22)
    v_cvt_f32_i32 v104, v48
    v_cvt_f32_i32 v105, v49
    v_cvt_f32_i32 v106, v50
    v_cvt_f32_i32 v107, v51
    buffer_load_dwordx4 v[44:47], v1, s[28:31], s71 offen offset:256 nt
    v_fmac_f32_dpp v160, v170, v104 row_newbcast:12 row_mask:0xf bank_mask:0xf
    v_fmac_f32_dpp v161, v170, v105 row_newbcast:12 row_mask:0xf bank_mask:0xf
    v_fmac_f32_dpp v162, v170, v106 row_newbcast:12 row_mask:0xf bank_mask:0xf
    v_fmac_f32_dpp v163, v170, v107 row_newbcast:12 row_mask:0xf bank_mask:0xf
    s_waitcnt vmcnt(22)
    v_cvt_f32_i32 v100, v52
    v_cvt_f32_i32 v101, v53
    v_cvt_f32_i32 v102, v54
    v_cvt_f32_i32 v103, v55
    buffer_load_dwordx4 v[48:51], v1, s[28:31], s71 offen offset:512 nt
    v_fmac_f32_dpp v152, v170, v100 row_newbcast:2 row_mask:0xf bank_mask:0xf
    v_fmac_f32_dpp v153, v170, v101 row_newbcast:2 row_mask:0xf bank_mask:0xf
    v_fmac_f32_dpp v154, v170, v102 row_newbcast:2 row_mask:0xf bank_mask:0xf
    v_fmac_f32_dpp v155, v170, v103 row_newbcast:2 row_mask:0xf bank_mask:0xf
    s_waitcnt vmcnt(22)
    v_cvt_f32_i32 v104, v56
    v_cvt_f32_i32 v105, v57
    v_cvt_f32_i32 v106, v58
    v_cvt_f32_i32 v107, v59
    s_add_u32 s71, s71, 3072
    buffer_load_dwordx4 v[52:55], v1, s[28:31], s71 offen offset:0 nt
    v_fmac_f32_dpp v156, v170, v104 row_newbcast:2 row_mask:0xf bank_mask:0xf
    v_fmac_f32_dpp v157, v170, v105 row_newbcast:2 row_mask:0xf bank_mask:0xf
    v_fmac_f32_dpp v158, v170, v106 row_newbcast:2 row_mask:0xf bank_mask:0xf
    v_fmac_f32_dpp v159, v170, v107 row_newbcast:2 row_mask:0xf bank_mask:0xf
    s_waitcnt vmcnt(22)
    v_cvt_f32_i32 v100, v60
    v_cvt_f32_i32 v101, v61
    v_cvt_f32_i32 v102, v62
    v_cvt_f32_i32 v103, v63
    buffer_load_dwordx4 v[56:59], v1, s[28:31], s71 offen offset:256 nt
    v_fmac_f32_dpp v160, v170, v100 row_newbcast:2 row_mask:0xf bank_mask:0xf
    v_fmac_f32_dpp v161, v170, v101 row_newbcast:2 row_mask:0xf bank_mask:0xf
    v_fmac_f32_dpp v162, v170, v102 row_newbcast:2 row_mask:0xf bank_mask:0xf
    v_fmac_f32_dpp v163, v170, v103 row_newbcast:2 row_mask:0xf bank_mask:0xf
    s_waitcnt vmcnt(22)
    v_cvt_f32_i32 v104, v64
    v_cvt_f32_i32 v105, v65
    v_cvt_f32_i32 v106, v66
    v_cvt_f32_i32 v107, v67
    buffer_load_dwordx4 v[60:63], v1, s[28:31], s71 offen offset:512 nt
    v_fmac_f32_dpp v152, v170, v104 row_newbcast:10 row_mask:0xf bank_mask:0xf
    v_fmac_f32_dpp v153, v170, v105 row_newbcast:10 row_mask:0xf bank_mask:0xf
    v_fmac_f32_dpp v154, v170, v106 row_newbcast:10 row_mask:0xf bank_mask:0xf
    v_fmac_f32_dpp v155, v170, v107 row_newbcast:10 row_mask:0xf bank_mask:0xf
    s_waitcnt vmcnt(22)
    v_cvt_f32_i32 v100, v68
    v_cvt_f32_i32 v101, v69
    v_cvt_f32_i32 v102, v70
    v_cvt_f32_i32 v103, v71
    s_add_u32 s71, s71, 3072
    buffer_load_dwordx4 v[64:67], v1, s[28:31], s71 offen offset:0 nt
    v_fmac_f32_dpp v156, v170, v100 row_newbcast:10 row_mask:0xf bank_mask:0xf
    v_fmac_f32_dpp v157, v170, v101 row_newbcast:10 row_mask:0xf bank_mask:0xf
    v_fmac_f32_dpp v158, v170, v102 row_newbcast:10 row_mask:0xf bank_mask:0xf
    v_fmac_f32_dpp v159, v170, v103 row_newbcast:10 row_mask:0xf bank_mask:0xf
    s_waitcnt vmcnt(22)
    v_cvt_f32_i32 v104, v72
    v_cvt_f32_i32 v105, v73
    v_cvt_f32_i32 v106, v74
    v_cvt_f32_i32 v107, v75
    buffer_load_dwordx4 v[68:71], v1, s[28:31], s71 offen offset:256 nt
    v_fmac_f32_dpp v160, v170, v104 row_newbcast:10 row_mask:0xf bank_mask:0xf
    v_fmac_f32_dpp v161, v170, v105 row_newbcast:10 row_mask:0xf bank_mask:0xf
    v_fmac_f32_dpp v162, v170, v106 row_newbcast:10 row_mask:0xf bank_mask:0xf
    v_fmac_f32_dpp v163, v170, v107 row_newbcast:10 row_mask:0xf bank_mask:0xf
    s_waitcnt vmcnt(22)
    v_cvt_f32_i32 v100, v76
    v_cvt_f32_i32 v101, v77
    v_cvt_f32_i32 v102, v78
    v_cvt_f32_i32 v103, v79
    buffer_load_dwordx4 v[72:75], v1, s[28:31], s71 offen offset:512 nt
    v_fmac_f32_dpp v152, v170, v100 row_newbcast:6 row_mask:0xf bank_mask:0xf
    v_fmac_f32_dpp v153, v170, v101 row_newbcast:6 row_mask:0xf bank_mask:0xf
    v_fmac_f32_dpp v154, v170, v102 row_newbcast:6 row_mask:0xf bank_mask:0xf
    v_fmac_f32_dpp v155, v170, v103 row_newbcast:6 row_mask:0xf bank_mask:0xf
    s_waitcnt vmcnt(22)
    v_cvt_f32_i32 v104, v80
    v_cvt_f32_i32 v105, v81
    v_cvt_f32_i32 v106, v82
    v_cvt_f32_i32 v107, v83
    s_add_u32 s71, s71, 3072
    buffer_load_dwordx4 v[76:79], v1, s[28:31], s71 offen offset:0 nt
    v_fmac_f32_dpp v156, v170, v104 row_newbcast:6 row_mask:0xf bank_mask:0xf
    v_fmac_f32_dpp v157, v170, v105 row_newbcast:6 row_mask:0xf bank_mask:0xf
    v_fmac_f32_dpp v158, v170, v106 row_newbcast:6 row_mask:0xf bank_mask:0xf
    v_fmac_f32_dpp v159, v170, v107 row_newbcast:6 row_mask:0xf bank_mask:0xf
    s_waitcnt vmcnt(22)
    v_cvt_f32_i32 v100, v84
    v_cvt_f32_i32 v101, v85
    v_cvt_f32_i32 v102, v86
    v_cvt_f32_i32 v103, v87
    buffer_load_dwordx4 v[80:83], v1, s[28:31], s71 offen offset:256 nt
    v_fmac_f32_dpp v160, v170, v100 row_newbcast:6 row_mask:0xf bank_mask:0xf
    v_fmac_f32_dpp v161, v170, v101 row_newbcast:6 row_mask:0xf bank_mask:0xf
    v_fmac_f32_dpp v162, v170, v102 row_newbcast:6 row_mask:0xf bank_mask:0xf
    v_fmac_f32_dpp v163, v170, v103 row_newbcast:6 row_mask:0xf bank_mask:0xf
    s_waitcnt vmcnt(22)
    v_cvt_f32_i32 v104, v88
    v_cvt_f32_i32 v105, v89
    v_cvt_f32_i32 v106, v90
    v_cvt_f32_i32 v107, v91
    buffer_load_dwordx4 v[84:87], v1, s[28:31], s71 offen offset:512 nt
    v_fmac_f32_dpp v152, v170, v104 row_newbcast:14 row_mask:0xf bank_mask:0xf
    v_fmac_f32_dpp v153, v170, v105 row_newbcast:14 row_mask:0xf bank_mask:0xf
    v_fmac_f32_dpp v154, v170, v106 row_newbcast:14 row_mask:0xf bank_mask:0xf
    v_fmac_f32_dpp v155, v170, v107 row_newbcast:14 row_mask:0xf bank_mask:0xf
    s_waitcnt vmcnt(22)
    v_cvt_f32_i32 v100, v92
    v_cvt_f32_i32 v101, v93
    v_cvt_f32_i32 v102, v94
    v_cvt_f32_i32 v103, v95
    s_add_u32 s71, s71, 3072
    buffer_load_dwordx4 v[88:91], v1, s[28:31], s71 offen offset:0 nt
    v_fmac_f32_dpp v156, v170, v100 row_newbcast:14 row_mask:0xf bank_mask:0xf
    v_fmac_f32_dpp v157, v170, v101 row_newbcast:14 row_mask:0xf bank_mask:0xf
    v_fmac_f32_dpp v158, v170, v102 row_newbcast:14 row_mask:0xf bank_mask:0xf
    v_fmac_f32_dpp v159, v170, v103 row_newbcast:14 row_mask:0xf bank_mask:0xf
    ds_read_b32 v175, v174
    s_waitcnt vmcnt(22)
    v_cvt_f32_i32 v104, v96
    v_cvt_f32_i32 v105, v97
    v_cvt_f32_i32 v106, v98
    v_cvt_f32_i32 v107, v99
    buffer_load_dwordx4 v[92:95], v1, s[28:31], s71 offen offset:256 nt
    v_fmac_f32_dpp v160, v170, v104 row_newbcast:14 row_mask:0xf bank_mask:0xf
    v_fmac_f32_dpp v161, v170, v105 row_newbcast:14 row_mask:0xf bank_mask:0xf
    v_fmac_f32_dpp v162, v170, v106 row_newbcast:14 row_mask:0xf bank_mask:0xf
    v_fmac_f32_dpp v163, v170, v107 row_newbcast:14 row_mask:0xf bank_mask:0xf
    s_waitcnt vmcnt(22)
    v_cvt_f32_i32 v100, v4
    v_cvt_f32_i32 v101, v5
    v_cvt_f32_i32 v102, v6
    v_cvt_f32_i32 v103, v7
    buffer_load_dwordx4 v[96:99], v1, s[28:31], s71 offen offset:512 nt
    v_fmac_f32_dpp v152, v170, v100 row_newbcast:1 row_mask:0xf bank_mask:0xf
    v_fmac_f32_dpp v153, v170, v101 row_newbcast:1 row_mask:0xf bank_mask:0xf
    v_fmac_f32_dpp v154, v170, v102 row_newbcast:1 row_mask:0xf bank_mask:0xf
    v_fmac_f32_dpp v155, v170, v103 row_newbcast:1 row_mask:0xf bank_mask:0xf
    s_waitcnt lgkmcnt(0)
    v_readfirstlane_b32 s80, v175
    s_cmp_lg_u32 s80, -1
    s_cbranch_scc1 L_tkoks
L_tkws:
    ds_read_b32 v175, v174
    s_waitcnt lgkmcnt(0)
    v_readfirstlane_b32 s80, v175
    s_cmp_eq_u32 s80, -1
    s_cbranch_scc1 L_tkws
L_tkoks:
    v_add_u32 v174, 4, v174
    s_cmp_ge_u32 s80, 384
    s_cbranch_scc1 L_dtail
    s_lshr_b32 s81, s80, 6
    s_and_b32 s80, s80, 63
    s_mul_i32 s56, s81, 64
    s_add_u32 s56, s56, s80
    s_add_u32 s56, s56, s94
    s_and_b32 s56, s56, 511
    s_mov_b32 s57, s59
    s_add_u32 s70, s57, s56
    s_and_b32 s95, s2, 192
    s_add_u32 s95, s95, s80
    s_lshl_b32 s95, s95, 3
    s_add_u32 s95, s95, s81
    s_lshl_b32 s95, s95, 8
    s_add_u32 s95, s95, 18874368
    s_waitcnt vmcnt(22)
    v_cvt_f32_i32 v104, v8
    v_cvt_f32_i32 v105, v9
    v_cvt_f32_i32 v106, v10
    v_cvt_f32_i32 v107, v11
    s_lshl_b32 s73, s70, 7
    buffer_load_dword v171, v172, s[52:55], s95 offen sc0 sc1
    buffer_load_ushort v168, v3, s[40:43], s73 offen
    buffer_load_ushort v169, v3, s[44:47], s73 offen
    s_mul_i32 s71, s70, 49152
    buffer_load_dwordx4 v[4:7], v1, s[28:31], s71 offen offset:0 nt
    v_fmac_f32_dpp v156, v170, v104 row_newbcast:1 row_mask:0xf bank_mask:0xf
    v_fmac_f32_dpp v157, v170, v105 row_newbcast:1 row_mask:0xf bank_mask:0xf
    v_fmac_f32_dpp v158, v170, v106 row_newbcast:1 row_mask:0xf bank_mask:0xf
    v_fmac_f32_dpp v159, v170, v107 row_newbcast:1 row_mask:0xf bank_mask:0xf
    s_waitcnt vmcnt(25)
    v_cvt_f32_i32 v100, v12
    v_cvt_f32_i32 v101, v13
    v_cvt_f32_i32 v102, v14
    v_cvt_f32_i32 v103, v15
    buffer_load_dwordx4 v[8:11], v1, s[28:31], s71 offen offset:256 nt
    v_fmac_f32_dpp v160, v170, v100 row_newbcast:1 row_mask:0xf bank_mask:0xf
    v_fmac_f32_dpp v161, v170, v101 row_newbcast:1 row_mask:0xf bank_mask:0xf
    v_fmac_f32_dpp v162, v170, v102 row_newbcast:1 row_mask:0xf bank_mask:0xf
    v_fmac_f32_dpp v163, v170, v103 row_newbcast:1 row_mask:0xf bank_mask:0xf
    s_waitcnt vmcnt(25)
    v_cvt_f32_i32 v104, v16
    v_cvt_f32_i32 v105, v17
    v_cvt_f32_i32 v106, v18
    v_cvt_f32_i32 v107, v19
    buffer_load_dwordx4 v[12:15], v1, s[28:31], s71 offen offset:512 nt
    v_fmac_f32_dpp v152, v170, v104 row_newbcast:9 row_mask:0xf bank_mask:0xf
    v_fmac_f32_dpp v153, v170, v105 row_newbcast:9 row_mask:0xf bank_mask:0xf
    v_fmac_f32_dpp v154, v170, v106 row_newbcast:9 row_mask:0xf bank_mask:0xf
    v_fmac_f32_dpp v155, v170, v107 row_newbcast:9 row_mask:0xf bank_mask:0xf
    s_waitcnt vmcnt(25)
    v_cvt_f32_i32 v100, v20
    v_cvt_f32_i32 v101, v21
    v_cvt_f32_i32 v102, v22
    v_cvt_f32_i32 v103, v23
    s_add_u32 s71, s71, 3072
    buffer_load_dwordx4 v[16:19], v1, s[28:31], s71 offen offset:0 nt
    v_fmac_f32_dpp v156, v170, v100 row_newbcast:9 row_mask:0xf bank_mask:0xf
    v_fmac_f32_dpp v157, v170, v101 row_newbcast:9 row_mask:0xf bank_mask:0xf
    v_fmac_f32_dpp v158, v170, v102 row_newbcast:9 row_mask:0xf bank_mask:0xf
    v_fmac_f32_dpp v159, v170, v103 row_newbcast:9 row_mask:0xf bank_mask:0xf
    s_waitcnt vmcnt(25)
    v_cvt_f32_i32 v104, v24
    v_cvt_f32_i32 v105, v25
    v_cvt_f32_i32 v106, v26
    v_cvt_f32_i32 v107, v27
    buffer_load_dwordx4 v[20:23], v1, s[28:31], s71 offen offset:256 nt
    v_fmac_f32_dpp v160, v170, v104 row_newbcast:9 row_mask:0xf bank_mask:0xf
    v_fmac_f32_dpp v161, v170, v105 row_newbcast:9 row_mask:0xf bank_mask:0xf
    v_fmac_f32_dpp v162, v170, v106 row_newbcast:9 row_mask:0xf bank_mask:0xf
    v_fmac_f32_dpp v163, v170, v107 row_newbcast:9 row_mask:0xf bank_mask:0xf
    s_waitcnt vmcnt(25)
    v_cvt_f32_i32 v100, v28
    v_cvt_f32_i32 v101, v29
    v_cvt_f32_i32 v102, v30
    v_cvt_f32_i32 v103, v31
    buffer_load_dwordx4 v[24:27], v1, s[28:31], s71 offen offset:512 nt
    v_fmac_f32_dpp v152, v170, v100 row_newbcast:5 row_mask:0xf bank_mask:0xf
    v_fmac_f32_dpp v153, v170, v101 row_newbcast:5 row_mask:0xf bank_mask:0xf
    v_fmac_f32_dpp v154, v170, v102 row_newbcast:5 row_mask:0xf bank_mask:0xf
    v_fmac_f32_dpp v155, v170, v103 row_newbcast:5 row_mask:0xf bank_mask:0xf
    s_waitcnt vmcnt(25)
    v_cvt_f32_i32 v104, v32
    v_cvt_f32_i32 v105, v33
    v_cvt_f32_i32 v106, v34
    v_cvt_f32_i32 v107, v35
    s_add_u32 s71, s71, 3072
    buffer_load_dwordx4 v[28:31], v1, s[28:31], s71 offen offset:0 nt
    v_fmac_f32_dpp v156, v170, v104 row_newbcast:5 row_mask:0xf bank_mask:0xf
    v_fmac_f32_dpp v157, v170, v105 row_newbcast:5 row_mask:0xf bank_mask:0xf
    v_fmac_f32_dpp v158, v170, v106 row_newbcast:5 row_mask:0xf bank_mask:0xf
    v_fmac_f32_dpp v159, v170, v107 row_newbcast:5 row_mask:0xf bank_mask:0xf
    s_waitcnt vmcnt(25)
    v_cvt_f32_i32 v100, v36
    v_cvt_f32_i32 v101, v37
    v_cvt_f32_i32 v102, v38
    v_cvt_f32_i32 v103, v39
    buffer_load_dwordx4 v[32:35], v1, s[28:31], s71 offen offset:256 nt
    v_fmac_f32_dpp v160, v170, v100 row_newbcast:5 row_mask:0xf bank_mask:0xf
    v_fmac_f32_dpp v161, v170, v101 row_newbcast:5 row_mask:0xf bank_mask:0xf
    v_fmac_f32_dpp v162, v170, v102 row_newbcast:5 row_mask:0xf bank_mask:0xf
    v_fmac_f32_dpp v163, v170, v103 row_newbcast:5 row_mask:0xf bank_mask:0xf
    s_waitcnt vmcnt(25)
    v_cvt_f32_i32 v104, v40
    v_cvt_f32_i32 v105, v41
    v_cvt_f32_i32 v106, v42
    v_cvt_f32_i32 v107, v43
    buffer_load_dwordx4 v[36:39], v1, s[28:31], s71 offen offset:512 nt
    v_fmac_f32_dpp v152, v170, v104 row_newbcast:13 row_mask:0xf bank_mask:0xf
    v_fmac_f32_dpp v153, v170, v105 row_newbcast:13 row_mask:0xf bank_mask:0xf
    v_fmac_f32_dpp v154, v170, v106 row_newbcast:13 row_mask:0xf bank_mask:0xf
    v_fmac_f32_dpp v155, v170, v107 row_newbcast:13 row_mask:0xf bank_mask:0xf
    s_waitcnt vmcnt(25)
    v_cvt_f32_i32 v100, v44
    v_cvt_f32_i32 v101, v45
    v_cvt_f32_i32 v102, v46
    v_cvt_f32_i32 v103, v47
    s_add_u32 s71, s71, 3072
    buffer_load_dwordx4 v[40:43], v1, s[28:31], s71 offen offset:0 nt
    v_fmac_f32_dpp v156, v170, v100 row_newbcast:13 row_mask:0xf bank_mask:0xf
    v_fmac_f32_dpp v157, v170, v101 row_newbcast:13 row_mask:0xf bank_mask:0xf
    v_fmac_f32_dpp v158, v170, v102 row_newbcast:13 row_mask:0xf bank_mask:0xf
    v_fmac_f32_dpp v159, v170, v103 row_newbcast:13 row_mask:0xf bank_mask:0xf
    s_waitcnt vmcnt(25)
    v_cvt_f32_i32 v104, v48
    v_cvt_f32_i32 v105, v49
    v_cvt_f32_i32 v106, v50
    v_cvt_f32_i32 v107, v51
    buffer_load_dwordx4 v[44:47], v1, s[28:31], s71 offen offset:256 nt
    v_fmac_f32_dpp v160, v170, v104 row_newbcast:13 row_mask:0xf bank_mask:0xf
    v_fmac_f32_dpp v161, v170, v105 row_newbcast:13 row_mask:0xf bank_mask:0xf
    v_fmac_f32_dpp v162, v170, v106 row_newbcast:13 row_mask:0xf bank_mask:0xf
    v_fmac_f32_dpp v163, v170, v107 row_newbcast:13 row_mask:0xf bank_mask:0xf
    s_waitcnt vmcnt(25)
    v_cvt_f32_i32 v100, v52
    v_cvt_f32_i32 v101, v53
    v_cvt_f32_i32 v102, v54
    v_cvt_f32_i32 v103, v55
    buffer_load_dwordx4 v[48:51], v1, s[28:31], s71 offen offset:512 nt
    v_fmac_f32_dpp v152, v170, v100 row_newbcast:3 row_mask:0xf bank_mask:0xf
    v_fmac_f32_dpp v153, v170, v101 row_newbcast:3 row_mask:0xf bank_mask:0xf
    v_fmac_f32_dpp v154, v170, v102 row_newbcast:3 row_mask:0xf bank_mask:0xf
    v_fmac_f32_dpp v155, v170, v103 row_newbcast:3 row_mask:0xf bank_mask:0xf
    s_waitcnt vmcnt(25)
    v_cvt_f32_i32 v104, v56
    v_cvt_f32_i32 v105, v57
    v_cvt_f32_i32 v106, v58
    v_cvt_f32_i32 v107, v59
    s_add_u32 s71, s71, 3072
    buffer_load_dwordx4 v[52:55], v1, s[28:31], s71 offen offset:0 nt
    v_fmac_f32_dpp v156, v170, v104 row_newbcast:3 row_mask:0xf bank_mask:0xf
    v_fmac_f32_dpp v157, v170, v105 row_newbcast:3 row_mask:0xf bank_mask:0xf
    v_fmac_f32_dpp v158, v170, v106 row_newbcast:3 row_mask:0xf bank_mask:0xf
    v_fmac_f32_dpp v159, v170, v107 row_newbcast:3 row_mask:0xf bank_mask:0xf
    s_waitcnt vmcnt(25)
    v_cvt_f32_i32 v100, v60
    v_cvt_f32_i32 v101, v61
    v_cvt_f32_i32 v102, v62
    v_cvt_f32_i32 v103, v63
    buffer_load_dwordx4 v[56:59], v1, s[28:31], s71 offen offset:256 nt
    v_fmac_f32_dpp v160, v170, v100 row_newbcast:3 row_mask:0xf bank_mask:0xf
    v_fmac_f32_dpp v161, v170, v101 row_newbcast:3 row_mask:0xf bank_mask:0xf
    v_fmac_f32_dpp v162, v170, v102 row_newbcast:3 row_mask:0xf bank_mask:0xf
    v_fmac_f32_dpp v163, v170, v103 row_newbcast:3 row_mask:0xf bank_mask:0xf
    s_waitcnt vmcnt(25)
    v_cvt_f32_i32 v104, v64
    v_cvt_f32_i32 v105, v65
    v_cvt_f32_i32 v106, v66
    v_cvt_f32_i32 v107, v67
    buffer_load_dwordx4 v[60:63], v1, s[28:31], s71 offen offset:512 nt
    v_fmac_f32_dpp v152, v170, v104 row_newbcast:11 row_mask:0xf bank_mask:0xf
    v_fmac_f32_dpp v153, v170, v105 row_newbcast:11 row_mask:0xf bank_mask:0xf
    v_fmac_f32_dpp v154, v170, v106 row_newbcast:11 row_mask:0xf bank_mask:0xf
    v_fmac_f32_dpp v155, v170, v107 row_newbcast:11 row_mask:0xf bank_mask:0xf
    s_waitcnt vmcnt(25)
    v_cvt_f32_i32 v100, v68
    v_cvt_f32_i32 v101, v69
    v_cvt_f32_i32 v102, v70
    v_cvt_f32_i32 v103, v71
    s_add_u32 s71, s71, 3072
    buffer_load_dwordx4 v[64:67], v1, s[28:31], s71 offen offset:0 nt
    v_fmac_f32_dpp v156, v170, v100 row_newbcast:11 row_mask:0xf bank_mask:0xf
    v_fmac_f32_dpp v157, v170, v101 row_newbcast:11 row_mask:0xf bank_mask:0xf
    v_fmac_f32_dpp v158, v170, v102 row_newbcast:11 row_mask:0xf bank_mask:0xf
    v_fmac_f32_dpp v159, v170, v103 row_newbcast:11 row_mask:0xf bank_mask:0xf
    s_waitcnt vmcnt(25)
    v_cvt_f32_i32 v104, v72
    v_cvt_f32_i32 v105, v73
    v_cvt_f32_i32 v106, v74
    v_cvt_f32_i32 v107, v75
    buffer_load_dwordx4 v[68:71], v1, s[28:31], s71 offen offset:256 nt
    v_fmac_f32_dpp v160, v170, v104 row_newbcast:11 row_mask:0xf bank_mask:0xf
    v_fmac_f32_dpp v161, v170, v105 row_newbcast:11 row_mask:0xf bank_mask:0xf
    v_fmac_f32_dpp v162, v170, v106 row_newbcast:11 row_mask:0xf bank_mask:0xf
    v_fmac_f32_dpp v163, v170, v107 row_newbcast:11 row_mask:0xf bank_mask:0xf
    s_waitcnt vmcnt(25)
    v_cvt_f32_i32 v100, v76
    v_cvt_f32_i32 v101, v77
    v_cvt_f32_i32 v102, v78
    v_cvt_f32_i32 v103, v79
    buffer_load_dwordx4 v[72:75], v1, s[28:31], s71 offen offset:512 nt
    v_fmac_f32_dpp v152, v170, v100 row_newbcast:7 row_mask:0xf bank_mask:0xf
    v_fmac_f32_dpp v153, v170, v101 row_newbcast:7 row_mask:0xf bank_mask:0xf
    v_fmac_f32_dpp v154, v170, v102 row_newbcast:7 row_mask:0xf bank_mask:0xf
    v_fmac_f32_dpp v155, v170, v103 row_newbcast:7 row_mask:0xf bank_mask:0xf
    s_waitcnt vmcnt(25)
    v_cvt_f32_i32 v104, v80
    v_cvt_f32_i32 v105, v81
    v_cvt_f32_i32 v106, v82
    v_cvt_f32_i32 v107, v83
    s_add_u32 s71, s71, 3072
    buffer_load_dwordx4 v[76:79], v1, s[28:31], s71 offen offset:0 nt
    v_fmac_f32_dpp v156, v170, v104 row_newbcast:7 row_mask:0xf bank_mask:0xf
    v_fmac_f32_dpp v157, v170, v105 row_newbcast:7 row_mask:0xf bank_mask:0xf
    v_fmac_f32_dpp v158, v170, v106 row_newbcast:7 row_mask:0xf bank_mask:0xf
    v_fmac_f32_dpp v159, v170, v107 row_newbcast:7 row_mask:0xf bank_mask:0xf
    s_waitcnt vmcnt(25)
    v_cvt_f32_i32 v100, v84
    v_cvt_f32_i32 v101, v85
    v_cvt_f32_i32 v102, v86
    v_cvt_f32_i32 v103, v87
    buffer_load_dwordx4 v[80:83], v1, s[28:31], s71 offen offset:256 nt
    v_fmac_f32_dpp v160, v170, v100 row_newbcast:7 row_mask:0xf bank_mask:0xf
    v_fmac_f32_dpp v161, v170, v101 row_newbcast:7 row_mask:0xf bank_mask:0xf
    v_fmac_f32_dpp v162, v170, v102 row_newbcast:7 row_mask:0xf bank_mask:0xf
    v_fmac_f32_dpp v163, v170, v103 row_newbcast:7 row_mask:0xf bank_mask:0xf
    s_waitcnt vmcnt(25)
    v_cvt_f32_i32 v104, v88
    v_cvt_f32_i32 v105, v89
    v_cvt_f32_i32 v106, v90
    v_cvt_f32_i32 v107, v91
    buffer_load_dwordx4 v[84:87], v1, s[28:31], s71 offen offset:512 nt
    v_fmac_f32_dpp v152, v170, v104 row_newbcast:15 row_mask:0xf bank_mask:0xf
    v_fmac_f32_dpp v153, v170, v105 row_newbcast:15 row_mask:0xf bank_mask:0xf
    v_fmac_f32_dpp v154, v170, v106 row_newbcast:15 row_mask:0xf bank_mask:0xf
    v_fmac_f32_dpp v155, v170, v107 row_newbcast:15 row_mask:0xf bank_mask:0xf
    s_waitcnt vmcnt(25)
    v_cvt_f32_i32 v100, v92
    v_cvt_f32_i32 v101, v93
    v_cvt_f32_i32 v102, v94
    v_cvt_f32_i32 v103, v95
    s_add_u32 s71, s71, 3072
    buffer_load_dwordx4 v[88:91], v1, s[28:31], s71 offen offset:0 nt
    v_fmac_f32_dpp v156, v170, v100 row_newbcast:15 row_mask:0xf bank_mask:0xf
    v_fmac_f32_dpp v157, v170, v101 row_newbcast:15 row_mask:0xf bank_mask:0xf
    v_fmac_f32_dpp v158, v170, v102 row_newbcast:15 row_mask:0xf bank_mask:0xf
    v_fmac_f32_dpp v159, v170, v103 row_newbcast:15 row_mask:0xf bank_mask:0xf
    s_waitcnt vmcnt(25)
    v_cvt_f32_i32 v104, v96
    v_cvt_f32_i32 v105, v97
    v_cvt_f32_i32 v106, v98
    v_cvt_f32_i32 v107, v99
    buffer_load_dwordx4 v[92:95], v1, s[28:31], s71 offen offset:256 nt
    v_fmac_f32_dpp v160, v170, v104 row_newbcast:15 row_mask:0xf bank_mask:0xf
    v_fmac_f32_dpp v161, v170, v105 row_newbcast:15 row_mask:0xf bank_mask:0xf
    v_fmac_f32_dpp v162, v170, v106 row_newbcast:15 row_mask:0xf bank_mask:0xf
    v_fmac_f32_dpp v163, v170, v107 row_newbcast:15 row_mask:0xf bank_mask:0xf
    s_sub_u32 s77, s77, 1
    s_cmp_lg_u32 s77, 0
    s_cbranch_scc1 L_nofl3
    s_nop 0
    v_add_f32_dpp v166, v166, v166 row_ror:8 row_mask:0xf bank_mask:0xf
    v_add_f32_dpp v167, v167, v167 row_ror:8 row_mask:0xf bank_mask:0xf
    s_nop 0
    v_add_f32_dpp v166, v166, v166 row_ror:4 row_mask:0xf bank_mask:0xf
    v_add_f32_dpp v167, v167, v167 row_ror:4 row_mask:0xf bank_mask:0xf
    s_nop 0
    v_add_f32_dpp v166, v166, v166 row_ror:2 row_mask:0xf bank_mask:0xf
    v_add_f32_dpp v167, v167, v167 row_ror:2 row_mask:0xf bank_mask:0xf
    s_nop 0
    v_add_f32_dpp v166, v166, v166 row_ror:1 row_mask:0xf bank_mask:0xf
    v_add_f32_dpp v167, v167, v167 row_ror:1 row_mask:0xf bank_mask:0xf
    v_mov_b32 v182, v165
    v_mov_b32 v183, v165
    s_nop 1
    v_permlane32_swap_b32 v182, v183
    s_nop 1
    v_max_f32 v182, v182, v183
    v_mov_b32 v183, v182
    s_nop 1
    v_permlane16_swap_b32 v182, v183
    s_nop 1
    v_max_f32 v182, v182, v183
    v_sub_f32 v183, v165, v182
    v_exp_f32 v183, v183
    v_mov_b32 v104, v182
    v_mul_f32 v166, v166, v183
    v_mul_f32 v167, v167, v183
    v_fma_f32 v152, v152, v183, -v167
    v_fma_f32 v153, v153, v183, -v167
    v_fma_f32 v154, v154, v183, -v167
    v_fma_f32 v155, v155, v183, -v167
    v_fma_f32 v156, v156, v183, -v167
    v_fma_f32 v157, v157, v183, -v167
    v_fma_f32 v158, v158, v183, -v167
    v_fma_f32 v159, v159, v183, -v167
    v_fma_f32 v160, v160, v183, -v167
    v_fma_f32 v161, v161, v183, -v167
    v_fma_f32 v162, v162, v183, -v167
    v_fma_f32 v163, v163, v183, -v167
    v_mov_b32 v182, v166
    s_nop 1
    v_permlane32_swap_b32 v166, v182
    v_permlane32_swap_b32 v152, v154
    v_permlane32_swap_b32 v153, v155
    v_permlane32_swap_b32 v156, v158
    v_permlane32_swap_b32 v157, v159
    v_permlane32_swap_b32 v160, v162
    v_permlane32_swap_b32 v161, v163
    s_nop 1
    v_add_f32 v166, v166, v182
    v_add_f32 v152, v152, v154
    v_add_f32 v153, v153, v155
    v_add_f32 v156, v156, v158
    v_add_f32 v157, v157, v159
    v_add_f32 v160, v160, v162
    v_add_f32 v161, v161, v163
    v_mov_b32 v182, v166
    s_nop 1
    v_permlane16_swap_b32 v166, v182
    v_permlane16_swap_b32 v152, v153
    v_permlane16_swap_b32 v156, v157
    v_permlane16_swap_b32 v160, v161
    s_nop 1
    v_add_f32 v105, v166, v182
    v_add_f32 v100, v152, v153
    v_add_f32 v101, v156, v157
    v_add_f32 v102, v160, v161
    v_cndmask_b32 v103, v104, v105, s[66:67]
    ds_write_b128 v186, v[100:103] offset:3328
    v_mov_b32 v165, 0xf149f2ca
    v_mov_b32 v166, 0
    v_mov_b32 v167, 0
    v_mov_b32 v152, 0
    v_mov_b32 v153, 0
    v_mov_b32 v154, 0
    v_mov_b32 v155, 0
    v_mov_b32 v156, 0
    v_mov_b32 v157, 0
    v_mov_b32 v158, 0
    v_mov_b32 v159, 0
    v_mov_b32 v160, 0
    v_mov_b32 v161, 0
    v_mov_b32 v162, 0
    v_mov_b32 v163, 0
    s_waitcnt lgkmcnt(0)
    s_mov_b64 exec, 1
    ds_add_u32 v187, v188
    s_mov_b64 exec, -1
    v_add_u32 v186, 1024, v186
    v_add_u32 v187, 4, v187
    s_mov_b32 s77, 8
L_nofl3:
L_dloop:
    s_waitcnt vmcnt(23)
    v_lshlrev_b32 v168, 16, v168
    v_lshlrev_b32 v169, 16, v169
    v_max_f32_dpp v182, v171, v171 row_ror:8 row_mask:0xf bank_mask:0xf
    s_nop 1
    v_max_f32_dpp v182, v182, v182 row_ror:4 row_mask:0xf bank_mask:0xf
    s_nop 1
    v_max_f32_dpp v182, v182, v182 row_ror:2 row_mask:0xf bank_mask:0xf
    s_nop 1
    v_max_f32_dpp v182, v182, v182 row_ror:1 row_mask:0xf bank_mask:0xf
    v_max_f32 v182, v182, v165
    v_sub_f32 v183, v165, v182
    v_sub_f32 v170, v171, v182
    v_exp_f32 v183, v183
    v_exp_f32 v170, v170
    v_mov_b32 v165, v182
    v_fma_f32 v166, v166, v183, v170
    v_mul_f32 v170, v170, v168
    v_mul_f32 v167, v167, v183
    v_fmac_f32 v167, v170, v169
    v_mul_f32 v152, v152, v183
    v_mul_f32 v153, v153, v183
    v_mul_f32 v154, v154, v183
    v_mul_f32 v155, v155, v183
    v_mul_f32 v156, v156, v183
    v_mul_f32 v157, v157, v183
    v_mul_f32 v158, v158, v183
    v_mul_f32 v159, v159, v183
    v_mul_f32 v160, v160, v183
    v_mul_f32 v161, v161, v183
    v_mul_f32 v162, v162, v183
    v_mul_f32 v163, v163, v183
    s_waitcnt vmcnt(22)
    v_cvt_f32_i32 v100, v4
    v_cvt_f32_i32 v101, v5
    v_cvt_f32_i32 v102, v6
    v_cvt_f32_i32 v103, v7
    buffer_load_dwordx4 v[96:99], v1, s[28:31], s71 offen offset:512 nt
    v_fmac_f32_dpp v152, v170, v100 row_newbcast:0 row_mask:0xf bank_mask:0xf
    v_fmac_f32_dpp v153, v170, v101 row_newbcast:0 row_mask:0xf bank_mask:0xf
    v_fmac_f32_dpp v154, v170, v102 row_newbcast:0 row_mask:0xf bank_mask:0xf
    v_fmac_f32_dpp v155, v170, v103 row_newbcast:0 row_mask:0xf bank_mask:0xf
    s_waitcnt vmcnt(22)
    v_cvt_f32_i32 v104, v8
    v_cvt_f32_i32 v105, v9
    v_cvt_f32_i32 v106, v10
    v_cvt_f32_i32 v107, v11
    s_add_u32 s71, s71, 3072
    buffer_load_dwordx4 v[4:7], v1, s[28:31], s71 offen offset:0 nt
    v_fmac_f32_dpp v156, v170, v104 row_newbcast:0 row_mask:0xf bank_mask:0xf
    v_fmac_f32_dpp v157, v170, v105 row_newbcast:0 row_mask:0xf bank_mask:0xf
    v_fmac_f32_dpp v158, v170, v106 row_newbcast:0 row_mask:0xf bank_mask:0xf
    v_fmac_f32_dpp v159, v170, v107 row_newbcast:0 row_mask:0xf bank_mask:0xf
    s_waitcnt vmcnt(22)
    v_cvt_f32_i32 v100, v12
    v_cvt_f32_i32 v101, v13
    v_cvt_f32_i32 v102, v14
    v_cvt_f32_i32 v103, v15
    buffer_load_dwordx4 v[8:11], v1, s[28:31], s71 offen offset:256 nt
    v_fmac_f32_dpp v160, v170, v100 row_newbcast:0 row_mask:0xf bank_mask:0xf
    v_fmac_f32_dpp v161, v170, v101 row_newbcast:0 row_mask:0xf bank_mask:0xf
    v_fmac_f32_dpp v162, v170, v102 row_newbcast:0 row_mask:0xf bank_mask:0xf
    v_fmac_f32_dpp v163, v170, v103 row_newbcast:0 row_mask:0xf bank_mask:0xf
    s_waitcnt vmcnt(22)
    v_cvt_f32_i32 v104, v16
    v_cvt_f32_i32 v105, v17
    v_cvt_f32_i32 v106, v18
    v_cvt_f32_i32 v107, v19
    buffer_load_dwordx4 v[12:15], v1, s[28:31], s71 offen offset:512 nt
    v_fmac_f32_dpp v152, v170, v104 row_newbcast:8 row_mask:0xf bank_mask:0xf
    v_fmac_f32_dpp v153, v170, v105 row_newbcast:8 row_mask:0xf bank_mask:0xf
    v_fmac_f32_dpp v154, v170, v106 row_newbcast:8 row_mask:0xf bank_mask:0xf
    v_fmac_f32_dpp v155, v170, v107 row_newbcast:8 row_mask:0xf bank_mask:0xf
    s_mov_b64 exec, 1
    ds_max_u32 v188, v173 offset:131
    s_mov_b64 exec, -1
    v_add_u32 v173, 1, v173
    s_waitcnt vmcnt(22)
    v_cvt_f32_i32 v100, v20
    v_cvt_f32_i32 v101, v21
    v_cvt_f32_i32 v102, v22
    v_cvt_f32_i32 v103, v23
    s_add_u32 s71, s71, 3072
    buffer_load_dwordx4 v[16:19], v1, s[28:31], s71 offen offset:0 nt
    v_fmac_f32_dpp v156, v170, v100 row_newbcast:8 row_mask:0xf bank_mask:0xf
    v_fmac_f32_dpp v157, v170, v101 row_newbcast:8 row_mask:0xf bank_mask:0xf
    v_fmac_f32_dpp v158, v170, v102 row_newbcast:8 row_mask:0xf bank_mask:0xf
    v_fmac_f32_dpp v159, v170, v103 row_newbcast:8 row_mask:0xf bank_mask:0xf
    s_waitcnt vmcnt(22)
    v_cvt_f32_i32 v104, v24
    v_cvt_f32_i32 v105, v25
    v_cvt_f32_i32 v106, v26
    v_cvt_f32_i32 v107, v27
    buffer_load_dwordx4 v[20:23], v1, s[28:31], s71 offen offset:256 nt
    v_fmac_f32_dpp v160, v170, v104 row_newbcast:8 row_mask:0xf bank_mask:0xf
    v_fmac_f32_dpp v161, v170, v105 row_newbcast:8 row_mask:0xf bank_mask:0xf
    v_fmac_f32_dpp v162, v170, v106 row_newbcast:8 row_mask:0xf bank_mask:0xf
    v_fmac_f32_dpp v163, v170, v107 row_newbcast:8 row_mask:0xf bank_mask:0xf
    s_waitcnt vmcnt(22)
    v_cvt_f32_i32 v100, v28
    v_cvt_f32_i32 v101, v29
    v_cvt_f32_i32 v102, v30
    v_cvt_f32_i32 v103, v31
    buffer_load_dwordx4 v[24:27], v1, s[28:31], s71 offen offset:512 nt
    v_fmac_f32_dpp v152, v170, v100 row_newbcast:4 row_mask:0xf bank_mask:0xf
    v_fmac_f32_dpp v153, v170, v101 row_newbcast:4 row_mask:0xf bank_mask:0xf
    v_fmac_f32_dpp v154, v170, v102 row_newbcast:4 row_mask:0xf bank_mask:0xf
    v_fmac_f32_dpp v155, v170, v103 row_newbcast:4 row_mask:0xf bank_mask:0xf
    s_waitcnt vmcnt(22)
    v_cvt_f32_i32 v104, v32
    v_cvt_f32_i32 v105, v33
    v_cvt_f32_i32 v106, v34
    v_cvt_f32_i32 v107, v35
    s_add_u32 s71, s71, 3072
    buffer_load_dwordx4 v[28:31], v1, s[28:31], s71 offen offset:0 nt
    v_fmac_f32_dpp v156, v170, v104 row_newbcast:4 row_mask:0xf bank_mask:0xf
    v_fmac_f32_dpp v157, v170, v105 row_newbcast:4 row_mask:0xf bank_mask:0xf
    v_fmac_f32_dpp v158, v170, v106 row_newbcast:4 row_mask:0xf bank_mask:0xf
    v_fmac_f32_dpp v159, v170, v107 row_newbcast:4 row_mask:0xf bank_mask:0xf
    s_waitcnt vmcnt(22)
    v_cvt_f32_i32 v100, v36
    v_cvt_f32_i32 v101, v37
    v_cvt_f32_i32 v102, v38
    v_cvt_f32_i32 v103, v39
    buffer_load_dwordx4 v[32:35], v1, s[28:31], s71 offen offset:256 nt
    v_fmac_f32_dpp v160, v170, v100 row_newbcast:4 row_mask:0xf bank_mask:0xf
    v_fmac_f32_dpp v161, v170, v101 row_newbcast:4 row_mask:0xf bank_mask:0xf
    v_fmac_f32_dpp v162, v170, v102 row_newbcast:4 row_mask:0xf bank_mask:0xf
    v_fmac_f32_dpp v163, v170, v103 row_newbcast:4 row_mask:0xf bank_mask:0xf
    s_waitcnt vmcnt(22)
    v_cvt_f32_i32 v104, v40
    v_cvt_f32_i32 v105, v41
    v_cvt_f32_i32 v106, v42
    v_cvt_f32_i32 v107, v43
    buffer_load_dwordx4 v[36:39], v1, s[28:31], s71 offen offset:512 nt
    v_fmac_f32_dpp v152, v170, v104 row_newbcast:12 row_mask:0xf bank_mask:0xf
    v_fmac_f32_dpp v153, v170, v105 row_newbcast:12 row_mask:0xf bank_mask:0xf
    v_fmac_f32_dpp v154, v170, v106 row_newbcast:12 row_mask:0xf bank_mask:0xf
    v_fmac_f32_dpp v155, v170, v107 row_newbcast:12 row_mask:0xf bank_mask:0xf
    s_waitcnt vmcnt(22)
    v_cvt_f32_i32 v100, v44
    v_cvt_f32_i32 v101, v45
    v_cvt_f32_i32 v102, v46
    v_cvt_f32_i32 v103, v47
    s_add_u32 s71, s71, 3072
    buffer_load_dwordx4 v[40:43], v1, s[28:31], s71 offen offset:0 nt
    v_fmac_f32_dpp v156, v170, v100 row_newbcast:12 row_mask:0xf bank_mask:0xf
    v_fmac_f32_dpp v157, v170, v101 row_newbcast:12 row_mask:0xf bank_mask:0xf
    v_fmac_f32_dpp v158, v170, v102 row_newbcast:12 row_mask:0xf bank_mask:0xf
    v_fmac_f32_dpp v159, v170, v103 row_newbcast:12 row_mask:0xf bank_mask:0xf
    s_waitcnt vmcnt(22)
    v_cvt_f32_i32 v104, v48
    v_cvt_f32_i32 v105, v49
    v_cvt_f32_i32 v106, v50
    v_cvt_f32_i32 v107, v51
    buffer_load_dwordx4 v[44:47], v1, s[28:31], s71 offen offset:256 nt
    v_fmac_f32_dpp v160, v170, v104 row_newbcast:12 row_mask:0xf bank_mask:0xf
    v_fmac_f32_dpp v161, v170, v105 row_newbcast:12 row_mask:0xf bank_mask:0xf
    v_fmac_f32_dpp v162, v170, v106 row_newbcast:12 row_mask:0xf bank_mask:0xf
    v_fmac_f32_dpp v163, v170, v107 row_newbcast:12 row_mask:0xf bank_mask:0xf
    s_waitcnt vmcnt(22)
    v_cvt_f32_i32 v100, v52
    v_cvt_f32_i32 v101, v53
    v_cvt_f32_i32 v102, v54
    v_cvt_f32_i32 v103, v55
    buffer_load_dwordx4 v[48:51], v1, s[28:31], s71 offen offset:512 nt
    v_fmac_f32_dpp v152, v170, v100 row_newbcast:2 row_mask:0xf bank_mask:0xf
    v_fmac_f32_dpp v153, v170, v101 row_newbcast:2 row_mask:0xf bank_mask:0xf
    v_fmac_f32_dpp v154, v170, v102 row_newbcast:2 row_mask:0xf bank_mask:0xf
    v_fmac_f32_dpp v155, v170, v103 row_newbcast:2 row_mask:0xf bank_mask:0xf
    s_waitcnt vmcnt(22)
    v_cvt_f32_i32 v104, v56
    v_cvt_f32_i32 v105, v57
    v_cvt_f32_i32 v106, v58
    v_cvt_f32_i32 v107, v59
    s_add_u32 s71, s71, 3072
    buffer_load_dwordx4 v[52:55], v1, s[28:31], s71 offen offset:0 nt
    v_fmac_f32_dpp v156, v170, v104 row_newbcast:2 row_mask:0xf bank_mask:0xf
    v_fmac_f32_dpp v157, v170, v105 row_newbcast:2 row_mask:0xf bank_mask:0xf
    v_fmac_f32_dpp v158, v170, v106 row_newbcast:2 row_mask:0xf bank_mask:0xf
    v_fmac_f32_dpp v159, v170, v107 row_newbcast:2 row_mask:0xf bank_mask:0xf
    s_waitcnt vmcnt(22)
    v_cvt_f32_i32 v100, v60
    v_cvt_f32_i32 v101, v61
    v_cvt_f32_i32 v102, v62
    v_cvt_f32_i32 v103, v63
    buffer_load_dwordx4 v[56:59], v1, s[28:31], s71 offen offset:256 nt
    v_fmac_f32_dpp v160, v170, v100 row_newbcast:2 row_mask:0xf bank_mask:0xf
    v_fmac_f32_dpp v161, v170, v101 row_newbcast:2 row_mask:0xf bank_mask:0xf
    v_fmac_f32_dpp v162, v170, v102 row_newbcast:2 row_mask:0xf bank_mask:0xf
    v_fmac_f32_dpp v163, v170, v103 row_newbcast:2 row_mask:0xf bank_mask:0xf
    s_waitcnt vmcnt(22)
    v_cvt_f32_i32 v104, v64
    v_cvt_f32_i32 v105, v65
    v_cvt_f32_i32 v106, v66
    v_cvt_f32_i32 v107, v67
    buffer_load_dwordx4 v[60:63], v1, s[28:31], s71 offen offset:512 nt
    v_fmac_f32_dpp v152, v170, v104 row_newbcast:10 row_mask:0xf bank_mask:0xf
    v_fmac_f32_dpp v153, v170, v105 row_newbcast:10 row_mask:0xf bank_mask:0xf
    v_fmac_f32_dpp v154, v170, v106 row_newbcast:10 row_mask:0xf bank_mask:0xf
    v_fmac_f32_dpp v155, v170, v107 row_newbcast:10 row_mask:0xf bank_mask:0xf
    s_waitcnt vmcnt(22)
    v_cvt_f32_i32 v100, v68
    v_cvt_f32_i32 v101, v69
    v_cvt_f32_i32 v102, v70
    v_cvt_f32_i32 v103, v71
    s_add_u32 s71, s71, 3072
    buffer_load_dwordx4 v[64:67], v1, s[28:31], s71 offen offset:0 nt
    v_fmac_f32_dpp v156, v170, v100 row_newbcast:10 row_mask:0xf bank_mask:0xf
    v_fmac_f32_dpp v157, v170, v101 row_newbcast:10 row_mask:0xf bank_mask:0xf
    v_fmac_f32_dpp v158, v170, v102 row_newbcast:10 row_mask:0xf bank_mask:0xf
    v_fmac_f32_dpp v159, v170, v103 row_newbcast:10 row_mask:0xf bank_mask:0xf
    s_waitcnt vmcnt(22)
    v_cvt_f32_i32 v104, v72
    v_cvt_f32_i32 v105, v73
    v_cvt_f32_i32 v106, v74
    v_cvt_f32_i32 v107, v75
    buffer_load_dwordx4 v[68:71], v1, s[28:31], s71 offen offset:256 nt
    v_fmac_f32_dpp v160, v170, v104 row_newbcast:10 row_mask:0xf bank_mask:0xf
    v_fmac_f32_dpp v161, v170, v105 row_newbcast:10 row_mask:0xf bank_mask:0xf
    v_fmac_f32_dpp v162, v170, v106 row_newbcast:10 row_mask:0xf bank_mask:0xf
    v_fmac_f32_dpp v163, v170, v107 row_newbcast:10 row_mask:0xf bank_mask:0xf
    s_waitcnt vmcnt(22)
    v_cvt_f32_i32 v100, v76
    v_cvt_f32_i32 v101, v77
    v_cvt_f32_i32 v102, v78
    v_cvt_f32_i32 v103, v79
    buffer_load_dwordx4 v[72:75], v1, s[28:31], s71 offen offset:512 nt
    v_fmac_f32_dpp v152, v170, v100 row_newbcast:6 row_mask:0xf bank_mask:0xf
    v_fmac_f32_dpp v153, v170, v101 row_newbcast:6 row_mask:0xf bank_mask:0xf
    v_fmac_f32_dpp v154, v170, v102 row_newbcast:6 row_mask:0xf bank_mask:0xf
    v_fmac_f32_dpp v155, v170, v103 row_newbcast:6 row_mask:0xf bank_mask:0xf
    s_waitcnt vmcnt(22)
    v_cvt_f32_i32 v104, v80
    v_cvt_f32_i32 v105, v81
    v_cvt_f32_i32 v106, v82
    v_cvt_f32_i32 v107, v83
    s_add_u32 s71, s71, 3072
    buffer_load_dwordx4 v[76:79], v1, s[28:31], s71 offen offset:0 nt
    v_fmac_f32_dpp v156, v170, v104 row_newbcast:6 row_mask:0xf bank_mask:0xf
    v_fmac_f32_dpp v157, v170, v105 row_newbcast:6 row_mask:0xf bank_mask:0xf
    v_fmac_f32_dpp v158, v170, v106 row_newbcast:6 row_mask:0xf bank_mask:0xf
    v_fmac_f32_dpp v159, v170, v107 row_newbcast:6 row_mask:0xf bank_mask:0xf
    s_waitcnt vmcnt(22)
    v_cvt_f32_i32 v100, v84
    v_cvt_f32_i32 v101, v85
    v_cvt_f32_i32 v102, v86
    v_cvt_f32_i32 v103, v87
    buffer_load_dwordx4 v[80:83], v1, s[28:31], s71 offen offset:256 nt
    v_fmac_f32_dpp v160, v170, v100 row_newbcast:6 row_mask:0xf bank_mask:0xf
    v_fmac_f32_dpp v161, v170, v101 row_newbcast:6 row_mask:0xf bank_mask:0xf
    v_fmac_f32_dpp v162, v170, v102 row_newbcast:6 row_mask:0xf bank_mask:0xf
    v_fmac_f32_dpp v163, v170, v103 row_newbcast:6 row_mask:0xf bank_mask:0xf
    s_waitcnt vmcnt(22)
    v_cvt_f32_i32 v104, v88
    v_cvt_f32_i32 v105, v89
    v_cvt_f32_i32 v106, v90
    v_cvt_f32_i32 v107, v91
    buffer_load_dwordx4 v[84:87], v1, s[28:31], s71 offen offset:512 nt
    v_fmac_f32_dpp v152, v170, v104 row_newbcast:14 row_mask:0xf bank_mask:0xf
    v_fmac_f32_dpp v153, v170, v105 row_newbcast:14 row_mask:0xf bank_mask:0xf
    v_fmac_f32_dpp v154, v170, v106 row_newbcast:14 row_mask:0xf bank_mask:0xf
    v_fmac_f32_dpp v155, v170, v107 row_newbcast:14 row_mask:0xf bank_mask:0xf
    s_waitcnt vmcnt(22)
    v_cvt_f32_i32 v100, v92
    v_cvt_f32_i32 v101, v93
    v_cvt_f32_i32 v102, v94
    v_cvt_f32_i32 v103, v95
    s_add_u32 s71, s71, 3072
    buffer_load_dwordx4 v[88:91], v1, s[28:31], s71 offen offset:0 nt
    v_fmac_f32_dpp v156, v170, v100 row_newbcast:14 row_mask:0xf bank_mask:0xf
    v_fmac_f32_dpp v157, v170, v101 row_newbcast:14 row_mask:0xf bank_mask:0xf
    v_fmac_f32_dpp v158, v170, v102 row_newbcast:14 row_mask:0xf bank_mask:0xf
    v_fmac_f32_dpp v159, v170, v103 row_newbcast:14 row_mask:0xf bank_mask:0xf
    ds_read_b32 v175, v174
    s_waitcnt vmcnt(22)
    v_cvt_f32_i32 v104, v96
    v_cvt_f32_i32 v105, v97
    v_cvt_f32_i32 v106, v98
    v_cvt_f32_i32 v107, v99
    buffer_load_dwordx4 v[92:95], v1, s[28:31], s71 offen offset:256 nt
    v_fmac_f32_dpp v160, v170, v104 row_newbcast:14 row_mask:0xf bank_mask:0xf
    v_fmac_f32_dpp v161, v170, v105 row_newbcast:14 row_mask:0xf bank_mask:0xf
    v_fmac_f32_dpp v162, v170, v106 row_newbcast:14 row_mask:0xf bank_mask:0xf
    v_fmac_f32_dpp v163, v170, v107 row_newbcast:14 row_mask:0xf bank_mask:0xf
    s_waitcnt vmcnt(22)
    v_cvt_f32_i32 v100, v4
    v_cvt_f32_i32 v101, v5
    v_cvt_f32_i32 v102, v6
    v_cvt_f32_i32 v103, v7
    buffer_load_dwordx4 v[96:99], v1, s[28:31], s71 offen offset:512 nt
    v_fmac_f32_dpp v152, v170, v100 row_newbcast:1 row_mask:0xf bank_mask:0xf
    v_fmac_f32_dpp v153, v170, v101 row_newbcast:1 row_mask:0xf bank_mask:0xf
    v_fmac_f32_dpp v154, v170, v102 row_newbcast:1 row_mask:0xf bank_mask:0xf
    v_fmac_f32_dpp v155, v170, v103 row_newbcast:1 row_mask:0xf bank_mask:0xf
    s_waitcnt lgkmcnt(0)
    v_readfirstlane_b32 s80, v175
    s_cmp_lg_u32 s80, -1
    s_cbranch_scc1 L_tkok
L_tkw:
    ds_read_b32 v175, v174
    s_waitcnt lgkmcnt(0)
    v_readfirstlane_b32 s80, v175
    s_cmp_eq_u32 s80, -1
    s_cbranch_scc1 L_tkw
L_tkok:
    v_add_u32 v174, 4, v174
    s_cmp_ge_u32 s80, 384
    s_cbranch_scc1 L_dtail
    s_lshr_b32 s81, s80, 6
    s_and_b32 s80, s80, 63
    s_mul_i32 s56, s81, 64
    s_add_u32 s56, s56, s80
    s_add_u32 s56, s56, s94
    s_and_b32 s56, s56, 511
    s_mov_b32 s57, s59
    s_add_u32 s70, s57, s56
    s_and_b32 s95, s2, 192
    s_add_u32 s95, s95, s80
    s_lshl_b32 s95, s95, 3
    s_add_u32 s95, s95, s81
    s_lshl_b32 s95, s95, 8
    s_add_u32 s95, s95, 18874368
    s_waitcnt vmcnt(22)
    v_cvt_f32_i32 v104, v8
    v_cvt_f32_i32 v105, v9
    v_cvt_f32_i32 v106, v10
    v_cvt_f32_i32 v107, v11
    s_lshl_b32 s73, s70, 7
    buffer_load_dword v171, v172, s[52:55], s95 offen sc0 sc1
    buffer_load_ushort v168, v3, s[40:43], s73 offen
    buffer_load_ushort v169, v3, s[44:47], s73 offen
    s_mul_i32 s71, s70, 49152
    buffer_load_dwordx4 v[4:7], v1, s[28:31], s71 offen offset:0 nt
    v_fmac_f32_dpp v156, v170, v104 row_newbcast:1 row_mask:0xf bank_mask:0xf
    v_fmac_f32_dpp v157, v170, v105 row_newbcast:1 row_mask:0xf bank_mask:0xf
    v_fmac_f32_dpp v158, v170, v106 row_newbcast:1 row_mask:0xf bank_mask:0xf
    v_fmac_f32_dpp v159, v170, v107 row_newbcast:1 row_mask:0xf bank_mask:0xf
    s_waitcnt vmcnt(25)
    v_cvt_f32_i32 v100, v12
    v_cvt_f32_i32 v101, v13
    v_cvt_f32_i32 v102, v14
    v_cvt_f32_i32 v103, v15
    buffer_load_dwordx4 v[8:11], v1, s[28:31], s71 offen offset:256 nt
    v_fmac_f32_dpp v160, v170, v100 row_newbcast:1 row_mask:0xf bank_mask:0xf
    v_fmac_f32_dpp v161, v170, v101 row_newbcast:1 row_mask:0xf bank_mask:0xf
    v_fmac_f32_dpp v162, v170, v102 row_newbcast:1 row_mask:0xf bank_mask:0xf
    v_fmac_f32_dpp v163, v170, v103 row_newbcast:1 row_mask:0xf bank_mask:0xf
    s_waitcnt vmcnt(25)
    v_cvt_f32_i32 v104, v16
    v_cvt_f32_i32 v105, v17
    v_cvt_f32_i32 v106, v18
    v_cvt_f32_i32 v107, v19
    buffer_load_dwordx4 v[12:15], v1, s[28:31], s71 offen offset:512 nt
    v_fmac_f32_dpp v152, v170, v104 row_newbcast:9 row_mask:0xf bank_mask:0xf
    v_fmac_f32_dpp v153, v170, v105 row_newbcast:9 row_mask:0xf bank_mask:0xf
    v_fmac_f32_dpp v154, v170, v106 row_newbcast:9 row_mask:0xf bank_mask:0xf
    v_fmac_f32_dpp v155, v170, v107 row_newbcast:9 row_mask:0xf bank_mask:0xf
    s_waitcnt vmcnt(25)
    v_cvt_f32_i32 v100, v20
    v_cvt_f32_i32 v101, v21
    v_cvt_f32_i32 v102, v22
    v_cvt_f32_i32 v103, v23
    s_add_u32 s71, s71, 3072
    buffer_load_dwordx4 v[16:19], v1, s[28:31], s71 offen offset:0 nt
    v_fmac_f32_dpp v156, v170, v100 row_newbcast:9 row_mask:0xf bank_mask:0xf
    v_fmac_f32_dpp v157, v170, v101 row_newbcast:9 row_mask:0xf bank_mask:0xf
    v_fmac_f32_dpp v158, v170, v102 row_newbcast:9 row_mask:0xf bank_mask:0xf
    v_fmac_f32_dpp v159, v170, v103 row_newbcast:9 row_mask:0xf bank_mask:0xf
    s_waitcnt vmcnt(25)
    v_cvt_f32_i32 v104, v24
    v_cvt_f32_i32 v105, v25
    v_cvt_f32_i32 v106, v26
    v_cvt_f32_i32 v107, v27
    buffer_load_dwordx4 v[20:23], v1, s[28:31], s71 offen offset:256 nt
    v_fmac_f32_dpp v160, v170, v104 row_newbcast:9 row_mask:0xf bank_mask:0xf
    v_fmac_f32_dpp v161, v170, v105 row_newbcast:9 row_mask:0xf bank_mask:0xf
    v_fmac_f32_dpp v162, v170, v106 row_newbcast:9 row_mask:0xf bank_mask:0xf
    v_fmac_f32_dpp v163, v170, v107 row_newbcast:9 row_mask:0xf bank_mask:0xf
    s_waitcnt vmcnt(25)
    v_cvt_f32_i32 v100, v28
    v_cvt_f32_i32 v101, v29
    v_cvt_f32_i32 v102, v30
    v_cvt_f32_i32 v103, v31
    buffer_load_dwordx4 v[24:27], v1, s[28:31], s71 offen offset:512 nt
    v_fmac_f32_dpp v152, v170, v100 row_newbcast:5 row_mask:0xf bank_mask:0xf
    v_fmac_f32_dpp v153, v170, v101 row_newbcast:5 row_mask:0xf bank_mask:0xf
    v_fmac_f32_dpp v154, v170, v102 row_newbcast:5 row_mask:0xf bank_mask:0xf
    v_fmac_f32_dpp v155, v170, v103 row_newbcast:5 row_mask:0xf bank_mask:0xf
    s_waitcnt vmcnt(25)
    v_cvt_f32_i32 v104, v32
    v_cvt_f32_i32 v105, v33
    v_cvt_f32_i32 v106, v34
    v_cvt_f32_i32 v107, v35
    s_add_u32 s71, s71, 3072
    buffer_load_dwordx4 v[28:31], v1, s[28:31], s71 offen offset:0 nt
    v_fmac_f32_dpp v156, v170, v104 row_newbcast:5 row_mask:0xf bank_mask:0xf
    v_fmac_f32_dpp v157, v170, v105 row_newbcast:5 row_mask:0xf bank_mask:0xf
    v_fmac_f32_dpp v158, v170, v106 row_newbcast:5 row_mask:0xf bank_mask:0xf
    v_fmac_f32_dpp v159, v170, v107 row_newbcast:5 row_mask:0xf bank_mask:0xf
    s_waitcnt vmcnt(25)
    v_cvt_f32_i32 v100, v36
    v_cvt_f32_i32 v101, v37
    v_cvt_f32_i32 v102, v38
    v_cvt_f32_i32 v103, v39
    buffer_load_dwordx4 v[32:35], v1, s[28:31], s71 offen offset:256 nt
    v_fmac_f32_dpp v160, v170, v100 row_newbcast:5 row_mask:0xf bank_mask:0xf
    v_fmac_f32_dpp v161, v170, v101 row_newbcast:5 row_mask:0xf bank_mask:0xf
    v_fmac_f32_dpp v162, v170, v102 row_newbcast:5 row_mask:0xf bank_mask:0xf
    v_fmac_f32_dpp v163, v170, v103 row_newbcast:5 row_mask:0xf bank_mask:0xf
    s_waitcnt vmcnt(25)
    v_cvt_f32_i32 v104, v40
    v_cvt_f32_i32 v105, v41
    v_cvt_f32_i32 v106, v42
    v_cvt_f32_i32 v107, v43
    buffer_load_dwordx4 v[36:39], v1, s[28:31], s71 offen offset:512 nt
    v_fmac_f32_dpp v152, v170, v104 row_newbcast:13 row_mask:0xf bank_mask:0xf
    v_fmac_f32_dpp v153, v170, v105 row_newbcast:13 row_mask:0xf bank_mask:0xf
    v_fmac_f32_dpp v154, v170, v106 row_newbcast:13 row_mask:0xf bank_mask:0xf
    v_fmac_f32_dpp v155, v170, v107 row_newbcast:13 row_mask:0xf bank_mask:0xf
    s_waitcnt vmcnt(25)
    v_cvt_f32_i32 v100, v44
    v_cvt_f32_i32 v101, v45
    v_cvt_f32_i32 v102, v46
    v_cvt_f32_i32 v103, v47
    s_add_u32 s71, s71, 3072
    buffer_load_dwordx4 v[40:43], v1, s[28:31], s71 offen offset:0 nt
    v_fmac_f32_dpp v156, v170, v100 row_newbcast:13 row_mask:0xf bank_mask:0xf
    v_fmac_f32_dpp v157, v170, v101 row_newbcast:13 row_mask:0xf bank_mask:0xf
    v_fmac_f32_dpp v158, v170, v102 row_newbcast:13 row_mask:0xf bank_mask:0xf
    v_fmac_f32_dpp v159, v170, v103 row_newbcast:13 row_mask:0xf bank_mask:0xf
    s_waitcnt vmcnt(25)
    v_cvt_f32_i32 v104, v48
    v_cvt_f32_i32 v105, v49
    v_cvt_f32_i32 v106, v50
    v_cvt_f32_i32 v107, v51
    buffer_load_dwordx4 v[44:47], v1, s[28:31], s71 offen offset:256 nt
    v_fmac_f32_dpp v160, v170, v104 row_newbcast:13 row_mask:0xf bank_mask:0xf
    v_fmac_f32_dpp v161, v170, v105 row_newbcast:13 row_mask:0xf bank_mask:0xf
    v_fmac_f32_dpp v162, v170, v106 row_newbcast:13 row_mask:0xf bank_mask:0xf
    v_fmac_f32_dpp v163, v170, v107 row_newbcast:13 row_mask:0xf bank_mask:0xf
    s_waitcnt vmcnt(25)
    v_cvt_f32_i32 v100, v52
    v_cvt_f32_i32 v101, v53
    v_cvt_f32_i32 v102, v54
    v_cvt_f32_i32 v103, v55
    buffer_load_dwordx4 v[48:51], v1, s[28:31], s71 offen offset:512 nt
    v_fmac_f32_dpp v152, v170, v100 row_newbcast:3 row_mask:0xf bank_mask:0xf
    v_fmac_f32_dpp v153, v170, v101 row_newbcast:3 row_mask:0xf bank_mask:0xf
    v_fmac_f32_dpp v154, v170, v102 row_newbcast:3 row_mask:0xf bank_mask:0xf
    v_fmac_f32_dpp v155, v170, v103 row_newbcast:3 row_mask:0xf bank_mask:0xf
    s_waitcnt vmcnt(25)
    v_cvt_f32_i32 v104, v56
    v_cvt_f32_i32 v105, v57
    v_cvt_f32_i32 v106, v58
    v_cvt_f32_i32 v107, v59
    s_add_u32 s71, s71, 3072
    buffer_load_dwordx4 v[52:55], v1, s[28:31], s71 offen offset:0 nt
    v_fmac_f32_dpp v156, v170, v104 row_newbcast:3 row_mask:0xf bank_mask:0xf
    v_fmac_f32_dpp v157, v170, v105 row_newbcast:3 row_mask:0xf bank_mask:0xf
    v_fmac_f32_dpp v158, v170, v106 row_newbcast:3 row_mask:0xf bank_mask:0xf
    v_fmac_f32_dpp v159, v170, v107 row_newbcast:3 row_mask:0xf bank_mask:0xf
    s_waitcnt vmcnt(25)
    v_cvt_f32_i32 v100, v60
    v_cvt_f32_i32 v101, v61
    v_cvt_f32_i32 v102, v62
    v_cvt_f32_i32 v103, v63
    buffer_load_dwordx4 v[56:59], v1, s[28:31], s71 offen offset:256 nt
    v_fmac_f32_dpp v160, v170, v100 row_newbcast:3 row_mask:0xf bank_mask:0xf
    v_fmac_f32_dpp v161, v170, v101 row_newbcast:3 row_mask:0xf bank_mask:0xf
    v_fmac_f32_dpp v162, v170, v102 row_newbcast:3 row_mask:0xf bank_mask:0xf
    v_fmac_f32_dpp v163, v170, v103 row_newbcast:3 row_mask:0xf bank_mask:0xf
    s_waitcnt vmcnt(25)
    v_cvt_f32_i32 v104, v64
    v_cvt_f32_i32 v105, v65
    v_cvt_f32_i32 v106, v66
    v_cvt_f32_i32 v107, v67
    buffer_load_dwordx4 v[60:63], v1, s[28:31], s71 offen offset:512 nt
    v_fmac_f32_dpp v152, v170, v104 row_newbcast:11 row_mask:0xf bank_mask:0xf
    v_fmac_f32_dpp v153, v170, v105 row_newbcast:11 row_mask:0xf bank_mask:0xf
    v_fmac_f32_dpp v154, v170, v106 row_newbcast:11 row_mask:0xf bank_mask:0xf
    v_fmac_f32_dpp v155, v170, v107 row_newbcast:11 row_mask:0xf bank_mask:0xf
    s_waitcnt vmcnt(25)
    v_cvt_f32_i32 v100, v68
    v_cvt_f32_i32 v101, v69
    v_cvt_f32_i32 v102, v70
    v_cvt_f32_i32 v103, v71
    s_add_u32 s71, s71, 3072
    buffer_load_dwordx4 v[64:67], v1, s[28:31], s71 offen offset:0 nt
    v_fmac_f32_dpp v156, v170, v100 row_newbcast:11 row_mask:0xf bank_mask:0xf
    v_fmac_f32_dpp v157, v170, v101 row_newbcast:11 row_mask:0xf bank_mask:0xf
    v_fmac_f32_dpp v158, v170, v102 row_newbcast:11 row_mask:0xf bank_mask:0xf
    v_fmac_f32_dpp v159, v170, v103 row_newbcast:11 row_mask:0xf bank_mask:0xf
    s_waitcnt vmcnt(25)
    v_cvt_f32_i32 v104, v72
    v_cvt_f32_i32 v105, v73
    v_cvt_f32_i32 v106, v74
    v_cvt_f32_i32 v107, v75
    buffer_load_dwordx4 v[68:71], v1, s[28:31], s71 offen offset:256 nt
    v_fmac_f32_dpp v160, v170, v104 row_newbcast:11 row_mask:0xf bank_mask:0xf
    v_fmac_f32_dpp v161, v170, v105 row_newbcast:11 row_mask:0xf bank_mask:0xf
    v_fmac_f32_dpp v162, v170, v106 row_newbcast:11 row_mask:0xf bank_mask:0xf
    v_fmac_f32_dpp v163, v170, v107 row_newbcast:11 row_mask:0xf bank_mask:0xf
    s_waitcnt vmcnt(25)
    v_cvt_f32_i32 v100, v76
    v_cvt_f32_i32 v101, v77
    v_cvt_f32_i32 v102, v78
    v_cvt_f32_i32 v103, v79
    buffer_load_dwordx4 v[72:75], v1, s[28:31], s71 offen offset:512 nt
    v_fmac_f32_dpp v152, v170, v100 row_newbcast:7 row_mask:0xf bank_mask:0xf
    v_fmac_f32_dpp v153, v170, v101 row_newbcast:7 row_mask:0xf bank_mask:0xf
    v_fmac_f32_dpp v154, v170, v102 row_newbcast:7 row_mask:0xf bank_mask:0xf
    v_fmac_f32_dpp v155, v170, v103 row_newbcast:7 row_mask:0xf bank_mask:0xf
    s_waitcnt vmcnt(25)
    v_cvt_f32_i32 v104, v80
    v_cvt_f32_i32 v105, v81
    v_cvt_f32_i32 v106, v82
    v_cvt_f32_i32 v107, v83
    s_add_u32 s71, s71, 3072
    buffer_load_dwordx4 v[76:79], v1, s[28:31], s71 offen offset:0 nt
    v_fmac_f32_dpp v156, v170, v104 row_newbcast:7 row_mask:0xf bank_mask:0xf
    v_fmac_f32_dpp v157, v170, v105 row_newbcast:7 row_mask:0xf bank_mask:0xf
    v_fmac_f32_dpp v158, v170, v106 row_newbcast:7 row_mask:0xf bank_mask:0xf
    v_fmac_f32_dpp v159, v170, v107 row_newbcast:7 row_mask:0xf bank_mask:0xf
    s_waitcnt vmcnt(25)
    v_cvt_f32_i32 v100, v84
    v_cvt_f32_i32 v101, v85
    v_cvt_f32_i32 v102, v86
    v_cvt_f32_i32 v103, v87
    buffer_load_dwordx4 v[80:83], v1, s[28:31], s71 offen offset:256 nt
    v_fmac_f32_dpp v160, v170, v100 row_newbcast:7 row_mask:0xf bank_mask:0xf
    v_fmac_f32_dpp v161, v170, v101 row_newbcast:7 row_mask:0xf bank_mask:0xf
    v_fmac_f32_dpp v162, v170, v102 row_newbcast:7 row_mask:0xf bank_mask:0xf
    v_fmac_f32_dpp v163, v170, v103 row_newbcast:7 row_mask:0xf bank_mask:0xf
    s_waitcnt vmcnt(25)
    v_cvt_f32_i32 v104, v88
    v_cvt_f32_i32 v105, v89
    v_cvt_f32_i32 v106, v90
    v_cvt_f32_i32 v107, v91
    buffer_load_dwordx4 v[84:87], v1, s[28:31], s71 offen offset:512 nt
    v_fmac_f32_dpp v152, v170, v104 row_newbcast:15 row_mask:0xf bank_mask:0xf
    v_fmac_f32_dpp v153, v170, v105 row_newbcast:15 row_mask:0xf bank_mask:0xf
    v_fmac_f32_dpp v154, v170, v106 row_newbcast:15 row_mask:0xf bank_mask:0xf
    v_fmac_f32_dpp v155, v170, v107 row_newbcast:15 row_mask:0xf bank_mask:0xf
    s_waitcnt vmcnt(25)
    v_cvt_f32_i32 v100, v92
    v_cvt_f32_i32 v101, v93
    v_cvt_f32_i32 v102, v94
    v_cvt_f32_i32 v103, v95
    s_add_u32 s71, s71, 3072
    buffer_load_dwordx4 v[88:91], v1, s[28:31], s71 offen offset:0 nt
    v_fmac_f32_dpp v156, v170, v100 row_newbcast:15 row_mask:0xf bank_mask:0xf
    v_fmac_f32_dpp v157, v170, v101 row_newbcast:15 row_mask:0xf bank_mask:0xf
    v_fmac_f32_dpp v158, v170, v102 row_newbcast:15 row_mask:0xf bank_mask:0xf
    v_fmac_f32_dpp v159, v170, v103 row_newbcast:15 row_mask:0xf bank_mask:0xf
    s_waitcnt vmcnt(25)
    v_cvt_f32_i32 v104, v96
    v_cvt_f32_i32 v105, v97
    v_cvt_f32_i32 v106, v98
    v_cvt_f32_i32 v107, v99
    buffer_load_dwordx4 v[92:95], v1, s[28:31], s71 offen offset:256 nt
    v_fmac_f32_dpp v160, v170, v104 row_newbcast:15 row_mask:0xf bank_mask:0xf
    v_fmac_f32_dpp v161, v170, v105 row_newbcast:15 row_mask:0xf bank_mask:0xf
    v_fmac_f32_dpp v162, v170, v106 row_newbcast:15 row_mask:0xf bank_mask:0xf
    v_fmac_f32_dpp v163, v170, v107 row_newbcast:15 row_mask:0xf bank_mask:0xf
    s_branch L_dloop
L_dtail:
    ds_write_b32 v188, v188 offset:143
    s_waitcnt vmcnt(22)
    v_cvt_f32_i32 v104, v8
    v_cvt_f32_i32 v105, v9
    v_cvt_f32_i32 v106, v10
    v_cvt_f32_i32 v107, v11
    v_fmac_f32_dpp v156, v170, v104 row_newbcast:1 row_mask:0xf bank_mask:0xf
    v_fmac_f32_dpp v157, v170, v105 row_newbcast:1 row_mask:0xf bank_mask:0xf
    v_fmac_f32_dpp v158, v170, v106 row_newbcast:1 row_mask:0xf bank_mask:0xf
    v_fmac_f32_dpp v159, v170, v107 row_newbcast:1 row_mask:0xf bank_mask:0xf
    s_waitcnt vmcnt(21)
    v_cvt_f32_i32 v100, v12
    v_cvt_f32_i32 v101, v13
    v_cvt_f32_i32 v102, v14
    v_cvt_f32_i32 v103, v15
    v_fmac_f32_dpp v160, v170, v100 row_newbcast:1 row_mask:0xf bank_mask:0xf
    v_fmac_f32_dpp v161, v170, v101 row_newbcast:1 row_mask:0xf bank_mask:0xf
    v_fmac_f32_dpp v162, v170, v102 row_newbcast:1 row_mask:0xf bank_mask:0xf
    v_fmac_f32_dpp v163, v170, v103 row_newbcast:1 row_mask:0xf bank_mask:0xf
    s_waitcnt vmcnt(20)
    v_cvt_f32_i32 v104, v16
    v_cvt_f32_i32 v105, v17
    v_cvt_f32_i32 v106, v18
    v_cvt_f32_i32 v107, v19
    v_fmac_f32_dpp v152, v170, v104 row_newbcast:9 row_mask:0xf bank_mask:0xf
    v_fmac_f32_dpp v153, v170, v105 row_newbcast:9 row_mask:0xf bank_mask:0xf
    v_fmac_f32_dpp v154, v170, v106 row_newbcast:9 row_mask:0xf bank_mask:0xf
    v_fmac_f32_dpp v155, v170, v107 row_newbcast:9 row_mask:0xf bank_mask:0xf
    s_waitcnt vmcnt(19)
    v_cvt_f32_i32 v100, v20
    v_cvt_f32_i32 v101, v21
    v_cvt_f32_i32 v102, v22
    v_cvt_f32_i32 v103, v23
    v_fmac_f32_dpp v156, v170, v100 row_newbcast:9 row_mask:0xf bank_mask:0xf
    v_fmac_f32_dpp v157, v170, v101 row_newbcast:9 row_mask:0xf bank_mask:0xf
    v_fmac_f32_dpp v158, v170, v102 row_newbcast:9 row_mask:0xf bank_mask:0xf
    v_fmac_f32_dpp v159, v170, v103 row_newbcast:9 row_mask:0xf bank_mask:0xf
    s_waitcnt vmcnt(18)
    v_cvt_f32_i32 v104, v24
    v_cvt_f32_i32 v105, v25
    v_cvt_f32_i32 v106, v26
    v_cvt_f32_i32 v107, v27
    v_fmac_f32_dpp v160, v170, v104 row_newbcast:9 row_mask:0xf bank_mask:0xf
    v_fmac_f32_dpp v161, v170, v105 row_newbcast:9 row_mask:0xf bank_mask:0xf
    v_fmac_f32_dpp v162, v170, v106 row_newbcast:9 row_mask:0xf bank_mask:0xf
    v_fmac_f32_dpp v163, v170, v107 row_newbcast:9 row_mask:0xf bank_mask:0xf
    s_waitcnt vmcnt(17)
    v_cvt_f32_i32 v100, v28
    v_cvt_f32_i32 v101, v29
    v_cvt_f32_i32 v102, v30
    v_cvt_f32_i32 v103, v31
    v_fmac_f32_dpp v152, v170, v100 row_newbcast:5 row_mask:0xf bank_mask:0xf
    v_fmac_f32_dpp v153, v170, v101 row_newbcast:5 row_mask:0xf bank_mask:0xf
    v_fmac_f32_dpp v154, v170, v102 row_newbcast:5 row_mask:0xf bank_mask:0xf
    v_fmac_f32_dpp v155, v170, v103 row_newbcast:5 row_mask:0xf bank_mask:0xf
    s_waitcnt vmcnt(16)
    v_cvt_f32_i32 v104, v32
    v_cvt_f32_i32 v105, v33
    v_cvt_f32_i32 v106, v34
    v_cvt_f32_i32 v107, v35
    v_fmac_f32_dpp v156, v170, v104 row_newbcast:5 row_mask:0xf bank_mask:0xf
    v_fmac_f32_dpp v157, v170, v105 row_newbcast:5 row_mask:0xf bank_mask:0xf
    v_fmac_f32_dpp v158, v170, v106 row_newbcast:5 row_mask:0xf bank_mask:0xf
    v_fmac_f32_dpp v159, v170, v107 row_newbcast:5 row_mask:0xf bank_mask:0xf
    s_waitcnt vmcnt(15)
    v_cvt_f32_i32 v100, v36
    v_cvt_f32_i32 v101, v37
    v_cvt_f32_i32 v102, v38
    v_cvt_f32_i32 v103, v39
    v_fmac_f32_dpp v160, v170, v100 row_newbcast:5 row_mask:0xf bank_mask:0xf
    v_fmac_f32_dpp v161, v170, v101 row_newbcast:5 row_mask:0xf bank_mask:0xf
    v_fmac_f32_dpp v162, v170, v102 row_newbcast:5 row_mask:0xf bank_mask:0xf
    v_fmac_f32_dpp v163, v170, v103 row_newbcast:5 row_mask:0xf bank_mask:0xf
    s_waitcnt vmcnt(14)
    v_cvt_f32_i32 v104, v40
    v_cvt_f32_i32 v105, v41
    v_cvt_f32_i32 v106, v42
    v_cvt_f32_i32 v107, v43
    v_fmac_f32_dpp v152, v170, v104 row_newbcast:13 row_mask:0xf bank_mask:0xf
    v_fmac_f32_dpp v153, v170, v105 row_newbcast:13 row_mask:0xf bank_mask:0xf
    v_fmac_f32_dpp v154, v170, v106 row_newbcast:13 row_mask:0xf bank_mask:0xf
    v_fmac_f32_dpp v155, v170, v107 row_newbcast:13 row_mask:0xf bank_mask:0xf
    s_waitcnt vmcnt(13)
    v_cvt_f32_i32 v100, v44
    v_cvt_f32_i32 v101, v45
    v_cvt_f32_i32 v102, v46
    v_cvt_f32_i32 v103, v47
    v_fmac_f32_dpp v156, v170, v100 row_newbcast:13 row_mask:0xf bank_mask:0xf
    v_fmac_f32_dpp v157, v170, v101 row_newbcast:13 row_mask:0xf bank_mask:0xf
    v_fmac_f32_dpp v158, v170, v102 row_newbcast:13 row_mask:0xf bank_mask:0xf
    v_fmac_f32_dpp v159, v170, v103 row_newbcast:13 row_mask:0xf bank_mask:0xf
    s_waitcnt vmcnt(12)
    v_cvt_f32_i32 v104, v48
    v_cvt_f32_i32 v105, v49
    v_cvt_f32_i32 v106, v50
    v_cvt_f32_i32 v107, v51
    v_fmac_f32_dpp v160, v170, v104 row_newbcast:13 row_mask:0xf bank_mask:0xf
    v_fmac_f32_dpp v161, v170, v105 row_newbcast:13 row_mask:0xf bank_mask:0xf
    v_fmac_f32_dpp v162, v170, v106 row_newbcast:13 row_mask:0xf bank_mask:0xf
    v_fmac_f32_dpp v163, v170, v107 row_newbcast:13 row_mask:0xf bank_mask:0xf
    s_waitcnt vmcnt(11)
    v_cvt_f32_i32 v100, v52
    v_cvt_f32_i32 v101, v53
    v_cvt_f32_i32 v102, v54
    v_cvt_f32_i32 v103, v55
    v_fmac_f32_dpp v152, v170, v100 row_newbcast:3 row_mask:0xf bank_mask:0xf
    v_fmac_f32_dpp v153, v170, v101 row_newbcast:3 row_mask:0xf bank_mask:0xf
    v_fmac_f32_dpp v154, v170, v102 row_newbcast:3 row_mask:0xf bank_mask:0xf
    v_fmac_f32_dpp v155, v170, v103 row_newbcast:3 row_mask:0xf bank_mask:0xf
    s_waitcnt vmcnt(10)
    v_cvt_f32_i32 v104, v56
    v_cvt_f32_i32 v105, v57
    v_cvt_f32_i32 v106, v58
    v_cvt_f32_i32 v107, v59
    v_fmac_f32_dpp v156, v170, v104 row_newbcast:3 row_mask:0xf bank_mask:0xf
    v_fmac_f32_dpp v157, v170, v105 row_newbcast:3 row_mask:0xf bank_mask:0xf
    v_fmac_f32_dpp v158, v170, v106 row_newbcast:3 row_mask:0xf bank_mask:0xf
    v_fmac_f32_dpp v159, v170, v107 row_newbcast:3 row_mask:0xf bank_mask:0xf
    s_waitcnt vmcnt(9)
    v_cvt_f32_i32 v100, v60
    v_cvt_f32_i32 v101, v61
    v_cvt_f32_i32 v102, v62
    v_cvt_f32_i32 v103, v63
    v_fmac_f32_dpp v160, v170, v100 row_newbcast:3 row_mask:0xf bank_mask:0xf
    v_fmac_f32_dpp v161, v170, v101 row_newbcast:3 row_mask:0xf bank_mask:0xf
    v_fmac_f32_dpp v162, v170, v102 row_newbcast:3 row_mask:0xf bank_mask:0xf
    v_fmac_f32_dpp v163, v170, v103 row_newbcast:3 row_mask:0xf bank_mask:0xf
    s_waitcnt vmcnt(8)
    v_cvt_f32_i32 v104, v64
    v_cvt_f32_i32 v105, v65
    v_cvt_f32_i32 v106, v66
    v_cvt_f32_i32 v107, v67
    v_fmac_f32_dpp v152, v170, v104 row_newbcast:11 row_mask:0xf bank_mask:0xf
    v_fmac_f32_dpp v153, v170, v105 row_newbcast:11 row_mask:0xf bank_mask:0xf
    v_fmac_f32_dpp v154, v170, v106 row_newbcast:11 row_mask:0xf bank_mask:0xf
    v_fmac_f32_dpp v155, v170, v107 row_newbcast:11 row_mask:0xf bank_mask:0xf
    s_waitcnt vmcnt(7)
    v_cvt_f32_i32 v100, v68
    v_cvt_f32_i32 v101, v69
    v_cvt_f32_i32 v102, v70
    v_cvt_f32_i32 v103, v71
    v_fmac_f32_dpp v156, v170, v100 row_newbcast:11 row_mask:0xf bank_mask:0xf
    v_fmac_f32_dpp v157, v170, v101 row_newbcast:11 row_mask:0xf bank_mask:0xf
    v_fmac_f32_dpp v158, v170, v102 row_newbcast:11 row_mask:0xf bank_mask:0xf
    v_fmac_f32_dpp v159, v170, v103 row_newbcast:11 row_mask:0xf bank_mask:0xf
    s_waitcnt vmcnt(6)
    v_cvt_f32_i32 v104, v72
    v_cvt_f32_i32 v105, v73
    v_cvt_f32_i32 v106, v74
    v_cvt_f32_i32 v107, v75
    v_fmac_f32_dpp v160, v170, v104 row_newbcast:11 row_mask:0xf bank_mask:0xf
    v_fmac_f32_dpp v161, v170, v105 row_newbcast:11 row_mask:0xf bank_mask:0xf
    v_fmac_f32_dpp v162, v170, v106 row_newbcast:11 row_mask:0xf bank_mask:0xf
    v_fmac_f32_dpp v163, v170, v107 row_newbcast:11 row_mask:0xf bank_mask:0xf
    s_waitcnt vmcnt(5)
    v_cvt_f32_i32 v100, v76
    v_cvt_f32_i32 v101, v77
    v_cvt_f32_i32 v102, v78
    v_cvt_f32_i32 v103, v79
    v_fmac_f32_dpp v152, v170, v100 row_newbcast:7 row_mask:0xf bank_mask:0xf
    v_fmac_f32_dpp v153, v170, v101 row_newbcast:7 row_mask:0xf bank_mask:0xf
    v_fmac_f32_dpp v154, v170, v102 row_newbcast:7 row_mask:0xf bank_mask:0xf
    v_fmac_f32_dpp v155, v170, v103 row_newbcast:7 row_mask:0xf bank_mask:0xf
    s_waitcnt vmcnt(4)
    v_cvt_f32_i32 v104, v80
    v_cvt_f32_i32 v105, v81
    v_cvt_f32_i32 v106, v82
    v_cvt_f32_i32 v107, v83
    v_fmac_f32_dpp v156, v170, v104 row_newbcast:7 row_mask:0xf bank_mask:0xf
    v_fmac_f32_dpp v157, v170, v105 row_newbcast:7 row_mask:0xf bank_mask:0xf
    v_fmac_f32_dpp v158, v170, v106 row_newbcast:7 row_mask:0xf bank_mask:0xf
    v_fmac_f32_dpp v159, v170, v107 row_newbcast:7 row_mask:0xf bank_mask:0xf
    s_waitcnt vmcnt(3)
    v_cvt_f32_i32 v100, v84
    v_cvt_f32_i32 v101, v85
    v_cvt_f32_i32 v102, v86
    v_cvt_f32_i32 v103, v87
    v_fmac_f32_dpp v160, v170, v100 row_newbcast:7 row_mask:0xf bank_mask:0xf
    v_fmac_f32_dpp v161, v170, v101 row_newbcast:7 row_mask:0xf bank_mask:0xf
    v_fmac_f32_dpp v162, v170, v102 row_newbcast:7 row_mask:0xf bank_mask:0xf
    v_fmac_f32_dpp v163, v170, v103 row_newbcast:7 row_mask:0xf bank_mask:0xf
    s_waitcnt vmcnt(2)
    v_cvt_f32_i32 v104, v88
    v_cvt_f32_i32 v105, v89
    v_cvt_f32_i32 v106, v90
    v_cvt_f32_i32 v107, v91
    v_fmac_f32_dpp v152, v170, v104 row_newbcast:15 row_mask:0xf bank_mask:0xf
    v_fmac_f32_dpp v153, v170, v105 row_newbcast:15 row_mask:0xf bank_mask:0xf
    v_fmac_f32_dpp v154, v170, v106 row_newbcast:15 row_mask:0xf bank_mask:0xf
    v_fmac_f32_dpp v155, v170, v107 row_newbcast:15 row_mask:0xf bank_mask:0xf
    s_waitcnt vmcnt(1)
    v_cvt_f32_i32 v100, v92
    v_cvt_f32_i32 v101, v93
    v_cvt_f32_i32 v102, v94
    v_cvt_f32_i32 v103, v95
    v_fmac_f32_dpp v156, v170, v100 row_newbcast:15 row_mask:0xf bank_mask:0xf
    v_fmac_f32_dpp v157, v170, v101 row_newbcast:15 row_mask:0xf bank_mask:0xf
    v_fmac_f32_dpp v158, v170, v102 row_newbcast:15 row_mask:0xf bank_mask:0xf
    v_fmac_f32_dpp v159, v170, v103 row_newbcast:15 row_mask:0xf bank_mask:0xf
    s_waitcnt vmcnt(0)
    v_cvt_f32_i32 v104, v96
    v_cvt_f32_i32 v105, v97
    v_cvt_f32_i32 v106, v98
    v_cvt_f32_i32 v107, v99
    v_fmac_f32_dpp v160, v170, v104 row_newbcast:15 row_mask:0xf bank_mask:0xf
    v_fmac_f32_dpp v161, v170, v105 row_newbcast:15 row_mask:0xf bank_mask:0xf
    v_fmac_f32_dpp v162, v170, v106 row_newbcast:15 row_mask:0xf bank_mask:0xf
    v_fmac_f32_dpp v163, v170, v107 row_newbcast:15 row_mask:0xf bank_mask:0xf
    s_nop 0
    v_add_f32_dpp v166, v166, v166 row_ror:8 row_mask:0xf bank_mask:0xf
    v_add_f32_dpp v167, v167, v167 row_ror:8 row_mask:0xf bank_mask:0xf
    s_nop 0
    v_add_f32_dpp v166, v166, v166 row_ror:4 row_mask:0xf bank_mask:0xf
    v_add_f32_dpp v167, v167, v167 row_ror:4 row_mask:0xf bank_mask:0xf
    s_nop 0
    v_add_f32_dpp v166, v166, v166 row_ror:2 row_mask:0xf bank_mask:0xf
    v_add_f32_dpp v167, v167, v167 row_ror:2 row_mask:0xf bank_mask:0xf
    s_nop 0
    v_add_f32_dpp v166, v166, v166 row_ror:1 row_mask:0xf bank_mask:0xf
    v_add_f32_dpp v167, v167, v167 row_ror:1 row_mask:0xf bank_mask:0xf
    v_mov_b32 v182, v165
    v_mov_b32 v183, v165
    s_nop 1
    v_permlane32_swap_b32 v182, v183
    s_nop 1
    v_max_f32 v182, v182, v183
    v_mov_b32 v183, v182
    s_nop 1
    v_permlane16_swap_b32 v182, v183
    s_nop 1
    v_max_f32 v182, v182, v183
    v_sub_f32 v183, v165, v182
    v_exp_f32 v183, v183
    v_mov_b32 v104, v182
    v_mul_f32 v166, v166, v183
    v_mul_f32 v167, v167, v183
    v_fma_f32 v152, v152, v183, -v167
    v_fma_f32 v153, v153, v183, -v167
    v_fma_f32 v154, v154, v183, -v167
    v_fma_f32 v155, v155, v183, -v167
    v_fma_f32 v156, v156, v183, -v167
    v_fma_f32 v157, v157, v183, -v167
    v_fma_f32 v158, v158, v183, -v167
    v_fma_f32 v159, v159, v183, -v167
    v_fma_f32 v160, v160, v183, -v167
    v_fma_f32 v161, v161, v183, -v167
    v_fma_f32 v162, v162, v183, -v167
    v_fma_f32 v163, v163, v183, -v167
    v_mov_b32 v182, v166
    s_nop 1
    v_permlane32_swap_b32 v166, v182
    v_permlane32_swap_b32 v152, v154
    v_permlane32_swap_b32 v153, v155
    v_permlane32_swap_b32 v156, v158
    v_permlane32_swap_b32 v157, v159
    v_permlane32_swap_b32 v160, v162
    v_permlane32_swap_b32 v161, v163
    s_nop 1
    v_add_f32 v166, v166, v182
    v_add_f32 v152, v152, v154
    v_add_f32 v153, v153, v155
    v_add_f32 v156, v156, v158
    v_add_f32 v157, v157, v159
    v_add_f32 v160, v160, v162
    v_add_f32 v161, v161, v163
    v_mov_b32 v182, v166
    s_nop 1
    v_permlane16_swap_b32 v166, v182
    v_permlane16_swap_b32 v152, v153
    v_permlane16_swap_b32 v156, v157
    v_permlane16_swap_b32 v160, v161
    s_nop 1
    v_add_f32 v105, v166, v182
    v_add_f32 v100, v152, v153
    v_add_f32 v101, v156, v157
    v_add_f32 v102, v160, v161
    v_mov_b32 v103, s93
    v_mov_b32 v106, s93
    v_mov_b32 v107, s93
    v_lshlrev_b32 v183, 4, v0
    s_lshl_b32 s80, s2, 11
    buffer_store_dwordx4 v[100:103], v183, s[52:55], s80 offen offset:0 sc0 sc1
    s_mov_b64 exec, 1
    buffer_store_dwordx4 v[104:107], v183, s[52:55], s80 offen offset:1024 sc0 sc1
    s_mov_b64 exec, -1
    s_endpgm
L_service:
    v_lshlrev_b32 v5, 2, v0
    v_mov_b32 v3, 0
    ds_write_b32 v5, v3 offset:0
    v_lshlrev_b32 v1, 4, v0
    v_mov_b32 v2, v1
    v_lshlrev_b32 v28, 11, v0
    v_mov_b32 v4, 0
    v_mov_b32 v9, 0xf149f2ca
    v_cndmask_b32 v9, v9, v3, s[66:67]
    v_and_b32 v5, 15, v0
    v_lshrrev_b32 v6, 4, v0
    v_lshl_add_u32 v10, v5, 2, v6
    v_lshlrev_b32 v10, 1, v10
    s_getreg_b32 s72, hwreg(HW_REG_XCC_ID)
    s_and_b32 s72, s72, 15
    s_lshl_b32 s77, s2, 11
    s_add_u32 s77, s77, 2097152
    s_lshl_b32 s94, s79, 17
    s_add_u32 s94, s94, 2097152
    s_mov_b32 s71, 0
    s_mov_b32 s76, 0
    s_mov_b32 s95, 0
    s_waitcnt lgkmcnt(0)
    s_barrier
    s_mov_b32 s52, s22
    s_and_b32 s53, s23, 0xffff
    s_mov_b32 s54, 25165824
    s_mov_b32 s55, 0x00020000
    s_mov_b32 s56, s18
    s_and_b32 s57, s19, 0xffff
    s_mov_b32 s58, 12288
    s_mov_b32 s59, 0x00020000
L_poll:
    ds_read_b32 v5, v4
    s_waitcnt lgkmcnt(0)
    v_readfirstlane_b32 s80, v5
    s_cmp_eq_u32 s80, 0
    s_cbranch_scc1 L_poll
    ds_read_b128 v[12:15], v2 offset:3328
    s_cmp_lg_u32 s71, 0
    s_cbranch_scc1 L_guard
L_tag:
    ds_read_b32 v5, v3 offset:136
    s_waitcnt lgkmcnt(0)
    v_readfirstlane_b32 s69, v5
    s_cmp_eq_u32 s69, 0
    s_cbranch_scc1 L_tag
    s_lshl_b32 s81, s79, 17
L_reg:
    buffer_load_dwordx2 v[16:17], v28, s[52:55], s81 offen offset:1536 sc0 sc1
    s_waitcnt vmcnt(0)
    v_cmp_ne_u32 vcc, s69, v17
    s_cmp_lg_u64 vcc, 0
    s_cbranch_scc1 L_reg
    ds_write_b32 v3, v17 offset:140
    s_mov_b32 s95, s69
    v_cmp_eq_u32 s[86:87], s72, v16
    v_lshlrev_b32 v7, v16, 1
    s_nop 1
    v_or_b32_dpp v7, v7, v7 row_ror:8 row_mask:0xf bank_mask:0xf
    s_nop 1
    v_or_b32_dpp v7, v7, v7 row_ror:4 row_mask:0xf bank_mask:0xf
    s_nop 1
    v_or_b32_dpp v7, v7, v7 row_ror:2 row_mask:0xf bank_mask:0xf
    s_nop 1
    v_or_b32_dpp v7, v7, v7 row_ror:1 row_mask:0xf bank_mask:0xf
    v_mov_b32 v5, v7
    s_nop 1
    v_permlane32_swap_b32 v7, v5
    s_nop 1
    v_or_b32 v7, v7, v5
    v_mov_b32 v5, v7
    s_nop 1
    v_permlane16_swap_b32 v7, v5
    s_nop 1
    v_or_b32 v7, v7, v5
    s_bcnt1_i32_b64 s70, s[86:87]
    s_bfm_b64 s[84:85], s92, 0
    s_and_b64 s[84:85], s[84:85], s[86:87]
    s_bcnt1_i32_b64 s73, s[84:85]
    v_readfirstlane_b32 s88, v7
    s_mov_b32 s89, 0
    s_branch L_dep
L_guard:
    v_mov_b32 v17, s69
    s_mov_b64 exec, s[86:87]
    buffer_load_dwordx2 v[16:17], v28, s[52:55], s94 offen offset:1024 sc0 sc1
    s_mov_b64 exec, -1
    s_waitcnt vmcnt(0)
    v_cmp_eq_u32 vcc, s95, v17
    s_cmp_eq_u64 vcc, 0
    s_cbranch_scc1 L_guard
L_dep:
    s_add_u32 s71, s71, 1
    s_add_u32 s95, s95, 1
    s_waitcnt lgkmcnt(0)
    buffer_store_dwordx4 v[12:15], v1, s[52:55], s77 offen
    v_mov_b32 v6, s95
    s_mov_b64 exec, 1
    s_waitcnt vmcnt(0)
    buffer_store_dword v6, v3, s[52:55], s77 offen offset:1024
    s_mov_b64 exec, -1
    s_cmp_lg_u32 s76, s73
    s_cbranch_scc1 L_next
L_all:
    v_mov_b32 v16, s95
    s_mov_b64 exec, s[86:87]
    buffer_load_dword v16, v28, s[52:55], s94 offen offset:1024 sc0 sc1
    s_mov_b64 exec, -1
    s_waitcnt vmcnt(0)
    v_cmp_ne_u32 vcc, s95, v16
    s_cmp_lg_u64 vcc, 0
    s_cbranch_scc1 L_all
    s_mov_b32 s74, 0
    s_mov_b32 s75, s94
    s_mov_b64 s[84:85], s[86:87]
L_merge:
    v_mov_b32 v7, 0xf149f2ca
    v_mov_b32 v8, 0
    v_mov_b32 v12, 0
    v_mov_b32 v13, 0
    v_mov_b32 v14, 0
L_chunk:
    v_mov_b32 v48, 0
    v_mov_b32 v49, 0
    v_mov_b32 v50, 0
    v_mov_b32 v51, v9
    v_mov_b32 v52, 0
    v_mov_b32 v53, 0
    v_mov_b32 v54, 0
    v_mov_b32 v55, v9
    v_mov_b32 v56, 0
    v_mov_b32 v57, 0
    v_mov_b32 v58, 0
    v_mov_b32 v59, v9
    v_mov_b32 v60, 0
    v_mov_b32 v61, 0
    v_mov_b32 v62, 0
    v_mov_b32 v63, v9
    v_mov_b32 v64, 0
    v_mov_b32 v65, 0
    v_mov_b32 v66, 0
    v_mov_b32 v67, v9
    v_mov_b32 v68, 0
    v_mov_b32 v69, 0
    v_mov_b32 v70, 0
    v_mov_b32 v71, v9
    v_mov_b32 v72, 0
    v_mov_b32 v73, 0
    v_mov_b32 v74, 0
    v_mov_b32 v75, v9
    v_mov_b32 v76, 0
    v_mov_b32 v77, 0
    v_mov_b32 v78, 0
    v_mov_b32 v79, v9
    s_ff1_i32_b64 s80, s[84:85]
    s_bitset0_b64 s[84:85], s80
    s_lshl_b32 s81, s80, 11
    s_add_u32 s81, s81, s75
    s_cmp_ge_i32 s80, 0
    s_cselect_b64 exec, -1, 0
    buffer_load_dwordx4 v[48:51], v1, s[52:55], s81 offen sc0 sc1
    s_ff1_i32_b64 s80, s[84:85]
    s_bitset0_b64 s[84:85], s80
    s_lshl_b32 s81, s80, 11
    s_add_u32 s81, s81, s75
    s_cmp_ge_i32 s80, 0
    s_cselect_b64 exec, -1, 0
    buffer_load_dwordx4 v[52:55], v1, s[52:55], s81 offen sc0 sc1
    s_ff1_i32_b64 s80, s[84:85]
    s_bitset0_b64 s[84:85], s80
    s_lshl_b32 s81, s80, 11
    s_add_u32 s81, s81, s75
    s_cmp_ge_i32 s80, 0
    s_cselect_b64 exec, -1, 0
    buffer_load_dwordx4 v[56:59], v1, s[52:55], s81 offen sc0 sc1
    s_ff1_i32_b64 s80, s[84:85]
    s_bitset0_b64 s[84:85], s80
    s_lshl_b32 s81, s80, 11
    s_add_u32 s81, s81, s75
    s_cmp_ge_i32 s80, 0
    s_cselect_b64 exec, -1, 0
    buffer_load_dwordx4 v[60:63], v1, s[52:55], s81 offen sc0 sc1
    s_ff1_i32_b64 s80, s[84:85]
    s_bitset0_b64 s[84:85], s80
    s_lshl_b32 s81, s80, 11
    s_add_u32 s81, s81, s75
    s_cmp_ge_i32 s80, 0
    s_cselect_b64 exec, -1, 0
    buffer_load_dwordx4 v[64:67], v1, s[52:55], s81 offen sc0 sc1
    s_ff1_i32_b64 s80, s[84:85]
    s_bitset0_b64 s[84:85], s80
    s_lshl_b32 s81, s80, 11
    s_add_u32 s81, s81, s75
    s_cmp_ge_i32 s80, 0
    s_cselect_b64 exec, -1, 0
    buffer_load_dwordx4 v[68:71], v1, s[52:55], s81 offen sc0 sc1
    s_ff1_i32_b64 s80, s[84:85]
    s_bitset0_b64 s[84:85], s80
    s_lshl_b32 s81, s80, 11
    s_add_u32 s81, s81, s75
    s_cmp_ge_i32 s80, 0
    s_cselect_b64 exec, -1, 0
    buffer_load_dwordx4 v[72:75], v1, s[52:55], s81 offen sc0 sc1
    s_ff1_i32_b64 s80, s[84:85]
    s_bitset0_b64 s[84:85], s80
    s_lshl_b32 s81, s80, 11
    s_add_u32 s81, s81, s75
    s_cmp_ge_i32 s80, 0
    s_cselect_b64 exec, -1, 0
    buffer_load_dwordx4 v[76:79], v1, s[52:55], s81 offen sc0 sc1
    s_mov_b64 exec, -1
    s_waitcnt vmcnt(0)
    v_max3_f32 v5, v51, v55, v59
    v_max3_f32 v5, v5, v63, v67
    v_max3_f32 v5, v5, v71, v75
    v_max_f32 v5, v5, v79
    s_nop 1
    v_max_f32_dpp v6, v5, v7 quad_perm:[0,0,2,2] row_mask:0xf bank_mask:0xf
    v_sub_f32 v5, v7, v6
    v_exp_f32 v5, v5
    v_sub_f32_dpp v20, v51, v6 quad_perm:[0,0,2,2] row_mask:0xf bank_mask:0xf
    v_sub_f32_dpp v21, v55, v6 quad_perm:[0,0,2,2] row_mask:0xf bank_mask:0xf
    v_sub_f32_dpp v22, v59, v6 quad_perm:[0,0,2,2] row_mask:0xf bank_mask:0xf
    v_sub_f32_dpp v23, v63, v6 quad_perm:[0,0,2,2] row_mask:0xf bank_mask:0xf
    v_sub_f32_dpp v24, v67, v6 quad_perm:[0,0,2,2] row_mask:0xf bank_mask:0xf
    v_sub_f32_dpp v25, v71, v6 quad_perm:[0,0,2,2] row_mask:0xf bank_mask:0xf
    v_sub_f32_dpp v26, v75, v6 quad_perm:[0,0,2,2] row_mask:0xf bank_mask:0xf
    v_sub_f32_dpp v27, v79, v6 quad_perm:[0,0,2,2] row_mask:0xf bank_mask:0xf
    v_exp_f32 v20, v20
    v_exp_f32 v21, v21
    v_exp_f32 v22, v22
    v_exp_f32 v23, v23
    v_exp_f32 v24, v24
    v_exp_f32 v25, v25
    v_exp_f32 v26, v26
    v_exp_f32 v27, v27
    v_mov_b32 v7, v6
    v_mul_f32 v8, v8, v5
    v_mul_f32 v12, v12, v5
    v_mul_f32 v13, v13, v5
    v_mul_f32 v14, v14, v5
    v_fmac_f32 v12, v20, v48
    v_fmac_f32 v13, v20, v49
    v_fmac_f32 v14, v20, v50
    v_fmac_f32 v8, v20, v51
    v_fmac_f32 v12, v21, v52
    v_fmac_f32 v13, v21, v53
    v_fmac_f32 v14, v21, v54
    v_fmac_f32 v8, v21, v55
    v_fmac_f32 v12, v22, v56
    v_fmac_f32 v13, v22, v57
    v_fmac_f32 v14, v22, v58
    v_fmac_f32 v8, v22, v59
    v_fmac_f32 v12, v23, v60
    v_fmac_f32 v13, v23, v61
    v_fmac_f32 v14, v23, v62
    v_fmac_f32 v8, v23, v63
    v_fmac_f32 v12, v24, v64
    v_fmac_f32 v13, v24, v65
    v_fmac_f32 v14, v24, v66
    v_fmac_f32 v8, v24, v67
    v_fmac_f32 v12, v25, v68
    v_fmac_f32 v13, v25, v69
    v_fmac_f32 v14, v25, v70
    v_fmac_f32 v8, v25, v71
    v_fmac_f32 v12, v26, v72
    v_fmac_f32 v13, v26, v73
    v_fmac_f32 v14, v26, v74
    v_fmac_f32 v8, v26, v75
    v_fmac_f32 v12, v27, v76
    v_fmac_f32 v13, v27, v77
    v_fmac_f32 v14, v27, v78
    v_fmac_f32 v8, v27, v79
    s_cmp_lg_u64 s[84:85], 0
    s_cbranch_scc1 L_chunk
    s_cmp_lg_u32 s74, 0
    s_cbranch_scc1 L_fin
    v_cndmask_b32 v15, v7, v8, s[66:67]
    v_mov_b32 v5, s95
    v_mov_b32 v6, s70
    s_lshl_b32 s75, s79, 15
    s_add_u32 s75, s75, 1048576
    s_lshl_b32 s80, s72, 11
    s_add_u32 s80, s80, s75
    buffer_store_dwordx4 v[12:15], v1, s[52:55], s80 offen sc0 sc1
    s_mov_b64 exec, 1
    buffer_store_dword v5, v3, s[52:55], s77 offen offset:1028
    s_lshl_b32 s80, s79, 8
    s_add_u32 s80, s80, 23076864
    s_waitcnt vmcnt(0)
    buffer_atomic_add v6, v3, s[52:55], s80 offen sc0 sc1
    s_waitcnt vmcnt(0)
    s_mov_b64 exec, -1
    v_readfirstlane_b32 s80, v6
    s_add_u32 s80, s80, s70
    s_cmp_lg_u32 s80, 64
    s_cbranch_scc1 L_next
    s_mov_b32 s74, 1
    s_mov_b64 s[84:85], s[88:89]
    s_branch L_merge
L_fin:
    s_nop 1
    v_mov_b32_dpp v5, v8 quad_perm:[1,1,3,3] row_mask:0xf bank_mask:0xf
    v_rcp_f32 v5, v5
    s_mul_i32 s80, s79, 384
    v_mul_f32 v12, v12, v5
    v_mul_f32 v13, v13, v5
    v_mul_f32 v14, v14, v5
    v_cvt_pk_bf16_f32 v12, v12, v12
    v_cvt_pk_bf16_f32 v13, v13, v13
    v_cvt_pk_bf16_f32 v14, v14, v14
    buffer_store_short v12, v10, s[56:59], s80 offen offset:0
    buffer_store_short v13, v10, s[56:59], s80 offen offset:128
    buffer_store_short v14, v10, s[56:59], s80 offen offset:256
L_next:
    v_add_u32 v2, 1024, v2
    v_add_u32 v4, 4, v4
    s_add_u32 s79, s79, 4
    s_add_u32 s76, s76, 1
    s_cmp_eq_u32 s76, s70
    s_cselect_b32 s76, 0, s76
    s_cmp_lt_u32 s71, 7
    s_cbranch_scc1 L_poll
    s_lshr_b32 s78, s92, 4
    s_lshr_b32 s81, s2, 6
    s_mul_i32 s80, s78, 5
    s_mul_i32 s82, s81, 3
    s_add_u32 s80, s80, s82
    s_add_u32 s80, s80, 1
    s_xor_b32 s80, s80, s92
    s_and_b32 s80, s80, 15
    s_cbranch_scc1 L_end
    s_lshl_b32 s75, s81, 17
    v_and_b32 v5, 15, v0
    v_lshrrev_b32 v6, 4, v0
    v_lshlrev_b32 v28, 11, v6
    v_lshl_add_u32 v44, v5, 13, v28
    v_lshl_add_u32 v28, v5, 4, v28
    s_lshl_b32 s80, s78, 8
    v_add_u32 v28, s80, v28
    v_add_u32 v29, 8192, v28
    v_add_u32 v30, 16384, v28
    v_add_u32 v31, 24576, v28
    v_add_u32 v32, 32768, v28
    v_add_u32 v33, 40960, v28
    v_add_u32 v34, 49152, v28
    v_add_u32 v35, 57344, v28
    v_add_u32 v36, 65536, v28
    v_add_u32 v37, 73728, v28
    v_add_u32 v38, 81920, v28
    v_add_u32 v39, 90112, v28
    v_add_u32 v40, 98304, v28
    v_add_u32 v41, 106496, v28
    v_add_u32 v42, 114688, v28
    v_add_u32 v43, 122880, v28
    v_mov_b32 v51, 0
    v_mov_b32 v55, 0
    v_mov_b32 v59, 0
    v_mov_b32 v63, 0
    v_mov_b32 v67, 0
    v_mov_b32 v71, 0
    v_mov_b32 v75, 0
    v_mov_b32 v79, 0
    v_mov_b32 v83, 0
    v_mov_b32 v87, 0
    v_mov_b32 v91, 0
    v_mov_b32 v95, 0
    v_mov_b32 v99, 0
    v_mov_b32 v103, 0
    v_mov_b32 v107, 0
    v_mov_b32 v111, 0
    v_mov_b32 v19, 0
    v_lshlrev_b32 v10, 3, v5
    s_lshl_b32 s80, s78, 1
    s_mul_i32 s78, s79, 384
    s_add_u32 s78, s78, s80
L_dt:
    ds_read_b32 v5, v3 offset:144
    s_waitcnt lgkmcnt(0)
    v_readfirstlane_b32 s80, v5
    s_cmp_eq_u32 s80, 0
    s_cbranch_scc1 L_dt
L_pp:
    v_cmp_ne_u32 s[24:25], s69, v51
    v_cmp_ne_u32 s[26:27], s69, v55
    v_cmp_ne_u32 s[28:29], s69, v59
    v_cmp_ne_u32 s[30:31], s69, v63
    v_cmp_ne_u32 s[32:33], s69, v67
    v_cmp_ne_u32 s[34:35], s69, v71
    v_cmp_ne_u32 s[36:37], s69, v75
    v_cmp_ne_u32 s[38:39], s69, v79
    v_cmp_ne_u32 s[40:41], s69, v83
    v_cmp_ne_u32 s[42:43], s69, v87
    v_cmp_ne_u32 s[44:45], s69, v91
    v_cmp_ne_u32 s[46:47], s69, v95
    v_cmp_ne_u32 s[48:49], s69, v99
    v_cmp_ne_u32 s[50:51], s69, v103
    v_cmp_ne_u32 s[4:5], s69, v107
    v_cmp_ne_u32 s[6:7], s69, v111
    v_cmp_ne_u32 s[8:9], s69, v19
    s_or_b64 s[90:91], s[24:25], s[26:27]
    s_or_b64 s[90:91], s[90:91], s[28:29]
    s_or_b64 s[90:91], s[90:91], s[30:31]
    s_or_b64 s[90:91], s[90:91], s[32:33]
    s_or_b64 s[90:91], s[90:91], s[34:35]
    s_or_b64 s[90:91], s[90:91], s[36:37]
    s_or_b64 s[90:91], s[90:91], s[38:39]
    s_or_b64 s[90:91], s[90:91], s[40:41]
    s_or_b64 s[90:91], s[90:91], s[42:43]
    s_or_b64 s[90:91], s[90:91], s[44:45]
    s_or_b64 s[90:91], s[90:91], s[46:47]
    s_or_b64 s[90:91], s[90:91], s[48:49]
    s_or_b64 s[90:91], s[90:91], s[50:51]
    s_or_b64 s[90:91], s[90:91], s[4:5]
    s_or_b64 s[90:91], s[90:91], s[6:7]
    s_or_b64 s[90:91], s[90:91], s[8:9]
    s_cbranch_scc0 L_pd
    s_mov_b64 exec, s[8:9]
    buffer_load_dwordx4 v[16:19], v44, s[52:55], s75 offen offset:1024 sc0 sc1
    s_mov_b64 exec, s[24:25]
    buffer_load_dwordx4 v[48:51], v28, s[52:55], s75 offen offset:0 sc0 sc1
    s_mov_b64 exec, s[26:27]
    buffer_load_dwordx4 v[52:55], v29, s[52:55], s75 offen offset:0 sc0 sc1
    s_mov_b64 exec, s[28:29]
    buffer_load_dwordx4 v[56:59], v30, s[52:55], s75 offen offset:0 sc0 sc1
    s_mov_b64 exec, s[30:31]
    buffer_load_dwordx4 v[60:63], v31, s[52:55], s75 offen offset:0 sc0 sc1
    s_mov_b64 exec, s[32:33]
    buffer_load_dwordx4 v[64:67], v32, s[52:55], s75 offen offset:0 sc0 sc1
    s_mov_b64 exec, s[34:35]
    buffer_load_dwordx4 v[68:71], v33, s[52:55], s75 offen offset:0 sc0 sc1
    s_mov_b64 exec, s[36:37]
    buffer_load_dwordx4 v[72:75], v34, s[52:55], s75 offen offset:0 sc0 sc1
    s_mov_b64 exec, s[38:39]
    buffer_load_dwordx4 v[76:79], v35, s[52:55], s75 offen offset:0 sc0 sc1
    s_mov_b64 exec, s[40:41]
    buffer_load_dwordx4 v[80:83], v36, s[52:55], s75 offen offset:0 sc0 sc1
    s_mov_b64 exec, s[42:43]
    buffer_load_dwordx4 v[84:87], v37, s[52:55], s75 offen offset:0 sc0 sc1
    s_mov_b64 exec, s[44:45]
    buffer_load_dwordx4 v[88:91], v38, s[52:55], s75 offen offset:0 sc0 sc1
    s_mov_b64 exec, s[46:47]
    buffer_load_dwordx4 v[92:95], v39, s[52:55], s75 offen offset:0 sc0 sc1
    s_mov_b64 exec, s[48:49]
    buffer_load_dwordx4 v[96:99], v40, s[52:55], s75 offen offset:0 sc0 sc1
    s_mov_b64 exec, s[50:51]
    buffer_load_dwordx4 v[100:103], v41, s[52:55], s75 offen offset:0 sc0 sc1
    s_mov_b64 exec, s[4:5]
    buffer_load_dwordx4 v[104:107], v42, s[52:55], s75 offen offset:0 sc0 sc1
    s_mov_b64 exec, s[6:7]
    buffer_load_dwordx4 v[108:111], v43, s[52:55], s75 offen offset:0 sc0 sc1
    s_mov_b64 exec, -1
    s_waitcnt vmcnt(0)
    s_branch L_pp
L_pd:
    v_mov_b32 v7, v16
    s_nop 1
    v_max_f32_dpp v7, v7, v7 row_ror:8 row_mask:0xf bank_mask:0xf
    s_nop 1
    v_max_f32_dpp v7, v7, v7 row_ror:4 row_mask:0xf bank_mask:0xf
    s_nop 1
    v_max_f32_dpp v7, v7, v7 row_ror:2 row_mask:0xf bank_mask:0xf
    s_nop 1
    v_max_f32_dpp v7, v7, v7 row_ror:1 row_mask:0xf bank_mask:0xf
    v_mov_b32 v5, v7
    s_nop 1
    v_permlane32_swap_b32 v7, v5
    s_nop 1
    v_max_f32 v7, v7, v5
    v_mov_b32 v5, v7
    s_nop 1
    v_permlane16_swap_b32 v7, v5
    s_nop 1
    v_max_f32 v7, v7, v5
    v_sub_f32 v6, v16, v7
    v_exp_f32 v6, v6
    v_mov_b32 v12, 0
    v_mov_b32 v13, 0
    v_mov_b32 v14, 0
    v_mul_f32 v8, v6, v17
    v_fmac_f32_dpp v12, v6, v48 row_newbcast:0 row_mask:0xf bank_mask:0xf
    v_fmac_f32_dpp v13, v6, v49 row_newbcast:0 row_mask:0xf bank_mask:0xf
    v_fmac_f32_dpp v14, v6, v50 row_newbcast:0 row_mask:0xf bank_mask:0xf
    v_fmac_f32_dpp v12, v6, v52 row_newbcast:1 row_mask:0xf bank_mask:0xf
    v_fmac_f32_dpp v13, v6, v53 row_newbcast:1 row_mask:0xf bank_mask:0xf
    v_fmac_f32_dpp v14, v6, v54 row_newbcast:1 row_mask:0xf bank_mask:0xf
    v_fmac_f32_dpp v12, v6, v56 row_newbcast:2 row_mask:0xf bank_mask:0xf
    v_fmac_f32_dpp v13, v6, v57 row_newbcast:2 row_mask:0xf bank_mask:0xf
    v_fmac_f32_dpp v14, v6, v58 row_newbcast:2 row_mask:0xf bank_mask:0xf
    v_fmac_f32_dpp v12, v6, v60 row_newbcast:3 row_mask:0xf bank_mask:0xf
    v_fmac_f32_dpp v13, v6, v61 row_newbcast:3 row_mask:0xf bank_mask:0xf
    v_fmac_f32_dpp v14, v6, v62 row_newbcast:3 row_mask:0xf bank_mask:0xf
    v_fmac_f32_dpp v12, v6, v64 row_newbcast:4 row_mask:0xf bank_mask:0xf
    v_fmac_f32_dpp v13, v6, v65 row_newbcast:4 row_mask:0xf bank_mask:0xf
    v_fmac_f32_dpp v14, v6, v66 row_newbcast:4 row_mask:0xf bank_mask:0xf
    v_fmac_f32_dpp v12, v6, v68 row_newbcast:5 row_mask:0xf bank_mask:0xf
    v_fmac_f32_dpp v13, v6, v69 row_newbcast:5 row_mask:0xf bank_mask:0xf
    v_fmac_f32_dpp v14, v6, v70 row_newbcast:5 row_mask:0xf bank_mask:0xf
    v_fmac_f32_dpp v12, v6, v72 row_newbcast:6 row_mask:0xf bank_mask:0xf
    v_fmac_f32_dpp v13, v6, v73 row_newbcast:6 row_mask:0xf bank_mask:0xf
    v_fmac_f32_dpp v14, v6, v74 row_newbcast:6 row_mask:0xf bank_mask:0xf
    v_fmac_f32_dpp v12, v6, v76 row_newbcast:7 row_mask:0xf bank_mask:0xf
    v_fmac_f32_dpp v13, v6, v77 row_newbcast:7 row_mask:0xf bank_mask:0xf
    v_fmac_f32_dpp v14, v6, v78 row_newbcast:7 row_mask:0xf bank_mask:0xf
    v_fmac_f32_dpp v12, v6, v80 row_newbcast:8 row_mask:0xf bank_mask:0xf
    v_fmac_f32_dpp v13, v6, v81 row_newbcast:8 row_mask:0xf bank_mask:0xf
    v_fmac_f32_dpp v14, v6, v82 row_newbcast:8 row_mask:0xf bank_mask:0xf
    v_fmac_f32_dpp v12, v6, v84 row_newbcast:9 row_mask:0xf bank_mask:0xf
    v_fmac_f32_dpp v13, v6, v85 row_newbcast:9 row_mask:0xf bank_mask:0xf
    v_fmac_f32_dpp v14, v6, v86 row_newbcast:9 row_mask:0xf bank_mask:0xf
    v_fmac_f32_dpp v12, v6, v88 row_newbcast:10 row_mask:0xf bank_mask:0xf
    v_fmac_f32_dpp v13, v6, v89 row_newbcast:10 row_mask:0xf bank_mask:0xf
    v_fmac_f32_dpp v14, v6, v90 row_newbcast:10 row_mask:0xf bank_mask:0xf
    v_fmac_f32_dpp v12, v6, v92 row_newbcast:11 row_mask:0xf bank_mask:0xf
    v_fmac_f32_dpp v13, v6, v93 row_newbcast:11 row_mask:0xf bank_mask:0xf
    v_fmac_f32_dpp v14, v6, v94 row_newbcast:11 row_mask:0xf bank_mask:0xf
    v_fmac_f32_dpp v12, v6, v96 row_newbcast:12 row_mask:0xf bank_mask:0xf
    v_fmac_f32_dpp v13, v6, v97 row_newbcast:12 row_mask:0xf bank_mask:0xf
    v_fmac_f32_dpp v14, v6, v98 row_newbcast:12 row_mask:0xf bank_mask:0xf
    v_fmac_f32_dpp v12, v6, v100 row_newbcast:13 row_mask:0xf bank_mask:0xf
    v_fmac_f32_dpp v13, v6, v101 row_newbcast:13 row_mask:0xf bank_mask:0xf
    v_fmac_f32_dpp v14, v6, v102 row_newbcast:13 row_mask:0xf bank_mask:0xf
    v_fmac_f32_dpp v12, v6, v104 row_newbcast:14 row_mask:0xf bank_mask:0xf
    v_fmac_f32_dpp v13, v6, v105 row_newbcast:14 row_mask:0xf bank_mask:0xf
    v_fmac_f32_dpp v14, v6, v106 row_newbcast:14 row_mask:0xf bank_mask:0xf
    v_fmac_f32_dpp v12, v6, v108 row_newbcast:15 row_mask:0xf bank_mask:0xf
    v_fmac_f32_dpp v13, v6, v109 row_newbcast:15 row_mask:0xf bank_mask:0xf
    v_fmac_f32_dpp v14, v6, v110 row_newbcast:15 row_mask:0xf bank_mask:0xf
    s_nop 1
    v_add_f32_dpp v8, v8, v8 row_ror:8 row_mask:0xf bank_mask:0xf
    s_nop 1
    v_add_f32_dpp v8, v8, v8 row_ror:4 row_mask:0xf bank_mask:0xf
    s_nop 1
    v_add_f32_dpp v8, v8, v8 row_ror:2 row_mask:0xf bank_mask:0xf
    s_nop 1
    v_add_f32_dpp v8, v8, v8 row_ror:1 row_mask:0xf bank_mask:0xf
    v_mov_b32 v5, v8
    s_nop 1
    v_permlane32_swap_b32 v8, v5
    s_nop 1
    v_add_f32 v8, v8, v5
    v_mov_b32 v5, v8
    s_nop 1
    v_permlane16_swap_b32 v8, v5
    s_nop 1
    v_add_f32 v8, v8, v5
    v_rcp_f32 v8, v8
    v_mov_b32 v20, v12
    v_mov_b32 v21, v13
    v_mov_b32 v22, v14
    s_nop 1
    v_permlane32_swap_b32 v12, v20
    v_permlane32_swap_b32 v13, v21
    v_permlane32_swap_b32 v14, v22
    s_nop 1
    v_add_f32 v12, v12, v20
    v_add_f32 v13, v13, v21
    v_add_f32 v14, v14, v22
    v_mov_b32 v20, v12
    v_mov_b32 v21, v13
    v_mov_b32 v22, v14
    s_nop 1
    v_permlane16_swap_b32 v12, v20
    v_permlane16_swap_b32 v13, v21
    v_permlane16_swap_b32 v14, v22
    s_nop 1
    v_add_f32 v12, v12, v20
    v_add_f32 v13, v13, v21
    v_add_f32 v14, v14, v22
    v_mul_f32 v12, v12, v8
    v_mul_f32 v13, v13, v8
    v_mul_f32 v14, v14, v8
    v_cvt_pk_bf16_f32 v12, v12, v12
    v_cvt_pk_bf16_f32 v13, v13, v13
    v_cvt_pk_bf16_f32 v14, v14, v14
    s_mov_b64 exec, 0xffff
    buffer_store_short v12, v10, s[56:59], s78 offen offset:0
    buffer_store_short v13, v10, s[56:59], s78 offen offset:128
    buffer_store_short v14, v10, s[56:59], s78 offen offset:256
L_end:
    s_endpgm
L_ticket:
    v_lshlrev_b32 v1, 2, v0
    v_mov_b32 v2, 0
    v_lshlrev_b32 v4, 4, v0
    v_mov_b32 v8, -1
    v_mov_b32 v9, -1
    v_mov_b32 v10, -1
    v_mov_b32 v11, -1
    ds_write_b128 v4, v[8:11] offset:256
    ds_write_b128 v4, v[8:11] offset:1280
    ds_write_b128 v4, v[8:11] offset:2304
    s_memrealtime s[80:81]
    s_waitcnt lgkmcnt(0)
    s_barrier
    s_mov_b32 s52, s22
    s_and_b32 s53, s23, 0xffff
    s_mov_b32 s54, 25165824
    s_mov_b32 s55, 0x00020000
    s_mov_b32 s60, s20
    s_and_b32 s61, s21, 0xffff
    s_mov_b32 s62, 256
    s_mov_b32 s63, 0x00020000
    s_max_u32 s69, s80, 1
    s_cmp_lg_u32 s2, 0
    s_cbranch_scc1 L_kd
    v_lshlrev_b32 v5, 8, v0
    s_mov_b32 s80, 23068672
    buffer_store_dword v2, v5, s[52:55], s80 offen sc0 sc1
    v_mov_b32 v3, s69
    s_mov_b64 exec, 1
    s_waitcnt vmcnt(0)
    buffer_store_dword v3, v2, s[60:63], 0 offen sc0 sc1
    s_mov_b64 exec, -1
L_kd:
    ds_read_b32 v3, v2 offset:128
    s_waitcnt lgkmcnt(0)
    v_readfirstlane_b32 s80, v3
    s_cmp_eq_u32 s80, 0
    s_cbranch_scc1 L_kd
    ds_read_b128 v[8:11], v4 offset:26368
    ds_read_b128 v[12:15], v4 offset:27392
    s_lshl_b32 s80, s2, 11
    s_add_u32 s80, s80, 18874368
    s_waitcnt lgkmcnt(0)
    buffer_store_dwordx4 v[8:11], v4, s[52:55], s80 offen offset:0 sc0 sc1
    s_bfm_b64 exec, 32, 0
    buffer_store_dwordx4 v[12:15], v4, s[52:55], s80 offen offset:1024 sc0 sc1
    s_mov_b64 exec, -1
L_tg:
    buffer_load_dword v3, v2, s[60:63], 0 offen sc0 sc1
    s_waitcnt vmcnt(0)
    v_readfirstlane_b32 s69, v3
    s_cmp_eq_u32 s69, 0
    s_cbranch_scc1 L_tg
    ds_write_b32 v2, v3 offset:136
    s_getreg_b32 s81, hwreg(HW_REG_XCC_ID)
    s_and_b32 s81, s81, 15
    v_mov_b32 v16, s81
    v_mov_b32 v17, s69
    s_lshl_b32 s80, s2, 11
    s_mov_b64 exec, 1
    buffer_store_dwordx2 v[16:17], v2, s[52:55], s80 offen offset:1536 sc0 sc1
    s_lshr_b32 s82, s2, 6
    s_lshl_b32 s82, s82, 8
    s_add_u32 s82, s82, 23068672
    s_mov_b32 s70, 1
    v_mov_b32 v5, 260
L_rq:
    ds_read_b32 v3, v2 offset:132
    s_waitcnt lgkmcnt(0)
    v_readfirstlane_b32 s80, v3
    s_cmp_lt_u32 s80, s70
    s_cbranch_scc1 L_rq
    v_mov_b32 v3, 1
    buffer_atomic_add v3, v2, s[52:55], s82 offen sc0 sc1
    s_waitcnt vmcnt(0)
    v_add_u32 v3, 0, v3
    ds_write_b32 v5, v3
    v_readfirstlane_b32 s80, v3
    v_add_u32 v5, 4, v5
    s_add_u32 s70, s70, 1
    s_cmp_lt_u32 s80, 384
    s_cbranch_scc1 L_rq
    s_endpgm
.section .rodata,"a"
.p2align 6
.amdhsa_kernel standalone__kv_cache_quant_int4_int2_kv_with_per_channel_or_per_token_scales__decode_kernel
  .amdhsa_next_free_vgpr 189
  .amdhsa_next_free_sgpr 102
  .amdhsa_accum_offset 192
  .amdhsa_group_segment_fixed_size 0
  .amdhsa_kernarg_size 80
  .amdhsa_user_sgpr_count 2
  .amdhsa_user_sgpr_kernarg_segment_ptr 1
  .amdhsa_system_sgpr_workgroup_id_x 1
.end_amdhsa_kernel
```

```asm
; @launch grid=(256,1,1) block=(192,1,1) lds=98304
.amdgcn_target "amdgcn-amd-amdhsa--gfx950"
.text
.globl standalone__kv_cache_quant_int4_int2_kv_with_per_channel_or_per_token_scales__decode_kernel
.p2align 8
.type standalone__kv_cache_quant_int4_int2_kv_with_per_channel_or_per_token_scales__decode_kernel,@function
standalone__kv_cache_quant_int4_int2_kv_with_per_channel_or_per_token_scales__decode_kernel:
    s_cmp_ge_u32 s2, 256
    s_cbranch_scc1 L_end
    s_load_dwordx16 s[4:19], s[0:1], 0
    s_load_dwordx4 s[20:23], s[0:1], 64
    s_bfe_u32 s80, s2, 0x20003
    s_lshr_b32 s81, s2, 5
    s_and_b32 s3, s2, 7
    s_lshl_b32 s80, s80, 6
    s_lshl_b32 s81, s81, 3
    s_or_b32 s3, s3, s80
    s_or_b32 s3, s3, s81
    s_and_b32 s80, s2, 7
    s_lshr_b32 s2, s2, 3
    s_lshl_b32 s80, s80, 5
    s_or_b32 s2, s2, s80
    v_lshrrev_b32 v201, 6, v0
    v_and_b32 v0, 63, v0
    v_readfirstlane_b32 s68, v201
    s_lshr_b32 s79, s2, 6
    s_and_b32 s92, s2, 63
    s_mov_b32 s66, 0xaaaaaaaa
    s_mov_b32 s67, 0xaaaaaaaa
    s_cmp_eq_u32 s68, 1
    s_cbranch_scc1 L_service
    s_cmp_eq_u32 s68, 2
    s_cbranch_scc1 L_ticket
    s_setprio 1
    v_and_b32 v207, 15, v0
    v_lshrrev_b32 v206, 4, v0
    v_mul_u32_u24 v1, 768, v206
    v_lshl_add_u32 v1, v207, 4, v1
    v_lshlrev_b32 v2, 3, v207
    v_bfrev_b32 v203, v207
    v_lshrrev_b32 v203, 28, v203
    v_and_b32 v204, 7, v203
    v_lshl_add_u32 v3, v204, 2, v206
    v_lshlrev_b32 v3, 1, v3
    v_lshrrev_b32 v203, 3, v203
    v_lshl_add_u32 v3, v203, 12, v3
    v_lshlrev_b32 v208, 2, v0
    v_add_u32 v208, 11520, v208
    v_mov_b32 v209, v208
    v_lshlrev_b32 v210, 4, v0
    v_mov_b32 v211, 0
    v_mov_b32 v212, 1
    v_lshlrev_b32 v196, 2, v0
    v_mov_b32 v197, 1
    v_mov_b32 v198, 260
    s_mul_i32 s58, s79, 0
    s_and_b32 s94, s92, 448
    s_add_u32 s94, s94, s58
    s_add_u32 s94, s94, 256
    s_add_u32 s58, s58, s92
    s_and_b32 s58, s58, 511
    s_lshr_b32 s59, s3, 6
    s_lshl_b32 s69, s79, 9
    s_lshl_b32 s90, s59, 9
    s_and_b32 s80, s3, 63
    s_add_u32 s90, s90, s80
    s_sub_u32 s90, s90, s69
    s_sub_u32 s90, s90, s92
    s_add_u32 s59, s59, 28
    s_lshl_b32 s59, s59, 9
    s_mov_b32 s64, 0xcccccccc
    s_mov_b32 s65, 0xcccccccc
    s_mov_b32 s78, 0x3dd53b95
    s_waitcnt lgkmcnt(0)
    s_mov_b32 s24, s6
    s_and_b32 s25, s7, 0xffff
    s_mov_b32 s26, 805306368
    s_mov_b32 s27, 0x00020000
    s_mov_b32 s48, s4
    s_and_b32 s49, s5, 0xffff
    s_mov_b32 s50, 12288
    s_mov_b32 s51, 0x00020000
    s_mov_b32 s32, s10
    s_and_b32 s33, s11, 0xffff
    s_mov_b32 s34, 6291456
    s_mov_b32 s35, 0x00020000
    s_mov_b32 s36, s12
    s_and_b32 s37, s13, 0xffff
    s_mov_b32 s38, 6291456
    s_mov_b32 s39, 0x00020000
    s_mov_b32 s57, s69
    s_mov_b32 s56, s58
    s_mov_b32 s75, 8
    s_add_u32 s70, s57, s56
    s_mov_b32 s91, -56
    s_lshr_b32 s74, s70, 9
    s_mul_i32 s74, s74, 384
    buffer_load_dwordx2 v[170:171], v2, s[48:51], s74 offen offset:0
    buffer_load_dwordx2 v[172:173], v2, s[48:51], s74 offen offset:128
    buffer_load_dwordx2 v[174:175], v2, s[48:51], s74 offen offset:256
    s_and_b32 s80, s70, 63
    s_sub_u32 s72, s70, s80
    s_lshr_b32 s80, s80, 1
    s_add_u32 s72, s72, s80
    s_mul_i32 s72, s72, 384
    buffer_load_dwordx2 v[132:133], v2, s[32:35], s72 offen offset:0
    buffer_load_dwordx2 v[134:135], v2, s[32:35], s72 offen offset:128
    buffer_load_dwordx2 v[136:137], v2, s[32:35], s72 offen offset:256
    buffer_load_dwordx2 v[138:139], v2, s[36:39], s72 offen offset:0
    buffer_load_dwordx2 v[140:141], v2, s[36:39], s72 offen offset:128
    buffer_load_dwordx2 v[142:143], v2, s[36:39], s72 offen offset:256
    s_mul_i32 s71, s70, 49152
    s_and_b32 s80, s70, 63
    s_mul_i32 s80, s80, 24576
    s_sub_u32 s71, s71, s80
    buffer_load_dwordx4 v[4:7], v1, s[24:27], s71 offen offset:0 nt
    buffer_load_dwordx4 v[8:11], v1, s[24:27], s71 offen offset:256 nt
    buffer_load_dwordx4 v[12:15], v1, s[24:27], s71 offen offset:512 nt
    s_add_u32 s71, s71, 3072
    buffer_load_dwordx4 v[16:19], v1, s[24:27], s71 offen offset:0 nt
    buffer_load_dwordx4 v[20:23], v1, s[24:27], s71 offen offset:256 nt
    buffer_load_dwordx4 v[24:27], v1, s[24:27], s71 offen offset:512 nt
    s_add_u32 s71, s71, 3072
    buffer_load_dwordx4 v[28:31], v1, s[24:27], s71 offen offset:0 nt
    buffer_load_dwordx4 v[32:35], v1, s[24:27], s71 offen offset:256 nt
    buffer_load_dwordx4 v[36:39], v1, s[24:27], s71 offen offset:512 nt
    s_add_u32 s71, s71, 3072
    buffer_load_dwordx4 v[40:43], v1, s[24:27], s71 offen offset:0 nt
    buffer_load_dwordx4 v[44:47], v1, s[24:27], s71 offen offset:256 nt
    buffer_load_dwordx4 v[48:51], v1, s[24:27], s71 offen offset:512 nt
    s_add_u32 s72, s72, 12288
    buffer_load_dwordx2 v[156:157], v2, s[32:35], s72 offen offset:0
    buffer_load_dwordx2 v[158:159], v2, s[32:35], s72 offen offset:128
    buffer_load_dwordx2 v[160:161], v2, s[32:35], s72 offen offset:256
    buffer_load_dwordx2 v[162:163], v2, s[36:39], s72 offen offset:0
    buffer_load_dwordx2 v[164:165], v2, s[36:39], s72 offen offset:128
    buffer_load_dwordx2 v[166:167], v2, s[36:39], s72 offen offset:256
    s_add_u32 s71, s71, 3072
    buffer_load_dwordx4 v[52:55], v1, s[24:27], s71 offen offset:0 nt
    buffer_load_dwordx4 v[56:59], v1, s[24:27], s71 offen offset:256 nt
    buffer_load_dwordx4 v[60:63], v1, s[24:27], s71 offen offset:512 nt
    s_add_u32 s71, s71, 3072
    buffer_load_dwordx4 v[64:67], v1, s[24:27], s71 offen offset:0 nt
    buffer_load_dwordx4 v[68:71], v1, s[24:27], s71 offen offset:256 nt
    buffer_load_dwordx4 v[72:75], v1, s[24:27], s71 offen offset:512 nt
    s_add_u32 s71, s71, 3072
    buffer_load_dwordx4 v[76:79], v1, s[24:27], s71 offen offset:0 nt
    buffer_load_dwordx4 v[80:83], v1, s[24:27], s71 offen offset:256 nt
    buffer_load_dwordx4 v[84:87], v1, s[24:27], s71 offen offset:512 nt
    s_add_u32 s71, s71, 3072
    buffer_load_dwordx4 v[88:91], v1, s[24:27], s71 offen offset:0 nt
    buffer_load_dwordx4 v[92:95], v1, s[24:27], s71 offen offset:256 nt
    buffer_load_dwordx4 v[96:99], v1, s[24:27], s71 offen offset:512 nt
    s_mov_b32 s28, s8
    s_and_b32 s29, s9, 0xffff
    s_mov_b32 s30, 805306368
    s_mov_b32 s31, 0x00020000
    s_mov_b32 s40, s14
    s_and_b32 s41, s15, 0xffff
    s_mov_b32 s42, 2097152
    s_mov_b32 s43, 0x00020000
    s_mov_b32 s44, s16
    s_and_b32 s45, s17, 0xffff
    s_mov_b32 s46, 2097152
    s_mov_b32 s47, 0x00020000
    s_mov_b32 s52, s22
    s_and_b32 s53, s23, 0xffff
    s_mov_b32 s54, 25165824
    s_mov_b32 s55, 0x00020000
    s_mov_b32 s77, 8
    v_mov_b32 v188, 0xf149f2ca
    v_mov_b32 v189, 0
    v_mov_b32 v190, 0
    v_mov_b32 v176, 0
    v_mov_b32 v177, 0
    v_mov_b32 v178, 0
    v_mov_b32 v179, 0
    v_mov_b32 v180, 0
    v_mov_b32 v181, 0
    v_mov_b32 v182, 0
    v_mov_b32 v183, 0
    v_mov_b32 v184, 0
    v_mov_b32 v185, 0
    v_mov_b32 v186, 0
    v_mov_b32 v187, 0
    s_barrier
    s_waitcnt vmcnt(30)
    v_lshlrev_b32 v108, 16, v170
    v_and_b32 v109, 0xffff0000, v170
    v_lshlrev_b32 v110, 16, v171
    v_and_b32 v111, 0xffff0000, v171
    v_lshlrev_b32 v112, 16, v172
    v_and_b32 v113, 0xffff0000, v172
    v_lshlrev_b32 v114, 16, v173
    v_and_b32 v115, 0xffff0000, v173
    v_lshlrev_b32 v116, 16, v174
    v_and_b32 v117, 0xffff0000, v174
    v_lshlrev_b32 v118, 16, v175
    v_and_b32 v119, 0xffff0000, v175
    v_lshlrev_b32 v206, 16, v132
    v_and_b32 v207, 0xffff0000, v132
    v_mul_f32 v120, v206, v108
    v_mul_f32 v121, v207, v109
    v_lshlrev_b32 v206, 16, v138
    v_and_b32 v207, 0xffff0000, v138
    v_mul_f32 v191, v120, v206
    v_fmac_f32 v191, v121, v207
    v_lshlrev_b32 v206, 16, v133
    v_and_b32 v207, 0xffff0000, v133
    v_mul_f32 v122, v206, v110
    v_mul_f32 v123, v207, v111
    v_lshlrev_b32 v206, 16, v139
    v_and_b32 v207, 0xffff0000, v139
    v_fmac_f32 v191, v122, v206
    v_fmac_f32 v191, v123, v207
    v_lshlrev_b32 v206, 16, v134
    v_and_b32 v207, 0xffff0000, v134
    v_mul_f32 v124, v206, v112
    v_mul_f32 v125, v207, v113
    v_lshlrev_b32 v206, 16, v140
    v_and_b32 v207, 0xffff0000, v140
    v_fmac_f32 v191, v124, v206
    v_fmac_f32 v191, v125, v207
    v_lshlrev_b32 v206, 16, v135
    v_and_b32 v207, 0xffff0000, v135
    v_mul_f32 v126, v206, v114
    v_mul_f32 v127, v207, v115
    v_lshlrev_b32 v206, 16, v141
    v_and_b32 v207, 0xffff0000, v141
    v_fmac_f32 v191, v126, v206
    v_fmac_f32 v191, v127, v207
    v_lshlrev_b32 v206, 16, v136
    v_and_b32 v207, 0xffff0000, v136
    v_mul_f32 v128, v206, v116
    v_mul_f32 v129, v207, v117
    v_lshlrev_b32 v206, 16, v142
    v_and_b32 v207, 0xffff0000, v142
    v_fmac_f32 v191, v128, v206
    v_fmac_f32 v191, v129, v207
    v_lshlrev_b32 v206, 16, v137
    v_and_b32 v207, 0xffff0000, v137
    v_mul_f32 v130, v206, v118
    v_mul_f32 v131, v207, v119
    v_lshlrev_b32 v206, 16, v143
    v_and_b32 v207, 0xffff0000, v143
    v_fmac_f32 v191, v130, v206
    v_fmac_f32 v191, v131, v207
    s_mov_b32 s76, 63
L_loop0:
    s_waitcnt vmcnt(29)
    v_cvt_f32_i32 v100, v4
    v_cvt_f32_i32 v101, v5
    v_cvt_f32_i32 v102, v6
    v_cvt_f32_i32 v103, v7
    s_add_u32 s71, s71, 1551360
    buffer_load_dwordx4 v[4:7], v1, s[24:27], s71 offen offset:0 nt
    v_fma_f32 v200, v120, v100, -v191
    v_fmac_f32 v200, v121, v101
    v_fmac_f32 v200, v122, v102
    v_fmac_f32 v200, v123, v103
    s_waitcnt vmcnt(29)
    v_cvt_f32_i32 v104, v8
    v_cvt_f32_i32 v105, v9
    v_cvt_f32_i32 v106, v10
    v_cvt_f32_i32 v107, v11
    buffer_load_dwordx4 v[8:11], v1, s[24:27], s71 offen offset:256 nt
    v_fmac_f32 v200, v124, v104
    v_fmac_f32 v200, v125, v105
    v_fmac_f32 v200, v126, v106
    v_fmac_f32 v200, v127, v107
    s_waitcnt vmcnt(29)
    v_cvt_f32_i32 v100, v12
    v_cvt_f32_i32 v101, v13
    v_cvt_f32_i32 v102, v14
    v_cvt_f32_i32 v103, v15
    buffer_load_dwordx4 v[12:15], v1, s[24:27], s71 offen offset:512 nt
    v_fmac_f32 v200, v128, v100
    v_fmac_f32 v200, v129, v101
    v_fmac_f32 v200, v130, v102
    v_fmac_f32 v200, v131, v103
    s_nop 1
    v_add_f32_dpp v201, v200, v200 row_ror:8 row_mask:0xf bank_mask:0x3
    s_waitcnt vmcnt(29)
    v_cvt_f32_i32 v104, v16
    v_cvt_f32_i32 v105, v17
    v_cvt_f32_i32 v106, v18
    v_cvt_f32_i32 v107, v19
    s_add_u32 s71, s71, 3072
    buffer_load_dwordx4 v[16:19], v1, s[24:27], s71 offen offset:0 nt
    v_fma_f32 v200, v120, v104, -v191
    v_fmac_f32 v200, v121, v105
    v_fmac_f32 v200, v122, v106
    v_fmac_f32 v200, v123, v107
    s_waitcnt vmcnt(29)
    v_cvt_f32_i32 v100, v20
    v_cvt_f32_i32 v101, v21
    v_cvt_f32_i32 v102, v22
    v_cvt_f32_i32 v103, v23
    buffer_load_dwordx4 v[20:23], v1, s[24:27], s71 offen offset:256 nt
    v_fmac_f32 v200, v124, v100
    v_fmac_f32 v200, v125, v101
    v_fmac_f32 v200, v126, v102
    v_fmac_f32 v200, v127, v103
    s_waitcnt vmcnt(29)
    v_cvt_f32_i32 v104, v24
    v_cvt_f32_i32 v105, v25
    v_cvt_f32_i32 v106, v26
    v_cvt_f32_i32 v107, v27
    buffer_load_dwordx4 v[24:27], v1, s[24:27], s71 offen offset:512 nt
    v_fmac_f32 v200, v128, v104
    v_fmac_f32 v200, v129, v105
    v_fmac_f32 v200, v130, v106
    v_fmac_f32 v200, v131, v107
    s_nop 1
    v_add_f32_dpp v201, v200, v200 row_ror:8 row_mask:0xf bank_mask:0xc
    s_nop 1
    v_add_f32_dpp v202, v201, v201 row_shl:4 row_mask:0xf bank_mask:0x5
    s_waitcnt vmcnt(29)
    v_cvt_f32_i32 v100, v28
    v_cvt_f32_i32 v101, v29
    v_cvt_f32_i32 v102, v30
    v_cvt_f32_i32 v103, v31
    s_add_u32 s71, s71, 3072
    buffer_load_dwordx4 v[28:31], v1, s[24:27], s71 offen offset:0 nt
    v_fma_f32 v200, v120, v100, -v191
    v_fmac_f32 v200, v121, v101
    v_fmac_f32 v200, v122, v102
    v_fmac_f32 v200, v123, v103
    s_waitcnt vmcnt(29)
    v_cvt_f32_i32 v104, v32
    v_cvt_f32_i32 v105, v33
    v_cvt_f32_i32 v106, v34
    v_cvt_f32_i32 v107, v35
    buffer_load_dwordx4 v[32:35], v1, s[24:27], s71 offen offset:256 nt
    v_fmac_f32 v200, v124, v104
    v_fmac_f32 v200, v125, v105
    v_fmac_f32 v200, v126, v106
    v_fmac_f32 v200, v127, v107
    s_waitcnt vmcnt(29)
    v_cvt_f32_i32 v100, v36
    v_cvt_f32_i32 v101, v37
    v_cvt_f32_i32 v102, v38
    v_cvt_f32_i32 v103, v39
    s_add_u32 s56, s56, 64
    s_and_b32 s56, s56, 511
    s_sub_u32 s75, s75, 1
    s_cmp_eq_u32 s75, 0
    s_cselect_b32 s80, 2048, 0
    s_cselect_b32 s75, 8, s75
    s_add_u32 s57, s57, s80
    s_add_u32 s70, s57, s56
    s_add_u32 s91, s91, 1
    s_cmp_lt_u32 s91, 4
    s_cselect_b32 s80, s90, 0
    s_add_u32 s70, s70, s80
    s_lshr_b32 s74, s70, 9
    s_mul_i32 s74, s74, 384
    buffer_load_dwordx2 v[170:171], v2, s[48:51], s74 offen offset:0
    buffer_load_dwordx2 v[172:173], v2, s[48:51], s74 offen offset:128
    buffer_load_dwordx2 v[174:175], v2, s[48:51], s74 offen offset:256
    buffer_load_dwordx4 v[36:39], v1, s[24:27], s71 offen offset:512 nt
    v_fmac_f32 v200, v128, v100
    v_fmac_f32 v200, v129, v101
    v_fmac_f32 v200, v130, v102
    v_fmac_f32 v200, v131, v103
    s_nop 1
    v_add_f32_dpp v201, v200, v200 row_ror:8 row_mask:0xf bank_mask:0x3
    s_waitcnt vmcnt(32)
    v_cvt_f32_i32 v104, v40
    v_cvt_f32_i32 v105, v41
    v_cvt_f32_i32 v106, v42
    v_cvt_f32_i32 v107, v43
    s_add_u32 s71, s71, 3072
    buffer_load_dwordx4 v[40:43], v1, s[24:27], s71 offen offset:0 nt
    v_fma_f32 v200, v120, v104, -v191
    v_fmac_f32 v200, v121, v105
    v_fmac_f32 v200, v122, v106
    v_fmac_f32 v200, v123, v107
    s_waitcnt vmcnt(32)
    v_cvt_f32_i32 v100, v44
    v_cvt_f32_i32 v101, v45
    v_cvt_f32_i32 v102, v46
    v_cvt_f32_i32 v103, v47
    buffer_load_dwordx4 v[44:47], v1, s[24:27], s71 offen offset:256 nt
    v_fmac_f32 v200, v124, v100
    v_fmac_f32 v200, v125, v101
    v_fmac_f32 v200, v126, v102
    v_fmac_f32 v200, v127, v103
    s_waitcnt vmcnt(32)
    v_cvt_f32_i32 v104, v48
    v_cvt_f32_i32 v105, v49
    v_cvt_f32_i32 v106, v50
    v_cvt_f32_i32 v107, v51
    buffer_load_dwordx4 v[48:51], v1, s[24:27], s71 offen offset:512 nt
    v_fmac_f32 v200, v128, v104
    v_fmac_f32 v200, v129, v105
    v_fmac_f32 v200, v130, v106
    v_fmac_f32 v200, v131, v107
    s_nop 1
    v_add_f32_dpp v201, v200, v200 row_ror:8 row_mask:0xf bank_mask:0xc
    s_nop 1
    v_add_f32_dpp v202, v201, v201 row_shr:4 row_mask:0xf bank_mask:0xa
    s_nop 1
    v_add_f32_dpp v203, v202, v202 quad_perm:[2,3,0,1] row_mask:0xf bank_mask:0xf
    s_waitcnt vmcnt(26)
    v_cvt_f32_i32 v100, v52
    v_cvt_f32_i32 v101, v53
    v_cvt_f32_i32 v102, v54
    v_cvt_f32_i32 v103, v55
    s_and_b32 s80, s70, 63
    s_sub_u32 s72, s70, s80
    s_lshr_b32 s80, s80, 1
    s_add_u32 s72, s72, s80
    s_mul_i32 s72, s72, 384
    buffer_load_dwordx2 v[132:133], v2, s[32:35], s72 offen offset:0
    buffer_load_dwordx2 v[134:135], v2, s[32:35], s72 offen offset:128
    buffer_load_dwordx2 v[136:137], v2, s[32:35], s72 offen offset:256
    buffer_load_dwordx2 v[138:139], v2, s[36:39], s72 offen offset:0
    buffer_load_dwordx2 v[140:141], v2, s[36:39], s72 offen offset:128
    buffer_load_dwordx2 v[142:143], v2, s[36:39], s72 offen offset:256
    s_add_u32 s71, s71, 3072
    buffer_load_dwordx4 v[52:55], v1, s[24:27], s71 offen offset:0 nt
    v_fma_f32 v200, v120, v100, -v191
    v_fmac_f32 v200, v121, v101
    v_fmac_f32 v200, v122, v102
    v_fmac_f32 v200, v123, v103
    v_lshlrev_b32 v206, 16, v156
    v_and_b32 v207, 0xffff0000, v156
    v_mul_f32 v144, v206, v108
    v_mul_f32 v145, v207, v109
    s_waitcnt vmcnt(32)
    v_cvt_f32_i32 v104, v56
    v_cvt_f32_i32 v105, v57
    v_cvt_f32_i32 v106, v58
    v_cvt_f32_i32 v107, v59
    buffer_load_dwordx4 v[56:59], v1, s[24:27], s71 offen offset:256 nt
    v_fmac_f32 v200, v124, v104
    v_fmac_f32 v200, v125, v105
    v_fmac_f32 v200, v126, v106
    v_fmac_f32 v200, v127, v107
    v_lshlrev_b32 v206, 16, v162
    v_and_b32 v207, 0xffff0000, v162
    v_mul_f32 v168, v144, v206
    v_fmac_f32 v168, v145, v207
    s_waitcnt vmcnt(32)
    v_cvt_f32_i32 v100, v60
    v_cvt_f32_i32 v101, v61
    v_cvt_f32_i32 v102, v62
    v_cvt_f32_i32 v103, v63
    buffer_load_dwordx4 v[60:63], v1, s[24:27], s71 offen offset:512 nt
    v_fmac_f32 v200, v128, v100
    v_fmac_f32 v200, v129, v101
    v_fmac_f32 v200, v130, v102
    v_fmac_f32 v200, v131, v103
    v_lshlrev_b32 v206, 16, v157
    v_and_b32 v207, 0xffff0000, v157
    v_mul_f32 v146, v206, v110
    v_mul_f32 v147, v207, v111
    s_nop 1
    v_add_f32_dpp v201, v200, v200 row_ror:8 row_mask:0xf bank_mask:0x3
    s_waitcnt vmcnt(32)
    v_cvt_f32_i32 v104, v64
    v_cvt_f32_i32 v105, v65
    v_cvt_f32_i32 v106, v66
    v_cvt_f32_i32 v107, v67
    s_add_u32 s71, s71, 3072
    buffer_load_dwordx4 v[64:67], v1, s[24:27], s71 offen offset:0 nt
    v_fma_f32 v200, v120, v104, -v191
    v_fmac_f32 v200, v121, v105
    v_fmac_f32 v200, v122, v106
    v_fmac_f32 v200, v123, v107
    v_lshlrev_b32 v206, 16, v163
    v_and_b32 v207, 0xffff0000, v163
    v_fmac_f32 v168, v146, v206
    v_fmac_f32 v168, v147, v207
    s_waitcnt vmcnt(32)
    v_cvt_f32_i32 v100, v68
    v_cvt_f32_i32 v101, v69
    v_cvt_f32_i32 v102, v70
    v_cvt_f32_i32 v103, v71
    buffer_load_dwordx4 v[68:71], v1, s[24:27], s71 offen offset:256 nt
    v_fmac_f32 v200, v124, v100
    v_fmac_f32 v200, v125, v101
    v_fmac_f32 v200, v126, v102
    v_fmac_f32 v200, v127, v103
    v_lshlrev_b32 v206, 16, v158
    v_and_b32 v207, 0xffff0000, v158
    v_mul_f32 v148, v206, v112
    v_mul_f32 v149, v207, v113
    s_waitcnt vmcnt(32)
    v_cvt_f32_i32 v104, v72
    v_cvt_f32_i32 v105, v73
    v_cvt_f32_i32 v106, v74
    v_cvt_f32_i32 v107, v75
    buffer_load_dwordx4 v[72:75], v1, s[24:27], s71 offen offset:512 nt
    v_fmac_f32 v200, v128, v104
    v_fmac_f32 v200, v129, v105
    v_fmac_f32 v200, v130, v106
    v_fmac_f32 v200, v131, v107
    v_lshlrev_b32 v206, 16, v164
    v_and_b32 v207, 0xffff0000, v164
    v_fmac_f32 v168, v148, v206
    v_fmac_f32 v168, v149, v207
    s_nop 1
    v_add_f32_dpp v201, v200, v200 row_ror:8 row_mask:0xf bank_mask:0xc
    s_nop 1
    v_add_f32_dpp v202, v201, v201 row_shl:4 row_mask:0xf bank_mask:0x5
    s_waitcnt vmcnt(32)
    v_cvt_f32_i32 v100, v76
    v_cvt_f32_i32 v101, v77
    v_cvt_f32_i32 v102, v78
    v_cvt_f32_i32 v103, v79
    s_add_u32 s71, s71, 3072
    buffer_load_dwordx4 v[76:79], v1, s[24:27], s71 offen offset:0 nt
    v_fma_f32 v200, v120, v100, -v191
    v_fmac_f32 v200, v121, v101
    v_fmac_f32 v200, v122, v102
    v_fmac_f32 v200, v123, v103
    v_lshlrev_b32 v206, 16, v159
    v_and_b32 v207, 0xffff0000, v159
    v_mul_f32 v150, v206, v114
    v_mul_f32 v151, v207, v115
    s_waitcnt vmcnt(32)
    v_cvt_f32_i32 v104, v80
    v_cvt_f32_i32 v105, v81
    v_cvt_f32_i32 v106, v82
    v_cvt_f32_i32 v107, v83
    buffer_load_dwordx4 v[80:83], v1, s[24:27], s71 offen offset:256 nt
    v_fmac_f32 v200, v124, v104
    v_fmac_f32 v200, v125, v105
    v_fmac_f32 v200, v126, v106
    v_fmac_f32 v200, v127, v107
    v_lshlrev_b32 v206, 16, v165
    v_and_b32 v207, 0xffff0000, v165
    v_fmac_f32 v168, v150, v206
    v_fmac_f32 v168, v151, v207
    s_waitcnt vmcnt(32)
    v_cvt_f32_i32 v100, v84
    v_cvt_f32_i32 v101, v85
    v_cvt_f32_i32 v102, v86
    v_cvt_f32_i32 v103, v87
    buffer_load_dwordx4 v[84:87], v1, s[24:27], s71 offen offset:512 nt
    v_fmac_f32 v200, v128, v100
    v_fmac_f32 v200, v129, v101
    v_fmac_f32 v200, v130, v102
    v_fmac_f32 v200, v131, v103
    v_lshlrev_b32 v206, 16, v160
    v_and_b32 v207, 0xffff0000, v160
    v_mul_f32 v152, v206, v116
    v_mul_f32 v153, v207, v117
    s_nop 1
    v_add_f32_dpp v201, v200, v200 row_ror:8 row_mask:0xf bank_mask:0x3
    s_waitcnt vmcnt(32)
    v_cvt_f32_i32 v104, v88
    v_cvt_f32_i32 v105, v89
    v_cvt_f32_i32 v106, v90
    v_cvt_f32_i32 v107, v91
    s_add_u32 s71, s71, 3072
    buffer_load_dwordx4 v[88:91], v1, s[24:27], s71 offen offset:0 nt
    v_fma_f32 v200, v120, v104, -v191
    v_fmac_f32 v200, v121, v105
    v_fmac_f32 v200, v122, v106
    v_fmac_f32 v200, v123, v107
    v_lshlrev_b32 v206, 16, v166
    v_and_b32 v207, 0xffff0000, v166
    v_fmac_f32 v168, v152, v206
    v_fmac_f32 v168, v153, v207
    s_waitcnt vmcnt(32)
    v_cvt_f32_i32 v100, v92
    v_cvt_f32_i32 v101, v93
    v_cvt_f32_i32 v102, v94
    v_cvt_f32_i32 v103, v95
    buffer_load_dwordx4 v[92:95], v1, s[24:27], s71 offen offset:256 nt
    v_fmac_f32 v200, v124, v100
    v_fmac_f32 v200, v125, v101
    v_fmac_f32 v200, v126, v102
    v_fmac_f32 v200, v127, v103
    v_lshlrev_b32 v206, 16, v161
    v_and_b32 v207, 0xffff0000, v161
    v_mul_f32 v154, v206, v118
    v_mul_f32 v155, v207, v119
    s_waitcnt vmcnt(32)
    v_cvt_f32_i32 v104, v96
    v_cvt_f32_i32 v105, v97
    v_cvt_f32_i32 v106, v98
    v_cvt_f32_i32 v107, v99
    buffer_load_dwordx4 v[96:99], v1, s[24:27], s71 offen offset:512 nt
    v_fmac_f32 v200, v128, v104
    v_fmac_f32 v200, v129, v105
    v_fmac_f32 v200, v130, v106
    v_fmac_f32 v200, v131, v107
    v_lshlrev_b32 v206, 16, v167
    v_and_b32 v207, 0xffff0000, v167
    v_fmac_f32 v168, v154, v206
    v_fmac_f32 v168, v155, v207
    s_nop 1
    v_add_f32_dpp v201, v200, v200 row_ror:8 row_mask:0xf bank_mask:0xc
    s_nop 1
    v_add_f32_dpp v202, v201, v201 row_shr:4 row_mask:0xf bank_mask:0xa
    s_nop 1
    v_add_f32_dpp v204, v202, v202 quad_perm:[2,3,0,1] row_mask:0xf bank_mask:0xf
    v_cndmask_b32 v204, v203, v204, s[64:65]
    s_nop 1
    v_add_f32_dpp v205, v204, v204 quad_perm:[1,0,3,2] row_mask:0xf bank_mask:0xf
    s_waitcnt vmcnt(32)
    v_cvt_f32_i32 v100, v4
    v_cvt_f32_i32 v101, v5
    v_cvt_f32_i32 v102, v6
    v_cvt_f32_i32 v103, v7
    s_mul_i32 s71, s70, 49152
    s_and_b32 s80, s70, 63
    s_mul_i32 s80, s80, 24576
    s_sub_u32 s71, s71, s80
    buffer_load_dwordx4 v[4:7], v1, s[24:27], s71 offen offset:0 nt
    v_fma_f32 v200, v144, v100, -v168
    v_fmac_f32 v200, v145, v101
    v_fmac_f32 v200, v146, v102
    v_fmac_f32 v200, v147, v103
    s_waitcnt vmcnt(32)
    v_cvt_f32_i32 v104, v8
    v_cvt_f32_i32 v105, v9
    v_cvt_f32_i32 v106, v10
    v_cvt_f32_i32 v107, v11
    buffer_load_dwordx4 v[8:11], v1, s[24:27], s71 offen offset:256 nt
    v_fmac_f32 v200, v148, v104
    v_fmac_f32 v200, v149, v105
    v_fmac_f32 v200, v150, v106
    v_fmac_f32 v200, v151, v107
    s_waitcnt vmcnt(32)
    v_cvt_f32_i32 v100, v12
    v_cvt_f32_i32 v101, v13
    v_cvt_f32_i32 v102, v14
    v_cvt_f32_i32 v103, v15
    buffer_load_dwordx4 v[12:15], v1, s[24:27], s71 offen offset:512 nt
    v_fmac_f32 v200, v152, v100
    v_fmac_f32 v200, v153, v101
    v_fmac_f32 v200, v154, v102
    v_fmac_f32 v200, v155, v103
    s_nop 1
    v_add_f32_dpp v201, v200, v200 row_ror:8 row_mask:0xf bank_mask:0x3
    s_waitcnt vmcnt(32)
    v_cvt_f32_i32 v104, v16
    v_cvt_f32_i32 v105, v17
    v_cvt_f32_i32 v106, v18
    v_cvt_f32_i32 v107, v19
    s_add_u32 s71, s71, 3072
    buffer_load_dwordx4 v[16:19], v1, s[24:27], s71 offen offset:0 nt
    v_fma_f32 v200, v144, v104, -v168
    v_fmac_f32 v200, v145, v105
    v_fmac_f32 v200, v146, v106
    v_fmac_f32 v200, v147, v107
    s_waitcnt vmcnt(32)
    v_cvt_f32_i32 v100, v20
    v_cvt_f32_i32 v101, v21
    v_cvt_f32_i32 v102, v22
    v_cvt_f32_i32 v103, v23
    buffer_load_dwordx4 v[20:23], v1, s[24:27], s71 offen offset:256 nt
    v_fmac_f32 v200, v148, v100
    v_fmac_f32 v200, v149, v101
    v_fmac_f32 v200, v150, v102
    v_fmac_f32 v200, v151, v103
    s_waitcnt vmcnt(32)
    v_cvt_f32_i32 v104, v24
    v_cvt_f32_i32 v105, v25
    v_cvt_f32_i32 v106, v26
    v_cvt_f32_i32 v107, v27
    buffer_load_dwordx4 v[24:27], v1, s[24:27], s71 offen offset:512 nt
    v_fmac_f32 v200, v152, v104
    v_fmac_f32 v200, v153, v105
    v_fmac_f32 v200, v154, v106
    v_fmac_f32 v200, v155, v107
    s_nop 1
    v_add_f32_dpp v201, v200, v200 row_ror:8 row_mask:0xf bank_mask:0xc
    s_nop 1
    v_add_f32_dpp v202, v201, v201 row_shl:4 row_mask:0xf bank_mask:0x5
    s_waitcnt vmcnt(32)
    v_cvt_f32_i32 v100, v28
    v_cvt_f32_i32 v101, v29
    v_cvt_f32_i32 v102, v30
    v_cvt_f32_i32 v103, v31
    s_add_u32 s71, s71, 3072
    buffer_load_dwordx4 v[28:31], v1, s[24:27], s71 offen offset:0 nt
    v_fma_f32 v200, v144, v100, -v168
    v_fmac_f32 v200, v145, v101
    v_fmac_f32 v200, v146, v102
    v_fmac_f32 v200, v147, v103
    s_waitcnt vmcnt(32)
    v_cvt_f32_i32 v104, v32
    v_cvt_f32_i32 v105, v33
    v_cvt_f32_i32 v106, v34
    v_cvt_f32_i32 v107, v35
    buffer_load_dwordx4 v[32:35], v1, s[24:27], s71 offen offset:256 nt
    v_fmac_f32 v200, v148, v104
    v_fmac_f32 v200, v149, v105
    v_fmac_f32 v200, v150, v106
    v_fmac_f32 v200, v151, v107
    s_waitcnt vmcnt(29)
    v_cvt_f32_i32 v100, v36
    v_cvt_f32_i32 v101, v37
    v_cvt_f32_i32 v102, v38
    v_cvt_f32_i32 v103, v39
    buffer_load_dwordx4 v[36:39], v1, s[24:27], s71 offen offset:512 nt
    v_fmac_f32 v200, v152, v100
    v_fmac_f32 v200, v153, v101
    v_fmac_f32 v200, v154, v102
    v_fmac_f32 v200, v155, v103
    v_lshlrev_b32 v108, 16, v170
    v_and_b32 v109, 0xffff0000, v170
    v_lshlrev_b32 v110, 16, v171
    s_nop 1
    v_add_f32_dpp v201, v200, v200 row_ror:8 row_mask:0xf bank_mask:0x3
    s_waitcnt vmcnt(29)
    v_cvt_f32_i32 v104, v40
    v_cvt_f32_i32 v105, v41
    v_cvt_f32_i32 v106, v42
    v_cvt_f32_i32 v107, v43
    s_add_u32 s71, s71, 3072
    buffer_load_dwordx4 v[40:43], v1, s[24:27], s71 offen offset:0 nt
    v_fma_f32 v200, v144, v104, -v168
    v_fmac_f32 v200, v145, v105
    v_fmac_f32 v200, v146, v106
    v_fmac_f32 v200, v147, v107
    v_and_b32 v111, 0xffff0000, v171
    v_lshlrev_b32 v112, 16, v172
    v_and_b32 v113, 0xffff0000, v172
    s_waitcnt vmcnt(29)
    v_cvt_f32_i32 v100, v44
    v_cvt_f32_i32 v101, v45
    v_cvt_f32_i32 v102, v46
    v_cvt_f32_i32 v103, v47
    buffer_load_dwordx4 v[44:47], v1, s[24:27], s71 offen offset:256 nt
    v_fmac_f32 v200, v148, v100
    v_fmac_f32 v200, v149, v101
    v_fmac_f32 v200, v150, v102
    v_fmac_f32 v200, v151, v103
    v_lshlrev_b32 v114, 16, v173
    v_and_b32 v115, 0xffff0000, v173
    v_lshlrev_b32 v116, 16, v174
    s_waitcnt vmcnt(29)
    v_cvt_f32_i32 v104, v48
    v_cvt_f32_i32 v105, v49
    v_cvt_f32_i32 v106, v50
    v_cvt_f32_i32 v107, v51
    buffer_load_dwordx4 v[48:51], v1, s[24:27], s71 offen offset:512 nt
    v_fmac_f32 v200, v152, v104
    v_fmac_f32 v200, v153, v105
    v_fmac_f32 v200, v154, v106
    v_fmac_f32 v200, v155, v107
    v_and_b32 v117, 0xffff0000, v174
    v_lshlrev_b32 v118, 16, v175
    v_and_b32 v119, 0xffff0000, v175
    s_nop 1
    v_add_f32_dpp v201, v200, v200 row_ror:8 row_mask:0xf bank_mask:0xc
    s_nop 1
    v_add_f32_dpp v202, v201, v201 row_shr:4 row_mask:0xf bank_mask:0xa
    s_nop 1
    v_add_f32_dpp v203, v202, v202 quad_perm:[2,3,0,1] row_mask:0xf bank_mask:0xf
    s_waitcnt vmcnt(23)
    v_cvt_f32_i32 v100, v52
    v_cvt_f32_i32 v101, v53
    v_cvt_f32_i32 v102, v54
    v_cvt_f32_i32 v103, v55
    s_add_u32 s72, s72, 12288
    buffer_load_dwordx2 v[156:157], v2, s[32:35], s72 offen offset:0
    buffer_load_dwordx2 v[158:159], v2, s[32:35], s72 offen offset:128
    buffer_load_dwordx2 v[160:161], v2, s[32:35], s72 offen offset:256
    buffer_load_dwordx2 v[162:163], v2, s[36:39], s72 offen offset:0
    buffer_load_dwordx2 v[164:165], v2, s[36:39], s72 offen offset:128
    buffer_load_dwordx2 v[166:167], v2, s[36:39], s72 offen offset:256
    s_add_u32 s71, s71, 3072
    buffer_load_dwordx4 v[52:55], v1, s[24:27], s71 offen offset:0 nt
    v_fma_f32 v200, v144, v100, -v168
    v_fmac_f32 v200, v145, v101
    v_fmac_f32 v200, v146, v102
    v_fmac_f32 v200, v147, v103
    v_lshlrev_b32 v206, 16, v132
    v_and_b32 v207, 0xffff0000, v132
    v_mul_f32 v120, v206, v108
    v_mul_f32 v121, v207, v109
    s_waitcnt vmcnt(29)
    v_cvt_f32_i32 v104, v56
    v_cvt_f32_i32 v105, v57
    v_cvt_f32_i32 v106, v58
    v_cvt_f32_i32 v107, v59
    buffer_load_dwordx4 v[56:59], v1, s[24:27], s71 offen offset:256 nt
    v_fmac_f32 v200, v148, v104
    v_fmac_f32 v200, v149, v105
    v_fmac_f32 v200, v150, v106
    v_fmac_f32 v200, v151, v107
    v_lshlrev_b32 v206, 16, v138
    v_and_b32 v207, 0xffff0000, v138
    v_mul_f32 v191, v120, v206
    v_fmac_f32 v191, v121, v207
    s_waitcnt vmcnt(29)
    v_cvt_f32_i32 v100, v60
    v_cvt_f32_i32 v101, v61
    v_cvt_f32_i32 v102, v62
    v_cvt_f32_i32 v103, v63
    buffer_load_dwordx4 v[60:63], v1, s[24:27], s71 offen offset:512 nt
    v_fmac_f32 v200, v152, v100
    v_fmac_f32 v200, v153, v101
    v_fmac_f32 v200, v154, v102
    v_fmac_f32 v200, v155, v103
    v_lshlrev_b32 v206, 16, v133
    v_and_b32 v207, 0xffff0000, v133
    v_mul_f32 v122, v206, v110
    v_mul_f32 v123, v207, v111
    s_nop 1
    v_add_f32_dpp v201, v200, v200 row_ror:8 row_mask:0xf bank_mask:0x3
    s_waitcnt vmcnt(29)
    v_cvt_f32_i32 v104, v64
    v_cvt_f32_i32 v105, v65
    v_cvt_f32_i32 v106, v66
    v_cvt_f32_i32 v107, v67
    s_add_u32 s71, s71, 3072
    buffer_load_dwordx4 v[64:67], v1, s[24:27], s71 offen offset:0 nt
    v_fma_f32 v200, v144, v104, -v168
    v_fmac_f32 v200, v145, v105
    v_fmac_f32 v200, v146, v106
    v_fmac_f32 v200, v147, v107
    v_lshlrev_b32 v206, 16, v139
    v_and_b32 v207, 0xffff0000, v139
    v_fmac_f32 v191, v122, v206
    v_fmac_f32 v191, v123, v207
    s_waitcnt vmcnt(29)
    v_cvt_f32_i32 v100, v68
    v_cvt_f32_i32 v101, v69
    v_cvt_f32_i32 v102, v70
    v_cvt_f32_i32 v103, v71
    buffer_load_dwordx4 v[68:71], v1, s[24:27], s71 offen offset:256 nt
    v_fmac_f32 v200, v148, v100
    v_fmac_f32 v200, v149, v101
    v_fmac_f32 v200, v150, v102
    v_fmac_f32 v200, v151, v103
    v_lshlrev_b32 v206, 16, v134
    v_and_b32 v207, 0xffff0000, v134
    v_mul_f32 v124, v206, v112
    v_mul_f32 v125, v207, v113
    s_waitcnt vmcnt(29)
    v_cvt_f32_i32 v104, v72
    v_cvt_f32_i32 v105, v73
    v_cvt_f32_i32 v106, v74
    v_cvt_f32_i32 v107, v75
    buffer_load_dwordx4 v[72:75], v1, s[24:27], s71 offen offset:512 nt
    v_fmac_f32 v200, v152, v104
    v_fmac_f32 v200, v153, v105
    v_fmac_f32 v200, v154, v106
    v_fmac_f32 v200, v155, v107
    v_lshlrev_b32 v206, 16, v140
    v_and_b32 v207, 0xffff0000, v140
    v_fmac_f32 v191, v124, v206
    v_fmac_f32 v191, v125, v207
    s_nop 1
    v_add_f32_dpp v201, v200, v200 row_ror:8 row_mask:0xf bank_mask:0xc
    s_nop 1
    v_add_f32_dpp v202, v201, v201 row_shl:4 row_mask:0xf bank_mask:0x5
    s_waitcnt vmcnt(29)
    v_cvt_f32_i32 v100, v76
    v_cvt_f32_i32 v101, v77
    v_cvt_f32_i32 v102, v78
    v_cvt_f32_i32 v103, v79
    s_add_u32 s71, s71, 3072
    buffer_load_dwordx4 v[76:79], v1, s[24:27], s71 offen offset:0 nt
    v_fma_f32 v200, v144, v100, -v168
    v_fmac_f32 v200, v145, v101
    v_fmac_f32 v200, v146, v102
    v_fmac_f32 v200, v147, v103
    v_lshlrev_b32 v206, 16, v135
    v_and_b32 v207, 0xffff0000, v135
    v_mul_f32 v126, v206, v114
    v_mul_f32 v127, v207, v115
    s_waitcnt vmcnt(29)
    v_cvt_f32_i32 v104, v80
    v_cvt_f32_i32 v105, v81
    v_cvt_f32_i32 v106, v82
    v_cvt_f32_i32 v107, v83
    buffer_load_dwordx4 v[80:83], v1, s[24:27], s71 offen offset:256 nt
    v_fmac_f32 v200, v148, v104
    v_fmac_f32 v200, v149, v105
    v_fmac_f32 v200, v150, v106
    v_fmac_f32 v200, v151, v107
    v_lshlrev_b32 v206, 16, v141
    v_and_b32 v207, 0xffff0000, v141
    v_fmac_f32 v191, v126, v206
    v_fmac_f32 v191, v127, v207
    s_waitcnt vmcnt(29)
    v_cvt_f32_i32 v100, v84
    v_cvt_f32_i32 v101, v85
    v_cvt_f32_i32 v102, v86
    v_cvt_f32_i32 v103, v87
    buffer_load_dwordx4 v[84:87], v1, s[24:27], s71 offen offset:512 nt
    v_fmac_f32 v200, v152, v100
    v_fmac_f32 v200, v153, v101
    v_fmac_f32 v200, v154, v102
    v_fmac_f32 v200, v155, v103
    v_lshlrev_b32 v206, 16, v136
    v_and_b32 v207, 0xffff0000, v136
    v_mul_f32 v128, v206, v116
    v_mul_f32 v129, v207, v117
    s_nop 1
    v_add_f32_dpp v201, v200, v200 row_ror:8 row_mask:0xf bank_mask:0x3
    s_waitcnt vmcnt(29)
    v_cvt_f32_i32 v104, v88
    v_cvt_f32_i32 v105, v89
    v_cvt_f32_i32 v106, v90
    v_cvt_f32_i32 v107, v91
    s_add_u32 s71, s71, 3072
    buffer_load_dwordx4 v[88:91], v1, s[24:27], s71 offen offset:0 nt
    v_fma_f32 v200, v144, v104, -v168
    v_fmac_f32 v200, v145, v105
    v_fmac_f32 v200, v146, v106
    v_fmac_f32 v200, v147, v107
    v_lshlrev_b32 v206, 16, v142
    v_and_b32 v207, 0xffff0000, v142
    v_fmac_f32 v191, v128, v206
    v_fmac_f32 v191, v129, v207
    s_waitcnt vmcnt(29)
    v_cvt_f32_i32 v100, v92
    v_cvt_f32_i32 v101, v93
    v_cvt_f32_i32 v102, v94
    v_cvt_f32_i32 v103, v95
    buffer_load_dwordx4 v[92:95], v1, s[24:27], s71 offen offset:256 nt
    v_fmac_f32 v200, v148, v100
    v_fmac_f32 v200, v149, v101
    v_fmac_f32 v200, v150, v102
    v_fmac_f32 v200, v151, v103
    v_lshlrev_b32 v206, 16, v137
    v_and_b32 v207, 0xffff0000, v137
    v_mul_f32 v130, v206, v118
    v_mul_f32 v131, v207, v119
    s_waitcnt vmcnt(29)
    v_cvt_f32_i32 v104, v96
    v_cvt_f32_i32 v105, v97
    v_cvt_f32_i32 v106, v98
    v_cvt_f32_i32 v107, v99
    buffer_load_dwordx4 v[96:99], v1, s[24:27], s71 offen offset:512 nt
    v_fmac_f32 v200, v152, v104
    v_fmac_f32 v200, v153, v105
    v_fmac_f32 v200, v154, v106
    v_fmac_f32 v200, v155, v107
    v_lshlrev_b32 v206, 16, v143
    v_and_b32 v207, 0xffff0000, v143
    v_fmac_f32 v191, v130, v206
    v_fmac_f32 v191, v131, v207
    s_nop 1
    v_add_f32_dpp v201, v200, v200 row_ror:8 row_mask:0xf bank_mask:0xc
    s_nop 1
    v_add_f32_dpp v202, v201, v201 row_shr:4 row_mask:0xf bank_mask:0xa
    s_nop 1
    v_add_f32_dpp v204, v202, v202 quad_perm:[2,3,0,1] row_mask:0xf bank_mask:0xf
    v_cndmask_b32 v204, v203, v204, s[64:65]
    s_nop 1
    v_add_f32_dpp v203, v204, v204 quad_perm:[1,0,3,2] row_mask:0xf bank_mask:0xf
    v_cndmask_b32 v205, v205, v203, s[66:67]
    v_mul_f32 v205, s78, v205
    ds_write_b32 v208, v205
    v_add_u32 v208, 256, v208
    s_sub_u32 s76, s76, 1
    s_cmp_lg_u32 s76, 0
    s_cbranch_scc1 L_loop0
    s_waitcnt vmcnt(29)
    v_cvt_f32_i32 v100, v4
    v_cvt_f32_i32 v101, v5
    v_cvt_f32_i32 v102, v6
    v_cvt_f32_i32 v103, v7
    s_add_u32 s71, s71, 1551360
    buffer_load_dwordx4 v[4:7], v1, s[24:27], s71 offen offset:0 nt
    v_fma_f32 v200, v120, v100, -v191
    v_fmac_f32 v200, v121, v101
    v_fmac_f32 v200, v122, v102
    v_fmac_f32 v200, v123, v103
    s_waitcnt vmcnt(29)
    v_cvt_f32_i32 v104, v8
    v_cvt_f32_i32 v105, v9
    v_cvt_f32_i32 v106, v10
    v_cvt_f32_i32 v107, v11
    buffer_load_dwordx4 v[8:11], v1, s[24:27], s71 offen offset:256 nt
    v_fmac_f32 v200, v124, v104
    v_fmac_f32 v200, v125, v105
    v_fmac_f32 v200, v126, v106
    v_fmac_f32 v200, v127, v107
    s_waitcnt vmcnt(29)
    v_cvt_f32_i32 v100, v12
    v_cvt_f32_i32 v101, v13
    v_cvt_f32_i32 v102, v14
    v_cvt_f32_i32 v103, v15
    buffer_load_dwordx4 v[12:15], v1, s[24:27], s71 offen offset:512 nt
    v_fmac_f32 v200, v128, v100
    v_fmac_f32 v200, v129, v101
    v_fmac_f32 v200, v130, v102
    v_fmac_f32 v200, v131, v103
    s_nop 1
    v_add_f32_dpp v201, v200, v200 row_ror:8 row_mask:0xf bank_mask:0x3
    s_waitcnt vmcnt(29)
    v_cvt_f32_i32 v104, v16
    v_cvt_f32_i32 v105, v17
    v_cvt_f32_i32 v106, v18
    v_cvt_f32_i32 v107, v19
    s_add_u32 s71, s71, 3072
    buffer_load_dwordx4 v[16:19], v1, s[24:27], s71 offen offset:0 nt
    v_fma_f32 v200, v120, v104, -v191
    v_fmac_f32 v200, v121, v105
    v_fmac_f32 v200, v122, v106
    v_fmac_f32 v200, v123, v107
    s_waitcnt vmcnt(29)
    v_cvt_f32_i32 v100, v20
    v_cvt_f32_i32 v101, v21
    v_cvt_f32_i32 v102, v22
    v_cvt_f32_i32 v103, v23
    buffer_load_dwordx4 v[20:23], v1, s[24:27], s71 offen offset:256 nt
    v_fmac_f32 v200, v124, v100
    v_fmac_f32 v200, v125, v101
    v_fmac_f32 v200, v126, v102
    v_fmac_f32 v200, v127, v103
    s_waitcnt vmcnt(29)
    v_cvt_f32_i32 v104, v24
    v_cvt_f32_i32 v105, v25
    v_cvt_f32_i32 v106, v26
    v_cvt_f32_i32 v107, v27
    buffer_load_dwordx4 v[24:27], v1, s[24:27], s71 offen offset:512 nt
    v_fmac_f32 v200, v128, v104
    v_fmac_f32 v200, v129, v105
    v_fmac_f32 v200, v130, v106
    v_fmac_f32 v200, v131, v107
    s_nop 1
    v_add_f32_dpp v201, v200, v200 row_ror:8 row_mask:0xf bank_mask:0xc
    s_nop 1
    v_add_f32_dpp v202, v201, v201 row_shl:4 row_mask:0xf bank_mask:0x5
    s_waitcnt vmcnt(29)
    v_cvt_f32_i32 v100, v28
    v_cvt_f32_i32 v101, v29
    v_cvt_f32_i32 v102, v30
    v_cvt_f32_i32 v103, v31
    s_add_u32 s71, s71, 3072
    buffer_load_dwordx4 v[28:31], v1, s[24:27], s71 offen offset:0 nt
    v_fma_f32 v200, v120, v100, -v191
    v_fmac_f32 v200, v121, v101
    v_fmac_f32 v200, v122, v102
    v_fmac_f32 v200, v123, v103
    s_waitcnt vmcnt(29)
    v_cvt_f32_i32 v104, v32
    v_cvt_f32_i32 v105, v33
    v_cvt_f32_i32 v106, v34
    v_cvt_f32_i32 v107, v35
    buffer_load_dwordx4 v[32:35], v1, s[24:27], s71 offen offset:256 nt
    v_fmac_f32 v200, v124, v104
    v_fmac_f32 v200, v125, v105
    v_fmac_f32 v200, v126, v106
    v_fmac_f32 v200, v127, v107
    s_waitcnt vmcnt(29)
    v_cvt_f32_i32 v100, v36
    v_cvt_f32_i32 v101, v37
    v_cvt_f32_i32 v102, v38
    v_cvt_f32_i32 v103, v39
    buffer_load_dwordx4 v[36:39], v1, s[24:27], s71 offen offset:512 nt
    v_fmac_f32 v200, v128, v100
    v_fmac_f32 v200, v129, v101
    v_fmac_f32 v200, v130, v102
    v_fmac_f32 v200, v131, v103
    s_nop 1
    v_add_f32_dpp v201, v200, v200 row_ror:8 row_mask:0xf bank_mask:0x3
    s_waitcnt vmcnt(29)
    v_cvt_f32_i32 v104, v40
    v_cvt_f32_i32 v105, v41
    v_cvt_f32_i32 v106, v42
    v_cvt_f32_i32 v107, v43
    s_add_u32 s71, s71, 3072
    buffer_load_dwordx4 v[40:43], v1, s[24:27], s71 offen offset:0 nt
    v_fma_f32 v200, v120, v104, -v191
    v_fmac_f32 v200, v121, v105
    v_fmac_f32 v200, v122, v106
    v_fmac_f32 v200, v123, v107
    s_waitcnt vmcnt(29)
    v_cvt_f32_i32 v100, v44
    v_cvt_f32_i32 v101, v45
    v_cvt_f32_i32 v102, v46
    v_cvt_f32_i32 v103, v47
    buffer_load_dwordx4 v[44:47], v1, s[24:27], s71 offen offset:256 nt
    v_fmac_f32 v200, v124, v100
    v_fmac_f32 v200, v125, v101
    v_fmac_f32 v200, v126, v102
    v_fmac_f32 v200, v127, v103
    s_waitcnt vmcnt(29)
    v_cvt_f32_i32 v104, v48
    v_cvt_f32_i32 v105, v49
    v_cvt_f32_i32 v106, v50
    v_cvt_f32_i32 v107, v51
    buffer_load_dwordx4 v[48:51], v1, s[24:27], s71 offen offset:512 nt
    v_fmac_f32 v200, v128, v104
    v_fmac_f32 v200, v129, v105
    v_fmac_f32 v200, v130, v106
    v_fmac_f32 v200, v131, v107
    s_nop 1
    v_add_f32_dpp v201, v200, v200 row_ror:8 row_mask:0xf bank_mask:0xc
    s_nop 1
    v_add_f32_dpp v202, v201, v201 row_shr:4 row_mask:0xf bank_mask:0xa
    s_nop 1
    v_add_f32_dpp v203, v202, v202 quad_perm:[2,3,0,1] row_mask:0xf bank_mask:0xf
    s_waitcnt vmcnt(23)
    v_cvt_f32_i32 v100, v52
    v_cvt_f32_i32 v101, v53
    v_cvt_f32_i32 v102, v54
    v_cvt_f32_i32 v103, v55
    s_add_u32 s71, s71, 3072
    buffer_load_dwordx4 v[52:55], v1, s[24:27], s71 offen offset:0 nt
    v_fma_f32 v200, v120, v100, -v191
    v_fmac_f32 v200, v121, v101
    v_fmac_f32 v200, v122, v102
    v_fmac_f32 v200, v123, v103
    v_lshlrev_b32 v206, 16, v156
    v_and_b32 v207, 0xffff0000, v156
    v_mul_f32 v144, v206, v108
    v_mul_f32 v145, v207, v109
    s_waitcnt vmcnt(23)
    v_cvt_f32_i32 v104, v56
    v_cvt_f32_i32 v105, v57
    v_cvt_f32_i32 v106, v58
    v_cvt_f32_i32 v107, v59
    buffer_load_dwordx4 v[56:59], v1, s[24:27], s71 offen offset:256 nt
    v_fmac_f32 v200, v124, v104
    v_fmac_f32 v200, v125, v105
    v_fmac_f32 v200, v126, v106
    v_fmac_f32 v200, v127, v107
    v_lshlrev_b32 v206, 16, v162
    v_and_b32 v207, 0xffff0000, v162
    v_mul_f32 v168, v144, v206
    v_fmac_f32 v168, v145, v207
    s_waitcnt vmcnt(23)
    v_cvt_f32_i32 v100, v60
    v_cvt_f32_i32 v101, v61
    v_cvt_f32_i32 v102, v62
    v_cvt_f32_i32 v103, v63
    buffer_load_dwordx4 v[60:63], v1, s[24:27], s71 offen offset:512 nt
    v_fmac_f32 v200, v128, v100
    v_fmac_f32 v200, v129, v101
    v_fmac_f32 v200, v130, v102
    v_fmac_f32 v200, v131, v103
    v_lshlrev_b32 v206, 16, v157
    v_and_b32 v207, 0xffff0000, v157
    v_mul_f32 v146, v206, v110
    v_mul_f32 v147, v207, v111
    s_nop 1
    v_add_f32_dpp v201, v200, v200 row_ror:8 row_mask:0xf bank_mask:0x3
    s_waitcnt vmcnt(23)
    v_cvt_f32_i32 v104, v64
    v_cvt_f32_i32 v105, v65
    v_cvt_f32_i32 v106, v66
    v_cvt_f32_i32 v107, v67
    s_add_u32 s71, s71, 3072
    buffer_load_dwordx4 v[64:67], v1, s[24:27], s71 offen offset:0 nt
    v_fma_f32 v200, v120, v104, -v191
    v_fmac_f32 v200, v121, v105
    v_fmac_f32 v200, v122, v106
    v_fmac_f32 v200, v123, v107
    v_lshlrev_b32 v206, 16, v163
    v_and_b32 v207, 0xffff0000, v163
    v_fmac_f32 v168, v146, v206
    v_fmac_f32 v168, v147, v207
    s_waitcnt vmcnt(23)
    v_cvt_f32_i32 v100, v68
    v_cvt_f32_i32 v101, v69
    v_cvt_f32_i32 v102, v70
    v_cvt_f32_i32 v103, v71
    buffer_load_dwordx4 v[68:71], v1, s[24:27], s71 offen offset:256 nt
    v_fmac_f32 v200, v124, v100
    v_fmac_f32 v200, v125, v101
    v_fmac_f32 v200, v126, v102
    v_fmac_f32 v200, v127, v103
    v_lshlrev_b32 v206, 16, v158
    v_and_b32 v207, 0xffff0000, v158
    v_mul_f32 v148, v206, v112
    v_mul_f32 v149, v207, v113
    s_waitcnt vmcnt(23)
    v_cvt_f32_i32 v104, v72
    v_cvt_f32_i32 v105, v73
    v_cvt_f32_i32 v106, v74
    v_cvt_f32_i32 v107, v75
    buffer_load_dwordx4 v[72:75], v1, s[24:27], s71 offen offset:512 nt
    v_fmac_f32 v200, v128, v104
    v_fmac_f32 v200, v129, v105
    v_fmac_f32 v200, v130, v106
    v_fmac_f32 v200, v131, v107
    v_lshlrev_b32 v206, 16, v164
    v_and_b32 v207, 0xffff0000, v164
    v_fmac_f32 v168, v148, v206
    v_fmac_f32 v168, v149, v207
    s_nop 1
    v_add_f32_dpp v201, v200, v200 row_ror:8 row_mask:0xf bank_mask:0xc
    s_nop 1
    v_add_f32_dpp v202, v201, v201 row_shl:4 row_mask:0xf bank_mask:0x5
    s_waitcnt vmcnt(23)
    v_cvt_f32_i32 v100, v76
    v_cvt_f32_i32 v101, v77
    v_cvt_f32_i32 v102, v78
    v_cvt_f32_i32 v103, v79
    s_add_u32 s71, s71, 3072
    buffer_load_dwordx4 v[76:79], v1, s[24:27], s71 offen offset:0 nt
    v_fma_f32 v200, v120, v100, -v191
    v_fmac_f32 v200, v121, v101
    v_fmac_f32 v200, v122, v102
    v_fmac_f32 v200, v123, v103
    v_lshlrev_b32 v206, 16, v159
    v_and_b32 v207, 0xffff0000, v159
    v_mul_f32 v150, v206, v114
    v_mul_f32 v151, v207, v115
    s_waitcnt vmcnt(23)
    v_cvt_f32_i32 v104, v80
    v_cvt_f32_i32 v105, v81
    v_cvt_f32_i32 v106, v82
    v_cvt_f32_i32 v107, v83
    buffer_load_dwordx4 v[80:83], v1, s[24:27], s71 offen offset:256 nt
    v_fmac_f32 v200, v124, v104
    v_fmac_f32 v200, v125, v105
    v_fmac_f32 v200, v126, v106
    v_fmac_f32 v200, v127, v107
    v_lshlrev_b32 v206, 16, v165
    v_and_b32 v207, 0xffff0000, v165
    v_fmac_f32 v168, v150, v206
    v_fmac_f32 v168, v151, v207
    s_waitcnt vmcnt(23)
    v_cvt_f32_i32 v100, v84
    v_cvt_f32_i32 v101, v85
    v_cvt_f32_i32 v102, v86
    v_cvt_f32_i32 v103, v87
    buffer_load_dwordx4 v[84:87], v1, s[24:27], s71 offen offset:512 nt
    v_fmac_f32 v200, v128, v100
    v_fmac_f32 v200, v129, v101
    v_fmac_f32 v200, v130, v102
    v_fmac_f32 v200, v131, v103
    v_lshlrev_b32 v206, 16, v160
    v_and_b32 v207, 0xffff0000, v160
    v_mul_f32 v152, v206, v116
    v_mul_f32 v153, v207, v117
    s_nop 1
    v_add_f32_dpp v201, v200, v200 row_ror:8 row_mask:0xf bank_mask:0x3
    s_waitcnt vmcnt(23)
    v_cvt_f32_i32 v104, v88
    v_cvt_f32_i32 v105, v89
    v_cvt_f32_i32 v106, v90
    v_cvt_f32_i32 v107, v91
    s_add_u32 s71, s71, 3072
    buffer_load_dwordx4 v[88:91], v1, s[24:27], s71 offen offset:0 nt
    v_fma_f32 v200, v120, v104, -v191
    v_fmac_f32 v200, v121, v105
    v_fmac_f32 v200, v122, v106
    v_fmac_f32 v200, v123, v107
    v_lshlrev_b32 v206, 16, v166
    v_and_b32 v207, 0xffff0000, v166
    v_fmac_f32 v168, v152, v206
    v_fmac_f32 v168, v153, v207
    s_waitcnt vmcnt(23)
    v_cvt_f32_i32 v100, v92
    v_cvt_f32_i32 v101, v93
    v_cvt_f32_i32 v102, v94
    v_cvt_f32_i32 v103, v95
    buffer_load_dwordx4 v[92:95], v1, s[24:27], s71 offen offset:256 nt
    v_fmac_f32 v200, v124, v100
    v_fmac_f32 v200, v125, v101
    v_fmac_f32 v200, v126, v102
    v_fmac_f32 v200, v127, v103
    v_lshlrev_b32 v206, 16, v161
    v_and_b32 v207, 0xffff0000, v161
    v_mul_f32 v154, v206, v118
    v_mul_f32 v155, v207, v119
    s_waitcnt vmcnt(23)
    v_cvt_f32_i32 v104, v96
    v_cvt_f32_i32 v105, v97
    v_cvt_f32_i32 v106, v98
    v_cvt_f32_i32 v107, v99
    buffer_load_dwordx4 v[96:99], v1, s[24:27], s71 offen offset:512 nt
    v_fmac_f32 v200, v128, v104
    v_fmac_f32 v200, v129, v105
    v_fmac_f32 v200, v130, v106
    v_fmac_f32 v200, v131, v107
    v_lshlrev_b32 v206, 16, v167
    v_and_b32 v207, 0xffff0000, v167
    v_fmac_f32 v168, v154, v206
    v_fmac_f32 v168, v155, v207
    s_nop 1
    v_add_f32_dpp v201, v200, v200 row_ror:8 row_mask:0xf bank_mask:0xc
    s_nop 1
    v_add_f32_dpp v202, v201, v201 row_shr:4 row_mask:0xf bank_mask:0xa
    s_nop 1
    v_add_f32_dpp v204, v202, v202 quad_perm:[2,3,0,1] row_mask:0xf bank_mask:0xf
    v_cndmask_b32 v204, v203, v204, s[64:65]
    s_nop 1
    v_add_f32_dpp v205, v204, v204 quad_perm:[1,0,3,2] row_mask:0xf bank_mask:0xf
    s_waitcnt vmcnt(23)
    v_cvt_f32_i32 v100, v4
    v_cvt_f32_i32 v101, v5
    v_cvt_f32_i32 v102, v6
    v_cvt_f32_i32 v103, v7
    s_mov_b32 s57, s69
    s_mov_b32 s56, s58
    s_mov_b32 s75, 8
    s_add_u32 s70, s57, s56
    s_mov_b32 s91, -56
    s_and_b32 s80, s70, 63
    s_mul_i32 s80, s80, 64
    s_lshl_b32 s73, s70, 7
    s_sub_u32 s73, s73, s80
    buffer_load_ushort v192, v3, s[40:43], s73 offen
    buffer_load_ushort v193, v3, s[44:47], s73 offen
    s_mul_i32 s71, s70, 49152
    s_and_b32 s80, s70, 63
    s_mul_i32 s80, s80, 24576
    s_sub_u32 s71, s71, s80
    buffer_load_dwordx4 v[4:7], v1, s[28:31], s71 offen offset:0 nt
    v_fma_f32 v200, v144, v100, -v168
    v_fmac_f32 v200, v145, v101
    v_fmac_f32 v200, v146, v102
    v_fmac_f32 v200, v147, v103
    s_waitcnt vmcnt(25)
    v_cvt_f32_i32 v104, v8
    v_cvt_f32_i32 v105, v9
    v_cvt_f32_i32 v106, v10
    v_cvt_f32_i32 v107, v11
    buffer_load_dwordx4 v[8:11], v1, s[28:31], s71 offen offset:256 nt
    v_fmac_f32 v200, v148, v104
    v_fmac_f32 v200, v149, v105
    v_fmac_f32 v200, v150, v106
    v_fmac_f32 v200, v151, v107
    s_waitcnt vmcnt(25)
    v_cvt_f32_i32 v100, v12
    v_cvt_f32_i32 v101, v13
    v_cvt_f32_i32 v102, v14
    v_cvt_f32_i32 v103, v15
    buffer_load_dwordx4 v[12:15], v1, s[28:31], s71 offen offset:512 nt
    v_fmac_f32 v200, v152, v100
    v_fmac_f32 v200, v153, v101
    v_fmac_f32 v200, v154, v102
    v_fmac_f32 v200, v155, v103
    s_nop 1
    v_add_f32_dpp v201, v200, v200 row_ror:8 row_mask:0xf bank_mask:0x3
    s_waitcnt vmcnt(25)
    v_cvt_f32_i32 v104, v16
    v_cvt_f32_i32 v105, v17
    v_cvt_f32_i32 v106, v18
    v_cvt_f32_i32 v107, v19
    s_add_u32 s71, s71, 3072
    buffer_load_dwordx4 v[16:19], v1, s[28:31], s71 offen offset:0 nt
    v_fma_f32 v200, v144, v104, -v168
    v_fmac_f32 v200, v145, v105
    v_fmac_f32 v200, v146, v106
    v_fmac_f32 v200, v147, v107
    s_waitcnt vmcnt(25)
    v_cvt_f32_i32 v100, v20
    v_cvt_f32_i32 v101, v21
    v_cvt_f32_i32 v102, v22
    v_cvt_f32_i32 v103, v23
    buffer_load_dwordx4 v[20:23], v1, s[28:31], s71 offen offset:256 nt
    v_fmac_f32 v200, v148, v100
    v_fmac_f32 v200, v149, v101
    v_fmac_f32 v200, v150, v102
    v_fmac_f32 v200, v151, v103
    s_waitcnt vmcnt(25)
    v_cvt_f32_i32 v104, v24
    v_cvt_f32_i32 v105, v25
    v_cvt_f32_i32 v106, v26
    v_cvt_f32_i32 v107, v27
    buffer_load_dwordx4 v[24:27], v1, s[28:31], s71 offen offset:512 nt
    v_fmac_f32 v200, v152, v104
    v_fmac_f32 v200, v153, v105
    v_fmac_f32 v200, v154, v106
    v_fmac_f32 v200, v155, v107
    s_nop 1
    v_add_f32_dpp v201, v200, v200 row_ror:8 row_mask:0xf bank_mask:0xc
    s_nop 1
    v_add_f32_dpp v202, v201, v201 row_shl:4 row_mask:0xf bank_mask:0x5
    s_waitcnt vmcnt(25)
    v_cvt_f32_i32 v100, v28
    v_cvt_f32_i32 v101, v29
    v_cvt_f32_i32 v102, v30
    v_cvt_f32_i32 v103, v31
    s_add_u32 s71, s71, 3072
    buffer_load_dwordx4 v[28:31], v1, s[28:31], s71 offen offset:0 nt
    v_fma_f32 v200, v144, v100, -v168
    v_fmac_f32 v200, v145, v101
    v_fmac_f32 v200, v146, v102
    v_fmac_f32 v200, v147, v103
    s_waitcnt vmcnt(25)
    v_cvt_f32_i32 v104, v32
    v_cvt_f32_i32 v105, v33
    v_cvt_f32_i32 v106, v34
    v_cvt_f32_i32 v107, v35
    buffer_load_dwordx4 v[32:35], v1, s[28:31], s71 offen offset:256 nt
    v_fmac_f32 v200, v148, v104
    v_fmac_f32 v200, v149, v105
    v_fmac_f32 v200, v150, v106
    v_fmac_f32 v200, v151, v107
    s_waitcnt vmcnt(25)
    v_cvt_f32_i32 v100, v36
    v_cvt_f32_i32 v101, v37
    v_cvt_f32_i32 v102, v38
    v_cvt_f32_i32 v103, v39
    buffer_load_dwordx4 v[36:39], v1, s[28:31], s71 offen offset:512 nt
    v_fmac_f32 v200, v152, v100
    v_fmac_f32 v200, v153, v101
    v_fmac_f32 v200, v154, v102
    v_fmac_f32 v200, v155, v103
    s_nop 1
    v_add_f32_dpp v201, v200, v200 row_ror:8 row_mask:0xf bank_mask:0x3
    s_waitcnt vmcnt(25)
    v_cvt_f32_i32 v104, v40
    v_cvt_f32_i32 v105, v41
    v_cvt_f32_i32 v106, v42
    v_cvt_f32_i32 v107, v43
    s_add_u32 s71, s71, 3072
    buffer_load_dwordx4 v[40:43], v1, s[28:31], s71 offen offset:0 nt
    v_fma_f32 v200, v144, v104, -v168
    v_fmac_f32 v200, v145, v105
    v_fmac_f32 v200, v146, v106
    v_fmac_f32 v200, v147, v107
    s_waitcnt vmcnt(25)
    v_cvt_f32_i32 v100, v44
    v_cvt_f32_i32 v101, v45
    v_cvt_f32_i32 v102, v46
    v_cvt_f32_i32 v103, v47
    buffer_load_dwordx4 v[44:47], v1, s[28:31], s71 offen offset:256 nt
    v_fmac_f32 v200, v148, v100
    v_fmac_f32 v200, v149, v101
    v_fmac_f32 v200, v150, v102
    v_fmac_f32 v200, v151, v103
    s_waitcnt vmcnt(25)
    v_cvt_f32_i32 v104, v48
    v_cvt_f32_i32 v105, v49
    v_cvt_f32_i32 v106, v50
    v_cvt_f32_i32 v107, v51
    buffer_load_dwordx4 v[48:51], v1, s[28:31], s71 offen offset:512 nt
    v_fmac_f32 v200, v152, v104
    v_fmac_f32 v200, v153, v105
    v_fmac_f32 v200, v154, v106
    v_fmac_f32 v200, v155, v107
    s_nop 1
    v_add_f32_dpp v201, v200, v200 row_ror:8 row_mask:0xf bank_mask:0xc
    s_nop 1
    v_add_f32_dpp v202, v201, v201 row_shr:4 row_mask:0xf bank_mask:0xa
    s_nop 1
    v_add_f32_dpp v203, v202, v202 quad_perm:[2,3,0,1] row_mask:0xf bank_mask:0xf
    s_waitcnt vmcnt(25)
    v_cvt_f32_i32 v100, v52
    v_cvt_f32_i32 v101, v53
    v_cvt_f32_i32 v102, v54
    v_cvt_f32_i32 v103, v55
    s_add_u32 s71, s71, 3072
    buffer_load_dwordx4 v[52:55], v1, s[28:31], s71 offen offset:0 nt
    v_fma_f32 v200, v144, v100, -v168
    v_fmac_f32 v200, v145, v101
    v_fmac_f32 v200, v146, v102
    v_fmac_f32 v200, v147, v103
    s_waitcnt vmcnt(25)
    v_cvt_f32_i32 v104, v56
    v_cvt_f32_i32 v105, v57
    v_cvt_f32_i32 v106, v58
    v_cvt_f32_i32 v107, v59
    buffer_load_dwordx4 v[56:59], v1, s[28:31], s71 offen offset:256 nt
    v_fmac_f32 v200, v148, v104
    v_fmac_f32 v200, v149, v105
    v_fmac_f32 v200, v150, v106
    v_fmac_f32 v200, v151, v107
    s_waitcnt vmcnt(25)
    v_cvt_f32_i32 v100, v60
    v_cvt_f32_i32 v101, v61
    v_cvt_f32_i32 v102, v62
    v_cvt_f32_i32 v103, v63
    buffer_load_dwordx4 v[60:63], v1, s[28:31], s71 offen offset:512 nt
    v_fmac_f32 v200, v152, v100
    v_fmac_f32 v200, v153, v101
    v_fmac_f32 v200, v154, v102
    v_fmac_f32 v200, v155, v103
    s_nop 1
    v_add_f32_dpp v201, v200, v200 row_ror:8 row_mask:0xf bank_mask:0x3
    s_waitcnt vmcnt(25)
    v_cvt_f32_i32 v104, v64
    v_cvt_f32_i32 v105, v65
    v_cvt_f32_i32 v106, v66
    v_cvt_f32_i32 v107, v67
    s_add_u32 s71, s71, 3072
    buffer_load_dwordx4 v[64:67], v1, s[28:31], s71 offen offset:0 nt
    v_fma_f32 v200, v144, v104, -v168
    v_fmac_f32 v200, v145, v105
    v_fmac_f32 v200, v146, v106
    v_fmac_f32 v200, v147, v107
    s_waitcnt vmcnt(25)
    v_cvt_f32_i32 v100, v68
    v_cvt_f32_i32 v101, v69
    v_cvt_f32_i32 v102, v70
    v_cvt_f32_i32 v103, v71
    buffer_load_dwordx4 v[68:71], v1, s[28:31], s71 offen offset:256 nt
    v_fmac_f32 v200, v148, v100
    v_fmac_f32 v200, v149, v101
    v_fmac_f32 v200, v150, v102
    v_fmac_f32 v200, v151, v103
    s_waitcnt vmcnt(25)
    v_cvt_f32_i32 v104, v72
    v_cvt_f32_i32 v105, v73
    v_cvt_f32_i32 v106, v74
    v_cvt_f32_i32 v107, v75
    buffer_load_dwordx4 v[72:75], v1, s[28:31], s71 offen offset:512 nt
    v_fmac_f32 v200, v152, v104
    v_fmac_f32 v200, v153, v105
    v_fmac_f32 v200, v154, v106
    v_fmac_f32 v200, v155, v107
    s_nop 1
    v_add_f32_dpp v201, v200, v200 row_ror:8 row_mask:0xf bank_mask:0xc
    s_nop 1
    v_add_f32_dpp v202, v201, v201 row_shl:4 row_mask:0xf bank_mask:0x5
    s_waitcnt vmcnt(25)
    v_cvt_f32_i32 v100, v76
    v_cvt_f32_i32 v101, v77
    v_cvt_f32_i32 v102, v78
    v_cvt_f32_i32 v103, v79
    s_add_u32 s71, s71, 3072
    buffer_load_dwordx4 v[76:79], v1, s[28:31], s71 offen offset:0 nt
    v_fma_f32 v200, v144, v100, -v168
    v_fmac_f32 v200, v145, v101
    v_fmac_f32 v200, v146, v102
    v_fmac_f32 v200, v147, v103
    s_waitcnt vmcnt(25)
    v_cvt_f32_i32 v104, v80
    v_cvt_f32_i32 v105, v81
    v_cvt_f32_i32 v106, v82
    v_cvt_f32_i32 v107, v83
    buffer_load_dwordx4 v[80:83], v1, s[28:31], s71 offen offset:256 nt
    v_fmac_f32 v200, v148, v104
    v_fmac_f32 v200, v149, v105
    v_fmac_f32 v200, v150, v106
    v_fmac_f32 v200, v151, v107
    s_waitcnt vmcnt(25)
    v_cvt_f32_i32 v100, v84
    v_cvt_f32_i32 v101, v85
    v_cvt_f32_i32 v102, v86
    v_cvt_f32_i32 v103, v87
    buffer_load_dwordx4 v[84:87], v1, s[28:31], s71 offen offset:512 nt
    v_fmac_f32 v200, v152, v100
    v_fmac_f32 v200, v153, v101
    v_fmac_f32 v200, v154, v102
    v_fmac_f32 v200, v155, v103
    s_nop 1
    v_add_f32_dpp v201, v200, v200 row_ror:8 row_mask:0xf bank_mask:0x3
    s_waitcnt vmcnt(25)
    v_cvt_f32_i32 v104, v88
    v_cvt_f32_i32 v105, v89
    v_cvt_f32_i32 v106, v90
    v_cvt_f32_i32 v107, v91
    s_add_u32 s71, s71, 3072
    buffer_load_dwordx4 v[88:91], v1, s[28:31], s71 offen offset:0 nt
    v_fma_f32 v200, v144, v104, -v168
    v_fmac_f32 v200, v145, v105
    v_fmac_f32 v200, v146, v106
    v_fmac_f32 v200, v147, v107
    s_waitcnt vmcnt(25)
    v_cvt_f32_i32 v100, v92
    v_cvt_f32_i32 v101, v93
    v_cvt_f32_i32 v102, v94
    v_cvt_f32_i32 v103, v95
    buffer_load_dwordx4 v[92:95], v1, s[28:31], s71 offen offset:256 nt
    v_fmac_f32 v200, v148, v100
    v_fmac_f32 v200, v149, v101
    v_fmac_f32 v200, v150, v102
    v_fmac_f32 v200, v151, v103
    s_waitcnt vmcnt(25)
    v_cvt_f32_i32 v104, v96
    v_cvt_f32_i32 v105, v97
    v_cvt_f32_i32 v106, v98
    v_cvt_f32_i32 v107, v99
    buffer_load_dwordx4 v[96:99], v1, s[28:31], s71 offen offset:512 nt
    v_fmac_f32 v200, v152, v104
    v_fmac_f32 v200, v153, v105
    v_fmac_f32 v200, v154, v106
    v_fmac_f32 v200, v155, v107
    s_nop 1
    v_add_f32_dpp v201, v200, v200 row_ror:8 row_mask:0xf bank_mask:0xc
    s_nop 1
    v_add_f32_dpp v202, v201, v201 row_shr:4 row_mask:0xf bank_mask:0xa
    s_nop 1
    v_add_f32_dpp v204, v202, v202 quad_perm:[2,3,0,1] row_mask:0xf bank_mask:0xf
    v_cndmask_b32 v204, v203, v204, s[64:65]
    s_nop 1
    v_add_f32_dpp v203, v204, v204 quad_perm:[1,0,3,2] row_mask:0xf bank_mask:0xf
    v_cndmask_b32 v205, v205, v203, s[66:67]
    v_mul_f32 v205, s78, v205
    ds_write_b32 v208, v205
    v_add_u32 v208, 256, v208
    s_mov_b64 exec, 1
    ds_add_u32 v212, v212 offset:127
    s_mov_b64 exec, -1
    ds_read_b32 v195, v209
    v_add_u32 v209, 256, v209
    s_mov_b32 s76, 59
L_loop1:
    s_waitcnt vmcnt(24)
    v_lshlrev_b32 v192, 16, v192
    v_lshlrev_b32 v193, 16, v193
    s_waitcnt lgkmcnt(0)
    v_max_f32_dpp v206, v195, v195 row_ror:8 row_mask:0xf bank_mask:0xf
    s_nop 1
    v_max_f32_dpp v206, v206, v206 row_ror:4 row_mask:0xf bank_mask:0xf
    s_nop 1
    v_max_f32_dpp v206, v206, v206 row_ror:2 row_mask:0xf bank_mask:0xf
    s_nop 1
    v_max_f32_dpp v206, v206, v206 row_ror:1 row_mask:0xf bank_mask:0xf
    v_max_f32 v206, v206, v188
    v_sub_f32 v207, v188, v206
    v_sub_f32 v194, v195, v206
    v_exp_f32 v207, v207
    v_exp_f32 v194, v194
    v_mov_b32 v188, v206
    v_fma_f32 v189, v189, v207, v194
    v_mul_f32 v194, v194, v192
    v_mul_f32 v190, v190, v207
    v_fmac_f32 v190, v194, v193
    ds_read_b32 v195, v209
    v_add_u32 v209, 256, v209
    v_mul_f32 v176, v176, v207
    v_mul_f32 v177, v177, v207
    v_mul_f32 v178, v178, v207
    v_mul_f32 v179, v179, v207
    v_mul_f32 v180, v180, v207
    v_mul_f32 v181, v181, v207
    v_mul_f32 v182, v182, v207
    v_mul_f32 v183, v183, v207
    v_mul_f32 v184, v184, v207
    v_mul_f32 v185, v185, v207
    v_mul_f32 v186, v186, v207
    v_mul_f32 v187, v187, v207
    s_waitcnt vmcnt(23)
    v_cvt_f32_i32 v100, v4
    v_cvt_f32_i32 v101, v5
    v_cvt_f32_i32 v102, v6
    v_cvt_f32_i32 v103, v7
    s_add_u32 s71, s71, 1551360
    buffer_load_dwordx4 v[4:7], v1, s[28:31], s71 offen offset:0 nt
    v_fmac_f32_dpp v176, v194, v100 row_newbcast:0 row_mask:0xf bank_mask:0xf
    v_fmac_f32_dpp v177, v194, v101 row_newbcast:0 row_mask:0xf bank_mask:0xf
    v_fmac_f32_dpp v178, v194, v102 row_newbcast:0 row_mask:0xf bank_mask:0xf
    v_fmac_f32_dpp v179, v194, v103 row_newbcast:0 row_mask:0xf bank_mask:0xf
    s_waitcnt vmcnt(23)
    v_cvt_f32_i32 v104, v8
    v_cvt_f32_i32 v105, v9
    v_cvt_f32_i32 v106, v10
    v_cvt_f32_i32 v107, v11
    buffer_load_dwordx4 v[8:11], v1, s[28:31], s71 offen offset:256 nt
    v_fmac_f32_dpp v180, v194, v104 row_newbcast:0 row_mask:0xf bank_mask:0xf
    v_fmac_f32_dpp v181, v194, v105 row_newbcast:0 row_mask:0xf bank_mask:0xf
    v_fmac_f32_dpp v182, v194, v106 row_newbcast:0 row_mask:0xf bank_mask:0xf
    v_fmac_f32_dpp v183, v194, v107 row_newbcast:0 row_mask:0xf bank_mask:0xf
    s_waitcnt vmcnt(23)
    v_cvt_f32_i32 v100, v12
    v_cvt_f32_i32 v101, v13
    v_cvt_f32_i32 v102, v14
    v_cvt_f32_i32 v103, v15
    buffer_load_dwordx4 v[12:15], v1, s[28:31], s71 offen offset:512 nt
    v_fmac_f32_dpp v184, v194, v100 row_newbcast:0 row_mask:0xf bank_mask:0xf
    v_fmac_f32_dpp v185, v194, v101 row_newbcast:0 row_mask:0xf bank_mask:0xf
    v_fmac_f32_dpp v186, v194, v102 row_newbcast:0 row_mask:0xf bank_mask:0xf
    v_fmac_f32_dpp v187, v194, v103 row_newbcast:0 row_mask:0xf bank_mask:0xf
    s_waitcnt vmcnt(23)
    v_cvt_f32_i32 v104, v16
    v_cvt_f32_i32 v105, v17
    v_cvt_f32_i32 v106, v18
    v_cvt_f32_i32 v107, v19
    s_add_u32 s71, s71, 3072
    buffer_load_dwordx4 v[16:19], v1, s[28:31], s71 offen offset:0 nt
    v_fmac_f32_dpp v176, v194, v104 row_newbcast:8 row_mask:0xf bank_mask:0xf
    v_fmac_f32_dpp v177, v194, v105 row_newbcast:8 row_mask:0xf bank_mask:0xf
    v_fmac_f32_dpp v178, v194, v106 row_newbcast:8 row_mask:0xf bank_mask:0xf
    v_fmac_f32_dpp v179, v194, v107 row_newbcast:8 row_mask:0xf bank_mask:0xf
    s_waitcnt vmcnt(23)
    v_cvt_f32_i32 v100, v20
    v_cvt_f32_i32 v101, v21
    v_cvt_f32_i32 v102, v22
    v_cvt_f32_i32 v103, v23
    buffer_load_dwordx4 v[20:23], v1, s[28:31], s71 offen offset:256 nt
    v_fmac_f32_dpp v180, v194, v100 row_newbcast:8 row_mask:0xf bank_mask:0xf
    v_fmac_f32_dpp v181, v194, v101 row_newbcast:8 row_mask:0xf bank_mask:0xf
    v_fmac_f32_dpp v182, v194, v102 row_newbcast:8 row_mask:0xf bank_mask:0xf
    v_fmac_f32_dpp v183, v194, v103 row_newbcast:8 row_mask:0xf bank_mask:0xf
    s_waitcnt vmcnt(23)
    v_cvt_f32_i32 v104, v24
    v_cvt_f32_i32 v105, v25
    v_cvt_f32_i32 v106, v26
    v_cvt_f32_i32 v107, v27
    buffer_load_dwordx4 v[24:27], v1, s[28:31], s71 offen offset:512 nt
    v_fmac_f32_dpp v184, v194, v104 row_newbcast:8 row_mask:0xf bank_mask:0xf
    v_fmac_f32_dpp v185, v194, v105 row_newbcast:8 row_mask:0xf bank_mask:0xf
    v_fmac_f32_dpp v186, v194, v106 row_newbcast:8 row_mask:0xf bank_mask:0xf
    v_fmac_f32_dpp v187, v194, v107 row_newbcast:8 row_mask:0xf bank_mask:0xf
    s_waitcnt vmcnt(23)
    v_cvt_f32_i32 v100, v28
    v_cvt_f32_i32 v101, v29
    v_cvt_f32_i32 v102, v30
    v_cvt_f32_i32 v103, v31
    s_add_u32 s71, s71, 3072
    buffer_load_dwordx4 v[28:31], v1, s[28:31], s71 offen offset:0 nt
    v_fmac_f32_dpp v176, v194, v100 row_newbcast:4 row_mask:0xf bank_mask:0xf
    v_fmac_f32_dpp v177, v194, v101 row_newbcast:4 row_mask:0xf bank_mask:0xf
    v_fmac_f32_dpp v178, v194, v102 row_newbcast:4 row_mask:0xf bank_mask:0xf
    v_fmac_f32_dpp v179, v194, v103 row_newbcast:4 row_mask:0xf bank_mask:0xf
    s_waitcnt vmcnt(23)
    v_cvt_f32_i32 v104, v32
    v_cvt_f32_i32 v105, v33
    v_cvt_f32_i32 v106, v34
    v_cvt_f32_i32 v107, v35
    buffer_load_dwordx4 v[32:35], v1, s[28:31], s71 offen offset:256 nt
    v_fmac_f32_dpp v180, v194, v104 row_newbcast:4 row_mask:0xf bank_mask:0xf
    v_fmac_f32_dpp v181, v194, v105 row_newbcast:4 row_mask:0xf bank_mask:0xf
    v_fmac_f32_dpp v182, v194, v106 row_newbcast:4 row_mask:0xf bank_mask:0xf
    v_fmac_f32_dpp v183, v194, v107 row_newbcast:4 row_mask:0xf bank_mask:0xf
    s_waitcnt vmcnt(23)
    v_cvt_f32_i32 v100, v36
    v_cvt_f32_i32 v101, v37
    v_cvt_f32_i32 v102, v38
    v_cvt_f32_i32 v103, v39
    buffer_load_dwordx4 v[36:39], v1, s[28:31], s71 offen offset:512 nt
    v_fmac_f32_dpp v184, v194, v100 row_newbcast:4 row_mask:0xf bank_mask:0xf
    v_fmac_f32_dpp v185, v194, v101 row_newbcast:4 row_mask:0xf bank_mask:0xf
    v_fmac_f32_dpp v186, v194, v102 row_newbcast:4 row_mask:0xf bank_mask:0xf
    v_fmac_f32_dpp v187, v194, v103 row_newbcast:4 row_mask:0xf bank_mask:0xf
    s_waitcnt vmcnt(23)
    v_cvt_f32_i32 v104, v40
    v_cvt_f32_i32 v105, v41
    v_cvt_f32_i32 v106, v42
    v_cvt_f32_i32 v107, v43
    s_add_u32 s71, s71, 3072
    buffer_load_dwordx4 v[40:43], v1, s[28:31], s71 offen offset:0 nt
    v_fmac_f32_dpp v176, v194, v104 row_newbcast:12 row_mask:0xf bank_mask:0xf
    v_fmac_f32_dpp v177, v194, v105 row_newbcast:12 row_mask:0xf bank_mask:0xf
    v_fmac_f32_dpp v178, v194, v106 row_newbcast:12 row_mask:0xf bank_mask:0xf
    v_fmac_f32_dpp v179, v194, v107 row_newbcast:12 row_mask:0xf bank_mask:0xf
    s_waitcnt vmcnt(23)
    v_cvt_f32_i32 v100, v44
    v_cvt_f32_i32 v101, v45
    v_cvt_f32_i32 v102, v46
    v_cvt_f32_i32 v103, v47
    buffer_load_dwordx4 v[44:47], v1, s[28:31], s71 offen offset:256 nt
    v_fmac_f32_dpp v180, v194, v100 row_newbcast:12 row_mask:0xf bank_mask:0xf
    v_fmac_f32_dpp v181, v194, v101 row_newbcast:12 row_mask:0xf bank_mask:0xf
    v_fmac_f32_dpp v182, v194, v102 row_newbcast:12 row_mask:0xf bank_mask:0xf
    v_fmac_f32_dpp v183, v194, v103 row_newbcast:12 row_mask:0xf bank_mask:0xf
    s_waitcnt vmcnt(23)
    v_cvt_f32_i32 v104, v48
    v_cvt_f32_i32 v105, v49
    v_cvt_f32_i32 v106, v50
    v_cvt_f32_i32 v107, v51
    buffer_load_dwordx4 v[48:51], v1, s[28:31], s71 offen offset:512 nt
    v_fmac_f32_dpp v184, v194, v104 row_newbcast:12 row_mask:0xf bank_mask:0xf
    v_fmac_f32_dpp v185, v194, v105 row_newbcast:12 row_mask:0xf bank_mask:0xf
    v_fmac_f32_dpp v186, v194, v106 row_newbcast:12 row_mask:0xf bank_mask:0xf
    v_fmac_f32_dpp v187, v194, v107 row_newbcast:12 row_mask:0xf bank_mask:0xf
    s_waitcnt vmcnt(23)
    v_cvt_f32_i32 v100, v52
    v_cvt_f32_i32 v101, v53
    v_cvt_f32_i32 v102, v54
    v_cvt_f32_i32 v103, v55
    s_add_u32 s71, s71, 3072
    buffer_load_dwordx4 v[52:55], v1, s[28:31], s71 offen offset:0 nt
    v_fmac_f32_dpp v176, v194, v100 row_newbcast:2 row_mask:0xf bank_mask:0xf
    v_fmac_f32_dpp v177, v194, v101 row_newbcast:2 row_mask:0xf bank_mask:0xf
    v_fmac_f32_dpp v178, v194, v102 row_newbcast:2 row_mask:0xf bank_mask:0xf
    v_fmac_f32_dpp v179, v194, v103 row_newbcast:2 row_mask:0xf bank_mask:0xf
    s_waitcnt vmcnt(23)
    v_cvt_f32_i32 v104, v56
    v_cvt_f32_i32 v105, v57
    v_cvt_f32_i32 v106, v58
    v_cvt_f32_i32 v107, v59
    buffer_load_dwordx4 v[56:59], v1, s[28:31], s71 offen offset:256 nt
    v_fmac_f32_dpp v180, v194, v104 row_newbcast:2 row_mask:0xf bank_mask:0xf
    v_fmac_f32_dpp v181, v194, v105 row_newbcast:2 row_mask:0xf bank_mask:0xf
    v_fmac_f32_dpp v182, v194, v106 row_newbcast:2 row_mask:0xf bank_mask:0xf
    v_fmac_f32_dpp v183, v194, v107 row_newbcast:2 row_mask:0xf bank_mask:0xf
    s_waitcnt vmcnt(23)
    v_cvt_f32_i32 v100, v60
    v_cvt_f32_i32 v101, v61
    v_cvt_f32_i32 v102, v62
    v_cvt_f32_i32 v103, v63
    buffer_load_dwordx4 v[60:63], v1, s[28:31], s71 offen offset:512 nt
    v_fmac_f32_dpp v184, v194, v100 row_newbcast:2 row_mask:0xf bank_mask:0xf
    v_fmac_f32_dpp v185, v194, v101 row_newbcast:2 row_mask:0xf bank_mask:0xf
    v_fmac_f32_dpp v186, v194, v102 row_newbcast:2 row_mask:0xf bank_mask:0xf
    v_fmac_f32_dpp v187, v194, v103 row_newbcast:2 row_mask:0xf bank_mask:0xf
    s_waitcnt vmcnt(23)
    v_cvt_f32_i32 v104, v64
    v_cvt_f32_i32 v105, v65
    v_cvt_f32_i32 v106, v66
    v_cvt_f32_i32 v107, v67
    s_add_u32 s71, s71, 3072
    buffer_load_dwordx4 v[64:67], v1, s[28:31], s71 offen offset:0 nt
    v_fmac_f32_dpp v176, v194, v104 row_newbcast:10 row_mask:0xf bank_mask:0xf
    v_fmac_f32_dpp v177, v194, v105 row_newbcast:10 row_mask:0xf bank_mask:0xf
    v_fmac_f32_dpp v178, v194, v106 row_newbcast:10 row_mask:0xf bank_mask:0xf
    v_fmac_f32_dpp v179, v194, v107 row_newbcast:10 row_mask:0xf bank_mask:0xf
    s_waitcnt vmcnt(23)
    v_cvt_f32_i32 v100, v68
    v_cvt_f32_i32 v101, v69
    v_cvt_f32_i32 v102, v70
    v_cvt_f32_i32 v103, v71
    buffer_load_dwordx4 v[68:71], v1, s[28:31], s71 offen offset:256 nt
    v_fmac_f32_dpp v180, v194, v100 row_newbcast:10 row_mask:0xf bank_mask:0xf
    v_fmac_f32_dpp v181, v194, v101 row_newbcast:10 row_mask:0xf bank_mask:0xf
    v_fmac_f32_dpp v182, v194, v102 row_newbcast:10 row_mask:0xf bank_mask:0xf
    v_fmac_f32_dpp v183, v194, v103 row_newbcast:10 row_mask:0xf bank_mask:0xf
    s_waitcnt vmcnt(23)
    v_cvt_f32_i32 v104, v72
    v_cvt_f32_i32 v105, v73
    v_cvt_f32_i32 v106, v74
    v_cvt_f32_i32 v107, v75
    buffer_load_dwordx4 v[72:75], v1, s[28:31], s71 offen offset:512 nt
    v_fmac_f32_dpp v184, v194, v104 row_newbcast:10 row_mask:0xf bank_mask:0xf
    v_fmac_f32_dpp v185, v194, v105 row_newbcast:10 row_mask:0xf bank_mask:0xf
    v_fmac_f32_dpp v186, v194, v106 row_newbcast:10 row_mask:0xf bank_mask:0xf
    v_fmac_f32_dpp v187, v194, v107 row_newbcast:10 row_mask:0xf bank_mask:0xf
    s_waitcnt vmcnt(23)
    v_cvt_f32_i32 v100, v76
    v_cvt_f32_i32 v101, v77
    v_cvt_f32_i32 v102, v78
    v_cvt_f32_i32 v103, v79
    s_add_u32 s71, s71, 3072
    buffer_load_dwordx4 v[76:79], v1, s[28:31], s71 offen offset:0 nt
    v_fmac_f32_dpp v176, v194, v100 row_newbcast:6 row_mask:0xf bank_mask:0xf
    v_fmac_f32_dpp v177, v194, v101 row_newbcast:6 row_mask:0xf bank_mask:0xf
    v_fmac_f32_dpp v178, v194, v102 row_newbcast:6 row_mask:0xf bank_mask:0xf
    v_fmac_f32_dpp v179, v194, v103 row_newbcast:6 row_mask:0xf bank_mask:0xf
    s_waitcnt vmcnt(23)
    v_cvt_f32_i32 v104, v80
    v_cvt_f32_i32 v105, v81
    v_cvt_f32_i32 v106, v82
    v_cvt_f32_i32 v107, v83
    buffer_load_dwordx4 v[80:83], v1, s[28:31], s71 offen offset:256 nt
    v_fmac_f32_dpp v180, v194, v104 row_newbcast:6 row_mask:0xf bank_mask:0xf
    v_fmac_f32_dpp v181, v194, v105 row_newbcast:6 row_mask:0xf bank_mask:0xf
    v_fmac_f32_dpp v182, v194, v106 row_newbcast:6 row_mask:0xf bank_mask:0xf
    v_fmac_f32_dpp v183, v194, v107 row_newbcast:6 row_mask:0xf bank_mask:0xf
    s_waitcnt vmcnt(23)
    v_cvt_f32_i32 v100, v84
    v_cvt_f32_i32 v101, v85
    v_cvt_f32_i32 v102, v86
    v_cvt_f32_i32 v103, v87
    buffer_load_dwordx4 v[84:87], v1, s[28:31], s71 offen offset:512 nt
    v_fmac_f32_dpp v184, v194, v100 row_newbcast:6 row_mask:0xf bank_mask:0xf
    v_fmac_f32_dpp v185, v194, v101 row_newbcast:6 row_mask:0xf bank_mask:0xf
    v_fmac_f32_dpp v186, v194, v102 row_newbcast:6 row_mask:0xf bank_mask:0xf
    v_fmac_f32_dpp v187, v194, v103 row_newbcast:6 row_mask:0xf bank_mask:0xf
    s_waitcnt vmcnt(23)
    v_cvt_f32_i32 v104, v88
    v_cvt_f32_i32 v105, v89
    v_cvt_f32_i32 v106, v90
    v_cvt_f32_i32 v107, v91
    s_add_u32 s71, s71, 3072
    buffer_load_dwordx4 v[88:91], v1, s[28:31], s71 offen offset:0 nt
    v_fmac_f32_dpp v176, v194, v104 row_newbcast:14 row_mask:0xf bank_mask:0xf
    v_fmac_f32_dpp v177, v194, v105 row_newbcast:14 row_mask:0xf bank_mask:0xf
    v_fmac_f32_dpp v178, v194, v106 row_newbcast:14 row_mask:0xf bank_mask:0xf
    v_fmac_f32_dpp v179, v194, v107 row_newbcast:14 row_mask:0xf bank_mask:0xf
    s_waitcnt vmcnt(23)
    v_cvt_f32_i32 v100, v92
    v_cvt_f32_i32 v101, v93
    v_cvt_f32_i32 v102, v94
    v_cvt_f32_i32 v103, v95
    buffer_load_dwordx4 v[92:95], v1, s[28:31], s71 offen offset:256 nt
    v_fmac_f32_dpp v180, v194, v100 row_newbcast:14 row_mask:0xf bank_mask:0xf
    v_fmac_f32_dpp v181, v194, v101 row_newbcast:14 row_mask:0xf bank_mask:0xf
    v_fmac_f32_dpp v182, v194, v102 row_newbcast:14 row_mask:0xf bank_mask:0xf
    v_fmac_f32_dpp v183, v194, v103 row_newbcast:14 row_mask:0xf bank_mask:0xf
    s_waitcnt vmcnt(23)
    v_cvt_f32_i32 v104, v96
    v_cvt_f32_i32 v105, v97
    v_cvt_f32_i32 v106, v98
    v_cvt_f32_i32 v107, v99
    buffer_load_dwordx4 v[96:99], v1, s[28:31], s71 offen offset:512 nt
    v_fmac_f32_dpp v184, v194, v104 row_newbcast:14 row_mask:0xf bank_mask:0xf
    v_fmac_f32_dpp v185, v194, v105 row_newbcast:14 row_mask:0xf bank_mask:0xf
    v_fmac_f32_dpp v186, v194, v106 row_newbcast:14 row_mask:0xf bank_mask:0xf
    v_fmac_f32_dpp v187, v194, v107 row_newbcast:14 row_mask:0xf bank_mask:0xf
    s_waitcnt vmcnt(23)
    v_cvt_f32_i32 v100, v4
    v_cvt_f32_i32 v101, v5
    v_cvt_f32_i32 v102, v6
    v_cvt_f32_i32 v103, v7
    s_add_u32 s56, s56, 64
    s_and_b32 s56, s56, 511
    s_sub_u32 s75, s75, 1
    s_cmp_eq_u32 s75, 0
    s_cselect_b32 s80, 2048, 0
    s_cselect_b32 s75, 8, s75
    s_add_u32 s57, s57, s80
    s_add_u32 s70, s57, s56
    s_add_u32 s91, s91, 1
    s_cmp_lt_u32 s91, 4
    s_cselect_b32 s80, s90, 0
    s_add_u32 s70, s70, s80
    s_and_b32 s80, s70, 63
    s_mul_i32 s80, s80, 64
    s_lshl_b32 s73, s70, 7
    s_sub_u32 s73, s73, s80
    buffer_load_ushort v192, v3, s[40:43], s73 offen
    buffer_load_ushort v193, v3, s[44:47], s73 offen
    s_mul_i32 s71, s70, 49152
    s_and_b32 s80, s70, 63
    s_mul_i32 s80, s80, 24576
    s_sub_u32 s71, s71, s80
    buffer_load_dwordx4 v[4:7], v1, s[28:31], s71 offen offset:0 nt
    v_fmac_f32_dpp v176, v194, v100 row_newbcast:1 row_mask:0xf bank_mask:0xf
    v_fmac_f32_dpp v177, v194, v101 row_newbcast:1 row_mask:0xf bank_mask:0xf
    v_fmac_f32_dpp v178, v194, v102 row_newbcast:1 row_mask:0xf bank_mask:0xf
    v_fmac_f32_dpp v179, v194, v103 row_newbcast:1 row_mask:0xf bank_mask:0xf
    s_waitcnt vmcnt(25)
    v_cvt_f32_i32 v104, v8
    v_cvt_f32_i32 v105, v9
    v_cvt_f32_i32 v106, v10
    v_cvt_f32_i32 v107, v11
    buffer_load_dwordx4 v[8:11], v1, s[28:31], s71 offen offset:256 nt
    v_fmac_f32_dpp v180, v194, v104 row_newbcast:1 row_mask:0xf bank_mask:0xf
    v_fmac_f32_dpp v181, v194, v105 row_newbcast:1 row_mask:0xf bank_mask:0xf
    v_fmac_f32_dpp v182, v194, v106 row_newbcast:1 row_mask:0xf bank_mask:0xf
    v_fmac_f32_dpp v183, v194, v107 row_newbcast:1 row_mask:0xf bank_mask:0xf
    s_waitcnt vmcnt(25)
    v_cvt_f32_i32 v100, v12
    v_cvt_f32_i32 v101, v13
    v_cvt_f32_i32 v102, v14
    v_cvt_f32_i32 v103, v15
    buffer_load_dwordx4 v[12:15], v1, s[28:31], s71 offen offset:512 nt
    v_fmac_f32_dpp v184, v194, v100 row_newbcast:1 row_mask:0xf bank_mask:0xf
    v_fmac_f32_dpp v185, v194, v101 row_newbcast:1 row_mask:0xf bank_mask:0xf
    v_fmac_f32_dpp v186, v194, v102 row_newbcast:1 row_mask:0xf bank_mask:0xf
    v_fmac_f32_dpp v187, v194, v103 row_newbcast:1 row_mask:0xf bank_mask:0xf
    s_waitcnt vmcnt(25)
    v_cvt_f32_i32 v104, v16
    v_cvt_f32_i32 v105, v17
    v_cvt_f32_i32 v106, v18
    v_cvt_f32_i32 v107, v19
    s_add_u32 s71, s71, 3072
    buffer_load_dwordx4 v[16:19], v1, s[28:31], s71 offen offset:0 nt
    v_fmac_f32_dpp v176, v194, v104 row_newbcast:9 row_mask:0xf bank_mask:0xf
    v_fmac_f32_dpp v177, v194, v105 row_newbcast:9 row_mask:0xf bank_mask:0xf
    v_fmac_f32_dpp v178, v194, v106 row_newbcast:9 row_mask:0xf bank_mask:0xf
    v_fmac_f32_dpp v179, v194, v107 row_newbcast:9 row_mask:0xf bank_mask:0xf
    s_cmp_eq_u32 s76, 1
    s_cselect_b64 exec, 1, 0
    ds_add_u32 v212, v212 offset:131
    s_mov_b64 exec, -1
    s_waitcnt vmcnt(25)
    v_cvt_f32_i32 v100, v20
    v_cvt_f32_i32 v101, v21
    v_cvt_f32_i32 v102, v22
    v_cvt_f32_i32 v103, v23
    buffer_load_dwordx4 v[20:23], v1, s[28:31], s71 offen offset:256 nt
    v_fmac_f32_dpp v180, v194, v100 row_newbcast:9 row_mask:0xf bank_mask:0xf
    v_fmac_f32_dpp v181, v194, v101 row_newbcast:9 row_mask:0xf bank_mask:0xf
    v_fmac_f32_dpp v182, v194, v102 row_newbcast:9 row_mask:0xf bank_mask:0xf
    v_fmac_f32_dpp v183, v194, v103 row_newbcast:9 row_mask:0xf bank_mask:0xf
    s_waitcnt vmcnt(25)
    v_cvt_f32_i32 v104, v24
    v_cvt_f32_i32 v105, v25
    v_cvt_f32_i32 v106, v26
    v_cvt_f32_i32 v107, v27
    buffer_load_dwordx4 v[24:27], v1, s[28:31], s71 offen offset:512 nt
    v_fmac_f32_dpp v184, v194, v104 row_newbcast:9 row_mask:0xf bank_mask:0xf
    v_fmac_f32_dpp v185, v194, v105 row_newbcast:9 row_mask:0xf bank_mask:0xf
    v_fmac_f32_dpp v186, v194, v106 row_newbcast:9 row_mask:0xf bank_mask:0xf
    v_fmac_f32_dpp v187, v194, v107 row_newbcast:9 row_mask:0xf bank_mask:0xf
    s_waitcnt vmcnt(25)
    v_cvt_f32_i32 v100, v28
    v_cvt_f32_i32 v101, v29
    v_cvt_f32_i32 v102, v30
    v_cvt_f32_i32 v103, v31
    s_add_u32 s71, s71, 3072
    buffer_load_dwordx4 v[28:31], v1, s[28:31], s71 offen offset:0 nt
    v_fmac_f32_dpp v176, v194, v100 row_newbcast:5 row_mask:0xf bank_mask:0xf
    v_fmac_f32_dpp v177, v194, v101 row_newbcast:5 row_mask:0xf bank_mask:0xf
    v_fmac_f32_dpp v178, v194, v102 row_newbcast:5 row_mask:0xf bank_mask:0xf
    v_fmac_f32_dpp v179, v194, v103 row_newbcast:5 row_mask:0xf bank_mask:0xf
    s_waitcnt vmcnt(25)
    v_cvt_f32_i32 v104, v32
    v_cvt_f32_i32 v105, v33
    v_cvt_f32_i32 v106, v34
    v_cvt_f32_i32 v107, v35
    buffer_load_dwordx4 v[32:35], v1, s[28:31], s71 offen offset:256 nt
    v_fmac_f32_dpp v180, v194, v104 row_newbcast:5 row_mask:0xf bank_mask:0xf
    v_fmac_f32_dpp v181, v194, v105 row_newbcast:5 row_mask:0xf bank_mask:0xf
    v_fmac_f32_dpp v182, v194, v106 row_newbcast:5 row_mask:0xf bank_mask:0xf
    v_fmac_f32_dpp v183, v194, v107 row_newbcast:5 row_mask:0xf bank_mask:0xf
    s_waitcnt vmcnt(25)
    v_cvt_f32_i32 v100, v36
    v_cvt_f32_i32 v101, v37
    v_cvt_f32_i32 v102, v38
    v_cvt_f32_i32 v103, v39
    buffer_load_dwordx4 v[36:39], v1, s[28:31], s71 offen offset:512 nt
    v_fmac_f32_dpp v184, v194, v100 row_newbcast:5 row_mask:0xf bank_mask:0xf
    v_fmac_f32_dpp v185, v194, v101 row_newbcast:5 row_mask:0xf bank_mask:0xf
    v_fmac_f32_dpp v186, v194, v102 row_newbcast:5 row_mask:0xf bank_mask:0xf
    v_fmac_f32_dpp v187, v194, v103 row_newbcast:5 row_mask:0xf bank_mask:0xf
    s_waitcnt vmcnt(25)
    v_cvt_f32_i32 v104, v40
    v_cvt_f32_i32 v105, v41
    v_cvt_f32_i32 v106, v42
    v_cvt_f32_i32 v107, v43
    s_add_u32 s71, s71, 3072
    buffer_load_dwordx4 v[40:43], v1, s[28:31], s71 offen offset:0 nt
    v_fmac_f32_dpp v176, v194, v104 row_newbcast:13 row_mask:0xf bank_mask:0xf
    v_fmac_f32_dpp v177, v194, v105 row_newbcast:13 row_mask:0xf bank_mask:0xf
    v_fmac_f32_dpp v178, v194, v106 row_newbcast:13 row_mask:0xf bank_mask:0xf
    v_fmac_f32_dpp v179, v194, v107 row_newbcast:13 row_mask:0xf bank_mask:0xf
    s_waitcnt vmcnt(25)
    v_cvt_f32_i32 v100, v44
    v_cvt_f32_i32 v101, v45
    v_cvt_f32_i32 v102, v46
    v_cvt_f32_i32 v103, v47
    buffer_load_dwordx4 v[44:47], v1, s[28:31], s71 offen offset:256 nt
    v_fmac_f32_dpp v180, v194, v100 row_newbcast:13 row_mask:0xf bank_mask:0xf
    v_fmac_f32_dpp v181, v194, v101 row_newbcast:13 row_mask:0xf bank_mask:0xf
    v_fmac_f32_dpp v182, v194, v102 row_newbcast:13 row_mask:0xf bank_mask:0xf
    v_fmac_f32_dpp v183, v194, v103 row_newbcast:13 row_mask:0xf bank_mask:0xf
    s_waitcnt vmcnt(25)
    v_cvt_f32_i32 v104, v48
    v_cvt_f32_i32 v105, v49
    v_cvt_f32_i32 v106, v50
    v_cvt_f32_i32 v107, v51
    buffer_load_dwordx4 v[48:51], v1, s[28:31], s71 offen offset:512 nt
    v_fmac_f32_dpp v184, v194, v104 row_newbcast:13 row_mask:0xf bank_mask:0xf
    v_fmac_f32_dpp v185, v194, v105 row_newbcast:13 row_mask:0xf bank_mask:0xf
    v_fmac_f32_dpp v186, v194, v106 row_newbcast:13 row_mask:0xf bank_mask:0xf
    v_fmac_f32_dpp v187, v194, v107 row_newbcast:13 row_mask:0xf bank_mask:0xf
    s_waitcnt vmcnt(25)
    v_cvt_f32_i32 v100, v52
    v_cvt_f32_i32 v101, v53
    v_cvt_f32_i32 v102, v54
    v_cvt_f32_i32 v103, v55
    s_add_u32 s71, s71, 3072
    buffer_load_dwordx4 v[52:55], v1, s[28:31], s71 offen offset:0 nt
    v_fmac_f32_dpp v176, v194, v100 row_newbcast:3 row_mask:0xf bank_mask:0xf
    v_fmac_f32_dpp v177, v194, v101 row_newbcast:3 row_mask:0xf bank_mask:0xf
    v_fmac_f32_dpp v178, v194, v102 row_newbcast:3 row_mask:0xf bank_mask:0xf
    v_fmac_f32_dpp v179, v194, v103 row_newbcast:3 row_mask:0xf bank_mask:0xf
    s_waitcnt vmcnt(25)
    v_cvt_f32_i32 v104, v56
    v_cvt_f32_i32 v105, v57
    v_cvt_f32_i32 v106, v58
    v_cvt_f32_i32 v107, v59
    buffer_load_dwordx4 v[56:59], v1, s[28:31], s71 offen offset:256 nt
    v_fmac_f32_dpp v180, v194, v104 row_newbcast:3 row_mask:0xf bank_mask:0xf
    v_fmac_f32_dpp v181, v194, v105 row_newbcast:3 row_mask:0xf bank_mask:0xf
    v_fmac_f32_dpp v182, v194, v106 row_newbcast:3 row_mask:0xf bank_mask:0xf
    v_fmac_f32_dpp v183, v194, v107 row_newbcast:3 row_mask:0xf bank_mask:0xf
    s_waitcnt vmcnt(25)
    v_cvt_f32_i32 v100, v60
    v_cvt_f32_i32 v101, v61
    v_cvt_f32_i32 v102, v62
    v_cvt_f32_i32 v103, v63
    buffer_load_dwordx4 v[60:63], v1, s[28:31], s71 offen offset:512 nt
    v_fmac_f32_dpp v184, v194, v100 row_newbcast:3 row_mask:0xf bank_mask:0xf
    v_fmac_f32_dpp v185, v194, v101 row_newbcast:3 row_mask:0xf bank_mask:0xf
    v_fmac_f32_dpp v186, v194, v102 row_newbcast:3 row_mask:0xf bank_mask:0xf
    v_fmac_f32_dpp v187, v194, v103 row_newbcast:3 row_mask:0xf bank_mask:0xf
    s_waitcnt vmcnt(25)
    v_cvt_f32_i32 v104, v64
    v_cvt_f32_i32 v105, v65
    v_cvt_f32_i32 v106, v66
    v_cvt_f32_i32 v107, v67
    s_add_u32 s71, s71, 3072
    buffer_load_dwordx4 v[64:67], v1, s[28:31], s71 offen offset:0 nt
    v_fmac_f32_dpp v176, v194, v104 row_newbcast:11 row_mask:0xf bank_mask:0xf
    v_fmac_f32_dpp v177, v194, v105 row_newbcast:11 row_mask:0xf bank_mask:0xf
    v_fmac_f32_dpp v178, v194, v106 row_newbcast:11 row_mask:0xf bank_mask:0xf
    v_fmac_f32_dpp v179, v194, v107 row_newbcast:11 row_mask:0xf bank_mask:0xf
    s_waitcnt vmcnt(25)
    v_cvt_f32_i32 v100, v68
    v_cvt_f32_i32 v101, v69
    v_cvt_f32_i32 v102, v70
    v_cvt_f32_i32 v103, v71
    buffer_load_dwordx4 v[68:71], v1, s[28:31], s71 offen offset:256 nt
    v_fmac_f32_dpp v180, v194, v100 row_newbcast:11 row_mask:0xf bank_mask:0xf
    v_fmac_f32_dpp v181, v194, v101 row_newbcast:11 row_mask:0xf bank_mask:0xf
    v_fmac_f32_dpp v182, v194, v102 row_newbcast:11 row_mask:0xf bank_mask:0xf
    v_fmac_f32_dpp v183, v194, v103 row_newbcast:11 row_mask:0xf bank_mask:0xf
    s_waitcnt vmcnt(25)
    v_cvt_f32_i32 v104, v72
    v_cvt_f32_i32 v105, v73
    v_cvt_f32_i32 v106, v74
    v_cvt_f32_i32 v107, v75
    buffer_load_dwordx4 v[72:75], v1, s[28:31], s71 offen offset:512 nt
    v_fmac_f32_dpp v184, v194, v104 row_newbcast:11 row_mask:0xf bank_mask:0xf
    v_fmac_f32_dpp v185, v194, v105 row_newbcast:11 row_mask:0xf bank_mask:0xf
    v_fmac_f32_dpp v186, v194, v106 row_newbcast:11 row_mask:0xf bank_mask:0xf
    v_fmac_f32_dpp v187, v194, v107 row_newbcast:11 row_mask:0xf bank_mask:0xf
    s_waitcnt vmcnt(25)
    v_cvt_f32_i32 v100, v76
    v_cvt_f32_i32 v101, v77
    v_cvt_f32_i32 v102, v78
    v_cvt_f32_i32 v103, v79
    s_add_u32 s71, s71, 3072
    buffer_load_dwordx4 v[76:79], v1, s[28:31], s71 offen offset:0 nt
    v_fmac_f32_dpp v176, v194, v100 row_newbcast:7 row_mask:0xf bank_mask:0xf
    v_fmac_f32_dpp v177, v194, v101 row_newbcast:7 row_mask:0xf bank_mask:0xf
    v_fmac_f32_dpp v178, v194, v102 row_newbcast:7 row_mask:0xf bank_mask:0xf
    v_fmac_f32_dpp v179, v194, v103 row_newbcast:7 row_mask:0xf bank_mask:0xf
    s_waitcnt vmcnt(25)
    v_cvt_f32_i32 v104, v80
    v_cvt_f32_i32 v105, v81
    v_cvt_f32_i32 v106, v82
    v_cvt_f32_i32 v107, v83
    buffer_load_dwordx4 v[80:83], v1, s[28:31], s71 offen offset:256 nt
    v_fmac_f32_dpp v180, v194, v104 row_newbcast:7 row_mask:0xf bank_mask:0xf
    v_fmac_f32_dpp v181, v194, v105 row_newbcast:7 row_mask:0xf bank_mask:0xf
    v_fmac_f32_dpp v182, v194, v106 row_newbcast:7 row_mask:0xf bank_mask:0xf
    v_fmac_f32_dpp v183, v194, v107 row_newbcast:7 row_mask:0xf bank_mask:0xf
    s_waitcnt vmcnt(25)
    v_cvt_f32_i32 v100, v84
    v_cvt_f32_i32 v101, v85
    v_cvt_f32_i32 v102, v86
    v_cvt_f32_i32 v103, v87
    buffer_load_dwordx4 v[84:87], v1, s[28:31], s71 offen offset:512 nt
    v_fmac_f32_dpp v184, v194, v100 row_newbcast:7 row_mask:0xf bank_mask:0xf
    v_fmac_f32_dpp v185, v194, v101 row_newbcast:7 row_mask:0xf bank_mask:0xf
    v_fmac_f32_dpp v186, v194, v102 row_newbcast:7 row_mask:0xf bank_mask:0xf
    v_fmac_f32_dpp v187, v194, v103 row_newbcast:7 row_mask:0xf bank_mask:0xf
    s_waitcnt vmcnt(25)
    v_cvt_f32_i32 v104, v88
    v_cvt_f32_i32 v105, v89
    v_cvt_f32_i32 v106, v90
    v_cvt_f32_i32 v107, v91
    s_add_u32 s71, s71, 3072
    buffer_load_dwordx4 v[88:91], v1, s[28:31], s71 offen offset:0 nt
    v_fmac_f32_dpp v176, v194, v104 row_newbcast:15 row_mask:0xf bank_mask:0xf
    v_fmac_f32_dpp v177, v194, v105 row_newbcast:15 row_mask:0xf bank_mask:0xf
    v_fmac_f32_dpp v178, v194, v106 row_newbcast:15 row_mask:0xf bank_mask:0xf
    v_fmac_f32_dpp v179, v194, v107 row_newbcast:15 row_mask:0xf bank_mask:0xf
    s_waitcnt vmcnt(25)
    v_cvt_f32_i32 v100, v92
    v_cvt_f32_i32 v101, v93
    v_cvt_f32_i32 v102, v94
    v_cvt_f32_i32 v103, v95
    buffer_load_dwordx4 v[92:95], v1, s[28:31], s71 offen offset:256 nt
    v_fmac_f32_dpp v180, v194, v100 row_newbcast:15 row_mask:0xf bank_mask:0xf
    v_fmac_f32_dpp v181, v194, v101 row_newbcast:15 row_mask:0xf bank_mask:0xf
    v_fmac_f32_dpp v182, v194, v102 row_newbcast:15 row_mask:0xf bank_mask:0xf
    v_fmac_f32_dpp v183, v194, v103 row_newbcast:15 row_mask:0xf bank_mask:0xf
    s_waitcnt vmcnt(25)
    v_cvt_f32_i32 v104, v96
    v_cvt_f32_i32 v105, v97
    v_cvt_f32_i32 v106, v98
    v_cvt_f32_i32 v107, v99
    buffer_load_dwordx4 v[96:99], v1, s[28:31], s71 offen offset:512 nt
    v_fmac_f32_dpp v184, v194, v104 row_newbcast:15 row_mask:0xf bank_mask:0xf
    v_fmac_f32_dpp v185, v194, v105 row_newbcast:15 row_mask:0xf bank_mask:0xf
    v_fmac_f32_dpp v186, v194, v106 row_newbcast:15 row_mask:0xf bank_mask:0xf
    v_fmac_f32_dpp v187, v194, v107 row_newbcast:15 row_mask:0xf bank_mask:0xf
    s_sub_u32 s77, s77, 1
    s_cmp_lg_u32 s77, 0
    s_cbranch_scc1 L_nofl2
    s_nop 0
    v_add_f32_dpp v189, v189, v189 row_ror:8 row_mask:0xf bank_mask:0xf
    v_add_f32_dpp v190, v190, v190 row_ror:8 row_mask:0xf bank_mask:0xf
    s_nop 0
    v_add_f32_dpp v189, v189, v189 row_ror:4 row_mask:0xf bank_mask:0xf
    v_add_f32_dpp v190, v190, v190 row_ror:4 row_mask:0xf bank_mask:0xf
    s_nop 0
    v_add_f32_dpp v189, v189, v189 row_ror:2 row_mask:0xf bank_mask:0xf
    v_add_f32_dpp v190, v190, v190 row_ror:2 row_mask:0xf bank_mask:0xf
    s_nop 0
    v_add_f32_dpp v189, v189, v189 row_ror:1 row_mask:0xf bank_mask:0xf
    v_add_f32_dpp v190, v190, v190 row_ror:1 row_mask:0xf bank_mask:0xf
    v_mov_b32 v206, v188
    v_mov_b32 v207, v188
    s_nop 1
    v_permlane32_swap_b32 v206, v207
    s_nop 1
    v_max_f32 v206, v206, v207
    v_mov_b32 v207, v206
    s_nop 1
    v_permlane16_swap_b32 v206, v207
    s_nop 1
    v_max_f32 v206, v206, v207
    v_sub_f32 v207, v188, v206
    v_exp_f32 v207, v207
    v_mov_b32 v104, v206
    v_mul_f32 v189, v189, v207
    v_mul_f32 v190, v190, v207
    v_fma_f32 v176, v176, v207, -v190
    v_fma_f32 v177, v177, v207, -v190
    v_fma_f32 v178, v178, v207, -v190
    v_fma_f32 v179, v179, v207, -v190
    v_fma_f32 v180, v180, v207, -v190
    v_fma_f32 v181, v181, v207, -v190
    v_fma_f32 v182, v182, v207, -v190
    v_fma_f32 v183, v183, v207, -v190
    v_fma_f32 v184, v184, v207, -v190
    v_fma_f32 v185, v185, v207, -v190
    v_fma_f32 v186, v186, v207, -v190
    v_fma_f32 v187, v187, v207, -v190
    v_mov_b32 v206, v189
    s_nop 1
    v_permlane32_swap_b32 v189, v206
    v_permlane32_swap_b32 v176, v178
    v_permlane32_swap_b32 v177, v179
    v_permlane32_swap_b32 v180, v182
    v_permlane32_swap_b32 v181, v183
    v_permlane32_swap_b32 v184, v186
    v_permlane32_swap_b32 v185, v187
    s_nop 1
    v_add_f32 v189, v189, v206
    v_add_f32 v176, v176, v178
    v_add_f32 v177, v177, v179
    v_add_f32 v180, v180, v182
    v_add_f32 v181, v181, v183
    v_add_f32 v184, v184, v186
    v_add_f32 v185, v185, v187
    v_mov_b32 v206, v189
    s_nop 1
    v_permlane16_swap_b32 v189, v206
    v_permlane16_swap_b32 v176, v177
    v_permlane16_swap_b32 v180, v181
    v_permlane16_swap_b32 v184, v185
    s_nop 1
    v_add_f32 v105, v189, v206
    v_add_f32 v100, v176, v177
    v_add_f32 v101, v180, v181
    v_add_f32 v102, v184, v185
    v_cndmask_b32 v103, v104, v105, s[66:67]
    ds_write_b128 v210, v[100:103] offset:3328
    v_mov_b32 v188, 0xf149f2ca
    v_mov_b32 v189, 0
    v_mov_b32 v190, 0
    v_mov_b32 v176, 0
    v_mov_b32 v177, 0
    v_mov_b32 v178, 0
    v_mov_b32 v179, 0
    v_mov_b32 v180, 0
    v_mov_b32 v181, 0
    v_mov_b32 v182, 0
    v_mov_b32 v183, 0
    v_mov_b32 v184, 0
    v_mov_b32 v185, 0
    v_mov_b32 v186, 0
    v_mov_b32 v187, 0
    s_waitcnt lgkmcnt(0)
    s_mov_b64 exec, 1
    ds_add_u32 v211, v212
    s_mov_b64 exec, -1
    v_add_u32 v210, 1024, v210
    v_add_u32 v211, 4, v211
    s_mov_b32 s77, 8
L_nofl2:
    s_sub_u32 s76, s76, 1
    s_cmp_lg_u32 s76, 0
    s_cbranch_scc1 L_loop1
L_tagw:
    ds_read_b32 v199, v212 offset:139
    s_waitcnt lgkmcnt(0)
    v_readfirstlane_b32 s93, v199
    s_cmp_eq_u32 s93, 0
    s_cbranch_scc1 L_tagw
    s_waitcnt vmcnt(24)
    v_lshlrev_b32 v192, 16, v192
    v_lshlrev_b32 v193, 16, v193
    s_waitcnt lgkmcnt(0)
    v_max_f32_dpp v206, v195, v195 row_ror:8 row_mask:0xf bank_mask:0xf
    s_nop 1
    v_max_f32_dpp v206, v206, v206 row_ror:4 row_mask:0xf bank_mask:0xf
    s_nop 1
    v_max_f32_dpp v206, v206, v206 row_ror:2 row_mask:0xf bank_mask:0xf
    s_nop 1
    v_max_f32_dpp v206, v206, v206 row_ror:1 row_mask:0xf bank_mask:0xf
    v_max_f32 v206, v206, v188
    v_sub_f32 v207, v188, v206
    v_sub_f32 v194, v195, v206
    v_exp_f32 v207, v207
    v_exp_f32 v194, v194
    v_mov_b32 v188, v206
    v_fma_f32 v189, v189, v207, v194
    v_mul_f32 v194, v194, v192
    v_mul_f32 v190, v190, v207
    v_fmac_f32 v190, v194, v193
    v_mul_f32 v176, v176, v207
    v_mul_f32 v177, v177, v207
    v_mul_f32 v178, v178, v207
    v_mul_f32 v179, v179, v207
    v_mul_f32 v180, v180, v207
    v_mul_f32 v181, v181, v207
    v_mul_f32 v182, v182, v207
    v_mul_f32 v183, v183, v207
    v_mul_f32 v184, v184, v207
    v_mul_f32 v185, v185, v207
    v_mul_f32 v186, v186, v207
    v_mul_f32 v187, v187, v207
    s_waitcnt vmcnt(23)
    v_cvt_f32_i32 v100, v4
    v_cvt_f32_i32 v101, v5
    v_cvt_f32_i32 v102, v6
    v_cvt_f32_i32 v103, v7
    s_add_u32 s71, s71, 1551360
    buffer_load_dwordx4 v[4:7], v1, s[28:31], s71 offen offset:0 nt
    v_fmac_f32_dpp v176, v194, v100 row_newbcast:0 row_mask:0xf bank_mask:0xf
    v_fmac_f32_dpp v177, v194, v101 row_newbcast:0 row_mask:0xf bank_mask:0xf
    v_fmac_f32_dpp v178, v194, v102 row_newbcast:0 row_mask:0xf bank_mask:0xf
    v_fmac_f32_dpp v179, v194, v103 row_newbcast:0 row_mask:0xf bank_mask:0xf
    s_waitcnt vmcnt(23)
    v_cvt_f32_i32 v104, v8
    v_cvt_f32_i32 v105, v9
    v_cvt_f32_i32 v106, v10
    v_cvt_f32_i32 v107, v11
    buffer_load_dwordx4 v[8:11], v1, s[28:31], s71 offen offset:256 nt
    v_fmac_f32_dpp v180, v194, v104 row_newbcast:0 row_mask:0xf bank_mask:0xf
    v_fmac_f32_dpp v181, v194, v105 row_newbcast:0 row_mask:0xf bank_mask:0xf
    v_fmac_f32_dpp v182, v194, v106 row_newbcast:0 row_mask:0xf bank_mask:0xf
    v_fmac_f32_dpp v183, v194, v107 row_newbcast:0 row_mask:0xf bank_mask:0xf
    s_waitcnt vmcnt(23)
    v_cvt_f32_i32 v100, v12
    v_cvt_f32_i32 v101, v13
    v_cvt_f32_i32 v102, v14
    v_cvt_f32_i32 v103, v15
    buffer_load_dwordx4 v[12:15], v1, s[28:31], s71 offen offset:512 nt
    v_fmac_f32_dpp v184, v194, v100 row_newbcast:0 row_mask:0xf bank_mask:0xf
    v_fmac_f32_dpp v185, v194, v101 row_newbcast:0 row_mask:0xf bank_mask:0xf
    v_fmac_f32_dpp v186, v194, v102 row_newbcast:0 row_mask:0xf bank_mask:0xf
    v_fmac_f32_dpp v187, v194, v103 row_newbcast:0 row_mask:0xf bank_mask:0xf
    s_waitcnt vmcnt(23)
    v_cvt_f32_i32 v104, v16
    v_cvt_f32_i32 v105, v17
    v_cvt_f32_i32 v106, v18
    v_cvt_f32_i32 v107, v19
    s_add_u32 s71, s71, 3072
    buffer_load_dwordx4 v[16:19], v1, s[28:31], s71 offen offset:0 nt
    v_fmac_f32_dpp v176, v194, v104 row_newbcast:8 row_mask:0xf bank_mask:0xf
    v_fmac_f32_dpp v177, v194, v105 row_newbcast:8 row_mask:0xf bank_mask:0xf
    v_fmac_f32_dpp v178, v194, v106 row_newbcast:8 row_mask:0xf bank_mask:0xf
    v_fmac_f32_dpp v179, v194, v107 row_newbcast:8 row_mask:0xf bank_mask:0xf
    s_waitcnt vmcnt(23)
    v_cvt_f32_i32 v100, v20
    v_cvt_f32_i32 v101, v21
    v_cvt_f32_i32 v102, v22
    v_cvt_f32_i32 v103, v23
    buffer_load_dwordx4 v[20:23], v1, s[28:31], s71 offen offset:256 nt
    v_fmac_f32_dpp v180, v194, v100 row_newbcast:8 row_mask:0xf bank_mask:0xf
    v_fmac_f32_dpp v181, v194, v101 row_newbcast:8 row_mask:0xf bank_mask:0xf
    v_fmac_f32_dpp v182, v194, v102 row_newbcast:8 row_mask:0xf bank_mask:0xf
    v_fmac_f32_dpp v183, v194, v103 row_newbcast:8 row_mask:0xf bank_mask:0xf
    s_waitcnt vmcnt(23)
    v_cvt_f32_i32 v104, v24
    v_cvt_f32_i32 v105, v25
    v_cvt_f32_i32 v106, v26
    v_cvt_f32_i32 v107, v27
    buffer_load_dwordx4 v[24:27], v1, s[28:31], s71 offen offset:512 nt
    v_fmac_f32_dpp v184, v194, v104 row_newbcast:8 row_mask:0xf bank_mask:0xf
    v_fmac_f32_dpp v185, v194, v105 row_newbcast:8 row_mask:0xf bank_mask:0xf
    v_fmac_f32_dpp v186, v194, v106 row_newbcast:8 row_mask:0xf bank_mask:0xf
    v_fmac_f32_dpp v187, v194, v107 row_newbcast:8 row_mask:0xf bank_mask:0xf
    s_waitcnt vmcnt(23)
    v_cvt_f32_i32 v100, v28
    v_cvt_f32_i32 v101, v29
    v_cvt_f32_i32 v102, v30
    v_cvt_f32_i32 v103, v31
    s_add_u32 s71, s71, 3072
    buffer_load_dwordx4 v[28:31], v1, s[28:31], s71 offen offset:0 nt
    v_fmac_f32_dpp v176, v194, v100 row_newbcast:4 row_mask:0xf bank_mask:0xf
    v_fmac_f32_dpp v177, v194, v101 row_newbcast:4 row_mask:0xf bank_mask:0xf
    v_fmac_f32_dpp v178, v194, v102 row_newbcast:4 row_mask:0xf bank_mask:0xf
    v_fmac_f32_dpp v179, v194, v103 row_newbcast:4 row_mask:0xf bank_mask:0xf
    s_waitcnt vmcnt(23)
    v_cvt_f32_i32 v104, v32
    v_cvt_f32_i32 v105, v33
    v_cvt_f32_i32 v106, v34
    v_cvt_f32_i32 v107, v35
    buffer_load_dwordx4 v[32:35], v1, s[28:31], s71 offen offset:256 nt
    v_fmac_f32_dpp v180, v194, v104 row_newbcast:4 row_mask:0xf bank_mask:0xf
    v_fmac_f32_dpp v181, v194, v105 row_newbcast:4 row_mask:0xf bank_mask:0xf
    v_fmac_f32_dpp v182, v194, v106 row_newbcast:4 row_mask:0xf bank_mask:0xf
    v_fmac_f32_dpp v183, v194, v107 row_newbcast:4 row_mask:0xf bank_mask:0xf
    s_waitcnt vmcnt(23)
    v_cvt_f32_i32 v100, v36
    v_cvt_f32_i32 v101, v37
    v_cvt_f32_i32 v102, v38
    v_cvt_f32_i32 v103, v39
    buffer_load_dwordx4 v[36:39], v1, s[28:31], s71 offen offset:512 nt
    v_fmac_f32_dpp v184, v194, v100 row_newbcast:4 row_mask:0xf bank_mask:0xf
    v_fmac_f32_dpp v185, v194, v101 row_newbcast:4 row_mask:0xf bank_mask:0xf
    v_fmac_f32_dpp v186, v194, v102 row_newbcast:4 row_mask:0xf bank_mask:0xf
    v_fmac_f32_dpp v187, v194, v103 row_newbcast:4 row_mask:0xf bank_mask:0xf
    s_waitcnt vmcnt(23)
    v_cvt_f32_i32 v104, v40
    v_cvt_f32_i32 v105, v41
    v_cvt_f32_i32 v106, v42
    v_cvt_f32_i32 v107, v43
    s_add_u32 s71, s71, 3072
    buffer_load_dwordx4 v[40:43], v1, s[28:31], s71 offen offset:0 nt
    v_fmac_f32_dpp v176, v194, v104 row_newbcast:12 row_mask:0xf bank_mask:0xf
    v_fmac_f32_dpp v177, v194, v105 row_newbcast:12 row_mask:0xf bank_mask:0xf
    v_fmac_f32_dpp v178, v194, v106 row_newbcast:12 row_mask:0xf bank_mask:0xf
    v_fmac_f32_dpp v179, v194, v107 row_newbcast:12 row_mask:0xf bank_mask:0xf
    s_waitcnt vmcnt(23)
    v_cvt_f32_i32 v100, v44
    v_cvt_f32_i32 v101, v45
    v_cvt_f32_i32 v102, v46
    v_cvt_f32_i32 v103, v47
    buffer_load_dwordx4 v[44:47], v1, s[28:31], s71 offen offset:256 nt
    v_fmac_f32_dpp v180, v194, v100 row_newbcast:12 row_mask:0xf bank_mask:0xf
    v_fmac_f32_dpp v181, v194, v101 row_newbcast:12 row_mask:0xf bank_mask:0xf
    v_fmac_f32_dpp v182, v194, v102 row_newbcast:12 row_mask:0xf bank_mask:0xf
    v_fmac_f32_dpp v183, v194, v103 row_newbcast:12 row_mask:0xf bank_mask:0xf
    s_waitcnt vmcnt(23)
    v_cvt_f32_i32 v104, v48
    v_cvt_f32_i32 v105, v49
    v_cvt_f32_i32 v106, v50
    v_cvt_f32_i32 v107, v51
    buffer_load_dwordx4 v[48:51], v1, s[28:31], s71 offen offset:512 nt
    v_fmac_f32_dpp v184, v194, v104 row_newbcast:12 row_mask:0xf bank_mask:0xf
    v_fmac_f32_dpp v185, v194, v105 row_newbcast:12 row_mask:0xf bank_mask:0xf
    v_fmac_f32_dpp v186, v194, v106 row_newbcast:12 row_mask:0xf bank_mask:0xf
    v_fmac_f32_dpp v187, v194, v107 row_newbcast:12 row_mask:0xf bank_mask:0xf
    s_waitcnt vmcnt(23)
    v_cvt_f32_i32 v100, v52
    v_cvt_f32_i32 v101, v53
    v_cvt_f32_i32 v102, v54
    v_cvt_f32_i32 v103, v55
    s_add_u32 s71, s71, 3072
    buffer_load_dwordx4 v[52:55], v1, s[28:31], s71 offen offset:0 nt
    v_fmac_f32_dpp v176, v194, v100 row_newbcast:2 row_mask:0xf bank_mask:0xf
    v_fmac_f32_dpp v177, v194, v101 row_newbcast:2 row_mask:0xf bank_mask:0xf
    v_fmac_f32_dpp v178, v194, v102 row_newbcast:2 row_mask:0xf bank_mask:0xf
    v_fmac_f32_dpp v179, v194, v103 row_newbcast:2 row_mask:0xf bank_mask:0xf
    s_waitcnt vmcnt(23)
    v_cvt_f32_i32 v104, v56
    v_cvt_f32_i32 v105, v57
    v_cvt_f32_i32 v106, v58
    v_cvt_f32_i32 v107, v59
    buffer_load_dwordx4 v[56:59], v1, s[28:31], s71 offen offset:256 nt
    v_fmac_f32_dpp v180, v194, v104 row_newbcast:2 row_mask:0xf bank_mask:0xf
    v_fmac_f32_dpp v181, v194, v105 row_newbcast:2 row_mask:0xf bank_mask:0xf
    v_fmac_f32_dpp v182, v194, v106 row_newbcast:2 row_mask:0xf bank_mask:0xf
    v_fmac_f32_dpp v183, v194, v107 row_newbcast:2 row_mask:0xf bank_mask:0xf
    s_waitcnt vmcnt(23)
    v_cvt_f32_i32 v100, v60
    v_cvt_f32_i32 v101, v61
    v_cvt_f32_i32 v102, v62
    v_cvt_f32_i32 v103, v63
    buffer_load_dwordx4 v[60:63], v1, s[28:31], s71 offen offset:512 nt
    v_fmac_f32_dpp v184, v194, v100 row_newbcast:2 row_mask:0xf bank_mask:0xf
    v_fmac_f32_dpp v185, v194, v101 row_newbcast:2 row_mask:0xf bank_mask:0xf
    v_fmac_f32_dpp v186, v194, v102 row_newbcast:2 row_mask:0xf bank_mask:0xf
    v_fmac_f32_dpp v187, v194, v103 row_newbcast:2 row_mask:0xf bank_mask:0xf
    s_waitcnt vmcnt(23)
    v_cvt_f32_i32 v104, v64
    v_cvt_f32_i32 v105, v65
    v_cvt_f32_i32 v106, v66
    v_cvt_f32_i32 v107, v67
    s_add_u32 s71, s71, 3072
    buffer_load_dwordx4 v[64:67], v1, s[28:31], s71 offen offset:0 nt
    v_fmac_f32_dpp v176, v194, v104 row_newbcast:10 row_mask:0xf bank_mask:0xf
    v_fmac_f32_dpp v177, v194, v105 row_newbcast:10 row_mask:0xf bank_mask:0xf
    v_fmac_f32_dpp v178, v194, v106 row_newbcast:10 row_mask:0xf bank_mask:0xf
    v_fmac_f32_dpp v179, v194, v107 row_newbcast:10 row_mask:0xf bank_mask:0xf
    s_waitcnt vmcnt(23)
    v_cvt_f32_i32 v100, v68
    v_cvt_f32_i32 v101, v69
    v_cvt_f32_i32 v102, v70
    v_cvt_f32_i32 v103, v71
    buffer_load_dwordx4 v[68:71], v1, s[28:31], s71 offen offset:256 nt
    v_fmac_f32_dpp v180, v194, v100 row_newbcast:10 row_mask:0xf bank_mask:0xf
    v_fmac_f32_dpp v181, v194, v101 row_newbcast:10 row_mask:0xf bank_mask:0xf
    v_fmac_f32_dpp v182, v194, v102 row_newbcast:10 row_mask:0xf bank_mask:0xf
    v_fmac_f32_dpp v183, v194, v103 row_newbcast:10 row_mask:0xf bank_mask:0xf
    s_waitcnt vmcnt(23)
    v_cvt_f32_i32 v104, v72
    v_cvt_f32_i32 v105, v73
    v_cvt_f32_i32 v106, v74
    v_cvt_f32_i32 v107, v75
    buffer_load_dwordx4 v[72:75], v1, s[28:31], s71 offen offset:512 nt
    v_fmac_f32_dpp v184, v194, v104 row_newbcast:10 row_mask:0xf bank_mask:0xf
    v_fmac_f32_dpp v185, v194, v105 row_newbcast:10 row_mask:0xf bank_mask:0xf
    v_fmac_f32_dpp v186, v194, v106 row_newbcast:10 row_mask:0xf bank_mask:0xf
    v_fmac_f32_dpp v187, v194, v107 row_newbcast:10 row_mask:0xf bank_mask:0xf
    s_waitcnt vmcnt(23)
    v_cvt_f32_i32 v100, v76
    v_cvt_f32_i32 v101, v77
    v_cvt_f32_i32 v102, v78
    v_cvt_f32_i32 v103, v79
    s_add_u32 s71, s71, 3072
    buffer_load_dwordx4 v[76:79], v1, s[28:31], s71 offen offset:0 nt
    v_fmac_f32_dpp v176, v194, v100 row_newbcast:6 row_mask:0xf bank_mask:0xf
    v_fmac_f32_dpp v177, v194, v101 row_newbcast:6 row_mask:0xf bank_mask:0xf
    v_fmac_f32_dpp v178, v194, v102 row_newbcast:6 row_mask:0xf bank_mask:0xf
    v_fmac_f32_dpp v179, v194, v103 row_newbcast:6 row_mask:0xf bank_mask:0xf
    s_waitcnt vmcnt(23)
    v_cvt_f32_i32 v104, v80
    v_cvt_f32_i32 v105, v81
    v_cvt_f32_i32 v106, v82
    v_cvt_f32_i32 v107, v83
    buffer_load_dwordx4 v[80:83], v1, s[28:31], s71 offen offset:256 nt
    v_fmac_f32_dpp v180, v194, v104 row_newbcast:6 row_mask:0xf bank_mask:0xf
    v_fmac_f32_dpp v181, v194, v105 row_newbcast:6 row_mask:0xf bank_mask:0xf
    v_fmac_f32_dpp v182, v194, v106 row_newbcast:6 row_mask:0xf bank_mask:0xf
    v_fmac_f32_dpp v183, v194, v107 row_newbcast:6 row_mask:0xf bank_mask:0xf
    s_waitcnt vmcnt(23)
    v_cvt_f32_i32 v100, v84
    v_cvt_f32_i32 v101, v85
    v_cvt_f32_i32 v102, v86
    v_cvt_f32_i32 v103, v87
    buffer_load_dwordx4 v[84:87], v1, s[28:31], s71 offen offset:512 nt
    v_fmac_f32_dpp v184, v194, v100 row_newbcast:6 row_mask:0xf bank_mask:0xf
    v_fmac_f32_dpp v185, v194, v101 row_newbcast:6 row_mask:0xf bank_mask:0xf
    v_fmac_f32_dpp v186, v194, v102 row_newbcast:6 row_mask:0xf bank_mask:0xf
    v_fmac_f32_dpp v187, v194, v103 row_newbcast:6 row_mask:0xf bank_mask:0xf
    s_waitcnt vmcnt(23)
    v_cvt_f32_i32 v104, v88
    v_cvt_f32_i32 v105, v89
    v_cvt_f32_i32 v106, v90
    v_cvt_f32_i32 v107, v91
    s_add_u32 s71, s71, 3072
    buffer_load_dwordx4 v[88:91], v1, s[28:31], s71 offen offset:0 nt
    v_fmac_f32_dpp v176, v194, v104 row_newbcast:14 row_mask:0xf bank_mask:0xf
    v_fmac_f32_dpp v177, v194, v105 row_newbcast:14 row_mask:0xf bank_mask:0xf
    v_fmac_f32_dpp v178, v194, v106 row_newbcast:14 row_mask:0xf bank_mask:0xf
    v_fmac_f32_dpp v179, v194, v107 row_newbcast:14 row_mask:0xf bank_mask:0xf
    ds_read_b32 v199, v198
    s_waitcnt vmcnt(23)
    v_cvt_f32_i32 v100, v92
    v_cvt_f32_i32 v101, v93
    v_cvt_f32_i32 v102, v94
    v_cvt_f32_i32 v103, v95
    buffer_load_dwordx4 v[92:95], v1, s[28:31], s71 offen offset:256 nt
    v_fmac_f32_dpp v180, v194, v100 row_newbcast:14 row_mask:0xf bank_mask:0xf
    v_fmac_f32_dpp v181, v194, v101 row_newbcast:14 row_mask:0xf bank_mask:0xf
    v_fmac_f32_dpp v182, v194, v102 row_newbcast:14 row_mask:0xf bank_mask:0xf
    v_fmac_f32_dpp v183, v194, v103 row_newbcast:14 row_mask:0xf bank_mask:0xf
    s_waitcnt vmcnt(23)
    v_cvt_f32_i32 v104, v96
    v_cvt_f32_i32 v105, v97
    v_cvt_f32_i32 v106, v98
    v_cvt_f32_i32 v107, v99
    buffer_load_dwordx4 v[96:99], v1, s[28:31], s71 offen offset:512 nt
    v_fmac_f32_dpp v184, v194, v104 row_newbcast:14 row_mask:0xf bank_mask:0xf
    v_fmac_f32_dpp v185, v194, v105 row_newbcast:14 row_mask:0xf bank_mask:0xf
    v_fmac_f32_dpp v186, v194, v106 row_newbcast:14 row_mask:0xf bank_mask:0xf
    v_fmac_f32_dpp v187, v194, v107 row_newbcast:14 row_mask:0xf bank_mask:0xf
    s_waitcnt lgkmcnt(0)
    v_readfirstlane_b32 s80, v199
    s_cmp_lg_u32 s80, -1
    s_cbranch_scc1 L_tkoks
L_tkws:
    ds_read_b32 v199, v198
    s_waitcnt lgkmcnt(0)
    v_readfirstlane_b32 s80, v199
    s_cmp_eq_u32 s80, -1
    s_cbranch_scc1 L_tkws
L_tkoks:
    v_add_u32 v198, 4, v198
    s_cmp_ge_u32 s80, 256
    s_cbranch_scc1 L_dtail
    s_lshr_b32 s81, s80, 6
    s_and_b32 s80, s80, 63
    s_mul_i32 s56, s81, 64
    s_add_u32 s56, s56, s80
    s_add_u32 s56, s56, s94
    s_and_b32 s56, s56, 511
    s_mov_b32 s57, s59
    s_add_u32 s70, s57, s56
    s_and_b32 s95, s3, 192
    s_add_u32 s95, s95, s80
    s_lshl_b32 s95, s95, 3
    s_add_u32 s95, s95, s81
    s_lshl_b32 s95, s95, 8
    s_add_u32 s95, s95, 18874368
    s_waitcnt vmcnt(23)
    v_cvt_f32_i32 v100, v4
    v_cvt_f32_i32 v101, v5
    v_cvt_f32_i32 v102, v6
    v_cvt_f32_i32 v103, v7
    s_and_b32 s80, s70, 63
    s_mul_i32 s80, s80, 64
    s_lshl_b32 s73, s70, 7
    s_sub_u32 s73, s73, s80
    buffer_load_dword v195, v196, s[52:55], s95 offen sc0 sc1
    buffer_load_ushort v192, v3, s[40:43], s73 offen
    buffer_load_ushort v193, v3, s[44:47], s73 offen
    s_mul_i32 s71, s70, 49152
    s_and_b32 s80, s70, 63
    s_mul_i32 s80, s80, 24576
    s_sub_u32 s71, s71, s80
    buffer_load_dwordx4 v[4:7], v1, s[28:31], s71 offen offset:0 nt
    v_fmac_f32_dpp v176, v194, v100 row_newbcast:1 row_mask:0xf bank_mask:0xf
    v_fmac_f32_dpp v177, v194, v101 row_newbcast:1 row_mask:0xf bank_mask:0xf
    v_fmac_f32_dpp v178, v194, v102 row_newbcast:1 row_mask:0xf bank_mask:0xf
    v_fmac_f32_dpp v179, v194, v103 row_newbcast:1 row_mask:0xf bank_mask:0xf
    s_waitcnt vmcnt(26)
    v_cvt_f32_i32 v104, v8
    v_cvt_f32_i32 v105, v9
    v_cvt_f32_i32 v106, v10
    v_cvt_f32_i32 v107, v11
    buffer_load_dwordx4 v[8:11], v1, s[28:31], s71 offen offset:256 nt
    v_fmac_f32_dpp v180, v194, v104 row_newbcast:1 row_mask:0xf bank_mask:0xf
    v_fmac_f32_dpp v181, v194, v105 row_newbcast:1 row_mask:0xf bank_mask:0xf
    v_fmac_f32_dpp v182, v194, v106 row_newbcast:1 row_mask:0xf bank_mask:0xf
    v_fmac_f32_dpp v183, v194, v107 row_newbcast:1 row_mask:0xf bank_mask:0xf
    s_waitcnt vmcnt(26)
    v_cvt_f32_i32 v100, v12
    v_cvt_f32_i32 v101, v13
    v_cvt_f32_i32 v102, v14
    v_cvt_f32_i32 v103, v15
    buffer_load_dwordx4 v[12:15], v1, s[28:31], s71 offen offset:512 nt
    v_fmac_f32_dpp v184, v194, v100 row_newbcast:1 row_mask:0xf bank_mask:0xf
    v_fmac_f32_dpp v185, v194, v101 row_newbcast:1 row_mask:0xf bank_mask:0xf
    v_fmac_f32_dpp v186, v194, v102 row_newbcast:1 row_mask:0xf bank_mask:0xf
    v_fmac_f32_dpp v187, v194, v103 row_newbcast:1 row_mask:0xf bank_mask:0xf
    s_waitcnt vmcnt(26)
    v_cvt_f32_i32 v104, v16
    v_cvt_f32_i32 v105, v17
    v_cvt_f32_i32 v106, v18
    v_cvt_f32_i32 v107, v19
    s_add_u32 s71, s71, 3072
    buffer_load_dwordx4 v[16:19], v1, s[28:31], s71 offen offset:0 nt
    v_fmac_f32_dpp v176, v194, v104 row_newbcast:9 row_mask:0xf bank_mask:0xf
    v_fmac_f32_dpp v177, v194, v105 row_newbcast:9 row_mask:0xf bank_mask:0xf
    v_fmac_f32_dpp v178, v194, v106 row_newbcast:9 row_mask:0xf bank_mask:0xf
    v_fmac_f32_dpp v179, v194, v107 row_newbcast:9 row_mask:0xf bank_mask:0xf
    s_mov_b64 exec, 1
    ds_add_u32 v212, v212 offset:131
    s_mov_b64 exec, -1
    s_waitcnt vmcnt(26)
    v_cvt_f32_i32 v100, v20
    v_cvt_f32_i32 v101, v21
    v_cvt_f32_i32 v102, v22
    v_cvt_f32_i32 v103, v23
    buffer_load_dwordx4 v[20:23], v1, s[28:31], s71 offen offset:256 nt
    v_fmac_f32_dpp v180, v194, v100 row_newbcast:9 row_mask:0xf bank_mask:0xf
    v_fmac_f32_dpp v181, v194, v101 row_newbcast:9 row_mask:0xf bank_mask:0xf
    v_fmac_f32_dpp v182, v194, v102 row_newbcast:9 row_mask:0xf bank_mask:0xf
    v_fmac_f32_dpp v183, v194, v103 row_newbcast:9 row_mask:0xf bank_mask:0xf
    s_waitcnt vmcnt(26)
    v_cvt_f32_i32 v104, v24
    v_cvt_f32_i32 v105, v25
    v_cvt_f32_i32 v106, v26
    v_cvt_f32_i32 v107, v27
    buffer_load_dwordx4 v[24:27], v1, s[28:31], s71 offen offset:512 nt
    v_fmac_f32_dpp v184, v194, v104 row_newbcast:9 row_mask:0xf bank_mask:0xf
    v_fmac_f32_dpp v185, v194, v105 row_newbcast:9 row_mask:0xf bank_mask:0xf
    v_fmac_f32_dpp v186, v194, v106 row_newbcast:9 row_mask:0xf bank_mask:0xf
    v_fmac_f32_dpp v187, v194, v107 row_newbcast:9 row_mask:0xf bank_mask:0xf
    s_waitcnt vmcnt(26)
    v_cvt_f32_i32 v100, v28
    v_cvt_f32_i32 v101, v29
    v_cvt_f32_i32 v102, v30
    v_cvt_f32_i32 v103, v31
    s_add_u32 s71, s71, 3072
    buffer_load_dwordx4 v[28:31], v1, s[28:31], s71 offen offset:0 nt
    v_fmac_f32_dpp v176, v194, v100 row_newbcast:5 row_mask:0xf bank_mask:0xf
    v_fmac_f32_dpp v177, v194, v101 row_newbcast:5 row_mask:0xf bank_mask:0xf
    v_fmac_f32_dpp v178, v194, v102 row_newbcast:5 row_mask:0xf bank_mask:0xf
    v_fmac_f32_dpp v179, v194, v103 row_newbcast:5 row_mask:0xf bank_mask:0xf
    s_waitcnt vmcnt(26)
    v_cvt_f32_i32 v104, v32
    v_cvt_f32_i32 v105, v33
    v_cvt_f32_i32 v106, v34
    v_cvt_f32_i32 v107, v35
    buffer_load_dwordx4 v[32:35], v1, s[28:31], s71 offen offset:256 nt
    v_fmac_f32_dpp v180, v194, v104 row_newbcast:5 row_mask:0xf bank_mask:0xf
    v_fmac_f32_dpp v181, v194, v105 row_newbcast:5 row_mask:0xf bank_mask:0xf
    v_fmac_f32_dpp v182, v194, v106 row_newbcast:5 row_mask:0xf bank_mask:0xf
    v_fmac_f32_dpp v183, v194, v107 row_newbcast:5 row_mask:0xf bank_mask:0xf
    s_waitcnt vmcnt(26)
    v_cvt_f32_i32 v100, v36
    v_cvt_f32_i32 v101, v37
    v_cvt_f32_i32 v102, v38
    v_cvt_f32_i32 v103, v39
    buffer_load_dwordx4 v[36:39], v1, s[28:31], s71 offen offset:512 nt
    v_fmac_f32_dpp v184, v194, v100 row_newbcast:5 row_mask:0xf bank_mask:0xf
    v_fmac_f32_dpp v185, v194, v101 row_newbcast:5 row_mask:0xf bank_mask:0xf
    v_fmac_f32_dpp v186, v194, v102 row_newbcast:5 row_mask:0xf bank_mask:0xf
    v_fmac_f32_dpp v187, v194, v103 row_newbcast:5 row_mask:0xf bank_mask:0xf
    s_waitcnt vmcnt(26)
    v_cvt_f32_i32 v104, v40
    v_cvt_f32_i32 v105, v41
    v_cvt_f32_i32 v106, v42
    v_cvt_f32_i32 v107, v43
    s_add_u32 s71, s71, 3072
    buffer_load_dwordx4 v[40:43], v1, s[28:31], s71 offen offset:0 nt
    v_fmac_f32_dpp v176, v194, v104 row_newbcast:13 row_mask:0xf bank_mask:0xf
    v_fmac_f32_dpp v177, v194, v105 row_newbcast:13 row_mask:0xf bank_mask:0xf
    v_fmac_f32_dpp v178, v194, v106 row_newbcast:13 row_mask:0xf bank_mask:0xf
    v_fmac_f32_dpp v179, v194, v107 row_newbcast:13 row_mask:0xf bank_mask:0xf
    s_waitcnt vmcnt(26)
    v_cvt_f32_i32 v100, v44
    v_cvt_f32_i32 v101, v45
    v_cvt_f32_i32 v102, v46
    v_cvt_f32_i32 v103, v47
    buffer_load_dwordx4 v[44:47], v1, s[28:31], s71 offen offset:256 nt
    v_fmac_f32_dpp v180, v194, v100 row_newbcast:13 row_mask:0xf bank_mask:0xf
    v_fmac_f32_dpp v181, v194, v101 row_newbcast:13 row_mask:0xf bank_mask:0xf
    v_fmac_f32_dpp v182, v194, v102 row_newbcast:13 row_mask:0xf bank_mask:0xf
    v_fmac_f32_dpp v183, v194, v103 row_newbcast:13 row_mask:0xf bank_mask:0xf
    s_waitcnt vmcnt(26)
    v_cvt_f32_i32 v104, v48
    v_cvt_f32_i32 v105, v49
    v_cvt_f32_i32 v106, v50
    v_cvt_f32_i32 v107, v51
    buffer_load_dwordx4 v[48:51], v1, s[28:31], s71 offen offset:512 nt
    v_fmac_f32_dpp v184, v194, v104 row_newbcast:13 row_mask:0xf bank_mask:0xf
    v_fmac_f32_dpp v185, v194, v105 row_newbcast:13 row_mask:0xf bank_mask:0xf
    v_fmac_f32_dpp v186, v194, v106 row_newbcast:13 row_mask:0xf bank_mask:0xf
    v_fmac_f32_dpp v187, v194, v107 row_newbcast:13 row_mask:0xf bank_mask:0xf
    s_waitcnt vmcnt(26)
    v_cvt_f32_i32 v100, v52
    v_cvt_f32_i32 v101, v53
    v_cvt_f32_i32 v102, v54
    v_cvt_f32_i32 v103, v55
    s_add_u32 s71, s71, 3072
    buffer_load_dwordx4 v[52:55], v1, s[28:31], s71 offen offset:0 nt
    v_fmac_f32_dpp v176, v194, v100 row_newbcast:3 row_mask:0xf bank_mask:0xf
    v_fmac_f32_dpp v177, v194, v101 row_newbcast:3 row_mask:0xf bank_mask:0xf
    v_fmac_f32_dpp v178, v194, v102 row_newbcast:3 row_mask:0xf bank_mask:0xf
    v_fmac_f32_dpp v179, v194, v103 row_newbcast:3 row_mask:0xf bank_mask:0xf
    s_waitcnt vmcnt(26)
    v_cvt_f32_i32 v104, v56
    v_cvt_f32_i32 v105, v57
    v_cvt_f32_i32 v106, v58
    v_cvt_f32_i32 v107, v59
    buffer_load_dwordx4 v[56:59], v1, s[28:31], s71 offen offset:256 nt
    v_fmac_f32_dpp v180, v194, v104 row_newbcast:3 row_mask:0xf bank_mask:0xf
    v_fmac_f32_dpp v181, v194, v105 row_newbcast:3 row_mask:0xf bank_mask:0xf
    v_fmac_f32_dpp v182, v194, v106 row_newbcast:3 row_mask:0xf bank_mask:0xf
    v_fmac_f32_dpp v183, v194, v107 row_newbcast:3 row_mask:0xf bank_mask:0xf
    s_waitcnt vmcnt(26)
    v_cvt_f32_i32 v100, v60
    v_cvt_f32_i32 v101, v61
    v_cvt_f32_i32 v102, v62
    v_cvt_f32_i32 v103, v63
    buffer_load_dwordx4 v[60:63], v1, s[28:31], s71 offen offset:512 nt
    v_fmac_f32_dpp v184, v194, v100 row_newbcast:3 row_mask:0xf bank_mask:0xf
    v_fmac_f32_dpp v185, v194, v101 row_newbcast:3 row_mask:0xf bank_mask:0xf
    v_fmac_f32_dpp v186, v194, v102 row_newbcast:3 row_mask:0xf bank_mask:0xf
    v_fmac_f32_dpp v187, v194, v103 row_newbcast:3 row_mask:0xf bank_mask:0xf
    s_waitcnt vmcnt(26)
    v_cvt_f32_i32 v104, v64
    v_cvt_f32_i32 v105, v65
    v_cvt_f32_i32 v106, v66
    v_cvt_f32_i32 v107, v67
    s_add_u32 s71, s71, 3072
    buffer_load_dwordx4 v[64:67], v1, s[28:31], s71 offen offset:0 nt
    v_fmac_f32_dpp v176, v194, v104 row_newbcast:11 row_mask:0xf bank_mask:0xf
    v_fmac_f32_dpp v177, v194, v105 row_newbcast:11 row_mask:0xf bank_mask:0xf
    v_fmac_f32_dpp v178, v194, v106 row_newbcast:11 row_mask:0xf bank_mask:0xf
    v_fmac_f32_dpp v179, v194, v107 row_newbcast:11 row_mask:0xf bank_mask:0xf
    s_waitcnt vmcnt(26)
    v_cvt_f32_i32 v100, v68
    v_cvt_f32_i32 v101, v69
    v_cvt_f32_i32 v102, v70
    v_cvt_f32_i32 v103, v71
    buffer_load_dwordx4 v[68:71], v1, s[28:31], s71 offen offset:256 nt
    v_fmac_f32_dpp v180, v194, v100 row_newbcast:11 row_mask:0xf bank_mask:0xf
    v_fmac_f32_dpp v181, v194, v101 row_newbcast:11 row_mask:0xf bank_mask:0xf
    v_fmac_f32_dpp v182, v194, v102 row_newbcast:11 row_mask:0xf bank_mask:0xf
    v_fmac_f32_dpp v183, v194, v103 row_newbcast:11 row_mask:0xf bank_mask:0xf
    s_waitcnt vmcnt(26)
    v_cvt_f32_i32 v104, v72
    v_cvt_f32_i32 v105, v73
    v_cvt_f32_i32 v106, v74
    v_cvt_f32_i32 v107, v75
    buffer_load_dwordx4 v[72:75], v1, s[28:31], s71 offen offset:512 nt
    v_fmac_f32_dpp v184, v194, v104 row_newbcast:11 row_mask:0xf bank_mask:0xf
    v_fmac_f32_dpp v185, v194, v105 row_newbcast:11 row_mask:0xf bank_mask:0xf
    v_fmac_f32_dpp v186, v194, v106 row_newbcast:11 row_mask:0xf bank_mask:0xf
    v_fmac_f32_dpp v187, v194, v107 row_newbcast:11 row_mask:0xf bank_mask:0xf
    s_waitcnt vmcnt(26)
    v_cvt_f32_i32 v100, v76
    v_cvt_f32_i32 v101, v77
    v_cvt_f32_i32 v102, v78
    v_cvt_f32_i32 v103, v79
    s_add_u32 s71, s71, 3072
    buffer_load_dwordx4 v[76:79], v1, s[28:31], s71 offen offset:0 nt
    v_fmac_f32_dpp v176, v194, v100 row_newbcast:7 row_mask:0xf bank_mask:0xf
    v_fmac_f32_dpp v177, v194, v101 row_newbcast:7 row_mask:0xf bank_mask:0xf
    v_fmac_f32_dpp v178, v194, v102 row_newbcast:7 row_mask:0xf bank_mask:0xf
    v_fmac_f32_dpp v179, v194, v103 row_newbcast:7 row_mask:0xf bank_mask:0xf
    s_waitcnt vmcnt(26)
    v_cvt_f32_i32 v104, v80
    v_cvt_f32_i32 v105, v81
    v_cvt_f32_i32 v106, v82
    v_cvt_f32_i32 v107, v83
    buffer_load_dwordx4 v[80:83], v1, s[28:31], s71 offen offset:256 nt
    v_fmac_f32_dpp v180, v194, v104 row_newbcast:7 row_mask:0xf bank_mask:0xf
    v_fmac_f32_dpp v181, v194, v105 row_newbcast:7 row_mask:0xf bank_mask:0xf
    v_fmac_f32_dpp v182, v194, v106 row_newbcast:7 row_mask:0xf bank_mask:0xf
    v_fmac_f32_dpp v183, v194, v107 row_newbcast:7 row_mask:0xf bank_mask:0xf
    s_waitcnt vmcnt(26)
    v_cvt_f32_i32 v100, v84
    v_cvt_f32_i32 v101, v85
    v_cvt_f32_i32 v102, v86
    v_cvt_f32_i32 v103, v87
    buffer_load_dwordx4 v[84:87], v1, s[28:31], s71 offen offset:512 nt
    v_fmac_f32_dpp v184, v194, v100 row_newbcast:7 row_mask:0xf bank_mask:0xf
    v_fmac_f32_dpp v185, v194, v101 row_newbcast:7 row_mask:0xf bank_mask:0xf
    v_fmac_f32_dpp v186, v194, v102 row_newbcast:7 row_mask:0xf bank_mask:0xf
    v_fmac_f32_dpp v187, v194, v103 row_newbcast:7 row_mask:0xf bank_mask:0xf
    s_waitcnt vmcnt(26)
    v_cvt_f32_i32 v104, v88
    v_cvt_f32_i32 v105, v89
    v_cvt_f32_i32 v106, v90
    v_cvt_f32_i32 v107, v91
    s_add_u32 s71, s71, 3072
    buffer_load_dwordx4 v[88:91], v1, s[28:31], s71 offen offset:0 nt
    v_fmac_f32_dpp v176, v194, v104 row_newbcast:15 row_mask:0xf bank_mask:0xf
    v_fmac_f32_dpp v177, v194, v105 row_newbcast:15 row_mask:0xf bank_mask:0xf
    v_fmac_f32_dpp v178, v194, v106 row_newbcast:15 row_mask:0xf bank_mask:0xf
    v_fmac_f32_dpp v179, v194, v107 row_newbcast:15 row_mask:0xf bank_mask:0xf
    s_waitcnt vmcnt(26)
    v_cvt_f32_i32 v100, v92
    v_cvt_f32_i32 v101, v93
    v_cvt_f32_i32 v102, v94
    v_cvt_f32_i32 v103, v95
    buffer_load_dwordx4 v[92:95], v1, s[28:31], s71 offen offset:256 nt
    v_fmac_f32_dpp v180, v194, v100 row_newbcast:15 row_mask:0xf bank_mask:0xf
    v_fmac_f32_dpp v181, v194, v101 row_newbcast:15 row_mask:0xf bank_mask:0xf
    v_fmac_f32_dpp v182, v194, v102 row_newbcast:15 row_mask:0xf bank_mask:0xf
    v_fmac_f32_dpp v183, v194, v103 row_newbcast:15 row_mask:0xf bank_mask:0xf
    s_waitcnt vmcnt(26)
    v_cvt_f32_i32 v104, v96
    v_cvt_f32_i32 v105, v97
    v_cvt_f32_i32 v106, v98
    v_cvt_f32_i32 v107, v99
    buffer_load_dwordx4 v[96:99], v1, s[28:31], s71 offen offset:512 nt
    v_fmac_f32_dpp v184, v194, v104 row_newbcast:15 row_mask:0xf bank_mask:0xf
    v_fmac_f32_dpp v185, v194, v105 row_newbcast:15 row_mask:0xf bank_mask:0xf
    v_fmac_f32_dpp v186, v194, v106 row_newbcast:15 row_mask:0xf bank_mask:0xf
    v_fmac_f32_dpp v187, v194, v107 row_newbcast:15 row_mask:0xf bank_mask:0xf
    s_sub_u32 s77, s77, 1
    s_cmp_lg_u32 s77, 0
    s_cbranch_scc1 L_nofl3
    s_nop 0
    v_add_f32_dpp v189, v189, v189 row_ror:8 row_mask:0xf bank_mask:0xf
    v_add_f32_dpp v190, v190, v190 row_ror:8 row_mask:0xf bank_mask:0xf
    s_nop 0
    v_add_f32_dpp v189, v189, v189 row_ror:4 row_mask:0xf bank_mask:0xf
    v_add_f32_dpp v190, v190, v190 row_ror:4 row_mask:0xf bank_mask:0xf
    s_nop 0
    v_add_f32_dpp v189, v189, v189 row_ror:2 row_mask:0xf bank_mask:0xf
    v_add_f32_dpp v190, v190, v190 row_ror:2 row_mask:0xf bank_mask:0xf
    s_nop 0
    v_add_f32_dpp v189, v189, v189 row_ror:1 row_mask:0xf bank_mask:0xf
    v_add_f32_dpp v190, v190, v190 row_ror:1 row_mask:0xf bank_mask:0xf
    v_mov_b32 v206, v188
    v_mov_b32 v207, v188
    s_nop 1
    v_permlane32_swap_b32 v206, v207
    s_nop 1
    v_max_f32 v206, v206, v207
    v_mov_b32 v207, v206
    s_nop 1
    v_permlane16_swap_b32 v206, v207
    s_nop 1
    v_max_f32 v206, v206, v207
    v_sub_f32 v207, v188, v206
    v_exp_f32 v207, v207
    v_mov_b32 v104, v206
    v_mul_f32 v189, v189, v207
    v_mul_f32 v190, v190, v207
    v_fma_f32 v176, v176, v207, -v190
    v_fma_f32 v177, v177, v207, -v190
    v_fma_f32 v178, v178, v207, -v190
    v_fma_f32 v179, v179, v207, -v190
    v_fma_f32 v180, v180, v207, -v190
    v_fma_f32 v181, v181, v207, -v190
    v_fma_f32 v182, v182, v207, -v190
    v_fma_f32 v183, v183, v207, -v190
    v_fma_f32 v184, v184, v207, -v190
    v_fma_f32 v185, v185, v207, -v190
    v_fma_f32 v186, v186, v207, -v190
    v_fma_f32 v187, v187, v207, -v190
    v_mov_b32 v206, v189
    s_nop 1
    v_permlane32_swap_b32 v189, v206
    v_permlane32_swap_b32 v176, v178
    v_permlane32_swap_b32 v177, v179
    v_permlane32_swap_b32 v180, v182
    v_permlane32_swap_b32 v181, v183
    v_permlane32_swap_b32 v184, v186
    v_permlane32_swap_b32 v185, v187
    s_nop 1
    v_add_f32 v189, v189, v206
    v_add_f32 v176, v176, v178
    v_add_f32 v177, v177, v179
    v_add_f32 v180, v180, v182
    v_add_f32 v181, v181, v183
    v_add_f32 v184, v184, v186
    v_add_f32 v185, v185, v187
    v_mov_b32 v206, v189
    s_nop 1
    v_permlane16_swap_b32 v189, v206
    v_permlane16_swap_b32 v176, v177
    v_permlane16_swap_b32 v180, v181
    v_permlane16_swap_b32 v184, v185
    s_nop 1
    v_add_f32 v105, v189, v206
    v_add_f32 v100, v176, v177
    v_add_f32 v101, v180, v181
    v_add_f32 v102, v184, v185
    v_cndmask_b32 v103, v104, v105, s[66:67]
    ds_write_b128 v210, v[100:103] offset:3328
    v_mov_b32 v188, 0xf149f2ca
    v_mov_b32 v189, 0
    v_mov_b32 v190, 0
    v_mov_b32 v176, 0
    v_mov_b32 v177, 0
    v_mov_b32 v178, 0
    v_mov_b32 v179, 0
    v_mov_b32 v180, 0
    v_mov_b32 v181, 0
    v_mov_b32 v182, 0
    v_mov_b32 v183, 0
    v_mov_b32 v184, 0
    v_mov_b32 v185, 0
    v_mov_b32 v186, 0
    v_mov_b32 v187, 0
    s_waitcnt lgkmcnt(0)
    s_mov_b64 exec, 1
    ds_add_u32 v211, v212
    s_mov_b64 exec, -1
    v_add_u32 v210, 1024, v210
    v_add_u32 v211, 4, v211
    s_mov_b32 s77, 8
L_nofl3:
L_dloop:
    s_waitcnt vmcnt(24)
    v_lshlrev_b32 v192, 16, v192
    v_lshlrev_b32 v193, 16, v193
    v_max_f32_dpp v206, v195, v195 row_ror:8 row_mask:0xf bank_mask:0xf
    s_nop 1
    v_max_f32_dpp v206, v206, v206 row_ror:4 row_mask:0xf bank_mask:0xf
    s_nop 1
    v_max_f32_dpp v206, v206, v206 row_ror:2 row_mask:0xf bank_mask:0xf
    s_nop 1
    v_max_f32_dpp v206, v206, v206 row_ror:1 row_mask:0xf bank_mask:0xf
    v_max_f32 v206, v206, v188
    v_sub_f32 v207, v188, v206
    v_sub_f32 v194, v195, v206
    v_exp_f32 v207, v207
    v_exp_f32 v194, v194
    v_mov_b32 v188, v206
    v_fma_f32 v189, v189, v207, v194
    v_mul_f32 v194, v194, v192
    v_mul_f32 v190, v190, v207
    v_fmac_f32 v190, v194, v193
    v_mul_f32 v176, v176, v207
    v_mul_f32 v177, v177, v207
    v_mul_f32 v178, v178, v207
    v_mul_f32 v179, v179, v207
    v_mul_f32 v180, v180, v207
    v_mul_f32 v181, v181, v207
    v_mul_f32 v182, v182, v207
    v_mul_f32 v183, v183, v207
    v_mul_f32 v184, v184, v207
    v_mul_f32 v185, v185, v207
    v_mul_f32 v186, v186, v207
    v_mul_f32 v187, v187, v207
    s_waitcnt vmcnt(23)
    v_cvt_f32_i32 v100, v4
    v_cvt_f32_i32 v101, v5
    v_cvt_f32_i32 v102, v6
    v_cvt_f32_i32 v103, v7
    s_add_u32 s71, s71, 1551360
    buffer_load_dwordx4 v[4:7], v1, s[28:31], s71 offen offset:0 nt
    v_fmac_f32_dpp v176, v194, v100 row_newbcast:0 row_mask:0xf bank_mask:0xf
    v_fmac_f32_dpp v177, v194, v101 row_newbcast:0 row_mask:0xf bank_mask:0xf
    v_fmac_f32_dpp v178, v194, v102 row_newbcast:0 row_mask:0xf bank_mask:0xf
    v_fmac_f32_dpp v179, v194, v103 row_newbcast:0 row_mask:0xf bank_mask:0xf
    s_waitcnt vmcnt(23)
    v_cvt_f32_i32 v104, v8
    v_cvt_f32_i32 v105, v9
    v_cvt_f32_i32 v106, v10
    v_cvt_f32_i32 v107, v11
    buffer_load_dwordx4 v[8:11], v1, s[28:31], s71 offen offset:256 nt
    v_fmac_f32_dpp v180, v194, v104 row_newbcast:0 row_mask:0xf bank_mask:0xf
    v_fmac_f32_dpp v181, v194, v105 row_newbcast:0 row_mask:0xf bank_mask:0xf
    v_fmac_f32_dpp v182, v194, v106 row_newbcast:0 row_mask:0xf bank_mask:0xf
    v_fmac_f32_dpp v183, v194, v107 row_newbcast:0 row_mask:0xf bank_mask:0xf
    s_waitcnt vmcnt(23)
    v_cvt_f32_i32 v100, v12
    v_cvt_f32_i32 v101, v13
    v_cvt_f32_i32 v102, v14
    v_cvt_f32_i32 v103, v15
    buffer_load_dwordx4 v[12:15], v1, s[28:31], s71 offen offset:512 nt
    v_fmac_f32_dpp v184, v194, v100 row_newbcast:0 row_mask:0xf bank_mask:0xf
    v_fmac_f32_dpp v185, v194, v101 row_newbcast:0 row_mask:0xf bank_mask:0xf
    v_fmac_f32_dpp v186, v194, v102 row_newbcast:0 row_mask:0xf bank_mask:0xf
    v_fmac_f32_dpp v187, v194, v103 row_newbcast:0 row_mask:0xf bank_mask:0xf
    s_waitcnt vmcnt(23)
    v_cvt_f32_i32 v104, v16
    v_cvt_f32_i32 v105, v17
    v_cvt_f32_i32 v106, v18
    v_cvt_f32_i32 v107, v19
    s_add_u32 s71, s71, 3072
    buffer_load_dwordx4 v[16:19], v1, s[28:31], s71 offen offset:0 nt
    v_fmac_f32_dpp v176, v194, v104 row_newbcast:8 row_mask:0xf bank_mask:0xf
    v_fmac_f32_dpp v177, v194, v105 row_newbcast:8 row_mask:0xf bank_mask:0xf
    v_fmac_f32_dpp v178, v194, v106 row_newbcast:8 row_mask:0xf bank_mask:0xf
    v_fmac_f32_dpp v179, v194, v107 row_newbcast:8 row_mask:0xf bank_mask:0xf
    s_waitcnt vmcnt(23)
    v_cvt_f32_i32 v100, v20
    v_cvt_f32_i32 v101, v21
    v_cvt_f32_i32 v102, v22
    v_cvt_f32_i32 v103, v23
    buffer_load_dwordx4 v[20:23], v1, s[28:31], s71 offen offset:256 nt
    v_fmac_f32_dpp v180, v194, v100 row_newbcast:8 row_mask:0xf bank_mask:0xf
    v_fmac_f32_dpp v181, v194, v101 row_newbcast:8 row_mask:0xf bank_mask:0xf
    v_fmac_f32_dpp v182, v194, v102 row_newbcast:8 row_mask:0xf bank_mask:0xf
    v_fmac_f32_dpp v183, v194, v103 row_newbcast:8 row_mask:0xf bank_mask:0xf
    s_waitcnt vmcnt(23)
    v_cvt_f32_i32 v104, v24
    v_cvt_f32_i32 v105, v25
    v_cvt_f32_i32 v106, v26
    v_cvt_f32_i32 v107, v27
    buffer_load_dwordx4 v[24:27], v1, s[28:31], s71 offen offset:512 nt
    v_fmac_f32_dpp v184, v194, v104 row_newbcast:8 row_mask:0xf bank_mask:0xf
    v_fmac_f32_dpp v185, v194, v105 row_newbcast:8 row_mask:0xf bank_mask:0xf
    v_fmac_f32_dpp v186, v194, v106 row_newbcast:8 row_mask:0xf bank_mask:0xf
    v_fmac_f32_dpp v187, v194, v107 row_newbcast:8 row_mask:0xf bank_mask:0xf
    s_waitcnt vmcnt(23)
    v_cvt_f32_i32 v100, v28
    v_cvt_f32_i32 v101, v29
    v_cvt_f32_i32 v102, v30
    v_cvt_f32_i32 v103, v31
    s_add_u32 s71, s71, 3072
    buffer_load_dwordx4 v[28:31], v1, s[28:31], s71 offen offset:0 nt
    v_fmac_f32_dpp v176, v194, v100 row_newbcast:4 row_mask:0xf bank_mask:0xf
    v_fmac_f32_dpp v177, v194, v101 row_newbcast:4 row_mask:0xf bank_mask:0xf
    v_fmac_f32_dpp v178, v194, v102 row_newbcast:4 row_mask:0xf bank_mask:0xf
    v_fmac_f32_dpp v179, v194, v103 row_newbcast:4 row_mask:0xf bank_mask:0xf
    s_waitcnt vmcnt(23)
    v_cvt_f32_i32 v104, v32
    v_cvt_f32_i32 v105, v33
    v_cvt_f32_i32 v106, v34
    v_cvt_f32_i32 v107, v35
    buffer_load_dwordx4 v[32:35], v1, s[28:31], s71 offen offset:256 nt
    v_fmac_f32_dpp v180, v194, v104 row_newbcast:4 row_mask:0xf bank_mask:0xf
    v_fmac_f32_dpp v181, v194, v105 row_newbcast:4 row_mask:0xf bank_mask:0xf
    v_fmac_f32_dpp v182, v194, v106 row_newbcast:4 row_mask:0xf bank_mask:0xf
    v_fmac_f32_dpp v183, v194, v107 row_newbcast:4 row_mask:0xf bank_mask:0xf
    s_waitcnt vmcnt(23)
    v_cvt_f32_i32 v100, v36
    v_cvt_f32_i32 v101, v37
    v_cvt_f32_i32 v102, v38
    v_cvt_f32_i32 v103, v39
    buffer_load_dwordx4 v[36:39], v1, s[28:31], s71 offen offset:512 nt
    v_fmac_f32_dpp v184, v194, v100 row_newbcast:4 row_mask:0xf bank_mask:0xf
    v_fmac_f32_dpp v185, v194, v101 row_newbcast:4 row_mask:0xf bank_mask:0xf
    v_fmac_f32_dpp v186, v194, v102 row_newbcast:4 row_mask:0xf bank_mask:0xf
    v_fmac_f32_dpp v187, v194, v103 row_newbcast:4 row_mask:0xf bank_mask:0xf
    s_waitcnt vmcnt(23)
    v_cvt_f32_i32 v104, v40
    v_cvt_f32_i32 v105, v41
    v_cvt_f32_i32 v106, v42
    v_cvt_f32_i32 v107, v43
    s_add_u32 s71, s71, 3072
    buffer_load_dwordx4 v[40:43], v1, s[28:31], s71 offen offset:0 nt
    v_fmac_f32_dpp v176, v194, v104 row_newbcast:12 row_mask:0xf bank_mask:0xf
    v_fmac_f32_dpp v177, v194, v105 row_newbcast:12 row_mask:0xf bank_mask:0xf
    v_fmac_f32_dpp v178, v194, v106 row_newbcast:12 row_mask:0xf bank_mask:0xf
    v_fmac_f32_dpp v179, v194, v107 row_newbcast:12 row_mask:0xf bank_mask:0xf
    s_waitcnt vmcnt(23)
    v_cvt_f32_i32 v100, v44
    v_cvt_f32_i32 v101, v45
    v_cvt_f32_i32 v102, v46
    v_cvt_f32_i32 v103, v47
    buffer_load_dwordx4 v[44:47], v1, s[28:31], s71 offen offset:256 nt
    v_fmac_f32_dpp v180, v194, v100 row_newbcast:12 row_mask:0xf bank_mask:0xf
    v_fmac_f32_dpp v181, v194, v101 row_newbcast:12 row_mask:0xf bank_mask:0xf
    v_fmac_f32_dpp v182, v194, v102 row_newbcast:12 row_mask:0xf bank_mask:0xf
    v_fmac_f32_dpp v183, v194, v103 row_newbcast:12 row_mask:0xf bank_mask:0xf
    s_waitcnt vmcnt(23)
    v_cvt_f32_i32 v104, v48
    v_cvt_f32_i32 v105, v49
    v_cvt_f32_i32 v106, v50
    v_cvt_f32_i32 v107, v51
    buffer_load_dwordx4 v[48:51], v1, s[28:31], s71 offen offset:512 nt
    v_fmac_f32_dpp v184, v194, v104 row_newbcast:12 row_mask:0xf bank_mask:0xf
    v_fmac_f32_dpp v185, v194, v105 row_newbcast:12 row_mask:0xf bank_mask:0xf
    v_fmac_f32_dpp v186, v194, v106 row_newbcast:12 row_mask:0xf bank_mask:0xf
    v_fmac_f32_dpp v187, v194, v107 row_newbcast:12 row_mask:0xf bank_mask:0xf
    s_waitcnt vmcnt(23)
    v_cvt_f32_i32 v100, v52
    v_cvt_f32_i32 v101, v53
    v_cvt_f32_i32 v102, v54
    v_cvt_f32_i32 v103, v55
    s_add_u32 s71, s71, 3072
    buffer_load_dwordx4 v[52:55], v1, s[28:31], s71 offen offset:0 nt
    v_fmac_f32_dpp v176, v194, v100 row_newbcast:2 row_mask:0xf bank_mask:0xf
    v_fmac_f32_dpp v177, v194, v101 row_newbcast:2 row_mask:0xf bank_mask:0xf
    v_fmac_f32_dpp v178, v194, v102 row_newbcast:2 row_mask:0xf bank_mask:0xf
    v_fmac_f32_dpp v179, v194, v103 row_newbcast:2 row_mask:0xf bank_mask:0xf
    s_waitcnt vmcnt(23)
    v_cvt_f32_i32 v104, v56
    v_cvt_f32_i32 v105, v57
    v_cvt_f32_i32 v106, v58
    v_cvt_f32_i32 v107, v59
    buffer_load_dwordx4 v[56:59], v1, s[28:31], s71 offen offset:256 nt
    v_fmac_f32_dpp v180, v194, v104 row_newbcast:2 row_mask:0xf bank_mask:0xf
    v_fmac_f32_dpp v181, v194, v105 row_newbcast:2 row_mask:0xf bank_mask:0xf
    v_fmac_f32_dpp v182, v194, v106 row_newbcast:2 row_mask:0xf bank_mask:0xf
    v_fmac_f32_dpp v183, v194, v107 row_newbcast:2 row_mask:0xf bank_mask:0xf
    s_waitcnt vmcnt(23)
    v_cvt_f32_i32 v100, v60
    v_cvt_f32_i32 v101, v61
    v_cvt_f32_i32 v102, v62
    v_cvt_f32_i32 v103, v63
    buffer_load_dwordx4 v[60:63], v1, s[28:31], s71 offen offset:512 nt
    v_fmac_f32_dpp v184, v194, v100 row_newbcast:2 row_mask:0xf bank_mask:0xf
    v_fmac_f32_dpp v185, v194, v101 row_newbcast:2 row_mask:0xf bank_mask:0xf
    v_fmac_f32_dpp v186, v194, v102 row_newbcast:2 row_mask:0xf bank_mask:0xf
    v_fmac_f32_dpp v187, v194, v103 row_newbcast:2 row_mask:0xf bank_mask:0xf
    s_waitcnt vmcnt(23)
    v_cvt_f32_i32 v104, v64
    v_cvt_f32_i32 v105, v65
    v_cvt_f32_i32 v106, v66
    v_cvt_f32_i32 v107, v67
    s_add_u32 s71, s71, 3072
    buffer_load_dwordx4 v[64:67], v1, s[28:31], s71 offen offset:0 nt
    v_fmac_f32_dpp v176, v194, v104 row_newbcast:10 row_mask:0xf bank_mask:0xf
    v_fmac_f32_dpp v177, v194, v105 row_newbcast:10 row_mask:0xf bank_mask:0xf
    v_fmac_f32_dpp v178, v194, v106 row_newbcast:10 row_mask:0xf bank_mask:0xf
    v_fmac_f32_dpp v179, v194, v107 row_newbcast:10 row_mask:0xf bank_mask:0xf
    s_waitcnt vmcnt(23)
    v_cvt_f32_i32 v100, v68
    v_cvt_f32_i32 v101, v69
    v_cvt_f32_i32 v102, v70
    v_cvt_f32_i32 v103, v71
    buffer_load_dwordx4 v[68:71], v1, s[28:31], s71 offen offset:256 nt
    v_fmac_f32_dpp v180, v194, v100 row_newbcast:10 row_mask:0xf bank_mask:0xf
    v_fmac_f32_dpp v181, v194, v101 row_newbcast:10 row_mask:0xf bank_mask:0xf
    v_fmac_f32_dpp v182, v194, v102 row_newbcast:10 row_mask:0xf bank_mask:0xf
    v_fmac_f32_dpp v183, v194, v103 row_newbcast:10 row_mask:0xf bank_mask:0xf
    s_waitcnt vmcnt(23)
    v_cvt_f32_i32 v104, v72
    v_cvt_f32_i32 v105, v73
    v_cvt_f32_i32 v106, v74
    v_cvt_f32_i32 v107, v75
    buffer_load_dwordx4 v[72:75], v1, s[28:31], s71 offen offset:512 nt
    v_fmac_f32_dpp v184, v194, v104 row_newbcast:10 row_mask:0xf bank_mask:0xf
    v_fmac_f32_dpp v185, v194, v105 row_newbcast:10 row_mask:0xf bank_mask:0xf
    v_fmac_f32_dpp v186, v194, v106 row_newbcast:10 row_mask:0xf bank_mask:0xf
    v_fmac_f32_dpp v187, v194, v107 row_newbcast:10 row_mask:0xf bank_mask:0xf
    s_waitcnt vmcnt(23)
    v_cvt_f32_i32 v100, v76
    v_cvt_f32_i32 v101, v77
    v_cvt_f32_i32 v102, v78
    v_cvt_f32_i32 v103, v79
    s_add_u32 s71, s71, 3072
    buffer_load_dwordx4 v[76:79], v1, s[28:31], s71 offen offset:0 nt
    v_fmac_f32_dpp v176, v194, v100 row_newbcast:6 row_mask:0xf bank_mask:0xf
    v_fmac_f32_dpp v177, v194, v101 row_newbcast:6 row_mask:0xf bank_mask:0xf
    v_fmac_f32_dpp v178, v194, v102 row_newbcast:6 row_mask:0xf bank_mask:0xf
    v_fmac_f32_dpp v179, v194, v103 row_newbcast:6 row_mask:0xf bank_mask:0xf
    s_waitcnt vmcnt(23)
    v_cvt_f32_i32 v104, v80
    v_cvt_f32_i32 v105, v81
    v_cvt_f32_i32 v106, v82
    v_cvt_f32_i32 v107, v83
    buffer_load_dwordx4 v[80:83], v1, s[28:31], s71 offen offset:256 nt
    v_fmac_f32_dpp v180, v194, v104 row_newbcast:6 row_mask:0xf bank_mask:0xf
    v_fmac_f32_dpp v181, v194, v105 row_newbcast:6 row_mask:0xf bank_mask:0xf
    v_fmac_f32_dpp v182, v194, v106 row_newbcast:6 row_mask:0xf bank_mask:0xf
    v_fmac_f32_dpp v183, v194, v107 row_newbcast:6 row_mask:0xf bank_mask:0xf
    s_waitcnt vmcnt(23)
    v_cvt_f32_i32 v100, v84
    v_cvt_f32_i32 v101, v85
    v_cvt_f32_i32 v102, v86
    v_cvt_f32_i32 v103, v87
    buffer_load_dwordx4 v[84:87], v1, s[28:31], s71 offen offset:512 nt
    v_fmac_f32_dpp v184, v194, v100 row_newbcast:6 row_mask:0xf bank_mask:0xf
    v_fmac_f32_dpp v185, v194, v101 row_newbcast:6 row_mask:0xf bank_mask:0xf
    v_fmac_f32_dpp v186, v194, v102 row_newbcast:6 row_mask:0xf bank_mask:0xf
    v_fmac_f32_dpp v187, v194, v103 row_newbcast:6 row_mask:0xf bank_mask:0xf
    s_waitcnt vmcnt(23)
    v_cvt_f32_i32 v104, v88
    v_cvt_f32_i32 v105, v89
    v_cvt_f32_i32 v106, v90
    v_cvt_f32_i32 v107, v91
    s_add_u32 s71, s71, 3072
    buffer_load_dwordx4 v[88:91], v1, s[28:31], s71 offen offset:0 nt
    v_fmac_f32_dpp v176, v194, v104 row_newbcast:14 row_mask:0xf bank_mask:0xf
    v_fmac_f32_dpp v177, v194, v105 row_newbcast:14 row_mask:0xf bank_mask:0xf
    v_fmac_f32_dpp v178, v194, v106 row_newbcast:14 row_mask:0xf bank_mask:0xf
    v_fmac_f32_dpp v179, v194, v107 row_newbcast:14 row_mask:0xf bank_mask:0xf
    ds_read_b32 v199, v198
    s_waitcnt vmcnt(23)
    v_cvt_f32_i32 v100, v92
    v_cvt_f32_i32 v101, v93
    v_cvt_f32_i32 v102, v94
    v_cvt_f32_i32 v103, v95
    buffer_load_dwordx4 v[92:95], v1, s[28:31], s71 offen offset:256 nt
    v_fmac_f32_dpp v180, v194, v100 row_newbcast:14 row_mask:0xf bank_mask:0xf
    v_fmac_f32_dpp v181, v194, v101 row_newbcast:14 row_mask:0xf bank_mask:0xf
    v_fmac_f32_dpp v182, v194, v102 row_newbcast:14 row_mask:0xf bank_mask:0xf
    v_fmac_f32_dpp v183, v194, v103 row_newbcast:14 row_mask:0xf bank_mask:0xf
    s_waitcnt vmcnt(23)
    v_cvt_f32_i32 v104, v96
    v_cvt_f32_i32 v105, v97
    v_cvt_f32_i32 v106, v98
    v_cvt_f32_i32 v107, v99
    buffer_load_dwordx4 v[96:99], v1, s[28:31], s71 offen offset:512 nt
    v_fmac_f32_dpp v184, v194, v104 row_newbcast:14 row_mask:0xf bank_mask:0xf
    v_fmac_f32_dpp v185, v194, v105 row_newbcast:14 row_mask:0xf bank_mask:0xf
    v_fmac_f32_dpp v186, v194, v106 row_newbcast:14 row_mask:0xf bank_mask:0xf
    v_fmac_f32_dpp v187, v194, v107 row_newbcast:14 row_mask:0xf bank_mask:0xf
    s_waitcnt lgkmcnt(0)
    v_readfirstlane_b32 s80, v199
    s_cmp_lg_u32 s80, -1
    s_cbranch_scc1 L_tkok
L_tkw:
    ds_read_b32 v199, v198
    s_waitcnt lgkmcnt(0)
    v_readfirstlane_b32 s80, v199
    s_cmp_eq_u32 s80, -1
    s_cbranch_scc1 L_tkw
L_tkok:
    v_add_u32 v198, 4, v198
    s_cmp_ge_u32 s80, 256
    s_cbranch_scc1 L_dtail
    s_lshr_b32 s81, s80, 6
    s_and_b32 s80, s80, 63
    s_mul_i32 s56, s81, 64
    s_add_u32 s56, s56, s80
    s_add_u32 s56, s56, s94
    s_and_b32 s56, s56, 511
    s_mov_b32 s57, s59
    s_add_u32 s70, s57, s56
    s_and_b32 s95, s3, 192
    s_add_u32 s95, s95, s80
    s_lshl_b32 s95, s95, 3
    s_add_u32 s95, s95, s81
    s_lshl_b32 s95, s95, 8
    s_add_u32 s95, s95, 18874368
    s_waitcnt vmcnt(23)
    v_cvt_f32_i32 v100, v4
    v_cvt_f32_i32 v101, v5
    v_cvt_f32_i32 v102, v6
    v_cvt_f32_i32 v103, v7
    s_and_b32 s80, s70, 63
    s_mul_i32 s80, s80, 64
    s_lshl_b32 s73, s70, 7
    s_sub_u32 s73, s73, s80
    buffer_load_dword v195, v196, s[52:55], s95 offen sc0 sc1
    buffer_load_ushort v192, v3, s[40:43], s73 offen
    buffer_load_ushort v193, v3, s[44:47], s73 offen
    s_mul_i32 s71, s70, 49152
    s_and_b32 s80, s70, 63
    s_mul_i32 s80, s80, 24576
    s_sub_u32 s71, s71, s80
    buffer_load_dwordx4 v[4:7], v1, s[28:31], s71 offen offset:0 nt
    v_fmac_f32_dpp v176, v194, v100 row_newbcast:1 row_mask:0xf bank_mask:0xf
    v_fmac_f32_dpp v177, v194, v101 row_newbcast:1 row_mask:0xf bank_mask:0xf
    v_fmac_f32_dpp v178, v194, v102 row_newbcast:1 row_mask:0xf bank_mask:0xf
    v_fmac_f32_dpp v179, v194, v103 row_newbcast:1 row_mask:0xf bank_mask:0xf
    s_waitcnt vmcnt(26)
    v_cvt_f32_i32 v104, v8
    v_cvt_f32_i32 v105, v9
    v_cvt_f32_i32 v106, v10
    v_cvt_f32_i32 v107, v11
    buffer_load_dwordx4 v[8:11], v1, s[28:31], s71 offen offset:256 nt
    v_fmac_f32_dpp v180, v194, v104 row_newbcast:1 row_mask:0xf bank_mask:0xf
    v_fmac_f32_dpp v181, v194, v105 row_newbcast:1 row_mask:0xf bank_mask:0xf
    v_fmac_f32_dpp v182, v194, v106 row_newbcast:1 row_mask:0xf bank_mask:0xf
    v_fmac_f32_dpp v183, v194, v107 row_newbcast:1 row_mask:0xf bank_mask:0xf
    s_waitcnt vmcnt(26)
    v_cvt_f32_i32 v100, v12
    v_cvt_f32_i32 v101, v13
    v_cvt_f32_i32 v102, v14
    v_cvt_f32_i32 v103, v15
    buffer_load_dwordx4 v[12:15], v1, s[28:31], s71 offen offset:512 nt
    v_fmac_f32_dpp v184, v194, v100 row_newbcast:1 row_mask:0xf bank_mask:0xf
    v_fmac_f32_dpp v185, v194, v101 row_newbcast:1 row_mask:0xf bank_mask:0xf
    v_fmac_f32_dpp v186, v194, v102 row_newbcast:1 row_mask:0xf bank_mask:0xf
    v_fmac_f32_dpp v187, v194, v103 row_newbcast:1 row_mask:0xf bank_mask:0xf
    s_waitcnt vmcnt(26)
    v_cvt_f32_i32 v104, v16
    v_cvt_f32_i32 v105, v17
    v_cvt_f32_i32 v106, v18
    v_cvt_f32_i32 v107, v19
    s_add_u32 s71, s71, 3072
    buffer_load_dwordx4 v[16:19], v1, s[28:31], s71 offen offset:0 nt
    v_fmac_f32_dpp v176, v194, v104 row_newbcast:9 row_mask:0xf bank_mask:0xf
    v_fmac_f32_dpp v177, v194, v105 row_newbcast:9 row_mask:0xf bank_mask:0xf
    v_fmac_f32_dpp v178, v194, v106 row_newbcast:9 row_mask:0xf bank_mask:0xf
    v_fmac_f32_dpp v179, v194, v107 row_newbcast:9 row_mask:0xf bank_mask:0xf
    s_mov_b64 exec, 1
    ds_add_u32 v212, v212 offset:131
    s_mov_b64 exec, -1
    s_waitcnt vmcnt(26)
    v_cvt_f32_i32 v100, v20
    v_cvt_f32_i32 v101, v21
    v_cvt_f32_i32 v102, v22
    v_cvt_f32_i32 v103, v23
    buffer_load_dwordx4 v[20:23], v1, s[28:31], s71 offen offset:256 nt
    v_fmac_f32_dpp v180, v194, v100 row_newbcast:9 row_mask:0xf bank_mask:0xf
    v_fmac_f32_dpp v181, v194, v101 row_newbcast:9 row_mask:0xf bank_mask:0xf
    v_fmac_f32_dpp v182, v194, v102 row_newbcast:9 row_mask:0xf bank_mask:0xf
    v_fmac_f32_dpp v183, v194, v103 row_newbcast:9 row_mask:0xf bank_mask:0xf
    s_waitcnt vmcnt(26)
    v_cvt_f32_i32 v104, v24
    v_cvt_f32_i32 v105, v25
    v_cvt_f32_i32 v106, v26
    v_cvt_f32_i32 v107, v27
    buffer_load_dwordx4 v[24:27], v1, s[28:31], s71 offen offset:512 nt
    v_fmac_f32_dpp v184, v194, v104 row_newbcast:9 row_mask:0xf bank_mask:0xf
    v_fmac_f32_dpp v185, v194, v105 row_newbcast:9 row_mask:0xf bank_mask:0xf
    v_fmac_f32_dpp v186, v194, v106 row_newbcast:9 row_mask:0xf bank_mask:0xf
    v_fmac_f32_dpp v187, v194, v107 row_newbcast:9 row_mask:0xf bank_mask:0xf
    s_waitcnt vmcnt(26)
    v_cvt_f32_i32 v100, v28
    v_cvt_f32_i32 v101, v29
    v_cvt_f32_i32 v102, v30
    v_cvt_f32_i32 v103, v31
    s_add_u32 s71, s71, 3072
    buffer_load_dwordx4 v[28:31], v1, s[28:31], s71 offen offset:0 nt
    v_fmac_f32_dpp v176, v194, v100 row_newbcast:5 row_mask:0xf bank_mask:0xf
    v_fmac_f32_dpp v177, v194, v101 row_newbcast:5 row_mask:0xf bank_mask:0xf
    v_fmac_f32_dpp v178, v194, v102 row_newbcast:5 row_mask:0xf bank_mask:0xf
    v_fmac_f32_dpp v179, v194, v103 row_newbcast:5 row_mask:0xf bank_mask:0xf
    s_waitcnt vmcnt(26)
    v_cvt_f32_i32 v104, v32
    v_cvt_f32_i32 v105, v33
    v_cvt_f32_i32 v106, v34
    v_cvt_f32_i32 v107, v35
    buffer_load_dwordx4 v[32:35], v1, s[28:31], s71 offen offset:256 nt
    v_fmac_f32_dpp v180, v194, v104 row_newbcast:5 row_mask:0xf bank_mask:0xf
    v_fmac_f32_dpp v181, v194, v105 row_newbcast:5 row_mask:0xf bank_mask:0xf
    v_fmac_f32_dpp v182, v194, v106 row_newbcast:5 row_mask:0xf bank_mask:0xf
    v_fmac_f32_dpp v183, v194, v107 row_newbcast:5 row_mask:0xf bank_mask:0xf
    s_waitcnt vmcnt(26)
    v_cvt_f32_i32 v100, v36
    v_cvt_f32_i32 v101, v37
    v_cvt_f32_i32 v102, v38
    v_cvt_f32_i32 v103, v39
    buffer_load_dwordx4 v[36:39], v1, s[28:31], s71 offen offset:512 nt
    v_fmac_f32_dpp v184, v194, v100 row_newbcast:5 row_mask:0xf bank_mask:0xf
    v_fmac_f32_dpp v185, v194, v101 row_newbcast:5 row_mask:0xf bank_mask:0xf
    v_fmac_f32_dpp v186, v194, v102 row_newbcast:5 row_mask:0xf bank_mask:0xf
    v_fmac_f32_dpp v187, v194, v103 row_newbcast:5 row_mask:0xf bank_mask:0xf
    s_waitcnt vmcnt(26)
    v_cvt_f32_i32 v104, v40
    v_cvt_f32_i32 v105, v41
    v_cvt_f32_i32 v106, v42
    v_cvt_f32_i32 v107, v43
    s_add_u32 s71, s71, 3072
    buffer_load_dwordx4 v[40:43], v1, s[28:31], s71 offen offset:0 nt
    v_fmac_f32_dpp v176, v194, v104 row_newbcast:13 row_mask:0xf bank_mask:0xf
    v_fmac_f32_dpp v177, v194, v105 row_newbcast:13 row_mask:0xf bank_mask:0xf
    v_fmac_f32_dpp v178, v194, v106 row_newbcast:13 row_mask:0xf bank_mask:0xf
    v_fmac_f32_dpp v179, v194, v107 row_newbcast:13 row_mask:0xf bank_mask:0xf
    s_waitcnt vmcnt(26)
    v_cvt_f32_i32 v100, v44
    v_cvt_f32_i32 v101, v45
    v_cvt_f32_i32 v102, v46
    v_cvt_f32_i32 v103, v47
    buffer_load_dwordx4 v[44:47], v1, s[28:31], s71 offen offset:256 nt
    v_fmac_f32_dpp v180, v194, v100 row_newbcast:13 row_mask:0xf bank_mask:0xf
    v_fmac_f32_dpp v181, v194, v101 row_newbcast:13 row_mask:0xf bank_mask:0xf
    v_fmac_f32_dpp v182, v194, v102 row_newbcast:13 row_mask:0xf bank_mask:0xf
    v_fmac_f32_dpp v183, v194, v103 row_newbcast:13 row_mask:0xf bank_mask:0xf
    s_waitcnt vmcnt(26)
    v_cvt_f32_i32 v104, v48
    v_cvt_f32_i32 v105, v49
    v_cvt_f32_i32 v106, v50
    v_cvt_f32_i32 v107, v51
    buffer_load_dwordx4 v[48:51], v1, s[28:31], s71 offen offset:512 nt
    v_fmac_f32_dpp v184, v194, v104 row_newbcast:13 row_mask:0xf bank_mask:0xf
    v_fmac_f32_dpp v185, v194, v105 row_newbcast:13 row_mask:0xf bank_mask:0xf
    v_fmac_f32_dpp v186, v194, v106 row_newbcast:13 row_mask:0xf bank_mask:0xf
    v_fmac_f32_dpp v187, v194, v107 row_newbcast:13 row_mask:0xf bank_mask:0xf
    s_waitcnt vmcnt(26)
    v_cvt_f32_i32 v100, v52
    v_cvt_f32_i32 v101, v53
    v_cvt_f32_i32 v102, v54
    v_cvt_f32_i32 v103, v55
    s_add_u32 s71, s71, 3072
    buffer_load_dwordx4 v[52:55], v1, s[28:31], s71 offen offset:0 nt
    v_fmac_f32_dpp v176, v194, v100 row_newbcast:3 row_mask:0xf bank_mask:0xf
    v_fmac_f32_dpp v177, v194, v101 row_newbcast:3 row_mask:0xf bank_mask:0xf
    v_fmac_f32_dpp v178, v194, v102 row_newbcast:3 row_mask:0xf bank_mask:0xf
    v_fmac_f32_dpp v179, v194, v103 row_newbcast:3 row_mask:0xf bank_mask:0xf
    s_waitcnt vmcnt(26)
    v_cvt_f32_i32 v104, v56
    v_cvt_f32_i32 v105, v57
    v_cvt_f32_i32 v106, v58
    v_cvt_f32_i32 v107, v59
    buffer_load_dwordx4 v[56:59], v1, s[28:31], s71 offen offset:256 nt
    v_fmac_f32_dpp v180, v194, v104 row_newbcast:3 row_mask:0xf bank_mask:0xf
    v_fmac_f32_dpp v181, v194, v105 row_newbcast:3 row_mask:0xf bank_mask:0xf
    v_fmac_f32_dpp v182, v194, v106 row_newbcast:3 row_mask:0xf bank_mask:0xf
    v_fmac_f32_dpp v183, v194, v107 row_newbcast:3 row_mask:0xf bank_mask:0xf
    s_waitcnt vmcnt(26)
    v_cvt_f32_i32 v100, v60
    v_cvt_f32_i32 v101, v61
    v_cvt_f32_i32 v102, v62
    v_cvt_f32_i32 v103, v63
    buffer_load_dwordx4 v[60:63], v1, s[28:31], s71 offen offset:512 nt
    v_fmac_f32_dpp v184, v194, v100 row_newbcast:3 row_mask:0xf bank_mask:0xf
    v_fmac_f32_dpp v185, v194, v101 row_newbcast:3 row_mask:0xf bank_mask:0xf
    v_fmac_f32_dpp v186, v194, v102 row_newbcast:3 row_mask:0xf bank_mask:0xf
    v_fmac_f32_dpp v187, v194, v103 row_newbcast:3 row_mask:0xf bank_mask:0xf
    s_waitcnt vmcnt(26)
    v_cvt_f32_i32 v104, v64
    v_cvt_f32_i32 v105, v65
    v_cvt_f32_i32 v106, v66
    v_cvt_f32_i32 v107, v67
    s_add_u32 s71, s71, 3072
    buffer_load_dwordx4 v[64:67], v1, s[28:31], s71 offen offset:0 nt
    v_fmac_f32_dpp v176, v194, v104 row_newbcast:11 row_mask:0xf bank_mask:0xf
    v_fmac_f32_dpp v177, v194, v105 row_newbcast:11 row_mask:0xf bank_mask:0xf
    v_fmac_f32_dpp v178, v194, v106 row_newbcast:11 row_mask:0xf bank_mask:0xf
    v_fmac_f32_dpp v179, v194, v107 row_newbcast:11 row_mask:0xf bank_mask:0xf
    s_waitcnt vmcnt(26)
    v_cvt_f32_i32 v100, v68
    v_cvt_f32_i32 v101, v69
    v_cvt_f32_i32 v102, v70
    v_cvt_f32_i32 v103, v71
    buffer_load_dwordx4 v[68:71], v1, s[28:31], s71 offen offset:256 nt
    v_fmac_f32_dpp v180, v194, v100 row_newbcast:11 row_mask:0xf bank_mask:0xf
    v_fmac_f32_dpp v181, v194, v101 row_newbcast:11 row_mask:0xf bank_mask:0xf
    v_fmac_f32_dpp v182, v194, v102 row_newbcast:11 row_mask:0xf bank_mask:0xf
    v_fmac_f32_dpp v183, v194, v103 row_newbcast:11 row_mask:0xf bank_mask:0xf
    s_waitcnt vmcnt(26)
    v_cvt_f32_i32 v104, v72
    v_cvt_f32_i32 v105, v73
    v_cvt_f32_i32 v106, v74
    v_cvt_f32_i32 v107, v75
    buffer_load_dwordx4 v[72:75], v1, s[28:31], s71 offen offset:512 nt
    v_fmac_f32_dpp v184, v194, v104 row_newbcast:11 row_mask:0xf bank_mask:0xf
    v_fmac_f32_dpp v185, v194, v105 row_newbcast:11 row_mask:0xf bank_mask:0xf
    v_fmac_f32_dpp v186, v194, v106 row_newbcast:11 row_mask:0xf bank_mask:0xf
    v_fmac_f32_dpp v187, v194, v107 row_newbcast:11 row_mask:0xf bank_mask:0xf
    s_waitcnt vmcnt(26)
    v_cvt_f32_i32 v100, v76
    v_cvt_f32_i32 v101, v77
    v_cvt_f32_i32 v102, v78
    v_cvt_f32_i32 v103, v79
    s_add_u32 s71, s71, 3072
    buffer_load_dwordx4 v[76:79], v1, s[28:31], s71 offen offset:0 nt
    v_fmac_f32_dpp v176, v194, v100 row_newbcast:7 row_mask:0xf bank_mask:0xf
    v_fmac_f32_dpp v177, v194, v101 row_newbcast:7 row_mask:0xf bank_mask:0xf
    v_fmac_f32_dpp v178, v194, v102 row_newbcast:7 row_mask:0xf bank_mask:0xf
    v_fmac_f32_dpp v179, v194, v103 row_newbcast:7 row_mask:0xf bank_mask:0xf
    s_waitcnt vmcnt(26)
    v_cvt_f32_i32 v104, v80
    v_cvt_f32_i32 v105, v81
    v_cvt_f32_i32 v106, v82
    v_cvt_f32_i32 v107, v83
    buffer_load_dwordx4 v[80:83], v1, s[28:31], s71 offen offset:256 nt
    v_fmac_f32_dpp v180, v194, v104 row_newbcast:7 row_mask:0xf bank_mask:0xf
    v_fmac_f32_dpp v181, v194, v105 row_newbcast:7 row_mask:0xf bank_mask:0xf
    v_fmac_f32_dpp v182, v194, v106 row_newbcast:7 row_mask:0xf bank_mask:0xf
    v_fmac_f32_dpp v183, v194, v107 row_newbcast:7 row_mask:0xf bank_mask:0xf
    s_waitcnt vmcnt(26)
    v_cvt_f32_i32 v100, v84
    v_cvt_f32_i32 v101, v85
    v_cvt_f32_i32 v102, v86
    v_cvt_f32_i32 v103, v87
    buffer_load_dwordx4 v[84:87], v1, s[28:31], s71 offen offset:512 nt
    v_fmac_f32_dpp v184, v194, v100 row_newbcast:7 row_mask:0xf bank_mask:0xf
    v_fmac_f32_dpp v185, v194, v101 row_newbcast:7 row_mask:0xf bank_mask:0xf
    v_fmac_f32_dpp v186, v194, v102 row_newbcast:7 row_mask:0xf bank_mask:0xf
    v_fmac_f32_dpp v187, v194, v103 row_newbcast:7 row_mask:0xf bank_mask:0xf
    s_waitcnt vmcnt(26)
    v_cvt_f32_i32 v104, v88
    v_cvt_f32_i32 v105, v89
    v_cvt_f32_i32 v106, v90
    v_cvt_f32_i32 v107, v91
    s_add_u32 s71, s71, 3072
    buffer_load_dwordx4 v[88:91], v1, s[28:31], s71 offen offset:0 nt
    v_fmac_f32_dpp v176, v194, v104 row_newbcast:15 row_mask:0xf bank_mask:0xf
    v_fmac_f32_dpp v177, v194, v105 row_newbcast:15 row_mask:0xf bank_mask:0xf
    v_fmac_f32_dpp v178, v194, v106 row_newbcast:15 row_mask:0xf bank_mask:0xf
    v_fmac_f32_dpp v179, v194, v107 row_newbcast:15 row_mask:0xf bank_mask:0xf
    s_waitcnt vmcnt(26)
    v_cvt_f32_i32 v100, v92
    v_cvt_f32_i32 v101, v93
    v_cvt_f32_i32 v102, v94
    v_cvt_f32_i32 v103, v95
    buffer_load_dwordx4 v[92:95], v1, s[28:31], s71 offen offset:256 nt
    v_fmac_f32_dpp v180, v194, v100 row_newbcast:15 row_mask:0xf bank_mask:0xf
    v_fmac_f32_dpp v181, v194, v101 row_newbcast:15 row_mask:0xf bank_mask:0xf
    v_fmac_f32_dpp v182, v194, v102 row_newbcast:15 row_mask:0xf bank_mask:0xf
    v_fmac_f32_dpp v183, v194, v103 row_newbcast:15 row_mask:0xf bank_mask:0xf
    s_waitcnt vmcnt(26)
    v_cvt_f32_i32 v104, v96
    v_cvt_f32_i32 v105, v97
    v_cvt_f32_i32 v106, v98
    v_cvt_f32_i32 v107, v99
    buffer_load_dwordx4 v[96:99], v1, s[28:31], s71 offen offset:512 nt
    v_fmac_f32_dpp v184, v194, v104 row_newbcast:15 row_mask:0xf bank_mask:0xf
    v_fmac_f32_dpp v185, v194, v105 row_newbcast:15 row_mask:0xf bank_mask:0xf
    v_fmac_f32_dpp v186, v194, v106 row_newbcast:15 row_mask:0xf bank_mask:0xf
    v_fmac_f32_dpp v187, v194, v107 row_newbcast:15 row_mask:0xf bank_mask:0xf
    s_branch L_dloop
L_dtail:
    ds_write_b32 v212, v212 offset:143
    s_waitcnt vmcnt(23)
    v_cvt_f32_i32 v100, v4
    v_cvt_f32_i32 v101, v5
    v_cvt_f32_i32 v102, v6
    v_cvt_f32_i32 v103, v7
    v_fmac_f32_dpp v176, v194, v100 row_newbcast:1 row_mask:0xf bank_mask:0xf
    v_fmac_f32_dpp v177, v194, v101 row_newbcast:1 row_mask:0xf bank_mask:0xf
    v_fmac_f32_dpp v178, v194, v102 row_newbcast:1 row_mask:0xf bank_mask:0xf
    v_fmac_f32_dpp v179, v194, v103 row_newbcast:1 row_mask:0xf bank_mask:0xf
    s_waitcnt vmcnt(22)
    v_cvt_f32_i32 v104, v8
    v_cvt_f32_i32 v105, v9
    v_cvt_f32_i32 v106, v10
    v_cvt_f32_i32 v107, v11
    v_fmac_f32_dpp v180, v194, v104 row_newbcast:1 row_mask:0xf bank_mask:0xf
    v_fmac_f32_dpp v181, v194, v105 row_newbcast:1 row_mask:0xf bank_mask:0xf
    v_fmac_f32_dpp v182, v194, v106 row_newbcast:1 row_mask:0xf bank_mask:0xf
    v_fmac_f32_dpp v183, v194, v107 row_newbcast:1 row_mask:0xf bank_mask:0xf
    s_waitcnt vmcnt(21)
    v_cvt_f32_i32 v100, v12
    v_cvt_f32_i32 v101, v13
    v_cvt_f32_i32 v102, v14
    v_cvt_f32_i32 v103, v15
    v_fmac_f32_dpp v184, v194, v100 row_newbcast:1 row_mask:0xf bank_mask:0xf
    v_fmac_f32_dpp v185, v194, v101 row_newbcast:1 row_mask:0xf bank_mask:0xf
    v_fmac_f32_dpp v186, v194, v102 row_newbcast:1 row_mask:0xf bank_mask:0xf
    v_fmac_f32_dpp v187, v194, v103 row_newbcast:1 row_mask:0xf bank_mask:0xf
    s_waitcnt vmcnt(20)
    v_cvt_f32_i32 v104, v16
    v_cvt_f32_i32 v105, v17
    v_cvt_f32_i32 v106, v18
    v_cvt_f32_i32 v107, v19
    v_fmac_f32_dpp v176, v194, v104 row_newbcast:9 row_mask:0xf bank_mask:0xf
    v_fmac_f32_dpp v177, v194, v105 row_newbcast:9 row_mask:0xf bank_mask:0xf
    v_fmac_f32_dpp v178, v194, v106 row_newbcast:9 row_mask:0xf bank_mask:0xf
    v_fmac_f32_dpp v179, v194, v107 row_newbcast:9 row_mask:0xf bank_mask:0xf
    s_waitcnt vmcnt(19)
    v_cvt_f32_i32 v100, v20
    v_cvt_f32_i32 v101, v21
    v_cvt_f32_i32 v102, v22
    v_cvt_f32_i32 v103, v23
    v_fmac_f32_dpp v180, v194, v100 row_newbcast:9 row_mask:0xf bank_mask:0xf
    v_fmac_f32_dpp v181, v194, v101 row_newbcast:9 row_mask:0xf bank_mask:0xf
    v_fmac_f32_dpp v182, v194, v102 row_newbcast:9 row_mask:0xf bank_mask:0xf
    v_fmac_f32_dpp v183, v194, v103 row_newbcast:9 row_mask:0xf bank_mask:0xf
    s_waitcnt vmcnt(18)
    v_cvt_f32_i32 v104, v24
    v_cvt_f32_i32 v105, v25
    v_cvt_f32_i32 v106, v26
    v_cvt_f32_i32 v107, v27
    v_fmac_f32_dpp v184, v194, v104 row_newbcast:9 row_mask:0xf bank_mask:0xf
    v_fmac_f32_dpp v185, v194, v105 row_newbcast:9 row_mask:0xf bank_mask:0xf
    v_fmac_f32_dpp v186, v194, v106 row_newbcast:9 row_mask:0xf bank_mask:0xf
    v_fmac_f32_dpp v187, v194, v107 row_newbcast:9 row_mask:0xf bank_mask:0xf
    s_waitcnt vmcnt(17)
    v_cvt_f32_i32 v100, v28
    v_cvt_f32_i32 v101, v29
    v_cvt_f32_i32 v102, v30
    v_cvt_f32_i32 v103, v31
    v_fmac_f32_dpp v176, v194, v100 row_newbcast:5 row_mask:0xf bank_mask:0xf
    v_fmac_f32_dpp v177, v194, v101 row_newbcast:5 row_mask:0xf bank_mask:0xf
    v_fmac_f32_dpp v178, v194, v102 row_newbcast:5 row_mask:0xf bank_mask:0xf
    v_fmac_f32_dpp v179, v194, v103 row_newbcast:5 row_mask:0xf bank_mask:0xf
    s_waitcnt vmcnt(16)
    v_cvt_f32_i32 v104, v32
    v_cvt_f32_i32 v105, v33
    v_cvt_f32_i32 v106, v34
    v_cvt_f32_i32 v107, v35
    v_fmac_f32_dpp v180, v194, v104 row_newbcast:5 row_mask:0xf bank_mask:0xf
    v_fmac_f32_dpp v181, v194, v105 row_newbcast:5 row_mask:0xf bank_mask:0xf
    v_fmac_f32_dpp v182, v194, v106 row_newbcast:5 row_mask:0xf bank_mask:0xf
    v_fmac_f32_dpp v183, v194, v107 row_newbcast:5 row_mask:0xf bank_mask:0xf
    s_waitcnt vmcnt(15)
    v_cvt_f32_i32 v100, v36
    v_cvt_f32_i32 v101, v37
    v_cvt_f32_i32 v102, v38
    v_cvt_f32_i32 v103, v39
    v_fmac_f32_dpp v184, v194, v100 row_newbcast:5 row_mask:0xf bank_mask:0xf
    v_fmac_f32_dpp v185, v194, v101 row_newbcast:5 row_mask:0xf bank_mask:0xf
    v_fmac_f32_dpp v186, v194, v102 row_newbcast:5 row_mask:0xf bank_mask:0xf
    v_fmac_f32_dpp v187, v194, v103 row_newbcast:5 row_mask:0xf bank_mask:0xf
    s_waitcnt vmcnt(14)
    v_cvt_f32_i32 v104, v40
    v_cvt_f32_i32 v105, v41
    v_cvt_f32_i32 v106, v42
    v_cvt_f32_i32 v107, v43
    v_fmac_f32_dpp v176, v194, v104 row_newbcast:13 row_mask:0xf bank_mask:0xf
    v_fmac_f32_dpp v177, v194, v105 row_newbcast:13 row_mask:0xf bank_mask:0xf
    v_fmac_f32_dpp v178, v194, v106 row_newbcast:13 row_mask:0xf bank_mask:0xf
    v_fmac_f32_dpp v179, v194, v107 row_newbcast:13 row_mask:0xf bank_mask:0xf
    s_waitcnt vmcnt(13)
    v_cvt_f32_i32 v100, v44
    v_cvt_f32_i32 v101, v45
    v_cvt_f32_i32 v102, v46
    v_cvt_f32_i32 v103, v47
    v_fmac_f32_dpp v180, v194, v100 row_newbcast:13 row_mask:0xf bank_mask:0xf
    v_fmac_f32_dpp v181, v194, v101 row_newbcast:13 row_mask:0xf bank_mask:0xf
    v_fmac_f32_dpp v182, v194, v102 row_newbcast:13 row_mask:0xf bank_mask:0xf
    v_fmac_f32_dpp v183, v194, v103 row_newbcast:13 row_mask:0xf bank_mask:0xf
    s_waitcnt vmcnt(12)
    v_cvt_f32_i32 v104, v48
    v_cvt_f32_i32 v105, v49
    v_cvt_f32_i32 v106, v50
    v_cvt_f32_i32 v107, v51
    v_fmac_f32_dpp v184, v194, v104 row_newbcast:13 row_mask:0xf bank_mask:0xf
    v_fmac_f32_dpp v185, v194, v105 row_newbcast:13 row_mask:0xf bank_mask:0xf
    v_fmac_f32_dpp v186, v194, v106 row_newbcast:13 row_mask:0xf bank_mask:0xf
    v_fmac_f32_dpp v187, v194, v107 row_newbcast:13 row_mask:0xf bank_mask:0xf
    s_waitcnt vmcnt(11)
    v_cvt_f32_i32 v100, v52
    v_cvt_f32_i32 v101, v53
    v_cvt_f32_i32 v102, v54
    v_cvt_f32_i32 v103, v55
    v_fmac_f32_dpp v176, v194, v100 row_newbcast:3 row_mask:0xf bank_mask:0xf
    v_fmac_f32_dpp v177, v194, v101 row_newbcast:3 row_mask:0xf bank_mask:0xf
    v_fmac_f32_dpp v178, v194, v102 row_newbcast:3 row_mask:0xf bank_mask:0xf
    v_fmac_f32_dpp v179, v194, v103 row_newbcast:3 row_mask:0xf bank_mask:0xf
    s_waitcnt vmcnt(10)
    v_cvt_f32_i32 v104, v56
    v_cvt_f32_i32 v105, v57
    v_cvt_f32_i32 v106, v58
    v_cvt_f32_i32 v107, v59
    v_fmac_f32_dpp v180, v194, v104 row_newbcast:3 row_mask:0xf bank_mask:0xf
    v_fmac_f32_dpp v181, v194, v105 row_newbcast:3 row_mask:0xf bank_mask:0xf
    v_fmac_f32_dpp v182, v194, v106 row_newbcast:3 row_mask:0xf bank_mask:0xf
    v_fmac_f32_dpp v183, v194, v107 row_newbcast:3 row_mask:0xf bank_mask:0xf
    s_waitcnt vmcnt(9)
    v_cvt_f32_i32 v100, v60
    v_cvt_f32_i32 v101, v61
    v_cvt_f32_i32 v102, v62
    v_cvt_f32_i32 v103, v63
    v_fmac_f32_dpp v184, v194, v100 row_newbcast:3 row_mask:0xf bank_mask:0xf
    v_fmac_f32_dpp v185, v194, v101 row_newbcast:3 row_mask:0xf bank_mask:0xf
    v_fmac_f32_dpp v186, v194, v102 row_newbcast:3 row_mask:0xf bank_mask:0xf
    v_fmac_f32_dpp v187, v194, v103 row_newbcast:3 row_mask:0xf bank_mask:0xf
    s_waitcnt vmcnt(8)
    v_cvt_f32_i32 v104, v64
    v_cvt_f32_i32 v105, v65
    v_cvt_f32_i32 v106, v66
    v_cvt_f32_i32 v107, v67
    v_fmac_f32_dpp v176, v194, v104 row_newbcast:11 row_mask:0xf bank_mask:0xf
    v_fmac_f32_dpp v177, v194, v105 row_newbcast:11 row_mask:0xf bank_mask:0xf
    v_fmac_f32_dpp v178, v194, v106 row_newbcast:11 row_mask:0xf bank_mask:0xf
    v_fmac_f32_dpp v179, v194, v107 row_newbcast:11 row_mask:0xf bank_mask:0xf
    s_waitcnt vmcnt(7)
    v_cvt_f32_i32 v100, v68
    v_cvt_f32_i32 v101, v69
    v_cvt_f32_i32 v102, v70
    v_cvt_f32_i32 v103, v71
    v_fmac_f32_dpp v180, v194, v100 row_newbcast:11 row_mask:0xf bank_mask:0xf
    v_fmac_f32_dpp v181, v194, v101 row_newbcast:11 row_mask:0xf bank_mask:0xf
    v_fmac_f32_dpp v182, v194, v102 row_newbcast:11 row_mask:0xf bank_mask:0xf
    v_fmac_f32_dpp v183, v194, v103 row_newbcast:11 row_mask:0xf bank_mask:0xf
    s_waitcnt vmcnt(6)
    v_cvt_f32_i32 v104, v72
    v_cvt_f32_i32 v105, v73
    v_cvt_f32_i32 v106, v74
    v_cvt_f32_i32 v107, v75
    v_fmac_f32_dpp v184, v194, v104 row_newbcast:11 row_mask:0xf bank_mask:0xf
    v_fmac_f32_dpp v185, v194, v105 row_newbcast:11 row_mask:0xf bank_mask:0xf
    v_fmac_f32_dpp v186, v194, v106 row_newbcast:11 row_mask:0xf bank_mask:0xf
    v_fmac_f32_dpp v187, v194, v107 row_newbcast:11 row_mask:0xf bank_mask:0xf
    s_waitcnt vmcnt(5)
    v_cvt_f32_i32 v100, v76
    v_cvt_f32_i32 v101, v77
    v_cvt_f32_i32 v102, v78
    v_cvt_f32_i32 v103, v79
    v_fmac_f32_dpp v176, v194, v100 row_newbcast:7 row_mask:0xf bank_mask:0xf
    v_fmac_f32_dpp v177, v194, v101 row_newbcast:7 row_mask:0xf bank_mask:0xf
    v_fmac_f32_dpp v178, v194, v102 row_newbcast:7 row_mask:0xf bank_mask:0xf
    v_fmac_f32_dpp v179, v194, v103 row_newbcast:7 row_mask:0xf bank_mask:0xf
    s_waitcnt vmcnt(4)
    v_cvt_f32_i32 v104, v80
    v_cvt_f32_i32 v105, v81
    v_cvt_f32_i32 v106, v82
    v_cvt_f32_i32 v107, v83
    v_fmac_f32_dpp v180, v194, v104 row_newbcast:7 row_mask:0xf bank_mask:0xf
    v_fmac_f32_dpp v181, v194, v105 row_newbcast:7 row_mask:0xf bank_mask:0xf
    v_fmac_f32_dpp v182, v194, v106 row_newbcast:7 row_mask:0xf bank_mask:0xf
    v_fmac_f32_dpp v183, v194, v107 row_newbcast:7 row_mask:0xf bank_mask:0xf
    s_waitcnt vmcnt(3)
    v_cvt_f32_i32 v100, v84
    v_cvt_f32_i32 v101, v85
    v_cvt_f32_i32 v102, v86
    v_cvt_f32_i32 v103, v87
    v_fmac_f32_dpp v184, v194, v100 row_newbcast:7 row_mask:0xf bank_mask:0xf
    v_fmac_f32_dpp v185, v194, v101 row_newbcast:7 row_mask:0xf bank_mask:0xf
    v_fmac_f32_dpp v186, v194, v102 row_newbcast:7 row_mask:0xf bank_mask:0xf
    v_fmac_f32_dpp v187, v194, v103 row_newbcast:7 row_mask:0xf bank_mask:0xf
    s_waitcnt vmcnt(2)
    v_cvt_f32_i32 v104, v88
    v_cvt_f32_i32 v105, v89
    v_cvt_f32_i32 v106, v90
    v_cvt_f32_i32 v107, v91
    v_fmac_f32_dpp v176, v194, v104 row_newbcast:15 row_mask:0xf bank_mask:0xf
    v_fmac_f32_dpp v177, v194, v105 row_newbcast:15 row_mask:0xf bank_mask:0xf
    v_fmac_f32_dpp v178, v194, v106 row_newbcast:15 row_mask:0xf bank_mask:0xf
    v_fmac_f32_dpp v179, v194, v107 row_newbcast:15 row_mask:0xf bank_mask:0xf
    s_waitcnt vmcnt(1)
    v_cvt_f32_i32 v100, v92
    v_cvt_f32_i32 v101, v93
    v_cvt_f32_i32 v102, v94
    v_cvt_f32_i32 v103, v95
    v_fmac_f32_dpp v180, v194, v100 row_newbcast:15 row_mask:0xf bank_mask:0xf
    v_fmac_f32_dpp v181, v194, v101 row_newbcast:15 row_mask:0xf bank_mask:0xf
    v_fmac_f32_dpp v182, v194, v102 row_newbcast:15 row_mask:0xf bank_mask:0xf
    v_fmac_f32_dpp v183, v194, v103 row_newbcast:15 row_mask:0xf bank_mask:0xf
    s_waitcnt vmcnt(0)
    v_cvt_f32_i32 v104, v96
    v_cvt_f32_i32 v105, v97
    v_cvt_f32_i32 v106, v98
    v_cvt_f32_i32 v107, v99
    v_fmac_f32_dpp v184, v194, v104 row_newbcast:15 row_mask:0xf bank_mask:0xf
    v_fmac_f32_dpp v185, v194, v105 row_newbcast:15 row_mask:0xf bank_mask:0xf
    v_fmac_f32_dpp v186, v194, v106 row_newbcast:15 row_mask:0xf bank_mask:0xf
    v_fmac_f32_dpp v187, v194, v107 row_newbcast:15 row_mask:0xf bank_mask:0xf
    s_nop 0
    v_add_f32_dpp v189, v189, v189 row_ror:8 row_mask:0xf bank_mask:0xf
    v_add_f32_dpp v190, v190, v190 row_ror:8 row_mask:0xf bank_mask:0xf
    s_nop 0
    v_add_f32_dpp v189, v189, v189 row_ror:4 row_mask:0xf bank_mask:0xf
    v_add_f32_dpp v190, v190, v190 row_ror:4 row_mask:0xf bank_mask:0xf
    s_nop 0
    v_add_f32_dpp v189, v189, v189 row_ror:2 row_mask:0xf bank_mask:0xf
    v_add_f32_dpp v190, v190, v190 row_ror:2 row_mask:0xf bank_mask:0xf
    s_nop 0
    v_add_f32_dpp v189, v189, v189 row_ror:1 row_mask:0xf bank_mask:0xf
    v_add_f32_dpp v190, v190, v190 row_ror:1 row_mask:0xf bank_mask:0xf
    v_mov_b32 v206, v188
    v_mov_b32 v207, v188
    s_nop 1
    v_permlane32_swap_b32 v206, v207
    s_nop 1
    v_max_f32 v206, v206, v207
    v_mov_b32 v207, v206
    s_nop 1
    v_permlane16_swap_b32 v206, v207
    s_nop 1
    v_max_f32 v206, v206, v207
    v_sub_f32 v207, v188, v206
    v_exp_f32 v207, v207
    v_mov_b32 v104, v206
    v_mul_f32 v189, v189, v207
    v_mul_f32 v190, v190, v207
    v_fma_f32 v176, v176, v207, -v190
    v_fma_f32 v177, v177, v207, -v190
    v_fma_f32 v178, v178, v207, -v190
    v_fma_f32 v179, v179, v207, -v190
    v_fma_f32 v180, v180, v207, -v190
    v_fma_f32 v181, v181, v207, -v190
    v_fma_f32 v182, v182, v207, -v190
    v_fma_f32 v183, v183, v207, -v190
    v_fma_f32 v184, v184, v207, -v190
    v_fma_f32 v185, v185, v207, -v190
    v_fma_f32 v186, v186, v207, -v190
    v_fma_f32 v187, v187, v207, -v190
    v_mov_b32 v206, v189
    s_nop 1
    v_permlane32_swap_b32 v189, v206
    v_permlane32_swap_b32 v176, v178
    v_permlane32_swap_b32 v177, v179
    v_permlane32_swap_b32 v180, v182
    v_permlane32_swap_b32 v181, v183
    v_permlane32_swap_b32 v184, v186
    v_permlane32_swap_b32 v185, v187
    s_nop 1
    v_add_f32 v189, v189, v206
    v_add_f32 v176, v176, v178
    v_add_f32 v177, v177, v179
    v_add_f32 v180, v180, v182
    v_add_f32 v181, v181, v183
    v_add_f32 v184, v184, v186
    v_add_f32 v185, v185, v187
    v_mov_b32 v206, v189
    s_nop 1
    v_permlane16_swap_b32 v189, v206
    v_permlane16_swap_b32 v176, v177
    v_permlane16_swap_b32 v180, v181
    v_permlane16_swap_b32 v184, v185
    s_nop 1
    v_add_f32 v105, v189, v206
    v_add_f32 v100, v176, v177
    v_add_f32 v101, v180, v181
    v_add_f32 v102, v184, v185
    v_mov_b32 v103, s93
    v_mov_b32 v106, s93
    v_mov_b32 v107, s93
    v_lshlrev_b32 v207, 4, v0
    s_lshl_b32 s80, s3, 11
    buffer_store_dwordx4 v[100:103], v207, s[52:55], s80 offen offset:0 sc0 sc1
    s_mov_b64 exec, 1
    buffer_store_dwordx4 v[104:107], v207, s[52:55], s80 offen offset:1024 sc0 sc1
    s_mov_b64 exec, -1
    s_endpgm
L_service:
    v_lshlrev_b32 v5, 2, v0
    v_mov_b32 v3, 0
    ds_write_b32 v5, v3 offset:0
    v_lshlrev_b32 v1, 4, v0
    v_mov_b32 v2, v1
    v_lshlrev_b32 v28, 11, v0
    v_mov_b32 v4, 0
    v_mov_b32 v9, 0xf149f2ca
    v_cndmask_b32 v9, v9, v3, s[66:67]
    v_and_b32 v5, 15, v0
    v_lshrrev_b32 v6, 4, v0
    v_lshl_add_u32 v10, v5, 2, v6
    v_lshlrev_b32 v10, 1, v10
    s_getreg_b32 s72, hwreg(HW_REG_XCC_ID)
    s_and_b32 s72, s72, 15
    s_lshl_b32 s77, s2, 11
    s_add_u32 s77, s77, 2097152
    s_lshl_b32 s94, s79, 17
    s_add_u32 s94, s94, 2097152
    s_mov_b32 s71, 0
    s_mov_b32 s76, 0
    s_mov_b32 s95, 0
    s_waitcnt lgkmcnt(0)
    s_barrier
    s_mov_b32 s52, s22
    s_and_b32 s53, s23, 0xffff
    s_mov_b32 s54, 25165824
    s_mov_b32 s55, 0x00020000
    s_mov_b32 s56, s18
    s_and_b32 s57, s19, 0xffff
    s_mov_b32 s58, 12288
    s_mov_b32 s59, 0x00020000
L_poll:
    ds_read_b32 v5, v4
    s_waitcnt lgkmcnt(0)
    v_readfirstlane_b32 s80, v5
    s_cmp_eq_u32 s80, 0
    s_cbranch_scc1 L_poll
    ds_read_b128 v[12:15], v2 offset:3328
    s_cmp_lg_u32 s71, 0
    s_cbranch_scc1 L_guard
L_tag:
    ds_read_b32 v5, v3 offset:136
    s_waitcnt lgkmcnt(0)
    v_readfirstlane_b32 s69, v5
    s_cmp_eq_u32 s69, 0
    s_cbranch_scc1 L_tag
    s_lshl_b32 s81, s79, 17
    s_lshr_b32 s82, s3, 6
    s_lshl_b32 s82, s82, 17
L_reg:
    buffer_load_dwordx2 v[16:17], v28, s[52:55], s81 offen offset:1536 sc0 sc1
    buffer_load_dwordx2 v[18:19], v28, s[52:55], s82 offen offset:1536 sc0 sc1
    s_waitcnt vmcnt(0)
    v_cmp_ne_u32 vcc, s69, v17
    s_cmp_lg_u64 vcc, 0
    s_cbranch_scc1 L_reg
    v_cmp_ne_u32 vcc, s69, v19
    s_cmp_lg_u64 vcc, 0
    s_cbranch_scc1 L_reg
    ds_write_b32 v3, v17 offset:140
    s_mov_b32 s95, s69
    v_cmp_eq_u32 s[86:87], s72, v16
    v_lshlrev_b32 v7, v16, 1
    s_nop 1
    v_or_b32_dpp v7, v7, v7 row_ror:8 row_mask:0xf bank_mask:0xf
    s_nop 1
    v_or_b32_dpp v7, v7, v7 row_ror:4 row_mask:0xf bank_mask:0xf
    s_nop 1
    v_or_b32_dpp v7, v7, v7 row_ror:2 row_mask:0xf bank_mask:0xf
    s_nop 1
    v_or_b32_dpp v7, v7, v7 row_ror:1 row_mask:0xf bank_mask:0xf
    v_mov_b32 v5, v7
    s_nop 1
    v_permlane32_swap_b32 v7, v5
    s_nop 1
    v_or_b32 v7, v7, v5
    v_mov_b32 v5, v7
    s_nop 1
    v_permlane16_swap_b32 v7, v5
    s_nop 1
    v_or_b32 v7, v7, v5
    s_bcnt1_i32_b64 s70, s[86:87]
    s_bfm_b64 s[84:85], s92, 0
    s_and_b64 s[84:85], s[84:85], s[86:87]
    s_bcnt1_i32_b64 s73, s[84:85]
    v_readfirstlane_b32 s88, v7
    s_mov_b32 s89, 0
    s_branch L_dep
L_guard:
    v_mov_b32 v17, s69
    s_mov_b64 exec, s[86:87]
    buffer_load_dwordx2 v[16:17], v28, s[52:55], s94 offen offset:1024 sc0 sc1
    s_mov_b64 exec, -1
    s_waitcnt vmcnt(0)
    v_cmp_eq_u32 vcc, s95, v17
    s_cmp_eq_u64 vcc, 0
    s_cbranch_scc1 L_guard
L_dep:
    s_add_u32 s71, s71, 1
    s_add_u32 s95, s95, 1
    s_waitcnt lgkmcnt(0)
    buffer_store_dwordx4 v[12:15], v1, s[52:55], s77 offen
    v_mov_b32 v6, s95
    s_mov_b64 exec, 1
    s_waitcnt vmcnt(0)
    buffer_store_dword v6, v3, s[52:55], s77 offen offset:1024
    s_mov_b64 exec, -1
    s_cmp_lg_u32 s76, s73
    s_cbranch_scc1 L_next
L_all:
    v_mov_b32 v16, s95
    s_mov_b64 exec, s[86:87]
    buffer_load_dword v16, v28, s[52:55], s94 offen offset:1024 sc0 sc1
    s_mov_b64 exec, -1
    s_waitcnt vmcnt(0)
    v_cmp_ne_u32 vcc, s95, v16
    s_cmp_lg_u64 vcc, 0
    s_cbranch_scc1 L_all
    s_mov_b32 s74, 0
    s_mov_b32 s75, s94
    s_mov_b64 s[84:85], s[86:87]
L_merge:
    v_mov_b32 v7, 0xf149f2ca
    v_mov_b32 v8, 0
    v_mov_b32 v12, 0
    v_mov_b32 v13, 0
    v_mov_b32 v14, 0
L_chunk:
    v_mov_b32 v48, 0
    v_mov_b32 v49, 0
    v_mov_b32 v50, 0
    v_mov_b32 v51, v9
    v_mov_b32 v52, 0
    v_mov_b32 v53, 0
    v_mov_b32 v54, 0
    v_mov_b32 v55, v9
    v_mov_b32 v56, 0
    v_mov_b32 v57, 0
    v_mov_b32 v58, 0
    v_mov_b32 v59, v9
    v_mov_b32 v60, 0
    v_mov_b32 v61, 0
    v_mov_b32 v62, 0
    v_mov_b32 v63, v9
    v_mov_b32 v64, 0
    v_mov_b32 v65, 0
    v_mov_b32 v66, 0
    v_mov_b32 v67, v9
    v_mov_b32 v68, 0
    v_mov_b32 v69, 0
    v_mov_b32 v70, 0
    v_mov_b32 v71, v9
    v_mov_b32 v72, 0
    v_mov_b32 v73, 0
    v_mov_b32 v74, 0
    v_mov_b32 v75, v9
    v_mov_b32 v76, 0
    v_mov_b32 v77, 0
    v_mov_b32 v78, 0
    v_mov_b32 v79, v9
    s_ff1_i32_b64 s80, s[84:85]
    s_bitset0_b64 s[84:85], s80
    s_lshl_b32 s81, s80, 11
    s_add_u32 s81, s81, s75
    s_cmp_ge_i32 s80, 0
    s_cselect_b64 exec, -1, 0
    buffer_load_dwordx4 v[48:51], v1, s[52:55], s81 offen sc0 sc1
    s_ff1_i32_b64 s80, s[84:85]
    s_bitset0_b64 s[84:85], s80
    s_lshl_b32 s81, s80, 11
    s_add_u32 s81, s81, s75
    s_cmp_ge_i32 s80, 0
    s_cselect_b64 exec, -1, 0
    buffer_load_dwordx4 v[52:55], v1, s[52:55], s81 offen sc0 sc1
    s_ff1_i32_b64 s80, s[84:85]
    s_bitset0_b64 s[84:85], s80
    s_lshl_b32 s81, s80, 11
    s_add_u32 s81, s81, s75
    s_cmp_ge_i32 s80, 0
    s_cselect_b64 exec, -1, 0
    buffer_load_dwordx4 v[56:59], v1, s[52:55], s81 offen sc0 sc1
    s_ff1_i32_b64 s80, s[84:85]
    s_bitset0_b64 s[84:85], s80
    s_lshl_b32 s81, s80, 11
    s_add_u32 s81, s81, s75
    s_cmp_ge_i32 s80, 0
    s_cselect_b64 exec, -1, 0
    buffer_load_dwordx4 v[60:63], v1, s[52:55], s81 offen sc0 sc1
    s_ff1_i32_b64 s80, s[84:85]
    s_bitset0_b64 s[84:85], s80
    s_lshl_b32 s81, s80, 11
    s_add_u32 s81, s81, s75
    s_cmp_ge_i32 s80, 0
    s_cselect_b64 exec, -1, 0
    buffer_load_dwordx4 v[64:67], v1, s[52:55], s81 offen sc0 sc1
    s_ff1_i32_b64 s80, s[84:85]
    s_bitset0_b64 s[84:85], s80
    s_lshl_b32 s81, s80, 11
    s_add_u32 s81, s81, s75
    s_cmp_ge_i32 s80, 0
    s_cselect_b64 exec, -1, 0
    buffer_load_dwordx4 v[68:71], v1, s[52:55], s81 offen sc0 sc1
    s_ff1_i32_b64 s80, s[84:85]
    s_bitset0_b64 s[84:85], s80
    s_lshl_b32 s81, s80, 11
    s_add_u32 s81, s81, s75
    s_cmp_ge_i32 s80, 0
    s_cselect_b64 exec, -1, 0
    buffer_load_dwordx4 v[72:75], v1, s[52:55], s81 offen sc0 sc1
    s_ff1_i32_b64 s80, s[84:85]
    s_bitset0_b64 s[84:85], s80
    s_lshl_b32 s81, s80, 11
    s_add_u32 s81, s81, s75
    s_cmp_ge_i32 s80, 0
    s_cselect_b64 exec, -1, 0
    buffer_load_dwordx4 v[76:79], v1, s[52:55], s81 offen sc0 sc1
    s_mov_b64 exec, -1
    s_waitcnt vmcnt(0)
    v_max3_f32 v5, v51, v55, v59
    v_max3_f32 v5, v5, v63, v67
    v_max3_f32 v5, v5, v71, v75
    v_max_f32 v5, v5, v79
    s_nop 1
    v_max_f32_dpp v6, v5, v7 quad_perm:[0,0,2,2] row_mask:0xf bank_mask:0xf
    v_sub_f32 v5, v7, v6
    v_exp_f32 v5, v5
    v_sub_f32_dpp v20, v51, v6 quad_perm:[0,0,2,2] row_mask:0xf bank_mask:0xf
    v_sub_f32_dpp v21, v55, v6 quad_perm:[0,0,2,2] row_mask:0xf bank_mask:0xf
    v_sub_f32_dpp v22, v59, v6 quad_perm:[0,0,2,2] row_mask:0xf bank_mask:0xf
    v_sub_f32_dpp v23, v63, v6 quad_perm:[0,0,2,2] row_mask:0xf bank_mask:0xf
    v_sub_f32_dpp v24, v67, v6 quad_perm:[0,0,2,2] row_mask:0xf bank_mask:0xf
    v_sub_f32_dpp v25, v71, v6 quad_perm:[0,0,2,2] row_mask:0xf bank_mask:0xf
    v_sub_f32_dpp v26, v75, v6 quad_perm:[0,0,2,2] row_mask:0xf bank_mask:0xf
    v_sub_f32_dpp v27, v79, v6 quad_perm:[0,0,2,2] row_mask:0xf bank_mask:0xf
    v_exp_f32 v20, v20
    v_exp_f32 v21, v21
    v_exp_f32 v22, v22
    v_exp_f32 v23, v23
    v_exp_f32 v24, v24
    v_exp_f32 v25, v25
    v_exp_f32 v26, v26
    v_exp_f32 v27, v27
    v_mov_b32 v7, v6
    v_mul_f32 v8, v8, v5
    v_mul_f32 v12, v12, v5
    v_mul_f32 v13, v13, v5
    v_mul_f32 v14, v14, v5
    v_fmac_f32 v12, v20, v48
    v_fmac_f32 v13, v20, v49
    v_fmac_f32 v14, v20, v50
    v_fmac_f32 v8, v20, v51
    v_fmac_f32 v12, v21, v52
    v_fmac_f32 v13, v21, v53
    v_fmac_f32 v14, v21, v54
    v_fmac_f32 v8, v21, v55
    v_fmac_f32 v12, v22, v56
    v_fmac_f32 v13, v22, v57
    v_fmac_f32 v14, v22, v58
    v_fmac_f32 v8, v22, v59
    v_fmac_f32 v12, v23, v60
    v_fmac_f32 v13, v23, v61
    v_fmac_f32 v14, v23, v62
    v_fmac_f32 v8, v23, v63
    v_fmac_f32 v12, v24, v64
    v_fmac_f32 v13, v24, v65
    v_fmac_f32 v14, v24, v66
    v_fmac_f32 v8, v24, v67
    v_fmac_f32 v12, v25, v68
    v_fmac_f32 v13, v25, v69
    v_fmac_f32 v14, v25, v70
    v_fmac_f32 v8, v25, v71
    v_fmac_f32 v12, v26, v72
    v_fmac_f32 v13, v26, v73
    v_fmac_f32 v14, v26, v74
    v_fmac_f32 v8, v26, v75
    v_fmac_f32 v12, v27, v76
    v_fmac_f32 v13, v27, v77
    v_fmac_f32 v14, v27, v78
    v_fmac_f32 v8, v27, v79
    s_cmp_lg_u64 s[84:85], 0
    s_cbranch_scc1 L_chunk
    s_cmp_lg_u32 s74, 0
    s_cbranch_scc1 L_fin
    v_cndmask_b32 v15, v7, v8, s[66:67]
    v_mov_b32 v5, s95
    v_mov_b32 v6, s70
    s_lshl_b32 s75, s79, 15
    s_add_u32 s75, s75, 1048576
    s_lshl_b32 s80, s72, 11
    s_add_u32 s80, s80, s75
    buffer_store_dwordx4 v[12:15], v1, s[52:55], s80 offen sc0 sc1
    s_mov_b64 exec, 1
    buffer_store_dword v5, v3, s[52:55], s77 offen offset:1028
    s_lshl_b32 s80, s79, 8
    s_add_u32 s80, s80, 23076864
    s_waitcnt vmcnt(0)
    buffer_atomic_add v6, v3, s[52:55], s80 offen sc0 sc1
    s_waitcnt vmcnt(0)
    s_mov_b64 exec, -1
    v_readfirstlane_b32 s80, v6
    s_add_u32 s80, s80, s70
    s_cmp_lg_u32 s80, 64
    s_cbranch_scc1 L_next
    s_mov_b32 s74, 1
    s_mov_b64 s[84:85], s[88:89]
    s_branch L_merge
L_fin:
    s_nop 1
    v_mov_b32_dpp v5, v8 quad_perm:[1,1,3,3] row_mask:0xf bank_mask:0xf
    v_rcp_f32 v5, v5
    s_mul_i32 s80, s79, 384
    v_mul_f32 v12, v12, v5
    v_mul_f32 v13, v13, v5
    v_mul_f32 v14, v14, v5
    v_cvt_pk_bf16_f32 v12, v12, v12
    v_cvt_pk_bf16_f32 v13, v13, v13
    v_cvt_pk_bf16_f32 v14, v14, v14
    buffer_store_short v12, v10, s[56:59], s80 offen offset:0
    buffer_store_short v13, v10, s[56:59], s80 offen offset:128
    buffer_store_short v14, v10, s[56:59], s80 offen offset:256
L_next:
    v_add_u32 v2, 1024, v2
    v_add_u32 v4, 4, v4
    s_add_u32 s79, s79, 4
    s_add_u32 s76, s76, 1
    s_cmp_eq_u32 s76, s70
    s_cselect_b32 s76, 0, s76
    s_cmp_lt_u32 s71, 7
    s_cbranch_scc1 L_poll
    s_and_b32 s92, s3, 63
    s_lshr_b32 s78, s92, 4
    s_lshr_b32 s81, s3, 6
    s_add_u32 s79, s81, 28
    s_mul_i32 s80, s78, 5
    s_mul_i32 s82, s81, 3
    s_add_u32 s80, s80, s82
    s_add_u32 s80, s80, 1
    s_xor_b32 s80, s80, s92
    s_and_b32 s80, s80, 15
    s_cbranch_scc1 L_end
    s_lshl_b32 s75, s81, 17
    v_and_b32 v5, 15, v0
    v_lshrrev_b32 v6, 4, v0
    v_lshlrev_b32 v28, 11, v6
    v_lshl_add_u32 v44, v5, 13, v28
    v_lshl_add_u32 v28, v5, 4, v28
    s_lshl_b32 s80, s78, 8
    v_add_u32 v28, s80, v28
    v_add_u32 v29, 8192, v28
    v_add_u32 v30, 16384, v28
    v_add_u32 v31, 24576, v28
    v_add_u32 v32, 32768, v28
    v_add_u32 v33, 40960, v28
    v_add_u32 v34, 49152, v28
    v_add_u32 v35, 57344, v28
    v_add_u32 v36, 65536, v28
    v_add_u32 v37, 73728, v28
    v_add_u32 v38, 81920, v28
    v_add_u32 v39, 90112, v28
    v_add_u32 v40, 98304, v28
    v_add_u32 v41, 106496, v28
    v_add_u32 v42, 114688, v28
    v_add_u32 v43, 122880, v28
    v_mov_b32 v51, 0
    v_mov_b32 v55, 0
    v_mov_b32 v59, 0
    v_mov_b32 v63, 0
    v_mov_b32 v67, 0
    v_mov_b32 v71, 0
    v_mov_b32 v75, 0
    v_mov_b32 v79, 0
    v_mov_b32 v83, 0
    v_mov_b32 v87, 0
    v_mov_b32 v91, 0
    v_mov_b32 v95, 0
    v_mov_b32 v99, 0
    v_mov_b32 v103, 0
    v_mov_b32 v107, 0
    v_mov_b32 v111, 0
    v_mov_b32 v19, 0
    v_lshlrev_b32 v10, 3, v5
    s_lshl_b32 s80, s78, 1
    s_mul_i32 s78, s79, 384
    s_add_u32 s78, s78, s80
L_dt:
    ds_read_b32 v5, v3 offset:144
    s_waitcnt lgkmcnt(0)
    v_readfirstlane_b32 s80, v5
    s_cmp_eq_u32 s80, 0
    s_cbranch_scc1 L_dt
L_pp:
    v_cmp_ne_u32 s[24:25], s69, v51
    v_cmp_ne_u32 s[26:27], s69, v55
    v_cmp_ne_u32 s[28:29], s69, v59
    v_cmp_ne_u32 s[30:31], s69, v63
    v_cmp_ne_u32 s[32:33], s69, v67
    v_cmp_ne_u32 s[34:35], s69, v71
    v_cmp_ne_u32 s[36:37], s69, v75
    v_cmp_ne_u32 s[38:39], s69, v79
    v_cmp_ne_u32 s[40:41], s69, v83
    v_cmp_ne_u32 s[42:43], s69, v87
    v_cmp_ne_u32 s[44:45], s69, v91
    v_cmp_ne_u32 s[46:47], s69, v95
    v_cmp_ne_u32 s[48:49], s69, v99
    v_cmp_ne_u32 s[50:51], s69, v103
    v_cmp_ne_u32 s[4:5], s69, v107
    v_cmp_ne_u32 s[6:7], s69, v111
    v_cmp_ne_u32 s[8:9], s69, v19
    s_or_b64 s[90:91], s[24:25], s[26:27]
    s_or_b64 s[90:91], s[90:91], s[28:29]
    s_or_b64 s[90:91], s[90:91], s[30:31]
    s_or_b64 s[90:91], s[90:91], s[32:33]
    s_or_b64 s[90:91], s[90:91], s[34:35]
    s_or_b64 s[90:91], s[90:91], s[36:37]
    s_or_b64 s[90:91], s[90:91], s[38:39]
    s_or_b64 s[90:91], s[90:91], s[40:41]
    s_or_b64 s[90:91], s[90:91], s[42:43]
    s_or_b64 s[90:91], s[90:91], s[44:45]
    s_or_b64 s[90:91], s[90:91], s[46:47]
    s_or_b64 s[90:91], s[90:91], s[48:49]
    s_or_b64 s[90:91], s[90:91], s[50:51]
    s_or_b64 s[90:91], s[90:91], s[4:5]
    s_or_b64 s[90:91], s[90:91], s[6:7]
    s_or_b64 s[90:91], s[90:91], s[8:9]
    s_cbranch_scc0 L_pd
    s_mov_b64 exec, s[8:9]
    buffer_load_dwordx4 v[16:19], v44, s[52:55], s75 offen offset:1024 sc0 sc1
    s_mov_b64 exec, s[24:25]
    buffer_load_dwordx4 v[48:51], v28, s[52:55], s75 offen offset:0 sc0 sc1
    s_mov_b64 exec, s[26:27]
    buffer_load_dwordx4 v[52:55], v29, s[52:55], s75 offen offset:0 sc0 sc1
    s_mov_b64 exec, s[28:29]
    buffer_load_dwordx4 v[56:59], v30, s[52:55], s75 offen offset:0 sc0 sc1
    s_mov_b64 exec, s[30:31]
    buffer_load_dwordx4 v[60:63], v31, s[52:55], s75 offen offset:0 sc0 sc1
    s_mov_b64 exec, s[32:33]
    buffer_load_dwordx4 v[64:67], v32, s[52:55], s75 offen offset:0 sc0 sc1
    s_mov_b64 exec, s[34:35]
    buffer_load_dwordx4 v[68:71], v33, s[52:55], s75 offen offset:0 sc0 sc1
    s_mov_b64 exec, s[36:37]
    buffer_load_dwordx4 v[72:75], v34, s[52:55], s75 offen offset:0 sc0 sc1
    s_mov_b64 exec, s[38:39]
    buffer_load_dwordx4 v[76:79], v35, s[52:55], s75 offen offset:0 sc0 sc1
    s_mov_b64 exec, s[40:41]
    buffer_load_dwordx4 v[80:83], v36, s[52:55], s75 offen offset:0 sc0 sc1
    s_mov_b64 exec, s[42:43]
    buffer_load_dwordx4 v[84:87], v37, s[52:55], s75 offen offset:0 sc0 sc1
    s_mov_b64 exec, s[44:45]
    buffer_load_dwordx4 v[88:91], v38, s[52:55], s75 offen offset:0 sc0 sc1
    s_mov_b64 exec, s[46:47]
    buffer_load_dwordx4 v[92:95], v39, s[52:55], s75 offen offset:0 sc0 sc1
    s_mov_b64 exec, s[48:49]
    buffer_load_dwordx4 v[96:99], v40, s[52:55], s75 offen offset:0 sc0 sc1
    s_mov_b64 exec, s[50:51]
    buffer_load_dwordx4 v[100:103], v41, s[52:55], s75 offen offset:0 sc0 sc1
    s_mov_b64 exec, s[4:5]
    buffer_load_dwordx4 v[104:107], v42, s[52:55], s75 offen offset:0 sc0 sc1
    s_mov_b64 exec, s[6:7]
    buffer_load_dwordx4 v[108:111], v43, s[52:55], s75 offen offset:0 sc0 sc1
    s_mov_b64 exec, -1
    s_waitcnt vmcnt(0)
    s_branch L_pp
L_pd:
    v_mov_b32 v7, v16
    s_nop 1
    v_max_f32_dpp v7, v7, v7 row_ror:8 row_mask:0xf bank_mask:0xf
    s_nop 1
    v_max_f32_dpp v7, v7, v7 row_ror:4 row_mask:0xf bank_mask:0xf
    s_nop 1
    v_max_f32_dpp v7, v7, v7 row_ror:2 row_mask:0xf bank_mask:0xf
    s_nop 1
    v_max_f32_dpp v7, v7, v7 row_ror:1 row_mask:0xf bank_mask:0xf
    v_mov_b32 v5, v7
    s_nop 1
    v_permlane32_swap_b32 v7, v5
    s_nop 1
    v_max_f32 v7, v7, v5
    v_mov_b32 v5, v7
    s_nop 1
    v_permlane16_swap_b32 v7, v5
    s_nop 1
    v_max_f32 v7, v7, v5
    v_sub_f32 v6, v16, v7
    v_exp_f32 v6, v6
    v_mov_b32 v12, 0
    v_mov_b32 v13, 0
    v_mov_b32 v14, 0
    v_mul_f32 v8, v6, v17
    v_fmac_f32_dpp v12, v6, v48 row_newbcast:0 row_mask:0xf bank_mask:0xf
    v_fmac_f32_dpp v13, v6, v49 row_newbcast:0 row_mask:0xf bank_mask:0xf
    v_fmac_f32_dpp v14, v6, v50 row_newbcast:0 row_mask:0xf bank_mask:0xf
    v_fmac_f32_dpp v12, v6, v52 row_newbcast:1 row_mask:0xf bank_mask:0xf
    v_fmac_f32_dpp v13, v6, v53 row_newbcast:1 row_mask:0xf bank_mask:0xf
    v_fmac_f32_dpp v14, v6, v54 row_newbcast:1 row_mask:0xf bank_mask:0xf
    v_fmac_f32_dpp v12, v6, v56 row_newbcast:2 row_mask:0xf bank_mask:0xf
    v_fmac_f32_dpp v13, v6, v57 row_newbcast:2 row_mask:0xf bank_mask:0xf
    v_fmac_f32_dpp v14, v6, v58 row_newbcast:2 row_mask:0xf bank_mask:0xf
    v_fmac_f32_dpp v12, v6, v60 row_newbcast:3 row_mask:0xf bank_mask:0xf
    v_fmac_f32_dpp v13, v6, v61 row_newbcast:3 row_mask:0xf bank_mask:0xf
    v_fmac_f32_dpp v14, v6, v62 row_newbcast:3 row_mask:0xf bank_mask:0xf
    v_fmac_f32_dpp v12, v6, v64 row_newbcast:4 row_mask:0xf bank_mask:0xf
    v_fmac_f32_dpp v13, v6, v65 row_newbcast:4 row_mask:0xf bank_mask:0xf
    v_fmac_f32_dpp v14, v6, v66 row_newbcast:4 row_mask:0xf bank_mask:0xf
    v_fmac_f32_dpp v12, v6, v68 row_newbcast:5 row_mask:0xf bank_mask:0xf
    v_fmac_f32_dpp v13, v6, v69 row_newbcast:5 row_mask:0xf bank_mask:0xf
    v_fmac_f32_dpp v14, v6, v70 row_newbcast:5 row_mask:0xf bank_mask:0xf
    v_fmac_f32_dpp v12, v6, v72 row_newbcast:6 row_mask:0xf bank_mask:0xf
    v_fmac_f32_dpp v13, v6, v73 row_newbcast:6 row_mask:0xf bank_mask:0xf
    v_fmac_f32_dpp v14, v6, v74 row_newbcast:6 row_mask:0xf bank_mask:0xf
    v_fmac_f32_dpp v12, v6, v76 row_newbcast:7 row_mask:0xf bank_mask:0xf
    v_fmac_f32_dpp v13, v6, v77 row_newbcast:7 row_mask:0xf bank_mask:0xf
    v_fmac_f32_dpp v14, v6, v78 row_newbcast:7 row_mask:0xf bank_mask:0xf
    v_fmac_f32_dpp v12, v6, v80 row_newbcast:8 row_mask:0xf bank_mask:0xf
    v_fmac_f32_dpp v13, v6, v81 row_newbcast:8 row_mask:0xf bank_mask:0xf
    v_fmac_f32_dpp v14, v6, v82 row_newbcast:8 row_mask:0xf bank_mask:0xf
    v_fmac_f32_dpp v12, v6, v84 row_newbcast:9 row_mask:0xf bank_mask:0xf
    v_fmac_f32_dpp v13, v6, v85 row_newbcast:9 row_mask:0xf bank_mask:0xf
    v_fmac_f32_dpp v14, v6, v86 row_newbcast:9 row_mask:0xf bank_mask:0xf
    v_fmac_f32_dpp v12, v6, v88 row_newbcast:10 row_mask:0xf bank_mask:0xf
    v_fmac_f32_dpp v13, v6, v89 row_newbcast:10 row_mask:0xf bank_mask:0xf
    v_fmac_f32_dpp v14, v6, v90 row_newbcast:10 row_mask:0xf bank_mask:0xf
    v_fmac_f32_dpp v12, v6, v92 row_newbcast:11 row_mask:0xf bank_mask:0xf
    v_fmac_f32_dpp v13, v6, v93 row_newbcast:11 row_mask:0xf bank_mask:0xf
    v_fmac_f32_dpp v14, v6, v94 row_newbcast:11 row_mask:0xf bank_mask:0xf
    v_fmac_f32_dpp v12, v6, v96 row_newbcast:12 row_mask:0xf bank_mask:0xf
    v_fmac_f32_dpp v13, v6, v97 row_newbcast:12 row_mask:0xf bank_mask:0xf
    v_fmac_f32_dpp v14, v6, v98 row_newbcast:12 row_mask:0xf bank_mask:0xf
    v_fmac_f32_dpp v12, v6, v100 row_newbcast:13 row_mask:0xf bank_mask:0xf
    v_fmac_f32_dpp v13, v6, v101 row_newbcast:13 row_mask:0xf bank_mask:0xf
    v_fmac_f32_dpp v14, v6, v102 row_newbcast:13 row_mask:0xf bank_mask:0xf
    v_fmac_f32_dpp v12, v6, v104 row_newbcast:14 row_mask:0xf bank_mask:0xf
    v_fmac_f32_dpp v13, v6, v105 row_newbcast:14 row_mask:0xf bank_mask:0xf
    v_fmac_f32_dpp v14, v6, v106 row_newbcast:14 row_mask:0xf bank_mask:0xf
    v_fmac_f32_dpp v12, v6, v108 row_newbcast:15 row_mask:0xf bank_mask:0xf
    v_fmac_f32_dpp v13, v6, v109 row_newbcast:15 row_mask:0xf bank_mask:0xf
    v_fmac_f32_dpp v14, v6, v110 row_newbcast:15 row_mask:0xf bank_mask:0xf
    s_nop 1
    v_add_f32_dpp v8, v8, v8 row_ror:8 row_mask:0xf bank_mask:0xf
    s_nop 1
    v_add_f32_dpp v8, v8, v8 row_ror:4 row_mask:0xf bank_mask:0xf
    s_nop 1
    v_add_f32_dpp v8, v8, v8 row_ror:2 row_mask:0xf bank_mask:0xf
    s_nop 1
    v_add_f32_dpp v8, v8, v8 row_ror:1 row_mask:0xf bank_mask:0xf
    v_mov_b32 v5, v8
    s_nop 1
    v_permlane32_swap_b32 v8, v5
    s_nop 1
    v_add_f32 v8, v8, v5
    v_mov_b32 v5, v8
    s_nop 1
    v_permlane16_swap_b32 v8, v5
    s_nop 1
    v_add_f32 v8, v8, v5
    v_rcp_f32 v8, v8
    v_mov_b32 v20, v12
    v_mov_b32 v21, v13
    v_mov_b32 v22, v14
    s_nop 1
    v_permlane32_swap_b32 v12, v20
    v_permlane32_swap_b32 v13, v21
    v_permlane32_swap_b32 v14, v22
    s_nop 1
    v_add_f32 v12, v12, v20
    v_add_f32 v13, v13, v21
    v_add_f32 v14, v14, v22
    v_mov_b32 v20, v12
    v_mov_b32 v21, v13
    v_mov_b32 v22, v14
    s_nop 1
    v_permlane16_swap_b32 v12, v20
    v_permlane16_swap_b32 v13, v21
    v_permlane16_swap_b32 v14, v22
    s_nop 1
    v_add_f32 v12, v12, v20
    v_add_f32 v13, v13, v21
    v_add_f32 v14, v14, v22
    v_mul_f32 v12, v12, v8
    v_mul_f32 v13, v13, v8
    v_mul_f32 v14, v14, v8
    v_cvt_pk_bf16_f32 v12, v12, v12
    v_cvt_pk_bf16_f32 v13, v13, v13
    v_cvt_pk_bf16_f32 v14, v14, v14
    s_mov_b64 exec, 0xffff
    buffer_store_short v12, v10, s[56:59], s78 offen offset:0
    buffer_store_short v13, v10, s[56:59], s78 offen offset:128
    buffer_store_short v14, v10, s[56:59], s78 offen offset:256
L_end:
    s_endpgm
L_ticket:
    v_lshlrev_b32 v1, 2, v0
    v_mov_b32 v2, 0
    v_lshlrev_b32 v4, 4, v0
    v_mov_b32 v8, -1
    v_mov_b32 v9, -1
    v_mov_b32 v10, -1
    v_mov_b32 v11, -1
    ds_write_b128 v4, v[8:11] offset:256
    ds_write_b128 v4, v[8:11] offset:1280
    ds_write_b128 v4, v[8:11] offset:2304
    s_memrealtime s[80:81]
    s_waitcnt lgkmcnt(0)
    s_barrier
    s_mov_b32 s52, s22
    s_and_b32 s53, s23, 0xffff
    s_mov_b32 s54, 25165824
    s_mov_b32 s55, 0x00020000
    s_mov_b32 s60, s20
    s_and_b32 s61, s21, 0xffff
    s_mov_b32 s62, 256
    s_mov_b32 s63, 0x00020000
    s_max_u32 s69, s80, 1
    s_cmp_lg_u32 s2, 0
    s_cbranch_scc1 L_kd
    v_lshlrev_b32 v5, 8, v0
    s_mov_b32 s80, 23068672
    buffer_store_dword v2, v5, s[52:55], s80 offen sc0 sc1
    v_mov_b32 v3, s69
    s_mov_b64 exec, 1
    s_waitcnt vmcnt(0)
    buffer_store_dword v3, v2, s[60:63], 0 offen sc0 sc1
    s_mov_b64 exec, -1
L_kd:
    ds_read_b32 v3, v2 offset:128
    s_waitcnt lgkmcnt(0)
    v_readfirstlane_b32 s80, v3
    s_cmp_eq_u32 s80, 0
    s_cbranch_scc1 L_kd
    ds_read_b128 v[8:11], v4 offset:26880
    s_lshl_b32 s80, s2, 11
    s_add_u32 s80, s80, 18874368
    s_waitcnt lgkmcnt(0)
    buffer_store_dwordx4 v[8:11], v4, s[52:55], s80 offen offset:0 sc0 sc1
    s_mov_b64 exec, -1
L_tg:
    buffer_load_dword v3, v2, s[60:63], 0 offen sc0 sc1
    s_waitcnt vmcnt(0)
    v_readfirstlane_b32 s69, v3
    s_cmp_eq_u32 s69, 0
    s_cbranch_scc1 L_tg
    ds_write_b32 v2, v3 offset:136
    s_getreg_b32 s81, hwreg(HW_REG_XCC_ID)
    s_and_b32 s81, s81, 15
    v_mov_b32 v16, s81
    v_mov_b32 v17, s69
    s_lshl_b32 s80, s2, 11
    s_mov_b64 exec, 1
    buffer_store_dwordx2 v[16:17], v2, s[52:55], s80 offen offset:1536 sc0 sc1
    s_lshr_b32 s82, s3, 6
    s_lshl_b32 s82, s82, 8
    s_add_u32 s82, s82, 23068672
    s_mov_b64 exec, -1
    s_mov_b32 s70, 1
    s_mov_b32 s71, 0
    s_mov_b32 s72, 1
    v_add_u32 v5, 260, v1
    v_lshlrev_b32 v4, 6, v0
L_rq0:
    s_mov_b64 exec, 1
L_rq:
    ds_read_b32 v3, v2 offset:132
    s_waitcnt lgkmcnt(0)
    v_readfirstlane_b32 s80, v3
    s_cmp_lt_u32 s80, s70
    s_cbranch_scc1 L_rq
    v_mov_b32 v3, 1
    buffer_atomic_add v3, v2, s[52:55], s82 offen sc0 sc1
    s_waitcnt vmcnt(0)
    v_readfirstlane_b32 s71, v3
L_have:
    s_lshr_b32 s80, s71, 6
    s_min_u32 s80, s80, 4
    s_lshl_b32 s80, s80, 2
    s_lshr_b32 s81, 0x43210, s80
    s_lshr_b32 s80, 0x11111, s80
    s_and_b32 s81, s81, 15
    s_and_b32 s80, s80, 15
    s_lshl_b32 s81, s81, 6
    s_and_b32 s83, s71, 63
    s_add_u32 s81, s81, s83
    s_bfm_b64 exec, s80, 0
    v_add_u32 v3, s81, v4
    ds_write_b32 v5, v3
    s_mov_b64 exec, -1
    s_add_u32 s70, s70, s80
    s_lshl_b32 s80, s80, 2
    v_add_u32 v5, s80, v5
    s_cmp_lt_u32 s71, 256
    s_cbranch_scc1 L_rq0
    s_endpgm
.section .rodata,"a"
.p2align 6
.amdhsa_kernel standalone__kv_cache_quant_int4_int2_kv_with_per_channel_or_per_token_scales__decode_kernel
  .amdhsa_next_free_vgpr 213
  .amdhsa_next_free_sgpr 102
  .amdhsa_accum_offset 216
  .amdhsa_group_segment_fixed_size 0
  .amdhsa_kernarg_size 80
  .amdhsa_user_sgpr_count 2
  .amdhsa_user_sgpr_kernarg_segment_ptr 1
  .amdhsa_system_sgpr_workgroup_id_x 1
.end_amdhsa_kernel
```

```asm
; @launch grid=(256,1,1) block=(256,1,1) lds=98304
.amdgcn_target "amdgcn-amd-amdhsa--gfx950"
.text
.globl standalone__kv_cache_quant_int4_int2_kv_with_per_channel_or_per_token_scales__decode_kernel
.p2align 8
.type standalone__kv_cache_quant_int4_int2_kv_with_per_channel_or_per_token_scales__decode_kernel,@function
standalone__kv_cache_quant_int4_int2_kv_with_per_channel_or_per_token_scales__decode_kernel:
    s_cmp_ge_u32 s2, 256
    s_cbranch_scc1 L_end
    s_load_dwordx16 s[4:19], s[0:1], 0
    s_load_dwordx4 s[20:23], s[0:1], 64
    s_bfe_u32 s80, s2, 0x20003
    s_and_b32 s81, s2, 7
    s_lshr_b32 s3, s2, 5
    s_lshl_b32 s80, s80, 6
    s_lshl_b32 s81, s81, 3
    s_or_b32 s3, s3, s80
    s_or_b32 s3, s3, s81
    s_and_b32 s80, s2, 7
    s_lshr_b32 s2, s2, 3
    s_lshl_b32 s80, s80, 5
    s_or_b32 s2, s2, s80
    v_lshrrev_b32 v225, 6, v0
    v_and_b32 v0, 63, v0
    v_readfirstlane_b32 s68, v225
    s_lshr_b32 s79, s2, 6
    s_and_b32 s92, s2, 63
    s_mov_b32 s66, 0xaaaaaaaa
    s_mov_b32 s67, 0xaaaaaaaa
    s_cmp_eq_u32 s68, 1
    s_cbranch_scc1 L_service
    s_cmp_eq_u32 s68, 2
    s_cbranch_scc1 L_ticket
    s_cmp_eq_u32 s68, 3
    s_cbranch_scc1 L_ctl
    s_mov_b64 vcc, 0
    s_setprio 1
    v_and_b32 v231, 15, v0
    v_lshrrev_b32 v230, 4, v0
    v_mul_u32_u24 v1, 768, v230
    v_lshl_add_u32 v1, v231, 4, v1
    v_lshlrev_b32 v2, 3, v231
    v_bfrev_b32 v227, v231
    v_lshrrev_b32 v227, 28, v227
    v_and_b32 v228, 3, v227
    v_lshl_add_u32 v3, v228, 2, v230
    v_lshlrev_b32 v3, 1, v3
    v_lshrrev_b32 v227, 2, v227
    v_lshl_add_u32 v3, v227, 11, v3
    v_lshlrev_b32 v241, 2, v0
    v_add_u32 v242, 11520, v241
    v_add_u32 v241, 11264, v241
    v_lshlrev_b32 v243, 4, v0
    v_mov_b32 v244, 0
    v_mov_b32 v245, 1
    v_lshlrev_b32 v220, 2, v0
    v_mov_b32 v221, 1
    v_mov_b32 v222, 260
    s_mul_i32 s58, s79, 0
    s_and_b32 s94, s92, 448
    s_add_u32 s94, s94, s58
    s_add_u32 s94, s94, 256
    s_add_u32 s58, s58, s92
    s_and_b32 s58, s58, 511
    s_lshr_b32 s59, s3, 6
    s_lshl_b32 s69, s79, 9
    s_lshl_b32 s90, s59, 9
    s_and_b32 s80, s3, 63
    s_add_u32 s90, s90, s80
    s_sub_u32 s90, s90, s69
    s_sub_u32 s90, s90, s92
    s_add_u32 s59, s59, 28
    s_lshl_b32 s59, s59, 9
    s_mov_b32 s64, 0xcccccccc
    s_mov_b32 s65, 0xcccccccc
    s_mov_b32 s60, 0x6fd53b95
    s_mov_b32 s62, 0x80000001
    s_mov_b32 s61, 0x6fd53b95
    s_mov_b32 s63, 0x80000001
    s_waitcnt lgkmcnt(0)
    s_mov_b32 s24, s6
    s_and_b32 s25, s7, 0xffff
    s_mov_b32 s26, 805306368
    s_mov_b32 s27, 0x00020000
    s_mov_b32 s48, s4
    s_and_b32 s49, s5, 0xffff
    s_mov_b32 s50, 12288
    s_mov_b32 s51, 0x00020000
    s_mov_b32 s32, s10
    s_and_b32 s33, s11, 0xffff
    s_mov_b32 s34, 6291456
    s_mov_b32 s35, 0x00020000
    s_mov_b32 s36, s12
    s_and_b32 s37, s13, 0xffff
    s_mov_b32 s38, 6291456
    s_mov_b32 s39, 0x00020000
    s_mov_b32 s57, s69
    s_mov_b32 s56, s58
    s_mov_b32 s75, 8
    s_add_u32 s70, s57, s56
    s_mov_b32 s91, -56
    s_lshr_b32 s74, s70, 9
    s_mul_i32 s74, s74, 384
    buffer_load_dwordx2 v[194:195], v2, s[48:51], s74 offen offset:0
    buffer_load_dwordx2 v[196:197], v2, s[48:51], s74 offen offset:128
    buffer_load_dwordx2 v[198:199], v2, s[48:51], s74 offen offset:256
    s_and_b32 s80, s70, 63
    s_sub_u32 s72, s70, s80
    s_lshr_b32 s80, s80, 2
    s_add_u32 s72, s72, s80
    s_mul_i32 s72, s72, 384
    buffer_load_dwordx2 v[132:133], v2, s[32:35], s72 offen offset:0
    buffer_load_dwordx2 v[134:135], v2, s[32:35], s72 offen offset:128
    buffer_load_dwordx2 v[136:137], v2, s[32:35], s72 offen offset:256
    buffer_load_dwordx2 v[138:139], v2, s[36:39], s72 offen offset:0
    buffer_load_dwordx2 v[140:141], v2, s[36:39], s72 offen offset:128
    buffer_load_dwordx2 v[142:143], v2, s[36:39], s72 offen offset:256
    s_mul_i32 s71, s70, 49152
    s_and_b32 s80, s70, 63
    s_mul_i32 s80, s80, 36864
    s_sub_u32 s71, s71, s80
    buffer_load_dwordx4 v[4:7], v1, s[24:27], s71 offen offset:0 nt
    buffer_load_dwordx4 v[8:11], v1, s[24:27], s71 offen offset:256 nt
    buffer_load_dwordx4 v[12:15], v1, s[24:27], s71 offen offset:512 nt
    s_add_u32 s71, s71, 3072
    buffer_load_dwordx4 v[16:19], v1, s[24:27], s71 offen offset:0 nt
    s_add_u32 s72, s72, 6144
    buffer_load_dwordx2 v[156:157], v2, s[32:35], s72 offen offset:0
    buffer_load_dwordx2 v[158:159], v2, s[32:35], s72 offen offset:128
    buffer_load_dwordx2 v[160:161], v2, s[32:35], s72 offen offset:256
    buffer_load_dwordx2 v[162:163], v2, s[36:39], s72 offen offset:0
    buffer_load_dwordx2 v[164:165], v2, s[36:39], s72 offen offset:128
    buffer_load_dwordx2 v[166:167], v2, s[36:39], s72 offen offset:256
    buffer_load_dwordx4 v[20:23], v1, s[24:27], s71 offen offset:256 nt
    buffer_load_dwordx4 v[24:27], v1, s[24:27], s71 offen offset:512 nt
    s_add_u32 s71, s71, 3072
    buffer_load_dwordx4 v[28:31], v1, s[24:27], s71 offen offset:0 nt
    buffer_load_dwordx4 v[32:35], v1, s[24:27], s71 offen offset:256 nt
    buffer_load_dwordx4 v[36:39], v1, s[24:27], s71 offen offset:512 nt
    s_add_u32 s71, s71, 3072
    buffer_load_dwordx4 v[40:43], v1, s[24:27], s71 offen offset:0 nt
    buffer_load_dwordx4 v[44:47], v1, s[24:27], s71 offen offset:256 nt
    buffer_load_dwordx4 v[48:51], v1, s[24:27], s71 offen offset:512 nt
    s_add_u32 s71, s71, 777216
    buffer_load_dwordx4 v[52:55], v1, s[24:27], s71 offen offset:0 nt
    buffer_load_dwordx4 v[56:59], v1, s[24:27], s71 offen offset:256 nt
    buffer_load_dwordx4 v[60:63], v1, s[24:27], s71 offen offset:512 nt
    s_add_u32 s71, s71, 3072
    buffer_load_dwordx4 v[64:67], v1, s[24:27], s71 offen offset:0 nt
    s_add_u32 s72, s72, 6144
    buffer_load_dwordx2 v[168:169], v2, s[32:35], s72 offen offset:0
    buffer_load_dwordx2 v[170:171], v2, s[32:35], s72 offen offset:128
    buffer_load_dwordx2 v[172:173], v2, s[32:35], s72 offen offset:256
    buffer_load_dwordx2 v[174:175], v2, s[36:39], s72 offen offset:0
    buffer_load_dwordx2 v[176:177], v2, s[36:39], s72 offen offset:128
    buffer_load_dwordx2 v[178:179], v2, s[36:39], s72 offen offset:256
    buffer_load_dwordx4 v[68:71], v1, s[24:27], s71 offen offset:256 nt
    buffer_load_dwordx4 v[72:75], v1, s[24:27], s71 offen offset:512 nt
    s_add_u32 s71, s71, 3072
    buffer_load_dwordx4 v[76:79], v1, s[24:27], s71 offen offset:0 nt
    buffer_load_dwordx4 v[80:83], v1, s[24:27], s71 offen offset:256 nt
    buffer_load_dwordx4 v[84:87], v1, s[24:27], s71 offen offset:512 nt
    s_add_u32 s71, s71, 3072
    buffer_load_dwordx4 v[88:91], v1, s[24:27], s71 offen offset:0 nt
    buffer_load_dwordx4 v[92:95], v1, s[24:27], s71 offen offset:256 nt
    buffer_load_dwordx4 v[96:99], v1, s[24:27], s71 offen offset:512 nt
    s_mov_b32 s28, s8
    s_and_b32 s29, s9, 0xffff
    s_mov_b32 s30, 805306368
    s_mov_b32 s31, 0x00020000
    s_mov_b32 s40, s14
    s_and_b32 s41, s15, 0xffff
    s_mov_b32 s42, 2097152
    s_mov_b32 s43, 0x00020000
    s_mov_b32 s44, s16
    s_and_b32 s45, s17, 0xffff
    s_mov_b32 s46, 2097152
    s_mov_b32 s47, 0x00020000
    s_mov_b32 s52, s22
    s_and_b32 s53, s23, 0xffff
    s_mov_b32 s54, 25165824
    s_mov_b32 s55, 0x00020000
    s_mov_b32 s77, 8
    v_mov_b32 v212, 0xf149f2ca
    v_mov_b32 v213, 0
    v_mov_b32 v214, 0
    v_mov_b32 v200, 0
    v_mov_b32 v201, 0
    v_mov_b32 v202, 0
    v_mov_b32 v203, 0
    v_mov_b32 v204, 0
    v_mov_b32 v205, 0
    v_mov_b32 v206, 0
    v_mov_b32 v207, 0
    v_mov_b32 v208, 0
    v_mov_b32 v209, 0
    v_mov_b32 v210, 0
    v_mov_b32 v211, 0
    s_barrier
    s_waitcnt vmcnt(36)
    v_lshlrev_b32 v108, 16, v194
    v_and_b32 v109, 0xffff0000, v194
    v_pk_mul_f32 v[108:109], v[108:109], s[60:61]
    v_lshlrev_b32 v110, 16, v195
    v_and_b32 v111, 0xffff0000, v195
    v_pk_mul_f32 v[110:111], v[110:111], s[60:61]
    v_lshlrev_b32 v112, 16, v196
    v_and_b32 v113, 0xffff0000, v196
    v_pk_mul_f32 v[112:113], v[112:113], s[60:61]
    v_lshlrev_b32 v114, 16, v197
    v_and_b32 v115, 0xffff0000, v197
    v_pk_mul_f32 v[114:115], v[114:115], s[60:61]
    v_lshlrev_b32 v116, 16, v198
    v_and_b32 v117, 0xffff0000, v198
    v_pk_mul_f32 v[116:117], v[116:117], s[60:61]
    v_lshlrev_b32 v118, 16, v199
    v_and_b32 v119, 0xffff0000, v199
    v_pk_mul_f32 v[118:119], v[118:119], s[60:61]
    v_lshlrev_b32 v230, 16, v132
    v_and_b32 v231, 0xffff0000, v132
    v_pk_mul_f32 v[120:121], v[230:231], v[108:109]
    v_lshlrev_b32 v230, 16, v138
    v_and_b32 v231, 0xffff0000, v138
    v_pk_mul_f32 v[234:235], v[120:121], v[230:231]
    v_lshlrev_b32 v230, 16, v133
    v_and_b32 v231, 0xffff0000, v133
    v_pk_mul_f32 v[122:123], v[230:231], v[110:111]
    v_lshlrev_b32 v230, 16, v139
    v_and_b32 v231, 0xffff0000, v139
    v_pk_fma_f32 v[234:235], v[122:123], v[230:231], v[234:235]
    v_lshlrev_b32 v230, 16, v134
    v_and_b32 v231, 0xffff0000, v134
    v_pk_mul_f32 v[124:125], v[230:231], v[112:113]
    v_lshlrev_b32 v230, 16, v140
    v_and_b32 v231, 0xffff0000, v140
    v_pk_fma_f32 v[234:235], v[124:125], v[230:231], v[234:235]
    v_lshlrev_b32 v230, 16, v135
    v_and_b32 v231, 0xffff0000, v135
    v_pk_mul_f32 v[126:127], v[230:231], v[114:115]
    v_lshlrev_b32 v230, 16, v141
    v_and_b32 v231, 0xffff0000, v141
    v_pk_fma_f32 v[234:235], v[126:127], v[230:231], v[234:235]
    v_lshlrev_b32 v230, 16, v136
    v_and_b32 v231, 0xffff0000, v136
    v_pk_mul_f32 v[128:129], v[230:231], v[116:117]
    v_lshlrev_b32 v230, 16, v142
    v_and_b32 v231, 0xffff0000, v142
    v_pk_fma_f32 v[234:235], v[128:129], v[230:231], v[234:235]
    v_lshlrev_b32 v230, 16, v137
    v_and_b32 v231, 0xffff0000, v137
    v_pk_mul_f32 v[130:131], v[230:231], v[118:119]
    v_lshlrev_b32 v230, 16, v143
    v_and_b32 v231, 0xffff0000, v143
    v_pk_fma_f32 v[234:235], v[130:131], v[230:231], v[234:235]
    v_pk_mul_f32 v[234:235], v[234:235], s[62:63]
    s_mov_b32 s76, 63
L_loop0:
    s_waitcnt vmcnt(35)
    v_pk_fma_f32 v[232:233], v[120:121], v[4:5], v[234:235]
    v_pk_fma_f32 v[232:233], v[122:123], v[6:7], v[232:233]
    ds_read_b32 v246, v245 offset:147
    s_add_u32 s71, s71, 777216
    s_cbranch_vccnz L_th24_0
L_tb24_0:
    buffer_load_dwordx4 v[4:7], v1, s[24:27], s71 offen offset:0 nt
    v_add_f32_dpp v225, v224, v224 row_ror:8 row_mask:0xf bank_mask:0xc
    s_waitcnt vmcnt(35)
    v_pk_fma_f32 v[232:233], v[124:125], v[8:9], v[232:233]
    v_pk_fma_f32 v[232:233], v[126:127], v[10:11], v[232:233]
    buffer_load_dwordx4 v[8:11], v1, s[24:27], s71 offen offset:256 nt
    v_add_f32_dpp v226, v225, v225 row_shr:4 row_mask:0xf bank_mask:0xa
    s_waitcnt vmcnt(35)
    v_pk_fma_f32 v[232:233], v[128:129], v[12:13], v[232:233]
    v_pk_fma_f32 v[232:233], v[130:131], v[14:15], v[232:233]
    s_waitcnt lgkmcnt(0)
    v_cmp_ne_u32 vcc, 0, v246
    ds_add_u32 v220, v245 offset:28160
    buffer_load_dwordx4 v[12:15], v1, s[24:27], s71 offen offset:512 nt
    v_add_f32_dpp v228, v226, v226 quad_perm:[2,3,0,1] row_mask:0xf bank_mask:0xf
    v_add_f32 v224, v232, v233
    s_waitcnt vmcnt(35)
    v_pk_fma_f32 v[232:233], v[120:121], v[16:17], v[234:235]
    v_pk_fma_f32 v[232:233], v[122:123], v[18:19], v[232:233]
    s_add_u32 s71, s71, 3072
    s_cbranch_vccnz L_th27_0
L_tb27_0:
    buffer_load_dwordx4 v[16:19], v1, s[24:27], s71 offen offset:0 nt
    v_cndmask_b32 v228, v227, v228, s[64:65]
    v_add_f32_dpp v225, v224, v224 row_ror:8 row_mask:0xf bank_mask:0x3
    s_waitcnt vmcnt(29)
    v_pk_fma_f32 v[232:233], v[124:125], v[20:21], v[232:233]
    v_pk_fma_f32 v[232:233], v[126:127], v[22:23], v[232:233]
    s_add_u32 s72, s72, 6144
    buffer_load_dwordx2 v[180:181], v2, s[32:35], s72 offen offset:0
    buffer_load_dwordx2 v[182:183], v2, s[32:35], s72 offen offset:128
    buffer_load_dwordx2 v[184:185], v2, s[32:35], s72 offen offset:256
    buffer_load_dwordx2 v[186:187], v2, s[36:39], s72 offen offset:0
    buffer_load_dwordx2 v[188:189], v2, s[36:39], s72 offen offset:128
    buffer_load_dwordx2 v[190:191], v2, s[36:39], s72 offen offset:256
    buffer_load_dwordx4 v[20:23], v1, s[24:27], s71 offen offset:256 nt
    v_add_f32_dpp v227, v228, v228 quad_perm:[1,0,3,2] row_mask:0xf bank_mask:0xf
    v_lshlrev_b32 v230, 16, v156
    v_and_b32 v231, 0xffff0000, v156
    v_pk_mul_f32 v[144:145], v[230:231], v[108:109]
    v_lshlrev_b32 v230, 16, v162
    v_and_b32 v231, 0xffff0000, v162
    s_waitcnt vmcnt(35)
    v_pk_fma_f32 v[232:233], v[128:129], v[24:25], v[232:233]
    v_pk_fma_f32 v[232:233], v[130:131], v[26:27], v[232:233]
    ds_add_u32 v220, v245 offset:28160
    buffer_load_dwordx4 v[24:27], v1, s[24:27], s71 offen offset:512 nt
    v_cndmask_b32 v229, v229, v227, s[66:67]
    v_mul_f32 v229, 0x58000000, v229
    ds_write_b32 v241, v229
    v_add_u32 v241, 256, v241
    v_add_f32 v224, v232, v233
    v_pk_mul_f32 v[236:237], v[144:145], v[230:231]
    v_lshlrev_b32 v230, 16, v157
    v_and_b32 v231, 0xffff0000, v157
    v_pk_mul_f32 v[146:147], v[230:231], v[110:111]
    v_lshlrev_b32 v230, 16, v163
    s_waitcnt vmcnt(35)
    v_pk_fma_f32 v[232:233], v[120:121], v[28:29], v[234:235]
    v_pk_fma_f32 v[232:233], v[122:123], v[30:31], v[232:233]
    s_add_u32 s71, s71, 3072
    s_cbranch_vccnz L_th30_0
L_tb30_0:
    buffer_load_dwordx4 v[28:31], v1, s[24:27], s71 offen offset:0 nt
    v_add_f32_dpp v225, v224, v224 row_ror:8 row_mask:0xf bank_mask:0xc
    v_and_b32 v231, 0xffff0000, v163
    v_pk_fma_f32 v[236:237], v[146:147], v[230:231], v[236:237]
    v_lshlrev_b32 v230, 16, v158
    v_and_b32 v231, 0xffff0000, v158
    v_pk_mul_f32 v[148:149], v[230:231], v[112:113]
    s_waitcnt vmcnt(35)
    v_pk_fma_f32 v[232:233], v[124:125], v[32:33], v[232:233]
    v_pk_fma_f32 v[232:233], v[126:127], v[34:35], v[232:233]
    buffer_load_dwordx4 v[32:35], v1, s[24:27], s71 offen offset:256 nt
    v_add_f32_dpp v226, v225, v225 row_shl:4 row_mask:0xf bank_mask:0x5
    v_lshlrev_b32 v230, 16, v164
    v_and_b32 v231, 0xffff0000, v164
    v_pk_fma_f32 v[236:237], v[148:149], v[230:231], v[236:237]
    v_lshlrev_b32 v230, 16, v159
    v_and_b32 v231, 0xffff0000, v159
    s_waitcnt vmcnt(35)
    v_pk_fma_f32 v[232:233], v[128:129], v[36:37], v[232:233]
    v_pk_fma_f32 v[232:233], v[130:131], v[38:39], v[232:233]
    ds_add_u32 v220, v245 offset:28160
    buffer_load_dwordx4 v[36:39], v1, s[24:27], s71 offen offset:512 nt
    v_add_f32 v224, v232, v233
    v_pk_mul_f32 v[150:151], v[230:231], v[114:115]
    v_lshlrev_b32 v230, 16, v165
    v_and_b32 v231, 0xffff0000, v165
    v_pk_fma_f32 v[236:237], v[150:151], v[230:231], v[236:237]
    v_lshlrev_b32 v230, 16, v160
    s_waitcnt vmcnt(35)
    v_pk_fma_f32 v[232:233], v[120:121], v[40:41], v[234:235]
    v_pk_fma_f32 v[232:233], v[122:123], v[42:43], v[232:233]
    s_add_u32 s71, s71, 3072
    s_cbranch_vccnz L_th33_0
L_tb33_0:
    buffer_load_dwordx4 v[40:43], v1, s[24:27], s71 offen offset:0 nt
    v_add_f32_dpp v225, v224, v224 row_ror:8 row_mask:0xf bank_mask:0x3
    v_and_b32 v231, 0xffff0000, v160
    v_pk_mul_f32 v[152:153], v[230:231], v[116:117]
    v_lshlrev_b32 v230, 16, v166
    v_and_b32 v231, 0xffff0000, v166
    v_pk_fma_f32 v[236:237], v[152:153], v[230:231], v[236:237]
    s_waitcnt vmcnt(35)
    v_pk_fma_f32 v[232:233], v[124:125], v[44:45], v[232:233]
    v_pk_fma_f32 v[232:233], v[126:127], v[46:47], v[232:233]
    buffer_load_dwordx4 v[44:47], v1, s[24:27], s71 offen offset:256 nt
    v_lshlrev_b32 v230, 16, v161
    v_and_b32 v231, 0xffff0000, v161
    v_pk_mul_f32 v[154:155], v[230:231], v[118:119]
    v_lshlrev_b32 v230, 16, v167
    v_and_b32 v231, 0xffff0000, v167
    s_waitcnt vmcnt(35)
    v_pk_fma_f32 v[232:233], v[128:129], v[48:49], v[232:233]
    v_pk_fma_f32 v[232:233], v[130:131], v[50:51], v[232:233]
    ds_add_u32 v220, v245 offset:28160
    buffer_load_dwordx4 v[48:51], v1, s[24:27], s71 offen offset:512 nt
    v_add_f32 v224, v232, v233
    v_pk_fma_f32 v[236:237], v[154:155], v[230:231], v[236:237]
    v_pk_mul_f32 v[236:237], v[236:237], s[62:63]
    s_waitcnt vmcnt(35)
    v_pk_fma_f32 v[232:233], v[144:145], v[52:53], v[236:237]
    v_pk_fma_f32 v[232:233], v[146:147], v[54:55], v[232:233]
    ds_read_b32 v246, v245 offset:147
    s_add_u32 s56, s56, 64
    s_and_b32 s56, s56, 511
    s_sub_u32 s75, s75, 1
    s_cmp_eq_u32 s75, 0
    s_cselect_b32 s80, 2048, 0
    s_cselect_b32 s75, 8, s75
    s_add_u32 s57, s57, s80
    s_add_u32 s70, s57, s56
    s_add_u32 s91, s91, 1
    s_cmp_lt_u32 s91, 4
    s_cselect_b32 s80, s90, 0
    s_add_u32 s70, s70, s80
    s_lshr_b32 s74, s70, 9
    s_mul_i32 s74, s74, 384
    buffer_load_dwordx2 v[194:195], v2, s[48:51], s74 offen offset:0
    buffer_load_dwordx2 v[196:197], v2, s[48:51], s74 offen offset:128
    buffer_load_dwordx2 v[198:199], v2, s[48:51], s74 offen offset:256
    s_add_u32 s71, s71, 777216
    s_cbranch_vccnz L_th36_0
L_tb36_0:
    buffer_load_dwordx4 v[52:55], v1, s[24:27], s71 offen offset:0 nt
    v_add_f32_dpp v225, v224, v224 row_ror:8 row_mask:0xf bank_mask:0xc
    s_waitcnt vmcnt(38)
    v_pk_fma_f32 v[232:233], v[148:149], v[56:57], v[232:233]
    v_pk_fma_f32 v[232:233], v[150:151], v[58:59], v[232:233]
    buffer_load_dwordx4 v[56:59], v1, s[24:27], s71 offen offset:256 nt
    v_add_f32_dpp v226, v225, v225 row_shr:4 row_mask:0xf bank_mask:0xa
    s_waitcnt vmcnt(38)
    v_pk_fma_f32 v[232:233], v[152:153], v[60:61], v[232:233]
    v_pk_fma_f32 v[232:233], v[154:155], v[62:63], v[232:233]
    s_waitcnt lgkmcnt(0)
    v_cmp_ne_u32 vcc, 0, v246
    ds_add_u32 v220, v245 offset:28160
    buffer_load_dwordx4 v[60:63], v1, s[24:27], s71 offen offset:512 nt
    v_add_f32_dpp v227, v226, v226 quad_perm:[2,3,0,1] row_mask:0xf bank_mask:0xf
    v_add_f32 v224, v232, v233
    s_waitcnt vmcnt(38)
    v_pk_fma_f32 v[232:233], v[144:145], v[64:65], v[236:237]
    v_pk_fma_f32 v[232:233], v[146:147], v[66:67], v[232:233]
    s_add_u32 s71, s71, 3072
    s_cbranch_vccnz L_th39_0
L_tb39_0:
    buffer_load_dwordx4 v[64:67], v1, s[24:27], s71 offen offset:0 nt
    v_add_f32_dpp v225, v224, v224 row_ror:8 row_mask:0xf bank_mask:0x3
    s_waitcnt vmcnt(32)
    v_pk_fma_f32 v[232:233], v[148:149], v[68:69], v[232:233]
    v_pk_fma_f32 v[232:233], v[150:151], v[70:71], v[232:233]
    s_and_b32 s80, s70, 63
    s_sub_u32 s72, s70, s80
    s_lshr_b32 s80, s80, 2
    s_add_u32 s72, s72, s80
    s_mul_i32 s72, s72, 384
    buffer_load_dwordx2 v[132:133], v2, s[32:35], s72 offen offset:0
    buffer_load_dwordx2 v[134:135], v2, s[32:35], s72 offen offset:128
    buffer_load_dwordx2 v[136:137], v2, s[32:35], s72 offen offset:256
    buffer_load_dwordx2 v[138:139], v2, s[36:39], s72 offen offset:0
    buffer_load_dwordx2 v[140:141], v2, s[36:39], s72 offen offset:128
    buffer_load_dwordx2 v[142:143], v2, s[36:39], s72 offen offset:256
    buffer_load_dwordx4 v[68:71], v1, s[24:27], s71 offen offset:256 nt
    v_lshlrev_b32 v230, 16, v168
    v_and_b32 v231, 0xffff0000, v168
    v_pk_mul_f32 v[120:121], v[230:231], v[108:109]
    v_lshlrev_b32 v230, 16, v174
    v_and_b32 v231, 0xffff0000, v174
    s_waitcnt vmcnt(38)
    v_pk_fma_f32 v[232:233], v[152:153], v[72:73], v[232:233]
    v_pk_fma_f32 v[232:233], v[154:155], v[74:75], v[232:233]
    ds_add_u32 v220, v245 offset:28160
    buffer_load_dwordx4 v[72:75], v1, s[24:27], s71 offen offset:512 nt
    v_add_f32 v224, v232, v233
    v_pk_mul_f32 v[234:235], v[120:121], v[230:231]
    v_lshlrev_b32 v230, 16, v169
    v_and_b32 v231, 0xffff0000, v169
    v_pk_mul_f32 v[122:123], v[230:231], v[110:111]
    v_lshlrev_b32 v230, 16, v175
    s_waitcnt vmcnt(38)
    v_pk_fma_f32 v[232:233], v[144:145], v[76:77], v[236:237]
    v_pk_fma_f32 v[232:233], v[146:147], v[78:79], v[232:233]
    s_add_u32 s71, s71, 3072
    s_cbranch_vccnz L_th42_0
L_tb42_0:
    buffer_load_dwordx4 v[76:79], v1, s[24:27], s71 offen offset:0 nt
    v_add_f32_dpp v225, v224, v224 row_ror:8 row_mask:0xf bank_mask:0xc
    v_and_b32 v231, 0xffff0000, v175
    v_pk_fma_f32 v[234:235], v[122:123], v[230:231], v[234:235]
    v_lshlrev_b32 v230, 16, v170
    v_and_b32 v231, 0xffff0000, v170
    v_pk_mul_f32 v[124:125], v[230:231], v[112:113]
    s_waitcnt vmcnt(38)
    v_pk_fma_f32 v[232:233], v[148:149], v[80:81], v[232:233]
    v_pk_fma_f32 v[232:233], v[150:151], v[82:83], v[232:233]
    buffer_load_dwordx4 v[80:83], v1, s[24:27], s71 offen offset:256 nt
    v_add_f32_dpp v226, v225, v225 row_shl:4 row_mask:0xf bank_mask:0x5
    v_lshlrev_b32 v230, 16, v176
    v_and_b32 v231, 0xffff0000, v176
    v_pk_fma_f32 v[234:235], v[124:125], v[230:231], v[234:235]
    v_lshlrev_b32 v230, 16, v171
    v_and_b32 v231, 0xffff0000, v171
    s_waitcnt vmcnt(38)
    v_pk_fma_f32 v[232:233], v[152:153], v[84:85], v[232:233]
    v_pk_fma_f32 v[232:233], v[154:155], v[86:87], v[232:233]
    ds_add_u32 v220, v245 offset:28160
    buffer_load_dwordx4 v[84:87], v1, s[24:27], s71 offen offset:512 nt
    v_add_f32 v224, v232, v233
    v_pk_mul_f32 v[126:127], v[230:231], v[114:115]
    v_lshlrev_b32 v230, 16, v177
    v_and_b32 v231, 0xffff0000, v177
    v_pk_fma_f32 v[234:235], v[126:127], v[230:231], v[234:235]
    v_lshlrev_b32 v230, 16, v172
    s_waitcnt vmcnt(38)
    v_pk_fma_f32 v[232:233], v[144:145], v[88:89], v[236:237]
    v_pk_fma_f32 v[232:233], v[146:147], v[90:91], v[232:233]
    s_add_u32 s71, s71, 3072
    s_cbranch_vccnz L_th45_0
L_tb45_0:
    buffer_load_dwordx4 v[88:91], v1, s[24:27], s71 offen offset:0 nt
    v_add_f32_dpp v225, v224, v224 row_ror:8 row_mask:0xf bank_mask:0x3
    v_and_b32 v231, 0xffff0000, v172
    v_pk_mul_f32 v[128:129], v[230:231], v[116:117]
    v_lshlrev_b32 v230, 16, v178
    v_and_b32 v231, 0xffff0000, v178
    v_pk_fma_f32 v[234:235], v[128:129], v[230:231], v[234:235]
    s_waitcnt vmcnt(38)
    v_pk_fma_f32 v[232:233], v[148:149], v[92:93], v[232:233]
    v_pk_fma_f32 v[232:233], v[150:151], v[94:95], v[232:233]
    buffer_load_dwordx4 v[92:95], v1, s[24:27], s71 offen offset:256 nt
    v_lshlrev_b32 v230, 16, v173
    v_and_b32 v231, 0xffff0000, v173
    v_pk_mul_f32 v[130:131], v[230:231], v[118:119]
    v_lshlrev_b32 v230, 16, v179
    v_and_b32 v231, 0xffff0000, v179
    s_waitcnt vmcnt(38)
    v_pk_fma_f32 v[232:233], v[152:153], v[96:97], v[232:233]
    v_pk_fma_f32 v[232:233], v[154:155], v[98:99], v[232:233]
    ds_add_u32 v220, v245 offset:28160
    buffer_load_dwordx4 v[96:99], v1, s[24:27], s71 offen offset:512 nt
    v_add_f32 v224, v232, v233
    v_pk_fma_f32 v[234:235], v[130:131], v[230:231], v[234:235]
    v_pk_mul_f32 v[234:235], v[234:235], s[62:63]
    s_waitcnt vmcnt(38)
    v_pk_fma_f32 v[232:233], v[120:121], v[4:5], v[234:235]
    v_pk_fma_f32 v[232:233], v[122:123], v[6:7], v[232:233]
    ds_read_b32 v246, v245 offset:147
    s_mul_i32 s71, s70, 49152
    s_and_b32 s80, s70, 63
    s_mul_i32 s80, s80, 36864
    s_sub_u32 s71, s71, s80
    s_cbranch_vccnz L_th0_0
L_tb0_0:
    buffer_load_dwordx4 v[4:7], v1, s[24:27], s71 offen offset:0 nt
    v_add_f32_dpp v225, v224, v224 row_ror:8 row_mask:0xf bank_mask:0xc
    s_waitcnt vmcnt(38)
    v_pk_fma_f32 v[232:233], v[124:125], v[8:9], v[232:233]
    v_pk_fma_f32 v[232:233], v[126:127], v[10:11], v[232:233]
    buffer_load_dwordx4 v[8:11], v1, s[24:27], s71 offen offset:256 nt
    v_add_f32_dpp v226, v225, v225 row_shr:4 row_mask:0xf bank_mask:0xa
    s_waitcnt vmcnt(38)
    v_pk_fma_f32 v[232:233], v[128:129], v[12:13], v[232:233]
    v_pk_fma_f32 v[232:233], v[130:131], v[14:15], v[232:233]
    s_waitcnt lgkmcnt(0)
    v_cmp_ne_u32 vcc, 0, v246
    ds_add_u32 v220, v245 offset:28160
    buffer_load_dwordx4 v[12:15], v1, s[24:27], s71 offen offset:512 nt
    v_add_f32_dpp v228, v226, v226 quad_perm:[2,3,0,1] row_mask:0xf bank_mask:0xf
    v_add_f32 v224, v232, v233
    s_waitcnt vmcnt(38)
    v_pk_fma_f32 v[232:233], v[120:121], v[16:17], v[234:235]
    v_pk_fma_f32 v[232:233], v[122:123], v[18:19], v[232:233]
    s_add_u32 s71, s71, 3072
    s_cbranch_vccnz L_th3_0
L_tb3_0:
    buffer_load_dwordx4 v[16:19], v1, s[24:27], s71 offen offset:0 nt
    v_cndmask_b32 v228, v227, v228, s[64:65]
    v_add_f32_dpp v225, v224, v224 row_ror:8 row_mask:0xf bank_mask:0x3
    s_waitcnt vmcnt(32)
    v_pk_fma_f32 v[232:233], v[124:125], v[20:21], v[232:233]
    v_pk_fma_f32 v[232:233], v[126:127], v[22:23], v[232:233]
    s_add_u32 s72, s72, 6144
    buffer_load_dwordx2 v[156:157], v2, s[32:35], s72 offen offset:0
    buffer_load_dwordx2 v[158:159], v2, s[32:35], s72 offen offset:128
    buffer_load_dwordx2 v[160:161], v2, s[32:35], s72 offen offset:256
    buffer_load_dwordx2 v[162:163], v2, s[36:39], s72 offen offset:0
    buffer_load_dwordx2 v[164:165], v2, s[36:39], s72 offen offset:128
    buffer_load_dwordx2 v[166:167], v2, s[36:39], s72 offen offset:256
    buffer_load_dwordx4 v[20:23], v1, s[24:27], s71 offen offset:256 nt
    v_add_f32_dpp v229, v228, v228 quad_perm:[1,0,3,2] row_mask:0xf bank_mask:0xf
    v_lshlrev_b32 v230, 16, v180
    v_and_b32 v231, 0xffff0000, v180
    v_pk_mul_f32 v[144:145], v[230:231], v[108:109]
    v_lshlrev_b32 v230, 16, v186
    v_and_b32 v231, 0xffff0000, v186
    s_waitcnt vmcnt(38)
    v_pk_fma_f32 v[232:233], v[128:129], v[24:25], v[232:233]
    v_pk_fma_f32 v[232:233], v[130:131], v[26:27], v[232:233]
    ds_add_u32 v220, v245 offset:28160
    buffer_load_dwordx4 v[24:27], v1, s[24:27], s71 offen offset:512 nt
    v_add_f32 v224, v232, v233
    v_pk_mul_f32 v[236:237], v[144:145], v[230:231]
    v_lshlrev_b32 v230, 16, v181
    v_and_b32 v231, 0xffff0000, v181
    v_pk_mul_f32 v[146:147], v[230:231], v[110:111]
    v_lshlrev_b32 v230, 16, v187
    s_waitcnt vmcnt(38)
    v_pk_fma_f32 v[232:233], v[120:121], v[28:29], v[234:235]
    v_pk_fma_f32 v[232:233], v[122:123], v[30:31], v[232:233]
    s_add_u32 s71, s71, 3072
    s_cbranch_vccnz L_th6_0
L_tb6_0:
    buffer_load_dwordx4 v[28:31], v1, s[24:27], s71 offen offset:0 nt
    v_add_f32_dpp v225, v224, v224 row_ror:8 row_mask:0xf bank_mask:0xc
    v_and_b32 v231, 0xffff0000, v187
    v_pk_fma_f32 v[236:237], v[146:147], v[230:231], v[236:237]
    v_lshlrev_b32 v230, 16, v182
    v_and_b32 v231, 0xffff0000, v182
    v_pk_mul_f32 v[148:149], v[230:231], v[112:113]
    s_waitcnt vmcnt(38)
    v_pk_fma_f32 v[232:233], v[124:125], v[32:33], v[232:233]
    v_pk_fma_f32 v[232:233], v[126:127], v[34:35], v[232:233]
    buffer_load_dwordx4 v[32:35], v1, s[24:27], s71 offen offset:256 nt
    v_add_f32_dpp v226, v225, v225 row_shl:4 row_mask:0xf bank_mask:0x5
    v_lshlrev_b32 v230, 16, v188
    v_and_b32 v231, 0xffff0000, v188
    v_pk_fma_f32 v[236:237], v[148:149], v[230:231], v[236:237]
    v_lshlrev_b32 v230, 16, v183
    v_and_b32 v231, 0xffff0000, v183
    s_waitcnt vmcnt(38)
    v_pk_fma_f32 v[232:233], v[128:129], v[36:37], v[232:233]
    v_pk_fma_f32 v[232:233], v[130:131], v[38:39], v[232:233]
    ds_add_u32 v220, v245 offset:28160
    buffer_load_dwordx4 v[36:39], v1, s[24:27], s71 offen offset:512 nt
    v_add_f32 v224, v232, v233
    v_pk_mul_f32 v[150:151], v[230:231], v[114:115]
    v_lshlrev_b32 v230, 16, v189
    v_and_b32 v231, 0xffff0000, v189
    v_pk_fma_f32 v[236:237], v[150:151], v[230:231], v[236:237]
    v_lshlrev_b32 v230, 16, v184
    s_waitcnt vmcnt(38)
    v_pk_fma_f32 v[232:233], v[120:121], v[40:41], v[234:235]
    v_pk_fma_f32 v[232:233], v[122:123], v[42:43], v[232:233]
    s_add_u32 s71, s71, 3072
    s_cbranch_vccnz L_th9_0
L_tb9_0:
    buffer_load_dwordx4 v[40:43], v1, s[24:27], s71 offen offset:0 nt
    v_add_f32_dpp v225, v224, v224 row_ror:8 row_mask:0xf bank_mask:0x3
    v_and_b32 v231, 0xffff0000, v184
    v_pk_mul_f32 v[152:153], v[230:231], v[116:117]
    v_lshlrev_b32 v230, 16, v190
    v_and_b32 v231, 0xffff0000, v190
    v_pk_fma_f32 v[236:237], v[152:153], v[230:231], v[236:237]
    s_waitcnt vmcnt(38)
    v_pk_fma_f32 v[232:233], v[124:125], v[44:45], v[232:233]
    v_pk_fma_f32 v[232:233], v[126:127], v[46:47], v[232:233]
    buffer_load_dwordx4 v[44:47], v1, s[24:27], s71 offen offset:256 nt
    v_lshlrev_b32 v230, 16, v185
    v_and_b32 v231, 0xffff0000, v185
    v_pk_mul_f32 v[154:155], v[230:231], v[118:119]
    v_lshlrev_b32 v230, 16, v191
    v_and_b32 v231, 0xffff0000, v191
    s_waitcnt vmcnt(38)
    v_pk_fma_f32 v[232:233], v[128:129], v[48:49], v[232:233]
    v_pk_fma_f32 v[232:233], v[130:131], v[50:51], v[232:233]
    ds_add_u32 v220, v245 offset:28160
    buffer_load_dwordx4 v[48:51], v1, s[24:27], s71 offen offset:512 nt
    v_add_f32 v224, v232, v233
    v_pk_fma_f32 v[236:237], v[154:155], v[230:231], v[236:237]
    v_pk_mul_f32 v[236:237], v[236:237], s[62:63]
    s_waitcnt vmcnt(35)
    v_pk_fma_f32 v[232:233], v[144:145], v[52:53], v[236:237]
    v_pk_fma_f32 v[232:233], v[146:147], v[54:55], v[232:233]
    ds_read_b32 v246, v245 offset:147
    s_add_u32 s71, s71, 777216
    s_cbranch_vccnz L_th12_0
L_tb12_0:
    buffer_load_dwordx4 v[52:55], v1, s[24:27], s71 offen offset:0 nt
    v_add_f32_dpp v225, v224, v224 row_ror:8 row_mask:0xf bank_mask:0xc
    v_lshlrev_b32 v108, 16, v194
    v_and_b32 v109, 0xffff0000, v194
    v_pk_mul_f32 v[108:109], v[108:109], s[60:61]
    v_lshlrev_b32 v110, 16, v195
    v_and_b32 v111, 0xffff0000, v195
    s_waitcnt vmcnt(35)
    v_pk_fma_f32 v[232:233], v[148:149], v[56:57], v[232:233]
    v_pk_fma_f32 v[232:233], v[150:151], v[58:59], v[232:233]
    buffer_load_dwordx4 v[56:59], v1, s[24:27], s71 offen offset:256 nt
    v_add_f32_dpp v226, v225, v225 row_shr:4 row_mask:0xf bank_mask:0xa
    v_pk_mul_f32 v[110:111], v[110:111], s[60:61]
    v_lshlrev_b32 v112, 16, v196
    v_and_b32 v113, 0xffff0000, v196
    v_pk_mul_f32 v[112:113], v[112:113], s[60:61]
    v_lshlrev_b32 v114, 16, v197
    s_waitcnt vmcnt(35)
    v_pk_fma_f32 v[232:233], v[152:153], v[60:61], v[232:233]
    v_pk_fma_f32 v[232:233], v[154:155], v[62:63], v[232:233]
    s_waitcnt lgkmcnt(0)
    v_cmp_ne_u32 vcc, 0, v246
    ds_add_u32 v220, v245 offset:28160
    buffer_load_dwordx4 v[60:63], v1, s[24:27], s71 offen offset:512 nt
    v_add_f32_dpp v227, v226, v226 quad_perm:[2,3,0,1] row_mask:0xf bank_mask:0xf
    v_add_f32 v224, v232, v233
    v_and_b32 v115, 0xffff0000, v197
    v_pk_mul_f32 v[114:115], v[114:115], s[60:61]
    v_lshlrev_b32 v116, 16, v198
    v_and_b32 v117, 0xffff0000, v198
    v_pk_mul_f32 v[116:117], v[116:117], s[60:61]
    s_waitcnt vmcnt(35)
    v_pk_fma_f32 v[232:233], v[144:145], v[64:65], v[236:237]
    v_pk_fma_f32 v[232:233], v[146:147], v[66:67], v[232:233]
    s_add_u32 s71, s71, 3072
    s_cbranch_vccnz L_th15_0
L_tb15_0:
    buffer_load_dwordx4 v[64:67], v1, s[24:27], s71 offen offset:0 nt
    v_add_f32_dpp v225, v224, v224 row_ror:8 row_mask:0xf bank_mask:0x3
    v_lshlrev_b32 v118, 16, v199
    v_and_b32 v119, 0xffff0000, v199
    v_pk_mul_f32 v[118:119], v[118:119], s[60:61]
    s_waitcnt vmcnt(29)
    v_pk_fma_f32 v[232:233], v[148:149], v[68:69], v[232:233]
    v_pk_fma_f32 v[232:233], v[150:151], v[70:71], v[232:233]
    s_add_u32 s72, s72, 6144
    buffer_load_dwordx2 v[168:169], v2, s[32:35], s72 offen offset:0
    buffer_load_dwordx2 v[170:171], v2, s[32:35], s72 offen offset:128
    buffer_load_dwordx2 v[172:173], v2, s[32:35], s72 offen offset:256
    buffer_load_dwordx2 v[174:175], v2, s[36:39], s72 offen offset:0
    buffer_load_dwordx2 v[176:177], v2, s[36:39], s72 offen offset:128
    buffer_load_dwordx2 v[178:179], v2, s[36:39], s72 offen offset:256
    buffer_load_dwordx4 v[68:71], v1, s[24:27], s71 offen offset:256 nt
    v_lshlrev_b32 v230, 16, v132
    v_and_b32 v231, 0xffff0000, v132
    v_pk_mul_f32 v[120:121], v[230:231], v[108:109]
    v_lshlrev_b32 v230, 16, v138
    v_and_b32 v231, 0xffff0000, v138
    s_waitcnt vmcnt(35)
    v_pk_fma_f32 v[232:233], v[152:153], v[72:73], v[232:233]
    v_pk_fma_f32 v[232:233], v[154:155], v[74:75], v[232:233]
    ds_add_u32 v220, v245 offset:28160
    buffer_load_dwordx4 v[72:75], v1, s[24:27], s71 offen offset:512 nt
    v_add_f32 v224, v232, v233
    v_pk_mul_f32 v[234:235], v[120:121], v[230:231]
    v_lshlrev_b32 v230, 16, v133
    v_and_b32 v231, 0xffff0000, v133
    v_pk_mul_f32 v[122:123], v[230:231], v[110:111]
    v_lshlrev_b32 v230, 16, v139
    s_waitcnt vmcnt(35)
    v_pk_fma_f32 v[232:233], v[144:145], v[76:77], v[236:237]
    v_pk_fma_f32 v[232:233], v[146:147], v[78:79], v[232:233]
    s_add_u32 s71, s71, 3072
    s_cbranch_vccnz L_th18_0
L_tb18_0:
    buffer_load_dwordx4 v[76:79], v1, s[24:27], s71 offen offset:0 nt
    v_add_f32_dpp v225, v224, v224 row_ror:8 row_mask:0xf bank_mask:0xc
    v_and_b32 v231, 0xffff0000, v139
    v_pk_fma_f32 v[234:235], v[122:123], v[230:231], v[234:235]
    v_lshlrev_b32 v230, 16, v134
    v_and_b32 v231, 0xffff0000, v134
    v_pk_mul_f32 v[124:125], v[230:231], v[112:113]
    s_waitcnt vmcnt(35)
    v_pk_fma_f32 v[232:233], v[148:149], v[80:81], v[232:233]
    v_pk_fma_f32 v[232:233], v[150:151], v[82:83], v[232:233]
    buffer_load_dwordx4 v[80:83], v1, s[24:27], s71 offen offset:256 nt
    v_add_f32_dpp v226, v225, v225 row_shl:4 row_mask:0xf bank_mask:0x5
    v_lshlrev_b32 v230, 16, v140
    v_and_b32 v231, 0xffff0000, v140
    v_pk_fma_f32 v[234:235], v[124:125], v[230:231], v[234:235]
    v_lshlrev_b32 v230, 16, v135
    v_and_b32 v231, 0xffff0000, v135
    s_waitcnt vmcnt(35)
    v_pk_fma_f32 v[232:233], v[152:153], v[84:85], v[232:233]
    v_pk_fma_f32 v[232:233], v[154:155], v[86:87], v[232:233]
    ds_add_u32 v220, v245 offset:28160
    buffer_load_dwordx4 v[84:87], v1, s[24:27], s71 offen offset:512 nt
    v_add_f32 v224, v232, v233
    v_pk_mul_f32 v[126:127], v[230:231], v[114:115]
    v_lshlrev_b32 v230, 16, v141
    v_and_b32 v231, 0xffff0000, v141
    v_pk_fma_f32 v[234:235], v[126:127], v[230:231], v[234:235]
    v_lshlrev_b32 v230, 16, v136
    s_waitcnt vmcnt(35)
    v_pk_fma_f32 v[232:233], v[144:145], v[88:89], v[236:237]
    v_pk_fma_f32 v[232:233], v[146:147], v[90:91], v[232:233]
    s_add_u32 s71, s71, 3072
    s_cbranch_vccnz L_th21_0
L_tb21_0:
    buffer_load_dwordx4 v[88:91], v1, s[24:27], s71 offen offset:0 nt
    v_add_f32_dpp v225, v224, v224 row_ror:8 row_mask:0xf bank_mask:0x3
    v_and_b32 v231, 0xffff0000, v136
    v_pk_mul_f32 v[128:129], v[230:231], v[116:117]
    v_lshlrev_b32 v230, 16, v142
    v_and_b32 v231, 0xffff0000, v142
    v_pk_fma_f32 v[234:235], v[128:129], v[230:231], v[234:235]
    s_waitcnt vmcnt(35)
    v_pk_fma_f32 v[232:233], v[148:149], v[92:93], v[232:233]
    v_pk_fma_f32 v[232:233], v[150:151], v[94:95], v[232:233]
    buffer_load_dwordx4 v[92:95], v1, s[24:27], s71 offen offset:256 nt
    v_lshlrev_b32 v230, 16, v137
    v_and_b32 v231, 0xffff0000, v137
    v_pk_mul_f32 v[130:131], v[230:231], v[118:119]
    v_lshlrev_b32 v230, 16, v143
    v_and_b32 v231, 0xffff0000, v143
    s_waitcnt vmcnt(35)
    v_pk_fma_f32 v[232:233], v[152:153], v[96:97], v[232:233]
    v_pk_fma_f32 v[232:233], v[154:155], v[98:99], v[232:233]
    ds_add_u32 v220, v245 offset:28160
    buffer_load_dwordx4 v[96:99], v1, s[24:27], s71 offen offset:512 nt
    v_add_f32 v224, v232, v233
    v_pk_fma_f32 v[234:235], v[130:131], v[230:231], v[234:235]
    v_pk_mul_f32 v[234:235], v[234:235], s[62:63]
    s_sub_u32 s76, s76, 1
    s_cmp_lg_u32 s76, 0
    s_cbranch_scc1 L_loop0
    s_waitcnt vmcnt(35)
    v_pk_fma_f32 v[232:233], v[120:121], v[4:5], v[234:235]
    v_pk_fma_f32 v[232:233], v[122:123], v[6:7], v[232:233]
    ds_read_b32 v246, v245 offset:147
    s_add_u32 s71, s71, 777216
    s_cbranch_vccnz L_th24_1
L_tb24_1:
    buffer_load_dwordx4 v[4:7], v1, s[24:27], s71 offen offset:0 nt
    v_add_f32_dpp v225, v224, v224 row_ror:8 row_mask:0xf bank_mask:0xc
    s_waitcnt vmcnt(35)
    v_pk_fma_f32 v[232:233], v[124:125], v[8:9], v[232:233]
    v_pk_fma_f32 v[232:233], v[126:127], v[10:11], v[232:233]
    buffer_load_dwordx4 v[8:11], v1, s[24:27], s71 offen offset:256 nt
    v_add_f32_dpp v226, v225, v225 row_shr:4 row_mask:0xf bank_mask:0xa
    s_waitcnt vmcnt(35)
    v_pk_fma_f32 v[232:233], v[128:129], v[12:13], v[232:233]
    v_pk_fma_f32 v[232:233], v[130:131], v[14:15], v[232:233]
    s_waitcnt lgkmcnt(0)
    v_cmp_ne_u32 vcc, 0, v246
    ds_add_u32 v220, v245 offset:28160
    buffer_load_dwordx4 v[12:15], v1, s[24:27], s71 offen offset:512 nt
    v_add_f32_dpp v228, v226, v226 quad_perm:[2,3,0,1] row_mask:0xf bank_mask:0xf
    v_add_f32 v224, v232, v233
    s_waitcnt vmcnt(35)
    v_pk_fma_f32 v[232:233], v[120:121], v[16:17], v[234:235]
    v_pk_fma_f32 v[232:233], v[122:123], v[18:19], v[232:233]
    s_add_u32 s71, s71, 3072
    s_cbranch_vccnz L_th27_1
L_tb27_1:
    buffer_load_dwordx4 v[16:19], v1, s[24:27], s71 offen offset:0 nt
    v_cndmask_b32 v228, v227, v228, s[64:65]
    v_add_f32_dpp v225, v224, v224 row_ror:8 row_mask:0xf bank_mask:0x3
    s_waitcnt vmcnt(29)
    v_pk_fma_f32 v[232:233], v[124:125], v[20:21], v[232:233]
    v_pk_fma_f32 v[232:233], v[126:127], v[22:23], v[232:233]
    s_add_u32 s72, s72, 6144
    buffer_load_dwordx2 v[180:181], v2, s[32:35], s72 offen offset:0
    buffer_load_dwordx2 v[182:183], v2, s[32:35], s72 offen offset:128
    buffer_load_dwordx2 v[184:185], v2, s[32:35], s72 offen offset:256
    buffer_load_dwordx2 v[186:187], v2, s[36:39], s72 offen offset:0
    buffer_load_dwordx2 v[188:189], v2, s[36:39], s72 offen offset:128
    buffer_load_dwordx2 v[190:191], v2, s[36:39], s72 offen offset:256
    buffer_load_dwordx4 v[20:23], v1, s[24:27], s71 offen offset:256 nt
    v_add_f32_dpp v227, v228, v228 quad_perm:[1,0,3,2] row_mask:0xf bank_mask:0xf
    v_lshlrev_b32 v230, 16, v156
    v_and_b32 v231, 0xffff0000, v156
    v_pk_mul_f32 v[144:145], v[230:231], v[108:109]
    v_lshlrev_b32 v230, 16, v162
    v_and_b32 v231, 0xffff0000, v162
    s_waitcnt vmcnt(35)
    v_pk_fma_f32 v[232:233], v[128:129], v[24:25], v[232:233]
    v_pk_fma_f32 v[232:233], v[130:131], v[26:27], v[232:233]
    ds_add_u32 v220, v245 offset:28160
    buffer_load_dwordx4 v[24:27], v1, s[24:27], s71 offen offset:512 nt
    v_cndmask_b32 v229, v229, v227, s[66:67]
    v_mul_f32 v229, 0x58000000, v229
    ds_write_b32 v241, v229
    v_add_u32 v241, 256, v241
    v_add_f32 v224, v232, v233
    v_pk_mul_f32 v[236:237], v[144:145], v[230:231]
    v_lshlrev_b32 v230, 16, v157
    v_and_b32 v231, 0xffff0000, v157
    v_pk_mul_f32 v[146:147], v[230:231], v[110:111]
    v_lshlrev_b32 v230, 16, v163
    s_waitcnt vmcnt(35)
    v_pk_fma_f32 v[232:233], v[120:121], v[28:29], v[234:235]
    v_pk_fma_f32 v[232:233], v[122:123], v[30:31], v[232:233]
    s_add_u32 s71, s71, 3072
    s_cbranch_vccnz L_th30_1
L_tb30_1:
    buffer_load_dwordx4 v[28:31], v1, s[24:27], s71 offen offset:0 nt
    v_add_f32_dpp v225, v224, v224 row_ror:8 row_mask:0xf bank_mask:0xc
    v_and_b32 v231, 0xffff0000, v163
    v_pk_fma_f32 v[236:237], v[146:147], v[230:231], v[236:237]
    v_lshlrev_b32 v230, 16, v158
    v_and_b32 v231, 0xffff0000, v158
    v_pk_mul_f32 v[148:149], v[230:231], v[112:113]
    s_waitcnt vmcnt(35)
    v_pk_fma_f32 v[232:233], v[124:125], v[32:33], v[232:233]
    v_pk_fma_f32 v[232:233], v[126:127], v[34:35], v[232:233]
    buffer_load_dwordx4 v[32:35], v1, s[24:27], s71 offen offset:256 nt
    v_add_f32_dpp v226, v225, v225 row_shl:4 row_mask:0xf bank_mask:0x5
    v_lshlrev_b32 v230, 16, v164
    v_and_b32 v231, 0xffff0000, v164
    v_pk_fma_f32 v[236:237], v[148:149], v[230:231], v[236:237]
    v_lshlrev_b32 v230, 16, v159
    v_and_b32 v231, 0xffff0000, v159
    s_waitcnt vmcnt(35)
    v_pk_fma_f32 v[232:233], v[128:129], v[36:37], v[232:233]
    v_pk_fma_f32 v[232:233], v[130:131], v[38:39], v[232:233]
    ds_add_u32 v220, v245 offset:28160
    buffer_load_dwordx4 v[36:39], v1, s[24:27], s71 offen offset:512 nt
    v_add_f32 v224, v232, v233
    v_pk_mul_f32 v[150:151], v[230:231], v[114:115]
    v_lshlrev_b32 v230, 16, v165
    v_and_b32 v231, 0xffff0000, v165
    v_pk_fma_f32 v[236:237], v[150:151], v[230:231], v[236:237]
    v_lshlrev_b32 v230, 16, v160
    s_waitcnt vmcnt(35)
    v_pk_fma_f32 v[232:233], v[120:121], v[40:41], v[234:235]
    v_pk_fma_f32 v[232:233], v[122:123], v[42:43], v[232:233]
    s_add_u32 s71, s71, 3072
    s_cbranch_vccnz L_th33_1
L_tb33_1:
    buffer_load_dwordx4 v[40:43], v1, s[24:27], s71 offen offset:0 nt
    v_add_f32_dpp v225, v224, v224 row_ror:8 row_mask:0xf bank_mask:0x3
    v_and_b32 v231, 0xffff0000, v160
    v_pk_mul_f32 v[152:153], v[230:231], v[116:117]
    v_lshlrev_b32 v230, 16, v166
    v_and_b32 v231, 0xffff0000, v166
    v_pk_fma_f32 v[236:237], v[152:153], v[230:231], v[236:237]
    s_waitcnt vmcnt(35)
    v_pk_fma_f32 v[232:233], v[124:125], v[44:45], v[232:233]
    v_pk_fma_f32 v[232:233], v[126:127], v[46:47], v[232:233]
    buffer_load_dwordx4 v[44:47], v1, s[24:27], s71 offen offset:256 nt
    v_lshlrev_b32 v230, 16, v161
    v_and_b32 v231, 0xffff0000, v161
    v_pk_mul_f32 v[154:155], v[230:231], v[118:119]
    v_lshlrev_b32 v230, 16, v167
    v_and_b32 v231, 0xffff0000, v167
    s_waitcnt vmcnt(35)
    v_pk_fma_f32 v[232:233], v[128:129], v[48:49], v[232:233]
    v_pk_fma_f32 v[232:233], v[130:131], v[50:51], v[232:233]
    ds_add_u32 v220, v245 offset:28160
    buffer_load_dwordx4 v[48:51], v1, s[24:27], s71 offen offset:512 nt
    v_add_f32 v224, v232, v233
    v_pk_fma_f32 v[236:237], v[154:155], v[230:231], v[236:237]
    v_pk_mul_f32 v[236:237], v[236:237], s[62:63]
    s_waitcnt vmcnt(35)
    v_pk_fma_f32 v[232:233], v[144:145], v[52:53], v[236:237]
    v_pk_fma_f32 v[232:233], v[146:147], v[54:55], v[232:233]
    ds_read_b32 v246, v245 offset:147
    s_add_u32 s71, s71, 777216
    s_cbranch_vccnz L_th36_1
L_tb36_1:
    buffer_load_dwordx4 v[52:55], v1, s[24:27], s71 offen offset:0 nt
    v_add_f32_dpp v225, v224, v224 row_ror:8 row_mask:0xf bank_mask:0xc
    s_waitcnt vmcnt(35)
    v_pk_fma_f32 v[232:233], v[148:149], v[56:57], v[232:233]
    v_pk_fma_f32 v[232:233], v[150:151], v[58:59], v[232:233]
    buffer_load_dwordx4 v[56:59], v1, s[24:27], s71 offen offset:256 nt
    v_add_f32_dpp v226, v225, v225 row_shr:4 row_mask:0xf bank_mask:0xa
    s_waitcnt vmcnt(35)
    v_pk_fma_f32 v[232:233], v[152:153], v[60:61], v[232:233]
    v_pk_fma_f32 v[232:233], v[154:155], v[62:63], v[232:233]
    s_waitcnt lgkmcnt(0)
    v_cmp_ne_u32 vcc, 0, v246
    ds_add_u32 v220, v245 offset:28160
    buffer_load_dwordx4 v[60:63], v1, s[24:27], s71 offen offset:512 nt
    v_add_f32_dpp v227, v226, v226 quad_perm:[2,3,0,1] row_mask:0xf bank_mask:0xf
    v_add_f32 v224, v232, v233
    s_waitcnt vmcnt(35)
    v_pk_fma_f32 v[232:233], v[144:145], v[64:65], v[236:237]
    v_pk_fma_f32 v[232:233], v[146:147], v[66:67], v[232:233]
    s_add_u32 s71, s71, 3072
    s_cbranch_vccnz L_th39_1
L_tb39_1:
    buffer_load_dwordx4 v[64:67], v1, s[24:27], s71 offen offset:0 nt
    v_add_f32_dpp v225, v224, v224 row_ror:8 row_mask:0xf bank_mask:0x3
    s_waitcnt vmcnt(29)
    v_pk_fma_f32 v[232:233], v[148:149], v[68:69], v[232:233]
    v_pk_fma_f32 v[232:233], v[150:151], v[70:71], v[232:233]
    buffer_load_dwordx4 v[68:71], v1, s[24:27], s71 offen offset:256 nt
    v_lshlrev_b32 v230, 16, v168
    v_and_b32 v231, 0xffff0000, v168
    v_pk_mul_f32 v[120:121], v[230:231], v[108:109]
    v_lshlrev_b32 v230, 16, v174
    v_and_b32 v231, 0xffff0000, v174
    s_waitcnt vmcnt(29)
    v_pk_fma_f32 v[232:233], v[152:153], v[72:73], v[232:233]
    v_pk_fma_f32 v[232:233], v[154:155], v[74:75], v[232:233]
    ds_add_u32 v220, v245 offset:28160
    buffer_load_dwordx4 v[72:75], v1, s[24:27], s71 offen offset:512 nt
    v_add_f32 v224, v232, v233
    v_pk_mul_f32 v[234:235], v[120:121], v[230:231]
    v_lshlrev_b32 v230, 16, v169
    v_and_b32 v231, 0xffff0000, v169
    v_pk_mul_f32 v[122:123], v[230:231], v[110:111]
    v_lshlrev_b32 v230, 16, v175
    s_waitcnt vmcnt(29)
    v_pk_fma_f32 v[232:233], v[144:145], v[76:77], v[236:237]
    v_pk_fma_f32 v[232:233], v[146:147], v[78:79], v[232:233]
    s_add_u32 s71, s71, 3072
    s_cbranch_vccnz L_th42_1
L_tb42_1:
    buffer_load_dwordx4 v[76:79], v1, s[24:27], s71 offen offset:0 nt
    v_add_f32_dpp v225, v224, v224 row_ror:8 row_mask:0xf bank_mask:0xc
    v_and_b32 v231, 0xffff0000, v175
    v_pk_fma_f32 v[234:235], v[122:123], v[230:231], v[234:235]
    v_lshlrev_b32 v230, 16, v170
    v_and_b32 v231, 0xffff0000, v170
    v_pk_mul_f32 v[124:125], v[230:231], v[112:113]
    s_waitcnt vmcnt(29)
    v_pk_fma_f32 v[232:233], v[148:149], v[80:81], v[232:233]
    v_pk_fma_f32 v[232:233], v[150:151], v[82:83], v[232:233]
    buffer_load_dwordx4 v[80:83], v1, s[24:27], s71 offen offset:256 nt
    v_add_f32_dpp v226, v225, v225 row_shl:4 row_mask:0xf bank_mask:0x5
    v_lshlrev_b32 v230, 16, v176
    v_and_b32 v231, 0xffff0000, v176
    v_pk_fma_f32 v[234:235], v[124:125], v[230:231], v[234:235]
    v_lshlrev_b32 v230, 16, v171
    v_and_b32 v231, 0xffff0000, v171
    s_waitcnt vmcnt(29)
    v_pk_fma_f32 v[232:233], v[152:153], v[84:85], v[232:233]
    v_pk_fma_f32 v[232:233], v[154:155], v[86:87], v[232:233]
    ds_add_u32 v220, v245 offset:28160
    buffer_load_dwordx4 v[84:87], v1, s[24:27], s71 offen offset:512 nt
    v_add_f32 v224, v232, v233
    v_pk_mul_f32 v[126:127], v[230:231], v[114:115]
    v_lshlrev_b32 v230, 16, v177
    v_and_b32 v231, 0xffff0000, v177
    v_pk_fma_f32 v[234:235], v[126:127], v[230:231], v[234:235]
    v_lshlrev_b32 v230, 16, v172
    s_waitcnt vmcnt(29)
    v_pk_fma_f32 v[232:233], v[144:145], v[88:89], v[236:237]
    v_pk_fma_f32 v[232:233], v[146:147], v[90:91], v[232:233]
    s_add_u32 s71, s71, 3072
    s_cbranch_vccnz L_th45_1
L_tb45_1:
    buffer_load_dwordx4 v[88:91], v1, s[24:27], s71 offen offset:0 nt
    v_add_f32_dpp v225, v224, v224 row_ror:8 row_mask:0xf bank_mask:0x3
    v_and_b32 v231, 0xffff0000, v172
    v_pk_mul_f32 v[128:129], v[230:231], v[116:117]
    v_lshlrev_b32 v230, 16, v178
    v_and_b32 v231, 0xffff0000, v178
    v_pk_fma_f32 v[234:235], v[128:129], v[230:231], v[234:235]
    s_waitcnt vmcnt(29)
    v_pk_fma_f32 v[232:233], v[148:149], v[92:93], v[232:233]
    v_pk_fma_f32 v[232:233], v[150:151], v[94:95], v[232:233]
    buffer_load_dwordx4 v[92:95], v1, s[24:27], s71 offen offset:256 nt
    v_lshlrev_b32 v230, 16, v173
    v_and_b32 v231, 0xffff0000, v173
    v_pk_mul_f32 v[130:131], v[230:231], v[118:119]
    v_lshlrev_b32 v230, 16, v179
    v_and_b32 v231, 0xffff0000, v179
    s_waitcnt vmcnt(29)
    v_pk_fma_f32 v[232:233], v[152:153], v[96:97], v[232:233]
    v_pk_fma_f32 v[232:233], v[154:155], v[98:99], v[232:233]
    ds_add_u32 v220, v245 offset:28160
    buffer_load_dwordx4 v[96:99], v1, s[24:27], s71 offen offset:512 nt
    v_add_f32 v224, v232, v233
    v_pk_fma_f32 v[234:235], v[130:131], v[230:231], v[234:235]
    v_pk_mul_f32 v[234:235], v[234:235], s[62:63]
    s_waitcnt vmcnt(29)
    v_pk_fma_f32 v[232:233], v[120:121], v[4:5], v[234:235]
    v_pk_fma_f32 v[232:233], v[122:123], v[6:7], v[232:233]
    ds_read_b32 v246, v245 offset:147
    s_mov_b32 s57, s69
    s_mov_b32 s56, s58
    s_mov_b32 s75, 8
    s_add_u32 s70, s57, s56
    s_mov_b32 s91, -56
    s_and_b32 s80, s70, 63
    s_mul_i32 s80, s80, 96
    s_lshl_b32 s73, s70, 7
    s_sub_u32 s73, s73, s80
    buffer_load_ushort v216, v3, s[40:43], s73 offen
    buffer_load_ushort v217, v3, s[44:47], s73 offen
    s_mul_i32 s71, s70, 49152
    s_and_b32 s80, s70, 63
    s_mul_i32 s80, s80, 36864
    s_sub_u32 s71, s71, s80
    s_cbranch_vccnz L_th0_1
L_tb0_1:
    buffer_load_dwordx4 v[4:7], v1, s[28:31], s71 offen offset:0 nt
    v_add_f32_dpp v225, v224, v224 row_ror:8 row_mask:0xf bank_mask:0xc
    s_waitcnt vmcnt(31)
    v_pk_fma_f32 v[232:233], v[124:125], v[8:9], v[232:233]
    v_pk_fma_f32 v[232:233], v[126:127], v[10:11], v[232:233]
    buffer_load_dwordx4 v[8:11], v1, s[28:31], s71 offen offset:256 nt
    v_add_f32_dpp v226, v225, v225 row_shr:4 row_mask:0xf bank_mask:0xa
    s_waitcnt vmcnt(31)
    v_pk_fma_f32 v[232:233], v[128:129], v[12:13], v[232:233]
    v_pk_fma_f32 v[232:233], v[130:131], v[14:15], v[232:233]
    s_waitcnt lgkmcnt(0)
    v_cmp_ne_u32 vcc, 0, v246
    ds_add_u32 v220, v245 offset:28160
    buffer_load_dwordx4 v[12:15], v1, s[28:31], s71 offen offset:512 nt
    v_add_f32_dpp v228, v226, v226 quad_perm:[2,3,0,1] row_mask:0xf bank_mask:0xf
    v_add_f32 v224, v232, v233
    s_waitcnt vmcnt(31)
    v_pk_fma_f32 v[232:233], v[120:121], v[16:17], v[234:235]
    v_pk_fma_f32 v[232:233], v[122:123], v[18:19], v[232:233]
    s_add_u32 s71, s71, 3072
    s_cbranch_vccnz L_th3_1
L_tb3_1:
    buffer_load_dwordx4 v[16:19], v1, s[28:31], s71 offen offset:0 nt
    v_cndmask_b32 v228, v227, v228, s[64:65]
    v_add_f32_dpp v225, v224, v224 row_ror:8 row_mask:0xf bank_mask:0x3
    s_waitcnt vmcnt(25)
    v_pk_fma_f32 v[232:233], v[124:125], v[20:21], v[232:233]
    v_pk_fma_f32 v[232:233], v[126:127], v[22:23], v[232:233]
    buffer_load_dwordx4 v[20:23], v1, s[28:31], s71 offen offset:256 nt
    v_add_f32_dpp v229, v228, v228 quad_perm:[1,0,3,2] row_mask:0xf bank_mask:0xf
    v_lshlrev_b32 v230, 16, v180
    v_and_b32 v231, 0xffff0000, v180
    v_pk_mul_f32 v[144:145], v[230:231], v[108:109]
    v_lshlrev_b32 v230, 16, v186
    v_and_b32 v231, 0xffff0000, v186
    s_waitcnt vmcnt(25)
    v_pk_fma_f32 v[232:233], v[128:129], v[24:25], v[232:233]
    v_pk_fma_f32 v[232:233], v[130:131], v[26:27], v[232:233]
    ds_add_u32 v220, v245 offset:28160
    buffer_load_dwordx4 v[24:27], v1, s[28:31], s71 offen offset:512 nt
    v_add_f32 v224, v232, v233
    v_pk_mul_f32 v[236:237], v[144:145], v[230:231]
    v_lshlrev_b32 v230, 16, v181
    v_and_b32 v231, 0xffff0000, v181
    v_pk_mul_f32 v[146:147], v[230:231], v[110:111]
    v_lshlrev_b32 v230, 16, v187
    s_waitcnt vmcnt(25)
    v_pk_fma_f32 v[232:233], v[120:121], v[28:29], v[234:235]
    v_pk_fma_f32 v[232:233], v[122:123], v[30:31], v[232:233]
    s_add_u32 s71, s71, 3072
    s_cbranch_vccnz L_th6_1
L_tb6_1:
    buffer_load_dwordx4 v[28:31], v1, s[28:31], s71 offen offset:0 nt
    v_add_f32_dpp v225, v224, v224 row_ror:8 row_mask:0xf bank_mask:0xc
    v_and_b32 v231, 0xffff0000, v187
    v_pk_fma_f32 v[236:237], v[146:147], v[230:231], v[236:237]
    v_lshlrev_b32 v230, 16, v182
    v_and_b32 v231, 0xffff0000, v182
    v_pk_mul_f32 v[148:149], v[230:231], v[112:113]
    s_waitcnt vmcnt(25)
    v_pk_fma_f32 v[232:233], v[124:125], v[32:33], v[232:233]
    v_pk_fma_f32 v[232:233], v[126:127], v[34:35], v[232:233]
    buffer_load_dwordx4 v[32:35], v1, s[28:31], s71 offen offset:256 nt
    v_add_f32_dpp v226, v225, v225 row_shl:4 row_mask:0xf bank_mask:0x5
    v_lshlrev_b32 v230, 16, v188
    v_and_b32 v231, 0xffff0000, v188
    v_pk_fma_f32 v[236:237], v[148:149], v[230:231], v[236:237]
    v_lshlrev_b32 v230, 16, v183
    v_and_b32 v231, 0xffff0000, v183
    s_waitcnt vmcnt(25)
    v_pk_fma_f32 v[232:233], v[128:129], v[36:37], v[232:233]
    v_pk_fma_f32 v[232:233], v[130:131], v[38:39], v[232:233]
    ds_add_u32 v220, v245 offset:28160
    buffer_load_dwordx4 v[36:39], v1, s[28:31], s71 offen offset:512 nt
    v_add_f32 v224, v232, v233
    v_pk_mul_f32 v[150:151], v[230:231], v[114:115]
    v_lshlrev_b32 v230, 16, v189
    v_and_b32 v231, 0xffff0000, v189
    v_pk_fma_f32 v[236:237], v[150:151], v[230:231], v[236:237]
    v_lshlrev_b32 v230, 16, v184
    s_waitcnt vmcnt(25)
    v_pk_fma_f32 v[232:233], v[120:121], v[40:41], v[234:235]
    v_pk_fma_f32 v[232:233], v[122:123], v[42:43], v[232:233]
    s_add_u32 s71, s71, 3072
    s_cbranch_vccnz L_th9_1
L_tb9_1:
    buffer_load_dwordx4 v[40:43], v1, s[28:31], s71 offen offset:0 nt
    v_add_f32_dpp v225, v224, v224 row_ror:8 row_mask:0xf bank_mask:0x3
    v_and_b32 v231, 0xffff0000, v184
    v_pk_mul_f32 v[152:153], v[230:231], v[116:117]
    v_lshlrev_b32 v230, 16, v190
    v_and_b32 v231, 0xffff0000, v190
    v_pk_fma_f32 v[236:237], v[152:153], v[230:231], v[236:237]
    s_waitcnt vmcnt(25)
    v_pk_fma_f32 v[232:233], v[124:125], v[44:45], v[232:233]
    v_pk_fma_f32 v[232:233], v[126:127], v[46:47], v[232:233]
    buffer_load_dwordx4 v[44:47], v1, s[28:31], s71 offen offset:256 nt
    v_lshlrev_b32 v230, 16, v185
    v_and_b32 v231, 0xffff0000, v185
    v_pk_mul_f32 v[154:155], v[230:231], v[118:119]
    v_lshlrev_b32 v230, 16, v191
    v_and_b32 v231, 0xffff0000, v191
    s_waitcnt vmcnt(25)
    v_pk_fma_f32 v[232:233], v[128:129], v[48:49], v[232:233]
    v_pk_fma_f32 v[232:233], v[130:131], v[50:51], v[232:233]
    ds_add_u32 v220, v245 offset:28160
    buffer_load_dwordx4 v[48:51], v1, s[28:31], s71 offen offset:512 nt
    v_add_f32 v224, v232, v233
    v_pk_fma_f32 v[236:237], v[154:155], v[230:231], v[236:237]
    v_pk_mul_f32 v[236:237], v[236:237], s[62:63]
    s_waitcnt vmcnt(25)
    v_pk_fma_f32 v[232:233], v[144:145], v[52:53], v[236:237]
    v_pk_fma_f32 v[232:233], v[146:147], v[54:55], v[232:233]
    ds_read_b32 v246, v245 offset:147
    s_add_u32 s71, s71, 777216
    s_cbranch_vccnz L_th12_1
L_tb12_1:
    buffer_load_dwordx4 v[52:55], v1, s[28:31], s71 offen offset:0 nt
    v_add_f32_dpp v225, v224, v224 row_ror:8 row_mask:0xf bank_mask:0xc
    s_waitcnt vmcnt(25)
    v_pk_fma_f32 v[232:233], v[148:149], v[56:57], v[232:233]
    v_pk_fma_f32 v[232:233], v[150:151], v[58:59], v[232:233]
    buffer_load_dwordx4 v[56:59], v1, s[28:31], s71 offen offset:256 nt
    v_add_f32_dpp v226, v225, v225 row_shr:4 row_mask:0xf bank_mask:0xa
    s_waitcnt vmcnt(25)
    v_pk_fma_f32 v[232:233], v[152:153], v[60:61], v[232:233]
    v_pk_fma_f32 v[232:233], v[154:155], v[62:63], v[232:233]
    s_waitcnt lgkmcnt(0)
    v_cmp_ne_u32 vcc, 0, v246
    ds_add_u32 v220, v245 offset:28160
    buffer_load_dwordx4 v[60:63], v1, s[28:31], s71 offen offset:512 nt
    v_add_f32_dpp v227, v226, v226 quad_perm:[2,3,0,1] row_mask:0xf bank_mask:0xf
    v_add_f32 v224, v232, v233
    s_waitcnt vmcnt(25)
    v_pk_fma_f32 v[232:233], v[144:145], v[64:65], v[236:237]
    v_pk_fma_f32 v[232:233], v[146:147], v[66:67], v[232:233]
    s_add_u32 s71, s71, 3072
    s_cbranch_vccnz L_th15_1
L_tb15_1:
    buffer_load_dwordx4 v[64:67], v1, s[28:31], s71 offen offset:0 nt
    v_add_f32_dpp v225, v224, v224 row_ror:8 row_mask:0xf bank_mask:0x3
    s_waitcnt vmcnt(25)
    v_pk_fma_f32 v[232:233], v[148:149], v[68:69], v[232:233]
    v_pk_fma_f32 v[232:233], v[150:151], v[70:71], v[232:233]
    buffer_load_dwordx4 v[68:71], v1, s[28:31], s71 offen offset:256 nt
    s_waitcnt vmcnt(25)
    v_pk_fma_f32 v[232:233], v[152:153], v[72:73], v[232:233]
    v_pk_fma_f32 v[232:233], v[154:155], v[74:75], v[232:233]
    ds_add_u32 v220, v245 offset:28160
    buffer_load_dwordx4 v[72:75], v1, s[28:31], s71 offen offset:512 nt
    v_add_f32 v224, v232, v233
    s_waitcnt vmcnt(25)
    v_pk_fma_f32 v[232:233], v[144:145], v[76:77], v[236:237]
    v_pk_fma_f32 v[232:233], v[146:147], v[78:79], v[232:233]
    s_add_u32 s71, s71, 3072
    s_cbranch_vccnz L_th18_1
L_tb18_1:
    buffer_load_dwordx4 v[76:79], v1, s[28:31], s71 offen offset:0 nt
    v_add_f32_dpp v225, v224, v224 row_ror:8 row_mask:0xf bank_mask:0xc
    s_waitcnt vmcnt(25)
    v_pk_fma_f32 v[232:233], v[148:149], v[80:81], v[232:233]
    v_pk_fma_f32 v[232:233], v[150:151], v[82:83], v[232:233]
    buffer_load_dwordx4 v[80:83], v1, s[28:31], s71 offen offset:256 nt
    v_add_f32_dpp v226, v225, v225 row_shl:4 row_mask:0xf bank_mask:0x5
    s_waitcnt vmcnt(25)
    v_pk_fma_f32 v[232:233], v[152:153], v[84:85], v[232:233]
    v_pk_fma_f32 v[232:233], v[154:155], v[86:87], v[232:233]
    ds_add_u32 v220, v245 offset:28160
    buffer_load_dwordx4 v[84:87], v1, s[28:31], s71 offen offset:512 nt
    v_add_f32 v224, v232, v233
    s_waitcnt vmcnt(25)
    v_pk_fma_f32 v[232:233], v[144:145], v[88:89], v[236:237]
    v_pk_fma_f32 v[232:233], v[146:147], v[90:91], v[232:233]
    s_add_u32 s71, s71, 3072
    s_cbranch_vccnz L_th21_1
L_tb21_1:
    buffer_load_dwordx4 v[88:91], v1, s[28:31], s71 offen offset:0 nt
    v_add_f32_dpp v225, v224, v224 row_ror:8 row_mask:0xf bank_mask:0x3
    s_waitcnt vmcnt(25)
    v_pk_fma_f32 v[232:233], v[148:149], v[92:93], v[232:233]
    v_pk_fma_f32 v[232:233], v[150:151], v[94:95], v[232:233]
    buffer_load_dwordx4 v[92:95], v1, s[28:31], s71 offen offset:256 nt
    s_waitcnt vmcnt(25)
    v_pk_fma_f32 v[232:233], v[152:153], v[96:97], v[232:233]
    v_pk_fma_f32 v[232:233], v[154:155], v[98:99], v[232:233]
    ds_add_u32 v220, v245 offset:28160
    buffer_load_dwordx4 v[96:99], v1, s[28:31], s71 offen offset:512 nt
    v_add_f32 v224, v232, v233
    s_nop 1
    v_add_f32_dpp v225, v224, v224 row_ror:8 row_mask:0xf bank_mask:0xc
    s_nop 1
    v_add_f32_dpp v226, v225, v225 row_shr:4 row_mask:0xf bank_mask:0xa
    s_nop 1
    v_add_f32_dpp v228, v226, v226 quad_perm:[2,3,0,1] row_mask:0xf bank_mask:0xf
    s_nop 1
    v_cndmask_b32 v228, v227, v228, s[64:65]
    s_nop 1
    v_add_f32_dpp v227, v228, v228 quad_perm:[1,0,3,2] row_mask:0xf bank_mask:0xf
    s_nop 1
    v_cndmask_b32 v229, v229, v227, s[66:67]
    v_mul_f32 v229, 0x58000000, v229
    ds_write_b32 v241, v229
    v_add_u32 v241, 256, v241
    s_mov_b64 exec, 1
    ds_add_u32 v245, v245 offset:127
    s_mov_b64 exec, -1
    ds_read_b32 v219, v242
    v_add_u32 v242, 256, v242
    s_mov_b32 s76, 59
L_loop1:
    s_waitcnt vmcnt(24)
    v_lshlrev_b32 v216, 16, v216
    v_lshlrev_b32 v217, 16, v217
    s_waitcnt lgkmcnt(0)
    v_max_f32_dpp v230, v219, v219 row_ror:8 row_mask:0xf bank_mask:0xf
    s_nop 1
    v_max_f32_dpp v230, v230, v230 row_ror:4 row_mask:0xf bank_mask:0xf
    s_nop 1
    v_max_f32_dpp v230, v230, v230 row_ror:2 row_mask:0xf bank_mask:0xf
    s_nop 1
    v_max_f32_dpp v230, v230, v230 row_ror:1 row_mask:0xf bank_mask:0xf
    v_max_f32 v230, v230, v212
    v_sub_f32 v231, v212, v230
    v_sub_f32 v218, v219, v230
    v_exp_f32 v231, v231
    v_exp_f32 v218, v218
    v_mov_b32 v212, v230
    v_fma_f32 v213, v213, v231, v218
    v_mul_f32 v218, v218, v216
    v_mul_f32 v214, v214, v231
    v_mul_f32 v240, 0x71800000, v218
    v_fmac_f32 v214, v218, v217
    ds_read_b32 v219, v242
    v_add_u32 v242, 256, v242
    v_pk_mul_f32 v[200:201], v[200:201], v[230:231] op_sel:[0,1] op_sel_hi:[1,1]
    v_pk_mul_f32 v[202:203], v[202:203], v[230:231] op_sel:[0,1] op_sel_hi:[1,1]
    v_pk_mul_f32 v[204:205], v[204:205], v[230:231] op_sel:[0,1] op_sel_hi:[1,1]
    v_pk_mul_f32 v[206:207], v[206:207], v[230:231] op_sel:[0,1] op_sel_hi:[1,1]
    v_pk_mul_f32 v[208:209], v[208:209], v[230:231] op_sel:[0,1] op_sel_hi:[1,1]
    v_pk_mul_f32 v[210:211], v[210:211], v[230:231] op_sel:[0,1] op_sel_hi:[1,1]
    v_mov_b32_dpp v238, v240 row_newbcast:0 row_mask:0xf bank_mask:0xf
    s_waitcnt vmcnt(23)
    v_pk_fma_f32 v[200:201], v[238:239], v[4:5], v[200:201] op_sel_hi:[0,1,1]
    v_pk_fma_f32 v[202:203], v[238:239], v[6:7], v[202:203] op_sel_hi:[0,1,1]
    ds_read_b32 v246, v245 offset:147
    s_add_u32 s71, s71, 777216
    s_cbranch_vccnz L_th24_2
L_tb24_2:
    buffer_load_dwordx4 v[4:7], v1, s[28:31], s71 offen offset:0 nt
    s_waitcnt vmcnt(23)
    v_pk_fma_f32 v[204:205], v[238:239], v[8:9], v[204:205] op_sel_hi:[0,1,1]
    v_pk_fma_f32 v[206:207], v[238:239], v[10:11], v[206:207] op_sel_hi:[0,1,1]
    buffer_load_dwordx4 v[8:11], v1, s[28:31], s71 offen offset:256 nt
    s_waitcnt vmcnt(23)
    v_pk_fma_f32 v[208:209], v[238:239], v[12:13], v[208:209] op_sel_hi:[0,1,1]
    v_pk_fma_f32 v[210:211], v[238:239], v[14:15], v[210:211] op_sel_hi:[0,1,1]
    s_waitcnt lgkmcnt(0)
    v_cmp_ne_u32 vcc, 0, v246
    ds_add_u32 v220, v245 offset:28160
    buffer_load_dwordx4 v[12:15], v1, s[28:31], s71 offen offset:512 nt
    v_mov_b32_dpp v238, v240 row_newbcast:8 row_mask:0xf bank_mask:0xf
    s_waitcnt vmcnt(23)
    v_pk_fma_f32 v[200:201], v[238:239], v[16:17], v[200:201] op_sel_hi:[0,1,1]
    v_pk_fma_f32 v[202:203], v[238:239], v[18:19], v[202:203] op_sel_hi:[0,1,1]
    s_add_u32 s71, s71, 3072
    s_cbranch_vccnz L_th27_2
L_tb27_2:
    buffer_load_dwordx4 v[16:19], v1, s[28:31], s71 offen offset:0 nt
    s_waitcnt vmcnt(23)
    v_pk_fma_f32 v[204:205], v[238:239], v[20:21], v[204:205] op_sel_hi:[0,1,1]
    v_pk_fma_f32 v[206:207], v[238:239], v[22:23], v[206:207] op_sel_hi:[0,1,1]
    buffer_load_dwordx4 v[20:23], v1, s[28:31], s71 offen offset:256 nt
    s_waitcnt vmcnt(23)
    v_pk_fma_f32 v[208:209], v[238:239], v[24:25], v[208:209] op_sel_hi:[0,1,1]
    v_pk_fma_f32 v[210:211], v[238:239], v[26:27], v[210:211] op_sel_hi:[0,1,1]
    ds_add_u32 v220, v245 offset:28160
    buffer_load_dwordx4 v[24:27], v1, s[28:31], s71 offen offset:512 nt
    v_mov_b32_dpp v238, v240 row_newbcast:4 row_mask:0xf bank_mask:0xf
    s_waitcnt vmcnt(23)
    v_pk_fma_f32 v[200:201], v[238:239], v[28:29], v[200:201] op_sel_hi:[0,1,1]
    v_pk_fma_f32 v[202:203], v[238:239], v[30:31], v[202:203] op_sel_hi:[0,1,1]
    s_add_u32 s71, s71, 3072
    s_cbranch_vccnz L_th30_2
L_tb30_2:
    buffer_load_dwordx4 v[28:31], v1, s[28:31], s71 offen offset:0 nt
    s_waitcnt vmcnt(23)
    v_pk_fma_f32 v[204:205], v[238:239], v[32:33], v[204:205] op_sel_hi:[0,1,1]
    v_pk_fma_f32 v[206:207], v[238:239], v[34:35], v[206:207] op_sel_hi:[0,1,1]
    buffer_load_dwordx4 v[32:35], v1, s[28:31], s71 offen offset:256 nt
    s_waitcnt vmcnt(23)
    v_pk_fma_f32 v[208:209], v[238:239], v[36:37], v[208:209] op_sel_hi:[0,1,1]
    v_pk_fma_f32 v[210:211], v[238:239], v[38:39], v[210:211] op_sel_hi:[0,1,1]
    ds_add_u32 v220, v245 offset:28160
    buffer_load_dwordx4 v[36:39], v1, s[28:31], s71 offen offset:512 nt
    v_mov_b32_dpp v238, v240 row_newbcast:12 row_mask:0xf bank_mask:0xf
    s_waitcnt vmcnt(23)
    v_pk_fma_f32 v[200:201], v[238:239], v[40:41], v[200:201] op_sel_hi:[0,1,1]
    v_pk_fma_f32 v[202:203], v[238:239], v[42:43], v[202:203] op_sel_hi:[0,1,1]
    s_add_u32 s71, s71, 3072
    s_cbranch_vccnz L_th33_2
L_tb33_2:
    buffer_load_dwordx4 v[40:43], v1, s[28:31], s71 offen offset:0 nt
    s_waitcnt vmcnt(23)
    v_pk_fma_f32 v[204:205], v[238:239], v[44:45], v[204:205] op_sel_hi:[0,1,1]
    v_pk_fma_f32 v[206:207], v[238:239], v[46:47], v[206:207] op_sel_hi:[0,1,1]
    buffer_load_dwordx4 v[44:47], v1, s[28:31], s71 offen offset:256 nt
    s_waitcnt vmcnt(23)
    v_pk_fma_f32 v[208:209], v[238:239], v[48:49], v[208:209] op_sel_hi:[0,1,1]
    v_pk_fma_f32 v[210:211], v[238:239], v[50:51], v[210:211] op_sel_hi:[0,1,1]
    ds_add_u32 v220, v245 offset:28160
    buffer_load_dwordx4 v[48:51], v1, s[28:31], s71 offen offset:512 nt
    v_mov_b32_dpp v238, v240 row_newbcast:2 row_mask:0xf bank_mask:0xf
    s_waitcnt vmcnt(23)
    v_pk_fma_f32 v[200:201], v[238:239], v[52:53], v[200:201] op_sel_hi:[0,1,1]
    v_pk_fma_f32 v[202:203], v[238:239], v[54:55], v[202:203] op_sel_hi:[0,1,1]
    ds_read_b32 v246, v245 offset:147
    s_add_u32 s71, s71, 777216
    s_cbranch_vccnz L_th36_2
L_tb36_2:
    buffer_load_dwordx4 v[52:55], v1, s[28:31], s71 offen offset:0 nt
    s_waitcnt vmcnt(23)
    v_pk_fma_f32 v[204:205], v[238:239], v[56:57], v[204:205] op_sel_hi:[0,1,1]
    v_pk_fma_f32 v[206:207], v[238:239], v[58:59], v[206:207] op_sel_hi:[0,1,1]
    buffer_load_dwordx4 v[56:59], v1, s[28:31], s71 offen offset:256 nt
    s_waitcnt vmcnt(23)
    v_pk_fma_f32 v[208:209], v[238:239], v[60:61], v[208:209] op_sel_hi:[0,1,1]
    v_pk_fma_f32 v[210:211], v[238:239], v[62:63], v[210:211] op_sel_hi:[0,1,1]
    s_waitcnt lgkmcnt(0)
    v_cmp_ne_u32 vcc, 0, v246
    ds_add_u32 v220, v245 offset:28160
    buffer_load_dwordx4 v[60:63], v1, s[28:31], s71 offen offset:512 nt
    v_mov_b32_dpp v238, v240 row_newbcast:10 row_mask:0xf bank_mask:0xf
    s_waitcnt vmcnt(23)
    v_pk_fma_f32 v[200:201], v[238:239], v[64:65], v[200:201] op_sel_hi:[0,1,1]
    v_pk_fma_f32 v[202:203], v[238:239], v[66:67], v[202:203] op_sel_hi:[0,1,1]
    s_add_u32 s71, s71, 3072
    s_cbranch_vccnz L_th39_2
L_tb39_2:
    buffer_load_dwordx4 v[64:67], v1, s[28:31], s71 offen offset:0 nt
    s_waitcnt vmcnt(23)
    v_pk_fma_f32 v[204:205], v[238:239], v[68:69], v[204:205] op_sel_hi:[0,1,1]
    v_pk_fma_f32 v[206:207], v[238:239], v[70:71], v[206:207] op_sel_hi:[0,1,1]
    buffer_load_dwordx4 v[68:71], v1, s[28:31], s71 offen offset:256 nt
    s_waitcnt vmcnt(23)
    v_pk_fma_f32 v[208:209], v[238:239], v[72:73], v[208:209] op_sel_hi:[0,1,1]
    v_pk_fma_f32 v[210:211], v[238:239], v[74:75], v[210:211] op_sel_hi:[0,1,1]
    ds_add_u32 v220, v245 offset:28160
    buffer_load_dwordx4 v[72:75], v1, s[28:31], s71 offen offset:512 nt
    v_mov_b32_dpp v238, v240 row_newbcast:6 row_mask:0xf bank_mask:0xf
    s_waitcnt vmcnt(23)
    v_pk_fma_f32 v[200:201], v[238:239], v[76:77], v[200:201] op_sel_hi:[0,1,1]
    v_pk_fma_f32 v[202:203], v[238:239], v[78:79], v[202:203] op_sel_hi:[0,1,1]
    s_add_u32 s71, s71, 3072
    s_cbranch_vccnz L_th42_2
L_tb42_2:
    buffer_load_dwordx4 v[76:79], v1, s[28:31], s71 offen offset:0 nt
    s_waitcnt vmcnt(23)
    v_pk_fma_f32 v[204:205], v[238:239], v[80:81], v[204:205] op_sel_hi:[0,1,1]
    v_pk_fma_f32 v[206:207], v[238:239], v[82:83], v[206:207] op_sel_hi:[0,1,1]
    buffer_load_dwordx4 v[80:83], v1, s[28:31], s71 offen offset:256 nt
    s_waitcnt vmcnt(23)
    v_pk_fma_f32 v[208:209], v[238:239], v[84:85], v[208:209] op_sel_hi:[0,1,1]
    v_pk_fma_f32 v[210:211], v[238:239], v[86:87], v[210:211] op_sel_hi:[0,1,1]
    ds_add_u32 v220, v245 offset:28160
    buffer_load_dwordx4 v[84:87], v1, s[28:31], s71 offen offset:512 nt
    v_mov_b32_dpp v238, v240 row_newbcast:14 row_mask:0xf bank_mask:0xf
    s_waitcnt vmcnt(23)
    v_pk_fma_f32 v[200:201], v[238:239], v[88:89], v[200:201] op_sel_hi:[0,1,1]
    v_pk_fma_f32 v[202:203], v[238:239], v[90:91], v[202:203] op_sel_hi:[0,1,1]
    s_add_u32 s71, s71, 3072
    s_cbranch_vccnz L_th45_2
L_tb45_2:
    buffer_load_dwordx4 v[88:91], v1, s[28:31], s71 offen offset:0 nt
    s_waitcnt vmcnt(23)
    v_pk_fma_f32 v[204:205], v[238:239], v[92:93], v[204:205] op_sel_hi:[0,1,1]
    v_pk_fma_f32 v[206:207], v[238:239], v[94:95], v[206:207] op_sel_hi:[0,1,1]
    buffer_load_dwordx4 v[92:95], v1, s[28:31], s71 offen offset:256 nt
    s_waitcnt vmcnt(23)
    v_pk_fma_f32 v[208:209], v[238:239], v[96:97], v[208:209] op_sel_hi:[0,1,1]
    v_pk_fma_f32 v[210:211], v[238:239], v[98:99], v[210:211] op_sel_hi:[0,1,1]
    ds_add_u32 v220, v245 offset:28160
    buffer_load_dwordx4 v[96:99], v1, s[28:31], s71 offen offset:512 nt
    v_mov_b32_dpp v238, v240 row_newbcast:1 row_mask:0xf bank_mask:0xf
    s_waitcnt vmcnt(23)
    v_pk_fma_f32 v[200:201], v[238:239], v[4:5], v[200:201] op_sel_hi:[0,1,1]
    v_pk_fma_f32 v[202:203], v[238:239], v[6:7], v[202:203] op_sel_hi:[0,1,1]
    ds_read_b32 v246, v245 offset:147
    s_add_u32 s56, s56, 64
    s_and_b32 s56, s56, 511
    s_sub_u32 s75, s75, 1
    s_cmp_eq_u32 s75, 0
    s_cselect_b32 s80, 2048, 0
    s_cselect_b32 s75, 8, s75
    s_add_u32 s57, s57, s80
    s_add_u32 s70, s57, s56
    s_add_u32 s91, s91, 1
    s_cmp_lt_u32 s91, 4
    s_cselect_b32 s80, s90, 0
    s_add_u32 s70, s70, s80
    s_and_b32 s80, s70, 63
    s_mul_i32 s80, s80, 96
    s_lshl_b32 s73, s70, 7
    s_sub_u32 s73, s73, s80
    buffer_load_ushort v216, v3, s[40:43], s73 offen
    buffer_load_ushort v217, v3, s[44:47], s73 offen
    s_mul_i32 s71, s70, 49152
    s_and_b32 s80, s70, 63
    s_mul_i32 s80, s80, 36864
    s_sub_u32 s71, s71, s80
    s_cbranch_vccnz L_th0_2
L_tb0_2:
    buffer_load_dwordx4 v[4:7], v1, s[28:31], s71 offen offset:0 nt
    s_waitcnt vmcnt(25)
    v_pk_fma_f32 v[204:205], v[238:239], v[8:9], v[204:205] op_sel_hi:[0,1,1]
    v_pk_fma_f32 v[206:207], v[238:239], v[10:11], v[206:207] op_sel_hi:[0,1,1]
    buffer_load_dwordx4 v[8:11], v1, s[28:31], s71 offen offset:256 nt
    s_waitcnt vmcnt(25)
    v_pk_fma_f32 v[208:209], v[238:239], v[12:13], v[208:209] op_sel_hi:[0,1,1]
    v_pk_fma_f32 v[210:211], v[238:239], v[14:15], v[210:211] op_sel_hi:[0,1,1]
    s_waitcnt lgkmcnt(0)
    v_cmp_ne_u32 vcc, 0, v246
    ds_add_u32 v220, v245 offset:28160
    buffer_load_dwordx4 v[12:15], v1, s[28:31], s71 offen offset:512 nt
    v_mov_b32_dpp v238, v240 row_newbcast:9 row_mask:0xf bank_mask:0xf
    s_waitcnt vmcnt(25)
    v_pk_fma_f32 v[200:201], v[238:239], v[16:17], v[200:201] op_sel_hi:[0,1,1]
    v_pk_fma_f32 v[202:203], v[238:239], v[18:19], v[202:203] op_sel_hi:[0,1,1]
    s_add_u32 s71, s71, 3072
    s_cbranch_vccnz L_th3_2
L_tb3_2:
    buffer_load_dwordx4 v[16:19], v1, s[28:31], s71 offen offset:0 nt
    s_cmp_eq_u32 s76, 1
    s_cselect_b64 exec, 1, 0
    ds_add_u32 v245, v245 offset:131
    s_mov_b64 exec, -1
    s_waitcnt vmcnt(25)
    v_pk_fma_f32 v[204:205], v[238:239], v[20:21], v[204:205] op_sel_hi:[0,1,1]
    v_pk_fma_f32 v[206:207], v[238:239], v[22:23], v[206:207] op_sel_hi:[0,1,1]
    buffer_load_dwordx4 v[20:23], v1, s[28:31], s71 offen offset:256 nt
    s_waitcnt vmcnt(25)
    v_pk_fma_f32 v[208:209], v[238:239], v[24:25], v[208:209] op_sel_hi:[0,1,1]
    v_pk_fma_f32 v[210:211], v[238:239], v[26:27], v[210:211] op_sel_hi:[0,1,1]
    ds_add_u32 v220, v245 offset:28160
    buffer_load_dwordx4 v[24:27], v1, s[28:31], s71 offen offset:512 nt
    v_mov_b32_dpp v238, v240 row_newbcast:5 row_mask:0xf bank_mask:0xf
    s_waitcnt vmcnt(25)
    v_pk_fma_f32 v[200:201], v[238:239], v[28:29], v[200:201] op_sel_hi:[0,1,1]
    v_pk_fma_f32 v[202:203], v[238:239], v[30:31], v[202:203] op_sel_hi:[0,1,1]
    s_add_u32 s71, s71, 3072
    s_cbranch_vccnz L_th6_2
L_tb6_2:
    buffer_load_dwordx4 v[28:31], v1, s[28:31], s71 offen offset:0 nt
    s_waitcnt vmcnt(25)
    v_pk_fma_f32 v[204:205], v[238:239], v[32:33], v[204:205] op_sel_hi:[0,1,1]
    v_pk_fma_f32 v[206:207], v[238:239], v[34:35], v[206:207] op_sel_hi:[0,1,1]
    buffer_load_dwordx4 v[32:35], v1, s[28:31], s71 offen offset:256 nt
    s_waitcnt vmcnt(25)
    v_pk_fma_f32 v[208:209], v[238:239], v[36:37], v[208:209] op_sel_hi:[0,1,1]
    v_pk_fma_f32 v[210:211], v[238:239], v[38:39], v[210:211] op_sel_hi:[0,1,1]
    ds_add_u32 v220, v245 offset:28160
    buffer_load_dwordx4 v[36:39], v1, s[28:31], s71 offen offset:512 nt
    v_mov_b32_dpp v238, v240 row_newbcast:13 row_mask:0xf bank_mask:0xf
    s_waitcnt vmcnt(25)
    v_pk_fma_f32 v[200:201], v[238:239], v[40:41], v[200:201] op_sel_hi:[0,1,1]
    v_pk_fma_f32 v[202:203], v[238:239], v[42:43], v[202:203] op_sel_hi:[0,1,1]
    s_add_u32 s71, s71, 3072
    s_cbranch_vccnz L_th9_2
L_tb9_2:
    buffer_load_dwordx4 v[40:43], v1, s[28:31], s71 offen offset:0 nt
    s_waitcnt vmcnt(25)
    v_pk_fma_f32 v[204:205], v[238:239], v[44:45], v[204:205] op_sel_hi:[0,1,1]
    v_pk_fma_f32 v[206:207], v[238:239], v[46:47], v[206:207] op_sel_hi:[0,1,1]
    buffer_load_dwordx4 v[44:47], v1, s[28:31], s71 offen offset:256 nt
    s_waitcnt vmcnt(25)
    v_pk_fma_f32 v[208:209], v[238:239], v[48:49], v[208:209] op_sel_hi:[0,1,1]
    v_pk_fma_f32 v[210:211], v[238:239], v[50:51], v[210:211] op_sel_hi:[0,1,1]
    ds_add_u32 v220, v245 offset:28160
    buffer_load_dwordx4 v[48:51], v1, s[28:31], s71 offen offset:512 nt
    v_mov_b32_dpp v238, v240 row_newbcast:3 row_mask:0xf bank_mask:0xf
    s_waitcnt vmcnt(25)
    v_pk_fma_f32 v[200:201], v[238:239], v[52:53], v[200:201] op_sel_hi:[0,1,1]
    v_pk_fma_f32 v[202:203], v[238:239], v[54:55], v[202:203] op_sel_hi:[0,1,1]
    ds_read_b32 v246, v245 offset:147
    s_add_u32 s71, s71, 777216
    s_cbranch_vccnz L_th12_2
L_tb12_2:
    buffer_load_dwordx4 v[52:55], v1, s[28:31], s71 offen offset:0 nt
    s_waitcnt vmcnt(25)
    v_pk_fma_f32 v[204:205], v[238:239], v[56:57], v[204:205] op_sel_hi:[0,1,1]
    v_pk_fma_f32 v[206:207], v[238:239], v[58:59], v[206:207] op_sel_hi:[0,1,1]
    buffer_load_dwordx4 v[56:59], v1, s[28:31], s71 offen offset:256 nt
    s_waitcnt vmcnt(25)
    v_pk_fma_f32 v[208:209], v[238:239], v[60:61], v[208:209] op_sel_hi:[0,1,1]
    v_pk_fma_f32 v[210:211], v[238:239], v[62:63], v[210:211] op_sel_hi:[0,1,1]
    s_waitcnt lgkmcnt(0)
    v_cmp_ne_u32 vcc, 0, v246
    ds_add_u32 v220, v245 offset:28160
    buffer_load_dwordx4 v[60:63], v1, s[28:31], s71 offen offset:512 nt
    v_mov_b32_dpp v238, v240 row_newbcast:11 row_mask:0xf bank_mask:0xf
    s_waitcnt vmcnt(25)
    v_pk_fma_f32 v[200:201], v[238:239], v[64:65], v[200:201] op_sel_hi:[0,1,1]
    v_pk_fma_f32 v[202:203], v[238:239], v[66:67], v[202:203] op_sel_hi:[0,1,1]
    s_add_u32 s71, s71, 3072
    s_cbranch_vccnz L_th15_2
L_tb15_2:
    buffer_load_dwordx4 v[64:67], v1, s[28:31], s71 offen offset:0 nt
    s_waitcnt vmcnt(25)
    v_pk_fma_f32 v[204:205], v[238:239], v[68:69], v[204:205] op_sel_hi:[0,1,1]
    v_pk_fma_f32 v[206:207], v[238:239], v[70:71], v[206:207] op_sel_hi:[0,1,1]
    buffer_load_dwordx4 v[68:71], v1, s[28:31], s71 offen offset:256 nt
    s_waitcnt vmcnt(25)
    v_pk_fma_f32 v[208:209], v[238:239], v[72:73], v[208:209] op_sel_hi:[0,1,1]
    v_pk_fma_f32 v[210:211], v[238:239], v[74:75], v[210:211] op_sel_hi:[0,1,1]
    ds_add_u32 v220, v245 offset:28160
    buffer_load_dwordx4 v[72:75], v1, s[28:31], s71 offen offset:512 nt
    v_mov_b32_dpp v238, v240 row_newbcast:7 row_mask:0xf bank_mask:0xf
    s_waitcnt vmcnt(25)
    v_pk_fma_f32 v[200:201], v[238:239], v[76:77], v[200:201] op_sel_hi:[0,1,1]
    v_pk_fma_f32 v[202:203], v[238:239], v[78:79], v[202:203] op_sel_hi:[0,1,1]
    s_add_u32 s71, s71, 3072
    s_cbranch_vccnz L_th18_2
L_tb18_2:
    buffer_load_dwordx4 v[76:79], v1, s[28:31], s71 offen offset:0 nt
    s_waitcnt vmcnt(25)
    v_pk_fma_f32 v[204:205], v[238:239], v[80:81], v[204:205] op_sel_hi:[0,1,1]
    v_pk_fma_f32 v[206:207], v[238:239], v[82:83], v[206:207] op_sel_hi:[0,1,1]
    buffer_load_dwordx4 v[80:83], v1, s[28:31], s71 offen offset:256 nt
    s_waitcnt vmcnt(25)
    v_pk_fma_f32 v[208:209], v[238:239], v[84:85], v[208:209] op_sel_hi:[0,1,1]
    v_pk_fma_f32 v[210:211], v[238:239], v[86:87], v[210:211] op_sel_hi:[0,1,1]
    ds_add_u32 v220, v245 offset:28160
    buffer_load_dwordx4 v[84:87], v1, s[28:31], s71 offen offset:512 nt
    v_mov_b32_dpp v238, v240 row_newbcast:15 row_mask:0xf bank_mask:0xf
    s_waitcnt vmcnt(25)
    v_pk_fma_f32 v[200:201], v[238:239], v[88:89], v[200:201] op_sel_hi:[0,1,1]
    v_pk_fma_f32 v[202:203], v[238:239], v[90:91], v[202:203] op_sel_hi:[0,1,1]
    s_add_u32 s71, s71, 3072
    s_cbranch_vccnz L_th21_2
L_tb21_2:
    buffer_load_dwordx4 v[88:91], v1, s[28:31], s71 offen offset:0 nt
    s_waitcnt vmcnt(25)
    v_pk_fma_f32 v[204:205], v[238:239], v[92:93], v[204:205] op_sel_hi:[0,1,1]
    v_pk_fma_f32 v[206:207], v[238:239], v[94:95], v[206:207] op_sel_hi:[0,1,1]
    buffer_load_dwordx4 v[92:95], v1, s[28:31], s71 offen offset:256 nt
    s_waitcnt vmcnt(25)
    v_pk_fma_f32 v[208:209], v[238:239], v[96:97], v[208:209] op_sel_hi:[0,1,1]
    v_pk_fma_f32 v[210:211], v[238:239], v[98:99], v[210:211] op_sel_hi:[0,1,1]
    ds_add_u32 v220, v245 offset:28160
    buffer_load_dwordx4 v[96:99], v1, s[28:31], s71 offen offset:512 nt
    s_sub_u32 s77, s77, 1
    s_cmp_lg_u32 s77, 0
    s_cbranch_scc1 L_nofl2
    s_nop 0
    v_add_f32_dpp v213, v213, v213 row_ror:8 row_mask:0xf bank_mask:0xf
    v_add_f32_dpp v214, v214, v214 row_ror:8 row_mask:0xf bank_mask:0xf
    s_nop 0
    v_add_f32_dpp v213, v213, v213 row_ror:4 row_mask:0xf bank_mask:0xf
    v_add_f32_dpp v214, v214, v214 row_ror:4 row_mask:0xf bank_mask:0xf
    s_nop 0
    v_add_f32_dpp v213, v213, v213 row_ror:2 row_mask:0xf bank_mask:0xf
    v_add_f32_dpp v214, v214, v214 row_ror:2 row_mask:0xf bank_mask:0xf
    s_nop 0
    v_add_f32_dpp v213, v213, v213 row_ror:1 row_mask:0xf bank_mask:0xf
    v_add_f32_dpp v214, v214, v214 row_ror:1 row_mask:0xf bank_mask:0xf
    v_mov_b32 v230, v212
    v_mov_b32 v231, v212
    s_nop 1
    v_permlane32_swap_b32 v230, v231
    s_nop 1
    v_max_f32 v230, v230, v231
    v_mov_b32 v231, v230
    s_nop 1
    v_permlane16_swap_b32 v230, v231
    s_nop 1
    v_max_f32 v230, v230, v231
    v_sub_f32 v231, v212, v230
    v_exp_f32 v231, v231
    v_mov_b32 v104, v230
    v_mul_f32 v213, v213, v231
    v_mul_f32 v214, v214, v231
    v_mul_f32 v231, 0x58000000, v231
    v_fma_f32 v200, v200, v231, -v214
    v_fma_f32 v201, v201, v231, -v214
    v_fma_f32 v202, v202, v231, -v214
    v_fma_f32 v203, v203, v231, -v214
    v_fma_f32 v204, v204, v231, -v214
    v_fma_f32 v205, v205, v231, -v214
    v_fma_f32 v206, v206, v231, -v214
    v_fma_f32 v207, v207, v231, -v214
    v_fma_f32 v208, v208, v231, -v214
    v_fma_f32 v209, v209, v231, -v214
    v_fma_f32 v210, v210, v231, -v214
    v_fma_f32 v211, v211, v231, -v214
    v_mov_b32 v230, v213
    s_nop 1
    v_permlane32_swap_b32 v213, v230
    v_permlane32_swap_b32 v200, v202
    v_permlane32_swap_b32 v201, v203
    v_permlane32_swap_b32 v204, v206
    v_permlane32_swap_b32 v205, v207
    v_permlane32_swap_b32 v208, v210
    v_permlane32_swap_b32 v209, v211
    s_nop 1
    v_add_f32 v213, v213, v230
    v_add_f32 v200, v200, v202
    v_add_f32 v201, v201, v203
    v_add_f32 v204, v204, v206
    v_add_f32 v205, v205, v207
    v_add_f32 v208, v208, v210
    v_add_f32 v209, v209, v211
    v_mov_b32 v230, v213
    s_nop 1
    v_permlane16_swap_b32 v213, v230
    v_permlane16_swap_b32 v200, v201
    v_permlane16_swap_b32 v204, v205
    v_permlane16_swap_b32 v208, v209
    s_nop 1
    v_add_f32 v105, v213, v230
    v_add_f32 v100, v200, v201
    v_add_f32 v101, v204, v205
    v_add_f32 v102, v208, v209
    v_cndmask_b32 v103, v104, v105, s[66:67]
    ds_write_b128 v243, v[100:103] offset:3328
    v_mov_b32 v212, 0xf149f2ca
    v_mov_b32 v213, 0
    v_mov_b32 v214, 0
    v_mov_b32 v200, 0
    v_mov_b32 v201, 0
    v_mov_b32 v202, 0
    v_mov_b32 v203, 0
    v_mov_b32 v204, 0
    v_mov_b32 v205, 0
    v_mov_b32 v206, 0
    v_mov_b32 v207, 0
    v_mov_b32 v208, 0
    v_mov_b32 v209, 0
    v_mov_b32 v210, 0
    v_mov_b32 v211, 0
    s_waitcnt lgkmcnt(0)
    s_mov_b64 exec, 1
    ds_add_u32 v244, v245
    s_mov_b64 exec, -1
    v_add_u32 v243, 1024, v243
    v_add_u32 v244, 4, v244
    s_mov_b32 s77, 8
L_nofl2:
    s_sub_u32 s76, s76, 1
    s_cmp_lg_u32 s76, 0
    s_cbranch_scc1 L_loop1
L_tagw:
    ds_read_b32 v223, v245 offset:139
    s_waitcnt lgkmcnt(0)
    v_readfirstlane_b32 s93, v223
    s_cmp_eq_u32 s93, 0
    s_cbranch_scc1 L_tagw
    s_waitcnt vmcnt(24)
    v_lshlrev_b32 v216, 16, v216
    v_lshlrev_b32 v217, 16, v217
    s_waitcnt lgkmcnt(0)
    v_max_f32_dpp v230, v219, v219 row_ror:8 row_mask:0xf bank_mask:0xf
    s_nop 1
    v_max_f32_dpp v230, v230, v230 row_ror:4 row_mask:0xf bank_mask:0xf
    s_nop 1
    v_max_f32_dpp v230, v230, v230 row_ror:2 row_mask:0xf bank_mask:0xf
    s_nop 1
    v_max_f32_dpp v230, v230, v230 row_ror:1 row_mask:0xf bank_mask:0xf
    v_max_f32 v230, v230, v212
    v_sub_f32 v231, v212, v230
    v_sub_f32 v218, v219, v230
    v_exp_f32 v231, v231
    v_exp_f32 v218, v218
    v_mov_b32 v212, v230
    v_fma_f32 v213, v213, v231, v218
    v_mul_f32 v218, v218, v216
    v_mul_f32 v214, v214, v231
    v_mul_f32 v240, 0x71800000, v218
    v_fmac_f32 v214, v218, v217
    v_pk_mul_f32 v[200:201], v[200:201], v[230:231] op_sel:[0,1] op_sel_hi:[1,1]
    v_pk_mul_f32 v[202:203], v[202:203], v[230:231] op_sel:[0,1] op_sel_hi:[1,1]
    v_pk_mul_f32 v[204:205], v[204:205], v[230:231] op_sel:[0,1] op_sel_hi:[1,1]
    v_pk_mul_f32 v[206:207], v[206:207], v[230:231] op_sel:[0,1] op_sel_hi:[1,1]
    v_pk_mul_f32 v[208:209], v[208:209], v[230:231] op_sel:[0,1] op_sel_hi:[1,1]
    v_pk_mul_f32 v[210:211], v[210:211], v[230:231] op_sel:[0,1] op_sel_hi:[1,1]
    v_mov_b32_dpp v238, v240 row_newbcast:0 row_mask:0xf bank_mask:0xf
    s_waitcnt vmcnt(23)
    v_pk_fma_f32 v[200:201], v[238:239], v[4:5], v[200:201] op_sel_hi:[0,1,1]
    v_pk_fma_f32 v[202:203], v[238:239], v[6:7], v[202:203] op_sel_hi:[0,1,1]
    ds_read_b32 v246, v245 offset:147
    s_add_u32 s71, s71, 777216
    s_cbranch_vccnz L_th24_3
L_tb24_3:
    buffer_load_dwordx4 v[4:7], v1, s[28:31], s71 offen offset:0 nt
    s_waitcnt vmcnt(23)
    v_pk_fma_f32 v[204:205], v[238:239], v[8:9], v[204:205] op_sel_hi:[0,1,1]
    v_pk_fma_f32 v[206:207], v[238:239], v[10:11], v[206:207] op_sel_hi:[0,1,1]
    buffer_load_dwordx4 v[8:11], v1, s[28:31], s71 offen offset:256 nt
    s_waitcnt vmcnt(23)
    v_pk_fma_f32 v[208:209], v[238:239], v[12:13], v[208:209] op_sel_hi:[0,1,1]
    v_pk_fma_f32 v[210:211], v[238:239], v[14:15], v[210:211] op_sel_hi:[0,1,1]
    s_waitcnt lgkmcnt(0)
    v_cmp_ne_u32 vcc, 0, v246
    ds_add_u32 v220, v245 offset:28160
    buffer_load_dwordx4 v[12:15], v1, s[28:31], s71 offen offset:512 nt
    v_mov_b32_dpp v238, v240 row_newbcast:8 row_mask:0xf bank_mask:0xf
    s_waitcnt vmcnt(23)
    v_pk_fma_f32 v[200:201], v[238:239], v[16:17], v[200:201] op_sel_hi:[0,1,1]
    v_pk_fma_f32 v[202:203], v[238:239], v[18:19], v[202:203] op_sel_hi:[0,1,1]
    s_add_u32 s71, s71, 3072
    s_cbranch_vccnz L_th27_3
L_tb27_3:
    buffer_load_dwordx4 v[16:19], v1, s[28:31], s71 offen offset:0 nt
    s_waitcnt vmcnt(23)
    v_pk_fma_f32 v[204:205], v[238:239], v[20:21], v[204:205] op_sel_hi:[0,1,1]
    v_pk_fma_f32 v[206:207], v[238:239], v[22:23], v[206:207] op_sel_hi:[0,1,1]
    buffer_load_dwordx4 v[20:23], v1, s[28:31], s71 offen offset:256 nt
    s_waitcnt vmcnt(23)
    v_pk_fma_f32 v[208:209], v[238:239], v[24:25], v[208:209] op_sel_hi:[0,1,1]
    v_pk_fma_f32 v[210:211], v[238:239], v[26:27], v[210:211] op_sel_hi:[0,1,1]
    ds_add_u32 v220, v245 offset:28160
    buffer_load_dwordx4 v[24:27], v1, s[28:31], s71 offen offset:512 nt
    v_mov_b32_dpp v238, v240 row_newbcast:4 row_mask:0xf bank_mask:0xf
    s_waitcnt vmcnt(23)
    v_pk_fma_f32 v[200:201], v[238:239], v[28:29], v[200:201] op_sel_hi:[0,1,1]
    v_pk_fma_f32 v[202:203], v[238:239], v[30:31], v[202:203] op_sel_hi:[0,1,1]
    s_add_u32 s71, s71, 3072
    s_cbranch_vccnz L_th30_3
L_tb30_3:
    buffer_load_dwordx4 v[28:31], v1, s[28:31], s71 offen offset:0 nt
    s_waitcnt vmcnt(23)
    v_pk_fma_f32 v[204:205], v[238:239], v[32:33], v[204:205] op_sel_hi:[0,1,1]
    v_pk_fma_f32 v[206:207], v[238:239], v[34:35], v[206:207] op_sel_hi:[0,1,1]
    buffer_load_dwordx4 v[32:35], v1, s[28:31], s71 offen offset:256 nt
    s_waitcnt vmcnt(23)
    v_pk_fma_f32 v[208:209], v[238:239], v[36:37], v[208:209] op_sel_hi:[0,1,1]
    v_pk_fma_f32 v[210:211], v[238:239], v[38:39], v[210:211] op_sel_hi:[0,1,1]
    ds_add_u32 v220, v245 offset:28160
    buffer_load_dwordx4 v[36:39], v1, s[28:31], s71 offen offset:512 nt
    v_mov_b32_dpp v238, v240 row_newbcast:12 row_mask:0xf bank_mask:0xf
    s_waitcnt vmcnt(23)
    v_pk_fma_f32 v[200:201], v[238:239], v[40:41], v[200:201] op_sel_hi:[0,1,1]
    v_pk_fma_f32 v[202:203], v[238:239], v[42:43], v[202:203] op_sel_hi:[0,1,1]
    s_add_u32 s71, s71, 3072
    s_cbranch_vccnz L_th33_3
L_tb33_3:
    buffer_load_dwordx4 v[40:43], v1, s[28:31], s71 offen offset:0 nt
    s_waitcnt vmcnt(23)
    v_pk_fma_f32 v[204:205], v[238:239], v[44:45], v[204:205] op_sel_hi:[0,1,1]
    v_pk_fma_f32 v[206:207], v[238:239], v[46:47], v[206:207] op_sel_hi:[0,1,1]
    buffer_load_dwordx4 v[44:47], v1, s[28:31], s71 offen offset:256 nt
    s_waitcnt vmcnt(23)
    v_pk_fma_f32 v[208:209], v[238:239], v[48:49], v[208:209] op_sel_hi:[0,1,1]
    v_pk_fma_f32 v[210:211], v[238:239], v[50:51], v[210:211] op_sel_hi:[0,1,1]
    ds_add_u32 v220, v245 offset:28160
    buffer_load_dwordx4 v[48:51], v1, s[28:31], s71 offen offset:512 nt
    v_mov_b32_dpp v238, v240 row_newbcast:2 row_mask:0xf bank_mask:0xf
    s_waitcnt vmcnt(23)
    v_pk_fma_f32 v[200:201], v[238:239], v[52:53], v[200:201] op_sel_hi:[0,1,1]
    v_pk_fma_f32 v[202:203], v[238:239], v[54:55], v[202:203] op_sel_hi:[0,1,1]
    ds_read_b32 v246, v245 offset:147
    s_add_u32 s71, s71, 777216
    s_cbranch_vccnz L_th36_3
L_tb36_3:
    buffer_load_dwordx4 v[52:55], v1, s[28:31], s71 offen offset:0 nt
    s_waitcnt vmcnt(23)
    v_pk_fma_f32 v[204:205], v[238:239], v[56:57], v[204:205] op_sel_hi:[0,1,1]
    v_pk_fma_f32 v[206:207], v[238:239], v[58:59], v[206:207] op_sel_hi:[0,1,1]
    buffer_load_dwordx4 v[56:59], v1, s[28:31], s71 offen offset:256 nt
    s_waitcnt vmcnt(23)
    v_pk_fma_f32 v[208:209], v[238:239], v[60:61], v[208:209] op_sel_hi:[0,1,1]
    v_pk_fma_f32 v[210:211], v[238:239], v[62:63], v[210:211] op_sel_hi:[0,1,1]
    s_waitcnt lgkmcnt(0)
    v_cmp_ne_u32 vcc, 0, v246
    ds_add_u32 v220, v245 offset:28160
    buffer_load_dwordx4 v[60:63], v1, s[28:31], s71 offen offset:512 nt
    v_mov_b32_dpp v238, v240 row_newbcast:10 row_mask:0xf bank_mask:0xf
    s_waitcnt vmcnt(23)
    v_pk_fma_f32 v[200:201], v[238:239], v[64:65], v[200:201] op_sel_hi:[0,1,1]
    v_pk_fma_f32 v[202:203], v[238:239], v[66:67], v[202:203] op_sel_hi:[0,1,1]
    s_add_u32 s71, s71, 3072
    s_cbranch_vccnz L_th39_3
L_tb39_3:
    buffer_load_dwordx4 v[64:67], v1, s[28:31], s71 offen offset:0 nt
    s_waitcnt vmcnt(23)
    v_pk_fma_f32 v[204:205], v[238:239], v[68:69], v[204:205] op_sel_hi:[0,1,1]
    v_pk_fma_f32 v[206:207], v[238:239], v[70:71], v[206:207] op_sel_hi:[0,1,1]
    buffer_load_dwordx4 v[68:71], v1, s[28:31], s71 offen offset:256 nt
    s_waitcnt vmcnt(23)
    v_pk_fma_f32 v[208:209], v[238:239], v[72:73], v[208:209] op_sel_hi:[0,1,1]
    v_pk_fma_f32 v[210:211], v[238:239], v[74:75], v[210:211] op_sel_hi:[0,1,1]
    ds_add_u32 v220, v245 offset:28160
    buffer_load_dwordx4 v[72:75], v1, s[28:31], s71 offen offset:512 nt
    v_mov_b32_dpp v238, v240 row_newbcast:6 row_mask:0xf bank_mask:0xf
    s_waitcnt vmcnt(23)
    v_pk_fma_f32 v[200:201], v[238:239], v[76:77], v[200:201] op_sel_hi:[0,1,1]
    v_pk_fma_f32 v[202:203], v[238:239], v[78:79], v[202:203] op_sel_hi:[0,1,1]
    s_add_u32 s71, s71, 3072
    s_cbranch_vccnz L_th42_3
L_tb42_3:
    buffer_load_dwordx4 v[76:79], v1, s[28:31], s71 offen offset:0 nt
    s_waitcnt vmcnt(23)
    v_pk_fma_f32 v[204:205], v[238:239], v[80:81], v[204:205] op_sel_hi:[0,1,1]
    v_pk_fma_f32 v[206:207], v[238:239], v[82:83], v[206:207] op_sel_hi:[0,1,1]
    buffer_load_dwordx4 v[80:83], v1, s[28:31], s71 offen offset:256 nt
    s_waitcnt vmcnt(23)
    v_pk_fma_f32 v[208:209], v[238:239], v[84:85], v[208:209] op_sel_hi:[0,1,1]
    v_pk_fma_f32 v[210:211], v[238:239], v[86:87], v[210:211] op_sel_hi:[0,1,1]
    ds_add_u32 v220, v245 offset:28160
    buffer_load_dwordx4 v[84:87], v1, s[28:31], s71 offen offset:512 nt
    v_mov_b32_dpp v238, v240 row_newbcast:14 row_mask:0xf bank_mask:0xf
    s_waitcnt vmcnt(23)
    v_pk_fma_f32 v[200:201], v[238:239], v[88:89], v[200:201] op_sel_hi:[0,1,1]
    v_pk_fma_f32 v[202:203], v[238:239], v[90:91], v[202:203] op_sel_hi:[0,1,1]
    s_add_u32 s71, s71, 3072
    s_cbranch_vccnz L_th45_3
L_tb45_3:
    buffer_load_dwordx4 v[88:91], v1, s[28:31], s71 offen offset:0 nt
    ds_read_b32 v223, v222
    s_waitcnt vmcnt(23)
    v_pk_fma_f32 v[204:205], v[238:239], v[92:93], v[204:205] op_sel_hi:[0,1,1]
    v_pk_fma_f32 v[206:207], v[238:239], v[94:95], v[206:207] op_sel_hi:[0,1,1]
    buffer_load_dwordx4 v[92:95], v1, s[28:31], s71 offen offset:256 nt
    s_waitcnt vmcnt(23)
    v_pk_fma_f32 v[208:209], v[238:239], v[96:97], v[208:209] op_sel_hi:[0,1,1]
    v_pk_fma_f32 v[210:211], v[238:239], v[98:99], v[210:211] op_sel_hi:[0,1,1]
    ds_add_u32 v220, v245 offset:28160
    buffer_load_dwordx4 v[96:99], v1, s[28:31], s71 offen offset:512 nt
    s_waitcnt lgkmcnt(0)
    v_readfirstlane_b32 s80, v223
    s_cmp_lg_u32 s80, -1
    s_cbranch_scc1 L_tkoks
L_tkws:
    ds_read_b32 v223, v222
    s_waitcnt lgkmcnt(0)
    v_readfirstlane_b32 s80, v223
    s_cmp_eq_u32 s80, -1
    s_cbranch_scc1 L_tkws
L_tkoks:
    v_add_u32 v222, 4, v222
    s_cmp_ge_u32 s80, 256
    s_cbranch_scc1 L_dtail
    s_lshr_b32 s81, s80, 6
    s_and_b32 s80, s80, 63
    s_mul_i32 s56, s81, 64
    s_add_u32 s56, s56, s80
    s_add_u32 s56, s56, s94
    s_and_b32 s56, s56, 511
    s_mov_b32 s57, s59
    s_add_u32 s70, s57, s56
    s_and_b32 s95, s3, 192
    s_add_u32 s95, s95, s80
    s_lshl_b32 s95, s95, 3
    s_add_u32 s95, s95, s81
    s_lshl_b32 s95, s95, 8
    s_add_u32 s95, s95, 18874368
    v_mov_b32_dpp v238, v240 row_newbcast:1 row_mask:0xf bank_mask:0xf
    s_waitcnt vmcnt(23)
    v_pk_fma_f32 v[200:201], v[238:239], v[4:5], v[200:201] op_sel_hi:[0,1,1]
    v_pk_fma_f32 v[202:203], v[238:239], v[6:7], v[202:203] op_sel_hi:[0,1,1]
    ds_read_b32 v246, v245 offset:147
    s_and_b32 s80, s70, 63
    s_mul_i32 s80, s80, 96
    s_lshl_b32 s73, s70, 7
    s_sub_u32 s73, s73, s80
    buffer_load_dword v219, v220, s[52:55], s95 offen sc0 sc1
    buffer_load_ushort v216, v3, s[40:43], s73 offen
    buffer_load_ushort v217, v3, s[44:47], s73 offen
    s_mul_i32 s71, s70, 49152
    s_and_b32 s80, s70, 63
    s_mul_i32 s80, s80, 36864
    s_sub_u32 s71, s71, s80
    s_cbranch_vccnz L_th0_3
L_tb0_3:
    buffer_load_dwordx4 v[4:7], v1, s[28:31], s71 offen offset:0 nt
    s_waitcnt vmcnt(26)
    v_pk_fma_f32 v[204:205], v[238:239], v[8:9], v[204:205] op_sel_hi:[0,1,1]
    v_pk_fma_f32 v[206:207], v[238:239], v[10:11], v[206:207] op_sel_hi:[0,1,1]
    buffer_load_dwordx4 v[8:11], v1, s[28:31], s71 offen offset:256 nt
    s_waitcnt vmcnt(26)
    v_pk_fma_f32 v[208:209], v[238:239], v[12:13], v[208:209] op_sel_hi:[0,1,1]
    v_pk_fma_f32 v[210:211], v[238:239], v[14:15], v[210:211] op_sel_hi:[0,1,1]
    s_waitcnt lgkmcnt(0)
    v_cmp_ne_u32 vcc, 0, v246
    ds_add_u32 v220, v245 offset:28160
    buffer_load_dwordx4 v[12:15], v1, s[28:31], s71 offen offset:512 nt
    v_mov_b32_dpp v238, v240 row_newbcast:9 row_mask:0xf bank_mask:0xf
    s_waitcnt vmcnt(26)
    v_pk_fma_f32 v[200:201], v[238:239], v[16:17], v[200:201] op_sel_hi:[0,1,1]
    v_pk_fma_f32 v[202:203], v[238:239], v[18:19], v[202:203] op_sel_hi:[0,1,1]
    s_add_u32 s71, s71, 3072
    s_cbranch_vccnz L_th3_3
L_tb3_3:
    buffer_load_dwordx4 v[16:19], v1, s[28:31], s71 offen offset:0 nt
    s_mov_b64 exec, 1
    ds_add_u32 v245, v245 offset:131
    s_mov_b64 exec, -1
    s_waitcnt vmcnt(26)
    v_pk_fma_f32 v[204:205], v[238:239], v[20:21], v[204:205] op_sel_hi:[0,1,1]
    v_pk_fma_f32 v[206:207], v[238:239], v[22:23], v[206:207] op_sel_hi:[0,1,1]
    buffer_load_dwordx4 v[20:23], v1, s[28:31], s71 offen offset:256 nt
    s_waitcnt vmcnt(26)
    v_pk_fma_f32 v[208:209], v[238:239], v[24:25], v[208:209] op_sel_hi:[0,1,1]
    v_pk_fma_f32 v[210:211], v[238:239], v[26:27], v[210:211] op_sel_hi:[0,1,1]
    ds_add_u32 v220, v245 offset:28160
    buffer_load_dwordx4 v[24:27], v1, s[28:31], s71 offen offset:512 nt
    v_mov_b32_dpp v238, v240 row_newbcast:5 row_mask:0xf bank_mask:0xf
    s_waitcnt vmcnt(26)
    v_pk_fma_f32 v[200:201], v[238:239], v[28:29], v[200:201] op_sel_hi:[0,1,1]
    v_pk_fma_f32 v[202:203], v[238:239], v[30:31], v[202:203] op_sel_hi:[0,1,1]
    s_add_u32 s71, s71, 3072
    s_cbranch_vccnz L_th6_3
L_tb6_3:
    buffer_load_dwordx4 v[28:31], v1, s[28:31], s71 offen offset:0 nt
    s_waitcnt vmcnt(26)
    v_pk_fma_f32 v[204:205], v[238:239], v[32:33], v[204:205] op_sel_hi:[0,1,1]
    v_pk_fma_f32 v[206:207], v[238:239], v[34:35], v[206:207] op_sel_hi:[0,1,1]
    buffer_load_dwordx4 v[32:35], v1, s[28:31], s71 offen offset:256 nt
    s_waitcnt vmcnt(26)
    v_pk_fma_f32 v[208:209], v[238:239], v[36:37], v[208:209] op_sel_hi:[0,1,1]
    v_pk_fma_f32 v[210:211], v[238:239], v[38:39], v[210:211] op_sel_hi:[0,1,1]
    ds_add_u32 v220, v245 offset:28160
    buffer_load_dwordx4 v[36:39], v1, s[28:31], s71 offen offset:512 nt
    v_mov_b32_dpp v238, v240 row_newbcast:13 row_mask:0xf bank_mask:0xf
    s_waitcnt vmcnt(26)
    v_pk_fma_f32 v[200:201], v[238:239], v[40:41], v[200:201] op_sel_hi:[0,1,1]
    v_pk_fma_f32 v[202:203], v[238:239], v[42:43], v[202:203] op_sel_hi:[0,1,1]
    s_add_u32 s71, s71, 3072
    s_cbranch_vccnz L_th9_3
L_tb9_3:
    buffer_load_dwordx4 v[40:43], v1, s[28:31], s71 offen offset:0 nt
    s_waitcnt vmcnt(26)
    v_pk_fma_f32 v[204:205], v[238:239], v[44:45], v[204:205] op_sel_hi:[0,1,1]
    v_pk_fma_f32 v[206:207], v[238:239], v[46:47], v[206:207] op_sel_hi:[0,1,1]
    buffer_load_dwordx4 v[44:47], v1, s[28:31], s71 offen offset:256 nt
    s_waitcnt vmcnt(26)
    v_pk_fma_f32 v[208:209], v[238:239], v[48:49], v[208:209] op_sel_hi:[0,1,1]
    v_pk_fma_f32 v[210:211], v[238:239], v[50:51], v[210:211] op_sel_hi:[0,1,1]
    ds_add_u32 v220, v245 offset:28160
    buffer_load_dwordx4 v[48:51], v1, s[28:31], s71 offen offset:512 nt
    v_mov_b32_dpp v238, v240 row_newbcast:3 row_mask:0xf bank_mask:0xf
    s_waitcnt vmcnt(26)
    v_pk_fma_f32 v[200:201], v[238:239], v[52:53], v[200:201] op_sel_hi:[0,1,1]
    v_pk_fma_f32 v[202:203], v[238:239], v[54:55], v[202:203] op_sel_hi:[0,1,1]
    ds_read_b32 v246, v245 offset:147
    s_add_u32 s71, s71, 777216
    s_cbranch_vccnz L_th12_3
L_tb12_3:
    buffer_load_dwordx4 v[52:55], v1, s[28:31], s71 offen offset:0 nt
    s_waitcnt vmcnt(26)
    v_pk_fma_f32 v[204:205], v[238:239], v[56:57], v[204:205] op_sel_hi:[0,1,1]
    v_pk_fma_f32 v[206:207], v[238:239], v[58:59], v[206:207] op_sel_hi:[0,1,1]
    buffer_load_dwordx4 v[56:59], v1, s[28:31], s71 offen offset:256 nt
    s_waitcnt vmcnt(26)
    v_pk_fma_f32 v[208:209], v[238:239], v[60:61], v[208:209] op_sel_hi:[0,1,1]
    v_pk_fma_f32 v[210:211], v[238:239], v[62:63], v[210:211] op_sel_hi:[0,1,1]
    s_waitcnt lgkmcnt(0)
    v_cmp_ne_u32 vcc, 0, v246
    ds_add_u32 v220, v245 offset:28160
    buffer_load_dwordx4 v[60:63], v1, s[28:31], s71 offen offset:512 nt
    v_mov_b32_dpp v238, v240 row_newbcast:11 row_mask:0xf bank_mask:0xf
    s_waitcnt vmcnt(26)
    v_pk_fma_f32 v[200:201], v[238:239], v[64:65], v[200:201] op_sel_hi:[0,1,1]
    v_pk_fma_f32 v[202:203], v[238:239], v[66:67], v[202:203] op_sel_hi:[0,1,1]
    s_add_u32 s71, s71, 3072
    s_cbranch_vccnz L_th15_3
L_tb15_3:
    buffer_load_dwordx4 v[64:67], v1, s[28:31], s71 offen offset:0 nt
    s_waitcnt vmcnt(26)
    v_pk_fma_f32 v[204:205], v[238:239], v[68:69], v[204:205] op_sel_hi:[0,1,1]
    v_pk_fma_f32 v[206:207], v[238:239], v[70:71], v[206:207] op_sel_hi:[0,1,1]
    buffer_load_dwordx4 v[68:71], v1, s[28:31], s71 offen offset:256 nt
    s_waitcnt vmcnt(26)
    v_pk_fma_f32 v[208:209], v[238:239], v[72:73], v[208:209] op_sel_hi:[0,1,1]
    v_pk_fma_f32 v[210:211], v[238:239], v[74:75], v[210:211] op_sel_hi:[0,1,1]
    ds_add_u32 v220, v245 offset:28160
    buffer_load_dwordx4 v[72:75], v1, s[28:31], s71 offen offset:512 nt
    v_mov_b32_dpp v238, v240 row_newbcast:7 row_mask:0xf bank_mask:0xf
    s_waitcnt vmcnt(26)
    v_pk_fma_f32 v[200:201], v[238:239], v[76:77], v[200:201] op_sel_hi:[0,1,1]
    v_pk_fma_f32 v[202:203], v[238:239], v[78:79], v[202:203] op_sel_hi:[0,1,1]
    s_add_u32 s71, s71, 3072
    s_cbranch_vccnz L_th18_3
L_tb18_3:
    buffer_load_dwordx4 v[76:79], v1, s[28:31], s71 offen offset:0 nt
    s_waitcnt vmcnt(26)
    v_pk_fma_f32 v[204:205], v[238:239], v[80:81], v[204:205] op_sel_hi:[0,1,1]
    v_pk_fma_f32 v[206:207], v[238:239], v[82:83], v[206:207] op_sel_hi:[0,1,1]
    buffer_load_dwordx4 v[80:83], v1, s[28:31], s71 offen offset:256 nt
    s_waitcnt vmcnt(26)
    v_pk_fma_f32 v[208:209], v[238:239], v[84:85], v[208:209] op_sel_hi:[0,1,1]
    v_pk_fma_f32 v[210:211], v[238:239], v[86:87], v[210:211] op_sel_hi:[0,1,1]
    ds_add_u32 v220, v245 offset:28160
    buffer_load_dwordx4 v[84:87], v1, s[28:31], s71 offen offset:512 nt
    v_mov_b32_dpp v238, v240 row_newbcast:15 row_mask:0xf bank_mask:0xf
    s_waitcnt vmcnt(26)
    v_pk_fma_f32 v[200:201], v[238:239], v[88:89], v[200:201] op_sel_hi:[0,1,1]
    v_pk_fma_f32 v[202:203], v[238:239], v[90:91], v[202:203] op_sel_hi:[0,1,1]
    s_add_u32 s71, s71, 3072
    s_cbranch_vccnz L_th21_3
L_tb21_3:
    buffer_load_dwordx4 v[88:91], v1, s[28:31], s71 offen offset:0 nt
    s_waitcnt vmcnt(26)
    v_pk_fma_f32 v[204:205], v[238:239], v[92:93], v[204:205] op_sel_hi:[0,1,1]
    v_pk_fma_f32 v[206:207], v[238:239], v[94:95], v[206:207] op_sel_hi:[0,1,1]
    buffer_load_dwordx4 v[92:95], v1, s[28:31], s71 offen offset:256 nt
    s_waitcnt vmcnt(26)
    v_pk_fma_f32 v[208:209], v[238:239], v[96:97], v[208:209] op_sel_hi:[0,1,1]
    v_pk_fma_f32 v[210:211], v[238:239], v[98:99], v[210:211] op_sel_hi:[0,1,1]
    ds_add_u32 v220, v245 offset:28160
    buffer_load_dwordx4 v[96:99], v1, s[28:31], s71 offen offset:512 nt
    s_sub_u32 s77, s77, 1
    s_cmp_lg_u32 s77, 0
    s_cbranch_scc1 L_nofl3
    s_nop 0
    v_add_f32_dpp v213, v213, v213 row_ror:8 row_mask:0xf bank_mask:0xf
    v_add_f32_dpp v214, v214, v214 row_ror:8 row_mask:0xf bank_mask:0xf
    s_nop 0
    v_add_f32_dpp v213, v213, v213 row_ror:4 row_mask:0xf bank_mask:0xf
    v_add_f32_dpp v214, v214, v214 row_ror:4 row_mask:0xf bank_mask:0xf
    s_nop 0
    v_add_f32_dpp v213, v213, v213 row_ror:2 row_mask:0xf bank_mask:0xf
    v_add_f32_dpp v214, v214, v214 row_ror:2 row_mask:0xf bank_mask:0xf
    s_nop 0
    v_add_f32_dpp v213, v213, v213 row_ror:1 row_mask:0xf bank_mask:0xf
    v_add_f32_dpp v214, v214, v214 row_ror:1 row_mask:0xf bank_mask:0xf
    v_mov_b32 v230, v212
    v_mov_b32 v231, v212
    s_nop 1
    v_permlane32_swap_b32 v230, v231
    s_nop 1
    v_max_f32 v230, v230, v231
    v_mov_b32 v231, v230
    s_nop 1
    v_permlane16_swap_b32 v230, v231
    s_nop 1
    v_max_f32 v230, v230, v231
    v_sub_f32 v231, v212, v230
    v_exp_f32 v231, v231
    v_mov_b32 v104, v230
    v_mul_f32 v213, v213, v231
    v_mul_f32 v214, v214, v231
    v_mul_f32 v231, 0x58000000, v231
    v_fma_f32 v200, v200, v231, -v214
    v_fma_f32 v201, v201, v231, -v214
    v_fma_f32 v202, v202, v231, -v214
    v_fma_f32 v203, v203, v231, -v214
    v_fma_f32 v204, v204, v231, -v214
    v_fma_f32 v205, v205, v231, -v214
    v_fma_f32 v206, v206, v231, -v214
    v_fma_f32 v207, v207, v231, -v214
    v_fma_f32 v208, v208, v231, -v214
    v_fma_f32 v209, v209, v231, -v214
    v_fma_f32 v210, v210, v231, -v214
    v_fma_f32 v211, v211, v231, -v214
    v_mov_b32 v230, v213
    s_nop 1
    v_permlane32_swap_b32 v213, v230
    v_permlane32_swap_b32 v200, v202
    v_permlane32_swap_b32 v201, v203
    v_permlane32_swap_b32 v204, v206
    v_permlane32_swap_b32 v205, v207
    v_permlane32_swap_b32 v208, v210
    v_permlane32_swap_b32 v209, v211
    s_nop 1
    v_add_f32 v213, v213, v230
    v_add_f32 v200, v200, v202
    v_add_f32 v201, v201, v203
    v_add_f32 v204, v204, v206
    v_add_f32 v205, v205, v207
    v_add_f32 v208, v208, v210
    v_add_f32 v209, v209, v211
    v_mov_b32 v230, v213
    s_nop 1
    v_permlane16_swap_b32 v213, v230
    v_permlane16_swap_b32 v200, v201
    v_permlane16_swap_b32 v204, v205
    v_permlane16_swap_b32 v208, v209
    s_nop 1
    v_add_f32 v105, v213, v230
    v_add_f32 v100, v200, v201
    v_add_f32 v101, v204, v205
    v_add_f32 v102, v208, v209
    v_cndmask_b32 v103, v104, v105, s[66:67]
    ds_write_b128 v243, v[100:103] offset:3328
    v_mov_b32 v212, 0xf149f2ca
    v_mov_b32 v213, 0
    v_mov_b32 v214, 0
    v_mov_b32 v200, 0
    v_mov_b32 v201, 0
    v_mov_b32 v202, 0
    v_mov_b32 v203, 0
    v_mov_b32 v204, 0
    v_mov_b32 v205, 0
    v_mov_b32 v206, 0
    v_mov_b32 v207, 0
    v_mov_b32 v208, 0
    v_mov_b32 v209, 0
    v_mov_b32 v210, 0
    v_mov_b32 v211, 0
    s_waitcnt lgkmcnt(0)
    s_mov_b64 exec, 1
    ds_add_u32 v244, v245
    s_mov_b64 exec, -1
    v_add_u32 v243, 1024, v243
    v_add_u32 v244, 4, v244
    s_mov_b32 s77, 8
L_nofl3:
L_dloop:
    s_waitcnt vmcnt(24)
    v_lshlrev_b32 v216, 16, v216
    v_lshlrev_b32 v217, 16, v217
    v_max_f32_dpp v230, v219, v219 row_ror:8 row_mask:0xf bank_mask:0xf
    s_nop 1
    v_max_f32_dpp v230, v230, v230 row_ror:4 row_mask:0xf bank_mask:0xf
    s_nop 1
    v_max_f32_dpp v230, v230, v230 row_ror:2 row_mask:0xf bank_mask:0xf
    s_nop 1
    v_max_f32_dpp v230, v230, v230 row_ror:1 row_mask:0xf bank_mask:0xf
    v_max_f32 v230, v230, v212
    v_sub_f32 v231, v212, v230
    v_sub_f32 v218, v219, v230
    v_exp_f32 v231, v231
    v_exp_f32 v218, v218
    v_mov_b32 v212, v230
    v_fma_f32 v213, v213, v231, v218
    v_mul_f32 v218, v218, v216
    v_mul_f32 v214, v214, v231
    v_mul_f32 v240, 0x71800000, v218
    v_fmac_f32 v214, v218, v217
    v_pk_mul_f32 v[200:201], v[200:201], v[230:231] op_sel:[0,1] op_sel_hi:[1,1]
    v_pk_mul_f32 v[202:203], v[202:203], v[230:231] op_sel:[0,1] op_sel_hi:[1,1]
    v_pk_mul_f32 v[204:205], v[204:205], v[230:231] op_sel:[0,1] op_sel_hi:[1,1]
    v_pk_mul_f32 v[206:207], v[206:207], v[230:231] op_sel:[0,1] op_sel_hi:[1,1]
    v_pk_mul_f32 v[208:209], v[208:209], v[230:231] op_sel:[0,1] op_sel_hi:[1,1]
    v_pk_mul_f32 v[210:211], v[210:211], v[230:231] op_sel:[0,1] op_sel_hi:[1,1]
    v_mov_b32_dpp v238, v240 row_newbcast:0 row_mask:0xf bank_mask:0xf
    s_waitcnt vmcnt(23)
    v_pk_fma_f32 v[200:201], v[238:239], v[4:5], v[200:201] op_sel_hi:[0,1,1]
    v_pk_fma_f32 v[202:203], v[238:239], v[6:7], v[202:203] op_sel_hi:[0,1,1]
    ds_read_b32 v246, v245 offset:147
    s_add_u32 s71, s71, 777216
    s_cbranch_vccnz L_th24_4
L_tb24_4:
    buffer_load_dwordx4 v[4:7], v1, s[28:31], s71 offen offset:0 nt
    s_waitcnt vmcnt(23)
    v_pk_fma_f32 v[204:205], v[238:239], v[8:9], v[204:205] op_sel_hi:[0,1,1]
    v_pk_fma_f32 v[206:207], v[238:239], v[10:11], v[206:207] op_sel_hi:[0,1,1]
    buffer_load_dwordx4 v[8:11], v1, s[28:31], s71 offen offset:256 nt
    s_waitcnt vmcnt(23)
    v_pk_fma_f32 v[208:209], v[238:239], v[12:13], v[208:209] op_sel_hi:[0,1,1]
    v_pk_fma_f32 v[210:211], v[238:239], v[14:15], v[210:211] op_sel_hi:[0,1,1]
    s_waitcnt lgkmcnt(0)
    v_cmp_ne_u32 vcc, 0, v246
    ds_add_u32 v220, v245 offset:28160
    buffer_load_dwordx4 v[12:15], v1, s[28:31], s71 offen offset:512 nt
    v_mov_b32_dpp v238, v240 row_newbcast:8 row_mask:0xf bank_mask:0xf
    s_waitcnt vmcnt(23)
    v_pk_fma_f32 v[200:201], v[238:239], v[16:17], v[200:201] op_sel_hi:[0,1,1]
    v_pk_fma_f32 v[202:203], v[238:239], v[18:19], v[202:203] op_sel_hi:[0,1,1]
    s_add_u32 s71, s71, 3072
    s_cbranch_vccnz L_th27_4
L_tb27_4:
    buffer_load_dwordx4 v[16:19], v1, s[28:31], s71 offen offset:0 nt
    s_waitcnt vmcnt(23)
    v_pk_fma_f32 v[204:205], v[238:239], v[20:21], v[204:205] op_sel_hi:[0,1,1]
    v_pk_fma_f32 v[206:207], v[238:239], v[22:23], v[206:207] op_sel_hi:[0,1,1]
    buffer_load_dwordx4 v[20:23], v1, s[28:31], s71 offen offset:256 nt
    s_waitcnt vmcnt(23)
    v_pk_fma_f32 v[208:209], v[238:239], v[24:25], v[208:209] op_sel_hi:[0,1,1]
    v_pk_fma_f32 v[210:211], v[238:239], v[26:27], v[210:211] op_sel_hi:[0,1,1]
    ds_add_u32 v220, v245 offset:28160
    buffer_load_dwordx4 v[24:27], v1, s[28:31], s71 offen offset:512 nt
    v_mov_b32_dpp v238, v240 row_newbcast:4 row_mask:0xf bank_mask:0xf
    s_waitcnt vmcnt(23)
    v_pk_fma_f32 v[200:201], v[238:239], v[28:29], v[200:201] op_sel_hi:[0,1,1]
    v_pk_fma_f32 v[202:203], v[238:239], v[30:31], v[202:203] op_sel_hi:[0,1,1]
    s_add_u32 s71, s71, 3072
    s_cbranch_vccnz L_th30_4
L_tb30_4:
    buffer_load_dwordx4 v[28:31], v1, s[28:31], s71 offen offset:0 nt
    s_waitcnt vmcnt(23)
    v_pk_fma_f32 v[204:205], v[238:239], v[32:33], v[204:205] op_sel_hi:[0,1,1]
    v_pk_fma_f32 v[206:207], v[238:239], v[34:35], v[206:207] op_sel_hi:[0,1,1]
    buffer_load_dwordx4 v[32:35], v1, s[28:31], s71 offen offset:256 nt
    s_waitcnt vmcnt(23)
    v_pk_fma_f32 v[208:209], v[238:239], v[36:37], v[208:209] op_sel_hi:[0,1,1]
    v_pk_fma_f32 v[210:211], v[238:239], v[38:39], v[210:211] op_sel_hi:[0,1,1]
    ds_add_u32 v220, v245 offset:28160
    buffer_load_dwordx4 v[36:39], v1, s[28:31], s71 offen offset:512 nt
    v_mov_b32_dpp v238, v240 row_newbcast:12 row_mask:0xf bank_mask:0xf
    s_waitcnt vmcnt(23)
    v_pk_fma_f32 v[200:201], v[238:239], v[40:41], v[200:201] op_sel_hi:[0,1,1]
    v_pk_fma_f32 v[202:203], v[238:239], v[42:43], v[202:203] op_sel_hi:[0,1,1]
    s_add_u32 s71, s71, 3072
    s_cbranch_vccnz L_th33_4
L_tb33_4:
    buffer_load_dwordx4 v[40:43], v1, s[28:31], s71 offen offset:0 nt
    s_waitcnt vmcnt(23)
    v_pk_fma_f32 v[204:205], v[238:239], v[44:45], v[204:205] op_sel_hi:[0,1,1]
    v_pk_fma_f32 v[206:207], v[238:239], v[46:47], v[206:207] op_sel_hi:[0,1,1]
    buffer_load_dwordx4 v[44:47], v1, s[28:31], s71 offen offset:256 nt
    s_waitcnt vmcnt(23)
    v_pk_fma_f32 v[208:209], v[238:239], v[48:49], v[208:209] op_sel_hi:[0,1,1]
    v_pk_fma_f32 v[210:211], v[238:239], v[50:51], v[210:211] op_sel_hi:[0,1,1]
    ds_add_u32 v220, v245 offset:28160
    buffer_load_dwordx4 v[48:51], v1, s[28:31], s71 offen offset:512 nt
    v_mov_b32_dpp v238, v240 row_newbcast:2 row_mask:0xf bank_mask:0xf
    s_waitcnt vmcnt(23)
    v_pk_fma_f32 v[200:201], v[238:239], v[52:53], v[200:201] op_sel_hi:[0,1,1]
    v_pk_fma_f32 v[202:203], v[238:239], v[54:55], v[202:203] op_sel_hi:[0,1,1]
    ds_read_b32 v246, v245 offset:147
    s_add_u32 s71, s71, 777216
    s_cbranch_vccnz L_th36_4
L_tb36_4:
    buffer_load_dwordx4 v[52:55], v1, s[28:31], s71 offen offset:0 nt
    s_waitcnt vmcnt(23)
    v_pk_fma_f32 v[204:205], v[238:239], v[56:57], v[204:205] op_sel_hi:[0,1,1]
    v_pk_fma_f32 v[206:207], v[238:239], v[58:59], v[206:207] op_sel_hi:[0,1,1]
    buffer_load_dwordx4 v[56:59], v1, s[28:31], s71 offen offset:256 nt
    s_waitcnt vmcnt(23)
    v_pk_fma_f32 v[208:209], v[238:239], v[60:61], v[208:209] op_sel_hi:[0,1,1]
    v_pk_fma_f32 v[210:211], v[238:239], v[62:63], v[210:211] op_sel_hi:[0,1,1]
    s_waitcnt lgkmcnt(0)
    v_cmp_ne_u32 vcc, 0, v246
    ds_add_u32 v220, v245 offset:28160
    buffer_load_dwordx4 v[60:63], v1, s[28:31], s71 offen offset:512 nt
    v_mov_b32_dpp v238, v240 row_newbcast:10 row_mask:0xf bank_mask:0xf
    s_waitcnt vmcnt(23)
    v_pk_fma_f32 v[200:201], v[238:239], v[64:65], v[200:201] op_sel_hi:[0,1,1]
    v_pk_fma_f32 v[202:203], v[238:239], v[66:67], v[202:203] op_sel_hi:[0,1,1]
    s_add_u32 s71, s71, 3072
    s_cbranch_vccnz L_th39_4
L_tb39_4:
    buffer_load_dwordx4 v[64:67], v1, s[28:31], s71 offen offset:0 nt
    s_waitcnt vmcnt(23)
    v_pk_fma_f32 v[204:205], v[238:239], v[68:69], v[204:205] op_sel_hi:[0,1,1]
    v_pk_fma_f32 v[206:207], v[238:239], v[70:71], v[206:207] op_sel_hi:[0,1,1]
    buffer_load_dwordx4 v[68:71], v1, s[28:31], s71 offen offset:256 nt
    s_waitcnt vmcnt(23)
    v_pk_fma_f32 v[208:209], v[238:239], v[72:73], v[208:209] op_sel_hi:[0,1,1]
    v_pk_fma_f32 v[210:211], v[238:239], v[74:75], v[210:211] op_sel_hi:[0,1,1]
    ds_add_u32 v220, v245 offset:28160
    buffer_load_dwordx4 v[72:75], v1, s[28:31], s71 offen offset:512 nt
    v_mov_b32_dpp v238, v240 row_newbcast:6 row_mask:0xf bank_mask:0xf
    s_waitcnt vmcnt(23)
    v_pk_fma_f32 v[200:201], v[238:239], v[76:77], v[200:201] op_sel_hi:[0,1,1]
    v_pk_fma_f32 v[202:203], v[238:239], v[78:79], v[202:203] op_sel_hi:[0,1,1]
    s_add_u32 s71, s71, 3072
    s_cbranch_vccnz L_th42_4
L_tb42_4:
    buffer_load_dwordx4 v[76:79], v1, s[28:31], s71 offen offset:0 nt
    s_waitcnt vmcnt(23)
    v_pk_fma_f32 v[204:205], v[238:239], v[80:81], v[204:205] op_sel_hi:[0,1,1]
    v_pk_fma_f32 v[206:207], v[238:239], v[82:83], v[206:207] op_sel_hi:[0,1,1]
    buffer_load_dwordx4 v[80:83], v1, s[28:31], s71 offen offset:256 nt
    s_waitcnt vmcnt(23)
    v_pk_fma_f32 v[208:209], v[238:239], v[84:85], v[208:209] op_sel_hi:[0,1,1]
    v_pk_fma_f32 v[210:211], v[238:239], v[86:87], v[210:211] op_sel_hi:[0,1,1]
    ds_add_u32 v220, v245 offset:28160
    buffer_load_dwordx4 v[84:87], v1, s[28:31], s71 offen offset:512 nt
    v_mov_b32_dpp v238, v240 row_newbcast:14 row_mask:0xf bank_mask:0xf
    s_waitcnt vmcnt(23)
    v_pk_fma_f32 v[200:201], v[238:239], v[88:89], v[200:201] op_sel_hi:[0,1,1]
    v_pk_fma_f32 v[202:203], v[238:239], v[90:91], v[202:203] op_sel_hi:[0,1,1]
    s_add_u32 s71, s71, 3072
    s_cbranch_vccnz L_th45_4
L_tb45_4:
    buffer_load_dwordx4 v[88:91], v1, s[28:31], s71 offen offset:0 nt
    ds_read_b32 v223, v222
    s_waitcnt vmcnt(23)
    v_pk_fma_f32 v[204:205], v[238:239], v[92:93], v[204:205] op_sel_hi:[0,1,1]
    v_pk_fma_f32 v[206:207], v[238:239], v[94:95], v[206:207] op_sel_hi:[0,1,1]
    buffer_load_dwordx4 v[92:95], v1, s[28:31], s71 offen offset:256 nt
    s_waitcnt vmcnt(23)
    v_pk_fma_f32 v[208:209], v[238:239], v[96:97], v[208:209] op_sel_hi:[0,1,1]
    v_pk_fma_f32 v[210:211], v[238:239], v[98:99], v[210:211] op_sel_hi:[0,1,1]
    ds_add_u32 v220, v245 offset:28160
    buffer_load_dwordx4 v[96:99], v1, s[28:31], s71 offen offset:512 nt
    s_waitcnt lgkmcnt(0)
    v_readfirstlane_b32 s80, v223
    s_cmp_lg_u32 s80, -1
    s_cbranch_scc1 L_tkok
L_tkw:
    ds_read_b32 v223, v222
    s_waitcnt lgkmcnt(0)
    v_readfirstlane_b32 s80, v223
    s_cmp_eq_u32 s80, -1
    s_cbranch_scc1 L_tkw
L_tkok:
    v_add_u32 v222, 4, v222
    s_cmp_ge_u32 s80, 256
    s_cbranch_scc1 L_dtail
    s_lshr_b32 s81, s80, 6
    s_and_b32 s80, s80, 63
    s_mul_i32 s56, s81, 64
    s_add_u32 s56, s56, s80
    s_add_u32 s56, s56, s94
    s_and_b32 s56, s56, 511
    s_mov_b32 s57, s59
    s_add_u32 s70, s57, s56
    s_and_b32 s95, s3, 192
    s_add_u32 s95, s95, s80
    s_lshl_b32 s95, s95, 3
    s_add_u32 s95, s95, s81
    s_lshl_b32 s95, s95, 8
    s_add_u32 s95, s95, 18874368
    v_mov_b32_dpp v238, v240 row_newbcast:1 row_mask:0xf bank_mask:0xf
    s_waitcnt vmcnt(23)
    v_pk_fma_f32 v[200:201], v[238:239], v[4:5], v[200:201] op_sel_hi:[0,1,1]
    v_pk_fma_f32 v[202:203], v[238:239], v[6:7], v[202:203] op_sel_hi:[0,1,1]
    ds_read_b32 v246, v245 offset:147
    s_and_b32 s80, s70, 63
    s_mul_i32 s80, s80, 96
    s_lshl_b32 s73, s70, 7
    s_sub_u32 s73, s73, s80
    buffer_load_dword v219, v220, s[52:55], s95 offen sc0 sc1
    buffer_load_ushort v216, v3, s[40:43], s73 offen
    buffer_load_ushort v217, v3, s[44:47], s73 offen
    s_mul_i32 s71, s70, 49152
    s_and_b32 s80, s70, 63
    s_mul_i32 s80, s80, 36864
    s_sub_u32 s71, s71, s80
    s_cbranch_vccnz L_th0_4
L_tb0_4:
    buffer_load_dwordx4 v[4:7], v1, s[28:31], s71 offen offset:0 nt
    s_waitcnt vmcnt(26)
    v_pk_fma_f32 v[204:205], v[238:239], v[8:9], v[204:205] op_sel_hi:[0,1,1]
    v_pk_fma_f32 v[206:207], v[238:239], v[10:11], v[206:207] op_sel_hi:[0,1,1]
    buffer_load_dwordx4 v[8:11], v1, s[28:31], s71 offen offset:256 nt
    s_waitcnt vmcnt(26)
    v_pk_fma_f32 v[208:209], v[238:239], v[12:13], v[208:209] op_sel_hi:[0,1,1]
    v_pk_fma_f32 v[210:211], v[238:239], v[14:15], v[210:211] op_sel_hi:[0,1,1]
    s_waitcnt lgkmcnt(0)
    v_cmp_ne_u32 vcc, 0, v246
    ds_add_u32 v220, v245 offset:28160
    buffer_load_dwordx4 v[12:15], v1, s[28:31], s71 offen offset:512 nt
    v_mov_b32_dpp v238, v240 row_newbcast:9 row_mask:0xf bank_mask:0xf
    s_waitcnt vmcnt(26)
    v_pk_fma_f32 v[200:201], v[238:239], v[16:17], v[200:201] op_sel_hi:[0,1,1]
    v_pk_fma_f32 v[202:203], v[238:239], v[18:19], v[202:203] op_sel_hi:[0,1,1]
    s_add_u32 s71, s71, 3072
    s_cbranch_vccnz L_th3_4
L_tb3_4:
    buffer_load_dwordx4 v[16:19], v1, s[28:31], s71 offen offset:0 nt
    s_mov_b64 exec, 1
    ds_add_u32 v245, v245 offset:131
    s_mov_b64 exec, -1
    s_waitcnt vmcnt(26)
    v_pk_fma_f32 v[204:205], v[238:239], v[20:21], v[204:205] op_sel_hi:[0,1,1]
    v_pk_fma_f32 v[206:207], v[238:239], v[22:23], v[206:207] op_sel_hi:[0,1,1]
    buffer_load_dwordx4 v[20:23], v1, s[28:31], s71 offen offset:256 nt
    s_waitcnt vmcnt(26)
    v_pk_fma_f32 v[208:209], v[238:239], v[24:25], v[208:209] op_sel_hi:[0,1,1]
    v_pk_fma_f32 v[210:211], v[238:239], v[26:27], v[210:211] op_sel_hi:[0,1,1]
    ds_add_u32 v220, v245 offset:28160
    buffer_load_dwordx4 v[24:27], v1, s[28:31], s71 offen offset:512 nt
    v_mov_b32_dpp v238, v240 row_newbcast:5 row_mask:0xf bank_mask:0xf
    s_waitcnt vmcnt(26)
    v_pk_fma_f32 v[200:201], v[238:239], v[28:29], v[200:201] op_sel_hi:[0,1,1]
    v_pk_fma_f32 v[202:203], v[238:239], v[30:31], v[202:203] op_sel_hi:[0,1,1]
    s_add_u32 s71, s71, 3072
    s_cbranch_vccnz L_th6_4
L_tb6_4:
    buffer_load_dwordx4 v[28:31], v1, s[28:31], s71 offen offset:0 nt
    s_waitcnt vmcnt(26)
    v_pk_fma_f32 v[204:205], v[238:239], v[32:33], v[204:205] op_sel_hi:[0,1,1]
    v_pk_fma_f32 v[206:207], v[238:239], v[34:35], v[206:207] op_sel_hi:[0,1,1]
    buffer_load_dwordx4 v[32:35], v1, s[28:31], s71 offen offset:256 nt
    s_waitcnt vmcnt(26)
    v_pk_fma_f32 v[208:209], v[238:239], v[36:37], v[208:209] op_sel_hi:[0,1,1]
    v_pk_fma_f32 v[210:211], v[238:239], v[38:39], v[210:211] op_sel_hi:[0,1,1]
    ds_add_u32 v220, v245 offset:28160
    buffer_load_dwordx4 v[36:39], v1, s[28:31], s71 offen offset:512 nt
    v_mov_b32_dpp v238, v240 row_newbcast:13 row_mask:0xf bank_mask:0xf
    s_waitcnt vmcnt(26)
    v_pk_fma_f32 v[200:201], v[238:239], v[40:41], v[200:201] op_sel_hi:[0,1,1]
    v_pk_fma_f32 v[202:203], v[238:239], v[42:43], v[202:203] op_sel_hi:[0,1,1]
    s_add_u32 s71, s71, 3072
    s_cbranch_vccnz L_th9_4
L_tb9_4:
    buffer_load_dwordx4 v[40:43], v1, s[28:31], s71 offen offset:0 nt
    s_waitcnt vmcnt(26)
    v_pk_fma_f32 v[204:205], v[238:239], v[44:45], v[204:205] op_sel_hi:[0,1,1]
    v_pk_fma_f32 v[206:207], v[238:239], v[46:47], v[206:207] op_sel_hi:[0,1,1]
    buffer_load_dwordx4 v[44:47], v1, s[28:31], s71 offen offset:256 nt
    s_waitcnt vmcnt(26)
    v_pk_fma_f32 v[208:209], v[238:239], v[48:49], v[208:209] op_sel_hi:[0,1,1]
    v_pk_fma_f32 v[210:211], v[238:239], v[50:51], v[210:211] op_sel_hi:[0,1,1]
    ds_add_u32 v220, v245 offset:28160
    buffer_load_dwordx4 v[48:51], v1, s[28:31], s71 offen offset:512 nt
    v_mov_b32_dpp v238, v240 row_newbcast:3 row_mask:0xf bank_mask:0xf
    s_waitcnt vmcnt(26)
    v_pk_fma_f32 v[200:201], v[238:239], v[52:53], v[200:201] op_sel_hi:[0,1,1]
    v_pk_fma_f32 v[202:203], v[238:239], v[54:55], v[202:203] op_sel_hi:[0,1,1]
    ds_read_b32 v246, v245 offset:147
    s_add_u32 s71, s71, 777216
    s_cbranch_vccnz L_th12_4
L_tb12_4:
    buffer_load_dwordx4 v[52:55], v1, s[28:31], s71 offen offset:0 nt
    s_waitcnt vmcnt(26)
    v_pk_fma_f32 v[204:205], v[238:239], v[56:57], v[204:205] op_sel_hi:[0,1,1]
    v_pk_fma_f32 v[206:207], v[238:239], v[58:59], v[206:207] op_sel_hi:[0,1,1]
    buffer_load_dwordx4 v[56:59], v1, s[28:31], s71 offen offset:256 nt
    s_waitcnt vmcnt(26)
    v_pk_fma_f32 v[208:209], v[238:239], v[60:61], v[208:209] op_sel_hi:[0,1,1]
    v_pk_fma_f32 v[210:211], v[238:239], v[62:63], v[210:211] op_sel_hi:[0,1,1]
    s_waitcnt lgkmcnt(0)
    v_cmp_ne_u32 vcc, 0, v246
    ds_add_u32 v220, v245 offset:28160
    buffer_load_dwordx4 v[60:63], v1, s[28:31], s71 offen offset:512 nt
    v_mov_b32_dpp v238, v240 row_newbcast:11 row_mask:0xf bank_mask:0xf
    s_waitcnt vmcnt(26)
    v_pk_fma_f32 v[200:201], v[238:239], v[64:65], v[200:201] op_sel_hi:[0,1,1]
    v_pk_fma_f32 v[202:203], v[238:239], v[66:67], v[202:203] op_sel_hi:[0,1,1]
    s_add_u32 s71, s71, 3072
    s_cbranch_vccnz L_th15_4
L_tb15_4:
    buffer_load_dwordx4 v[64:67], v1, s[28:31], s71 offen offset:0 nt
    s_waitcnt vmcnt(26)
    v_pk_fma_f32 v[204:205], v[238:239], v[68:69], v[204:205] op_sel_hi:[0,1,1]
    v_pk_fma_f32 v[206:207], v[238:239], v[70:71], v[206:207] op_sel_hi:[0,1,1]
    buffer_load_dwordx4 v[68:71], v1, s[28:31], s71 offen offset:256 nt
    s_waitcnt vmcnt(26)
    v_pk_fma_f32 v[208:209], v[238:239], v[72:73], v[208:209] op_sel_hi:[0,1,1]
    v_pk_fma_f32 v[210:211], v[238:239], v[74:75], v[210:211] op_sel_hi:[0,1,1]
    ds_add_u32 v220, v245 offset:28160
    buffer_load_dwordx4 v[72:75], v1, s[28:31], s71 offen offset:512 nt
    v_mov_b32_dpp v238, v240 row_newbcast:7 row_mask:0xf bank_mask:0xf
    s_waitcnt vmcnt(26)
    v_pk_fma_f32 v[200:201], v[238:239], v[76:77], v[200:201] op_sel_hi:[0,1,1]
    v_pk_fma_f32 v[202:203], v[238:239], v[78:79], v[202:203] op_sel_hi:[0,1,1]
    s_add_u32 s71, s71, 3072
    s_cbranch_vccnz L_th18_4
L_tb18_4:
    buffer_load_dwordx4 v[76:79], v1, s[28:31], s71 offen offset:0 nt
    s_waitcnt vmcnt(26)
    v_pk_fma_f32 v[204:205], v[238:239], v[80:81], v[204:205] op_sel_hi:[0,1,1]
    v_pk_fma_f32 v[206:207], v[238:239], v[82:83], v[206:207] op_sel_hi:[0,1,1]
    buffer_load_dwordx4 v[80:83], v1, s[28:31], s71 offen offset:256 nt
    s_waitcnt vmcnt(26)
    v_pk_fma_f32 v[208:209], v[238:239], v[84:85], v[208:209] op_sel_hi:[0,1,1]
    v_pk_fma_f32 v[210:211], v[238:239], v[86:87], v[210:211] op_sel_hi:[0,1,1]
    ds_add_u32 v220, v245 offset:28160
    buffer_load_dwordx4 v[84:87], v1, s[28:31], s71 offen offset:512 nt
    v_mov_b32_dpp v238, v240 row_newbcast:15 row_mask:0xf bank_mask:0xf
    s_waitcnt vmcnt(26)
    v_pk_fma_f32 v[200:201], v[238:239], v[88:89], v[200:201] op_sel_hi:[0,1,1]
    v_pk_fma_f32 v[202:203], v[238:239], v[90:91], v[202:203] op_sel_hi:[0,1,1]
    s_add_u32 s71, s71, 3072
    s_cbranch_vccnz L_th21_4
L_tb21_4:
    buffer_load_dwordx4 v[88:91], v1, s[28:31], s71 offen offset:0 nt
    s_waitcnt vmcnt(26)
    v_pk_fma_f32 v[204:205], v[238:239], v[92:93], v[204:205] op_sel_hi:[0,1,1]
    v_pk_fma_f32 v[206:207], v[238:239], v[94:95], v[206:207] op_sel_hi:[0,1,1]
    buffer_load_dwordx4 v[92:95], v1, s[28:31], s71 offen offset:256 nt
    s_waitcnt vmcnt(26)
    v_pk_fma_f32 v[208:209], v[238:239], v[96:97], v[208:209] op_sel_hi:[0,1,1]
    v_pk_fma_f32 v[210:211], v[238:239], v[98:99], v[210:211] op_sel_hi:[0,1,1]
    ds_add_u32 v220, v245 offset:28160
    buffer_load_dwordx4 v[96:99], v1, s[28:31], s71 offen offset:512 nt
    s_branch L_dloop
L_dtail:
    ds_write_b32 v245, v245 offset:143
    v_mov_b32_dpp v238, v240 row_newbcast:1 row_mask:0xf bank_mask:0xf
    s_waitcnt vmcnt(23)
    v_pk_fma_f32 v[200:201], v[238:239], v[4:5], v[200:201] op_sel_hi:[0,1,1]
    v_pk_fma_f32 v[202:203], v[238:239], v[6:7], v[202:203] op_sel_hi:[0,1,1]
    s_waitcnt vmcnt(22)
    v_pk_fma_f32 v[204:205], v[238:239], v[8:9], v[204:205] op_sel_hi:[0,1,1]
    v_pk_fma_f32 v[206:207], v[238:239], v[10:11], v[206:207] op_sel_hi:[0,1,1]
    s_waitcnt vmcnt(21)
    v_pk_fma_f32 v[208:209], v[238:239], v[12:13], v[208:209] op_sel_hi:[0,1,1]
    v_pk_fma_f32 v[210:211], v[238:239], v[14:15], v[210:211] op_sel_hi:[0,1,1]
    v_mov_b32_dpp v238, v240 row_newbcast:9 row_mask:0xf bank_mask:0xf
    s_waitcnt vmcnt(20)
    v_pk_fma_f32 v[200:201], v[238:239], v[16:17], v[200:201] op_sel_hi:[0,1,1]
    v_pk_fma_f32 v[202:203], v[238:239], v[18:19], v[202:203] op_sel_hi:[0,1,1]
    s_waitcnt vmcnt(19)
    v_pk_fma_f32 v[204:205], v[238:239], v[20:21], v[204:205] op_sel_hi:[0,1,1]
    v_pk_fma_f32 v[206:207], v[238:239], v[22:23], v[206:207] op_sel_hi:[0,1,1]
    s_waitcnt vmcnt(18)
    v_pk_fma_f32 v[208:209], v[238:239], v[24:25], v[208:209] op_sel_hi:[0,1,1]
    v_pk_fma_f32 v[210:211], v[238:239], v[26:27], v[210:211] op_sel_hi:[0,1,1]
    v_mov_b32_dpp v238, v240 row_newbcast:5 row_mask:0xf bank_mask:0xf
    s_waitcnt vmcnt(17)
    v_pk_fma_f32 v[200:201], v[238:239], v[28:29], v[200:201] op_sel_hi:[0,1,1]
    v_pk_fma_f32 v[202:203], v[238:239], v[30:31], v[202:203] op_sel_hi:[0,1,1]
    s_waitcnt vmcnt(16)
    v_pk_fma_f32 v[204:205], v[238:239], v[32:33], v[204:205] op_sel_hi:[0,1,1]
    v_pk_fma_f32 v[206:207], v[238:239], v[34:35], v[206:207] op_sel_hi:[0,1,1]
    s_waitcnt vmcnt(15)
    v_pk_fma_f32 v[208:209], v[238:239], v[36:37], v[208:209] op_sel_hi:[0,1,1]
    v_pk_fma_f32 v[210:211], v[238:239], v[38:39], v[210:211] op_sel_hi:[0,1,1]
    v_mov_b32_dpp v238, v240 row_newbcast:13 row_mask:0xf bank_mask:0xf
    s_waitcnt vmcnt(14)
    v_pk_fma_f32 v[200:201], v[238:239], v[40:41], v[200:201] op_sel_hi:[0,1,1]
    v_pk_fma_f32 v[202:203], v[238:239], v[42:43], v[202:203] op_sel_hi:[0,1,1]
    s_waitcnt vmcnt(13)
    v_pk_fma_f32 v[204:205], v[238:239], v[44:45], v[204:205] op_sel_hi:[0,1,1]
    v_pk_fma_f32 v[206:207], v[238:239], v[46:47], v[206:207] op_sel_hi:[0,1,1]
    s_waitcnt vmcnt(12)
    v_pk_fma_f32 v[208:209], v[238:239], v[48:49], v[208:209] op_sel_hi:[0,1,1]
    v_pk_fma_f32 v[210:211], v[238:239], v[50:51], v[210:211] op_sel_hi:[0,1,1]
    v_mov_b32_dpp v238, v240 row_newbcast:3 row_mask:0xf bank_mask:0xf
    s_waitcnt vmcnt(11)
    v_pk_fma_f32 v[200:201], v[238:239], v[52:53], v[200:201] op_sel_hi:[0,1,1]
    v_pk_fma_f32 v[202:203], v[238:239], v[54:55], v[202:203] op_sel_hi:[0,1,1]
    s_waitcnt vmcnt(10)
    v_pk_fma_f32 v[204:205], v[238:239], v[56:57], v[204:205] op_sel_hi:[0,1,1]
    v_pk_fma_f32 v[206:207], v[238:239], v[58:59], v[206:207] op_sel_hi:[0,1,1]
    s_waitcnt vmcnt(9)
    v_pk_fma_f32 v[208:209], v[238:239], v[60:61], v[208:209] op_sel_hi:[0,1,1]
    v_pk_fma_f32 v[210:211], v[238:239], v[62:63], v[210:211] op_sel_hi:[0,1,1]
    v_mov_b32_dpp v238, v240 row_newbcast:11 row_mask:0xf bank_mask:0xf
    s_waitcnt vmcnt(8)
    v_pk_fma_f32 v[200:201], v[238:239], v[64:65], v[200:201] op_sel_hi:[0,1,1]
    v_pk_fma_f32 v[202:203], v[238:239], v[66:67], v[202:203] op_sel_hi:[0,1,1]
    s_waitcnt vmcnt(7)
    v_pk_fma_f32 v[204:205], v[238:239], v[68:69], v[204:205] op_sel_hi:[0,1,1]
    v_pk_fma_f32 v[206:207], v[238:239], v[70:71], v[206:207] op_sel_hi:[0,1,1]
    s_waitcnt vmcnt(6)
    v_pk_fma_f32 v[208:209], v[238:239], v[72:73], v[208:209] op_sel_hi:[0,1,1]
    v_pk_fma_f32 v[210:211], v[238:239], v[74:75], v[210:211] op_sel_hi:[0,1,1]
    v_mov_b32_dpp v238, v240 row_newbcast:7 row_mask:0xf bank_mask:0xf
    s_waitcnt vmcnt(5)
    v_pk_fma_f32 v[200:201], v[238:239], v[76:77], v[200:201] op_sel_hi:[0,1,1]
    v_pk_fma_f32 v[202:203], v[238:239], v[78:79], v[202:203] op_sel_hi:[0,1,1]
    s_waitcnt vmcnt(4)
    v_pk_fma_f32 v[204:205], v[238:239], v[80:81], v[204:205] op_sel_hi:[0,1,1]
    v_pk_fma_f32 v[206:207], v[238:239], v[82:83], v[206:207] op_sel_hi:[0,1,1]
    s_waitcnt vmcnt(3)
    v_pk_fma_f32 v[208:209], v[238:239], v[84:85], v[208:209] op_sel_hi:[0,1,1]
    v_pk_fma_f32 v[210:211], v[238:239], v[86:87], v[210:211] op_sel_hi:[0,1,1]
    v_mov_b32_dpp v238, v240 row_newbcast:15 row_mask:0xf bank_mask:0xf
    s_waitcnt vmcnt(2)
    v_pk_fma_f32 v[200:201], v[238:239], v[88:89], v[200:201] op_sel_hi:[0,1,1]
    v_pk_fma_f32 v[202:203], v[238:239], v[90:91], v[202:203] op_sel_hi:[0,1,1]
    s_waitcnt vmcnt(1)
    v_pk_fma_f32 v[204:205], v[238:239], v[92:93], v[204:205] op_sel_hi:[0,1,1]
    v_pk_fma_f32 v[206:207], v[238:239], v[94:95], v[206:207] op_sel_hi:[0,1,1]
    s_waitcnt vmcnt(0)
    v_pk_fma_f32 v[208:209], v[238:239], v[96:97], v[208:209] op_sel_hi:[0,1,1]
    v_pk_fma_f32 v[210:211], v[238:239], v[98:99], v[210:211] op_sel_hi:[0,1,1]
    s_nop 0
    v_add_f32_dpp v213, v213, v213 row_ror:8 row_mask:0xf bank_mask:0xf
    v_add_f32_dpp v214, v214, v214 row_ror:8 row_mask:0xf bank_mask:0xf
    s_nop 0
    v_add_f32_dpp v213, v213, v213 row_ror:4 row_mask:0xf bank_mask:0xf
    v_add_f32_dpp v214, v214, v214 row_ror:4 row_mask:0xf bank_mask:0xf
    s_nop 0
    v_add_f32_dpp v213, v213, v213 row_ror:2 row_mask:0xf bank_mask:0xf
    v_add_f32_dpp v214, v214, v214 row_ror:2 row_mask:0xf bank_mask:0xf
    s_nop 0
    v_add_f32_dpp v213, v213, v213 row_ror:1 row_mask:0xf bank_mask:0xf
    v_add_f32_dpp v214, v214, v214 row_ror:1 row_mask:0xf bank_mask:0xf
    v_mov_b32 v230, v212
    v_mov_b32 v231, v212
    s_nop 1
    v_permlane32_swap_b32 v230, v231
    s_nop 1
    v_max_f32 v230, v230, v231
    v_mov_b32 v231, v230
    s_nop 1
    v_permlane16_swap_b32 v230, v231
    s_nop 1
    v_max_f32 v230, v230, v231
    v_sub_f32 v231, v212, v230
    v_exp_f32 v231, v231
    v_mov_b32 v104, v230
    v_mul_f32 v213, v213, v231
    v_mul_f32 v214, v214, v231
    v_mul_f32 v231, 0x58000000, v231
    v_fma_f32 v200, v200, v231, -v214
    v_fma_f32 v201, v201, v231, -v214
    v_fma_f32 v202, v202, v231, -v214
    v_fma_f32 v203, v203, v231, -v214
    v_fma_f32 v204, v204, v231, -v214
    v_fma_f32 v205, v205, v231, -v214
    v_fma_f32 v206, v206, v231, -v214
    v_fma_f32 v207, v207, v231, -v214
    v_fma_f32 v208, v208, v231, -v214
    v_fma_f32 v209, v209, v231, -v214
    v_fma_f32 v210, v210, v231, -v214
    v_fma_f32 v211, v211, v231, -v214
    v_mov_b32 v230, v213
    s_nop 1
    v_permlane32_swap_b32 v213, v230
    v_permlane32_swap_b32 v200, v202
    v_permlane32_swap_b32 v201, v203
    v_permlane32_swap_b32 v204, v206
    v_permlane32_swap_b32 v205, v207
    v_permlane32_swap_b32 v208, v210
    v_permlane32_swap_b32 v209, v211
    s_nop 1
    v_add_f32 v213, v213, v230
    v_add_f32 v200, v200, v202
    v_add_f32 v201, v201, v203
    v_add_f32 v204, v204, v206
    v_add_f32 v205, v205, v207
    v_add_f32 v208, v208, v210
    v_add_f32 v209, v209, v211
    v_mov_b32 v230, v213
    s_nop 1
    v_permlane16_swap_b32 v213, v230
    v_permlane16_swap_b32 v200, v201
    v_permlane16_swap_b32 v204, v205
    v_permlane16_swap_b32 v208, v209
    s_nop 1
    v_add_f32 v105, v213, v230
    v_add_f32 v100, v200, v201
    v_add_f32 v101, v204, v205
    v_add_f32 v102, v208, v209
    v_mov_b32 v103, s93
    v_mov_b32 v106, s93
    v_mov_b32 v107, s93
    v_lshlrev_b32 v231, 4, v0
    s_lshl_b32 s80, s3, 11
    buffer_store_dwordx4 v[100:103], v231, s[52:55], s80 offen offset:0 sc0 sc1
    s_mov_b64 exec, 1
    buffer_store_dwordx4 v[104:107], v231, s[52:55], s80 offen offset:1024 sc0 sc1
    s_mov_b64 exec, -1
    s_endpgm
L_th24_0:
    s_waitcnt vmcnt(32)
    s_branch L_tb24_0
L_th27_0:
    s_waitcnt vmcnt(26)
    s_branch L_tb27_0
L_th30_0:
    s_waitcnt vmcnt(32)
    s_branch L_tb30_0
L_th33_0:
    s_waitcnt vmcnt(32)
    s_branch L_tb33_0
L_th36_0:
    s_waitcnt vmcnt(35)
    s_branch L_tb36_0
L_th39_0:
    s_waitcnt vmcnt(29)
    s_branch L_tb39_0
L_th42_0:
    s_waitcnt vmcnt(35)
    s_branch L_tb42_0
L_th45_0:
    s_waitcnt vmcnt(35)
    s_branch L_tb45_0
L_th0_0:
    s_waitcnt vmcnt(35)
    s_branch L_tb0_0
L_th3_0:
    s_waitcnt vmcnt(29)
    s_branch L_tb3_0
L_th6_0:
    s_waitcnt vmcnt(35)
    s_branch L_tb6_0
L_th9_0:
    s_waitcnt vmcnt(32)
    s_branch L_tb9_0
L_th12_0:
    s_waitcnt vmcnt(32)
    s_branch L_tb12_0
L_th15_0:
    s_waitcnt vmcnt(26)
    s_branch L_tb15_0
L_th18_0:
    s_waitcnt vmcnt(32)
    s_branch L_tb18_0
L_th21_0:
    s_waitcnt vmcnt(32)
    s_branch L_tb21_0
L_th24_1:
    s_waitcnt vmcnt(32)
    s_branch L_tb24_1
L_th27_1:
    s_waitcnt vmcnt(26)
    s_branch L_tb27_1
L_th30_1:
    s_waitcnt vmcnt(32)
    s_branch L_tb30_1
L_th33_1:
    s_waitcnt vmcnt(32)
    s_branch L_tb33_1
L_th36_1:
    s_waitcnt vmcnt(32)
    s_branch L_tb36_1
L_th39_1:
    s_waitcnt vmcnt(26)
    s_branch L_tb39_1
L_th42_1:
    s_waitcnt vmcnt(26)
    s_branch L_tb42_1
L_th45_1:
    s_waitcnt vmcnt(26)
    s_branch L_tb45_1
L_th0_1:
    s_waitcnt vmcnt(28)
    s_branch L_tb0_1
L_th3_1:
    s_waitcnt vmcnt(22)
    s_branch L_tb3_1
L_th6_1:
    s_waitcnt vmcnt(22)
    s_branch L_tb6_1
L_th9_1:
    s_waitcnt vmcnt(22)
    s_branch L_tb9_1
L_th12_1:
    s_waitcnt vmcnt(22)
    s_branch L_tb12_1
L_th15_1:
    s_waitcnt vmcnt(22)
    s_branch L_tb15_1
L_th18_1:
    s_waitcnt vmcnt(22)
    s_branch L_tb18_1
L_th21_1:
    s_waitcnt vmcnt(20)
    s_branch L_tb21_1
L_th24_2:
    s_waitcnt vmcnt(20)
    s_branch L_tb24_2
L_th27_2:
    s_waitcnt vmcnt(20)
    s_branch L_tb27_2
L_th30_2:
    s_waitcnt vmcnt(20)
    s_branch L_tb30_2
L_th33_2:
    s_waitcnt vmcnt(20)
    s_branch L_tb33_2
L_th36_2:
    s_waitcnt vmcnt(20)
    s_branch L_tb36_2
L_th39_2:
    s_waitcnt vmcnt(20)
    s_branch L_tb39_2
L_th42_2:
    s_waitcnt vmcnt(20)
    s_branch L_tb42_2
L_th45_2:
    s_waitcnt vmcnt(20)
    s_branch L_tb45_2
L_th0_2:
    s_waitcnt vmcnt(22)
    s_branch L_tb0_2
L_th3_2:
    s_waitcnt vmcnt(22)
    s_branch L_tb3_2
L_th6_2:
    s_waitcnt vmcnt(22)
    s_branch L_tb6_2
L_th9_2:
    s_waitcnt vmcnt(22)
    s_branch L_tb9_2
L_th12_2:
    s_waitcnt vmcnt(22)
    s_branch L_tb12_2
L_th15_2:
    s_waitcnt vmcnt(22)
    s_branch L_tb15_2
L_th18_2:
    s_waitcnt vmcnt(22)
    s_branch L_tb18_2
L_th21_2:
    s_waitcnt vmcnt(20)
    s_branch L_tb21_2
L_th24_3:
    s_waitcnt vmcnt(20)
    s_branch L_tb24_3
L_th27_3:
    s_waitcnt vmcnt(20)
    s_branch L_tb27_3
L_th30_3:
    s_waitcnt vmcnt(20)
    s_branch L_tb30_3
L_th33_3:
    s_waitcnt vmcnt(20)
    s_branch L_tb33_3
L_th36_3:
    s_waitcnt vmcnt(20)
    s_branch L_tb36_3
L_th39_3:
    s_waitcnt vmcnt(20)
    s_branch L_tb39_3
L_th42_3:
    s_waitcnt vmcnt(20)
    s_branch L_tb42_3
L_th45_3:
    s_waitcnt vmcnt(20)
    s_branch L_tb45_3
L_th0_3:
    s_waitcnt vmcnt(23)
    s_branch L_tb0_3
L_th3_3:
    s_waitcnt vmcnt(23)
    s_branch L_tb3_3
L_th6_3:
    s_waitcnt vmcnt(23)
    s_branch L_tb6_3
L_th9_3:
    s_waitcnt vmcnt(23)
    s_branch L_tb9_3
L_th12_3:
    s_waitcnt vmcnt(23)
    s_branch L_tb12_3
L_th15_3:
    s_waitcnt vmcnt(23)
    s_branch L_tb15_3
L_th18_3:
    s_waitcnt vmcnt(23)
    s_branch L_tb18_3
L_th21_3:
    s_waitcnt vmcnt(20)
    s_branch L_tb21_3
L_th24_4:
    s_waitcnt vmcnt(20)
    s_branch L_tb24_4
L_th27_4:
    s_waitcnt vmcnt(20)
    s_branch L_tb27_4
L_th30_4:
    s_waitcnt vmcnt(20)
    s_branch L_tb30_4
L_th33_4:
    s_waitcnt vmcnt(20)
    s_branch L_tb33_4
L_th36_4:
    s_waitcnt vmcnt(20)
    s_branch L_tb36_4
L_th39_4:
    s_waitcnt vmcnt(20)
    s_branch L_tb39_4
L_th42_4:
    s_waitcnt vmcnt(20)
    s_branch L_tb42_4
L_th45_4:
    s_waitcnt vmcnt(20)
    s_branch L_tb45_4
L_th0_4:
    s_waitcnt vmcnt(23)
    s_branch L_tb0_4
L_th3_4:
    s_waitcnt vmcnt(23)
    s_branch L_tb3_4
L_th6_4:
    s_waitcnt vmcnt(23)
    s_branch L_tb6_4
L_th9_4:
    s_waitcnt vmcnt(23)
    s_branch L_tb9_4
L_th12_4:
    s_waitcnt vmcnt(23)
    s_branch L_tb12_4
L_th15_4:
    s_waitcnt vmcnt(23)
    s_branch L_tb15_4
L_th18_4:
    s_waitcnt vmcnt(23)
    s_branch L_tb18_4
L_th21_4:
    s_waitcnt vmcnt(20)
    s_branch L_tb21_4
L_service:
    v_lshlrev_b32 v5, 2, v0
    v_mov_b32 v3, 0
    ds_write_b32 v5, v3 offset:0
    v_lshlrev_b32 v1, 4, v0
    v_mov_b32 v2, v1
    v_lshlrev_b32 v28, 11, v0
    v_mov_b32 v4, 0
    v_mov_b32 v9, 0xf149f2ca
    v_cndmask_b32 v9, v9, v3, s[66:67]
    v_and_b32 v5, 15, v0
    v_lshrrev_b32 v6, 4, v0
    v_lshl_add_u32 v10, v5, 2, v6
    v_lshlrev_b32 v10, 1, v10
    s_getreg_b32 s72, hwreg(HW_REG_XCC_ID)
    s_and_b32 s72, s72, 15
    s_lshl_b32 s77, s2, 11
    s_add_u32 s77, s77, 2097152
    s_lshl_b32 s94, s79, 17
    s_add_u32 s94, s94, 2097152
    s_mov_b32 s71, 0
    s_mov_b32 s76, 0
    s_mov_b32 s95, 0
    s_waitcnt lgkmcnt(0)
    s_barrier
    s_mov_b32 s52, s22
    s_and_b32 s53, s23, 0xffff
    s_mov_b32 s54, 25165824
    s_mov_b32 s55, 0x00020000
    s_mov_b32 s56, s18
    s_and_b32 s57, s19, 0xffff
    s_mov_b32 s58, 12288
    s_mov_b32 s59, 0x00020000
L_poll:
    ds_read_b32 v5, v4
    s_waitcnt lgkmcnt(0)
    v_readfirstlane_b32 s80, v5
    s_cmp_eq_u32 s80, 0
    s_cbranch_scc1 L_poll
    ds_read_b128 v[12:15], v2 offset:3328
    s_cmp_lg_u32 s71, 0
    s_cbranch_scc1 L_guard
L_tag:
    ds_read_b32 v5, v3 offset:136
    s_waitcnt lgkmcnt(0)
    v_readfirstlane_b32 s69, v5
    s_cmp_eq_u32 s69, 0
    s_cbranch_scc1 L_tag
    s_lshl_b32 s81, s79, 17
    s_lshr_b32 s82, s3, 6
    s_lshl_b32 s82, s82, 17
L_reg:
    buffer_load_dwordx2 v[16:17], v28, s[52:55], s81 offen offset:1536 sc0 sc1
    buffer_load_dwordx2 v[18:19], v28, s[52:55], s82 offen offset:1536 sc0 sc1
    s_waitcnt vmcnt(0)
    v_cmp_ne_u32 vcc, s69, v17
    s_cmp_lg_u64 vcc, 0
    s_cbranch_scc1 L_reg
    v_cmp_ne_u32 vcc, s69, v19
    s_cmp_lg_u64 vcc, 0
    s_cbranch_scc1 L_reg
    ds_write_b32 v3, v17 offset:140
    s_mov_b32 s95, s69
    v_cmp_eq_u32 s[86:87], s72, v16
    v_lshlrev_b32 v7, v16, 1
    s_nop 1
    v_or_b32_dpp v7, v7, v7 row_ror:8 row_mask:0xf bank_mask:0xf
    s_nop 1
    v_or_b32_dpp v7, v7, v7 row_ror:4 row_mask:0xf bank_mask:0xf
    s_nop 1
    v_or_b32_dpp v7, v7, v7 row_ror:2 row_mask:0xf bank_mask:0xf
    s_nop 1
    v_or_b32_dpp v7, v7, v7 row_ror:1 row_mask:0xf bank_mask:0xf
    v_mov_b32 v5, v7
    s_nop 1
    v_permlane32_swap_b32 v7, v5
    s_nop 1
    v_or_b32 v7, v7, v5
    v_mov_b32 v5, v7
    s_nop 1
    v_permlane16_swap_b32 v7, v5
    s_nop 1
    v_or_b32 v7, v7, v5
    s_bcnt1_i32_b64 s70, s[86:87]
    s_bfm_b64 s[84:85], s92, 0
    s_and_b64 s[84:85], s[84:85], s[86:87]
    s_bcnt1_i32_b64 s73, s[84:85]
    v_readfirstlane_b32 s88, v7
    s_mov_b32 s89, 0
    s_branch L_dep
L_guard:
    v_mov_b32 v17, s69
    s_mov_b64 exec, s[86:87]
    buffer_load_dwordx2 v[16:17], v28, s[52:55], s94 offen offset:1024 sc0 sc1
    s_mov_b64 exec, -1
    s_waitcnt vmcnt(0)
    v_cmp_eq_u32 vcc, s95, v17
    s_cmp_eq_u64 vcc, 0
    s_cbranch_scc1 L_guard
L_dep:
    s_add_u32 s71, s71, 1
    s_add_u32 s95, s95, 1
    s_waitcnt lgkmcnt(0)
    buffer_store_dwordx4 v[12:15], v1, s[52:55], s77 offen
    v_mov_b32 v6, s95
    s_mov_b64 exec, 1
    s_waitcnt vmcnt(0)
    buffer_store_dword v6, v3, s[52:55], s77 offen offset:1024
    s_mov_b64 exec, -1
    s_cmp_lg_u32 s76, s73
    s_cbranch_scc1 L_next
L_all:
    v_mov_b32 v16, s95
    s_mov_b64 exec, s[86:87]
    buffer_load_dword v16, v28, s[52:55], s94 offen offset:1024 sc0 sc1
    s_mov_b64 exec, -1
    s_waitcnt vmcnt(0)
    v_cmp_ne_u32 vcc, s95, v16
    s_cmp_lg_u64 vcc, 0
    s_cbranch_scc1 L_all
    s_mov_b32 s74, 0
    s_mov_b32 s75, s94
    s_mov_b64 s[84:85], s[86:87]
L_merge:
    v_mov_b32 v7, 0xf149f2ca
    v_mov_b32 v8, 0
    v_mov_b32 v12, 0
    v_mov_b32 v13, 0
    v_mov_b32 v14, 0
L_chunk:
    v_mov_b32 v48, 0
    v_mov_b32 v49, 0
    v_mov_b32 v50, 0
    v_mov_b32 v51, v9
    v_mov_b32 v52, 0
    v_mov_b32 v53, 0
    v_mov_b32 v54, 0
    v_mov_b32 v55, v9
    v_mov_b32 v56, 0
    v_mov_b32 v57, 0
    v_mov_b32 v58, 0
    v_mov_b32 v59, v9
    v_mov_b32 v60, 0
    v_mov_b32 v61, 0
    v_mov_b32 v62, 0
    v_mov_b32 v63, v9
    v_mov_b32 v64, 0
    v_mov_b32 v65, 0
    v_mov_b32 v66, 0
    v_mov_b32 v67, v9
    v_mov_b32 v68, 0
    v_mov_b32 v69, 0
    v_mov_b32 v70, 0
    v_mov_b32 v71, v9
    v_mov_b32 v72, 0
    v_mov_b32 v73, 0
    v_mov_b32 v74, 0
    v_mov_b32 v75, v9
    v_mov_b32 v76, 0
    v_mov_b32 v77, 0
    v_mov_b32 v78, 0
    v_mov_b32 v79, v9
    s_ff1_i32_b64 s80, s[84:85]
    s_bitset0_b64 s[84:85], s80
    s_lshl_b32 s81, s80, 11
    s_add_u32 s81, s81, s75
    s_cmp_ge_i32 s80, 0
    s_cselect_b64 exec, -1, 0
    buffer_load_dwordx4 v[48:51], v1, s[52:55], s81 offen sc0 sc1
    s_ff1_i32_b64 s80, s[84:85]
    s_bitset0_b64 s[84:85], s80
    s_lshl_b32 s81, s80, 11
    s_add_u32 s81, s81, s75
    s_cmp_ge_i32 s80, 0
    s_cselect_b64 exec, -1, 0
    buffer_load_dwordx4 v[52:55], v1, s[52:55], s81 offen sc0 sc1
    s_ff1_i32_b64 s80, s[84:85]
    s_bitset0_b64 s[84:85], s80
    s_lshl_b32 s81, s80, 11
    s_add_u32 s81, s81, s75
    s_cmp_ge_i32 s80, 0
    s_cselect_b64 exec, -1, 0
    buffer_load_dwordx4 v[56:59], v1, s[52:55], s81 offen sc0 sc1
    s_ff1_i32_b64 s80, s[84:85]
    s_bitset0_b64 s[84:85], s80
    s_lshl_b32 s81, s80, 11
    s_add_u32 s81, s81, s75
    s_cmp_ge_i32 s80, 0
    s_cselect_b64 exec, -1, 0
    buffer_load_dwordx4 v[60:63], v1, s[52:55], s81 offen sc0 sc1
    s_ff1_i32_b64 s80, s[84:85]
    s_bitset0_b64 s[84:85], s80
    s_lshl_b32 s81, s80, 11
    s_add_u32 s81, s81, s75
    s_cmp_ge_i32 s80, 0
    s_cselect_b64 exec, -1, 0
    buffer_load_dwordx4 v[64:67], v1, s[52:55], s81 offen sc0 sc1
    s_ff1_i32_b64 s80, s[84:85]
    s_bitset0_b64 s[84:85], s80
    s_lshl_b32 s81, s80, 11
    s_add_u32 s81, s81, s75
    s_cmp_ge_i32 s80, 0
    s_cselect_b64 exec, -1, 0
    buffer_load_dwordx4 v[68:71], v1, s[52:55], s81 offen sc0 sc1
    s_ff1_i32_b64 s80, s[84:85]
    s_bitset0_b64 s[84:85], s80
    s_lshl_b32 s81, s80, 11
    s_add_u32 s81, s81, s75
    s_cmp_ge_i32 s80, 0
    s_cselect_b64 exec, -1, 0
    buffer_load_dwordx4 v[72:75], v1, s[52:55], s81 offen sc0 sc1
    s_ff1_i32_b64 s80, s[84:85]
    s_bitset0_b64 s[84:85], s80
    s_lshl_b32 s81, s80, 11
    s_add_u32 s81, s81, s75
    s_cmp_ge_i32 s80, 0
    s_cselect_b64 exec, -1, 0
    buffer_load_dwordx4 v[76:79], v1, s[52:55], s81 offen sc0 sc1
    s_mov_b64 exec, -1
    s_waitcnt vmcnt(0)
    v_max3_f32 v5, v51, v55, v59
    v_max3_f32 v5, v5, v63, v67
    v_max3_f32 v5, v5, v71, v75
    v_max_f32 v5, v5, v79
    s_nop 1
    v_max_f32_dpp v6, v5, v7 quad_perm:[0,0,2,2] row_mask:0xf bank_mask:0xf
    v_sub_f32 v5, v7, v6
    v_exp_f32 v5, v5
    v_sub_f32_dpp v20, v51, v6 quad_perm:[0,0,2,2] row_mask:0xf bank_mask:0xf
    v_sub_f32_dpp v21, v55, v6 quad_perm:[0,0,2,2] row_mask:0xf bank_mask:0xf
    v_sub_f32_dpp v22, v59, v6 quad_perm:[0,0,2,2] row_mask:0xf bank_mask:0xf
    v_sub_f32_dpp v23, v63, v6 quad_perm:[0,0,2,2] row_mask:0xf bank_mask:0xf
    v_sub_f32_dpp v24, v67, v6 quad_perm:[0,0,2,2] row_mask:0xf bank_mask:0xf
    v_sub_f32_dpp v25, v71, v6 quad_perm:[0,0,2,2] row_mask:0xf bank_mask:0xf
    v_sub_f32_dpp v26, v75, v6 quad_perm:[0,0,2,2] row_mask:0xf bank_mask:0xf
    v_sub_f32_dpp v27, v79, v6 quad_perm:[0,0,2,2] row_mask:0xf bank_mask:0xf
    v_exp_f32 v20, v20
    v_exp_f32 v21, v21
    v_exp_f32 v22, v22
    v_exp_f32 v23, v23
    v_exp_f32 v24, v24
    v_exp_f32 v25, v25
    v_exp_f32 v26, v26
    v_exp_f32 v27, v27
    v_mov_b32 v7, v6
    v_mul_f32 v8, v8, v5
    v_mul_f32 v12, v12, v5
    v_mul_f32 v13, v13, v5
    v_mul_f32 v14, v14, v5
    v_fmac_f32 v12, v20, v48
    v_fmac_f32 v13, v20, v49
    v_fmac_f32 v14, v20, v50
    v_fmac_f32 v8, v20, v51
    v_fmac_f32 v12, v21, v52
    v_fmac_f32 v13, v21, v53
    v_fmac_f32 v14, v21, v54
    v_fmac_f32 v8, v21, v55
    v_fmac_f32 v12, v22, v56
    v_fmac_f32 v13, v22, v57
    v_fmac_f32 v14, v22, v58
    v_fmac_f32 v8, v22, v59
    v_fmac_f32 v12, v23, v60
    v_fmac_f32 v13, v23, v61
    v_fmac_f32 v14, v23, v62
    v_fmac_f32 v8, v23, v63
    v_fmac_f32 v12, v24, v64
    v_fmac_f32 v13, v24, v65
    v_fmac_f32 v14, v24, v66
    v_fmac_f32 v8, v24, v67
    v_fmac_f32 v12, v25, v68
    v_fmac_f32 v13, v25, v69
    v_fmac_f32 v14, v25, v70
    v_fmac_f32 v8, v25, v71
    v_fmac_f32 v12, v26, v72
    v_fmac_f32 v13, v26, v73
    v_fmac_f32 v14, v26, v74
    v_fmac_f32 v8, v26, v75
    v_fmac_f32 v12, v27, v76
    v_fmac_f32 v13, v27, v77
    v_fmac_f32 v14, v27, v78
    v_fmac_f32 v8, v27, v79
    s_cmp_lg_u64 s[84:85], 0
    s_cbranch_scc1 L_chunk
    s_cmp_lg_u32 s74, 0
    s_cbranch_scc1 L_fin
    v_cndmask_b32 v15, v7, v8, s[66:67]
    v_mov_b32 v5, s95
    v_mov_b32 v6, s70
    s_lshl_b32 s75, s79, 15
    s_add_u32 s75, s75, 1048576
    s_lshl_b32 s80, s72, 11
    s_add_u32 s80, s80, s75
    buffer_store_dwordx4 v[12:15], v1, s[52:55], s80 offen sc0 sc1
    s_mov_b64 exec, 1
    buffer_store_dword v5, v3, s[52:55], s77 offen offset:1028
    s_lshl_b32 s80, s79, 8
    s_add_u32 s80, s80, 23076864
    s_waitcnt vmcnt(0)
    buffer_atomic_add v6, v3, s[52:55], s80 offen sc0 sc1
    s_waitcnt vmcnt(0)
    s_mov_b64 exec, -1
    v_readfirstlane_b32 s80, v6
    s_add_u32 s80, s80, s70
    s_cmp_lg_u32 s80, 64
    s_cbranch_scc1 L_next
    s_mov_b32 s74, 1
    s_mov_b64 s[84:85], s[88:89]
    s_branch L_merge
L_fin:
    s_nop 1
    v_mov_b32_dpp v5, v8 quad_perm:[1,1,3,3] row_mask:0xf bank_mask:0xf
    v_rcp_f32 v5, v5
    s_mul_i32 s80, s79, 384
    v_mul_f32 v12, v12, v5
    v_mul_f32 v13, v13, v5
    v_mul_f32 v14, v14, v5
    v_cvt_pk_bf16_f32 v12, v12, v12
    v_cvt_pk_bf16_f32 v13, v13, v13
    v_cvt_pk_bf16_f32 v14, v14, v14
    buffer_store_short v12, v10, s[56:59], s80 offen offset:0
    buffer_store_short v13, v10, s[56:59], s80 offen offset:128
    buffer_store_short v14, v10, s[56:59], s80 offen offset:256
L_next:
    v_add_u32 v2, 1024, v2
    v_add_u32 v4, 4, v4
    s_add_u32 s79, s79, 4
    s_add_u32 s76, s76, 1
    s_cmp_eq_u32 s76, s70
    s_cselect_b32 s76, 0, s76
    s_cmp_lt_u32 s71, 7
    s_cbranch_scc1 L_poll
    s_and_b32 s92, s3, 63
    s_lshr_b32 s78, s92, 4
    s_lshr_b32 s81, s3, 6
    s_add_u32 s79, s81, 28
    s_mul_i32 s80, s78, 5
    s_mul_i32 s82, s81, 3
    s_add_u32 s80, s80, s82
    s_add_u32 s80, s80, 1
    s_xor_b32 s80, s80, s92
    s_and_b32 s80, s80, 15
    s_cbranch_scc1 L_end
    s_lshl_b32 s75, s81, 17
    v_and_b32 v5, 15, v0
    v_lshrrev_b32 v6, 4, v0
    v_lshlrev_b32 v28, 11, v6
    v_lshl_add_u32 v44, v5, 13, v28
    v_lshl_add_u32 v28, v5, 4, v28
    s_lshl_b32 s80, s78, 8
    v_add_u32 v28, s80, v28
    v_add_u32 v29, 8192, v28
    v_add_u32 v30, 16384, v28
    v_add_u32 v31, 24576, v28
    v_add_u32 v32, 32768, v28
    v_add_u32 v33, 40960, v28
    v_add_u32 v34, 49152, v28
    v_add_u32 v35, 57344, v28
    v_add_u32 v36, 65536, v28
    v_add_u32 v37, 73728, v28
    v_add_u32 v38, 81920, v28
    v_add_u32 v39, 90112, v28
    v_add_u32 v40, 98304, v28
    v_add_u32 v41, 106496, v28
    v_add_u32 v42, 114688, v28
    v_add_u32 v43, 122880, v28
    v_mov_b32 v51, 0
    v_mov_b32 v55, 0
    v_mov_b32 v59, 0
    v_mov_b32 v63, 0
    v_mov_b32 v67, 0
    v_mov_b32 v71, 0
    v_mov_b32 v75, 0
    v_mov_b32 v79, 0
    v_mov_b32 v83, 0
    v_mov_b32 v87, 0
    v_mov_b32 v91, 0
    v_mov_b32 v95, 0
    v_mov_b32 v99, 0
    v_mov_b32 v103, 0
    v_mov_b32 v107, 0
    v_mov_b32 v111, 0
    v_mov_b32 v19, 0
    v_lshlrev_b32 v10, 3, v5
    s_lshl_b32 s80, s78, 1
    s_mul_i32 s78, s79, 384
    s_add_u32 s78, s78, s80
L_dt:
    ds_read_b32 v5, v3 offset:144
    s_waitcnt lgkmcnt(0)
    v_readfirstlane_b32 s80, v5
    s_cmp_eq_u32 s80, 0
    s_cbranch_scc1 L_dt
L_pp:
    v_cmp_ne_u32 s[24:25], s69, v51
    v_cmp_ne_u32 s[26:27], s69, v55
    v_cmp_ne_u32 s[28:29], s69, v59
    v_cmp_ne_u32 s[30:31], s69, v63
    v_cmp_ne_u32 s[32:33], s69, v67
    v_cmp_ne_u32 s[34:35], s69, v71
    v_cmp_ne_u32 s[36:37], s69, v75
    v_cmp_ne_u32 s[38:39], s69, v79
    v_cmp_ne_u32 s[40:41], s69, v83
    v_cmp_ne_u32 s[42:43], s69, v87
    v_cmp_ne_u32 s[44:45], s69, v91
    v_cmp_ne_u32 s[46:47], s69, v95
    v_cmp_ne_u32 s[48:49], s69, v99
    v_cmp_ne_u32 s[50:51], s69, v103
    v_cmp_ne_u32 s[4:5], s69, v107
    v_cmp_ne_u32 s[6:7], s69, v111
    v_cmp_ne_u32 s[8:9], s69, v19
    s_or_b64 s[90:91], s[24:25], s[26:27]
    s_or_b64 s[90:91], s[90:91], s[28:29]
    s_or_b64 s[90:91], s[90:91], s[30:31]
    s_or_b64 s[90:91], s[90:91], s[32:33]
    s_or_b64 s[90:91], s[90:91], s[34:35]
    s_or_b64 s[90:91], s[90:91], s[36:37]
    s_or_b64 s[90:91], s[90:91], s[38:39]
    s_or_b64 s[90:91], s[90:91], s[40:41]
    s_or_b64 s[90:91], s[90:91], s[42:43]
    s_or_b64 s[90:91], s[90:91], s[44:45]
    s_or_b64 s[90:91], s[90:91], s[46:47]
    s_or_b64 s[90:91], s[90:91], s[48:49]
    s_or_b64 s[90:91], s[90:91], s[50:51]
    s_or_b64 s[90:91], s[90:91], s[4:5]
    s_or_b64 s[90:91], s[90:91], s[6:7]
    s_or_b64 s[90:91], s[90:91], s[8:9]
    s_cbranch_scc0 L_pd
    s_mov_b64 exec, s[8:9]
    buffer_load_dwordx4 v[16:19], v44, s[52:55], s75 offen offset:1024 sc0 sc1
    s_mov_b64 exec, s[24:25]
    buffer_load_dwordx4 v[48:51], v28, s[52:55], s75 offen offset:0 sc0 sc1
    s_mov_b64 exec, s[26:27]
    buffer_load_dwordx4 v[52:55], v29, s[52:55], s75 offen offset:0 sc0 sc1
    s_mov_b64 exec, s[28:29]
    buffer_load_dwordx4 v[56:59], v30, s[52:55], s75 offen offset:0 sc0 sc1
    s_mov_b64 exec, s[30:31]
    buffer_load_dwordx4 v[60:63], v31, s[52:55], s75 offen offset:0 sc0 sc1
    s_mov_b64 exec, s[32:33]
    buffer_load_dwordx4 v[64:67], v32, s[52:55], s75 offen offset:0 sc0 sc1
    s_mov_b64 exec, s[34:35]
    buffer_load_dwordx4 v[68:71], v33, s[52:55], s75 offen offset:0 sc0 sc1
    s_mov_b64 exec, s[36:37]
    buffer_load_dwordx4 v[72:75], v34, s[52:55], s75 offen offset:0 sc0 sc1
    s_mov_b64 exec, s[38:39]
    buffer_load_dwordx4 v[76:79], v35, s[52:55], s75 offen offset:0 sc0 sc1
    s_mov_b64 exec, s[40:41]
    buffer_load_dwordx4 v[80:83], v36, s[52:55], s75 offen offset:0 sc0 sc1
    s_mov_b64 exec, s[42:43]
    buffer_load_dwordx4 v[84:87], v37, s[52:55], s75 offen offset:0 sc0 sc1
    s_mov_b64 exec, s[44:45]
    buffer_load_dwordx4 v[88:91], v38, s[52:55], s75 offen offset:0 sc0 sc1
    s_mov_b64 exec, s[46:47]
    buffer_load_dwordx4 v[92:95], v39, s[52:55], s75 offen offset:0 sc0 sc1
    s_mov_b64 exec, s[48:49]
    buffer_load_dwordx4 v[96:99], v40, s[52:55], s75 offen offset:0 sc0 sc1
    s_mov_b64 exec, s[50:51]
    buffer_load_dwordx4 v[100:103], v41, s[52:55], s75 offen offset:0 sc0 sc1
    s_mov_b64 exec, s[4:5]
    buffer_load_dwordx4 v[104:107], v42, s[52:55], s75 offen offset:0 sc0 sc1
    s_mov_b64 exec, s[6:7]
    buffer_load_dwordx4 v[108:111], v43, s[52:55], s75 offen offset:0 sc0 sc1
    s_mov_b64 exec, -1
    s_waitcnt vmcnt(0)
    s_branch L_pp
L_pd:
    v_mov_b32 v7, v16
    s_nop 1
    v_max_f32_dpp v7, v7, v7 row_ror:8 row_mask:0xf bank_mask:0xf
    s_nop 1
    v_max_f32_dpp v7, v7, v7 row_ror:4 row_mask:0xf bank_mask:0xf
    s_nop 1
    v_max_f32_dpp v7, v7, v7 row_ror:2 row_mask:0xf bank_mask:0xf
    s_nop 1
    v_max_f32_dpp v7, v7, v7 row_ror:1 row_mask:0xf bank_mask:0xf
    v_mov_b32 v5, v7
    s_nop 1
    v_permlane32_swap_b32 v7, v5
    s_nop 1
    v_max_f32 v7, v7, v5
    v_mov_b32 v5, v7
    s_nop 1
    v_permlane16_swap_b32 v7, v5
    s_nop 1
    v_max_f32 v7, v7, v5
    v_sub_f32 v6, v16, v7
    v_exp_f32 v6, v6
    v_mov_b32 v12, 0
    v_mov_b32 v13, 0
    v_mov_b32 v14, 0
    v_mul_f32 v8, v6, v17
    v_fmac_f32_dpp v12, v6, v48 row_newbcast:0 row_mask:0xf bank_mask:0xf
    v_fmac_f32_dpp v13, v6, v49 row_newbcast:0 row_mask:0xf bank_mask:0xf
    v_fmac_f32_dpp v14, v6, v50 row_newbcast:0 row_mask:0xf bank_mask:0xf
    v_fmac_f32_dpp v12, v6, v52 row_newbcast:1 row_mask:0xf bank_mask:0xf
    v_fmac_f32_dpp v13, v6, v53 row_newbcast:1 row_mask:0xf bank_mask:0xf
    v_fmac_f32_dpp v14, v6, v54 row_newbcast:1 row_mask:0xf bank_mask:0xf
    v_fmac_f32_dpp v12, v6, v56 row_newbcast:2 row_mask:0xf bank_mask:0xf
    v_fmac_f32_dpp v13, v6, v57 row_newbcast:2 row_mask:0xf bank_mask:0xf
    v_fmac_f32_dpp v14, v6, v58 row_newbcast:2 row_mask:0xf bank_mask:0xf
    v_fmac_f32_dpp v12, v6, v60 row_newbcast:3 row_mask:0xf bank_mask:0xf
    v_fmac_f32_dpp v13, v6, v61 row_newbcast:3 row_mask:0xf bank_mask:0xf
    v_fmac_f32_dpp v14, v6, v62 row_newbcast:3 row_mask:0xf bank_mask:0xf
    v_fmac_f32_dpp v12, v6, v64 row_newbcast:4 row_mask:0xf bank_mask:0xf
    v_fmac_f32_dpp v13, v6, v65 row_newbcast:4 row_mask:0xf bank_mask:0xf
    v_fmac_f32_dpp v14, v6, v66 row_newbcast:4 row_mask:0xf bank_mask:0xf
    v_fmac_f32_dpp v12, v6, v68 row_newbcast:5 row_mask:0xf bank_mask:0xf
    v_fmac_f32_dpp v13, v6, v69 row_newbcast:5 row_mask:0xf bank_mask:0xf
    v_fmac_f32_dpp v14, v6, v70 row_newbcast:5 row_mask:0xf bank_mask:0xf
    v_fmac_f32_dpp v12, v6, v72 row_newbcast:6 row_mask:0xf bank_mask:0xf
    v_fmac_f32_dpp v13, v6, v73 row_newbcast:6 row_mask:0xf bank_mask:0xf
    v_fmac_f32_dpp v14, v6, v74 row_newbcast:6 row_mask:0xf bank_mask:0xf
    v_fmac_f32_dpp v12, v6, v76 row_newbcast:7 row_mask:0xf bank_mask:0xf
    v_fmac_f32_dpp v13, v6, v77 row_newbcast:7 row_mask:0xf bank_mask:0xf
    v_fmac_f32_dpp v14, v6, v78 row_newbcast:7 row_mask:0xf bank_mask:0xf
    v_fmac_f32_dpp v12, v6, v80 row_newbcast:8 row_mask:0xf bank_mask:0xf
    v_fmac_f32_dpp v13, v6, v81 row_newbcast:8 row_mask:0xf bank_mask:0xf
    v_fmac_f32_dpp v14, v6, v82 row_newbcast:8 row_mask:0xf bank_mask:0xf
    v_fmac_f32_dpp v12, v6, v84 row_newbcast:9 row_mask:0xf bank_mask:0xf
    v_fmac_f32_dpp v13, v6, v85 row_newbcast:9 row_mask:0xf bank_mask:0xf
    v_fmac_f32_dpp v14, v6, v86 row_newbcast:9 row_mask:0xf bank_mask:0xf
    v_fmac_f32_dpp v12, v6, v88 row_newbcast:10 row_mask:0xf bank_mask:0xf
    v_fmac_f32_dpp v13, v6, v89 row_newbcast:10 row_mask:0xf bank_mask:0xf
    v_fmac_f32_dpp v14, v6, v90 row_newbcast:10 row_mask:0xf bank_mask:0xf
    v_fmac_f32_dpp v12, v6, v92 row_newbcast:11 row_mask:0xf bank_mask:0xf
    v_fmac_f32_dpp v13, v6, v93 row_newbcast:11 row_mask:0xf bank_mask:0xf
    v_fmac_f32_dpp v14, v6, v94 row_newbcast:11 row_mask:0xf bank_mask:0xf
    v_fmac_f32_dpp v12, v6, v96 row_newbcast:12 row_mask:0xf bank_mask:0xf
    v_fmac_f32_dpp v13, v6, v97 row_newbcast:12 row_mask:0xf bank_mask:0xf
    v_fmac_f32_dpp v14, v6, v98 row_newbcast:12 row_mask:0xf bank_mask:0xf
    v_fmac_f32_dpp v12, v6, v100 row_newbcast:13 row_mask:0xf bank_mask:0xf
    v_fmac_f32_dpp v13, v6, v101 row_newbcast:13 row_mask:0xf bank_mask:0xf
    v_fmac_f32_dpp v14, v6, v102 row_newbcast:13 row_mask:0xf bank_mask:0xf
    v_fmac_f32_dpp v12, v6, v104 row_newbcast:14 row_mask:0xf bank_mask:0xf
    v_fmac_f32_dpp v13, v6, v105 row_newbcast:14 row_mask:0xf bank_mask:0xf
    v_fmac_f32_dpp v14, v6, v106 row_newbcast:14 row_mask:0xf bank_mask:0xf
    v_fmac_f32_dpp v12, v6, v108 row_newbcast:15 row_mask:0xf bank_mask:0xf
    v_fmac_f32_dpp v13, v6, v109 row_newbcast:15 row_mask:0xf bank_mask:0xf
    v_fmac_f32_dpp v14, v6, v110 row_newbcast:15 row_mask:0xf bank_mask:0xf
    s_nop 1
    v_add_f32_dpp v8, v8, v8 row_ror:8 row_mask:0xf bank_mask:0xf
    s_nop 1
    v_add_f32_dpp v8, v8, v8 row_ror:4 row_mask:0xf bank_mask:0xf
    s_nop 1
    v_add_f32_dpp v8, v8, v8 row_ror:2 row_mask:0xf bank_mask:0xf
    s_nop 1
    v_add_f32_dpp v8, v8, v8 row_ror:1 row_mask:0xf bank_mask:0xf
    v_mov_b32 v5, v8
    s_nop 1
    v_permlane32_swap_b32 v8, v5
    s_nop 1
    v_add_f32 v8, v8, v5
    v_mov_b32 v5, v8
    s_nop 1
    v_permlane16_swap_b32 v8, v5
    s_nop 1
    v_add_f32 v8, v8, v5
    v_rcp_f32 v8, v8
    v_mov_b32 v20, v12
    v_mov_b32 v21, v13
    v_mov_b32 v22, v14
    s_nop 1
    v_permlane32_swap_b32 v12, v20
    v_permlane32_swap_b32 v13, v21
    v_permlane32_swap_b32 v14, v22
    s_nop 1
    v_add_f32 v12, v12, v20
    v_add_f32 v13, v13, v21
    v_add_f32 v14, v14, v22
    v_mov_b32 v20, v12
    v_mov_b32 v21, v13
    v_mov_b32 v22, v14
    s_nop 1
    v_permlane16_swap_b32 v12, v20
    v_permlane16_swap_b32 v13, v21
    v_permlane16_swap_b32 v14, v22
    s_nop 1
    v_add_f32 v12, v12, v20
    v_add_f32 v13, v13, v21
    v_add_f32 v14, v14, v22
    v_mul_f32 v12, v12, v8
    v_mul_f32 v13, v13, v8
    v_mul_f32 v14, v14, v8
    v_cvt_pk_bf16_f32 v12, v12, v12
    v_cvt_pk_bf16_f32 v13, v13, v13
    v_cvt_pk_bf16_f32 v14, v14, v14
    s_mov_b64 exec, 0xffff
    buffer_store_short v12, v10, s[56:59], s78 offen offset:0
    buffer_store_short v13, v10, s[56:59], s78 offen offset:128
    buffer_store_short v14, v10, s[56:59], s78 offen offset:256
L_end:
    s_endpgm
L_ticket:
    v_lshlrev_b32 v1, 2, v0
    v_mov_b32 v2, 0
    v_lshlrev_b32 v4, 4, v0
    v_mov_b32 v8, -1
    v_mov_b32 v9, -1
    v_mov_b32 v10, -1
    v_mov_b32 v11, -1
    ds_write_b128 v4, v[8:11] offset:256
    ds_write_b128 v4, v[8:11] offset:1280
    ds_write_b128 v4, v[8:11] offset:2304
    s_memrealtime s[80:81]
    s_waitcnt lgkmcnt(0)
    s_barrier
    s_mov_b32 s52, s22
    s_and_b32 s53, s23, 0xffff
    s_mov_b32 s54, 25165824
    s_mov_b32 s55, 0x00020000
    s_mov_b32 s60, s20
    s_and_b32 s61, s21, 0xffff
    s_mov_b32 s62, 256
    s_mov_b32 s63, 0x00020000
    s_max_u32 s69, s80, 1
    s_cmp_lg_u32 s2, 0
    s_cbranch_scc1 L_kd
    v_lshlrev_b32 v5, 8, v0
    s_mov_b32 s80, 23068672
    buffer_store_dword v2, v5, s[52:55], s80 offen sc0 sc1
    v_mov_b32 v3, s69
    s_mov_b64 exec, 1
    s_waitcnt vmcnt(0)
    buffer_store_dword v3, v2, s[60:63], 0 offen sc0 sc1
    s_mov_b64 exec, -1
L_kd:
    ds_read_b32 v3, v2 offset:128
    s_waitcnt lgkmcnt(0)
    v_readfirstlane_b32 s80, v3
    s_cmp_eq_u32 s80, 0
    s_cbranch_scc1 L_kd
    ds_read_b128 v[8:11], v4 offset:26880
    s_lshl_b32 s80, s2, 11
    s_add_u32 s80, s80, 18874368
    s_waitcnt lgkmcnt(0)
    buffer_store_dwordx4 v[8:11], v4, s[52:55], s80 offen offset:0 sc0 sc1
    s_mov_b64 exec, -1
L_tg:
    buffer_load_dword v3, v2, s[60:63], 0 offen sc0 sc1
    s_waitcnt vmcnt(0)
    v_readfirstlane_b32 s69, v3
    s_cmp_eq_u32 s69, 0
    s_cbranch_scc1 L_tg
    ds_write_b32 v2, v3 offset:136
    s_getreg_b32 s81, hwreg(HW_REG_XCC_ID)
    s_and_b32 s81, s81, 15
    v_mov_b32 v16, s81
    v_mov_b32 v17, s69
    s_lshl_b32 s80, s2, 11
    s_mov_b64 exec, 1
    buffer_store_dwordx2 v[16:17], v2, s[52:55], s80 offen offset:1536 sc0 sc1
    s_lshr_b32 s82, s3, 6
    s_lshl_b32 s82, s82, 8
    s_add_u32 s82, s82, 23068672
    s_mov_b64 exec, -1
    s_mov_b32 s70, 1
    s_mov_b32 s71, 0
    s_mov_b32 s72, 1
    v_add_u32 v5, 260, v1
    v_lshlrev_b32 v4, 6, v0
L_rq0:
    s_mov_b64 exec, 1
L_rq:
    ds_read_b32 v3, v2 offset:132
    s_waitcnt lgkmcnt(0)
    v_readfirstlane_b32 s80, v3
    s_cmp_lt_u32 s80, s70
    s_cbranch_scc1 L_rq
    v_mov_b32 v3, 1
    buffer_atomic_add v3, v2, s[52:55], s82 offen sc0 sc1
    s_waitcnt vmcnt(0)
    v_readfirstlane_b32 s71, v3
L_have:
    s_lshr_b32 s80, s71, 6
    s_min_u32 s80, s80, 4
    s_lshl_b32 s80, s80, 2
    s_lshr_b32 s81, 0x43210, s80
    s_lshr_b32 s80, 0x11111, s80
    s_and_b32 s81, s81, 15
    s_and_b32 s80, s80, 15
    s_lshl_b32 s81, s81, 6
    s_and_b32 s83, s71, 63
    s_add_u32 s81, s81, s83
    s_bfm_b64 exec, s80, 0
    v_add_u32 v3, s81, v4
    ds_write_b32 v5, v3
    s_mov_b64 exec, -1
    s_add_u32 s70, s70, s80
    s_lshl_b32 s80, s80, 2
    v_add_u32 v5, s80, v5
    s_cmp_lt_u32 s71, 256
    s_cbranch_scc1 L_rq0
    s_endpgm
L_ctl:
    v_lshlrev_b32 v1, 2, v0
    v_mov_b32 v2, 0
    ds_write_b32 v1, v2 offset:28160
    s_and_b32 s70, s2, 31
    s_lshl_b32 s70, s70, 2
    s_mov_b32 s71, 1
    s_waitcnt lgkmcnt(0)
    s_barrier
    s_mov_b32 s60, s20
    s_and_b32 s61, s21, 0xffff
    s_mov_b32 s62, 256
    s_mov_b32 s63, 0x00020000
    s_mov_b32 s32, s10
    s_and_b32 s33, s11, 0xffff
    s_mov_b32 s34, 6291456
    s_mov_b32 s35, 0x00020000
    s_mov_b32 s36, s12
    s_and_b32 s37, s13, 0xffff
    s_mov_b32 s38, 6291456
    s_mov_b32 s39, 0x00020000
    s_mov_b32 s40, s14
    s_and_b32 s41, s15, 0xffff
    s_mov_b32 s42, 2097152
    s_mov_b32 s43, 0x00020000
    s_mov_b32 s44, s16
    s_and_b32 s45, s17, 0xffff
    s_mov_b32 s46, 2097152
    s_mov_b32 s47, 0x00020000
    v_cmp_le_u32 vcc, 56, v0
    v_cmp_gt_u32 s[80:81], 60, v0
    s_and_b64 vcc, vcc, s[80:81]
    v_mov_b32 v7, s2
    v_mov_b32 v8, s3
    v_cndmask_b32 v7, v7, v8, vcc
    v_lshrrev_b32 v8, 6, v7
    v_lshrrev_b32 v9, 3, v0
    v_lshl_add_u32 v8, v9, 2, v8
    v_and_b32 v9, 7, v0
    v_lshl_add_u32 v8, v8, 3, v9
    v_and_b32 v9, 3, v7
    v_lshl_add_u32 v8, v8, 2, v9
    v_bfe_u32 v9, v7, 2, 4
    v_lshl_add_u32 v8, v8, 4, v9
    v_mul_u32_u24 v9, 384, v8
    v_lshlrev_b32 v8, 7, v8
    buffer_load_dword v10, v9, s[32:35], 0 offen offset:0
    buffer_load_dword v11, v9, s[32:35], 0 offen offset:128
    buffer_load_dword v12, v9, s[32:35], 0 offen offset:256
    buffer_load_dword v13, v9, s[36:39], 0 offen offset:0
    buffer_load_dword v14, v9, s[36:39], 0 offen offset:128
    buffer_load_dword v15, v9, s[36:39], 0 offen offset:256
    buffer_load_dword v16, v8, s[40:43], 0 offen offset:0
    buffer_load_dword v17, v8, s[44:47], 0 offen offset:0
L_c:
    ds_read_b32 v3, v2 offset:28160
    ds_read_b32 v4, v2 offset:144
    s_mov_b64 exec, 1
    s_waitcnt lgkmcnt(0)
    v_add_u32 v3, 1, v3
    buffer_store_dword v3, v2, s[60:63], s70 offen offset:128
    s_mov_b64 exec, 0xffffffff
    buffer_load_dword v5, v1, s[60:63], 0 offen offset:128 sc1
    v_readfirstlane_b32 s72, v3
    v_readfirstlane_b32 s81, v4
    s_add_u32 s80, s71, s72
    s_mov_b32 s71, s72
    s_waitcnt vmcnt(0)
    v_cmp_ne_u32 vcc, 0, v5
    v_add_u32_dpp v5, v5, v5 row_ror:8 row_mask:0xf bank_mask:0xf
    s_nop 1
    v_add_u32_dpp v5, v5, v5 row_ror:4 row_mask:0xf bank_mask:0xf
    s_nop 1
    v_add_u32_dpp v5, v5, v5 row_ror:2 row_mask:0xf bank_mask:0xf
    s_nop 1
    v_add_u32_dpp v5, v5, v5 row_ror:1 row_mask:0xf bank_mask:0xf
    s_bcnt1_i32_b64 s73, vcc
    s_mul_i32 s80, s80, s73
    v_readlane_b32 s74, v5, 0
    v_readlane_b32 s73, v5, 16
    s_add_u32 s74, s74, s73
    s_lshl_b32 s74, s74, 1
    s_cmp_gt_i32 s80, s74
    s_cselect_b32 s80, 1, 0
    v_mov_b32 v6, s80
    ds_write_b32 v2, v6 offset:148
    s_cmp_eq_u32 s81, 0
    s_cbranch_scc1 L_c
    s_endpgm
.section .rodata,"a"
.p2align 6
.amdhsa_kernel standalone__kv_cache_quant_int4_int2_kv_with_per_channel_or_per_token_scales__decode_kernel
  .amdhsa_next_free_vgpr 247
  .amdhsa_next_free_sgpr 102
  .amdhsa_accum_offset 248
  .amdhsa_float_denorm_mode_32 3
  .amdhsa_group_segment_fixed_size 0
  .amdhsa_kernarg_size 80
  .amdhsa_user_sgpr_count 2
  .amdhsa_user_sgpr_kernarg_segment_ptr 1
  .amdhsa_system_sgpr_workgroup_id_x 1
.end_amdhsa_kernel
```

```asm
; @launch grid=(256,1,1) block=(256,1,1) lds=98304
.amdgcn_target "amdgcn-amd-amdhsa--gfx950"
.text
.globl standalone__kv_cache_quant_int4_int2_kv_with_per_channel_or_per_token_scales__decode_kernel
.p2align 12
.type standalone__kv_cache_quant_int4_int2_kv_with_per_channel_or_per_token_scales__decode_kernel,@function
standalone__kv_cache_quant_int4_int2_kv_with_per_channel_or_per_token_scales__decode_kernel:
    s_cmp_ge_u32 s2, 256
    s_cbranch_scc1 L_end
    s_load_dwordx16 s[4:19], s[0:1], 0
    s_load_dwordx4 s[20:23], s[0:1], 64
    s_bfe_u32 s80, s2, 0x20003
    s_and_b32 s81, s2, 7
    s_lshr_b32 s3, s2, 5
    s_lshl_b32 s80, s80, 6
    s_lshl_b32 s81, s81, 3
    s_or_b32 s3, s3, s80
    s_or_b32 s3, s3, s81
    s_and_b32 s80, s2, 7
    s_lshr_b32 s2, s2, 3
    s_lshl_b32 s80, s80, 5
    s_or_b32 s2, s2, s80
    v_lshrrev_b32 v229, 6, v0
    v_and_b32 v0, 63, v0
    v_readfirstlane_b32 s68, v229
    s_lshr_b32 s79, s2, 6
    s_and_b32 s92, s2, 63
    s_mov_b32 s66, 0xaaaaaaaa
    s_mov_b32 s67, 0xaaaaaaaa
    s_cmp_eq_u32 s68, 1
    s_cbranch_scc1 L_service
    s_cmp_eq_u32 s68, 2
    s_cbranch_scc1 L_ticket
    s_cmp_eq_u32 s68, 3
    s_cbranch_scc1 L_ctl
    s_mov_b64 vcc, 0
    s_setprio 1
    v_and_b32 v235, 15, v0
    v_lshrrev_b32 v234, 4, v0
    v_mul_u32_u24 v1, 768, v234
    v_lshl_add_u32 v1, v235, 4, v1
    v_lshlrev_b32 v2, 3, v235
    v_bfrev_b32 v231, v235
    v_lshrrev_b32 v231, 28, v231
    v_and_b32 v232, 3, v231
    v_lshl_add_u32 v3, v232, 2, v234
    v_lshlrev_b32 v3, 1, v3
    v_lshrrev_b32 v231, 2, v231
    v_lshl_add_u32 v3, v231, 11, v3
    v_lshlrev_b32 v239, 2, v0
    v_add_u32 v240, 3840, v239
    v_add_u32 v239, 3584, v239
    v_lshlrev_b32 v241, 4, v0
    v_mov_b32 v242, 0
    v_mov_b32 v243, 1
    v_lshlrev_b32 v224, 2, v0
    v_mov_b32 v225, 1
    v_mov_b32 v226, 260
    s_mul_i32 s58, s79, 0
    s_and_b32 s94, s92, 448
    s_add_u32 s94, s94, s58
    s_add_u32 s94, s94, 320
    s_add_u32 s58, s58, s92
    s_and_b32 s58, s58, 511
    s_lshr_b32 s59, s3, 6
    s_lshl_b32 s69, s79, 9
    s_add_u32 s59, s59, 28
    s_lshl_b32 s59, s59, 9
    s_mov_b32 s64, 0xcccccccc
    s_mov_b32 s65, 0xcccccccc
    s_mov_b32 s60, 0x6fd53b95
    s_mov_b32 s62, 0x80000001
    s_mov_b32 s61, 0x6fd53b95
    s_mov_b32 s63, 0x80000001
    s_waitcnt lgkmcnt(0)
    s_mov_b32 s24, s6
    s_and_b32 s25, s7, 0xffff
    s_mov_b32 s26, 805306368
    s_mov_b32 s27, 0x00020000
    s_mov_b32 s48, s4
    s_and_b32 s49, s5, 0xffff
    s_mov_b32 s50, 12288
    s_mov_b32 s51, 0x00020000
    s_mov_b32 s32, s10
    s_and_b32 s33, s11, 0xffff
    s_mov_b32 s34, 6291456
    s_mov_b32 s35, 0x00020000
    s_mov_b32 s36, s12
    s_and_b32 s37, s13, 0xffff
    s_mov_b32 s38, 6291456
    s_mov_b32 s39, 0x00020000
    s_add_u32 s70, s69, s92
    s_mov_b32 s91, 1
    s_lshr_b32 s74, s70, 9
    s_mul_i32 s74, s74, 384
    buffer_load_dwordx2 v[192:193], v2, s[48:51], s74 offen offset:0
    buffer_load_dwordx2 v[194:195], v2, s[48:51], s74 offen offset:128
    buffer_load_dwordx2 v[196:197], v2, s[48:51], s74 offen offset:256
    s_and_b32 s80, s70, 63
    s_sub_u32 s72, s70, s80
    s_lshr_b32 s80, s80, 2
    s_add_u32 s72, s72, s80
    s_mul_i32 s72, s72, 384
    buffer_load_dwordx2 v[132:133], v2, s[32:35], s72 offen offset:0
    buffer_load_dwordx2 v[134:135], v2, s[32:35], s72 offen offset:128
    buffer_load_dwordx2 v[136:137], v2, s[32:35], s72 offen offset:256
    buffer_load_dwordx2 v[138:139], v2, s[36:39], s72 offen offset:0
    buffer_load_dwordx2 v[140:141], v2, s[36:39], s72 offen offset:128
    buffer_load_dwordx2 v[142:143], v2, s[36:39], s72 offen offset:256
    s_mul_i32 s71, s70, 49152
    s_and_b32 s80, s70, 63
    s_mul_i32 s80, s80, 36864
    s_sub_u32 s71, s71, s80
    buffer_load_dwordx4 v[4:7], v1, s[24:27], s71 offen offset:0 nt
    buffer_load_dwordx4 v[8:11], v1, s[24:27], s71 offen offset:256 nt
    buffer_load_dwordx4 v[12:15], v1, s[24:27], s71 offen offset:512 nt
    s_add_u32 s71, s71, 3072
    buffer_load_dwordx4 v[16:19], v1, s[24:27], s71 offen offset:0 nt
    s_add_u32 s72, s72, 6144
    buffer_load_dwordx2 v[156:157], v2, s[32:35], s72 offen offset:0
    buffer_load_dwordx2 v[158:159], v2, s[32:35], s72 offen offset:128
    buffer_load_dwordx2 v[160:161], v2, s[32:35], s72 offen offset:256
    buffer_load_dwordx2 v[162:163], v2, s[36:39], s72 offen offset:0
    buffer_load_dwordx2 v[164:165], v2, s[36:39], s72 offen offset:128
    buffer_load_dwordx2 v[166:167], v2, s[36:39], s72 offen offset:256
    buffer_load_dwordx4 v[20:23], v1, s[24:27], s71 offen offset:256 nt
    buffer_load_dwordx4 v[24:27], v1, s[24:27], s71 offen offset:512 nt
    s_add_u32 s71, s71, 3072
    buffer_load_dwordx4 v[28:31], v1, s[24:27], s71 offen offset:0 nt
    buffer_load_dwordx4 v[32:35], v1, s[24:27], s71 offen offset:256 nt
    buffer_load_dwordx4 v[36:39], v1, s[24:27], s71 offen offset:512 nt
    s_add_u32 s71, s71, 3072
    buffer_load_dwordx4 v[40:43], v1, s[24:27], s71 offen offset:0 nt
    buffer_load_dwordx4 v[44:47], v1, s[24:27], s71 offen offset:256 nt
    buffer_load_dwordx4 v[48:51], v1, s[24:27], s71 offen offset:512 nt
    s_add_u32 s71, s71, 777216
    buffer_load_dwordx4 v[52:55], v1, s[24:27], s71 offen offset:0 nt
    buffer_load_dwordx4 v[56:59], v1, s[24:27], s71 offen offset:256 nt
    buffer_load_dwordx4 v[60:63], v1, s[24:27], s71 offen offset:512 nt
    s_add_u32 s71, s71, 3072
    buffer_load_dwordx4 v[64:67], v1, s[24:27], s71 offen offset:0 nt
    s_add_u32 s72, s72, 6144
    buffer_load_dwordx2 v[168:169], v2, s[32:35], s72 offen offset:0
    buffer_load_dwordx2 v[170:171], v2, s[32:35], s72 offen offset:128
    buffer_load_dwordx2 v[172:173], v2, s[32:35], s72 offen offset:256
    buffer_load_dwordx2 v[174:175], v2, s[36:39], s72 offen offset:0
    buffer_load_dwordx2 v[176:177], v2, s[36:39], s72 offen offset:128
    buffer_load_dwordx2 v[178:179], v2, s[36:39], s72 offen offset:256
    buffer_load_dwordx4 v[68:71], v1, s[24:27], s71 offen offset:256 nt
    buffer_load_dwordx4 v[72:75], v1, s[24:27], s71 offen offset:512 nt
    s_add_u32 s71, s71, 3072
    buffer_load_dwordx4 v[76:79], v1, s[24:27], s71 offen offset:0 nt
    buffer_load_dwordx4 v[80:83], v1, s[24:27], s71 offen offset:256 nt
    buffer_load_dwordx4 v[84:87], v1, s[24:27], s71 offen offset:512 nt
    s_add_u32 s71, s71, 3072
    buffer_load_dwordx4 v[88:91], v1, s[24:27], s71 offen offset:0 nt
    buffer_load_dwordx4 v[92:95], v1, s[24:27], s71 offen offset:256 nt
    buffer_load_dwordx4 v[96:99], v1, s[24:27], s71 offen offset:512 nt
    s_mov_b32 s28, s8
    s_and_b32 s29, s9, 0xffff
    s_mov_b32 s30, 805306368
    s_mov_b32 s31, 0x00020000
    s_mov_b32 s40, s14
    s_and_b32 s41, s15, 0xffff
    s_mov_b32 s42, 2097152
    s_mov_b32 s43, 0x00020000
    s_mov_b32 s44, s16
    s_and_b32 s45, s17, 0xffff
    s_mov_b32 s46, 2097152
    s_mov_b32 s47, 0x00020000
    s_mov_b32 s52, s22
    s_and_b32 s53, s23, 0xffff
    s_mov_b32 s54, 25165824
    s_mov_b32 s55, 0x00020000
    v_mov_b32 v229, s2
    v_mov_b32 v232, 8
    v_and_b32 v231, 7, v0
    s_mov_b32 exec_lo, 0x0
    s_mov_b32 exec_hi, 0x1f000000
    v_mov_b32 v229, s3
    s_mov_b32 exec_lo, 0x0
    s_mov_b32 exec_hi, 0x700
    v_mov_b32 v232, 3
    s_mov_b32 exec_lo, 0x0
    s_mov_b32 exec_hi, 0xf800
    v_mov_b32 v232, 5
    s_mov_b32 exec_lo, 0x0
    s_mov_b32 exec_hi, 0xf800
    v_add_u32 v231, 9, v231
    s_mov_b64 exec, -1
    v_lshrrev_b32 v230, 6, v229
    v_mad_u32_u24 v231, v230, v232, v231
    v_lshrrev_b32 v232, 3, v0
    v_lshl_add_u32 v231, v232, 5, v231
    v_and_b32 v229, 63, v229
    v_lshl_add_u32 v245, v231, 6, v229
    s_mov_b32 s4, 0x1010100
    s_mov_b32 s5, 0x1018901
    s_cmp_eq_u32 s79, 1
    s_cselect_b32 s4, 0x1010100, s4
    s_cselect_b32 s5, 0x1010901, s5
    s_cmp_eq_u32 s79, 2
    s_cselect_b32 s4, 0x1010100, s4
    s_cselect_b32 s5, 0x1012d01, s5
    s_cmp_eq_u32 s79, 3
    s_cselect_b32 s4, 0x1010100, s4
    s_cselect_b32 s5, 0x1010901, s5
    s_mov_b32 s7, 0xf149f2ca
    v_mov_b32 v216, 0xf149f2ca
    v_mov_b32 v217, 0
    v_mov_b32 v218, 0
    v_mov_b32 v204, 0
    v_mov_b32 v205, 0
    v_mov_b32 v206, 0
    v_mov_b32 v207, 0
    v_mov_b32 v208, 0
    v_mov_b32 v209, 0
    v_mov_b32 v210, 0
    v_mov_b32 v211, 0
    v_mov_b32 v212, 0
    v_mov_b32 v213, 0
    v_mov_b32 v214, 0
    v_mov_b32 v215, 0
    s_barrier
    s_waitcnt vmcnt(36)
    v_lshlrev_b32 v108, 16, v192
    v_and_b32 v109, 0xffff0000, v192
    v_pk_mul_f32 v[108:109], v[108:109], s[60:61]
    v_lshlrev_b32 v110, 16, v193
    v_and_b32 v111, 0xffff0000, v193
    v_pk_mul_f32 v[110:111], v[110:111], s[60:61]
    v_lshlrev_b32 v112, 16, v194
    v_and_b32 v113, 0xffff0000, v194
    v_pk_mul_f32 v[112:113], v[112:113], s[60:61]
    v_lshlrev_b32 v114, 16, v195
    v_and_b32 v115, 0xffff0000, v195
    v_pk_mul_f32 v[114:115], v[114:115], s[60:61]
    v_lshlrev_b32 v116, 16, v196
    v_and_b32 v117, 0xffff0000, v196
    v_pk_mul_f32 v[116:117], v[116:117], s[60:61]
    v_lshlrev_b32 v118, 16, v197
    v_and_b32 v119, 0xffff0000, v197
    v_pk_mul_f32 v[118:119], v[118:119], s[60:61]
    v_lshlrev_b32 v234, 16, v132
    v_and_b32 v235, 0xffff0000, v132
    v_pk_mul_f32 v[120:121], v[234:235], v[108:109]
    v_lshlrev_b32 v234, 16, v138
    v_and_b32 v235, 0xffff0000, v138
    v_pk_mul_f32 v[200:201], v[120:121], v[234:235]
    v_lshlrev_b32 v234, 16, v133
    v_and_b32 v235, 0xffff0000, v133
    v_pk_mul_f32 v[122:123], v[234:235], v[110:111]
    v_lshlrev_b32 v234, 16, v139
    v_and_b32 v235, 0xffff0000, v139
    v_pk_fma_f32 v[200:201], v[122:123], v[234:235], v[200:201]
    v_lshlrev_b32 v234, 16, v134
    v_and_b32 v235, 0xffff0000, v134
    v_pk_mul_f32 v[124:125], v[234:235], v[112:113]
    v_lshlrev_b32 v234, 16, v140
    v_and_b32 v235, 0xffff0000, v140
    v_pk_fma_f32 v[200:201], v[124:125], v[234:235], v[200:201]
    v_lshlrev_b32 v234, 16, v135
    v_and_b32 v235, 0xffff0000, v135
    v_pk_mul_f32 v[126:127], v[234:235], v[114:115]
    v_lshlrev_b32 v234, 16, v141
    v_and_b32 v235, 0xffff0000, v141
    v_pk_fma_f32 v[200:201], v[126:127], v[234:235], v[200:201]
    v_lshlrev_b32 v234, 16, v136
    v_and_b32 v235, 0xffff0000, v136
    v_pk_mul_f32 v[128:129], v[234:235], v[116:117]
    v_lshlrev_b32 v234, 16, v142
    v_and_b32 v235, 0xffff0000, v142
    v_pk_fma_f32 v[200:201], v[128:129], v[234:235], v[200:201]
    v_lshlrev_b32 v234, 16, v137
    v_and_b32 v235, 0xffff0000, v137
    v_pk_mul_f32 v[130:131], v[234:235], v[118:119]
    v_lshlrev_b32 v234, 16, v143
    v_and_b32 v235, 0xffff0000, v143
    v_pk_fma_f32 v[200:201], v[130:131], v[234:235], v[200:201]
    v_pk_mul_f32 v[200:201], v[200:201], s[62:63]
    s_mov_b32 s76, 63
L_loop0:
    s_waitcnt vmcnt(35)
    v_pk_fma_f32 v[198:199], v[120:121], v[4:5], v[200:201]
    v_pk_fma_f32 v[198:199], v[122:123], v[6:7], v[198:199]
    ds_read_b32 v244, v243 offset:147
    s_add_u32 s71, s71, 777216
    s_cbranch_vccnz L_th24_0
L_tb24_0:
    buffer_load_dwordx4 v[4:7], v1, s[24:27], s71 offen offset:0 nt
    v_add_f32_dpp v229, v228, v228 row_ror:8 row_mask:0xf bank_mask:0xc
    s_waitcnt vmcnt(35)
    v_pk_fma_f32 v[198:199], v[124:125], v[8:9], v[198:199]
    v_pk_fma_f32 v[198:199], v[126:127], v[10:11], v[198:199]
    buffer_load_dwordx4 v[8:11], v1, s[24:27], s71 offen offset:256 nt
    v_add_f32_dpp v230, v229, v229 row_shr:4 row_mask:0xf bank_mask:0xa
    s_waitcnt vmcnt(35)
    v_pk_fma_f32 v[198:199], v[128:129], v[12:13], v[198:199]
    v_pk_fma_f32 v[198:199], v[130:131], v[14:15], v[198:199]
    s_waitcnt lgkmcnt(0)
    v_cmp_lt_u32 vcc, v0, v244
    ds_add_u32 v224, v243 offset:3328
    buffer_load_dwordx4 v[12:15], v1, s[24:27], s71 offen offset:512 nt
    v_add_f32_dpp v232, v230, v230 quad_perm:[2,3,0,1] row_mask:0xf bank_mask:0xf
    v_add_f32 v228, v198, v199
    s_waitcnt vmcnt(35)
    v_pk_fma_f32 v[198:199], v[120:121], v[16:17], v[200:201]
    v_pk_fma_f32 v[198:199], v[122:123], v[18:19], v[198:199]
    s_add_u32 s71, s71, 3072
    s_cbranch_vccnz L_th27_0
L_tb27_0:
    buffer_load_dwordx4 v[16:19], v1, s[24:27], s71 offen offset:0 nt
    v_cndmask_b32 v232, v231, v232, s[64:65]
    v_add_f32_dpp v229, v228, v228 row_ror:8 row_mask:0xf bank_mask:0x3
    s_waitcnt vmcnt(29)
    v_pk_fma_f32 v[198:199], v[124:125], v[20:21], v[198:199]
    v_pk_fma_f32 v[198:199], v[126:127], v[22:23], v[198:199]
    s_add_u32 s72, s72, 6144
    buffer_load_dwordx2 v[180:181], v2, s[32:35], s72 offen offset:0
    buffer_load_dwordx2 v[182:183], v2, s[32:35], s72 offen offset:128
    buffer_load_dwordx2 v[184:185], v2, s[32:35], s72 offen offset:256
    buffer_load_dwordx2 v[186:187], v2, s[36:39], s72 offen offset:0
    buffer_load_dwordx2 v[188:189], v2, s[36:39], s72 offen offset:128
    buffer_load_dwordx2 v[190:191], v2, s[36:39], s72 offen offset:256
    buffer_load_dwordx4 v[20:23], v1, s[24:27], s71 offen offset:256 nt
    v_add_f32_dpp v231, v232, v232 quad_perm:[1,0,3,2] row_mask:0xf bank_mask:0xf
    v_lshlrev_b32 v234, 16, v156
    v_and_b32 v235, 0xffff0000, v156
    v_pk_mul_f32 v[144:145], v[234:235], v[108:109]
    v_lshlrev_b32 v234, 16, v162
    v_and_b32 v235, 0xffff0000, v162
    s_waitcnt vmcnt(35)
    v_pk_fma_f32 v[198:199], v[128:129], v[24:25], v[198:199]
    v_pk_fma_f32 v[198:199], v[130:131], v[26:27], v[198:199]
    ds_add_u32 v224, v243 offset:3328
    buffer_load_dwordx4 v[24:27], v1, s[24:27], s71 offen offset:512 nt
    v_cndmask_b32 v233, v233, v231, s[66:67]
    v_mul_f32 v233, 0x58000000, v233
    ds_write_b32 v239, v233
    v_add_u32 v239, 256, v239
    v_add_f32 v228, v198, v199
    v_pk_mul_f32 v[202:203], v[144:145], v[234:235]
    v_lshlrev_b32 v234, 16, v157
    v_and_b32 v235, 0xffff0000, v157
    v_pk_mul_f32 v[146:147], v[234:235], v[110:111]
    v_lshlrev_b32 v234, 16, v163
    s_waitcnt vmcnt(35)
    v_pk_fma_f32 v[198:199], v[120:121], v[28:29], v[200:201]
    v_pk_fma_f32 v[198:199], v[122:123], v[30:31], v[198:199]
    s_add_u32 s71, s71, 3072
    s_cbranch_vccnz L_th30_0
L_tb30_0:
    buffer_load_dwordx4 v[28:31], v1, s[24:27], s71 offen offset:0 nt
    v_add_f32_dpp v229, v228, v228 row_ror:8 row_mask:0xf bank_mask:0xc
    v_and_b32 v235, 0xffff0000, v163
    v_pk_fma_f32 v[202:203], v[146:147], v[234:235], v[202:203]
    v_lshlrev_b32 v234, 16, v158
    v_and_b32 v235, 0xffff0000, v158
    v_pk_mul_f32 v[148:149], v[234:235], v[112:113]
    s_waitcnt vmcnt(35)
    v_pk_fma_f32 v[198:199], v[124:125], v[32:33], v[198:199]
    v_pk_fma_f32 v[198:199], v[126:127], v[34:35], v[198:199]
    buffer_load_dwordx4 v[32:35], v1, s[24:27], s71 offen offset:256 nt
    v_add_f32_dpp v230, v229, v229 row_shl:4 row_mask:0xf bank_mask:0x5
    v_lshlrev_b32 v234, 16, v164
    v_and_b32 v235, 0xffff0000, v164
    v_pk_fma_f32 v[202:203], v[148:149], v[234:235], v[202:203]
    v_lshlrev_b32 v234, 16, v159
    v_and_b32 v235, 0xffff0000, v159
    s_waitcnt vmcnt(35)
    v_pk_fma_f32 v[198:199], v[128:129], v[36:37], v[198:199]
    v_pk_fma_f32 v[198:199], v[130:131], v[38:39], v[198:199]
    ds_add_u32 v224, v243 offset:3328
    buffer_load_dwordx4 v[36:39], v1, s[24:27], s71 offen offset:512 nt
    v_add_f32 v228, v198, v199
    v_pk_mul_f32 v[150:151], v[234:235], v[114:115]
    v_lshlrev_b32 v234, 16, v165
    v_and_b32 v235, 0xffff0000, v165
    v_pk_fma_f32 v[202:203], v[150:151], v[234:235], v[202:203]
    v_lshlrev_b32 v234, 16, v160
    s_waitcnt vmcnt(35)
    v_pk_fma_f32 v[198:199], v[120:121], v[40:41], v[200:201]
    v_pk_fma_f32 v[198:199], v[122:123], v[42:43], v[198:199]
    s_add_u32 s71, s71, 3072
    s_cbranch_vccnz L_th33_0
L_tb33_0:
    buffer_load_dwordx4 v[40:43], v1, s[24:27], s71 offen offset:0 nt
    v_add_f32_dpp v229, v228, v228 row_ror:8 row_mask:0xf bank_mask:0x3
    v_and_b32 v235, 0xffff0000, v160
    v_pk_mul_f32 v[152:153], v[234:235], v[116:117]
    v_lshlrev_b32 v234, 16, v166
    v_and_b32 v235, 0xffff0000, v166
    v_pk_fma_f32 v[202:203], v[152:153], v[234:235], v[202:203]
    s_waitcnt vmcnt(35)
    v_pk_fma_f32 v[198:199], v[124:125], v[44:45], v[198:199]
    v_pk_fma_f32 v[198:199], v[126:127], v[46:47], v[198:199]
    buffer_load_dwordx4 v[44:47], v1, s[24:27], s71 offen offset:256 nt
    v_lshlrev_b32 v234, 16, v161
    v_and_b32 v235, 0xffff0000, v161
    v_pk_mul_f32 v[154:155], v[234:235], v[118:119]
    v_lshlrev_b32 v234, 16, v167
    v_and_b32 v235, 0xffff0000, v167
    s_waitcnt vmcnt(35)
    v_pk_fma_f32 v[198:199], v[128:129], v[48:49], v[198:199]
    v_pk_fma_f32 v[198:199], v[130:131], v[50:51], v[198:199]
    ds_add_u32 v224, v243 offset:3328
    buffer_load_dwordx4 v[48:51], v1, s[24:27], s71 offen offset:512 nt
    v_add_f32 v228, v198, v199
    v_pk_fma_f32 v[202:203], v[154:155], v[234:235], v[202:203]
    v_pk_mul_f32 v[202:203], v[202:203], s[62:63]
    s_waitcnt vmcnt(35)
    v_pk_fma_f32 v[198:199], v[144:145], v[52:53], v[202:203]
    v_pk_fma_f32 v[198:199], v[146:147], v[54:55], v[198:199]
    ds_read_b32 v244, v243 offset:147
    v_readlane_b32 s70, v245, s91
    s_add_u32 s91, s91, 1
    s_lshr_b32 s74, s70, 9
    s_mul_i32 s74, s74, 384
    buffer_load_dwordx2 v[192:193], v2, s[48:51], s74 offen offset:0
    buffer_load_dwordx2 v[194:195], v2, s[48:51], s74 offen offset:128
    buffer_load_dwordx2 v[196:197], v2, s[48:51], s74 offen offset:256
    s_add_u32 s71, s71, 777216
    s_cbranch_vccnz L_th36_0
L_tb36_0:
    buffer_load_dwordx4 v[52:55], v1, s[24:27], s71 offen offset:0 nt
    v_add_f32_dpp v229, v228, v228 row_ror:8 row_mask:0xf bank_mask:0xc
    s_waitcnt vmcnt(38)
    v_pk_fma_f32 v[198:199], v[148:149], v[56:57], v[198:199]
    v_pk_fma_f32 v[198:199], v[150:151], v[58:59], v[198:199]
    buffer_load_dwordx4 v[56:59], v1, s[24:27], s71 offen offset:256 nt
    v_add_f32_dpp v230, v229, v229 row_shr:4 row_mask:0xf bank_mask:0xa
    s_waitcnt vmcnt(38)
    v_pk_fma_f32 v[198:199], v[152:153], v[60:61], v[198:199]
    v_pk_fma_f32 v[198:199], v[154:155], v[62:63], v[198:199]
    s_waitcnt lgkmcnt(0)
    v_cmp_lt_u32 vcc, v0, v244
    ds_add_u32 v224, v243 offset:3328
    buffer_load_dwordx4 v[60:63], v1, s[24:27], s71 offen offset:512 nt
    v_add_f32_dpp v231, v230, v230 quad_perm:[2,3,0,1] row_mask:0xf bank_mask:0xf
    v_add_f32 v228, v198, v199
    s_waitcnt vmcnt(38)
    v_pk_fma_f32 v[198:199], v[144:145], v[64:65], v[202:203]
    v_pk_fma_f32 v[198:199], v[146:147], v[66:67], v[198:199]
    s_add_u32 s71, s71, 3072
    s_cbranch_vccnz L_th39_0
L_tb39_0:
    buffer_load_dwordx4 v[64:67], v1, s[24:27], s71 offen offset:0 nt
    v_add_f32_dpp v229, v228, v228 row_ror:8 row_mask:0xf bank_mask:0x3
    s_waitcnt vmcnt(32)
    v_pk_fma_f32 v[198:199], v[148:149], v[68:69], v[198:199]
    v_pk_fma_f32 v[198:199], v[150:151], v[70:71], v[198:199]
    s_and_b32 s80, s70, 63
    s_sub_u32 s72, s70, s80
    s_lshr_b32 s80, s80, 2
    s_add_u32 s72, s72, s80
    s_mul_i32 s72, s72, 384
    buffer_load_dwordx2 v[132:133], v2, s[32:35], s72 offen offset:0
    buffer_load_dwordx2 v[134:135], v2, s[32:35], s72 offen offset:128
    buffer_load_dwordx2 v[136:137], v2, s[32:35], s72 offen offset:256
    buffer_load_dwordx2 v[138:139], v2, s[36:39], s72 offen offset:0
    buffer_load_dwordx2 v[140:141], v2, s[36:39], s72 offen offset:128
    buffer_load_dwordx2 v[142:143], v2, s[36:39], s72 offen offset:256
    buffer_load_dwordx4 v[68:71], v1, s[24:27], s71 offen offset:256 nt
    v_lshlrev_b32 v234, 16, v168
    v_and_b32 v235, 0xffff0000, v168
    v_pk_mul_f32 v[120:121], v[234:235], v[108:109]
    v_lshlrev_b32 v234, 16, v174
    v_and_b32 v235, 0xffff0000, v174
    s_waitcnt vmcnt(38)
    v_pk_fma_f32 v[198:199], v[152:153], v[72:73], v[198:199]
    v_pk_fma_f32 v[198:199], v[154:155], v[74:75], v[198:199]
    ds_add_u32 v224, v243 offset:3328
    buffer_load_dwordx4 v[72:75], v1, s[24:27], s71 offen offset:512 nt
    v_add_f32 v228, v198, v199
    v_pk_mul_f32 v[200:201], v[120:121], v[234:235]
    v_lshlrev_b32 v234, 16, v169
    v_and_b32 v235, 0xffff0000, v169
    v_pk_mul_f32 v[122:123], v[234:235], v[110:111]
    v_lshlrev_b32 v234, 16, v175
    s_waitcnt vmcnt(38)
    v_pk_fma_f32 v[198:199], v[144:145], v[76:77], v[202:203]
    v_pk_fma_f32 v[198:199], v[146:147], v[78:79], v[198:199]
    s_add_u32 s71, s71, 3072
    s_cbranch_vccnz L_th42_0
L_tb42_0:
    buffer_load_dwordx4 v[76:79], v1, s[24:27], s71 offen offset:0 nt
    v_add_f32_dpp v229, v228, v228 row_ror:8 row_mask:0xf bank_mask:0xc
    v_and_b32 v235, 0xffff0000, v175
    v_pk_fma_f32 v[200:201], v[122:123], v[234:235], v[200:201]
    v_lshlrev_b32 v234, 16, v170
    v_and_b32 v235, 0xffff0000, v170
    v_pk_mul_f32 v[124:125], v[234:235], v[112:113]
    s_waitcnt vmcnt(38)
    v_pk_fma_f32 v[198:199], v[148:149], v[80:81], v[198:199]
    v_pk_fma_f32 v[198:199], v[150:151], v[82:83], v[198:199]
    buffer_load_dwordx4 v[80:83], v1, s[24:27], s71 offen offset:256 nt
    v_add_f32_dpp v230, v229, v229 row_shl:4 row_mask:0xf bank_mask:0x5
    v_lshlrev_b32 v234, 16, v176
    v_and_b32 v235, 0xffff0000, v176
    v_pk_fma_f32 v[200:201], v[124:125], v[234:235], v[200:201]
    v_lshlrev_b32 v234, 16, v171
    v_and_b32 v235, 0xffff0000, v171
    s_waitcnt vmcnt(38)
    v_pk_fma_f32 v[198:199], v[152:153], v[84:85], v[198:199]
    v_pk_fma_f32 v[198:199], v[154:155], v[86:87], v[198:199]
    ds_add_u32 v224, v243 offset:3328
    buffer_load_dwordx4 v[84:87], v1, s[24:27], s71 offen offset:512 nt
    v_add_f32 v228, v198, v199
    v_pk_mul_f32 v[126:127], v[234:235], v[114:115]
    v_lshlrev_b32 v234, 16, v177
    v_and_b32 v235, 0xffff0000, v177
    v_pk_fma_f32 v[200:201], v[126:127], v[234:235], v[200:201]
    v_lshlrev_b32 v234, 16, v172
    s_waitcnt vmcnt(38)
    v_pk_fma_f32 v[198:199], v[144:145], v[88:89], v[202:203]
    v_pk_fma_f32 v[198:199], v[146:147], v[90:91], v[198:199]
    s_add_u32 s71, s71, 3072
    s_cbranch_vccnz L_th45_0
L_tb45_0:
    buffer_load_dwordx4 v[88:91], v1, s[24:27], s71 offen offset:0 nt
    v_add_f32_dpp v229, v228, v228 row_ror:8 row_mask:0xf bank_mask:0x3
    v_and_b32 v235, 0xffff0000, v172
    v_pk_mul_f32 v[128:129], v[234:235], v[116:117]
    v_lshlrev_b32 v234, 16, v178
    v_and_b32 v235, 0xffff0000, v178
    v_pk_fma_f32 v[200:201], v[128:129], v[234:235], v[200:201]
    s_waitcnt vmcnt(38)
    v_pk_fma_f32 v[198:199], v[148:149], v[92:93], v[198:199]
    v_pk_fma_f32 v[198:199], v[150:151], v[94:95], v[198:199]
    buffer_load_dwordx4 v[92:95], v1, s[24:27], s71 offen offset:256 nt
    v_lshlrev_b32 v234, 16, v173
    v_and_b32 v235, 0xffff0000, v173
    v_pk_mul_f32 v[130:131], v[234:235], v[118:119]
    v_lshlrev_b32 v234, 16, v179
    v_and_b32 v235, 0xffff0000, v179
    s_waitcnt vmcnt(38)
    v_pk_fma_f32 v[198:199], v[152:153], v[96:97], v[198:199]
    v_pk_fma_f32 v[198:199], v[154:155], v[98:99], v[198:199]
    ds_add_u32 v224, v243 offset:3328
    buffer_load_dwordx4 v[96:99], v1, s[24:27], s71 offen offset:512 nt
    v_add_f32 v228, v198, v199
    v_pk_fma_f32 v[200:201], v[130:131], v[234:235], v[200:201]
    v_pk_mul_f32 v[200:201], v[200:201], s[62:63]
    s_waitcnt vmcnt(38)
    v_pk_fma_f32 v[198:199], v[120:121], v[4:5], v[200:201]
    v_pk_fma_f32 v[198:199], v[122:123], v[6:7], v[198:199]
    ds_read_b32 v244, v243 offset:147
    s_mul_i32 s71, s70, 49152
    s_and_b32 s80, s70, 63
    s_mul_i32 s80, s80, 36864
    s_sub_u32 s71, s71, s80
    s_cbranch_vccnz L_th0_0
L_tb0_0:
    buffer_load_dwordx4 v[4:7], v1, s[24:27], s71 offen offset:0 nt
    v_add_f32_dpp v229, v228, v228 row_ror:8 row_mask:0xf bank_mask:0xc
    s_waitcnt vmcnt(38)
    v_pk_fma_f32 v[198:199], v[124:125], v[8:9], v[198:199]
    v_pk_fma_f32 v[198:199], v[126:127], v[10:11], v[198:199]
    buffer_load_dwordx4 v[8:11], v1, s[24:27], s71 offen offset:256 nt
    v_add_f32_dpp v230, v229, v229 row_shr:4 row_mask:0xf bank_mask:0xa
    s_waitcnt vmcnt(38)
    v_pk_fma_f32 v[198:199], v[128:129], v[12:13], v[198:199]
    v_pk_fma_f32 v[198:199], v[130:131], v[14:15], v[198:199]
    s_waitcnt lgkmcnt(0)
    v_cmp_lt_u32 vcc, v0, v244
    ds_add_u32 v224, v243 offset:3328
    buffer_load_dwordx4 v[12:15], v1, s[24:27], s71 offen offset:512 nt
    v_add_f32_dpp v232, v230, v230 quad_perm:[2,3,0,1] row_mask:0xf bank_mask:0xf
    v_add_f32 v228, v198, v199
    s_waitcnt vmcnt(38)
    v_pk_fma_f32 v[198:199], v[120:121], v[16:17], v[200:201]
    v_pk_fma_f32 v[198:199], v[122:123], v[18:19], v[198:199]
    s_add_u32 s71, s71, 3072
    s_cbranch_vccnz L_th3_0
L_tb3_0:
    buffer_load_dwordx4 v[16:19], v1, s[24:27], s71 offen offset:0 nt
    v_cndmask_b32 v232, v231, v232, s[64:65]
    v_add_f32_dpp v229, v228, v228 row_ror:8 row_mask:0xf bank_mask:0x3
    s_waitcnt vmcnt(32)
    v_pk_fma_f32 v[198:199], v[124:125], v[20:21], v[198:199]
    v_pk_fma_f32 v[198:199], v[126:127], v[22:23], v[198:199]
    s_add_u32 s72, s72, 6144
    buffer_load_dwordx2 v[156:157], v2, s[32:35], s72 offen offset:0
    buffer_load_dwordx2 v[158:159], v2, s[32:35], s72 offen offset:128
    buffer_load_dwordx2 v[160:161], v2, s[32:35], s72 offen offset:256
    buffer_load_dwordx2 v[162:163], v2, s[36:39], s72 offen offset:0
    buffer_load_dwordx2 v[164:165], v2, s[36:39], s72 offen offset:128
    buffer_load_dwordx2 v[166:167], v2, s[36:39], s72 offen offset:256
    buffer_load_dwordx4 v[20:23], v1, s[24:27], s71 offen offset:256 nt
    v_add_f32_dpp v233, v232, v232 quad_perm:[1,0,3,2] row_mask:0xf bank_mask:0xf
    v_lshlrev_b32 v234, 16, v180
    v_and_b32 v235, 0xffff0000, v180
    v_pk_mul_f32 v[144:145], v[234:235], v[108:109]
    v_lshlrev_b32 v234, 16, v186
    v_and_b32 v235, 0xffff0000, v186
    s_waitcnt vmcnt(38)
    v_pk_fma_f32 v[198:199], v[128:129], v[24:25], v[198:199]
    v_pk_fma_f32 v[198:199], v[130:131], v[26:27], v[198:199]
    ds_add_u32 v224, v243 offset:3328
    buffer_load_dwordx4 v[24:27], v1, s[24:27], s71 offen offset:512 nt
    v_add_f32 v228, v198, v199
    v_pk_mul_f32 v[202:203], v[144:145], v[234:235]
    v_lshlrev_b32 v234, 16, v181
    v_and_b32 v235, 0xffff0000, v181
    v_pk_mul_f32 v[146:147], v[234:235], v[110:111]
    v_lshlrev_b32 v234, 16, v187
    s_waitcnt vmcnt(38)
    v_pk_fma_f32 v[198:199], v[120:121], v[28:29], v[200:201]
    v_pk_fma_f32 v[198:199], v[122:123], v[30:31], v[198:199]
    s_add_u32 s71, s71, 3072
    s_cbranch_vccnz L_th6_0
L_tb6_0:
    buffer_load_dwordx4 v[28:31], v1, s[24:27], s71 offen offset:0 nt
    v_add_f32_dpp v229, v228, v228 row_ror:8 row_mask:0xf bank_mask:0xc
    v_and_b32 v235, 0xffff0000, v187
    v_pk_fma_f32 v[202:203], v[146:147], v[234:235], v[202:203]
    v_lshlrev_b32 v234, 16, v182
    v_and_b32 v235, 0xffff0000, v182
    v_pk_mul_f32 v[148:149], v[234:235], v[112:113]
    s_waitcnt vmcnt(38)
    v_pk_fma_f32 v[198:199], v[124:125], v[32:33], v[198:199]
    v_pk_fma_f32 v[198:199], v[126:127], v[34:35], v[198:199]
    buffer_load_dwordx4 v[32:35], v1, s[24:27], s71 offen offset:256 nt
    v_add_f32_dpp v230, v229, v229 row_shl:4 row_mask:0xf bank_mask:0x5
    v_lshlrev_b32 v234, 16, v188
    v_and_b32 v235, 0xffff0000, v188
    v_pk_fma_f32 v[202:203], v[148:149], v[234:235], v[202:203]
    v_lshlrev_b32 v234, 16, v183
    v_and_b32 v235, 0xffff0000, v183
    s_waitcnt vmcnt(38)
    v_pk_fma_f32 v[198:199], v[128:129], v[36:37], v[198:199]
    v_pk_fma_f32 v[198:199], v[130:131], v[38:39], v[198:199]
    ds_add_u32 v224, v243 offset:3328
    buffer_load_dwordx4 v[36:39], v1, s[24:27], s71 offen offset:512 nt
    v_add_f32 v228, v198, v199
    v_pk_mul_f32 v[150:151], v[234:235], v[114:115]
    v_lshlrev_b32 v234, 16, v189
    v_and_b32 v235, 0xffff0000, v189
    v_pk_fma_f32 v[202:203], v[150:151], v[234:235], v[202:203]
    s_branch L_x0
L_w0:
    s_branch L_w1
L_x0:
    v_lshlrev_b32 v234, 16, v184
    s_waitcnt vmcnt(38)
    v_pk_fma_f32 v[198:199], v[120:121], v[40:41], v[200:201]
    v_pk_fma_f32 v[198:199], v[122:123], v[42:43], v[198:199]
    s_add_u32 s71, s71, 3072
    s_cbranch_vccnz L_th9_0
L_tb9_0:
    buffer_load_dwordx4 v[40:43], v1, s[24:27], s71 offen offset:0 nt
    v_add_f32_dpp v229, v228, v228 row_ror:8 row_mask:0xf bank_mask:0x3
    v_and_b32 v235, 0xffff0000, v184
    v_pk_mul_f32 v[152:153], v[234:235], v[116:117]
    v_lshlrev_b32 v234, 16, v190
    v_and_b32 v235, 0xffff0000, v190
    v_pk_fma_f32 v[202:203], v[152:153], v[234:235], v[202:203]
    s_waitcnt vmcnt(38)
    v_pk_fma_f32 v[198:199], v[124:125], v[44:45], v[198:199]
    v_pk_fma_f32 v[198:199], v[126:127], v[46:47], v[198:199]
    buffer_load_dwordx4 v[44:47], v1, s[24:27], s71 offen offset:256 nt
    v_lshlrev_b32 v234, 16, v185
    v_and_b32 v235, 0xffff0000, v185
    v_pk_mul_f32 v[154:155], v[234:235], v[118:119]
    v_lshlrev_b32 v234, 16, v191
    v_and_b32 v235, 0xffff0000, v191
    s_waitcnt vmcnt(38)
    v_pk_fma_f32 v[198:199], v[128:129], v[48:49], v[198:199]
    v_pk_fma_f32 v[198:199], v[130:131], v[50:51], v[198:199]
    ds_add_u32 v224, v243 offset:3328
    buffer_load_dwordx4 v[48:51], v1, s[24:27], s71 offen offset:512 nt
    v_add_f32 v228, v198, v199
    v_pk_fma_f32 v[202:203], v[154:155], v[234:235], v[202:203]
    v_pk_mul_f32 v[202:203], v[202:203], s[62:63]
    s_waitcnt vmcnt(35)
    v_pk_fma_f32 v[198:199], v[144:145], v[52:53], v[202:203]
    v_pk_fma_f32 v[198:199], v[146:147], v[54:55], v[198:199]
    ds_read_b32 v244, v243 offset:147
    s_add_u32 s71, s71, 777216
    s_cbranch_vccnz L_th12_0
L_tb12_0:
    buffer_load_dwordx4 v[52:55], v1, s[24:27], s71 offen offset:0 nt
    v_add_f32_dpp v229, v228, v228 row_ror:8 row_mask:0xf bank_mask:0xc
    v_lshlrev_b32 v108, 16, v192
    v_and_b32 v109, 0xffff0000, v192
    v_pk_mul_f32 v[108:109], v[108:109], s[60:61]
    v_lshlrev_b32 v110, 16, v193
    v_and_b32 v111, 0xffff0000, v193
    s_waitcnt vmcnt(35)
    v_pk_fma_f32 v[198:199], v[148:149], v[56:57], v[198:199]
    v_pk_fma_f32 v[198:199], v[150:151], v[58:59], v[198:199]
    buffer_load_dwordx4 v[56:59], v1, s[24:27], s71 offen offset:256 nt
    v_add_f32_dpp v230, v229, v229 row_shr:4 row_mask:0xf bank_mask:0xa
    v_pk_mul_f32 v[110:111], v[110:111], s[60:61]
    v_lshlrev_b32 v112, 16, v194
    v_and_b32 v113, 0xffff0000, v194
    v_pk_mul_f32 v[112:113], v[112:113], s[60:61]
    v_lshlrev_b32 v114, 16, v195
    s_waitcnt vmcnt(35)
    v_pk_fma_f32 v[198:199], v[152:153], v[60:61], v[198:199]
    v_pk_fma_f32 v[198:199], v[154:155], v[62:63], v[198:199]
    s_waitcnt lgkmcnt(0)
    v_cmp_lt_u32 vcc, v0, v244
    ds_add_u32 v224, v243 offset:3328
    buffer_load_dwordx4 v[60:63], v1, s[24:27], s71 offen offset:512 nt
    v_add_f32_dpp v231, v230, v230 quad_perm:[2,3,0,1] row_mask:0xf bank_mask:0xf
    v_add_f32 v228, v198, v199
    v_and_b32 v115, 0xffff0000, v195
    v_pk_mul_f32 v[114:115], v[114:115], s[60:61]
    v_lshlrev_b32 v116, 16, v196
    v_and_b32 v117, 0xffff0000, v196
    v_pk_mul_f32 v[116:117], v[116:117], s[60:61]
    s_waitcnt vmcnt(35)
    v_pk_fma_f32 v[198:199], v[144:145], v[64:65], v[202:203]
    v_pk_fma_f32 v[198:199], v[146:147], v[66:67], v[198:199]
    s_add_u32 s71, s71, 3072
    s_cbranch_vccnz L_th15_0
L_tb15_0:
    buffer_load_dwordx4 v[64:67], v1, s[24:27], s71 offen offset:0 nt
    v_add_f32_dpp v229, v228, v228 row_ror:8 row_mask:0xf bank_mask:0x3
    v_lshlrev_b32 v118, 16, v197
    v_and_b32 v119, 0xffff0000, v197
    v_pk_mul_f32 v[118:119], v[118:119], s[60:61]
    s_waitcnt vmcnt(29)
    v_pk_fma_f32 v[198:199], v[148:149], v[68:69], v[198:199]
    v_pk_fma_f32 v[198:199], v[150:151], v[70:71], v[198:199]
    s_add_u32 s72, s72, 6144
    buffer_load_dwordx2 v[168:169], v2, s[32:35], s72 offen offset:0
    buffer_load_dwordx2 v[170:171], v2, s[32:35], s72 offen offset:128
    buffer_load_dwordx2 v[172:173], v2, s[32:35], s72 offen offset:256
    buffer_load_dwordx2 v[174:175], v2, s[36:39], s72 offen offset:0
    buffer_load_dwordx2 v[176:177], v2, s[36:39], s72 offen offset:128
    buffer_load_dwordx2 v[178:179], v2, s[36:39], s72 offen offset:256
    buffer_load_dwordx4 v[68:71], v1, s[24:27], s71 offen offset:256 nt
    v_lshlrev_b32 v234, 16, v132
    v_and_b32 v235, 0xffff0000, v132
    v_pk_mul_f32 v[120:121], v[234:235], v[108:109]
    v_lshlrev_b32 v234, 16, v138
    v_and_b32 v235, 0xffff0000, v138
    s_waitcnt vmcnt(35)
    v_pk_fma_f32 v[198:199], v[152:153], v[72:73], v[198:199]
    v_pk_fma_f32 v[198:199], v[154:155], v[74:75], v[198:199]
    ds_add_u32 v224, v243 offset:3328
    buffer_load_dwordx4 v[72:75], v1, s[24:27], s71 offen offset:512 nt
    v_add_f32 v228, v198, v199
    v_pk_mul_f32 v[200:201], v[120:121], v[234:235]
    v_lshlrev_b32 v234, 16, v133
    v_and_b32 v235, 0xffff0000, v133
    v_pk_mul_f32 v[122:123], v[234:235], v[110:111]
    v_lshlrev_b32 v234, 16, v139
    s_waitcnt vmcnt(35)
    v_pk_fma_f32 v[198:199], v[144:145], v[76:77], v[202:203]
    v_pk_fma_f32 v[198:199], v[146:147], v[78:79], v[198:199]
    s_add_u32 s71, s71, 3072
    s_cbranch_vccnz L_th18_0
L_tb18_0:
    buffer_load_dwordx4 v[76:79], v1, s[24:27], s71 offen offset:0 nt
    v_add_f32_dpp v229, v228, v228 row_ror:8 row_mask:0xf bank_mask:0xc
    v_and_b32 v235, 0xffff0000, v139
    v_pk_fma_f32 v[200:201], v[122:123], v[234:235], v[200:201]
    v_lshlrev_b32 v234, 16, v134
    v_and_b32 v235, 0xffff0000, v134
    v_pk_mul_f32 v[124:125], v[234:235], v[112:113]
    s_waitcnt vmcnt(35)
    v_pk_fma_f32 v[198:199], v[148:149], v[80:81], v[198:199]
    v_pk_fma_f32 v[198:199], v[150:151], v[82:83], v[198:199]
    buffer_load_dwordx4 v[80:83], v1, s[24:27], s71 offen offset:256 nt
    v_add_f32_dpp v230, v229, v229 row_shl:4 row_mask:0xf bank_mask:0x5
    v_lshlrev_b32 v234, 16, v140
    v_and_b32 v235, 0xffff0000, v140
    v_pk_fma_f32 v[200:201], v[124:125], v[234:235], v[200:201]
    v_lshlrev_b32 v234, 16, v135
    v_and_b32 v235, 0xffff0000, v135
    s_waitcnt vmcnt(35)
    v_pk_fma_f32 v[198:199], v[152:153], v[84:85], v[198:199]
    v_pk_fma_f32 v[198:199], v[154:155], v[86:87], v[198:199]
    ds_add_u32 v224, v243 offset:3328
    buffer_load_dwordx4 v[84:87], v1, s[24:27], s71 offen offset:512 nt
    v_add_f32 v228, v198, v199
    v_pk_mul_f32 v[126:127], v[234:235], v[114:115]
    v_lshlrev_b32 v234, 16, v141
    v_and_b32 v235, 0xffff0000, v141
    v_pk_fma_f32 v[200:201], v[126:127], v[234:235], v[200:201]
    v_lshlrev_b32 v234, 16, v136
    s_waitcnt vmcnt(35)
    v_pk_fma_f32 v[198:199], v[144:145], v[88:89], v[202:203]
    v_pk_fma_f32 v[198:199], v[146:147], v[90:91], v[198:199]
    s_add_u32 s71, s71, 3072
    s_cbranch_vccnz L_th21_0
L_tb21_0:
    buffer_load_dwordx4 v[88:91], v1, s[24:27], s71 offen offset:0 nt
    v_add_f32_dpp v229, v228, v228 row_ror:8 row_mask:0xf bank_mask:0x3
    v_and_b32 v235, 0xffff0000, v136
    v_pk_mul_f32 v[128:129], v[234:235], v[116:117]
    v_lshlrev_b32 v234, 16, v142
    v_and_b32 v235, 0xffff0000, v142
    v_pk_fma_f32 v[200:201], v[128:129], v[234:235], v[200:201]
    s_waitcnt vmcnt(35)
    v_pk_fma_f32 v[198:199], v[148:149], v[92:93], v[198:199]
    v_pk_fma_f32 v[198:199], v[150:151], v[94:95], v[198:199]
    buffer_load_dwordx4 v[92:95], v1, s[24:27], s71 offen offset:256 nt
    v_lshlrev_b32 v234, 16, v137
    v_and_b32 v235, 0xffff0000, v137
    v_pk_mul_f32 v[130:131], v[234:235], v[118:119]
    v_lshlrev_b32 v234, 16, v143
    v_and_b32 v235, 0xffff0000, v143
    s_waitcnt vmcnt(35)
    v_pk_fma_f32 v[198:199], v[152:153], v[96:97], v[198:199]
    v_pk_fma_f32 v[198:199], v[154:155], v[98:99], v[198:199]
    ds_add_u32 v224, v243 offset:3328
    buffer_load_dwordx4 v[96:99], v1, s[24:27], s71 offen offset:512 nt
    v_add_f32 v228, v198, v199
    v_pk_fma_f32 v[200:201], v[130:131], v[234:235], v[200:201]
    v_pk_mul_f32 v[200:201], v[200:201], s[62:63]
    s_sub_u32 s76, s76, 1
    s_cmp_lg_u32 s76, 0
    s_cbranch_scc1 L_loop0
    s_waitcnt vmcnt(35)
    v_pk_fma_f32 v[198:199], v[120:121], v[4:5], v[200:201]
    v_pk_fma_f32 v[198:199], v[122:123], v[6:7], v[198:199]
    ds_read_b32 v244, v243 offset:147
    s_add_u32 s71, s71, 777216
    s_cbranch_vccnz L_th24_1
L_tb24_1:
    buffer_load_dwordx4 v[4:7], v1, s[24:27], s71 offen offset:0 nt
    v_add_f32_dpp v229, v228, v228 row_ror:8 row_mask:0xf bank_mask:0xc
    s_waitcnt vmcnt(35)
    v_pk_fma_f32 v[198:199], v[124:125], v[8:9], v[198:199]
    v_pk_fma_f32 v[198:199], v[126:127], v[10:11], v[198:199]
    buffer_load_dwordx4 v[8:11], v1, s[24:27], s71 offen offset:256 nt
    v_add_f32_dpp v230, v229, v229 row_shr:4 row_mask:0xf bank_mask:0xa
    s_waitcnt vmcnt(35)
    v_pk_fma_f32 v[198:199], v[128:129], v[12:13], v[198:199]
    v_pk_fma_f32 v[198:199], v[130:131], v[14:15], v[198:199]
    s_waitcnt lgkmcnt(0)
    v_cmp_lt_u32 vcc, v0, v244
    ds_add_u32 v224, v243 offset:3328
    buffer_load_dwordx4 v[12:15], v1, s[24:27], s71 offen offset:512 nt
    v_add_f32_dpp v232, v230, v230 quad_perm:[2,3,0,1] row_mask:0xf bank_mask:0xf
    v_add_f32 v228, v198, v199
    s_waitcnt vmcnt(35)
    v_pk_fma_f32 v[198:199], v[120:121], v[16:17], v[200:201]
    v_pk_fma_f32 v[198:199], v[122:123], v[18:19], v[198:199]
    s_add_u32 s71, s71, 3072
    s_cbranch_vccnz L_th27_1
L_tb27_1:
    buffer_load_dwordx4 v[16:19], v1, s[24:27], s71 offen offset:0 nt
    v_cndmask_b32 v232, v231, v232, s[64:65]
    v_add_f32_dpp v229, v228, v228 row_ror:8 row_mask:0xf bank_mask:0x3
    s_waitcnt vmcnt(29)
    v_pk_fma_f32 v[198:199], v[124:125], v[20:21], v[198:199]
    v_pk_fma_f32 v[198:199], v[126:127], v[22:23], v[198:199]
    s_add_u32 s72, s72, 6144
    buffer_load_dwordx2 v[180:181], v2, s[32:35], s72 offen offset:0
    buffer_load_dwordx2 v[182:183], v2, s[32:35], s72 offen offset:128
    buffer_load_dwordx2 v[184:185], v2, s[32:35], s72 offen offset:256
    buffer_load_dwordx2 v[186:187], v2, s[36:39], s72 offen offset:0
    buffer_load_dwordx2 v[188:189], v2, s[36:39], s72 offen offset:128
    buffer_load_dwordx2 v[190:191], v2, s[36:39], s72 offen offset:256
    buffer_load_dwordx4 v[20:23], v1, s[24:27], s71 offen offset:256 nt
    v_add_f32_dpp v231, v232, v232 quad_perm:[1,0,3,2] row_mask:0xf bank_mask:0xf
    v_lshlrev_b32 v234, 16, v156
    v_and_b32 v235, 0xffff0000, v156
    v_pk_mul_f32 v[144:145], v[234:235], v[108:109]
    v_lshlrev_b32 v234, 16, v162
    v_and_b32 v235, 0xffff0000, v162
    s_waitcnt vmcnt(35)
    v_pk_fma_f32 v[198:199], v[128:129], v[24:25], v[198:199]
    v_pk_fma_f32 v[198:199], v[130:131], v[26:27], v[198:199]
    ds_add_u32 v224, v243 offset:3328
    buffer_load_dwordx4 v[24:27], v1, s[24:27], s71 offen offset:512 nt
    v_cndmask_b32 v233, v233, v231, s[66:67]
    v_mul_f32 v233, 0x58000000, v233
    ds_write_b32 v239, v233
    v_add_u32 v239, 256, v239
    v_add_f32 v228, v198, v199
    v_pk_mul_f32 v[202:203], v[144:145], v[234:235]
    v_lshlrev_b32 v234, 16, v157
    v_and_b32 v235, 0xffff0000, v157
    v_pk_mul_f32 v[146:147], v[234:235], v[110:111]
    v_lshlrev_b32 v234, 16, v163
    s_waitcnt vmcnt(35)
    v_pk_fma_f32 v[198:199], v[120:121], v[28:29], v[200:201]
    v_pk_fma_f32 v[198:199], v[122:123], v[30:31], v[198:199]
    s_add_u32 s71, s71, 3072
    s_cbranch_vccnz L_th30_1
L_tb30_1:
    buffer_load_dwordx4 v[28:31], v1, s[24:27], s71 offen offset:0 nt
    v_add_f32_dpp v229, v228, v228 row_ror:8 row_mask:0xf bank_mask:0xc
    v_and_b32 v235, 0xffff0000, v163
    v_pk_fma_f32 v[202:203], v[146:147], v[234:235], v[202:203]
    v_lshlrev_b32 v234, 16, v158
    v_and_b32 v235, 0xffff0000, v158
    v_pk_mul_f32 v[148:149], v[234:235], v[112:113]
    s_waitcnt vmcnt(35)
    v_pk_fma_f32 v[198:199], v[124:125], v[32:33], v[198:199]
    v_pk_fma_f32 v[198:199], v[126:127], v[34:35], v[198:199]
    buffer_load_dwordx4 v[32:35], v1, s[24:27], s71 offen offset:256 nt
    v_add_f32_dpp v230, v229, v229 row_shl:4 row_mask:0xf bank_mask:0x5
    v_lshlrev_b32 v234, 16, v164
    v_and_b32 v235, 0xffff0000, v164
    v_pk_fma_f32 v[202:203], v[148:149], v[234:235], v[202:203]
    v_lshlrev_b32 v234, 16, v159
    v_and_b32 v235, 0xffff0000, v159
    s_waitcnt vmcnt(35)
    v_pk_fma_f32 v[198:199], v[128:129], v[36:37], v[198:199]
    v_pk_fma_f32 v[198:199], v[130:131], v[38:39], v[198:199]
    ds_add_u32 v224, v243 offset:3328
    buffer_load_dwordx4 v[36:39], v1, s[24:27], s71 offen offset:512 nt
    v_add_f32 v228, v198, v199
    v_pk_mul_f32 v[150:151], v[234:235], v[114:115]
    v_lshlrev_b32 v234, 16, v165
    v_and_b32 v235, 0xffff0000, v165
    v_pk_fma_f32 v[202:203], v[150:151], v[234:235], v[202:203]
    v_lshlrev_b32 v234, 16, v160
    s_waitcnt vmcnt(35)
    v_pk_fma_f32 v[198:199], v[120:121], v[40:41], v[200:201]
    v_pk_fma_f32 v[198:199], v[122:123], v[42:43], v[198:199]
    s_add_u32 s71, s71, 3072
    s_cbranch_vccnz L_th33_1
L_tb33_1:
    buffer_load_dwordx4 v[40:43], v1, s[24:27], s71 offen offset:0 nt
    v_add_f32_dpp v229, v228, v228 row_ror:8 row_mask:0xf bank_mask:0x3
    v_and_b32 v235, 0xffff0000, v160
    v_pk_mul_f32 v[152:153], v[234:235], v[116:117]
    v_lshlrev_b32 v234, 16, v166
    v_and_b32 v235, 0xffff0000, v166
    v_pk_fma_f32 v[202:203], v[152:153], v[234:235], v[202:203]
    s_waitcnt vmcnt(35)
    v_pk_fma_f32 v[198:199], v[124:125], v[44:45], v[198:199]
    v_pk_fma_f32 v[198:199], v[126:127], v[46:47], v[198:199]
    buffer_load_dwordx4 v[44:47], v1, s[24:27], s71 offen offset:256 nt
    v_lshlrev_b32 v234, 16, v161
    v_and_b32 v235, 0xffff0000, v161
    v_pk_mul_f32 v[154:155], v[234:235], v[118:119]
    v_lshlrev_b32 v234, 16, v167
    v_and_b32 v235, 0xffff0000, v167
    s_waitcnt vmcnt(35)
    v_pk_fma_f32 v[198:199], v[128:129], v[48:49], v[198:199]
    v_pk_fma_f32 v[198:199], v[130:131], v[50:51], v[198:199]
    ds_add_u32 v224, v243 offset:3328
    buffer_load_dwordx4 v[48:51], v1, s[24:27], s71 offen offset:512 nt
    v_add_f32 v228, v198, v199
    v_pk_fma_f32 v[202:203], v[154:155], v[234:235], v[202:203]
    v_pk_mul_f32 v[202:203], v[202:203], s[62:63]
    s_waitcnt vmcnt(35)
    v_pk_fma_f32 v[198:199], v[144:145], v[52:53], v[202:203]
    v_pk_fma_f32 v[198:199], v[146:147], v[54:55], v[198:199]
    ds_read_b32 v244, v243 offset:147
    s_mov_b32 s91, 0
    v_readlane_b32 s70, v245, s91
    s_add_u32 s91, s91, 1
    s_and_b32 s80, s70, 63
    s_mul_i32 s80, s80, 96
    s_lshl_b32 s73, s70, 7
    s_sub_u32 s73, s73, s80
    buffer_load_ushort v220, v3, s[40:43], s73 offen
    buffer_load_ushort v221, v3, s[44:47], s73 offen
    s_add_u32 s71, s71, 777216
    s_cbranch_vccnz L_th36_1
L_tb36_1:
    buffer_load_dwordx4 v[52:55], v1, s[24:27], s71 offen offset:0 nt
    v_add_f32_dpp v229, v228, v228 row_ror:8 row_mask:0xf bank_mask:0xc
    s_waitcnt vmcnt(37)
    v_pk_fma_f32 v[198:199], v[148:149], v[56:57], v[198:199]
    v_pk_fma_f32 v[198:199], v[150:151], v[58:59], v[198:199]
    buffer_load_dwordx4 v[56:59], v1, s[24:27], s71 offen offset:256 nt
    v_add_f32_dpp v230, v229, v229 row_shr:4 row_mask:0xf bank_mask:0xa
    s_waitcnt vmcnt(37)
    v_pk_fma_f32 v[198:199], v[152:153], v[60:61], v[198:199]
    v_pk_fma_f32 v[198:199], v[154:155], v[62:63], v[198:199]
    s_waitcnt lgkmcnt(0)
    v_cmp_lt_u32 vcc, v0, v244
    ds_add_u32 v224, v243 offset:3328
    buffer_load_dwordx4 v[60:63], v1, s[24:27], s71 offen offset:512 nt
    v_add_f32_dpp v231, v230, v230 quad_perm:[2,3,0,1] row_mask:0xf bank_mask:0xf
    v_add_f32 v228, v198, v199
    s_waitcnt vmcnt(37)
    v_pk_fma_f32 v[198:199], v[144:145], v[64:65], v[202:203]
    v_pk_fma_f32 v[198:199], v[146:147], v[66:67], v[198:199]
    s_add_u32 s71, s71, 3072
    s_cbranch_vccnz L_th39_1
L_tb39_1:
    buffer_load_dwordx4 v[64:67], v1, s[24:27], s71 offen offset:0 nt
    v_add_f32_dpp v229, v228, v228 row_ror:8 row_mask:0xf bank_mask:0x3
    s_waitcnt vmcnt(31)
    v_pk_fma_f32 v[198:199], v[148:149], v[68:69], v[198:199]
    v_pk_fma_f32 v[198:199], v[150:151], v[70:71], v[198:199]
    buffer_load_dwordx4 v[68:71], v1, s[24:27], s71 offen offset:256 nt
    v_lshlrev_b32 v234, 16, v168
    v_and_b32 v235, 0xffff0000, v168
    v_pk_mul_f32 v[120:121], v[234:235], v[108:109]
    v_lshlrev_b32 v234, 16, v174
    v_and_b32 v235, 0xffff0000, v174
    s_waitcnt vmcnt(31)
    v_pk_fma_f32 v[198:199], v[152:153], v[72:73], v[198:199]
    v_pk_fma_f32 v[198:199], v[154:155], v[74:75], v[198:199]
    ds_add_u32 v224, v243 offset:3328
    buffer_load_dwordx4 v[72:75], v1, s[24:27], s71 offen offset:512 nt
    v_add_f32 v228, v198, v199
    v_pk_mul_f32 v[200:201], v[120:121], v[234:235]
    v_lshlrev_b32 v234, 16, v169
    v_and_b32 v235, 0xffff0000, v169
    v_pk_mul_f32 v[122:123], v[234:235], v[110:111]
    v_lshlrev_b32 v234, 16, v175
    s_waitcnt vmcnt(31)
    v_pk_fma_f32 v[198:199], v[144:145], v[76:77], v[202:203]
    v_pk_fma_f32 v[198:199], v[146:147], v[78:79], v[198:199]
    s_add_u32 s71, s71, 3072
    s_cbranch_vccnz L_th42_1
L_tb42_1:
    buffer_load_dwordx4 v[76:79], v1, s[24:27], s71 offen offset:0 nt
    v_add_f32_dpp v229, v228, v228 row_ror:8 row_mask:0xf bank_mask:0xc
    v_and_b32 v235, 0xffff0000, v175
    v_pk_fma_f32 v[200:201], v[122:123], v[234:235], v[200:201]
    v_lshlrev_b32 v234, 16, v170
    v_and_b32 v235, 0xffff0000, v170
    v_pk_mul_f32 v[124:125], v[234:235], v[112:113]
    s_waitcnt vmcnt(31)
    v_pk_fma_f32 v[198:199], v[148:149], v[80:81], v[198:199]
    v_pk_fma_f32 v[198:199], v[150:151], v[82:83], v[198:199]
    buffer_load_dwordx4 v[80:83], v1, s[24:27], s71 offen offset:256 nt
    v_add_f32_dpp v230, v229, v229 row_shl:4 row_mask:0xf bank_mask:0x5
    v_lshlrev_b32 v234, 16, v176
    v_and_b32 v235, 0xffff0000, v176
    v_pk_fma_f32 v[200:201], v[124:125], v[234:235], v[200:201]
    v_lshlrev_b32 v234, 16, v171
    v_and_b32 v235, 0xffff0000, v171
    s_waitcnt vmcnt(31)
    v_pk_fma_f32 v[198:199], v[152:153], v[84:85], v[198:199]
    v_pk_fma_f32 v[198:199], v[154:155], v[86:87], v[198:199]
    ds_add_u32 v224, v243 offset:3328
    buffer_load_dwordx4 v[84:87], v1, s[24:27], s71 offen offset:512 nt
    v_add_f32 v228, v198, v199
    v_pk_mul_f32 v[126:127], v[234:235], v[114:115]
    v_lshlrev_b32 v234, 16, v177
    v_and_b32 v235, 0xffff0000, v177
    v_pk_fma_f32 v[200:201], v[126:127], v[234:235], v[200:201]
    v_lshlrev_b32 v234, 16, v172
    s_waitcnt vmcnt(31)
    v_pk_fma_f32 v[198:199], v[144:145], v[88:89], v[202:203]
    v_pk_fma_f32 v[198:199], v[146:147], v[90:91], v[198:199]
    s_add_u32 s71, s71, 3072
    s_cbranch_vccnz L_th45_1
L_tb45_1:
    buffer_load_dwordx4 v[88:91], v1, s[24:27], s71 offen offset:0 nt
    v_add_f32_dpp v229, v228, v228 row_ror:8 row_mask:0xf bank_mask:0x3
    v_and_b32 v235, 0xffff0000, v172
    v_pk_mul_f32 v[128:129], v[234:235], v[116:117]
    v_lshlrev_b32 v234, 16, v178
    v_and_b32 v235, 0xffff0000, v178
    v_pk_fma_f32 v[200:201], v[128:129], v[234:235], v[200:201]
    s_waitcnt vmcnt(31)
    v_pk_fma_f32 v[198:199], v[148:149], v[92:93], v[198:199]
    v_pk_fma_f32 v[198:199], v[150:151], v[94:95], v[198:199]
    buffer_load_dwordx4 v[92:95], v1, s[24:27], s71 offen offset:256 nt
    v_lshlrev_b32 v234, 16, v173
    v_and_b32 v235, 0xffff0000, v173
    v_pk_mul_f32 v[130:131], v[234:235], v[118:119]
    v_lshlrev_b32 v234, 16, v179
    v_and_b32 v235, 0xffff0000, v179
    s_waitcnt vmcnt(31)
    v_pk_fma_f32 v[198:199], v[152:153], v[96:97], v[198:199]
    v_pk_fma_f32 v[198:199], v[154:155], v[98:99], v[198:199]
    ds_add_u32 v224, v243 offset:3328
    buffer_load_dwordx4 v[96:99], v1, s[24:27], s71 offen offset:512 nt
    v_add_f32 v228, v198, v199
    v_pk_fma_f32 v[200:201], v[130:131], v[234:235], v[200:201]
    v_pk_mul_f32 v[200:201], v[200:201], s[62:63]
    s_waitcnt vmcnt(31)
    v_pk_fma_f32 v[198:199], v[120:121], v[4:5], v[200:201]
    v_pk_fma_f32 v[198:199], v[122:123], v[6:7], v[198:199]
    ds_read_b32 v244, v243 offset:147
    s_mul_i32 s71, s70, 49152
    s_and_b32 s80, s70, 63
    s_mul_i32 s80, s80, 36864
    s_sub_u32 s71, s71, s80
    s_cbranch_vccnz L_th0_1
L_tb0_1:
    buffer_load_dwordx4 v[4:7], v1, s[28:31], s71 offen offset:0 nt
    v_add_f32_dpp v229, v228, v228 row_ror:8 row_mask:0xf bank_mask:0xc
    s_waitcnt vmcnt(31)
    v_pk_fma_f32 v[198:199], v[124:125], v[8:9], v[198:199]
    v_pk_fma_f32 v[198:199], v[126:127], v[10:11], v[198:199]
    buffer_load_dwordx4 v[8:11], v1, s[28:31], s71 offen offset:256 nt
    v_add_f32_dpp v230, v229, v229 row_shr:4 row_mask:0xf bank_mask:0xa
    s_waitcnt vmcnt(31)
    v_pk_fma_f32 v[198:199], v[128:129], v[12:13], v[198:199]
    v_pk_fma_f32 v[198:199], v[130:131], v[14:15], v[198:199]
    s_waitcnt lgkmcnt(0)
    v_cmp_lt_u32 vcc, v0, v244
    ds_add_u32 v224, v243 offset:3328
    buffer_load_dwordx4 v[12:15], v1, s[28:31], s71 offen offset:512 nt
    v_add_f32_dpp v232, v230, v230 quad_perm:[2,3,0,1] row_mask:0xf bank_mask:0xf
    v_add_f32 v228, v198, v199
    s_waitcnt vmcnt(31)
    v_pk_fma_f32 v[198:199], v[120:121], v[16:17], v[200:201]
    v_pk_fma_f32 v[198:199], v[122:123], v[18:19], v[198:199]
    s_add_u32 s71, s71, 3072
    s_cbranch_vccnz L_th3_1
L_tb3_1:
    buffer_load_dwordx4 v[16:19], v1, s[28:31], s71 offen offset:0 nt
    v_cndmask_b32 v232, v231, v232, s[64:65]
    v_add_f32_dpp v229, v228, v228 row_ror:8 row_mask:0xf bank_mask:0x3
    s_waitcnt vmcnt(25)
    v_pk_fma_f32 v[198:199], v[124:125], v[20:21], v[198:199]
    v_pk_fma_f32 v[198:199], v[126:127], v[22:23], v[198:199]
    buffer_load_dwordx4 v[20:23], v1, s[28:31], s71 offen offset:256 nt
    v_add_f32_dpp v233, v232, v232 quad_perm:[1,0,3,2] row_mask:0xf bank_mask:0xf
    v_lshlrev_b32 v234, 16, v180
    v_and_b32 v235, 0xffff0000, v180
    v_pk_mul_f32 v[144:145], v[234:235], v[108:109]
    v_lshlrev_b32 v234, 16, v186
    v_and_b32 v235, 0xffff0000, v186
    s_waitcnt vmcnt(25)
    v_pk_fma_f32 v[198:199], v[128:129], v[24:25], v[198:199]
    v_pk_fma_f32 v[198:199], v[130:131], v[26:27], v[198:199]
    ds_add_u32 v224, v243 offset:3328
    buffer_load_dwordx4 v[24:27], v1, s[28:31], s71 offen offset:512 nt
    v_add_f32 v228, v198, v199
    v_pk_mul_f32 v[202:203], v[144:145], v[234:235]
    v_lshlrev_b32 v234, 16, v181
    v_and_b32 v235, 0xffff0000, v181
    v_pk_mul_f32 v[146:147], v[234:235], v[110:111]
    v_lshlrev_b32 v234, 16, v187
    s_waitcnt vmcnt(25)
    v_pk_fma_f32 v[198:199], v[120:121], v[28:29], v[200:201]
    v_pk_fma_f32 v[198:199], v[122:123], v[30:31], v[198:199]
    s_add_u32 s71, s71, 3072
    s_cbranch_vccnz L_th6_1
L_tb6_1:
    buffer_load_dwordx4 v[28:31], v1, s[28:31], s71 offen offset:0 nt
    v_add_f32_dpp v229, v228, v228 row_ror:8 row_mask:0xf bank_mask:0xc
    v_and_b32 v235, 0xffff0000, v187
    v_pk_fma_f32 v[202:203], v[146:147], v[234:235], v[202:203]
    v_lshlrev_b32 v234, 16, v182
    v_and_b32 v235, 0xffff0000, v182
    v_pk_mul_f32 v[148:149], v[234:235], v[112:113]
    s_waitcnt vmcnt(25)
    v_pk_fma_f32 v[198:199], v[124:125], v[32:33], v[198:199]
    v_pk_fma_f32 v[198:199], v[126:127], v[34:35], v[198:199]
    buffer_load_dwordx4 v[32:35], v1, s[28:31], s71 offen offset:256 nt
    v_add_f32_dpp v230, v229, v229 row_shl:4 row_mask:0xf bank_mask:0x5
    v_lshlrev_b32 v234, 16, v188
    v_and_b32 v235, 0xffff0000, v188
    v_pk_fma_f32 v[202:203], v[148:149], v[234:235], v[202:203]
    v_lshlrev_b32 v234, 16, v183
    v_and_b32 v235, 0xffff0000, v183
    s_waitcnt vmcnt(25)
    v_pk_fma_f32 v[198:199], v[128:129], v[36:37], v[198:199]
    v_pk_fma_f32 v[198:199], v[130:131], v[38:39], v[198:199]
    ds_add_u32 v224, v243 offset:3328
    buffer_load_dwordx4 v[36:39], v1, s[28:31], s71 offen offset:512 nt
    v_add_f32 v228, v198, v199
    v_pk_mul_f32 v[150:151], v[234:235], v[114:115]
    v_lshlrev_b32 v234, 16, v189
    v_and_b32 v235, 0xffff0000, v189
    v_pk_fma_f32 v[202:203], v[150:151], v[234:235], v[202:203]
    v_lshlrev_b32 v234, 16, v184
    s_waitcnt vmcnt(25)
    v_pk_fma_f32 v[198:199], v[120:121], v[40:41], v[200:201]
    v_pk_fma_f32 v[198:199], v[122:123], v[42:43], v[198:199]
    s_add_u32 s71, s71, 3072
    s_cbranch_vccnz L_th9_1
L_tb9_1:
    buffer_load_dwordx4 v[40:43], v1, s[28:31], s71 offen offset:0 nt
    v_add_f32_dpp v229, v228, v228 row_ror:8 row_mask:0xf bank_mask:0x3
    v_and_b32 v235, 0xffff0000, v184
    v_pk_mul_f32 v[152:153], v[234:235], v[116:117]
    v_lshlrev_b32 v234, 16, v190
    v_and_b32 v235, 0xffff0000, v190
    v_pk_fma_f32 v[202:203], v[152:153], v[234:235], v[202:203]
    s_waitcnt vmcnt(25)
    v_pk_fma_f32 v[198:199], v[124:125], v[44:45], v[198:199]
    v_pk_fma_f32 v[198:199], v[126:127], v[46:47], v[198:199]
    buffer_load_dwordx4 v[44:47], v1, s[28:31], s71 offen offset:256 nt
    v_lshlrev_b32 v234, 16, v185
    v_and_b32 v235, 0xffff0000, v185
    v_pk_mul_f32 v[154:155], v[234:235], v[118:119]
    v_lshlrev_b32 v234, 16, v191
    v_and_b32 v235, 0xffff0000, v191
    s_waitcnt vmcnt(25)
    v_pk_fma_f32 v[198:199], v[128:129], v[48:49], v[198:199]
    v_pk_fma_f32 v[198:199], v[130:131], v[50:51], v[198:199]
    ds_add_u32 v224, v243 offset:3328
    buffer_load_dwordx4 v[48:51], v1, s[28:31], s71 offen offset:512 nt
    v_add_f32 v228, v198, v199
    v_pk_fma_f32 v[202:203], v[154:155], v[234:235], v[202:203]
    v_pk_mul_f32 v[202:203], v[202:203], s[62:63]
    s_waitcnt vmcnt(23)
    v_pk_fma_f32 v[198:199], v[144:145], v[52:53], v[202:203]
    v_pk_fma_f32 v[198:199], v[146:147], v[54:55], v[198:199]
    ds_read_b32 v244, v243 offset:147
    s_add_u32 s71, s71, 777216
    s_cbranch_vccnz L_th12_1
L_tb12_1:
    buffer_load_dwordx4 v[52:55], v1, s[28:31], s71 offen offset:0 nt
    v_add_f32_dpp v229, v228, v228 row_ror:8 row_mask:0xf bank_mask:0xc
    s_waitcnt vmcnt(23)
    v_pk_fma_f32 v[198:199], v[148:149], v[56:57], v[198:199]
    v_pk_fma_f32 v[198:199], v[150:151], v[58:59], v[198:199]
    buffer_load_dwordx4 v[56:59], v1, s[28:31], s71 offen offset:256 nt
    v_add_f32_dpp v230, v229, v229 row_shr:4 row_mask:0xf bank_mask:0xa
    s_waitcnt vmcnt(23)
    v_pk_fma_f32 v[198:199], v[152:153], v[60:61], v[198:199]
    v_pk_fma_f32 v[198:199], v[154:155], v[62:63], v[198:199]
    s_waitcnt lgkmcnt(0)
    v_cmp_lt_u32 vcc, v0, v244
    ds_add_u32 v224, v243 offset:3328
    buffer_load_dwordx4 v[60:63], v1, s[28:31], s71 offen offset:512 nt
    v_add_f32_dpp v231, v230, v230 quad_perm:[2,3,0,1] row_mask:0xf bank_mask:0xf
    v_add_f32 v228, v198, v199
    s_waitcnt vmcnt(23)
    v_pk_fma_f32 v[198:199], v[144:145], v[64:65], v[202:203]
    v_pk_fma_f32 v[198:199], v[146:147], v[66:67], v[198:199]
    s_add_u32 s71, s71, 3072
    s_cbranch_vccnz L_th15_1
L_tb15_1:
    buffer_load_dwordx4 v[64:67], v1, s[28:31], s71 offen offset:0 nt
    v_add_f32_dpp v229, v228, v228 row_ror:8 row_mask:0xf bank_mask:0x3
    s_waitcnt vmcnt(23)
    v_pk_fma_f32 v[198:199], v[148:149], v[68:69], v[198:199]
    v_pk_fma_f32 v[198:199], v[150:151], v[70:71], v[198:199]
    buffer_load_dwordx4 v[68:71], v1, s[28:31], s71 offen offset:256 nt
    s_waitcnt vmcnt(23)
    v_pk_fma_f32 v[198:199], v[152:153], v[72:73], v[198:199]
    v_pk_fma_f32 v[198:199], v[154:155], v[74:75], v[198:199]
    ds_add_u32 v224, v243 offset:3328
    buffer_load_dwordx4 v[72:75], v1, s[28:31], s71 offen offset:512 nt
    v_add_f32 v228, v198, v199
    s_waitcnt vmcnt(23)
    v_pk_fma_f32 v[198:199], v[144:145], v[76:77], v[202:203]
    v_pk_fma_f32 v[198:199], v[146:147], v[78:79], v[198:199]
    s_add_u32 s71, s71, 3072
    s_cbranch_vccnz L_th18_1
L_tb18_1:
    buffer_load_dwordx4 v[76:79], v1, s[28:31], s71 offen offset:0 nt
    v_add_f32_dpp v229, v228, v228 row_ror:8 row_mask:0xf bank_mask:0xc
    s_waitcnt vmcnt(23)
    v_pk_fma_f32 v[198:199], v[148:149], v[80:81], v[198:199]
    v_pk_fma_f32 v[198:199], v[150:151], v[82:83], v[198:199]
    buffer_load_dwordx4 v[80:83], v1, s[28:31], s71 offen offset:256 nt
    v_add_f32_dpp v230, v229, v229 row_shl:4 row_mask:0xf bank_mask:0x5
    s_waitcnt vmcnt(23)
    v_pk_fma_f32 v[198:199], v[152:153], v[84:85], v[198:199]
    v_pk_fma_f32 v[198:199], v[154:155], v[86:87], v[198:199]
    ds_add_u32 v224, v243 offset:3328
    buffer_load_dwordx4 v[84:87], v1, s[28:31], s71 offen offset:512 nt
    v_add_f32 v228, v198, v199
    s_waitcnt vmcnt(23)
    v_pk_fma_f32 v[198:199], v[144:145], v[88:89], v[202:203]
    v_pk_fma_f32 v[198:199], v[146:147], v[90:91], v[198:199]
    s_add_u32 s71, s71, 3072
    s_cbranch_vccnz L_th21_1
L_tb21_1:
    buffer_load_dwordx4 v[88:91], v1, s[28:31], s71 offen offset:0 nt
    v_add_f32_dpp v229, v228, v228 row_ror:8 row_mask:0xf bank_mask:0x3
    s_waitcnt vmcnt(23)
    v_pk_fma_f32 v[198:199], v[148:149], v[92:93], v[198:199]
    v_pk_fma_f32 v[198:199], v[150:151], v[94:95], v[198:199]
    buffer_load_dwordx4 v[92:95], v1, s[28:31], s71 offen offset:256 nt
    s_waitcnt vmcnt(23)
    v_pk_fma_f32 v[198:199], v[152:153], v[96:97], v[198:199]
    v_pk_fma_f32 v[198:199], v[154:155], v[98:99], v[198:199]
    ds_add_u32 v224, v243 offset:3328
    buffer_load_dwordx4 v[96:99], v1, s[28:31], s71 offen offset:512 nt
    s_branch L_x1
L_w1:
    s_branch L_w2
L_x1:
    v_add_f32 v228, v198, v199
    s_nop 1
    v_add_f32_dpp v229, v228, v228 row_ror:8 row_mask:0xf bank_mask:0xc
    s_nop 1
    v_add_f32_dpp v230, v229, v229 row_shr:4 row_mask:0xf bank_mask:0xa
    s_nop 1
    v_add_f32_dpp v232, v230, v230 quad_perm:[2,3,0,1] row_mask:0xf bank_mask:0xf
    s_nop 1
    v_cndmask_b32 v232, v231, v232, s[64:65]
    s_nop 1
    v_add_f32_dpp v231, v232, v232 quad_perm:[1,0,3,2] row_mask:0xf bank_mask:0xf
    s_nop 1
    v_cndmask_b32 v233, v233, v231, s[66:67]
    v_mul_f32 v233, 0x58000000, v233
    ds_write_b32 v239, v233
    v_add_u32 v239, 256, v239
    s_mov_b64 exec, 1
    ds_add_u32 v243, v243 offset:127
    s_mov_b64 exec, -1
    ds_read_b32 v223, v240
    v_add_u32 v240, 256, v240
    v_lshlrev_b32 v220, 16, v220
    v_lshlrev_b32 v221, 16, v221
    s_waitcnt lgkmcnt(0)
    v_max_f32_dpp v234, v223, v223 row_ror:8 row_mask:0xf bank_mask:0xf
    s_nop 1
    v_max_f32_dpp v234, v234, v234 row_ror:4 row_mask:0xf bank_mask:0xf
    s_nop 1
    v_max_f32_dpp v234, v234, v234 row_ror:2 row_mask:0xf bank_mask:0xf
    s_nop 1
    v_max_f32_dpp v234, v234, v234 row_ror:1 row_mask:0xf bank_mask:0xf
    v_mov_b32 v228, v216
    v_max_f32 v234, v234, v228
    v_sub_f32 v235, v228, v234
    v_sub_f32 v229, v223, v234
    v_exp_f32 v235, v235
    v_exp_f32 v229, v229
    s_nop 0
    v_mul_f32 v222, v229, v220
    v_mul_f32 v230, v222, v221
    v_mul_f32 v238, 0x71800000, v222
    s_nop 0
    s_mov_b32 s76, 60
L_loop1:
    v_mov_b32_dpp v236, v238 row_newbcast:0 row_mask:0xf bank_mask:0xf
    s_waitcnt vmcnt(23)
    v_pk_fma_f32 v[204:205], v[236:237], v[4:5], v[204:205] op_sel_hi:[0,1,1]
    v_pk_fma_f32 v[206:207], v[236:237], v[6:7], v[206:207] op_sel_hi:[0,1,1]
    ds_read_b32 v244, v243 offset:147
    s_add_u32 s71, s71, 777216
    s_cbranch_vccnz L_th24_2
L_tb24_2:
    buffer_load_dwordx4 v[4:7], v1, s[28:31], s71 offen offset:0 nt
    s_bitcmp0_b32 s4, 0
    s_cbranch_scc1 L_nofl2
    s_mov_b64 exec, 1
    ds_add_u32 v242, v243
    s_mov_b64 exec, -1
    v_add_u32 v241, 4096, v241
    v_add_u32 v242, 4, v242
L_nofl2:
    s_waitcnt vmcnt(23)
    v_pk_fma_f32 v[208:209], v[236:237], v[8:9], v[208:209] op_sel_hi:[0,1,1]
    v_pk_fma_f32 v[210:211], v[236:237], v[10:11], v[210:211] op_sel_hi:[0,1,1]
    buffer_load_dwordx4 v[8:11], v1, s[28:31], s71 offen offset:256 nt
    v_pk_mul_f32 v[212:213], v[212:213], v[234:235] op_sel:[0,1] op_sel_hi:[1,1]
    v_pk_mul_f32 v[214:215], v[214:215], v[234:235] op_sel:[0,1] op_sel_hi:[1,1]
    v_mov_b32 v216, v234
    s_waitcnt vmcnt(23)
    v_pk_fma_f32 v[212:213], v[236:237], v[12:13], v[212:213] op_sel_hi:[0,1,1]
    v_pk_fma_f32 v[214:215], v[236:237], v[14:15], v[214:215] op_sel_hi:[0,1,1]
    s_waitcnt lgkmcnt(0)
    v_cmp_lt_u32 vcc, v0, v244
    ds_add_u32 v224, v243 offset:3328
    buffer_load_dwordx4 v[12:15], v1, s[28:31], s71 offen offset:512 nt
    v_fma_f32 v217, v217, v235, v229
    v_mov_b32_dpp v236, v238 row_newbcast:8 row_mask:0xf bank_mask:0xf
    s_waitcnt vmcnt(23)
    v_pk_fma_f32 v[204:205], v[236:237], v[16:17], v[204:205] op_sel_hi:[0,1,1]
    v_pk_fma_f32 v[206:207], v[236:237], v[18:19], v[206:207] op_sel_hi:[0,1,1]
    s_add_u32 s71, s71, 3072
    s_cbranch_vccnz L_th27_2
L_tb27_2:
    buffer_load_dwordx4 v[16:19], v1, s[28:31], s71 offen offset:0 nt
    v_fma_f32 v218, v218, v235, v230
    s_waitcnt vmcnt(23)
    v_pk_fma_f32 v[208:209], v[236:237], v[20:21], v[208:209] op_sel_hi:[0,1,1]
    v_pk_fma_f32 v[210:211], v[236:237], v[22:23], v[210:211] op_sel_hi:[0,1,1]
    buffer_load_dwordx4 v[20:23], v1, s[28:31], s71 offen offset:256 nt
    ds_read_b32 v223, v240
    v_add_u32 v240, 256, v240
    s_waitcnt vmcnt(23)
    v_pk_fma_f32 v[212:213], v[236:237], v[24:25], v[212:213] op_sel_hi:[0,1,1]
    v_pk_fma_f32 v[214:215], v[236:237], v[26:27], v[214:215] op_sel_hi:[0,1,1]
    ds_add_u32 v224, v243 offset:3328
    buffer_load_dwordx4 v[24:27], v1, s[28:31], s71 offen offset:512 nt
    v_mov_b32_dpp v236, v238 row_newbcast:4 row_mask:0xf bank_mask:0xf
    s_waitcnt vmcnt(23)
    v_pk_fma_f32 v[204:205], v[236:237], v[28:29], v[204:205] op_sel_hi:[0,1,1]
    v_pk_fma_f32 v[206:207], v[236:237], v[30:31], v[206:207] op_sel_hi:[0,1,1]
    s_add_u32 s71, s71, 3072
    s_cbranch_vccnz L_th30_2
L_tb30_2:
    buffer_load_dwordx4 v[28:31], v1, s[28:31], s71 offen offset:0 nt
    ds_write_b128 v241, v[216:219] offset:23552
    s_waitcnt vmcnt(23)
    v_pk_fma_f32 v[208:209], v[236:237], v[32:33], v[208:209] op_sel_hi:[0,1,1]
    v_pk_fma_f32 v[210:211], v[236:237], v[34:35], v[210:211] op_sel_hi:[0,1,1]
    buffer_load_dwordx4 v[32:35], v1, s[28:31], s71 offen offset:256 nt
    s_waitcnt vmcnt(23)
    v_pk_fma_f32 v[212:213], v[236:237], v[36:37], v[212:213] op_sel_hi:[0,1,1]
    v_pk_fma_f32 v[214:215], v[236:237], v[38:39], v[214:215] op_sel_hi:[0,1,1]
    ds_add_u32 v224, v243 offset:3328
    buffer_load_dwordx4 v[36:39], v1, s[28:31], s71 offen offset:512 nt
    v_mov_b32_dpp v236, v238 row_newbcast:12 row_mask:0xf bank_mask:0xf
    s_waitcnt vmcnt(23)
    v_pk_fma_f32 v[204:205], v[236:237], v[40:41], v[204:205] op_sel_hi:[0,1,1]
    v_pk_fma_f32 v[206:207], v[236:237], v[42:43], v[206:207] op_sel_hi:[0,1,1]
    s_add_u32 s71, s71, 3072
    s_cbranch_vccnz L_th33_2
L_tb33_2:
    buffer_load_dwordx4 v[40:43], v1, s[28:31], s71 offen offset:0 nt
    s_waitcnt vmcnt(23)
    v_pk_fma_f32 v[208:209], v[236:237], v[44:45], v[208:209] op_sel_hi:[0,1,1]
    v_pk_fma_f32 v[210:211], v[236:237], v[46:47], v[210:211] op_sel_hi:[0,1,1]
    buffer_load_dwordx4 v[44:47], v1, s[28:31], s71 offen offset:256 nt
    s_waitcnt vmcnt(23)
    v_pk_fma_f32 v[212:213], v[236:237], v[48:49], v[212:213] op_sel_hi:[0,1,1]
    v_pk_fma_f32 v[214:215], v[236:237], v[50:51], v[214:215] op_sel_hi:[0,1,1]
    ds_add_u32 v224, v243 offset:3328
    buffer_load_dwordx4 v[48:51], v1, s[28:31], s71 offen offset:512 nt
    v_mov_b32_dpp v236, v238 row_newbcast:2 row_mask:0xf bank_mask:0xf
    s_waitcnt vmcnt(23)
    v_pk_fma_f32 v[204:205], v[236:237], v[52:53], v[204:205] op_sel_hi:[0,1,1]
    v_pk_fma_f32 v[206:207], v[236:237], v[54:55], v[206:207] op_sel_hi:[0,1,1]
    ds_read_b32 v244, v243 offset:147
    v_readlane_b32 s70, v245, s91
    s_add_u32 s91, s91, 1
    s_and_b32 s80, s70, 63
    s_mul_i32 s80, s80, 96
    s_lshl_b32 s73, s70, 7
    s_sub_u32 s73, s73, s80
    buffer_load_ushort v220, v3, s[40:43], s73 offen
    buffer_load_ushort v221, v3, s[44:47], s73 offen
    s_add_u32 s71, s71, 777216
    s_cbranch_vccnz L_th36_2
L_tb36_2:
    buffer_load_dwordx4 v[52:55], v1, s[28:31], s71 offen offset:0 nt
    s_waitcnt vmcnt(25)
    v_pk_fma_f32 v[208:209], v[236:237], v[56:57], v[208:209] op_sel_hi:[0,1,1]
    v_pk_fma_f32 v[210:211], v[236:237], v[58:59], v[210:211] op_sel_hi:[0,1,1]
    buffer_load_dwordx4 v[56:59], v1, s[28:31], s71 offen offset:256 nt
    s_waitcnt vmcnt(25)
    v_pk_fma_f32 v[212:213], v[236:237], v[60:61], v[212:213] op_sel_hi:[0,1,1]
    v_pk_fma_f32 v[214:215], v[236:237], v[62:63], v[214:215] op_sel_hi:[0,1,1]
    s_waitcnt lgkmcnt(0)
    v_cmp_lt_u32 vcc, v0, v244
    ds_add_u32 v224, v243 offset:3328
    buffer_load_dwordx4 v[60:63], v1, s[28:31], s71 offen offset:512 nt
    v_mov_b32_dpp v236, v238 row_newbcast:10 row_mask:0xf bank_mask:0xf
    s_waitcnt vmcnt(25)
    v_pk_fma_f32 v[204:205], v[236:237], v[64:65], v[204:205] op_sel_hi:[0,1,1]
    v_pk_fma_f32 v[206:207], v[236:237], v[66:67], v[206:207] op_sel_hi:[0,1,1]
    s_add_u32 s71, s71, 3072
    s_cbranch_vccnz L_th39_2
L_tb39_2:
    buffer_load_dwordx4 v[64:67], v1, s[28:31], s71 offen offset:0 nt
    s_waitcnt vmcnt(25)
    v_pk_fma_f32 v[208:209], v[236:237], v[68:69], v[208:209] op_sel_hi:[0,1,1]
    v_pk_fma_f32 v[210:211], v[236:237], v[70:71], v[210:211] op_sel_hi:[0,1,1]
    buffer_load_dwordx4 v[68:71], v1, s[28:31], s71 offen offset:256 nt
    s_waitcnt vmcnt(25)
    v_pk_fma_f32 v[212:213], v[236:237], v[72:73], v[212:213] op_sel_hi:[0,1,1]
    v_pk_fma_f32 v[214:215], v[236:237], v[74:75], v[214:215] op_sel_hi:[0,1,1]
    ds_add_u32 v224, v243 offset:3328
    buffer_load_dwordx4 v[72:75], v1, s[28:31], s71 offen offset:512 nt
    v_mov_b32_dpp v236, v238 row_newbcast:6 row_mask:0xf bank_mask:0xf
    s_waitcnt vmcnt(25)
    v_pk_fma_f32 v[204:205], v[236:237], v[76:77], v[204:205] op_sel_hi:[0,1,1]
    v_pk_fma_f32 v[206:207], v[236:237], v[78:79], v[206:207] op_sel_hi:[0,1,1]
    s_add_u32 s71, s71, 3072
    s_cbranch_vccnz L_th42_2
L_tb42_2:
    buffer_load_dwordx4 v[76:79], v1, s[28:31], s71 offen offset:0 nt
    s_waitcnt vmcnt(25)
    v_pk_fma_f32 v[208:209], v[236:237], v[80:81], v[208:209] op_sel_hi:[0,1,1]
    v_pk_fma_f32 v[210:211], v[236:237], v[82:83], v[210:211] op_sel_hi:[0,1,1]
    buffer_load_dwordx4 v[80:83], v1, s[28:31], s71 offen offset:256 nt
    s_waitcnt vmcnt(25)
    v_pk_fma_f32 v[212:213], v[236:237], v[84:85], v[212:213] op_sel_hi:[0,1,1]
    v_pk_fma_f32 v[214:215], v[236:237], v[86:87], v[214:215] op_sel_hi:[0,1,1]
    ds_add_u32 v224, v243 offset:3328
    buffer_load_dwordx4 v[84:87], v1, s[28:31], s71 offen offset:512 nt
    v_mov_b32_dpp v236, v238 row_newbcast:14 row_mask:0xf bank_mask:0xf
    s_waitcnt vmcnt(25)
    v_pk_fma_f32 v[204:205], v[236:237], v[88:89], v[204:205] op_sel_hi:[0,1,1]
    v_pk_fma_f32 v[206:207], v[236:237], v[90:91], v[206:207] op_sel_hi:[0,1,1]
    s_add_u32 s71, s71, 3072
    s_cbranch_vccnz L_th45_2
L_tb45_2:
    buffer_load_dwordx4 v[88:91], v1, s[28:31], s71 offen offset:0 nt
    s_waitcnt vmcnt(25)
    v_pk_fma_f32 v[208:209], v[236:237], v[92:93], v[208:209] op_sel_hi:[0,1,1]
    v_pk_fma_f32 v[210:211], v[236:237], v[94:95], v[210:211] op_sel_hi:[0,1,1]
    buffer_load_dwordx4 v[92:95], v1, s[28:31], s71 offen offset:256 nt
    s_waitcnt vmcnt(25)
    v_pk_fma_f32 v[212:213], v[236:237], v[96:97], v[212:213] op_sel_hi:[0,1,1]
    v_pk_fma_f32 v[214:215], v[236:237], v[98:99], v[214:215] op_sel_hi:[0,1,1]
    ds_add_u32 v224, v243 offset:3328
    buffer_load_dwordx4 v[96:99], v1, s[28:31], s71 offen offset:512 nt
    v_mov_b32_dpp v236, v238 row_newbcast:1 row_mask:0xf bank_mask:0xf
    s_waitcnt vmcnt(25)
    v_pk_fma_f32 v[204:205], v[236:237], v[4:5], v[204:205] op_sel_hi:[0,1,1]
    v_pk_fma_f32 v[206:207], v[236:237], v[6:7], v[206:207] op_sel_hi:[0,1,1]
    ds_read_b32 v244, v243 offset:147
    s_mul_i32 s71, s70, 49152
    s_and_b32 s80, s70, 63
    s_mul_i32 s80, s80, 36864
    s_sub_u32 s71, s71, s80
    s_cbranch_vccnz L_th0_2
L_tb0_2:
    buffer_load_dwordx4 v[4:7], v1, s[28:31], s71 offen offset:0 nt
    s_waitcnt vmcnt(25)
    v_pk_fma_f32 v[208:209], v[236:237], v[8:9], v[208:209] op_sel_hi:[0,1,1]
    v_pk_fma_f32 v[210:211], v[236:237], v[10:11], v[210:211] op_sel_hi:[0,1,1]
    buffer_load_dwordx4 v[8:11], v1, s[28:31], s71 offen offset:256 nt
    s_waitcnt vmcnt(25)
    v_pk_fma_f32 v[212:213], v[236:237], v[12:13], v[212:213] op_sel_hi:[0,1,1]
    v_pk_fma_f32 v[214:215], v[236:237], v[14:15], v[214:215] op_sel_hi:[0,1,1]
    s_waitcnt lgkmcnt(0)
    v_cmp_lt_u32 vcc, v0, v244
    ds_add_u32 v224, v243 offset:3328
    buffer_load_dwordx4 v[12:15], v1, s[28:31], s71 offen offset:512 nt
    v_max_f32_dpp v234, v223, v223 row_ror:8 row_mask:0xf bank_mask:0xf
    v_mov_b32_dpp v236, v238 row_newbcast:9 row_mask:0xf bank_mask:0xf
    s_waitcnt vmcnt(25)
    v_pk_fma_f32 v[204:205], v[236:237], v[16:17], v[204:205] op_sel_hi:[0,1,1]
    v_pk_fma_f32 v[206:207], v[236:237], v[18:19], v[206:207] op_sel_hi:[0,1,1]
    s_add_u32 s71, s71, 3072
    s_cbranch_vccnz L_th3_2
L_tb3_2:
    buffer_load_dwordx4 v[16:19], v1, s[28:31], s71 offen offset:0 nt
    v_max_f32_dpp v234, v234, v234 row_ror:4 row_mask:0xf bank_mask:0xf
    s_cmp_eq_u32 s76, 1
    s_cselect_b64 exec, 1, 0
    ds_add_u32 v243, v243 offset:131
    s_mov_b64 exec, -1
    s_waitcnt vmcnt(25)
    v_pk_fma_f32 v[208:209], v[236:237], v[20:21], v[208:209] op_sel_hi:[0,1,1]
    v_pk_fma_f32 v[210:211], v[236:237], v[22:23], v[210:211] op_sel_hi:[0,1,1]
    buffer_load_dwordx4 v[20:23], v1, s[28:31], s71 offen offset:256 nt
    v_max_f32_dpp v234, v234, v234 row_ror:2 row_mask:0xf bank_mask:0xf
    s_waitcnt vmcnt(25)
    v_pk_fma_f32 v[212:213], v[236:237], v[24:25], v[212:213] op_sel_hi:[0,1,1]
    v_pk_fma_f32 v[214:215], v[236:237], v[26:27], v[214:215] op_sel_hi:[0,1,1]
    ds_add_u32 v224, v243 offset:3328
    buffer_load_dwordx4 v[24:27], v1, s[28:31], s71 offen offset:512 nt
    v_max_f32_dpp v234, v234, v234 row_ror:1 row_mask:0xf bank_mask:0xf
    v_mov_b32_dpp v236, v238 row_newbcast:5 row_mask:0xf bank_mask:0xf
    s_waitcnt vmcnt(25)
    v_pk_fma_f32 v[204:205], v[236:237], v[28:29], v[204:205] op_sel_hi:[0,1,1]
    v_pk_fma_f32 v[206:207], v[236:237], v[30:31], v[206:207] op_sel_hi:[0,1,1]
    s_add_u32 s71, s71, 3072
    s_cbranch_vccnz L_th6_2
L_tb6_2:
    buffer_load_dwordx4 v[28:31], v1, s[28:31], s71 offen offset:0 nt
    s_lshr_b64 s[4:5], s[4:5], 1
    s_bitcmp1_b32 s4, 0
    s_cselect_b32 s6, s7, 0x7f7fffff
    v_min_f32 v228, s6, v216
    s_waitcnt vmcnt(25)
    v_pk_fma_f32 v[208:209], v[236:237], v[32:33], v[208:209] op_sel_hi:[0,1,1]
    v_pk_fma_f32 v[210:211], v[236:237], v[34:35], v[210:211] op_sel_hi:[0,1,1]
    buffer_load_dwordx4 v[32:35], v1, s[28:31], s71 offen offset:256 nt
    v_max_f32 v234, v234, v228
    s_waitcnt vmcnt(25)
    v_pk_fma_f32 v[212:213], v[236:237], v[36:37], v[212:213] op_sel_hi:[0,1,1]
    v_pk_fma_f32 v[214:215], v[236:237], v[38:39], v[214:215] op_sel_hi:[0,1,1]
    ds_add_u32 v224, v243 offset:3328
    buffer_load_dwordx4 v[36:39], v1, s[28:31], s71 offen offset:512 nt
    v_sub_f32 v235, v228, v234
    v_sub_f32 v229, v223, v234
    v_mov_b32_dpp v236, v238 row_newbcast:13 row_mask:0xf bank_mask:0xf
    s_waitcnt vmcnt(25)
    v_pk_fma_f32 v[204:205], v[236:237], v[40:41], v[204:205] op_sel_hi:[0,1,1]
    v_pk_fma_f32 v[206:207], v[236:237], v[42:43], v[206:207] op_sel_hi:[0,1,1]
    s_add_u32 s71, s71, 3072
    s_cbranch_vccnz L_th9_2
L_tb9_2:
    buffer_load_dwordx4 v[40:43], v1, s[28:31], s71 offen offset:0 nt
    v_exp_f32 v235, v235
    s_waitcnt vmcnt(25)
    v_pk_fma_f32 v[208:209], v[236:237], v[44:45], v[208:209] op_sel_hi:[0,1,1]
    v_pk_fma_f32 v[210:211], v[236:237], v[46:47], v[210:211] op_sel_hi:[0,1,1]
    buffer_load_dwordx4 v[44:47], v1, s[28:31], s71 offen offset:256 nt
    v_exp_f32 v229, v229
    s_waitcnt vmcnt(25)
    v_pk_fma_f32 v[212:213], v[236:237], v[48:49], v[212:213] op_sel_hi:[0,1,1]
    v_pk_fma_f32 v[214:215], v[236:237], v[50:51], v[214:215] op_sel_hi:[0,1,1]
    ds_add_u32 v224, v243 offset:3328
    buffer_load_dwordx4 v[48:51], v1, s[28:31], s71 offen offset:512 nt
    v_mov_b32_dpp v236, v238 row_newbcast:3 row_mask:0xf bank_mask:0xf
    s_waitcnt vmcnt(23)
    v_pk_fma_f32 v[204:205], v[236:237], v[52:53], v[204:205] op_sel_hi:[0,1,1]
    v_pk_fma_f32 v[206:207], v[236:237], v[54:55], v[206:207] op_sel_hi:[0,1,1]
    ds_read_b32 v244, v243 offset:147
    s_add_u32 s71, s71, 777216
    s_cbranch_vccnz L_th12_2
L_tb12_2:
    buffer_load_dwordx4 v[52:55], v1, s[28:31], s71 offen offset:0 nt
    v_lshlrev_b32 v220, 16, v220
    s_waitcnt vmcnt(23)
    v_pk_fma_f32 v[208:209], v[236:237], v[56:57], v[208:209] op_sel_hi:[0,1,1]
    v_pk_fma_f32 v[210:211], v[236:237], v[58:59], v[210:211] op_sel_hi:[0,1,1]
    buffer_load_dwordx4 v[56:59], v1, s[28:31], s71 offen offset:256 nt
    v_lshlrev_b32 v221, 16, v221
    s_waitcnt vmcnt(23)
    v_pk_fma_f32 v[212:213], v[236:237], v[60:61], v[212:213] op_sel_hi:[0,1,1]
    v_pk_fma_f32 v[214:215], v[236:237], v[62:63], v[214:215] op_sel_hi:[0,1,1]
    s_waitcnt lgkmcnt(0)
    v_cmp_lt_u32 vcc, v0, v244
    ds_add_u32 v224, v243 offset:3328
    buffer_load_dwordx4 v[60:63], v1, s[28:31], s71 offen offset:512 nt
    v_mov_b32_dpp v236, v238 row_newbcast:11 row_mask:0xf bank_mask:0xf
    s_waitcnt vmcnt(23)
    v_pk_fma_f32 v[204:205], v[236:237], v[64:65], v[204:205] op_sel_hi:[0,1,1]
    v_pk_fma_f32 v[206:207], v[236:237], v[66:67], v[206:207] op_sel_hi:[0,1,1]
    s_add_u32 s71, s71, 3072
    s_cbranch_vccnz L_th15_2
L_tb15_2:
    buffer_load_dwordx4 v[64:67], v1, s[28:31], s71 offen offset:0 nt
    v_mul_f32 v222, v229, v220
    s_waitcnt vmcnt(23)
    v_pk_fma_f32 v[208:209], v[236:237], v[68:69], v[208:209] op_sel_hi:[0,1,1]
    v_pk_fma_f32 v[210:211], v[236:237], v[70:71], v[210:211] op_sel_hi:[0,1,1]
    buffer_load_dwordx4 v[68:71], v1, s[28:31], s71 offen offset:256 nt
    v_mul_f32 v230, v222, v221
    s_waitcnt vmcnt(23)
    v_pk_fma_f32 v[212:213], v[236:237], v[72:73], v[212:213] op_sel_hi:[0,1,1]
    v_pk_fma_f32 v[214:215], v[236:237], v[74:75], v[214:215] op_sel_hi:[0,1,1]
    ds_add_u32 v224, v243 offset:3328
    buffer_load_dwordx4 v[72:75], v1, s[28:31], s71 offen offset:512 nt
    v_mov_b32_dpp v236, v238 row_newbcast:7 row_mask:0xf bank_mask:0xf
    s_waitcnt vmcnt(23)
    v_pk_fma_f32 v[204:205], v[236:237], v[76:77], v[204:205] op_sel_hi:[0,1,1]
    v_pk_fma_f32 v[206:207], v[236:237], v[78:79], v[206:207] op_sel_hi:[0,1,1]
    s_add_u32 s71, s71, 3072
    s_cbranch_vccnz L_th18_2
L_tb18_2:
    buffer_load_dwordx4 v[76:79], v1, s[28:31], s71 offen offset:0 nt
    s_waitcnt vmcnt(23)
    v_pk_fma_f32 v[208:209], v[236:237], v[80:81], v[208:209] op_sel_hi:[0,1,1]
    v_pk_fma_f32 v[210:211], v[236:237], v[82:83], v[210:211] op_sel_hi:[0,1,1]
    buffer_load_dwordx4 v[80:83], v1, s[28:31], s71 offen offset:256 nt
    s_waitcnt vmcnt(23)
    v_pk_fma_f32 v[212:213], v[236:237], v[84:85], v[212:213] op_sel_hi:[0,1,1]
    v_pk_fma_f32 v[214:215], v[236:237], v[86:87], v[214:215] op_sel_hi:[0,1,1]
    ds_add_u32 v224, v243 offset:3328
    buffer_load_dwordx4 v[84:87], v1, s[28:31], s71 offen offset:512 nt
    v_mov_b32_dpp v236, v238 row_newbcast:15 row_mask:0xf bank_mask:0xf
    s_waitcnt vmcnt(23)
    v_pk_fma_f32 v[204:205], v[236:237], v[88:89], v[204:205] op_sel_hi:[0,1,1]
    v_pk_fma_f32 v[206:207], v[236:237], v[90:91], v[206:207] op_sel_hi:[0,1,1]
    s_add_u32 s71, s71, 3072
    s_cbranch_vccnz L_th21_2
L_tb21_2:
    buffer_load_dwordx4 v[88:91], v1, s[28:31], s71 offen offset:0 nt
    ds_write_b128 v241, v[204:207] offset:20480
    v_mul_f32 v238, 0x71800000, v222
    s_waitcnt vmcnt(23)
    v_pk_fma_f32 v[208:209], v[236:237], v[92:93], v[208:209] op_sel_hi:[0,1,1]
    v_pk_fma_f32 v[210:211], v[236:237], v[94:95], v[210:211] op_sel_hi:[0,1,1]
    buffer_load_dwordx4 v[92:95], v1, s[28:31], s71 offen offset:256 nt
    ds_write_b128 v241, v[208:211] offset:21504
    v_pk_mul_f32 v[204:205], v[204:205], v[234:235] op_sel:[0,1] op_sel_hi:[1,1]
    v_pk_mul_f32 v[206:207], v[206:207], v[234:235] op_sel:[0,1] op_sel_hi:[1,1]
    s_waitcnt vmcnt(23)
    v_pk_fma_f32 v[212:213], v[236:237], v[96:97], v[212:213] op_sel_hi:[0,1,1]
    v_pk_fma_f32 v[214:215], v[236:237], v[98:99], v[214:215] op_sel_hi:[0,1,1]
    ds_add_u32 v224, v243 offset:3328
    buffer_load_dwordx4 v[96:99], v1, s[28:31], s71 offen offset:512 nt
    ds_write_b128 v241, v[212:215] offset:22528
    v_pk_mul_f32 v[208:209], v[208:209], v[234:235] op_sel:[0,1] op_sel_hi:[1,1]
    v_pk_mul_f32 v[210:211], v[210:211], v[234:235] op_sel:[0,1] op_sel_hi:[1,1]
    s_sub_u32 s76, s76, 1
    s_cmp_lg_u32 s76, 0
    s_cbranch_scc1 L_loop1
L_tagw:
    ds_read_b32 v227, v243 offset:139
    s_waitcnt lgkmcnt(0)
    v_readfirstlane_b32 s93, v227
    s_cmp_eq_u32 s93, 0
    s_cbranch_scc1 L_tagw
    v_mov_b32_dpp v236, v238 row_newbcast:0 row_mask:0xf bank_mask:0xf
    s_waitcnt vmcnt(23)
    v_pk_fma_f32 v[204:205], v[236:237], v[4:5], v[204:205] op_sel_hi:[0,1,1]
    v_pk_fma_f32 v[206:207], v[236:237], v[6:7], v[206:207] op_sel_hi:[0,1,1]
    ds_read_b32 v244, v243 offset:147
    s_add_u32 s71, s71, 777216
    s_cbranch_vccnz L_th24_3
L_tb24_3:
    buffer_load_dwordx4 v[4:7], v1, s[28:31], s71 offen offset:0 nt
    s_bitcmp0_b32 s4, 0
    s_cbranch_scc1 L_nofl3
    s_mov_b64 exec, 1
    ds_add_u32 v242, v243
    s_mov_b64 exec, -1
    v_add_u32 v241, 4096, v241
    v_add_u32 v242, 4, v242
L_nofl3:
    s_waitcnt vmcnt(23)
    v_pk_fma_f32 v[208:209], v[236:237], v[8:9], v[208:209] op_sel_hi:[0,1,1]
    v_pk_fma_f32 v[210:211], v[236:237], v[10:11], v[210:211] op_sel_hi:[0,1,1]
    buffer_load_dwordx4 v[8:11], v1, s[28:31], s71 offen offset:256 nt
    v_pk_mul_f32 v[212:213], v[212:213], v[234:235] op_sel:[0,1] op_sel_hi:[1,1]
    v_pk_mul_f32 v[214:215], v[214:215], v[234:235] op_sel:[0,1] op_sel_hi:[1,1]
    v_mov_b32 v216, v234
    s_waitcnt vmcnt(23)
    v_pk_fma_f32 v[212:213], v[236:237], v[12:13], v[212:213] op_sel_hi:[0,1,1]
    v_pk_fma_f32 v[214:215], v[236:237], v[14:15], v[214:215] op_sel_hi:[0,1,1]
    s_waitcnt lgkmcnt(0)
    v_cmp_lt_u32 vcc, v0, v244
    ds_add_u32 v224, v243 offset:3328
    buffer_load_dwordx4 v[12:15], v1, s[28:31], s71 offen offset:512 nt
    v_fma_f32 v217, v217, v235, v229
    v_mov_b32_dpp v236, v238 row_newbcast:8 row_mask:0xf bank_mask:0xf
    s_waitcnt vmcnt(23)
    v_pk_fma_f32 v[204:205], v[236:237], v[16:17], v[204:205] op_sel_hi:[0,1,1]
    v_pk_fma_f32 v[206:207], v[236:237], v[18:19], v[206:207] op_sel_hi:[0,1,1]
    s_add_u32 s71, s71, 3072
    s_cbranch_vccnz L_th27_3
L_tb27_3:
    buffer_load_dwordx4 v[16:19], v1, s[28:31], s71 offen offset:0 nt
    v_fma_f32 v218, v218, v235, v230
    s_waitcnt vmcnt(23)
    v_pk_fma_f32 v[208:209], v[236:237], v[20:21], v[208:209] op_sel_hi:[0,1,1]
    v_pk_fma_f32 v[210:211], v[236:237], v[22:23], v[210:211] op_sel_hi:[0,1,1]
    buffer_load_dwordx4 v[20:23], v1, s[28:31], s71 offen offset:256 nt
    s_waitcnt vmcnt(23)
    v_pk_fma_f32 v[212:213], v[236:237], v[24:25], v[212:213] op_sel_hi:[0,1,1]
    v_pk_fma_f32 v[214:215], v[236:237], v[26:27], v[214:215] op_sel_hi:[0,1,1]
    ds_add_u32 v224, v243 offset:3328
    buffer_load_dwordx4 v[24:27], v1, s[28:31], s71 offen offset:512 nt
    v_mov_b32_dpp v236, v238 row_newbcast:4 row_mask:0xf bank_mask:0xf
    s_waitcnt vmcnt(23)
    v_pk_fma_f32 v[204:205], v[236:237], v[28:29], v[204:205] op_sel_hi:[0,1,1]
    v_pk_fma_f32 v[206:207], v[236:237], v[30:31], v[206:207] op_sel_hi:[0,1,1]
    s_add_u32 s71, s71, 3072
    s_cbranch_vccnz L_th30_3
L_tb30_3:
    buffer_load_dwordx4 v[28:31], v1, s[28:31], s71 offen offset:0 nt
    s_waitcnt vmcnt(23)
    v_pk_fma_f32 v[208:209], v[236:237], v[32:33], v[208:209] op_sel_hi:[0,1,1]
    v_pk_fma_f32 v[210:211], v[236:237], v[34:35], v[210:211] op_sel_hi:[0,1,1]
    buffer_load_dwordx4 v[32:35], v1, s[28:31], s71 offen offset:256 nt
    s_waitcnt vmcnt(23)
    v_pk_fma_f32 v[212:213], v[236:237], v[36:37], v[212:213] op_sel_hi:[0,1,1]
    v_pk_fma_f32 v[214:215], v[236:237], v[38:39], v[214:215] op_sel_hi:[0,1,1]
    ds_add_u32 v224, v243 offset:3328
    buffer_load_dwordx4 v[36:39], v1, s[28:31], s71 offen offset:512 nt
    v_mov_b32_dpp v236, v238 row_newbcast:12 row_mask:0xf bank_mask:0xf
    s_waitcnt vmcnt(23)
    v_pk_fma_f32 v[204:205], v[236:237], v[40:41], v[204:205] op_sel_hi:[0,1,1]
    v_pk_fma_f32 v[206:207], v[236:237], v[42:43], v[206:207] op_sel_hi:[0,1,1]
    s_add_u32 s71, s71, 3072
    s_cbranch_vccnz L_th33_3
L_tb33_3:
    buffer_load_dwordx4 v[40:43], v1, s[28:31], s71 offen offset:0 nt
    s_waitcnt vmcnt(23)
    v_pk_fma_f32 v[208:209], v[236:237], v[44:45], v[208:209] op_sel_hi:[0,1,1]
    v_pk_fma_f32 v[210:211], v[236:237], v[46:47], v[210:211] op_sel_hi:[0,1,1]
    buffer_load_dwordx4 v[44:47], v1, s[28:31], s71 offen offset:256 nt
    s_waitcnt vmcnt(23)
    v_pk_fma_f32 v[212:213], v[236:237], v[48:49], v[212:213] op_sel_hi:[0,1,1]
    v_pk_fma_f32 v[214:215], v[236:237], v[50:51], v[214:215] op_sel_hi:[0,1,1]
    ds_add_u32 v224, v243 offset:3328
    buffer_load_dwordx4 v[48:51], v1, s[28:31], s71 offen offset:512 nt
    v_mov_b32_dpp v236, v238 row_newbcast:2 row_mask:0xf bank_mask:0xf
    s_waitcnt vmcnt(23)
    v_pk_fma_f32 v[204:205], v[236:237], v[52:53], v[204:205] op_sel_hi:[0,1,1]
    v_pk_fma_f32 v[206:207], v[236:237], v[54:55], v[206:207] op_sel_hi:[0,1,1]
    ds_read_b32 v244, v243 offset:147
    s_add_u32 s71, s71, 777216
    s_cbranch_vccnz L_th36_3
L_tb36_3:
    buffer_load_dwordx4 v[52:55], v1, s[28:31], s71 offen offset:0 nt
    s_waitcnt vmcnt(23)
    v_pk_fma_f32 v[208:209], v[236:237], v[56:57], v[208:209] op_sel_hi:[0,1,1]
    v_pk_fma_f32 v[210:211], v[236:237], v[58:59], v[210:211] op_sel_hi:[0,1,1]
    buffer_load_dwordx4 v[56:59], v1, s[28:31], s71 offen offset:256 nt
    s_waitcnt vmcnt(23)
    v_pk_fma_f32 v[212:213], v[236:237], v[60:61], v[212:213] op_sel_hi:[0,1,1]
    v_pk_fma_f32 v[214:215], v[236:237], v[62:63], v[214:215] op_sel_hi:[0,1,1]
    s_waitcnt lgkmcnt(0)
    v_cmp_lt_u32 vcc, v0, v244
    ds_add_u32 v224, v243 offset:3328
    buffer_load_dwordx4 v[60:63], v1, s[28:31], s71 offen offset:512 nt
    v_mov_b32_dpp v236, v238 row_newbcast:10 row_mask:0xf bank_mask:0xf
    s_waitcnt vmcnt(23)
    v_pk_fma_f32 v[204:205], v[236:237], v[64:65], v[204:205] op_sel_hi:[0,1,1]
    v_pk_fma_f32 v[206:207], v[236:237], v[66:67], v[206:207] op_sel_hi:[0,1,1]
    s_add_u32 s71, s71, 3072
    s_cbranch_vccnz L_th39_3
L_tb39_3:
    buffer_load_dwordx4 v[64:67], v1, s[28:31], s71 offen offset:0 nt
    s_waitcnt vmcnt(23)
    v_pk_fma_f32 v[208:209], v[236:237], v[68:69], v[208:209] op_sel_hi:[0,1,1]
    v_pk_fma_f32 v[210:211], v[236:237], v[70:71], v[210:211] op_sel_hi:[0,1,1]
    buffer_load_dwordx4 v[68:71], v1, s[28:31], s71 offen offset:256 nt
    s_waitcnt vmcnt(23)
    v_pk_fma_f32 v[212:213], v[236:237], v[72:73], v[212:213] op_sel_hi:[0,1,1]
    v_pk_fma_f32 v[214:215], v[236:237], v[74:75], v[214:215] op_sel_hi:[0,1,1]
    ds_add_u32 v224, v243 offset:3328
    buffer_load_dwordx4 v[72:75], v1, s[28:31], s71 offen offset:512 nt
    v_mov_b32_dpp v236, v238 row_newbcast:6 row_mask:0xf bank_mask:0xf
    s_waitcnt vmcnt(23)
    v_pk_fma_f32 v[204:205], v[236:237], v[76:77], v[204:205] op_sel_hi:[0,1,1]
    v_pk_fma_f32 v[206:207], v[236:237], v[78:79], v[206:207] op_sel_hi:[0,1,1]
    s_add_u32 s71, s71, 3072
    s_cbranch_vccnz L_th42_3
L_tb42_3:
    buffer_load_dwordx4 v[76:79], v1, s[28:31], s71 offen offset:0 nt
    s_waitcnt vmcnt(23)
    v_pk_fma_f32 v[208:209], v[236:237], v[80:81], v[208:209] op_sel_hi:[0,1,1]
    v_pk_fma_f32 v[210:211], v[236:237], v[82:83], v[210:211] op_sel_hi:[0,1,1]
    buffer_load_dwordx4 v[80:83], v1, s[28:31], s71 offen offset:256 nt
    s_waitcnt vmcnt(23)
    v_pk_fma_f32 v[212:213], v[236:237], v[84:85], v[212:213] op_sel_hi:[0,1,1]
    v_pk_fma_f32 v[214:215], v[236:237], v[86:87], v[214:215] op_sel_hi:[0,1,1]
    ds_add_u32 v224, v243 offset:3328
    buffer_load_dwordx4 v[84:87], v1, s[28:31], s71 offen offset:512 nt
    v_mov_b32_dpp v236, v238 row_newbcast:14 row_mask:0xf bank_mask:0xf
    s_waitcnt vmcnt(23)
    v_pk_fma_f32 v[204:205], v[236:237], v[88:89], v[204:205] op_sel_hi:[0,1,1]
    v_pk_fma_f32 v[206:207], v[236:237], v[90:91], v[206:207] op_sel_hi:[0,1,1]
    s_add_u32 s71, s71, 3072
    s_cbranch_vccnz L_th45_3
L_tb45_3:
    buffer_load_dwordx4 v[88:91], v1, s[28:31], s71 offen offset:0 nt
    ds_read_b32 v227, v226
    s_waitcnt vmcnt(23)
    v_pk_fma_f32 v[208:209], v[236:237], v[92:93], v[208:209] op_sel_hi:[0,1,1]
    v_pk_fma_f32 v[210:211], v[236:237], v[94:95], v[210:211] op_sel_hi:[0,1,1]
    buffer_load_dwordx4 v[92:95], v1, s[28:31], s71 offen offset:256 nt
    s_waitcnt vmcnt(23)
    v_pk_fma_f32 v[212:213], v[236:237], v[96:97], v[212:213] op_sel_hi:[0,1,1]
    v_pk_fma_f32 v[214:215], v[236:237], v[98:99], v[214:215] op_sel_hi:[0,1,1]
    ds_add_u32 v224, v243 offset:3328
    buffer_load_dwordx4 v[96:99], v1, s[28:31], s71 offen offset:512 nt
    s_waitcnt lgkmcnt(0)
    v_readfirstlane_b32 s80, v227
    s_cmp_lg_u32 s80, -1
    s_cbranch_scc1 L_tkoks
L_tkws:
    ds_read_b32 v227, v226
    s_waitcnt lgkmcnt(0)
    v_readfirstlane_b32 s80, v227
    s_cmp_eq_u32 s80, -1
    s_cbranch_scc1 L_tkws
L_tkoks:
    v_add_u32 v226, 4, v226
    s_cmp_ge_u32 s80, 160
    s_cbranch_scc1 L_deep
    s_lshr_b32 s81, s80, 6
    s_and_b32 s80, s80, 63
    s_mul_i32 s56, s81, 64
    s_add_u32 s56, s56, s80
    s_add_u32 s56, s56, s94
    s_and_b32 s56, s56, 511
    s_mov_b32 s57, s59
    s_add_u32 s70, s57, s56
    s_and_b32 s95, s3, 192
    s_add_u32 s95, s95, s80
    s_lshl_b32 s95, s95, 3
    s_add_u32 s95, s95, s81
    s_lshl_b32 s95, s95, 8
    s_add_u32 s95, s95, 18874368
    v_mov_b32_dpp v236, v238 row_newbcast:1 row_mask:0xf bank_mask:0xf
    s_waitcnt vmcnt(23)
    v_pk_fma_f32 v[204:205], v[236:237], v[4:5], v[204:205] op_sel_hi:[0,1,1]
    v_pk_fma_f32 v[206:207], v[236:237], v[6:7], v[206:207] op_sel_hi:[0,1,1]
    ds_read_b32 v244, v243 offset:147
    s_and_b32 s80, s70, 63
    s_mul_i32 s80, s80, 96
    s_lshl_b32 s73, s70, 7
    s_sub_u32 s73, s73, s80
    buffer_load_dword v223, v224, s[52:55], s95 offen sc0 sc1
    buffer_load_ushort v220, v3, s[40:43], s73 offen
    buffer_load_ushort v221, v3, s[44:47], s73 offen
    s_mul_i32 s71, s70, 49152
    s_and_b32 s80, s70, 63
    s_mul_i32 s80, s80, 36864
    s_sub_u32 s71, s71, s80
    s_cbranch_vccnz L_th0_3
L_tb0_3:
    buffer_load_dwordx4 v[4:7], v1, s[28:31], s71 offen offset:0 nt
    s_waitcnt vmcnt(26)
    v_pk_fma_f32 v[208:209], v[236:237], v[8:9], v[208:209] op_sel_hi:[0,1,1]
    v_pk_fma_f32 v[210:211], v[236:237], v[10:11], v[210:211] op_sel_hi:[0,1,1]
    buffer_load_dwordx4 v[8:11], v1, s[28:31], s71 offen offset:256 nt
    s_waitcnt vmcnt(26)
    v_pk_fma_f32 v[212:213], v[236:237], v[12:13], v[212:213] op_sel_hi:[0,1,1]
    v_pk_fma_f32 v[214:215], v[236:237], v[14:15], v[214:215] op_sel_hi:[0,1,1]
    s_waitcnt lgkmcnt(0)
    v_cmp_lt_u32 vcc, v0, v244
    ds_add_u32 v224, v243 offset:3328
    buffer_load_dwordx4 v[12:15], v1, s[28:31], s71 offen offset:512 nt
    v_mov_b32_dpp v236, v238 row_newbcast:9 row_mask:0xf bank_mask:0xf
    s_waitcnt vmcnt(26)
    v_pk_fma_f32 v[204:205], v[236:237], v[16:17], v[204:205] op_sel_hi:[0,1,1]
    v_pk_fma_f32 v[206:207], v[236:237], v[18:19], v[206:207] op_sel_hi:[0,1,1]
    s_add_u32 s71, s71, 3072
    s_cbranch_vccnz L_th3_3
L_tb3_3:
    buffer_load_dwordx4 v[16:19], v1, s[28:31], s71 offen offset:0 nt
    s_mov_b64 exec, 1
    ds_add_u32 v243, v243 offset:131
    s_mov_b64 exec, -1
    s_waitcnt vmcnt(26)
    v_pk_fma_f32 v[208:209], v[236:237], v[20:21], v[208:209] op_sel_hi:[0,1,1]
    v_pk_fma_f32 v[210:211], v[236:237], v[22:23], v[210:211] op_sel_hi:[0,1,1]
    buffer_load_dwordx4 v[20:23], v1, s[28:31], s71 offen offset:256 nt
    s_waitcnt vmcnt(26)
    v_pk_fma_f32 v[212:213], v[236:237], v[24:25], v[212:213] op_sel_hi:[0,1,1]
    v_pk_fma_f32 v[214:215], v[236:237], v[26:27], v[214:215] op_sel_hi:[0,1,1]
    ds_add_u32 v224, v243 offset:3328
    buffer_load_dwordx4 v[24:27], v1, s[28:31], s71 offen offset:512 nt
    v_mov_b32_dpp v236, v238 row_newbcast:5 row_mask:0xf bank_mask:0xf
    s_waitcnt vmcnt(26)
    v_pk_fma_f32 v[204:205], v[236:237], v[28:29], v[204:205] op_sel_hi:[0,1,1]
    v_pk_fma_f32 v[206:207], v[236:237], v[30:31], v[206:207] op_sel_hi:[0,1,1]
    s_add_u32 s71, s71, 3072
    s_cbranch_vccnz L_th6_3
L_tb6_3:
    buffer_load_dwordx4 v[28:31], v1, s[28:31], s71 offen offset:0 nt
    s_waitcnt vmcnt(26)
    v_pk_fma_f32 v[208:209], v[236:237], v[32:33], v[208:209] op_sel_hi:[0,1,1]
    v_pk_fma_f32 v[210:211], v[236:237], v[34:35], v[210:211] op_sel_hi:[0,1,1]
    buffer_load_dwordx4 v[32:35], v1, s[28:31], s71 offen offset:256 nt
    s_waitcnt vmcnt(26)
    v_pk_fma_f32 v[212:213], v[236:237], v[36:37], v[212:213] op_sel_hi:[0,1,1]
    v_pk_fma_f32 v[214:215], v[236:237], v[38:39], v[214:215] op_sel_hi:[0,1,1]
    ds_add_u32 v224, v243 offset:3328
    buffer_load_dwordx4 v[36:39], v1, s[28:31], s71 offen offset:512 nt
    v_mov_b32_dpp v236, v238 row_newbcast:13 row_mask:0xf bank_mask:0xf
    s_waitcnt vmcnt(26)
    v_pk_fma_f32 v[204:205], v[236:237], v[40:41], v[204:205] op_sel_hi:[0,1,1]
    v_pk_fma_f32 v[206:207], v[236:237], v[42:43], v[206:207] op_sel_hi:[0,1,1]
    s_add_u32 s71, s71, 3072
    s_cbranch_vccnz L_th9_3
L_tb9_3:
    buffer_load_dwordx4 v[40:43], v1, s[28:31], s71 offen offset:0 nt
    s_waitcnt vmcnt(26)
    v_pk_fma_f32 v[208:209], v[236:237], v[44:45], v[208:209] op_sel_hi:[0,1,1]
    v_pk_fma_f32 v[210:211], v[236:237], v[46:47], v[210:211] op_sel_hi:[0,1,1]
    s_branch L_x2
L_w2:
    s_branch L_w3
L_x2:
    buffer_load_dwordx4 v[44:47], v1, s[28:31], s71 offen offset:256 nt
    s_waitcnt vmcnt(26)
    v_pk_fma_f32 v[212:213], v[236:237], v[48:49], v[212:213] op_sel_hi:[0,1,1]
    v_pk_fma_f32 v[214:215], v[236:237], v[50:51], v[214:215] op_sel_hi:[0,1,1]
    ds_add_u32 v224, v243 offset:3328
    buffer_load_dwordx4 v[48:51], v1, s[28:31], s71 offen offset:512 nt
    v_mov_b32_dpp v236, v238 row_newbcast:3 row_mask:0xf bank_mask:0xf
    s_waitcnt vmcnt(26)
    v_pk_fma_f32 v[204:205], v[236:237], v[52:53], v[204:205] op_sel_hi:[0,1,1]
    v_pk_fma_f32 v[206:207], v[236:237], v[54:55], v[206:207] op_sel_hi:[0,1,1]
    ds_read_b32 v244, v243 offset:147
    s_add_u32 s71, s71, 777216
    s_cbranch_vccnz L_th12_3
L_tb12_3:
    buffer_load_dwordx4 v[52:55], v1, s[28:31], s71 offen offset:0 nt
    s_waitcnt vmcnt(26)
    v_pk_fma_f32 v[208:209], v[236:237], v[56:57], v[208:209] op_sel_hi:[0,1,1]
    v_pk_fma_f32 v[210:211], v[236:237], v[58:59], v[210:211] op_sel_hi:[0,1,1]
    buffer_load_dwordx4 v[56:59], v1, s[28:31], s71 offen offset:256 nt
    s_waitcnt vmcnt(26)
    v_pk_fma_f32 v[212:213], v[236:237], v[60:61], v[212:213] op_sel_hi:[0,1,1]
    v_pk_fma_f32 v[214:215], v[236:237], v[62:63], v[214:215] op_sel_hi:[0,1,1]
    s_waitcnt lgkmcnt(0)
    v_cmp_lt_u32 vcc, v0, v244
    ds_add_u32 v224, v243 offset:3328
    buffer_load_dwordx4 v[60:63], v1, s[28:31], s71 offen offset:512 nt
    v_mov_b32_dpp v236, v238 row_newbcast:11 row_mask:0xf bank_mask:0xf
    s_waitcnt vmcnt(26)
    v_pk_fma_f32 v[204:205], v[236:237], v[64:65], v[204:205] op_sel_hi:[0,1,1]
    v_pk_fma_f32 v[206:207], v[236:237], v[66:67], v[206:207] op_sel_hi:[0,1,1]
    s_add_u32 s71, s71, 3072
    s_cbranch_vccnz L_th15_3
L_tb15_3:
    buffer_load_dwordx4 v[64:67], v1, s[28:31], s71 offen offset:0 nt
    s_waitcnt vmcnt(26)
    v_pk_fma_f32 v[208:209], v[236:237], v[68:69], v[208:209] op_sel_hi:[0,1,1]
    v_pk_fma_f32 v[210:211], v[236:237], v[70:71], v[210:211] op_sel_hi:[0,1,1]
    buffer_load_dwordx4 v[68:71], v1, s[28:31], s71 offen offset:256 nt
    s_waitcnt vmcnt(26)
    v_pk_fma_f32 v[212:213], v[236:237], v[72:73], v[212:213] op_sel_hi:[0,1,1]
    v_pk_fma_f32 v[214:215], v[236:237], v[74:75], v[214:215] op_sel_hi:[0,1,1]
    ds_add_u32 v224, v243 offset:3328
    buffer_load_dwordx4 v[72:75], v1, s[28:31], s71 offen offset:512 nt
    v_mov_b32_dpp v236, v238 row_newbcast:7 row_mask:0xf bank_mask:0xf
    s_waitcnt vmcnt(26)
    v_pk_fma_f32 v[204:205], v[236:237], v[76:77], v[204:205] op_sel_hi:[0,1,1]
    v_pk_fma_f32 v[206:207], v[236:237], v[78:79], v[206:207] op_sel_hi:[0,1,1]
    s_add_u32 s71, s71, 3072
    s_cbranch_vccnz L_th18_3
L_tb18_3:
    buffer_load_dwordx4 v[76:79], v1, s[28:31], s71 offen offset:0 nt
    s_waitcnt vmcnt(26)
    v_pk_fma_f32 v[208:209], v[236:237], v[80:81], v[208:209] op_sel_hi:[0,1,1]
    v_pk_fma_f32 v[210:211], v[236:237], v[82:83], v[210:211] op_sel_hi:[0,1,1]
    buffer_load_dwordx4 v[80:83], v1, s[28:31], s71 offen offset:256 nt
    s_waitcnt vmcnt(26)
    v_pk_fma_f32 v[212:213], v[236:237], v[84:85], v[212:213] op_sel_hi:[0,1,1]
    v_pk_fma_f32 v[214:215], v[236:237], v[86:87], v[214:215] op_sel_hi:[0,1,1]
    ds_add_u32 v224, v243 offset:3328
    buffer_load_dwordx4 v[84:87], v1, s[28:31], s71 offen offset:512 nt
    v_mov_b32_dpp v236, v238 row_newbcast:15 row_mask:0xf bank_mask:0xf
    s_waitcnt vmcnt(26)
    v_pk_fma_f32 v[204:205], v[236:237], v[88:89], v[204:205] op_sel_hi:[0,1,1]
    v_pk_fma_f32 v[206:207], v[236:237], v[90:91], v[206:207] op_sel_hi:[0,1,1]
    s_add_u32 s71, s71, 3072
    s_cbranch_vccnz L_th21_3
L_tb21_3:
    buffer_load_dwordx4 v[88:91], v1, s[28:31], s71 offen offset:0 nt
    s_waitcnt vmcnt(26)
    v_pk_fma_f32 v[208:209], v[236:237], v[92:93], v[208:209] op_sel_hi:[0,1,1]
    v_pk_fma_f32 v[210:211], v[236:237], v[94:95], v[210:211] op_sel_hi:[0,1,1]
    buffer_load_dwordx4 v[92:95], v1, s[28:31], s71 offen offset:256 nt
    s_waitcnt vmcnt(26)
    v_pk_fma_f32 v[212:213], v[236:237], v[96:97], v[212:213] op_sel_hi:[0,1,1]
    v_pk_fma_f32 v[214:215], v[236:237], v[98:99], v[214:215] op_sel_hi:[0,1,1]
    ds_add_u32 v224, v243 offset:3328
    buffer_load_dwordx4 v[96:99], v1, s[28:31], s71 offen offset:512 nt
L_dloop:
    s_waitcnt vmcnt(24)
    v_lshlrev_b32 v220, 16, v220
    v_lshlrev_b32 v221, 16, v221
    v_max_f32_dpp v234, v223, v223 row_ror:8 row_mask:0xf bank_mask:0xf
    s_nop 1
    v_max_f32_dpp v234, v234, v234 row_ror:4 row_mask:0xf bank_mask:0xf
    s_nop 1
    v_max_f32_dpp v234, v234, v234 row_ror:2 row_mask:0xf bank_mask:0xf
    s_nop 1
    v_max_f32_dpp v234, v234, v234 row_ror:1 row_mask:0xf bank_mask:0xf
    v_max_f32 v234, v234, v216
    v_sub_f32 v235, v216, v234
    v_sub_f32 v222, v223, v234
    v_exp_f32 v235, v235
    v_exp_f32 v222, v222
    v_mov_b32 v216, v234
    v_fma_f32 v217, v217, v235, v222
    v_mul_f32 v222, v222, v220
    v_mul_f32 v218, v218, v235
    v_mul_f32 v238, 0x71800000, v222
    v_fmac_f32 v218, v222, v221
    v_pk_mul_f32 v[204:205], v[204:205], v[234:235] op_sel:[0,1] op_sel_hi:[1,1]
    v_pk_mul_f32 v[206:207], v[206:207], v[234:235] op_sel:[0,1] op_sel_hi:[1,1]
    v_pk_mul_f32 v[208:209], v[208:209], v[234:235] op_sel:[0,1] op_sel_hi:[1,1]
    v_pk_mul_f32 v[210:211], v[210:211], v[234:235] op_sel:[0,1] op_sel_hi:[1,1]
    v_pk_mul_f32 v[212:213], v[212:213], v[234:235] op_sel:[0,1] op_sel_hi:[1,1]
    v_pk_mul_f32 v[214:215], v[214:215], v[234:235] op_sel:[0,1] op_sel_hi:[1,1]
    v_mov_b32_dpp v236, v238 row_newbcast:0 row_mask:0xf bank_mask:0xf
    s_waitcnt vmcnt(23)
    v_pk_fma_f32 v[204:205], v[236:237], v[4:5], v[204:205] op_sel_hi:[0,1,1]
    v_pk_fma_f32 v[206:207], v[236:237], v[6:7], v[206:207] op_sel_hi:[0,1,1]
    ds_read_b32 v244, v243 offset:147
    s_add_u32 s71, s71, 777216
    s_cbranch_vccnz L_th24_4
L_tb24_4:
    buffer_load_dwordx4 v[4:7], v1, s[28:31], s71 offen offset:0 nt
    s_waitcnt vmcnt(23)
    v_pk_fma_f32 v[208:209], v[236:237], v[8:9], v[208:209] op_sel_hi:[0,1,1]
    v_pk_fma_f32 v[210:211], v[236:237], v[10:11], v[210:211] op_sel_hi:[0,1,1]
    buffer_load_dwordx4 v[8:11], v1, s[28:31], s71 offen offset:256 nt
    s_waitcnt vmcnt(23)
    v_pk_fma_f32 v[212:213], v[236:237], v[12:13], v[212:213] op_sel_hi:[0,1,1]
    v_pk_fma_f32 v[214:215], v[236:237], v[14:15], v[214:215] op_sel_hi:[0,1,1]
    s_waitcnt lgkmcnt(0)
    v_cmp_lt_u32 vcc, v0, v244
    ds_add_u32 v224, v243 offset:3328
    buffer_load_dwordx4 v[12:15], v1, s[28:31], s71 offen offset:512 nt
    v_mov_b32_dpp v236, v238 row_newbcast:8 row_mask:0xf bank_mask:0xf
    s_waitcnt vmcnt(23)
    v_pk_fma_f32 v[204:205], v[236:237], v[16:17], v[204:205] op_sel_hi:[0,1,1]
    v_pk_fma_f32 v[206:207], v[236:237], v[18:19], v[206:207] op_sel_hi:[0,1,1]
    s_add_u32 s71, s71, 3072
    s_cbranch_vccnz L_th27_4
L_tb27_4:
    buffer_load_dwordx4 v[16:19], v1, s[28:31], s71 offen offset:0 nt
    s_waitcnt vmcnt(23)
    v_pk_fma_f32 v[208:209], v[236:237], v[20:21], v[208:209] op_sel_hi:[0,1,1]
    v_pk_fma_f32 v[210:211], v[236:237], v[22:23], v[210:211] op_sel_hi:[0,1,1]
    buffer_load_dwordx4 v[20:23], v1, s[28:31], s71 offen offset:256 nt
    s_waitcnt vmcnt(23)
    v_pk_fma_f32 v[212:213], v[236:237], v[24:25], v[212:213] op_sel_hi:[0,1,1]
    v_pk_fma_f32 v[214:215], v[236:237], v[26:27], v[214:215] op_sel_hi:[0,1,1]
    ds_add_u32 v224, v243 offset:3328
    buffer_load_dwordx4 v[24:27], v1, s[28:31], s71 offen offset:512 nt
    v_mov_b32_dpp v236, v238 row_newbcast:4 row_mask:0xf bank_mask:0xf
    s_waitcnt vmcnt(23)
    v_pk_fma_f32 v[204:205], v[236:237], v[28:29], v[204:205] op_sel_hi:[0,1,1]
    v_pk_fma_f32 v[206:207], v[236:237], v[30:31], v[206:207] op_sel_hi:[0,1,1]
    s_add_u32 s71, s71, 3072
    s_cbranch_vccnz L_th30_4
L_tb30_4:
    buffer_load_dwordx4 v[28:31], v1, s[28:31], s71 offen offset:0 nt
    s_waitcnt vmcnt(23)
    v_pk_fma_f32 v[208:209], v[236:237], v[32:33], v[208:209] op_sel_hi:[0,1,1]
    v_pk_fma_f32 v[210:211], v[236:237], v[34:35], v[210:211] op_sel_hi:[0,1,1]
    buffer_load_dwordx4 v[32:35], v1, s[28:31], s71 offen offset:256 nt
    s_waitcnt vmcnt(23)
    v_pk_fma_f32 v[212:213], v[236:237], v[36:37], v[212:213] op_sel_hi:[0,1,1]
    v_pk_fma_f32 v[214:215], v[236:237], v[38:39], v[214:215] op_sel_hi:[0,1,1]
    ds_add_u32 v224, v243 offset:3328
    buffer_load_dwordx4 v[36:39], v1, s[28:31], s71 offen offset:512 nt
    v_mov_b32_dpp v236, v238 row_newbcast:12 row_mask:0xf bank_mask:0xf
    s_waitcnt vmcnt(23)
    v_pk_fma_f32 v[204:205], v[236:237], v[40:41], v[204:205] op_sel_hi:[0,1,1]
    v_pk_fma_f32 v[206:207], v[236:237], v[42:43], v[206:207] op_sel_hi:[0,1,1]
    s_add_u32 s71, s71, 3072
    s_cbranch_vccnz L_th33_4
L_tb33_4:
    buffer_load_dwordx4 v[40:43], v1, s[28:31], s71 offen offset:0 nt
    s_waitcnt vmcnt(23)
    v_pk_fma_f32 v[208:209], v[236:237], v[44:45], v[208:209] op_sel_hi:[0,1,1]
    v_pk_fma_f32 v[210:211], v[236:237], v[46:47], v[210:211] op_sel_hi:[0,1,1]
    buffer_load_dwordx4 v[44:47], v1, s[28:31], s71 offen offset:256 nt
    s_waitcnt vmcnt(23)
    v_pk_fma_f32 v[212:213], v[236:237], v[48:49], v[212:213] op_sel_hi:[0,1,1]
    v_pk_fma_f32 v[214:215], v[236:237], v[50:51], v[214:215] op_sel_hi:[0,1,1]
    ds_add_u32 v224, v243 offset:3328
    buffer_load_dwordx4 v[48:51], v1, s[28:31], s71 offen offset:512 nt
    v_mov_b32_dpp v236, v238 row_newbcast:2 row_mask:0xf bank_mask:0xf
    s_waitcnt vmcnt(23)
    v_pk_fma_f32 v[204:205], v[236:237], v[52:53], v[204:205] op_sel_hi:[0,1,1]
    v_pk_fma_f32 v[206:207], v[236:237], v[54:55], v[206:207] op_sel_hi:[0,1,1]
    ds_read_b32 v244, v243 offset:147
    s_add_u32 s71, s71, 777216
    s_cbranch_vccnz L_th36_4
L_tb36_4:
    buffer_load_dwordx4 v[52:55], v1, s[28:31], s71 offen offset:0 nt
    s_waitcnt vmcnt(23)
    v_pk_fma_f32 v[208:209], v[236:237], v[56:57], v[208:209] op_sel_hi:[0,1,1]
    v_pk_fma_f32 v[210:211], v[236:237], v[58:59], v[210:211] op_sel_hi:[0,1,1]
    buffer_load_dwordx4 v[56:59], v1, s[28:31], s71 offen offset:256 nt
    s_waitcnt vmcnt(23)
    v_pk_fma_f32 v[212:213], v[236:237], v[60:61], v[212:213] op_sel_hi:[0,1,1]
    v_pk_fma_f32 v[214:215], v[236:237], v[62:63], v[214:215] op_sel_hi:[0,1,1]
    s_waitcnt lgkmcnt(0)
    v_cmp_lt_u32 vcc, v0, v244
    ds_add_u32 v224, v243 offset:3328
    buffer_load_dwordx4 v[60:63], v1, s[28:31], s71 offen offset:512 nt
    v_mov_b32_dpp v236, v238 row_newbcast:10 row_mask:0xf bank_mask:0xf
    s_waitcnt vmcnt(23)
    v_pk_fma_f32 v[204:205], v[236:237], v[64:65], v[204:205] op_sel_hi:[0,1,1]
    v_pk_fma_f32 v[206:207], v[236:237], v[66:67], v[206:207] op_sel_hi:[0,1,1]
    s_add_u32 s71, s71, 3072
    s_cbranch_vccnz L_th39_4
L_tb39_4:
    buffer_load_dwordx4 v[64:67], v1, s[28:31], s71 offen offset:0 nt
    s_waitcnt vmcnt(23)
    v_pk_fma_f32 v[208:209], v[236:237], v[68:69], v[208:209] op_sel_hi:[0,1,1]
    v_pk_fma_f32 v[210:211], v[236:237], v[70:71], v[210:211] op_sel_hi:[0,1,1]
    buffer_load_dwordx4 v[68:71], v1, s[28:31], s71 offen offset:256 nt
    s_waitcnt vmcnt(23)
    v_pk_fma_f32 v[212:213], v[236:237], v[72:73], v[212:213] op_sel_hi:[0,1,1]
    v_pk_fma_f32 v[214:215], v[236:237], v[74:75], v[214:215] op_sel_hi:[0,1,1]
    ds_add_u32 v224, v243 offset:3328
    buffer_load_dwordx4 v[72:75], v1, s[28:31], s71 offen offset:512 nt
    v_mov_b32_dpp v236, v238 row_newbcast:6 row_mask:0xf bank_mask:0xf
    s_waitcnt vmcnt(23)
    v_pk_fma_f32 v[204:205], v[236:237], v[76:77], v[204:205] op_sel_hi:[0,1,1]
    v_pk_fma_f32 v[206:207], v[236:237], v[78:79], v[206:207] op_sel_hi:[0,1,1]
    s_add_u32 s71, s71, 3072
    s_cbranch_vccnz L_th42_4
L_tb42_4:
    buffer_load_dwordx4 v[76:79], v1, s[28:31], s71 offen offset:0 nt
    s_waitcnt vmcnt(23)
    v_pk_fma_f32 v[208:209], v[236:237], v[80:81], v[208:209] op_sel_hi:[0,1,1]
    v_pk_fma_f32 v[210:211], v[236:237], v[82:83], v[210:211] op_sel_hi:[0,1,1]
    buffer_load_dwordx4 v[80:83], v1, s[28:31], s71 offen offset:256 nt
    s_waitcnt vmcnt(23)
    v_pk_fma_f32 v[212:213], v[236:237], v[84:85], v[212:213] op_sel_hi:[0,1,1]
    v_pk_fma_f32 v[214:215], v[236:237], v[86:87], v[214:215] op_sel_hi:[0,1,1]
    ds_add_u32 v224, v243 offset:3328
    buffer_load_dwordx4 v[84:87], v1, s[28:31], s71 offen offset:512 nt
    v_mov_b32_dpp v236, v238 row_newbcast:14 row_mask:0xf bank_mask:0xf
    s_waitcnt vmcnt(23)
    v_pk_fma_f32 v[204:205], v[236:237], v[88:89], v[204:205] op_sel_hi:[0,1,1]
    v_pk_fma_f32 v[206:207], v[236:237], v[90:91], v[206:207] op_sel_hi:[0,1,1]
    s_add_u32 s71, s71, 3072
    s_cbranch_vccnz L_th45_4
L_tb45_4:
    buffer_load_dwordx4 v[88:91], v1, s[28:31], s71 offen offset:0 nt
    ds_read_b32 v227, v226
    s_waitcnt vmcnt(23)
    v_pk_fma_f32 v[208:209], v[236:237], v[92:93], v[208:209] op_sel_hi:[0,1,1]
    v_pk_fma_f32 v[210:211], v[236:237], v[94:95], v[210:211] op_sel_hi:[0,1,1]
    buffer_load_dwordx4 v[92:95], v1, s[28:31], s71 offen offset:256 nt
    s_waitcnt vmcnt(23)
    v_pk_fma_f32 v[212:213], v[236:237], v[96:97], v[212:213] op_sel_hi:[0,1,1]
    v_pk_fma_f32 v[214:215], v[236:237], v[98:99], v[214:215] op_sel_hi:[0,1,1]
    ds_add_u32 v224, v243 offset:3328
    buffer_load_dwordx4 v[96:99], v1, s[28:31], s71 offen offset:512 nt
    s_waitcnt lgkmcnt(0)
    v_readfirstlane_b32 s80, v227
    s_cmp_lg_u32 s80, -1
    s_cbranch_scc1 L_tkok
L_tkw:
    ds_read_b32 v227, v226
    s_waitcnt lgkmcnt(0)
    v_readfirstlane_b32 s80, v227
    s_cmp_eq_u32 s80, -1
    s_cbranch_scc1 L_tkw
L_tkok:
    v_add_u32 v226, 4, v226
    s_cmp_ge_u32 s80, 160
    s_cbranch_scc1 L_deep
    s_lshr_b32 s81, s80, 6
    s_and_b32 s80, s80, 63
    s_mul_i32 s56, s81, 64
    s_add_u32 s56, s56, s80
    s_add_u32 s56, s56, s94
    s_and_b32 s56, s56, 511
    s_mov_b32 s57, s59
    s_add_u32 s70, s57, s56
    s_and_b32 s95, s3, 192
    s_add_u32 s95, s95, s80
    s_lshl_b32 s95, s95, 3
    s_add_u32 s95, s95, s81
    s_lshl_b32 s95, s95, 8
    s_add_u32 s95, s95, 18874368
    v_mov_b32_dpp v236, v238 row_newbcast:1 row_mask:0xf bank_mask:0xf
    s_waitcnt vmcnt(23)
    v_pk_fma_f32 v[204:205], v[236:237], v[4:5], v[204:205] op_sel_hi:[0,1,1]
    v_pk_fma_f32 v[206:207], v[236:237], v[6:7], v[206:207] op_sel_hi:[0,1,1]
    ds_read_b32 v244, v243 offset:147
    s_and_b32 s80, s70, 63
    s_mul_i32 s80, s80, 96
    s_lshl_b32 s73, s70, 7
    s_sub_u32 s73, s73, s80
    buffer_load_dword v223, v224, s[52:55], s95 offen sc0 sc1
    buffer_load_ushort v220, v3, s[40:43], s73 offen
    buffer_load_ushort v221, v3, s[44:47], s73 offen
    s_mul_i32 s71, s70, 49152
    s_and_b32 s80, s70, 63
    s_mul_i32 s80, s80, 36864
    s_sub_u32 s71, s71, s80
    s_cbranch_vccnz L_th0_4
L_tb0_4:
    buffer_load_dwordx4 v[4:7], v1, s[28:31], s71 offen offset:0 nt
    s_waitcnt vmcnt(26)
    v_pk_fma_f32 v[208:209], v[236:237], v[8:9], v[208:209] op_sel_hi:[0,1,1]
    v_pk_fma_f32 v[210:211], v[236:237], v[10:11], v[210:211] op_sel_hi:[0,1,1]
    buffer_load_dwordx4 v[8:11], v1, s[28:31], s71 offen offset:256 nt
    s_waitcnt vmcnt(26)
    v_pk_fma_f32 v[212:213], v[236:237], v[12:13], v[212:213] op_sel_hi:[0,1,1]
    v_pk_fma_f32 v[214:215], v[236:237], v[14:15], v[214:215] op_sel_hi:[0,1,1]
    s_waitcnt lgkmcnt(0)
    v_cmp_lt_u32 vcc, v0, v244
    ds_add_u32 v224, v243 offset:3328
    buffer_load_dwordx4 v[12:15], v1, s[28:31], s71 offen offset:512 nt
    v_mov_b32_dpp v236, v238 row_newbcast:9 row_mask:0xf bank_mask:0xf
    s_waitcnt vmcnt(26)
    v_pk_fma_f32 v[204:205], v[236:237], v[16:17], v[204:205] op_sel_hi:[0,1,1]
    v_pk_fma_f32 v[206:207], v[236:237], v[18:19], v[206:207] op_sel_hi:[0,1,1]
    s_add_u32 s71, s71, 3072
    s_cbranch_vccnz L_th3_4
L_tb3_4:
    buffer_load_dwordx4 v[16:19], v1, s[28:31], s71 offen offset:0 nt
    s_mov_b64 exec, 1
    ds_add_u32 v243, v243 offset:131
    s_mov_b64 exec, -1
    s_waitcnt vmcnt(26)
    v_pk_fma_f32 v[208:209], v[236:237], v[20:21], v[208:209] op_sel_hi:[0,1,1]
    v_pk_fma_f32 v[210:211], v[236:237], v[22:23], v[210:211] op_sel_hi:[0,1,1]
    buffer_load_dwordx4 v[20:23], v1, s[28:31], s71 offen offset:256 nt
    s_waitcnt vmcnt(26)
    v_pk_fma_f32 v[212:213], v[236:237], v[24:25], v[212:213] op_sel_hi:[0,1,1]
    v_pk_fma_f32 v[214:215], v[236:237], v[26:27], v[214:215] op_sel_hi:[0,1,1]
    ds_add_u32 v224, v243 offset:3328
    buffer_load_dwordx4 v[24:27], v1, s[28:31], s71 offen offset:512 nt
    v_mov_b32_dpp v236, v238 row_newbcast:5 row_mask:0xf bank_mask:0xf
    s_waitcnt vmcnt(26)
    v_pk_fma_f32 v[204:205], v[236:237], v[28:29], v[204:205] op_sel_hi:[0,1,1]
    v_pk_fma_f32 v[206:207], v[236:237], v[30:31], v[206:207] op_sel_hi:[0,1,1]
    s_add_u32 s71, s71, 3072
    s_cbranch_vccnz L_th6_4
L_tb6_4:
    buffer_load_dwordx4 v[28:31], v1, s[28:31], s71 offen offset:0 nt
    s_waitcnt vmcnt(26)
    v_pk_fma_f32 v[208:209], v[236:237], v[32:33], v[208:209] op_sel_hi:[0,1,1]
    v_pk_fma_f32 v[210:211], v[236:237], v[34:35], v[210:211] op_sel_hi:[0,1,1]
    buffer_load_dwordx4 v[32:35], v1, s[28:31], s71 offen offset:256 nt
    s_waitcnt vmcnt(26)
    v_pk_fma_f32 v[212:213], v[236:237], v[36:37], v[212:213] op_sel_hi:[0,1,1]
    v_pk_fma_f32 v[214:215], v[236:237], v[38:39], v[214:215] op_sel_hi:[0,1,1]
    ds_add_u32 v224, v243 offset:3328
    buffer_load_dwordx4 v[36:39], v1, s[28:31], s71 offen offset:512 nt
    v_mov_b32_dpp v236, v238 row_newbcast:13 row_mask:0xf bank_mask:0xf
    s_waitcnt vmcnt(26)
    v_pk_fma_f32 v[204:205], v[236:237], v[40:41], v[204:205] op_sel_hi:[0,1,1]
    v_pk_fma_f32 v[206:207], v[236:237], v[42:43], v[206:207] op_sel_hi:[0,1,1]
    s_add_u32 s71, s71, 3072
    s_cbranch_vccnz L_th9_4
L_tb9_4:
    buffer_load_dwordx4 v[40:43], v1, s[28:31], s71 offen offset:0 nt
    s_waitcnt vmcnt(26)
    v_pk_fma_f32 v[208:209], v[236:237], v[44:45], v[208:209] op_sel_hi:[0,1,1]
    v_pk_fma_f32 v[210:211], v[236:237], v[46:47], v[210:211] op_sel_hi:[0,1,1]
    buffer_load_dwordx4 v[44:47], v1, s[28:31], s71 offen offset:256 nt
    s_waitcnt vmcnt(26)
    v_pk_fma_f32 v[212:213], v[236:237], v[48:49], v[212:213] op_sel_hi:[0,1,1]
    v_pk_fma_f32 v[214:215], v[236:237], v[50:51], v[214:215] op_sel_hi:[0,1,1]
    ds_add_u32 v224, v243 offset:3328
    buffer_load_dwordx4 v[48:51], v1, s[28:31], s71 offen offset:512 nt
    v_mov_b32_dpp v236, v238 row_newbcast:3 row_mask:0xf bank_mask:0xf
    s_waitcnt vmcnt(26)
    v_pk_fma_f32 v[204:205], v[236:237], v[52:53], v[204:205] op_sel_hi:[0,1,1]
    v_pk_fma_f32 v[206:207], v[236:237], v[54:55], v[206:207] op_sel_hi:[0,1,1]
    ds_read_b32 v244, v243 offset:147
    s_add_u32 s71, s71, 777216
    s_cbranch_vccnz L_th12_4
L_tb12_4:
    buffer_load_dwordx4 v[52:55], v1, s[28:31], s71 offen offset:0 nt
    s_waitcnt vmcnt(26)
    v_pk_fma_f32 v[208:209], v[236:237], v[56:57], v[208:209] op_sel_hi:[0,1,1]
    v_pk_fma_f32 v[210:211], v[236:237], v[58:59], v[210:211] op_sel_hi:[0,1,1]
    buffer_load_dwordx4 v[56:59], v1, s[28:31], s71 offen offset:256 nt
    s_waitcnt vmcnt(26)
    v_pk_fma_f32 v[212:213], v[236:237], v[60:61], v[212:213] op_sel_hi:[0,1,1]
    v_pk_fma_f32 v[214:215], v[236:237], v[62:63], v[214:215] op_sel_hi:[0,1,1]
    s_waitcnt lgkmcnt(0)
    v_cmp_lt_u32 vcc, v0, v244
    ds_add_u32 v224, v243 offset:3328
    buffer_load_dwordx4 v[60:63], v1, s[28:31], s71 offen offset:512 nt
    v_mov_b32_dpp v236, v238 row_newbcast:11 row_mask:0xf bank_mask:0xf
    s_waitcnt vmcnt(26)
    v_pk_fma_f32 v[204:205], v[236:237], v[64:65], v[204:205] op_sel_hi:[0,1,1]
    v_pk_fma_f32 v[206:207], v[236:237], v[66:67], v[206:207] op_sel_hi:[0,1,1]
    s_add_u32 s71, s71, 3072
    s_cbranch_vccnz L_th15_4
L_tb15_4:
    buffer_load_dwordx4 v[64:67], v1, s[28:31], s71 offen offset:0 nt
    s_waitcnt vmcnt(26)
    v_pk_fma_f32 v[208:209], v[236:237], v[68:69], v[208:209] op_sel_hi:[0,1,1]
    v_pk_fma_f32 v[210:211], v[236:237], v[70:71], v[210:211] op_sel_hi:[0,1,1]
    buffer_load_dwordx4 v[68:71], v1, s[28:31], s71 offen offset:256 nt
    s_waitcnt vmcnt(26)
    v_pk_fma_f32 v[212:213], v[236:237], v[72:73], v[212:213] op_sel_hi:[0,1,1]
    v_pk_fma_f32 v[214:215], v[236:237], v[74:75], v[214:215] op_sel_hi:[0,1,1]
    ds_add_u32 v224, v243 offset:3328
    buffer_load_dwordx4 v[72:75], v1, s[28:31], s71 offen offset:512 nt
    v_mov_b32_dpp v236, v238 row_newbcast:7 row_mask:0xf bank_mask:0xf
    s_waitcnt vmcnt(26)
    v_pk_fma_f32 v[204:205], v[236:237], v[76:77], v[204:205] op_sel_hi:[0,1,1]
    v_pk_fma_f32 v[206:207], v[236:237], v[78:79], v[206:207] op_sel_hi:[0,1,1]
    s_add_u32 s71, s71, 3072
    s_cbranch_vccnz L_th18_4
L_tb18_4:
    buffer_load_dwordx4 v[76:79], v1, s[28:31], s71 offen offset:0 nt
    s_waitcnt vmcnt(26)
    v_pk_fma_f32 v[208:209], v[236:237], v[80:81], v[208:209] op_sel_hi:[0,1,1]
    v_pk_fma_f32 v[210:211], v[236:237], v[82:83], v[210:211] op_sel_hi:[0,1,1]
    buffer_load_dwordx4 v[80:83], v1, s[28:31], s71 offen offset:256 nt
    s_waitcnt vmcnt(26)
    v_pk_fma_f32 v[212:213], v[236:237], v[84:85], v[212:213] op_sel_hi:[0,1,1]
    v_pk_fma_f32 v[214:215], v[236:237], v[86:87], v[214:215] op_sel_hi:[0,1,1]
    ds_add_u32 v224, v243 offset:3328
    buffer_load_dwordx4 v[84:87], v1, s[28:31], s71 offen offset:512 nt
    v_mov_b32_dpp v236, v238 row_newbcast:15 row_mask:0xf bank_mask:0xf
    s_waitcnt vmcnt(26)
    v_pk_fma_f32 v[204:205], v[236:237], v[88:89], v[204:205] op_sel_hi:[0,1,1]
    v_pk_fma_f32 v[206:207], v[236:237], v[90:91], v[206:207] op_sel_hi:[0,1,1]
    s_add_u32 s71, s71, 3072
    s_cbranch_vccnz L_th21_4
L_tb21_4:
    buffer_load_dwordx4 v[88:91], v1, s[28:31], s71 offen offset:0 nt
    s_waitcnt vmcnt(26)
    v_pk_fma_f32 v[208:209], v[236:237], v[92:93], v[208:209] op_sel_hi:[0,1,1]
    v_pk_fma_f32 v[210:211], v[236:237], v[94:95], v[210:211] op_sel_hi:[0,1,1]
    buffer_load_dwordx4 v[92:95], v1, s[28:31], s71 offen offset:256 nt
    s_waitcnt vmcnt(26)
    v_pk_fma_f32 v[212:213], v[236:237], v[96:97], v[212:213] op_sel_hi:[0,1,1]
    v_pk_fma_f32 v[214:215], v[236:237], v[98:99], v[214:215] op_sel_hi:[0,1,1]
    ds_add_u32 v224, v243 offset:3328
    buffer_load_dwordx4 v[96:99], v1, s[28:31], s71 offen offset:512 nt
    s_branch L_dloop
L_deep:
    s_cmp_ge_u32 s80, 192
    s_cbranch_scc1 L_dtail
    s_lshr_b32 s81, s80, 6
    s_and_b32 s80, s80, 63
    s_mul_i32 s56, s81, 64
    s_add_u32 s56, s56, s80
    s_add_u32 s56, s56, s94
    s_and_b32 s56, s56, 511
    s_mov_b32 s57, s59
    s_add_u32 s70, s57, s56
    s_and_b32 s95, s3, 192
    s_add_u32 s95, s95, s80
    s_lshl_b32 s95, s95, 3
    s_add_u32 s95, s95, s81
    s_lshl_b32 s95, s95, 8
    s_add_u32 s95, s95, 18874368
    s_and_b32 s80, s70, 63
    s_mul_i32 s80, s80, 96
    s_lshl_b32 s73, s70, 7
    s_sub_u32 s73, s73, s80
    buffer_load_dword v223, v224, s[52:55], s95 offen sc0 sc1
    buffer_load_ushort v220, v3, s[40:43], s73 offen
    buffer_load_ushort v221, v3, s[44:47], s73 offen
    s_mul_i32 s71, s70, 49152
    s_and_b32 s80, s70, 63
    s_mul_i32 s80, s80, 36864
    s_sub_u32 s71, s71, s80
    buffer_load_dwordx4 v[108:111], v1, s[28:31], s71 offen offset:0 nt
    buffer_load_dwordx4 v[112:115], v1, s[28:31], s71 offen offset:256 nt
    buffer_load_dwordx4 v[116:119], v1, s[28:31], s71 offen offset:512 nt
    s_add_u32 s71, s71, 3072
    buffer_load_dwordx4 v[120:123], v1, s[28:31], s71 offen offset:0 nt
    buffer_load_dwordx4 v[124:127], v1, s[28:31], s71 offen offset:256 nt
    buffer_load_dwordx4 v[128:131], v1, s[28:31], s71 offen offset:512 nt
    s_add_u32 s71, s71, 3072
    buffer_load_dwordx4 v[132:135], v1, s[28:31], s71 offen offset:0 nt
    buffer_load_dwordx4 v[136:139], v1, s[28:31], s71 offen offset:256 nt
    buffer_load_dwordx4 v[140:143], v1, s[28:31], s71 offen offset:512 nt
    s_add_u32 s71, s71, 3072
    buffer_load_dwordx4 v[144:147], v1, s[28:31], s71 offen offset:0 nt
    buffer_load_dwordx4 v[148:151], v1, s[28:31], s71 offen offset:256 nt
    buffer_load_dwordx4 v[152:155], v1, s[28:31], s71 offen offset:512 nt
    s_add_u32 s71, s71, 777216
    buffer_load_dwordx4 v[156:159], v1, s[28:31], s71 offen offset:0 nt
    buffer_load_dwordx4 v[160:163], v1, s[28:31], s71 offen offset:256 nt
    buffer_load_dwordx4 v[164:167], v1, s[28:31], s71 offen offset:512 nt
    s_add_u32 s71, s71, 3072
    buffer_load_dwordx4 v[168:171], v1, s[28:31], s71 offen offset:0 nt
    buffer_load_dwordx4 v[172:175], v1, s[28:31], s71 offen offset:256 nt
    buffer_load_dwordx4 v[176:179], v1, s[28:31], s71 offen offset:512 nt
    s_add_u32 s71, s71, 3072
    buffer_load_dwordx4 v[180:183], v1, s[28:31], s71 offen offset:0 nt
    buffer_load_dwordx4 v[184:187], v1, s[28:31], s71 offen offset:256 nt
    buffer_load_dwordx4 v[188:191], v1, s[28:31], s71 offen offset:512 nt
    s_add_u32 s71, s71, 3072
    buffer_load_dwordx4 v[192:195], v1, s[28:31], s71 offen offset:0 nt
    buffer_load_dwordx4 v[196:199], v1, s[28:31], s71 offen offset:256 nt
    buffer_load_dwordx4 v[200:203], v1, s[28:31], s71 offen offset:512 nt
    v_mov_b32_dpp v236, v238 row_newbcast:1 row_mask:0xf bank_mask:0xf
    s_waitcnt vmcnt(50)
    v_pk_fma_f32 v[204:205], v[236:237], v[4:5], v[204:205] op_sel_hi:[0,1,1]
    v_pk_fma_f32 v[206:207], v[236:237], v[6:7], v[206:207] op_sel_hi:[0,1,1]
    s_add_u32 s71, s71, 777216
    buffer_load_dwordx4 v[4:7], v1, s[28:31], s71 offen offset:0 nt
    s_waitcnt vmcnt(50)
    v_pk_fma_f32 v[208:209], v[236:237], v[8:9], v[208:209] op_sel_hi:[0,1,1]
    v_pk_fma_f32 v[210:211], v[236:237], v[10:11], v[210:211] op_sel_hi:[0,1,1]
    buffer_load_dwordx4 v[8:11], v1, s[28:31], s71 offen offset:256 nt
    s_waitcnt vmcnt(50)
    v_pk_fma_f32 v[212:213], v[236:237], v[12:13], v[212:213] op_sel_hi:[0,1,1]
    v_pk_fma_f32 v[214:215], v[236:237], v[14:15], v[214:215] op_sel_hi:[0,1,1]
    buffer_load_dwordx4 v[12:15], v1, s[28:31], s71 offen offset:512 nt
    v_mov_b32_dpp v236, v238 row_newbcast:9 row_mask:0xf bank_mask:0xf
    s_waitcnt vmcnt(50)
    v_pk_fma_f32 v[204:205], v[236:237], v[16:17], v[204:205] op_sel_hi:[0,1,1]
    v_pk_fma_f32 v[206:207], v[236:237], v[18:19], v[206:207] op_sel_hi:[0,1,1]
    s_add_u32 s71, s71, 3072
    buffer_load_dwordx4 v[16:19], v1, s[28:31], s71 offen offset:0 nt
    s_waitcnt vmcnt(50)
    v_pk_fma_f32 v[208:209], v[236:237], v[20:21], v[208:209] op_sel_hi:[0,1,1]
    v_pk_fma_f32 v[210:211], v[236:237], v[22:23], v[210:211] op_sel_hi:[0,1,1]
    buffer_load_dwordx4 v[20:23], v1, s[28:31], s71 offen offset:256 nt
    s_waitcnt vmcnt(50)
    v_pk_fma_f32 v[212:213], v[236:237], v[24:25], v[212:213] op_sel_hi:[0,1,1]
    v_pk_fma_f32 v[214:215], v[236:237], v[26:27], v[214:215] op_sel_hi:[0,1,1]
    buffer_load_dwordx4 v[24:27], v1, s[28:31], s71 offen offset:512 nt
    v_mov_b32_dpp v236, v238 row_newbcast:5 row_mask:0xf bank_mask:0xf
    s_waitcnt vmcnt(50)
    v_pk_fma_f32 v[204:205], v[236:237], v[28:29], v[204:205] op_sel_hi:[0,1,1]
    v_pk_fma_f32 v[206:207], v[236:237], v[30:31], v[206:207] op_sel_hi:[0,1,1]
    s_add_u32 s71, s71, 3072
    buffer_load_dwordx4 v[28:31], v1, s[28:31], s71 offen offset:0 nt
    s_waitcnt vmcnt(50)
    v_pk_fma_f32 v[208:209], v[236:237], v[32:33], v[208:209] op_sel_hi:[0,1,1]
    v_pk_fma_f32 v[210:211], v[236:237], v[34:35], v[210:211] op_sel_hi:[0,1,1]
    buffer_load_dwordx4 v[32:35], v1, s[28:31], s71 offen offset:256 nt
    s_waitcnt vmcnt(50)
    v_pk_fma_f32 v[212:213], v[236:237], v[36:37], v[212:213] op_sel_hi:[0,1,1]
    v_pk_fma_f32 v[214:215], v[236:237], v[38:39], v[214:215] op_sel_hi:[0,1,1]
    buffer_load_dwordx4 v[36:39], v1, s[28:31], s71 offen offset:512 nt
    v_mov_b32_dpp v236, v238 row_newbcast:13 row_mask:0xf bank_mask:0xf
    s_waitcnt vmcnt(50)
    v_pk_fma_f32 v[204:205], v[236:237], v[40:41], v[204:205] op_sel_hi:[0,1,1]
    v_pk_fma_f32 v[206:207], v[236:237], v[42:43], v[206:207] op_sel_hi:[0,1,1]
    s_add_u32 s71, s71, 3072
    buffer_load_dwordx4 v[40:43], v1, s[28:31], s71 offen offset:0 nt
    s_waitcnt vmcnt(50)
    v_pk_fma_f32 v[208:209], v[236:237], v[44:45], v[208:209] op_sel_hi:[0,1,1]
    v_pk_fma_f32 v[210:211], v[236:237], v[46:47], v[210:211] op_sel_hi:[0,1,1]
    buffer_load_dwordx4 v[44:47], v1, s[28:31], s71 offen offset:256 nt
    s_waitcnt vmcnt(50)
    v_pk_fma_f32 v[212:213], v[236:237], v[48:49], v[212:213] op_sel_hi:[0,1,1]
    v_pk_fma_f32 v[214:215], v[236:237], v[50:51], v[214:215] op_sel_hi:[0,1,1]
    buffer_load_dwordx4 v[48:51], v1, s[28:31], s71 offen offset:512 nt
    v_mov_b32_dpp v236, v238 row_newbcast:3 row_mask:0xf bank_mask:0xf
    s_waitcnt vmcnt(50)
    v_pk_fma_f32 v[204:205], v[236:237], v[52:53], v[204:205] op_sel_hi:[0,1,1]
    v_pk_fma_f32 v[206:207], v[236:237], v[54:55], v[206:207] op_sel_hi:[0,1,1]
    s_add_u32 s71, s71, 777216
    buffer_load_dwordx4 v[52:55], v1, s[28:31], s71 offen offset:0 nt
    s_waitcnt vmcnt(50)
    v_pk_fma_f32 v[208:209], v[236:237], v[56:57], v[208:209] op_sel_hi:[0,1,1]
    v_pk_fma_f32 v[210:211], v[236:237], v[58:59], v[210:211] op_sel_hi:[0,1,1]
    buffer_load_dwordx4 v[56:59], v1, s[28:31], s71 offen offset:256 nt
    s_waitcnt vmcnt(50)
    v_pk_fma_f32 v[212:213], v[236:237], v[60:61], v[212:213] op_sel_hi:[0,1,1]
    v_pk_fma_f32 v[214:215], v[236:237], v[62:63], v[214:215] op_sel_hi:[0,1,1]
    buffer_load_dwordx4 v[60:63], v1, s[28:31], s71 offen offset:512 nt
    v_mov_b32_dpp v236, v238 row_newbcast:11 row_mask:0xf bank_mask:0xf
    s_waitcnt vmcnt(50)
    v_pk_fma_f32 v[204:205], v[236:237], v[64:65], v[204:205] op_sel_hi:[0,1,1]
    v_pk_fma_f32 v[206:207], v[236:237], v[66:67], v[206:207] op_sel_hi:[0,1,1]
    s_add_u32 s71, s71, 3072
    buffer_load_dwordx4 v[64:67], v1, s[28:31], s71 offen offset:0 nt
    s_waitcnt vmcnt(50)
    v_pk_fma_f32 v[208:209], v[236:237], v[68:69], v[208:209] op_sel_hi:[0,1,1]
    v_pk_fma_f32 v[210:211], v[236:237], v[70:71], v[210:211] op_sel_hi:[0,1,1]
    buffer_load_dwordx4 v[68:71], v1, s[28:31], s71 offen offset:256 nt
    s_waitcnt vmcnt(50)
    v_pk_fma_f32 v[212:213], v[236:237], v[72:73], v[212:213] op_sel_hi:[0,1,1]
    v_pk_fma_f32 v[214:215], v[236:237], v[74:75], v[214:215] op_sel_hi:[0,1,1]
    buffer_load_dwordx4 v[72:75], v1, s[28:31], s71 offen offset:512 nt
    v_mov_b32_dpp v236, v238 row_newbcast:7 row_mask:0xf bank_mask:0xf
    s_waitcnt vmcnt(50)
    v_pk_fma_f32 v[204:205], v[236:237], v[76:77], v[204:205] op_sel_hi:[0,1,1]
    v_pk_fma_f32 v[206:207], v[236:237], v[78:79], v[206:207] op_sel_hi:[0,1,1]
    s_add_u32 s71, s71, 3072
    buffer_load_dwordx4 v[76:79], v1, s[28:31], s71 offen offset:0 nt
    s_waitcnt vmcnt(50)
    v_pk_fma_f32 v[208:209], v[236:237], v[80:81], v[208:209] op_sel_hi:[0,1,1]
    v_pk_fma_f32 v[210:211], v[236:237], v[82:83], v[210:211] op_sel_hi:[0,1,1]
    buffer_load_dwordx4 v[80:83], v1, s[28:31], s71 offen offset:256 nt
    s_waitcnt vmcnt(50)
    v_pk_fma_f32 v[212:213], v[236:237], v[84:85], v[212:213] op_sel_hi:[0,1,1]
    v_pk_fma_f32 v[214:215], v[236:237], v[86:87], v[214:215] op_sel_hi:[0,1,1]
    buffer_load_dwordx4 v[84:87], v1, s[28:31], s71 offen offset:512 nt
    v_mov_b32_dpp v236, v238 row_newbcast:15 row_mask:0xf bank_mask:0xf
    s_waitcnt vmcnt(50)
    v_pk_fma_f32 v[204:205], v[236:237], v[88:89], v[204:205] op_sel_hi:[0,1,1]
    v_pk_fma_f32 v[206:207], v[236:237], v[90:91], v[206:207] op_sel_hi:[0,1,1]
    s_add_u32 s71, s71, 3072
    buffer_load_dwordx4 v[88:91], v1, s[28:31], s71 offen offset:0 nt
    s_waitcnt vmcnt(50)
    v_pk_fma_f32 v[208:209], v[236:237], v[92:93], v[208:209] op_sel_hi:[0,1,1]
    v_pk_fma_f32 v[210:211], v[236:237], v[94:95], v[210:211] op_sel_hi:[0,1,1]
    buffer_load_dwordx4 v[92:95], v1, s[28:31], s71 offen offset:256 nt
    s_waitcnt vmcnt(50)
    v_pk_fma_f32 v[212:213], v[236:237], v[96:97], v[212:213] op_sel_hi:[0,1,1]
    v_pk_fma_f32 v[214:215], v[236:237], v[98:99], v[214:215] op_sel_hi:[0,1,1]
    buffer_load_dwordx4 v[96:99], v1, s[28:31], s71 offen offset:512 nt
    ds_write_b32 v243, v243 offset:143
    s_waitcnt vmcnt(48)
    v_lshlrev_b32 v220, 16, v220
    v_lshlrev_b32 v221, 16, v221
    v_max_f32_dpp v234, v223, v223 row_ror:8 row_mask:0xf bank_mask:0xf
    s_nop 1
    v_max_f32_dpp v234, v234, v234 row_ror:4 row_mask:0xf bank_mask:0xf
    s_nop 1
    v_max_f32_dpp v234, v234, v234 row_ror:2 row_mask:0xf bank_mask:0xf
    s_nop 1
    v_max_f32_dpp v234, v234, v234 row_ror:1 row_mask:0xf bank_mask:0xf
    v_max_f32 v234, v234, v216
    v_sub_f32 v235, v216, v234
    v_sub_f32 v222, v223, v234
    v_exp_f32 v235, v235
    v_exp_f32 v222, v222
    v_mov_b32 v216, v234
    v_fma_f32 v217, v217, v235, v222
    v_mul_f32 v222, v222, v220
    v_mul_f32 v218, v218, v235
    v_mul_f32 v238, 0x71800000, v222
    v_fmac_f32 v218, v222, v221
    v_pk_mul_f32 v[204:205], v[204:205], v[234:235] op_sel:[0,1] op_sel_hi:[1,1]
    v_pk_mul_f32 v[206:207], v[206:207], v[234:235] op_sel:[0,1] op_sel_hi:[1,1]
    v_pk_mul_f32 v[208:209], v[208:209], v[234:235] op_sel:[0,1] op_sel_hi:[1,1]
    v_pk_mul_f32 v[210:211], v[210:211], v[234:235] op_sel:[0,1] op_sel_hi:[1,1]
    v_pk_mul_f32 v[212:213], v[212:213], v[234:235] op_sel:[0,1] op_sel_hi:[1,1]
    s_branch L_x3
L_w3:
    s_branch L_w4
L_x3:
    v_pk_mul_f32 v[214:215], v[214:215], v[234:235] op_sel:[0,1] op_sel_hi:[1,1]
    v_mov_b32_dpp v236, v238 row_newbcast:0 row_mask:0xf bank_mask:0xf
    s_waitcnt vmcnt(47)
    v_pk_fma_f32 v[204:205], v[236:237], v[108:109], v[204:205] op_sel_hi:[0,1,1]
    v_pk_fma_f32 v[206:207], v[236:237], v[110:111], v[206:207] op_sel_hi:[0,1,1]
    s_waitcnt vmcnt(46)
    v_pk_fma_f32 v[208:209], v[236:237], v[112:113], v[208:209] op_sel_hi:[0,1,1]
    v_pk_fma_f32 v[210:211], v[236:237], v[114:115], v[210:211] op_sel_hi:[0,1,1]
    s_waitcnt vmcnt(45)
    v_pk_fma_f32 v[212:213], v[236:237], v[116:117], v[212:213] op_sel_hi:[0,1,1]
    v_pk_fma_f32 v[214:215], v[236:237], v[118:119], v[214:215] op_sel_hi:[0,1,1]
    v_mov_b32_dpp v236, v238 row_newbcast:8 row_mask:0xf bank_mask:0xf
    s_waitcnt vmcnt(44)
    v_pk_fma_f32 v[204:205], v[236:237], v[120:121], v[204:205] op_sel_hi:[0,1,1]
    v_pk_fma_f32 v[206:207], v[236:237], v[122:123], v[206:207] op_sel_hi:[0,1,1]
    s_waitcnt vmcnt(43)
    v_pk_fma_f32 v[208:209], v[236:237], v[124:125], v[208:209] op_sel_hi:[0,1,1]
    v_pk_fma_f32 v[210:211], v[236:237], v[126:127], v[210:211] op_sel_hi:[0,1,1]
    s_waitcnt vmcnt(42)
    v_pk_fma_f32 v[212:213], v[236:237], v[128:129], v[212:213] op_sel_hi:[0,1,1]
    v_pk_fma_f32 v[214:215], v[236:237], v[130:131], v[214:215] op_sel_hi:[0,1,1]
    v_mov_b32_dpp v236, v238 row_newbcast:4 row_mask:0xf bank_mask:0xf
    s_waitcnt vmcnt(41)
    v_pk_fma_f32 v[204:205], v[236:237], v[132:133], v[204:205] op_sel_hi:[0,1,1]
    v_pk_fma_f32 v[206:207], v[236:237], v[134:135], v[206:207] op_sel_hi:[0,1,1]
    s_waitcnt vmcnt(40)
    v_pk_fma_f32 v[208:209], v[236:237], v[136:137], v[208:209] op_sel_hi:[0,1,1]
    v_pk_fma_f32 v[210:211], v[236:237], v[138:139], v[210:211] op_sel_hi:[0,1,1]
    s_waitcnt vmcnt(39)
    v_pk_fma_f32 v[212:213], v[236:237], v[140:141], v[212:213] op_sel_hi:[0,1,1]
    v_pk_fma_f32 v[214:215], v[236:237], v[142:143], v[214:215] op_sel_hi:[0,1,1]
    v_mov_b32_dpp v236, v238 row_newbcast:12 row_mask:0xf bank_mask:0xf
    s_waitcnt vmcnt(38)
    v_pk_fma_f32 v[204:205], v[236:237], v[144:145], v[204:205] op_sel_hi:[0,1,1]
    v_pk_fma_f32 v[206:207], v[236:237], v[146:147], v[206:207] op_sel_hi:[0,1,1]
    s_waitcnt vmcnt(37)
    v_pk_fma_f32 v[208:209], v[236:237], v[148:149], v[208:209] op_sel_hi:[0,1,1]
    v_pk_fma_f32 v[210:211], v[236:237], v[150:151], v[210:211] op_sel_hi:[0,1,1]
    s_waitcnt vmcnt(36)
    v_pk_fma_f32 v[212:213], v[236:237], v[152:153], v[212:213] op_sel_hi:[0,1,1]
    v_pk_fma_f32 v[214:215], v[236:237], v[154:155], v[214:215] op_sel_hi:[0,1,1]
    v_mov_b32_dpp v236, v238 row_newbcast:2 row_mask:0xf bank_mask:0xf
    s_waitcnt vmcnt(35)
    v_pk_fma_f32 v[204:205], v[236:237], v[156:157], v[204:205] op_sel_hi:[0,1,1]
    v_pk_fma_f32 v[206:207], v[236:237], v[158:159], v[206:207] op_sel_hi:[0,1,1]
    s_waitcnt vmcnt(34)
    v_pk_fma_f32 v[208:209], v[236:237], v[160:161], v[208:209] op_sel_hi:[0,1,1]
    v_pk_fma_f32 v[210:211], v[236:237], v[162:163], v[210:211] op_sel_hi:[0,1,1]
    s_waitcnt vmcnt(33)
    v_pk_fma_f32 v[212:213], v[236:237], v[164:165], v[212:213] op_sel_hi:[0,1,1]
    v_pk_fma_f32 v[214:215], v[236:237], v[166:167], v[214:215] op_sel_hi:[0,1,1]
    v_mov_b32_dpp v236, v238 row_newbcast:10 row_mask:0xf bank_mask:0xf
    s_waitcnt vmcnt(32)
    v_pk_fma_f32 v[204:205], v[236:237], v[168:169], v[204:205] op_sel_hi:[0,1,1]
    v_pk_fma_f32 v[206:207], v[236:237], v[170:171], v[206:207] op_sel_hi:[0,1,1]
    s_waitcnt vmcnt(31)
    v_pk_fma_f32 v[208:209], v[236:237], v[172:173], v[208:209] op_sel_hi:[0,1,1]
    v_pk_fma_f32 v[210:211], v[236:237], v[174:175], v[210:211] op_sel_hi:[0,1,1]
    s_waitcnt vmcnt(30)
    v_pk_fma_f32 v[212:213], v[236:237], v[176:177], v[212:213] op_sel_hi:[0,1,1]
    v_pk_fma_f32 v[214:215], v[236:237], v[178:179], v[214:215] op_sel_hi:[0,1,1]
    v_mov_b32_dpp v236, v238 row_newbcast:6 row_mask:0xf bank_mask:0xf
    s_waitcnt vmcnt(29)
    v_pk_fma_f32 v[204:205], v[236:237], v[180:181], v[204:205] op_sel_hi:[0,1,1]
    v_pk_fma_f32 v[206:207], v[236:237], v[182:183], v[206:207] op_sel_hi:[0,1,1]
    s_waitcnt vmcnt(28)
    v_pk_fma_f32 v[208:209], v[236:237], v[184:185], v[208:209] op_sel_hi:[0,1,1]
    v_pk_fma_f32 v[210:211], v[236:237], v[186:187], v[210:211] op_sel_hi:[0,1,1]
    s_waitcnt vmcnt(27)
    v_pk_fma_f32 v[212:213], v[236:237], v[188:189], v[212:213] op_sel_hi:[0,1,1]
    v_pk_fma_f32 v[214:215], v[236:237], v[190:191], v[214:215] op_sel_hi:[0,1,1]
    v_mov_b32_dpp v236, v238 row_newbcast:14 row_mask:0xf bank_mask:0xf
    s_waitcnt vmcnt(26)
    v_pk_fma_f32 v[204:205], v[236:237], v[192:193], v[204:205] op_sel_hi:[0,1,1]
    v_pk_fma_f32 v[206:207], v[236:237], v[194:195], v[206:207] op_sel_hi:[0,1,1]
    s_waitcnt vmcnt(25)
    v_pk_fma_f32 v[208:209], v[236:237], v[196:197], v[208:209] op_sel_hi:[0,1,1]
    v_pk_fma_f32 v[210:211], v[236:237], v[198:199], v[210:211] op_sel_hi:[0,1,1]
    s_waitcnt vmcnt(24)
    v_pk_fma_f32 v[212:213], v[236:237], v[200:201], v[212:213] op_sel_hi:[0,1,1]
    v_pk_fma_f32 v[214:215], v[236:237], v[202:203], v[214:215] op_sel_hi:[0,1,1]
    v_mov_b32_dpp v236, v238 row_newbcast:1 row_mask:0xf bank_mask:0xf
    s_waitcnt vmcnt(23)
    v_pk_fma_f32 v[204:205], v[236:237], v[4:5], v[204:205] op_sel_hi:[0,1,1]
    v_pk_fma_f32 v[206:207], v[236:237], v[6:7], v[206:207] op_sel_hi:[0,1,1]
    s_waitcnt vmcnt(22)
    v_pk_fma_f32 v[208:209], v[236:237], v[8:9], v[208:209] op_sel_hi:[0,1,1]
    v_pk_fma_f32 v[210:211], v[236:237], v[10:11], v[210:211] op_sel_hi:[0,1,1]
    s_waitcnt vmcnt(21)
    v_pk_fma_f32 v[212:213], v[236:237], v[12:13], v[212:213] op_sel_hi:[0,1,1]
    v_pk_fma_f32 v[214:215], v[236:237], v[14:15], v[214:215] op_sel_hi:[0,1,1]
    v_mov_b32_dpp v236, v238 row_newbcast:9 row_mask:0xf bank_mask:0xf
    s_waitcnt vmcnt(20)
    v_pk_fma_f32 v[204:205], v[236:237], v[16:17], v[204:205] op_sel_hi:[0,1,1]
    v_pk_fma_f32 v[206:207], v[236:237], v[18:19], v[206:207] op_sel_hi:[0,1,1]
    s_waitcnt vmcnt(19)
    v_pk_fma_f32 v[208:209], v[236:237], v[20:21], v[208:209] op_sel_hi:[0,1,1]
    v_pk_fma_f32 v[210:211], v[236:237], v[22:23], v[210:211] op_sel_hi:[0,1,1]
    s_waitcnt vmcnt(18)
    v_pk_fma_f32 v[212:213], v[236:237], v[24:25], v[212:213] op_sel_hi:[0,1,1]
    v_pk_fma_f32 v[214:215], v[236:237], v[26:27], v[214:215] op_sel_hi:[0,1,1]
    v_mov_b32_dpp v236, v238 row_newbcast:5 row_mask:0xf bank_mask:0xf
    s_waitcnt vmcnt(17)
    v_pk_fma_f32 v[204:205], v[236:237], v[28:29], v[204:205] op_sel_hi:[0,1,1]
    v_pk_fma_f32 v[206:207], v[236:237], v[30:31], v[206:207] op_sel_hi:[0,1,1]
    s_waitcnt vmcnt(16)
    v_pk_fma_f32 v[208:209], v[236:237], v[32:33], v[208:209] op_sel_hi:[0,1,1]
    v_pk_fma_f32 v[210:211], v[236:237], v[34:35], v[210:211] op_sel_hi:[0,1,1]
    s_waitcnt vmcnt(15)
    v_pk_fma_f32 v[212:213], v[236:237], v[36:37], v[212:213] op_sel_hi:[0,1,1]
    v_pk_fma_f32 v[214:215], v[236:237], v[38:39], v[214:215] op_sel_hi:[0,1,1]
    v_mov_b32_dpp v236, v238 row_newbcast:13 row_mask:0xf bank_mask:0xf
    s_waitcnt vmcnt(14)
    v_pk_fma_f32 v[204:205], v[236:237], v[40:41], v[204:205] op_sel_hi:[0,1,1]
    v_pk_fma_f32 v[206:207], v[236:237], v[42:43], v[206:207] op_sel_hi:[0,1,1]
    s_waitcnt vmcnt(13)
    v_pk_fma_f32 v[208:209], v[236:237], v[44:45], v[208:209] op_sel_hi:[0,1,1]
    v_pk_fma_f32 v[210:211], v[236:237], v[46:47], v[210:211] op_sel_hi:[0,1,1]
    s_waitcnt vmcnt(12)
    v_pk_fma_f32 v[212:213], v[236:237], v[48:49], v[212:213] op_sel_hi:[0,1,1]
    v_pk_fma_f32 v[214:215], v[236:237], v[50:51], v[214:215] op_sel_hi:[0,1,1]
    v_mov_b32_dpp v236, v238 row_newbcast:3 row_mask:0xf bank_mask:0xf
    s_waitcnt vmcnt(11)
    v_pk_fma_f32 v[204:205], v[236:237], v[52:53], v[204:205] op_sel_hi:[0,1,1]
    v_pk_fma_f32 v[206:207], v[236:237], v[54:55], v[206:207] op_sel_hi:[0,1,1]
    s_waitcnt vmcnt(10)
    v_pk_fma_f32 v[208:209], v[236:237], v[56:57], v[208:209] op_sel_hi:[0,1,1]
    v_pk_fma_f32 v[210:211], v[236:237], v[58:59], v[210:211] op_sel_hi:[0,1,1]
    s_waitcnt vmcnt(9)
    v_pk_fma_f32 v[212:213], v[236:237], v[60:61], v[212:213] op_sel_hi:[0,1,1]
    v_pk_fma_f32 v[214:215], v[236:237], v[62:63], v[214:215] op_sel_hi:[0,1,1]
    v_mov_b32_dpp v236, v238 row_newbcast:11 row_mask:0xf bank_mask:0xf
    s_waitcnt vmcnt(8)
    v_pk_fma_f32 v[204:205], v[236:237], v[64:65], v[204:205] op_sel_hi:[0,1,1]
    v_pk_fma_f32 v[206:207], v[236:237], v[66:67], v[206:207] op_sel_hi:[0,1,1]
    s_waitcnt vmcnt(7)
    v_pk_fma_f32 v[208:209], v[236:237], v[68:69], v[208:209] op_sel_hi:[0,1,1]
    v_pk_fma_f32 v[210:211], v[236:237], v[70:71], v[210:211] op_sel_hi:[0,1,1]
    s_waitcnt vmcnt(6)
    v_pk_fma_f32 v[212:213], v[236:237], v[72:73], v[212:213] op_sel_hi:[0,1,1]
    v_pk_fma_f32 v[214:215], v[236:237], v[74:75], v[214:215] op_sel_hi:[0,1,1]
    v_mov_b32_dpp v236, v238 row_newbcast:7 row_mask:0xf bank_mask:0xf
    s_waitcnt vmcnt(5)
    v_pk_fma_f32 v[204:205], v[236:237], v[76:77], v[204:205] op_sel_hi:[0,1,1]
    v_pk_fma_f32 v[206:207], v[236:237], v[78:79], v[206:207] op_sel_hi:[0,1,1]
    s_waitcnt vmcnt(4)
    v_pk_fma_f32 v[208:209], v[236:237], v[80:81], v[208:209] op_sel_hi:[0,1,1]
    v_pk_fma_f32 v[210:211], v[236:237], v[82:83], v[210:211] op_sel_hi:[0,1,1]
    s_waitcnt vmcnt(3)
    v_pk_fma_f32 v[212:213], v[236:237], v[84:85], v[212:213] op_sel_hi:[0,1,1]
    v_pk_fma_f32 v[214:215], v[236:237], v[86:87], v[214:215] op_sel_hi:[0,1,1]
    v_mov_b32_dpp v236, v238 row_newbcast:15 row_mask:0xf bank_mask:0xf
    s_waitcnt vmcnt(2)
    v_pk_fma_f32 v[204:205], v[236:237], v[88:89], v[204:205] op_sel_hi:[0,1,1]
    v_pk_fma_f32 v[206:207], v[236:237], v[90:91], v[206:207] op_sel_hi:[0,1,1]
    s_waitcnt vmcnt(1)
    v_pk_fma_f32 v[208:209], v[236:237], v[92:93], v[208:209] op_sel_hi:[0,1,1]
    v_pk_fma_f32 v[210:211], v[236:237], v[94:95], v[210:211] op_sel_hi:[0,1,1]
    s_waitcnt vmcnt(0)
    v_pk_fma_f32 v[212:213], v[236:237], v[96:97], v[212:213] op_sel_hi:[0,1,1]
    v_pk_fma_f32 v[214:215], v[236:237], v[98:99], v[214:215] op_sel_hi:[0,1,1]
    s_branch L_final
L_dtail:
    ds_write_b32 v243, v243 offset:143
    v_mov_b32_dpp v236, v238 row_newbcast:1 row_mask:0xf bank_mask:0xf
    s_waitcnt vmcnt(23)
    v_pk_fma_f32 v[204:205], v[236:237], v[4:5], v[204:205] op_sel_hi:[0,1,1]
    v_pk_fma_f32 v[206:207], v[236:237], v[6:7], v[206:207] op_sel_hi:[0,1,1]
    s_waitcnt vmcnt(22)
    v_pk_fma_f32 v[208:209], v[236:237], v[8:9], v[208:209] op_sel_hi:[0,1,1]
    v_pk_fma_f32 v[210:211], v[236:237], v[10:11], v[210:211] op_sel_hi:[0,1,1]
    s_waitcnt vmcnt(21)
    v_pk_fma_f32 v[212:213], v[236:237], v[12:13], v[212:213] op_sel_hi:[0,1,1]
    v_pk_fma_f32 v[214:215], v[236:237], v[14:15], v[214:215] op_sel_hi:[0,1,1]
    v_mov_b32_dpp v236, v238 row_newbcast:9 row_mask:0xf bank_mask:0xf
    s_waitcnt vmcnt(20)
    v_pk_fma_f32 v[204:205], v[236:237], v[16:17], v[204:205] op_sel_hi:[0,1,1]
    v_pk_fma_f32 v[206:207], v[236:237], v[18:19], v[206:207] op_sel_hi:[0,1,1]
    s_waitcnt vmcnt(19)
    v_pk_fma_f32 v[208:209], v[236:237], v[20:21], v[208:209] op_sel_hi:[0,1,1]
    v_pk_fma_f32 v[210:211], v[236:237], v[22:23], v[210:211] op_sel_hi:[0,1,1]
    s_waitcnt vmcnt(18)
    v_pk_fma_f32 v[212:213], v[236:237], v[24:25], v[212:213] op_sel_hi:[0,1,1]
    v_pk_fma_f32 v[214:215], v[236:237], v[26:27], v[214:215] op_sel_hi:[0,1,1]
    v_mov_b32_dpp v236, v238 row_newbcast:5 row_mask:0xf bank_mask:0xf
    s_waitcnt vmcnt(17)
    v_pk_fma_f32 v[204:205], v[236:237], v[28:29], v[204:205] op_sel_hi:[0,1,1]
    v_pk_fma_f32 v[206:207], v[236:237], v[30:31], v[206:207] op_sel_hi:[0,1,1]
    s_waitcnt vmcnt(16)
    v_pk_fma_f32 v[208:209], v[236:237], v[32:33], v[208:209] op_sel_hi:[0,1,1]
    v_pk_fma_f32 v[210:211], v[236:237], v[34:35], v[210:211] op_sel_hi:[0,1,1]
    s_waitcnt vmcnt(15)
    v_pk_fma_f32 v[212:213], v[236:237], v[36:37], v[212:213] op_sel_hi:[0,1,1]
    v_pk_fma_f32 v[214:215], v[236:237], v[38:39], v[214:215] op_sel_hi:[0,1,1]
    v_mov_b32_dpp v236, v238 row_newbcast:13 row_mask:0xf bank_mask:0xf
    s_waitcnt vmcnt(14)
    v_pk_fma_f32 v[204:205], v[236:237], v[40:41], v[204:205] op_sel_hi:[0,1,1]
    v_pk_fma_f32 v[206:207], v[236:237], v[42:43], v[206:207] op_sel_hi:[0,1,1]
    s_waitcnt vmcnt(13)
    v_pk_fma_f32 v[208:209], v[236:237], v[44:45], v[208:209] op_sel_hi:[0,1,1]
    v_pk_fma_f32 v[210:211], v[236:237], v[46:47], v[210:211] op_sel_hi:[0,1,1]
    s_waitcnt vmcnt(12)
    v_pk_fma_f32 v[212:213], v[236:237], v[48:49], v[212:213] op_sel_hi:[0,1,1]
    v_pk_fma_f32 v[214:215], v[236:237], v[50:51], v[214:215] op_sel_hi:[0,1,1]
    v_mov_b32_dpp v236, v238 row_newbcast:3 row_mask:0xf bank_mask:0xf
    s_waitcnt vmcnt(11)
    v_pk_fma_f32 v[204:205], v[236:237], v[52:53], v[204:205] op_sel_hi:[0,1,1]
    v_pk_fma_f32 v[206:207], v[236:237], v[54:55], v[206:207] op_sel_hi:[0,1,1]
    s_waitcnt vmcnt(10)
    v_pk_fma_f32 v[208:209], v[236:237], v[56:57], v[208:209] op_sel_hi:[0,1,1]
    v_pk_fma_f32 v[210:211], v[236:237], v[58:59], v[210:211] op_sel_hi:[0,1,1]
    s_waitcnt vmcnt(9)
    v_pk_fma_f32 v[212:213], v[236:237], v[60:61], v[212:213] op_sel_hi:[0,1,1]
    v_pk_fma_f32 v[214:215], v[236:237], v[62:63], v[214:215] op_sel_hi:[0,1,1]
    v_mov_b32_dpp v236, v238 row_newbcast:11 row_mask:0xf bank_mask:0xf
    s_waitcnt vmcnt(8)
    v_pk_fma_f32 v[204:205], v[236:237], v[64:65], v[204:205] op_sel_hi:[0,1,1]
    v_pk_fma_f32 v[206:207], v[236:237], v[66:67], v[206:207] op_sel_hi:[0,1,1]
    s_waitcnt vmcnt(7)
    v_pk_fma_f32 v[208:209], v[236:237], v[68:69], v[208:209] op_sel_hi:[0,1,1]
    v_pk_fma_f32 v[210:211], v[236:237], v[70:71], v[210:211] op_sel_hi:[0,1,1]
    s_waitcnt vmcnt(6)
    v_pk_fma_f32 v[212:213], v[236:237], v[72:73], v[212:213] op_sel_hi:[0,1,1]
    v_pk_fma_f32 v[214:215], v[236:237], v[74:75], v[214:215] op_sel_hi:[0,1,1]
    v_mov_b32_dpp v236, v238 row_newbcast:7 row_mask:0xf bank_mask:0xf
    s_waitcnt vmcnt(5)
    v_pk_fma_f32 v[204:205], v[236:237], v[76:77], v[204:205] op_sel_hi:[0,1,1]
    v_pk_fma_f32 v[206:207], v[236:237], v[78:79], v[206:207] op_sel_hi:[0,1,1]
    s_waitcnt vmcnt(4)
    v_pk_fma_f32 v[208:209], v[236:237], v[80:81], v[208:209] op_sel_hi:[0,1,1]
    v_pk_fma_f32 v[210:211], v[236:237], v[82:83], v[210:211] op_sel_hi:[0,1,1]
    s_waitcnt vmcnt(3)
    v_pk_fma_f32 v[212:213], v[236:237], v[84:85], v[212:213] op_sel_hi:[0,1,1]
    v_pk_fma_f32 v[214:215], v[236:237], v[86:87], v[214:215] op_sel_hi:[0,1,1]
    v_mov_b32_dpp v236, v238 row_newbcast:15 row_mask:0xf bank_mask:0xf
    s_waitcnt vmcnt(2)
    v_pk_fma_f32 v[204:205], v[236:237], v[88:89], v[204:205] op_sel_hi:[0,1,1]
    v_pk_fma_f32 v[206:207], v[236:237], v[90:91], v[206:207] op_sel_hi:[0,1,1]
    s_waitcnt vmcnt(1)
    v_pk_fma_f32 v[208:209], v[236:237], v[92:93], v[208:209] op_sel_hi:[0,1,1]
    v_pk_fma_f32 v[210:211], v[236:237], v[94:95], v[210:211] op_sel_hi:[0,1,1]
    s_waitcnt vmcnt(0)
    v_pk_fma_f32 v[212:213], v[236:237], v[96:97], v[212:213] op_sel_hi:[0,1,1]
    v_pk_fma_f32 v[214:215], v[236:237], v[98:99], v[214:215] op_sel_hi:[0,1,1]
L_final:
    s_nop 0
    v_add_f32_dpp v217, v217, v217 row_ror:8 row_mask:0xf bank_mask:0xf
    v_add_f32_dpp v218, v218, v218 row_ror:8 row_mask:0xf bank_mask:0xf
    s_nop 0
    v_add_f32_dpp v217, v217, v217 row_ror:4 row_mask:0xf bank_mask:0xf
    v_add_f32_dpp v218, v218, v218 row_ror:4 row_mask:0xf bank_mask:0xf
    s_nop 0
    v_add_f32_dpp v217, v217, v217 row_ror:2 row_mask:0xf bank_mask:0xf
    v_add_f32_dpp v218, v218, v218 row_ror:2 row_mask:0xf bank_mask:0xf
    s_nop 0
    v_add_f32_dpp v217, v217, v217 row_ror:1 row_mask:0xf bank_mask:0xf
    v_add_f32_dpp v218, v218, v218 row_ror:1 row_mask:0xf bank_mask:0xf
    v_mov_b32 v234, v216
    v_mov_b32 v235, v216
    s_nop 1
    v_permlane32_swap_b32 v234, v235
    s_nop 1
    v_max_f32 v234, v234, v235
    v_mov_b32 v235, v234
    s_nop 1
    v_permlane16_swap_b32 v234, v235
    s_nop 1
    v_max_f32 v234, v234, v235
    v_sub_f32 v235, v216, v234
    v_exp_f32 v235, v235
    v_mov_b32 v104, v234
    v_mul_f32 v217, v217, v235
    v_mul_f32 v218, v218, v235
    v_mul_f32 v235, 0x58000000, v235
    v_fma_f32 v204, v204, v235, -v218
    v_fma_f32 v205, v205, v235, -v218
    v_fma_f32 v206, v206, v235, -v218
    v_fma_f32 v207, v207, v235, -v218
    v_fma_f32 v208, v208, v235, -v218
    v_fma_f32 v209, v209, v235, -v218
    v_fma_f32 v210, v210, v235, -v218
    v_fma_f32 v211, v211, v235, -v218
    v_fma_f32 v212, v212, v235, -v218
    v_fma_f32 v213, v213, v235, -v218
    v_fma_f32 v214, v214, v235, -v218
    v_fma_f32 v215, v215, v235, -v218
    v_mov_b32 v234, v217
    s_nop 1
    v_permlane32_swap_b32 v217, v234
    v_permlane32_swap_b32 v204, v206
    v_permlane32_swap_b32 v205, v207
    v_permlane32_swap_b32 v208, v210
    v_permlane32_swap_b32 v209, v211
    v_permlane32_swap_b32 v212, v214
    v_permlane32_swap_b32 v213, v215
    s_nop 1
    v_add_f32 v217, v217, v234
    v_add_f32 v204, v204, v206
    v_add_f32 v205, v205, v207
    v_add_f32 v208, v208, v210
    v_add_f32 v209, v209, v211
    v_add_f32 v212, v212, v214
    v_add_f32 v213, v213, v215
    v_mov_b32 v234, v217
    s_nop 1
    v_permlane16_swap_b32 v217, v234
    v_permlane16_swap_b32 v204, v205
    v_permlane16_swap_b32 v208, v209
    v_permlane16_swap_b32 v212, v213
    s_nop 1
    v_add_f32 v105, v217, v234
    v_add_f32 v100, v204, v205
    v_add_f32 v101, v208, v209
    v_add_f32 v102, v212, v213
    v_mov_b32 v103, s93
    v_mov_b32 v106, s93
    v_mov_b32 v107, s93
    v_lshlrev_b32 v235, 4, v0
    s_lshl_b32 s80, s3, 11
    buffer_store_dwordx4 v[100:103], v235, s[52:55], s80 offen offset:0 sc0 sc1
    s_mov_b64 exec, 1
    buffer_store_dwordx4 v[104:107], v235, s[52:55], s80 offen offset:1024 sc0 sc1
    s_mov_b64 exec, -1
    s_endpgm
L_th24_0:
    s_waitcnt vmcnt(32)
    s_cmp_eq_u32 vcc_lo, 1
    s_cbranch_scc1 L_tb24_0
    s_waitcnt vmcnt(23)
    s_branch L_tb24_0
L_th27_0:
    s_waitcnt vmcnt(26)
    s_cmp_eq_u32 vcc_lo, 1
    s_cbranch_scc1 L_tb27_0
    s_waitcnt vmcnt(23)
    s_branch L_tb27_0
L_th30_0:
    s_waitcnt vmcnt(32)
    s_cmp_eq_u32 vcc_lo, 1
    s_cbranch_scc1 L_tb30_0
    s_waitcnt vmcnt(29)
    s_branch L_tb30_0
L_th33_0:
    s_waitcnt vmcnt(32)
    s_cmp_eq_u32 vcc_lo, 1
    s_cbranch_scc1 L_tb33_0
    s_waitcnt vmcnt(29)
    s_branch L_tb33_0
L_th36_0:
    s_waitcnt vmcnt(35)
    s_cmp_eq_u32 vcc_lo, 1
    s_cbranch_scc1 L_tb36_0
    s_waitcnt vmcnt(26)
    s_branch L_tb36_0
L_th39_0:
    s_waitcnt vmcnt(29)
    s_cmp_eq_u32 vcc_lo, 1
    s_cbranch_scc1 L_tb39_0
    s_waitcnt vmcnt(26)
    s_branch L_tb39_0
L_th42_0:
    s_waitcnt vmcnt(35)
    s_cmp_eq_u32 vcc_lo, 1
    s_cbranch_scc1 L_tb42_0
    s_waitcnt vmcnt(32)
    s_branch L_tb42_0
L_th45_0:
    s_waitcnt vmcnt(35)
    s_cmp_eq_u32 vcc_lo, 1
    s_cbranch_scc1 L_tb45_0
    s_waitcnt vmcnt(32)
    s_branch L_tb45_0
L_th0_0:
    s_waitcnt vmcnt(35)
    s_cmp_eq_u32 vcc_lo, 1
    s_cbranch_scc1 L_tb0_0
    s_waitcnt vmcnt(26)
    s_branch L_tb0_0
L_th3_0:
    s_waitcnt vmcnt(29)
    s_cmp_eq_u32 vcc_lo, 1
    s_cbranch_scc1 L_tb3_0
    s_waitcnt vmcnt(26)
    s_branch L_tb3_0
L_th6_0:
    s_waitcnt vmcnt(35)
    s_cmp_eq_u32 vcc_lo, 1
    s_cbranch_scc1 L_tb6_0
    s_waitcnt vmcnt(29)
    s_branch L_tb6_0
L_th9_0:
    s_waitcnt vmcnt(32)
    s_cmp_eq_u32 vcc_lo, 1
    s_cbranch_scc1 L_tb9_0
    s_waitcnt vmcnt(29)
    s_branch L_tb9_0
L_th12_0:
    s_waitcnt vmcnt(32)
    s_cmp_eq_u32 vcc_lo, 1
    s_cbranch_scc1 L_tb12_0
    s_waitcnt vmcnt(23)
    s_branch L_tb12_0
L_th15_0:
    s_waitcnt vmcnt(26)
    s_cmp_eq_u32 vcc_lo, 1
    s_cbranch_scc1 L_tb15_0
    s_waitcnt vmcnt(23)
    s_branch L_tb15_0
L_th18_0:
    s_waitcnt vmcnt(32)
    s_cmp_eq_u32 vcc_lo, 1
    s_cbranch_scc1 L_tb18_0
    s_waitcnt vmcnt(29)
    s_branch L_tb18_0
L_th21_0:
    s_waitcnt vmcnt(32)
    s_cmp_eq_u32 vcc_lo, 1
    s_cbranch_scc1 L_tb21_0
    s_waitcnt vmcnt(29)
    s_branch L_tb21_0
L_th24_1:
    s_waitcnt vmcnt(32)
    s_cmp_eq_u32 vcc_lo, 1
    s_cbranch_scc1 L_tb24_1
    s_waitcnt vmcnt(23)
    s_branch L_tb24_1
L_th27_1:
    s_waitcnt vmcnt(26)
    s_cmp_eq_u32 vcc_lo, 1
    s_cbranch_scc1 L_tb27_1
    s_waitcnt vmcnt(23)
    s_branch L_tb27_1
L_th30_1:
    s_waitcnt vmcnt(32)
    s_cmp_eq_u32 vcc_lo, 1
    s_cbranch_scc1 L_tb30_1
    s_waitcnt vmcnt(29)
    s_branch L_tb30_1
L_th33_1:
    s_waitcnt vmcnt(32)
    s_cmp_eq_u32 vcc_lo, 1
    s_cbranch_scc1 L_tb33_1
    s_waitcnt vmcnt(29)
    s_branch L_tb33_1
L_th36_1:
    s_waitcnt vmcnt(34)
    s_cmp_eq_u32 vcc_lo, 1
    s_cbranch_scc1 L_tb36_1
    s_waitcnt vmcnt(25)
    s_branch L_tb36_1
L_th39_1:
    s_waitcnt vmcnt(28)
    s_cmp_eq_u32 vcc_lo, 1
    s_cbranch_scc1 L_tb39_1
    s_waitcnt vmcnt(25)
    s_branch L_tb39_1
L_th42_1:
    s_waitcnt vmcnt(28)
    s_cmp_eq_u32 vcc_lo, 1
    s_cbranch_scc1 L_tb42_1
    s_waitcnt vmcnt(25)
    s_branch L_tb42_1
L_th45_1:
    s_waitcnt vmcnt(28)
    s_cmp_eq_u32 vcc_lo, 1
    s_cbranch_scc1 L_tb45_1
    s_waitcnt vmcnt(25)
    s_branch L_tb45_1
L_th0_1:
    s_waitcnt vmcnt(28)
    s_cmp_eq_u32 vcc_lo, 1
    s_cbranch_scc1 L_tb0_1
    s_waitcnt vmcnt(19)
    s_branch L_tb0_1
L_th3_1:
    s_waitcnt vmcnt(22)
    s_cmp_eq_u32 vcc_lo, 1
    s_cbranch_scc1 L_tb3_1
    s_waitcnt vmcnt(19)
    s_branch L_tb3_1
L_th6_1:
    s_waitcnt vmcnt(22)
    s_cmp_eq_u32 vcc_lo, 1
    s_cbranch_scc1 L_tb6_1
    s_waitcnt vmcnt(17)
    s_branch L_tb6_1
L_th9_1:
    s_waitcnt vmcnt(20)
    s_cmp_eq_u32 vcc_lo, 1
    s_cbranch_scc1 L_tb9_1
    s_waitcnt vmcnt(17)
    s_branch L_tb9_1
L_th12_1:
    s_waitcnt vmcnt(20)
    s_cmp_eq_u32 vcc_lo, 1
    s_cbranch_scc1 L_tb12_1
    s_waitcnt vmcnt(17)
    s_branch L_tb12_1
L_th15_1:
    s_waitcnt vmcnt(20)
    s_cmp_eq_u32 vcc_lo, 1
    s_cbranch_scc1 L_tb15_1
    s_waitcnt vmcnt(17)
    s_branch L_tb15_1
L_th18_1:
    s_waitcnt vmcnt(20)
    s_cmp_eq_u32 vcc_lo, 1
    s_cbranch_scc1 L_tb18_1
    s_waitcnt vmcnt(17)
    s_branch L_tb18_1
L_th21_1:
    s_waitcnt vmcnt(20)
    s_cmp_eq_u32 vcc_lo, 1
    s_cbranch_scc1 L_tb21_1
    s_waitcnt vmcnt(17)
    s_branch L_tb21_1
L_th24_2:
    s_waitcnt vmcnt(20)
    s_cmp_eq_u32 vcc_lo, 1
    s_cbranch_scc1 L_tb24_2
    s_waitcnt vmcnt(17)
    s_branch L_tb24_2
L_th27_2:
    s_waitcnt vmcnt(20)
    s_cmp_eq_u32 vcc_lo, 1
    s_cbranch_scc1 L_tb27_2
    s_waitcnt vmcnt(17)
    s_branch L_tb27_2
L_th30_2:
    s_waitcnt vmcnt(20)
    s_cmp_eq_u32 vcc_lo, 1
    s_cbranch_scc1 L_tb30_2
    s_waitcnt vmcnt(17)
    s_branch L_tb30_2
L_th33_2:
    s_waitcnt vmcnt(20)
    s_cmp_eq_u32 vcc_lo, 1
    s_cbranch_scc1 L_tb33_2
    s_waitcnt vmcnt(17)
    s_branch L_tb33_2
L_th36_2:
    s_waitcnt vmcnt(22)
    s_cmp_eq_u32 vcc_lo, 1
    s_cbranch_scc1 L_tb36_2
    s_waitcnt vmcnt(19)
    s_branch L_tb36_2
L_th39_2:
    s_waitcnt vmcnt(22)
    s_cmp_eq_u32 vcc_lo, 1
    s_cbranch_scc1 L_tb39_2
    s_waitcnt vmcnt(19)
    s_branch L_tb39_2
L_th42_2:
    s_waitcnt vmcnt(22)
    s_cmp_eq_u32 vcc_lo, 1
    s_cbranch_scc1 L_tb42_2
    s_waitcnt vmcnt(19)
    s_branch L_tb42_2
L_th45_2:
    s_waitcnt vmcnt(22)
    s_cmp_eq_u32 vcc_lo, 1
    s_cbranch_scc1 L_tb45_2
    s_waitcnt vmcnt(19)
    s_branch L_tb45_2
L_th0_2:
    s_waitcnt vmcnt(22)
    s_cmp_eq_u32 vcc_lo, 1
    s_cbranch_scc1 L_tb0_2
    s_waitcnt vmcnt(19)
    s_branch L_tb0_2
L_th3_2:
    s_waitcnt vmcnt(22)
    s_cmp_eq_u32 vcc_lo, 1
    s_cbranch_scc1 L_tb3_2
    s_waitcnt vmcnt(19)
    s_branch L_tb3_2
L_th6_2:
    s_waitcnt vmcnt(22)
    s_cmp_eq_u32 vcc_lo, 1
    s_cbranch_scc1 L_tb6_2
    s_waitcnt vmcnt(17)
    s_branch L_tb6_2
L_th9_2:
    s_waitcnt vmcnt(20)
    s_cmp_eq_u32 vcc_lo, 1
    s_cbranch_scc1 L_tb9_2
    s_waitcnt vmcnt(17)
    s_branch L_tb9_2
L_th12_2:
    s_waitcnt vmcnt(20)
    s_cmp_eq_u32 vcc_lo, 1
    s_cbranch_scc1 L_tb12_2
    s_waitcnt vmcnt(17)
    s_branch L_tb12_2
L_th15_2:
    s_waitcnt vmcnt(20)
    s_cmp_eq_u32 vcc_lo, 1
    s_cbranch_scc1 L_tb15_2
    s_waitcnt vmcnt(17)
    s_branch L_tb15_2
L_th18_2:
    s_waitcnt vmcnt(20)
    s_cmp_eq_u32 vcc_lo, 1
    s_cbranch_scc1 L_tb18_2
    s_waitcnt vmcnt(17)
    s_branch L_tb18_2
L_th21_2:
    s_waitcnt vmcnt(20)
    s_cmp_eq_u32 vcc_lo, 1
    s_cbranch_scc1 L_tb21_2
    s_waitcnt vmcnt(17)
    s_branch L_tb21_2
L_th24_3:
    s_waitcnt vmcnt(20)
    s_cmp_eq_u32 vcc_lo, 1
    s_cbranch_scc1 L_tb24_3
    s_waitcnt vmcnt(17)
    s_branch L_tb24_3
L_th27_3:
    s_waitcnt vmcnt(20)
    s_cmp_eq_u32 vcc_lo, 1
    s_cbranch_scc1 L_tb27_3
    s_waitcnt vmcnt(17)
    s_branch L_tb27_3
L_th30_3:
    s_waitcnt vmcnt(20)
    s_cmp_eq_u32 vcc_lo, 1
    s_cbranch_scc1 L_tb30_3
    s_waitcnt vmcnt(17)
    s_branch L_tb30_3
L_th33_3:
    s_waitcnt vmcnt(20)
    s_cmp_eq_u32 vcc_lo, 1
    s_cbranch_scc1 L_tb33_3
    s_waitcnt vmcnt(17)
    s_branch L_tb33_3
L_th36_3:
    s_waitcnt vmcnt(20)
    s_cmp_eq_u32 vcc_lo, 1
    s_cbranch_scc1 L_tb36_3
    s_waitcnt vmcnt(17)
    s_branch L_tb36_3
L_th39_3:
    s_waitcnt vmcnt(20)
    s_cmp_eq_u32 vcc_lo, 1
    s_cbranch_scc1 L_tb39_3
    s_waitcnt vmcnt(17)
    s_branch L_tb39_3
L_th42_3:
    s_waitcnt vmcnt(20)
    s_cmp_eq_u32 vcc_lo, 1
    s_cbranch_scc1 L_tb42_3
    s_waitcnt vmcnt(17)
    s_branch L_tb42_3
L_th45_3:
    s_waitcnt vmcnt(20)
    s_cmp_eq_u32 vcc_lo, 1
    s_cbranch_scc1 L_tb45_3
    s_waitcnt vmcnt(17)
    s_branch L_tb45_3
L_th0_3:
    s_waitcnt vmcnt(23)
    s_cmp_eq_u32 vcc_lo, 1
    s_cbranch_scc1 L_tb0_3
    s_waitcnt vmcnt(20)
    s_branch L_tb0_3
L_th3_3:
    s_waitcnt vmcnt(23)
    s_cmp_eq_u32 vcc_lo, 1
    s_cbranch_scc1 L_tb3_3
    s_waitcnt vmcnt(20)
    s_branch L_tb3_3
L_th6_3:
    s_waitcnt vmcnt(23)
    s_cmp_eq_u32 vcc_lo, 1
    s_cbranch_scc1 L_tb6_3
    s_waitcnt vmcnt(20)
    s_branch L_tb6_3
L_th9_3:
    s_waitcnt vmcnt(23)
    s_cmp_eq_u32 vcc_lo, 1
    s_cbranch_scc1 L_tb9_3
    s_waitcnt vmcnt(20)
    s_branch L_tb9_3
L_th12_3:
    s_waitcnt vmcnt(23)
    s_cmp_eq_u32 vcc_lo, 1
    s_cbranch_scc1 L_tb12_3
    s_waitcnt vmcnt(20)
    s_branch L_tb12_3
L_th15_3:
    s_waitcnt vmcnt(23)
    s_cmp_eq_u32 vcc_lo, 1
    s_cbranch_scc1 L_tb15_3
    s_waitcnt vmcnt(20)
    s_branch L_tb15_3
L_th18_3:
    s_waitcnt vmcnt(23)
    s_cmp_eq_u32 vcc_lo, 1
    s_cbranch_scc1 L_tb18_3
    s_waitcnt vmcnt(17)
    s_branch L_tb18_3
L_th21_3:
    s_waitcnt vmcnt(20)
    s_cmp_eq_u32 vcc_lo, 1
    s_cbranch_scc1 L_tb21_3
    s_waitcnt vmcnt(17)
    s_branch L_tb21_3
L_th24_4:
    s_waitcnt vmcnt(20)
    s_cmp_eq_u32 vcc_lo, 1
    s_cbranch_scc1 L_tb24_4
    s_waitcnt vmcnt(17)
    s_branch L_tb24_4
L_th27_4:
    s_waitcnt vmcnt(20)
    s_cmp_eq_u32 vcc_lo, 1
    s_cbranch_scc1 L_tb27_4
    s_waitcnt vmcnt(17)
    s_branch L_tb27_4
L_th30_4:
    s_waitcnt vmcnt(20)
    s_cmp_eq_u32 vcc_lo, 1
    s_cbranch_scc1 L_tb30_4
    s_waitcnt vmcnt(17)
    s_branch L_tb30_4
L_th33_4:
    s_waitcnt vmcnt(20)
    s_cmp_eq_u32 vcc_lo, 1
    s_cbranch_scc1 L_tb33_4
    s_waitcnt vmcnt(17)
    s_branch L_tb33_4
L_th36_4:
    s_waitcnt vmcnt(20)
    s_cmp_eq_u32 vcc_lo, 1
    s_cbranch_scc1 L_tb36_4
    s_waitcnt vmcnt(17)
    s_branch L_tb36_4
L_th39_4:
    s_waitcnt vmcnt(20)
    s_cmp_eq_u32 vcc_lo, 1
    s_cbranch_scc1 L_tb39_4
    s_waitcnt vmcnt(17)
    s_branch L_tb39_4
L_th42_4:
    s_waitcnt vmcnt(20)
    s_cmp_eq_u32 vcc_lo, 1
    s_cbranch_scc1 L_tb42_4
    s_waitcnt vmcnt(17)
    s_branch L_tb42_4
L_th45_4:
    s_waitcnt vmcnt(20)
    s_cmp_eq_u32 vcc_lo, 1
    s_cbranch_scc1 L_tb45_4
    s_waitcnt vmcnt(17)
    s_branch L_tb45_4
L_th0_4:
    s_waitcnt vmcnt(23)
    s_cmp_eq_u32 vcc_lo, 1
    s_cbranch_scc1 L_tb0_4
    s_waitcnt vmcnt(20)
    s_branch L_tb0_4
L_th3_4:
    s_waitcnt vmcnt(23)
    s_cmp_eq_u32 vcc_lo, 1
    s_cbranch_scc1 L_tb3_4
    s_waitcnt vmcnt(20)
    s_branch L_tb3_4
L_th6_4:
    s_waitcnt vmcnt(23)
    s_cmp_eq_u32 vcc_lo, 1
    s_cbranch_scc1 L_tb6_4
    s_waitcnt vmcnt(20)
    s_branch L_tb6_4
L_th9_4:
    s_waitcnt vmcnt(23)
    s_cmp_eq_u32 vcc_lo, 1
    s_cbranch_scc1 L_tb9_4
    s_waitcnt vmcnt(20)
    s_branch L_tb9_4
L_th12_4:
    s_waitcnt vmcnt(23)
    s_cmp_eq_u32 vcc_lo, 1
    s_cbranch_scc1 L_tb12_4
    s_waitcnt vmcnt(20)
    s_branch L_tb12_4
L_th15_4:
    s_waitcnt vmcnt(23)
    s_cmp_eq_u32 vcc_lo, 1
    s_cbranch_scc1 L_tb15_4
    s_waitcnt vmcnt(20)
    s_branch L_tb15_4
L_th18_4:
    s_waitcnt vmcnt(23)
    s_cmp_eq_u32 vcc_lo, 1
    s_cbranch_scc1 L_tb18_4
    s_waitcnt vmcnt(17)
    s_branch L_tb18_4
L_th21_4:
    s_waitcnt vmcnt(20)
    s_cmp_eq_u32 vcc_lo, 1
    s_cbranch_scc1 L_tb21_4
    s_waitcnt vmcnt(17)
    s_branch L_tb21_4
L_service:
    v_lshlrev_b32 v5, 2, v0
    v_mov_b32 v3, 0
    ds_write_b32 v5, v3 offset:0
    v_lshlrev_b32 v1, 4, v0
    v_lshlrev_b32 v28, 11, v0
    v_mov_b32 v9, 0xf149f2ca
    v_cndmask_b32 v9, v9, v3, s[66:67]
    v_and_b32 v5, 15, v0
    v_lshrrev_b32 v6, 4, v0
    v_lshl_add_u32 v11, v5, 2, v6
    v_lshlrev_b32 v11, 1, v11
    s_getreg_b32 s72, hwreg(HW_REG_XCC_ID)
    s_and_b32 s72, s72, 15
    s_waitcnt lgkmcnt(0)
    s_barrier
    s_branch L_w0
L_walked:
    s_mov_b32 s52, s22
    s_and_b32 s53, s23, 0xffff
    s_mov_b32 s54, 25165824
    s_mov_b32 s55, 0x00020000
    s_mov_b32 s56, s18
    s_and_b32 s57, s19, 0xffff
    s_mov_b32 s58, 12288
    s_mov_b32 s59, 0x00020000
    s_mov_b32 s96, s79
    s_lshl_b32 s82, s79, 4
    v_mov_b32 v10, 0
    s_mov_b32 s80, 0x1010100
    s_mov_b32 s81, 0x1030102
    s_lshr_b64 s[80:81], s[80:81], s82
    v_writelane_b32 v10, s80, 0
    s_mov_b32 s80, 0x1050104
    s_mov_b32 s81, 0x1070106
    s_lshr_b64 s[80:81], s[80:81], s82
    v_writelane_b32 v10, s80, 1
    s_mov_b32 s80, 0x1090108
    s_mov_b32 s81, 0x10b010a
    s_lshr_b64 s[80:81], s[80:81], s82
    v_writelane_b32 v10, s80, 2
    s_mov_b32 s80, 0x10d010c
    s_mov_b32 s81, 0x10f010e
    s_lshr_b64 s[80:81], s[80:81], s82
    v_writelane_b32 v10, s80, 3
    s_mov_b32 s80, 0x1110110
    s_mov_b32 s81, 0x1130112
    s_lshr_b64 s[80:81], s[80:81], s82
    v_writelane_b32 v10, s80, 4
    s_mov_b32 s80, 0x2740074
    s_mov_b32 s81, 0x4750454
    s_lshr_b64 s[80:81], s[80:81], s82
    v_writelane_b32 v10, s80, 5
    s_mov_b32 s80, 0x2b60095
    s_mov_b32 s81, 0x2b70235
    s_lshr_b64 s[80:81], s[80:81], s82
    v_writelane_b32 v10, s80, 6
    s_mov_b32 s80, 0x1190036
    s_mov_b32 s81, 0x11b0456
    s_lshr_b64 s[80:81], s[80:81], s82
    v_writelane_b32 v10, s80, 7
    s_mov_b32 s80, 0x118
    s_mov_b32 s81, 0x77
    s_lshr_b64 s[80:81], s[80:81], s82
    v_writelane_b32 v10, s80, 8
    s_mov_b32 s80, 0x0
    s_mov_b32 s81, 0x11a
    s_lshr_b64 s[80:81], s[80:81], s82
    v_writelane_b32 v10, s80, 9
    v_and_b32 v10, 0xffff, v10
L_tag:
    s_branch L_x4
L_w4:
    s_branch L_w5
L_x4:
    ds_read_b32 v5, v3 offset:140
    ds_read_b64 v[16:17], v3 offset:152
    s_waitcnt lgkmcnt(0)
    v_readfirstlane_b32 s69, v5
    s_cmp_eq_u32 s69, 0
    s_cbranch_scc1 L_tag
    v_readfirstlane_b32 s86, v16
    v_readfirstlane_b32 s87, v17
    s_bfm_b64 s[84:85], s92, 0
    s_bcnt1_i32_b64 s70, s[86:87]
    s_and_b64 s[84:85], s[84:85], s[86:87]
    s_bcnt1_i32_b64 s71, s[84:85]
    s_mov_b32 s73, s71
L_round:
    s_min_u32 s80, s71, 63
    v_readlane_b32 s97, v10, s80
    s_lshl_b32 s80, s71, 2
    v_mov_b32 v4, s80
    s_cmp_eq_u32 s97, 0
    s_cbranch_scc1 L_last
L_poll:
    ds_read_b32 v5, v4 offset:0
    s_waitcnt lgkmcnt(0)
    v_readfirstlane_b32 s80, v5
    s_cmp_eq_u32 s80, 0
    s_cbranch_scc1 L_poll
    s_add_u32 s95, s69, s71
    s_add_u32 s95, s95, 1
    s_and_b32 s80, s71, 1
    s_lshl_b32 s80, s80, 19
    s_add_u32 s80, s80, 2097152
    s_lshl_b32 s77, s2, 11
    s_add_u32 s77, s77, s80
    s_lshl_b32 s75, s96, 17
    s_add_u32 s75, s75, s80
L_all:
    v_mov_b32 v16, s95
    s_mov_b64 exec, s[86:87]
    buffer_load_dword v16, v28, s[52:55], s75 offen offset:1024 sc0 sc1
    s_mov_b64 exec, -1
    s_waitcnt vmcnt(0)
    v_cmp_ne_u32 vcc, s95, v16
    s_cmp_lg_u64 vcc, 0
    s_cbranch_scc1 L_all
    s_mov_b32 s74, 0
    s_mov_b64 s[84:85], s[86:87]
L_merge:
    v_mov_b32 v7, 0xf149f2ca
    v_mov_b32 v8, 0
    v_mov_b32 v12, 0
    v_mov_b32 v13, 0
    v_mov_b32 v14, 0
L_chunk:
    v_mov_b32 v48, 0
    v_mov_b32 v49, 0
    v_mov_b32 v50, 0
    v_mov_b32 v51, v9
    v_mov_b32 v52, 0
    v_mov_b32 v53, 0
    v_mov_b32 v54, 0
    v_mov_b32 v55, v9
    v_mov_b32 v56, 0
    v_mov_b32 v57, 0
    v_mov_b32 v58, 0
    v_mov_b32 v59, v9
    v_mov_b32 v60, 0
    v_mov_b32 v61, 0
    v_mov_b32 v62, 0
    v_mov_b32 v63, v9
    v_mov_b32 v64, 0
    v_mov_b32 v65, 0
    v_mov_b32 v66, 0
    v_mov_b32 v67, v9
    v_mov_b32 v68, 0
    v_mov_b32 v69, 0
    v_mov_b32 v70, 0
    v_mov_b32 v71, v9
    v_mov_b32 v72, 0
    v_mov_b32 v73, 0
    v_mov_b32 v74, 0
    v_mov_b32 v75, v9
    v_mov_b32 v76, 0
    v_mov_b32 v77, 0
    v_mov_b32 v78, 0
    v_mov_b32 v79, v9
    v_mov_b32 v80, 0
    v_mov_b32 v81, 0
    v_mov_b32 v82, 0
    v_mov_b32 v83, v9
    v_mov_b32 v84, 0
    v_mov_b32 v85, 0
    v_mov_b32 v86, 0
    v_mov_b32 v87, v9
    v_mov_b32 v88, 0
    v_mov_b32 v89, 0
    v_mov_b32 v90, 0
    v_mov_b32 v91, v9
    v_mov_b32 v92, 0
    v_mov_b32 v93, 0
    v_mov_b32 v94, 0
    v_mov_b32 v95, v9
    v_mov_b32 v96, 0
    v_mov_b32 v97, 0
    v_mov_b32 v98, 0
    v_mov_b32 v99, v9
    v_mov_b32 v100, 0
    v_mov_b32 v101, 0
    v_mov_b32 v102, 0
    v_mov_b32 v103, v9
    v_mov_b32 v104, 0
    v_mov_b32 v105, 0
    v_mov_b32 v106, 0
    v_mov_b32 v107, v9
    v_mov_b32 v108, 0
    v_mov_b32 v109, 0
    v_mov_b32 v110, 0
    v_mov_b32 v111, v9
    v_mov_b32 v112, 0
    v_mov_b32 v113, 0
    v_mov_b32 v114, 0
    v_mov_b32 v115, v9
    v_mov_b32 v116, 0
    v_mov_b32 v117, 0
    v_mov_b32 v118, 0
    v_mov_b32 v119, v9
    v_mov_b32 v120, 0
    v_mov_b32 v121, 0
    v_mov_b32 v122, 0
    v_mov_b32 v123, v9
    v_mov_b32 v124, 0
    v_mov_b32 v125, 0
    v_mov_b32 v126, 0
    v_mov_b32 v127, v9
    v_mov_b32 v128, 0
    v_mov_b32 v129, 0
    v_mov_b32 v130, 0
    v_mov_b32 v131, v9
    v_mov_b32 v132, 0
    v_mov_b32 v133, 0
    v_mov_b32 v134, 0
    v_mov_b32 v135, v9
    v_mov_b32 v136, 0
    v_mov_b32 v137, 0
    v_mov_b32 v138, 0
    v_mov_b32 v139, v9
    v_mov_b32 v140, 0
    v_mov_b32 v141, 0
    v_mov_b32 v142, 0
    v_mov_b32 v143, v9
    v_mov_b32 v144, 0
    v_mov_b32 v145, 0
    v_mov_b32 v146, 0
    v_mov_b32 v147, v9
    v_mov_b32 v148, 0
    v_mov_b32 v149, 0
    v_mov_b32 v150, 0
    v_mov_b32 v151, v9
    v_mov_b32 v152, 0
    v_mov_b32 v153, 0
    v_mov_b32 v154, 0
    v_mov_b32 v155, v9
    v_mov_b32 v156, 0
    v_mov_b32 v157, 0
    v_mov_b32 v158, 0
    v_mov_b32 v159, v9
    v_mov_b32 v160, 0
    v_mov_b32 v161, 0
    v_mov_b32 v162, 0
    v_mov_b32 v163, v9
    v_mov_b32 v164, 0
    v_mov_b32 v165, 0
    v_mov_b32 v166, 0
    v_mov_b32 v167, v9
    v_mov_b32 v168, 0
    v_mov_b32 v169, 0
    v_mov_b32 v170, 0
    v_mov_b32 v171, v9
    v_mov_b32 v172, 0
    v_mov_b32 v173, 0
    v_mov_b32 v174, 0
    v_mov_b32 v175, v9
    s_ff1_i32_b64 s80, s[84:85]
    s_bitset0_b64 s[84:85], s80
    s_lshl_b32 s81, s80, 11
    s_add_u32 s81, s81, s75
    s_cmp_ge_i32 s80, 0
    s_cselect_b64 exec, -1, 0
    buffer_load_dwordx4 v[48:51], v1, s[52:55], s81 offen sc0 sc1
    s_ff1_i32_b64 s80, s[84:85]
    s_bitset0_b64 s[84:85], s80
    s_lshl_b32 s81, s80, 11
    s_add_u32 s81, s81, s75
    s_cmp_ge_i32 s80, 0
    s_cselect_b64 exec, -1, 0
    buffer_load_dwordx4 v[52:55], v1, s[52:55], s81 offen sc0 sc1
    s_ff1_i32_b64 s80, s[84:85]
    s_bitset0_b64 s[84:85], s80
    s_lshl_b32 s81, s80, 11
    s_add_u32 s81, s81, s75
    s_cmp_ge_i32 s80, 0
    s_cselect_b64 exec, -1, 0
    buffer_load_dwordx4 v[56:59], v1, s[52:55], s81 offen sc0 sc1
    s_ff1_i32_b64 s80, s[84:85]
    s_bitset0_b64 s[84:85], s80
    s_lshl_b32 s81, s80, 11
    s_add_u32 s81, s81, s75
    s_cmp_ge_i32 s80, 0
    s_cselect_b64 exec, -1, 0
    buffer_load_dwordx4 v[60:63], v1, s[52:55], s81 offen sc0 sc1
    s_ff1_i32_b64 s80, s[84:85]
    s_bitset0_b64 s[84:85], s80
    s_lshl_b32 s81, s80, 11
    s_add_u32 s81, s81, s75
    s_cmp_ge_i32 s80, 0
    s_cselect_b64 exec, -1, 0
    buffer_load_dwordx4 v[64:67], v1, s[52:55], s81 offen sc0 sc1
    s_ff1_i32_b64 s80, s[84:85]
    s_bitset0_b64 s[84:85], s80
    s_lshl_b32 s81, s80, 11
    s_add_u32 s81, s81, s75
    s_cmp_ge_i32 s80, 0
    s_cselect_b64 exec, -1, 0
    buffer_load_dwordx4 v[68:71], v1, s[52:55], s81 offen sc0 sc1
    s_ff1_i32_b64 s80, s[84:85]
    s_bitset0_b64 s[84:85], s80
    s_lshl_b32 s81, s80, 11
    s_add_u32 s81, s81, s75
    s_cmp_ge_i32 s80, 0
    s_cselect_b64 exec, -1, 0
    buffer_load_dwordx4 v[72:75], v1, s[52:55], s81 offen sc0 sc1
    s_ff1_i32_b64 s80, s[84:85]
    s_bitset0_b64 s[84:85], s80
    s_lshl_b32 s81, s80, 11
    s_add_u32 s81, s81, s75
    s_cmp_ge_i32 s80, 0
    s_cselect_b64 exec, -1, 0
    buffer_load_dwordx4 v[76:79], v1, s[52:55], s81 offen sc0 sc1
    s_ff1_i32_b64 s80, s[84:85]
    s_bitset0_b64 s[84:85], s80
    s_lshl_b32 s81, s80, 11
    s_add_u32 s81, s81, s75
    s_cmp_ge_i32 s80, 0
    s_cbranch_scc0 L_got
    s_cselect_b64 exec, -1, 0
    buffer_load_dwordx4 v[80:83], v1, s[52:55], s81 offen sc0 sc1
    s_ff1_i32_b64 s80, s[84:85]
    s_bitset0_b64 s[84:85], s80
    s_lshl_b32 s81, s80, 11
    s_add_u32 s81, s81, s75
    s_cmp_ge_i32 s80, 0
    s_cselect_b64 exec, -1, 0
    buffer_load_dwordx4 v[84:87], v1, s[52:55], s81 offen sc0 sc1
    s_ff1_i32_b64 s80, s[84:85]
    s_bitset0_b64 s[84:85], s80
    s_lshl_b32 s81, s80, 11
    s_add_u32 s81, s81, s75
    s_cmp_ge_i32 s80, 0
    s_cselect_b64 exec, -1, 0
    buffer_load_dwordx4 v[88:91], v1, s[52:55], s81 offen sc0 sc1
    s_ff1_i32_b64 s80, s[84:85]
    s_bitset0_b64 s[84:85], s80
    s_lshl_b32 s81, s80, 11
    s_add_u32 s81, s81, s75
    s_cmp_ge_i32 s80, 0
    s_cselect_b64 exec, -1, 0
    buffer_load_dwordx4 v[92:95], v1, s[52:55], s81 offen sc0 sc1
    s_ff1_i32_b64 s80, s[84:85]
    s_bitset0_b64 s[84:85], s80
    s_lshl_b32 s81, s80, 11
    s_add_u32 s81, s81, s75
    s_cmp_ge_i32 s80, 0
    s_cselect_b64 exec, -1, 0
    buffer_load_dwordx4 v[96:99], v1, s[52:55], s81 offen sc0 sc1
    s_ff1_i32_b64 s80, s[84:85]
    s_bitset0_b64 s[84:85], s80
    s_lshl_b32 s81, s80, 11
    s_add_u32 s81, s81, s75
    s_cmp_ge_i32 s80, 0
    s_cselect_b64 exec, -1, 0
    buffer_load_dwordx4 v[100:103], v1, s[52:55], s81 offen sc0 sc1
    s_ff1_i32_b64 s80, s[84:85]
    s_bitset0_b64 s[84:85], s80
    s_lshl_b32 s81, s80, 11
    s_add_u32 s81, s81, s75
    s_cmp_ge_i32 s80, 0
    s_cselect_b64 exec, -1, 0
    buffer_load_dwordx4 v[104:107], v1, s[52:55], s81 offen sc0 sc1
    s_ff1_i32_b64 s80, s[84:85]
    s_bitset0_b64 s[84:85], s80
    s_lshl_b32 s81, s80, 11
    s_add_u32 s81, s81, s75
    s_cmp_ge_i32 s80, 0
    s_cselect_b64 exec, -1, 0
    buffer_load_dwordx4 v[108:111], v1, s[52:55], s81 offen sc0 sc1
    s_ff1_i32_b64 s80, s[84:85]
    s_bitset0_b64 s[84:85], s80
    s_lshl_b32 s81, s80, 11
    s_add_u32 s81, s81, s75
    s_cmp_ge_i32 s80, 0
    s_cbranch_scc0 L_got
    s_cselect_b64 exec, -1, 0
    buffer_load_dwordx4 v[112:115], v1, s[52:55], s81 offen sc0 sc1
    s_ff1_i32_b64 s80, s[84:85]
    s_bitset0_b64 s[84:85], s80
    s_lshl_b32 s81, s80, 11
    s_add_u32 s81, s81, s75
    s_cmp_ge_i32 s80, 0
    s_cselect_b64 exec, -1, 0
    buffer_load_dwordx4 v[116:119], v1, s[52:55], s81 offen sc0 sc1
    s_ff1_i32_b64 s80, s[84:85]
    s_bitset0_b64 s[84:85], s80
    s_lshl_b32 s81, s80, 11
    s_add_u32 s81, s81, s75
    s_cmp_ge_i32 s80, 0
    s_cselect_b64 exec, -1, 0
    buffer_load_dwordx4 v[120:123], v1, s[52:55], s81 offen sc0 sc1
    s_ff1_i32_b64 s80, s[84:85]
    s_bitset0_b64 s[84:85], s80
    s_lshl_b32 s81, s80, 11
    s_add_u32 s81, s81, s75
    s_cmp_ge_i32 s80, 0
    s_cselect_b64 exec, -1, 0
    buffer_load_dwordx4 v[124:127], v1, s[52:55], s81 offen sc0 sc1
    s_ff1_i32_b64 s80, s[84:85]
    s_bitset0_b64 s[84:85], s80
    s_lshl_b32 s81, s80, 11
    s_add_u32 s81, s81, s75
    s_cmp_ge_i32 s80, 0
    s_cselect_b64 exec, -1, 0
    buffer_load_dwordx4 v[128:131], v1, s[52:55], s81 offen sc0 sc1
    s_ff1_i32_b64 s80, s[84:85]
    s_bitset0_b64 s[84:85], s80
    s_lshl_b32 s81, s80, 11
    s_add_u32 s81, s81, s75
    s_cmp_ge_i32 s80, 0
    s_cselect_b64 exec, -1, 0
    buffer_load_dwordx4 v[132:135], v1, s[52:55], s81 offen sc0 sc1
    s_ff1_i32_b64 s80, s[84:85]
    s_bitset0_b64 s[84:85], s80
    s_lshl_b32 s81, s80, 11
    s_add_u32 s81, s81, s75
    s_cmp_ge_i32 s80, 0
    s_cselect_b64 exec, -1, 0
    buffer_load_dwordx4 v[136:139], v1, s[52:55], s81 offen sc0 sc1
    s_ff1_i32_b64 s80, s[84:85]
    s_bitset0_b64 s[84:85], s80
    s_lshl_b32 s81, s80, 11
    s_add_u32 s81, s81, s75
    s_cmp_ge_i32 s80, 0
    s_cselect_b64 exec, -1, 0
    buffer_load_dwordx4 v[140:143], v1, s[52:55], s81 offen sc0 sc1
    s_ff1_i32_b64 s80, s[84:85]
    s_bitset0_b64 s[84:85], s80
    s_lshl_b32 s81, s80, 11
    s_add_u32 s81, s81, s75
    s_cmp_ge_i32 s80, 0
    s_cbranch_scc0 L_got
    s_cselect_b64 exec, -1, 0
    buffer_load_dwordx4 v[144:147], v1, s[52:55], s81 offen sc0 sc1
    s_ff1_i32_b64 s80, s[84:85]
    s_bitset0_b64 s[84:85], s80
    s_lshl_b32 s81, s80, 11
    s_add_u32 s81, s81, s75
    s_cmp_ge_i32 s80, 0
    s_cselect_b64 exec, -1, 0
    buffer_load_dwordx4 v[148:151], v1, s[52:55], s81 offen sc0 sc1
    s_ff1_i32_b64 s80, s[84:85]
    s_bitset0_b64 s[84:85], s80
    s_lshl_b32 s81, s80, 11
    s_add_u32 s81, s81, s75
    s_cmp_ge_i32 s80, 0
    s_cselect_b64 exec, -1, 0
    buffer_load_dwordx4 v[152:155], v1, s[52:55], s81 offen sc0 sc1
    s_ff1_i32_b64 s80, s[84:85]
    s_bitset0_b64 s[84:85], s80
    s_lshl_b32 s81, s80, 11
    s_add_u32 s81, s81, s75
    s_cmp_ge_i32 s80, 0
    s_cselect_b64 exec, -1, 0
    buffer_load_dwordx4 v[156:159], v1, s[52:55], s81 offen sc0 sc1
    s_ff1_i32_b64 s80, s[84:85]
    s_bitset0_b64 s[84:85], s80
    s_lshl_b32 s81, s80, 11
    s_add_u32 s81, s81, s75
    s_cmp_ge_i32 s80, 0
    s_cselect_b64 exec, -1, 0
    buffer_load_dwordx4 v[160:163], v1, s[52:55], s81 offen sc0 sc1
    s_ff1_i32_b64 s80, s[84:85]
    s_bitset0_b64 s[84:85], s80
    s_lshl_b32 s81, s80, 11
    s_add_u32 s81, s81, s75
    s_cmp_ge_i32 s80, 0
    s_cselect_b64 exec, -1, 0
    buffer_load_dwordx4 v[164:167], v1, s[52:55], s81 offen sc0 sc1
    s_ff1_i32_b64 s80, s[84:85]
    s_bitset0_b64 s[84:85], s80
    s_lshl_b32 s81, s80, 11
    s_add_u32 s81, s81, s75
    s_cmp_ge_i32 s80, 0
    s_cselect_b64 exec, -1, 0
    buffer_load_dwordx4 v[168:171], v1, s[52:55], s81 offen sc0 sc1
    s_ff1_i32_b64 s80, s[84:85]
    s_bitset0_b64 s[84:85], s80
    s_lshl_b32 s81, s80, 11
    s_add_u32 s81, s81, s75
    s_cmp_ge_i32 s80, 0
    s_cselect_b64 exec, -1, 0
    buffer_load_dwordx4 v[172:175], v1, s[52:55], s81 offen sc0 sc1
L_got:
    s_mov_b64 exec, -1
    s_waitcnt vmcnt(0)
    v_max_f32 v5, v51, v55
    v_max3_f32 v5, v5, v59, v63
    v_max3_f32 v5, v5, v67, v71
    v_max3_f32 v5, v5, v75, v79
    v_max3_f32 v5, v5, v83, v87
    v_max3_f32 v5, v5, v91, v95
    v_max3_f32 v5, v5, v99, v103
    v_max3_f32 v5, v5, v107, v111
    v_max3_f32 v5, v5, v115, v119
    v_max3_f32 v5, v5, v123, v127
    v_max3_f32 v5, v5, v131, v135
    v_max3_f32 v5, v5, v139, v143
    v_max3_f32 v5, v5, v147, v151
    v_max3_f32 v5, v5, v155, v159
    v_max3_f32 v5, v5, v163, v167
    v_max3_f32 v5, v5, v171, v175
    s_nop 1
    v_max_f32_dpp v6, v5, v7 quad_perm:[0,0,2,2] row_mask:0xf bank_mask:0xf
    v_sub_f32 v5, v7, v6
    v_exp_f32 v5, v5
    v_mov_b32 v7, v6
    v_mul_f32 v8, v8, v5
    v_mul_f32 v12, v12, v5
    v_mul_f32 v13, v13, v5
    v_mul_f32 v14, v14, v5
    v_sub_f32_dpp v20, v51, v6 quad_perm:[0,0,2,2] row_mask:0xf bank_mask:0xf
    v_sub_f32_dpp v21, v55, v6 quad_perm:[0,0,2,2] row_mask:0xf bank_mask:0xf
    v_sub_f32_dpp v22, v59, v6 quad_perm:[0,0,2,2] row_mask:0xf bank_mask:0xf
    v_sub_f32_dpp v23, v63, v6 quad_perm:[0,0,2,2] row_mask:0xf bank_mask:0xf
    v_sub_f32_dpp v24, v67, v6 quad_perm:[0,0,2,2] row_mask:0xf bank_mask:0xf
    v_sub_f32_dpp v25, v71, v6 quad_perm:[0,0,2,2] row_mask:0xf bank_mask:0xf
    v_sub_f32_dpp v26, v75, v6 quad_perm:[0,0,2,2] row_mask:0xf bank_mask:0xf
    v_sub_f32_dpp v27, v79, v6 quad_perm:[0,0,2,2] row_mask:0xf bank_mask:0xf
    v_exp_f32 v20, v20
    v_exp_f32 v21, v21
    v_exp_f32 v22, v22
    v_exp_f32 v23, v23
    v_exp_f32 v24, v24
    v_exp_f32 v25, v25
    v_exp_f32 v26, v26
    v_exp_f32 v27, v27
    s_nop 0
    v_fmac_f32 v12, v20, v48
    v_fmac_f32 v13, v20, v49
    v_fmac_f32 v14, v20, v50
    v_fmac_f32 v8, v20, v51
    v_fmac_f32 v12, v21, v52
    v_fmac_f32 v13, v21, v53
    v_fmac_f32 v14, v21, v54
    v_fmac_f32 v8, v21, v55
    v_fmac_f32 v12, v22, v56
    v_fmac_f32 v13, v22, v57
    v_fmac_f32 v14, v22, v58
    v_fmac_f32 v8, v22, v59
    v_fmac_f32 v12, v23, v60
    v_fmac_f32 v13, v23, v61
    v_fmac_f32 v14, v23, v62
    v_fmac_f32 v8, v23, v63
    v_fmac_f32 v12, v24, v64
    v_fmac_f32 v13, v24, v65
    v_fmac_f32 v14, v24, v66
    v_fmac_f32 v8, v24, v67
    v_fmac_f32 v12, v25, v68
    v_fmac_f32 v13, v25, v69
    v_fmac_f32 v14, v25, v70
    v_fmac_f32 v8, v25, v71
    v_fmac_f32 v12, v26, v72
    v_fmac_f32 v13, v26, v73
    v_fmac_f32 v14, v26, v74
    v_fmac_f32 v8, v26, v75
    v_fmac_f32 v12, v27, v76
    v_fmac_f32 v13, v27, v77
    v_fmac_f32 v14, v27, v78
    v_fmac_f32 v8, v27, v79
    v_sub_f32_dpp v20, v83, v6 quad_perm:[0,0,2,2] row_mask:0xf bank_mask:0xf
    v_sub_f32_dpp v21, v87, v6 quad_perm:[0,0,2,2] row_mask:0xf bank_mask:0xf
    v_sub_f32_dpp v22, v91, v6 quad_perm:[0,0,2,2] row_mask:0xf bank_mask:0xf
    v_sub_f32_dpp v23, v95, v6 quad_perm:[0,0,2,2] row_mask:0xf bank_mask:0xf
    v_sub_f32_dpp v24, v99, v6 quad_perm:[0,0,2,2] row_mask:0xf bank_mask:0xf
    v_sub_f32_dpp v25, v103, v6 quad_perm:[0,0,2,2] row_mask:0xf bank_mask:0xf
    v_sub_f32_dpp v26, v107, v6 quad_perm:[0,0,2,2] row_mask:0xf bank_mask:0xf
    v_sub_f32_dpp v27, v111, v6 quad_perm:[0,0,2,2] row_mask:0xf bank_mask:0xf
    v_exp_f32 v20, v20
    v_exp_f32 v21, v21
    v_exp_f32 v22, v22
    v_exp_f32 v23, v23
    v_exp_f32 v24, v24
    v_exp_f32 v25, v25
    v_exp_f32 v26, v26
    v_exp_f32 v27, v27
    s_nop 0
    v_fmac_f32 v12, v20, v80
    v_fmac_f32 v13, v20, v81
    v_fmac_f32 v14, v20, v82
    v_fmac_f32 v8, v20, v83
    v_fmac_f32 v12, v21, v84
    v_fmac_f32 v13, v21, v85
    v_fmac_f32 v14, v21, v86
    v_fmac_f32 v8, v21, v87
    v_fmac_f32 v12, v22, v88
    v_fmac_f32 v13, v22, v89
    v_fmac_f32 v14, v22, v90
    v_fmac_f32 v8, v22, v91
    v_fmac_f32 v12, v23, v92
    v_fmac_f32 v13, v23, v93
    v_fmac_f32 v14, v23, v94
    v_fmac_f32 v8, v23, v95
    v_fmac_f32 v12, v24, v96
    v_fmac_f32 v13, v24, v97
    v_fmac_f32 v14, v24, v98
    v_fmac_f32 v8, v24, v99
    v_fmac_f32 v12, v25, v100
    v_fmac_f32 v13, v25, v101
    v_fmac_f32 v14, v25, v102
    v_fmac_f32 v8, v25, v103
    v_fmac_f32 v12, v26, v104
    v_fmac_f32 v13, v26, v105
    v_fmac_f32 v14, v26, v106
    v_fmac_f32 v8, v26, v107
    v_fmac_f32 v12, v27, v108
    v_fmac_f32 v13, v27, v109
    v_fmac_f32 v14, v27, v110
    v_fmac_f32 v8, v27, v111
    v_sub_f32_dpp v20, v115, v6 quad_perm:[0,0,2,2] row_mask:0xf bank_mask:0xf
    v_sub_f32_dpp v21, v119, v6 quad_perm:[0,0,2,2] row_mask:0xf bank_mask:0xf
    v_sub_f32_dpp v22, v123, v6 quad_perm:[0,0,2,2] row_mask:0xf bank_mask:0xf
    v_sub_f32_dpp v23, v127, v6 quad_perm:[0,0,2,2] row_mask:0xf bank_mask:0xf
    v_sub_f32_dpp v24, v131, v6 quad_perm:[0,0,2,2] row_mask:0xf bank_mask:0xf
    v_sub_f32_dpp v25, v135, v6 quad_perm:[0,0,2,2] row_mask:0xf bank_mask:0xf
    v_sub_f32_dpp v26, v139, v6 quad_perm:[0,0,2,2] row_mask:0xf bank_mask:0xf
    v_sub_f32_dpp v27, v143, v6 quad_perm:[0,0,2,2] row_mask:0xf bank_mask:0xf
    v_exp_f32 v20, v20
    v_exp_f32 v21, v21
    v_exp_f32 v22, v22
    v_exp_f32 v23, v23
    v_exp_f32 v24, v24
    v_exp_f32 v25, v25
    v_exp_f32 v26, v26
    v_exp_f32 v27, v27
    s_nop 0
    v_fmac_f32 v12, v20, v112
    v_fmac_f32 v13, v20, v113
    v_fmac_f32 v14, v20, v114
    v_fmac_f32 v8, v20, v115
    v_fmac_f32 v12, v21, v116
    v_fmac_f32 v13, v21, v117
    v_fmac_f32 v14, v21, v118
    v_fmac_f32 v8, v21, v119
    v_fmac_f32 v12, v22, v120
    v_fmac_f32 v13, v22, v121
    v_fmac_f32 v14, v22, v122
    v_fmac_f32 v8, v22, v123
    v_fmac_f32 v12, v23, v124
    v_fmac_f32 v13, v23, v125
    v_fmac_f32 v14, v23, v126
    v_fmac_f32 v8, v23, v127
    v_fmac_f32 v12, v24, v128
    v_fmac_f32 v13, v24, v129
    v_fmac_f32 v14, v24, v130
    v_fmac_f32 v8, v24, v131
    v_fmac_f32 v12, v25, v132
    v_fmac_f32 v13, v25, v133
    v_fmac_f32 v14, v25, v134
    v_fmac_f32 v8, v25, v135
    v_fmac_f32 v12, v26, v136
    v_fmac_f32 v13, v26, v137
    v_fmac_f32 v14, v26, v138
    v_fmac_f32 v8, v26, v139
    v_fmac_f32 v12, v27, v140
    v_fmac_f32 v13, v27, v141
    v_fmac_f32 v14, v27, v142
    v_fmac_f32 v8, v27, v143
    v_sub_f32_dpp v20, v147, v6 quad_perm:[0,0,2,2] row_mask:0xf bank_mask:0xf
    v_sub_f32_dpp v21, v151, v6 quad_perm:[0,0,2,2] row_mask:0xf bank_mask:0xf
    v_sub_f32_dpp v22, v155, v6 quad_perm:[0,0,2,2] row_mask:0xf bank_mask:0xf
    v_sub_f32_dpp v23, v159, v6 quad_perm:[0,0,2,2] row_mask:0xf bank_mask:0xf
    v_sub_f32_dpp v24, v163, v6 quad_perm:[0,0,2,2] row_mask:0xf bank_mask:0xf
    v_sub_f32_dpp v25, v167, v6 quad_perm:[0,0,2,2] row_mask:0xf bank_mask:0xf
    v_sub_f32_dpp v26, v171, v6 quad_perm:[0,0,2,2] row_mask:0xf bank_mask:0xf
    v_sub_f32_dpp v27, v175, v6 quad_perm:[0,0,2,2] row_mask:0xf bank_mask:0xf
    v_exp_f32 v20, v20
    v_exp_f32 v21, v21
    v_exp_f32 v22, v22
    v_exp_f32 v23, v23
    v_exp_f32 v24, v24
    v_exp_f32 v25, v25
    v_exp_f32 v26, v26
    v_exp_f32 v27, v27
    s_nop 0
    v_fmac_f32 v12, v20, v144
    v_fmac_f32 v13, v20, v145
    v_fmac_f32 v14, v20, v146
    v_fmac_f32 v8, v20, v147
    v_fmac_f32 v12, v21, v148
    v_fmac_f32 v13, v21, v149
    v_fmac_f32 v14, v21, v150
    v_fmac_f32 v8, v21, v151
    v_fmac_f32 v12, v22, v152
    v_fmac_f32 v13, v22, v153
    v_fmac_f32 v14, v22, v154
    v_fmac_f32 v8, v22, v155
    v_fmac_f32 v12, v23, v156
    v_fmac_f32 v13, v23, v157
    v_fmac_f32 v14, v23, v158
    v_fmac_f32 v8, v23, v159
    v_fmac_f32 v12, v24, v160
    v_fmac_f32 v13, v24, v161
    v_fmac_f32 v14, v24, v162
    v_fmac_f32 v8, v24, v163
    v_fmac_f32 v12, v25, v164
    v_fmac_f32 v13, v25, v165
    v_fmac_f32 v14, v25, v166
    v_fmac_f32 v8, v25, v167
    v_fmac_f32 v12, v26, v168
    v_fmac_f32 v13, v26, v169
    v_fmac_f32 v14, v26, v170
    v_fmac_f32 v8, v26, v171
    v_fmac_f32 v12, v27, v172
    v_fmac_f32 v13, v27, v173
    v_fmac_f32 v14, v27, v174
    v_fmac_f32 v8, v27, v175
    s_cmp_lg_u64 s[84:85], 0
    s_cbranch_scc1 L_chunk
    s_cmp_lg_u32 s74, 0
    s_cbranch_scc1 L_fin
    v_cndmask_b32 v15, v7, v8, s[66:67]
    v_mov_b32 v5, s95
    s_and_b32 s79, s97, 31
    s_lshr_b32 s80, s97, 9
    s_lshl_b32 s80, s80, 4
    s_add_u32 s80, s80, s72
    s_bfm_b64 s[88:89], 1, s80
    s_bfe_u32 s83, s97, 0x40005
    s_mul_i32 s83, s83, s70
    s_lshl_b32 s83, s83, 16
    s_or_b32 s89, s89, s83
    v_mov_b32 v16, s88
    v_mov_b32 v17, s89
    s_lshl_b32 s75, s79, 17
    s_add_u32 s75, s75, 4194304
    s_lshl_b32 s80, s80, 11
    s_add_u32 s80, s80, s75
    buffer_store_dwordx4 v[12:15], v1, s[52:55], s80 offen sc0 sc1
    s_mov_b64 exec, 1
    buffer_store_dword v5, v3, s[52:55], s77 offen offset:1028
    s_lshl_b32 s80, s79, 8
    s_add_u32 s80, s80, 23076864
    s_waitcnt vmcnt(0)
    buffer_atomic_add_x2 v[16:17], v3, s[52:55], s80 offen sc0 sc1
    s_waitcnt vmcnt(0)
    s_mov_b64 exec, -1
    v_readfirstlane_b32 s84, v16
    v_readfirstlane_b32 s85, v17
    s_add_u32 s84, s84, s88
    s_add_u32 s85, s85, s89
    s_lshr_b32 s80, s85, 16
    s_cmp_lg_u32 s80, 512
    s_cbranch_scc1 L_next
    s_mov_b32 s74, 1
    s_and_b32 s85, s85, 0xffff
    s_branch L_merge
L_fin:
    s_nop 1
    v_mov_b32_dpp v5, v8 quad_perm:[1,1,3,3] row_mask:0xf bank_mask:0xf
    v_rcp_f32 v5, v5
    s_mul_i32 s80, s79, 384
    v_mul_f32 v12, v12, v5
    v_mul_f32 v13, v13, v5
    v_mul_f32 v14, v14, v5
    v_cvt_pk_bf16_f32 v12, v12, v12
    v_cvt_pk_bf16_f32 v13, v13, v13
    v_cvt_pk_bf16_f32 v14, v14, v14
    buffer_store_short v12, v11, s[56:59], s80 offen offset:0
    buffer_store_short v13, v11, s[56:59], s80 offen offset:128
    buffer_store_short v14, v11, s[56:59], s80 offen offset:256
L_next:
    s_add_u32 s71, s71, s70
    s_branch L_round
L_last:
    s_and_b32 s92, s3, 63
    s_lshr_b32 s78, s92, 4
    s_lshr_b32 s81, s3, 6
    s_add_u32 s79, s81, 28
    s_mul_i32 s80, s78, 5
    s_mul_i32 s82, s81, 3
    s_add_u32 s80, s80, s82
    s_add_u32 s80, s80, 1
    s_xor_b32 s80, s80, s92
    s_and_b32 s80, s80, 15
    s_cbranch_scc1 L_end
    s_lshl_b32 s75, s81, 17
    v_and_b32 v5, 15, v0
    v_lshrrev_b32 v6, 4, v0
    v_lshlrev_b32 v28, 11, v6
    v_lshl_add_u32 v44, v5, 13, v28
    v_lshl_add_u32 v28, v5, 4, v28
    s_lshl_b32 s80, s78, 8
    v_add_u32 v28, s80, v28
    v_add_u32 v29, 8192, v28
    v_add_u32 v30, 16384, v28
    v_add_u32 v31, 24576, v28
    v_add_u32 v32, 32768, v28
    v_add_u32 v33, 40960, v28
    v_add_u32 v34, 49152, v28
    v_add_u32 v35, 57344, v28
    v_add_u32 v36, 65536, v28
    v_add_u32 v37, 73728, v28
    v_add_u32 v38, 81920, v28
    v_add_u32 v39, 90112, v28
    v_add_u32 v40, 98304, v28
    v_add_u32 v41, 106496, v28
    v_add_u32 v42, 114688, v28
    v_add_u32 v43, 122880, v28
    v_mov_b32 v51, 0
    v_mov_b32 v55, 0
    v_mov_b32 v59, 0
    v_mov_b32 v63, 0
    v_mov_b32 v67, 0
    v_mov_b32 v71, 0
    v_mov_b32 v75, 0
    v_mov_b32 v79, 0
    v_mov_b32 v83, 0
    v_mov_b32 v87, 0
    v_mov_b32 v91, 0
    v_mov_b32 v95, 0
    v_mov_b32 v99, 0
    v_mov_b32 v103, 0
    v_mov_b32 v107, 0
    v_mov_b32 v111, 0
    v_mov_b32 v19, 0
    v_lshlrev_b32 v11, 3, v5
    s_lshl_b32 s80, s78, 1
    s_mul_i32 s78, s79, 384
    s_add_u32 s78, s78, s80
L_dt:
    ds_read_b32 v5, v3 offset:144
    s_waitcnt lgkmcnt(0)
    v_readfirstlane_b32 s80, v5
    s_cmp_eq_u32 s80, 0
    s_cbranch_scc1 L_dt
L_pp:
    v_cmp_ne_u32 s[24:25], s69, v51
    v_cmp_ne_u32 s[26:27], s69, v55
    v_cmp_ne_u32 s[28:29], s69, v59
    v_cmp_ne_u32 s[30:31], s69, v63
    v_cmp_ne_u32 s[32:33], s69, v67
    v_cmp_ne_u32 s[34:35], s69, v71
    v_cmp_ne_u32 s[36:37], s69, v75
    v_cmp_ne_u32 s[38:39], s69, v79
    v_cmp_ne_u32 s[40:41], s69, v83
    v_cmp_ne_u32 s[42:43], s69, v87
    v_cmp_ne_u32 s[44:45], s69, v91
    v_cmp_ne_u32 s[46:47], s69, v95
    v_cmp_ne_u32 s[48:49], s69, v99
    v_cmp_ne_u32 s[50:51], s69, v103
    v_cmp_ne_u32 s[4:5], s69, v107
    v_cmp_ne_u32 s[6:7], s69, v111
    v_cmp_ne_u32 s[8:9], s69, v19
    s_or_b64 s[90:91], s[24:25], s[26:27]
    s_or_b64 s[90:91], s[90:91], s[28:29]
    s_or_b64 s[90:91], s[90:91], s[30:31]
    s_or_b64 s[90:91], s[90:91], s[32:33]
    s_or_b64 s[90:91], s[90:91], s[34:35]
    s_or_b64 s[90:91], s[90:91], s[36:37]
    s_or_b64 s[90:91], s[90:91], s[38:39]
    s_or_b64 s[90:91], s[90:91], s[40:41]
    s_or_b64 s[90:91], s[90:91], s[42:43]
    s_or_b64 s[90:91], s[90:91], s[44:45]
    s_or_b64 s[90:91], s[90:91], s[46:47]
    s_or_b64 s[90:91], s[90:91], s[48:49]
    s_or_b64 s[90:91], s[90:91], s[50:51]
    s_or_b64 s[90:91], s[90:91], s[4:5]
    s_or_b64 s[90:91], s[90:91], s[6:7]
    s_or_b64 s[90:91], s[90:91], s[8:9]
    s_cbranch_scc0 L_pd
    s_mov_b64 exec, s[8:9]
    buffer_load_dwordx4 v[16:19], v44, s[52:55], s75 offen offset:1024 sc0 sc1
    s_mov_b64 exec, s[24:25]
    buffer_load_dwordx4 v[48:51], v28, s[52:55], s75 offen offset:0 sc0 sc1
    s_mov_b64 exec, s[26:27]
    buffer_load_dwordx4 v[52:55], v29, s[52:55], s75 offen offset:0 sc0 sc1
    s_mov_b64 exec, s[28:29]
    buffer_load_dwordx4 v[56:59], v30, s[52:55], s75 offen offset:0 sc0 sc1
    s_mov_b64 exec, s[30:31]
    buffer_load_dwordx4 v[60:63], v31, s[52:55], s75 offen offset:0 sc0 sc1
    s_mov_b64 exec, s[32:33]
    buffer_load_dwordx4 v[64:67], v32, s[52:55], s75 offen offset:0 sc0 sc1
    s_mov_b64 exec, s[34:35]
    buffer_load_dwordx4 v[68:71], v33, s[52:55], s75 offen offset:0 sc0 sc1
    s_mov_b64 exec, s[36:37]
    buffer_load_dwordx4 v[72:75], v34, s[52:55], s75 offen offset:0 sc0 sc1
    s_mov_b64 exec, s[38:39]
    buffer_load_dwordx4 v[76:79], v35, s[52:55], s75 offen offset:0 sc0 sc1
    s_mov_b64 exec, s[40:41]
    buffer_load_dwordx4 v[80:83], v36, s[52:55], s75 offen offset:0 sc0 sc1
    s_mov_b64 exec, s[42:43]
    buffer_load_dwordx4 v[84:87], v37, s[52:55], s75 offen offset:0 sc0 sc1
    s_mov_b64 exec, s[44:45]
    buffer_load_dwordx4 v[88:91], v38, s[52:55], s75 offen offset:0 sc0 sc1
    s_mov_b64 exec, s[46:47]
    buffer_load_dwordx4 v[92:95], v39, s[52:55], s75 offen offset:0 sc0 sc1
    s_mov_b64 exec, s[48:49]
    buffer_load_dwordx4 v[96:99], v40, s[52:55], s75 offen offset:0 sc0 sc1
    s_mov_b64 exec, s[50:51]
    buffer_load_dwordx4 v[100:103], v41, s[52:55], s75 offen offset:0 sc0 sc1
    s_mov_b64 exec, s[4:5]
    buffer_load_dwordx4 v[104:107], v42, s[52:55], s75 offen offset:0 sc0 sc1
    s_mov_b64 exec, s[6:7]
    buffer_load_dwordx4 v[108:111], v43, s[52:55], s75 offen offset:0 sc0 sc1
    s_mov_b64 exec, -1
    s_waitcnt vmcnt(0)
    s_branch L_pp
L_pd:
    v_mov_b32 v7, v16
    s_nop 1
    v_max_f32_dpp v7, v7, v7 row_ror:8 row_mask:0xf bank_mask:0xf
    s_nop 1
    v_max_f32_dpp v7, v7, v7 row_ror:4 row_mask:0xf bank_mask:0xf
    s_nop 1
    v_max_f32_dpp v7, v7, v7 row_ror:2 row_mask:0xf bank_mask:0xf
    s_nop 1
    v_max_f32_dpp v7, v7, v7 row_ror:1 row_mask:0xf bank_mask:0xf
    v_mov_b32 v5, v7
    s_nop 1
    v_permlane32_swap_b32 v7, v5
    s_nop 1
    v_max_f32 v7, v7, v5
    v_mov_b32 v5, v7
    s_nop 1
    v_permlane16_swap_b32 v7, v5
    s_nop 1
    v_max_f32 v7, v7, v5
    v_sub_f32 v6, v16, v7
    v_exp_f32 v6, v6
    v_mov_b32 v12, 0
    v_mov_b32 v13, 0
    v_mov_b32 v14, 0
    v_mul_f32 v8, v6, v17
    v_fmac_f32_dpp v12, v6, v48 row_newbcast:0 row_mask:0xf bank_mask:0xf
    v_fmac_f32_dpp v13, v6, v49 row_newbcast:0 row_mask:0xf bank_mask:0xf
    v_fmac_f32_dpp v14, v6, v50 row_newbcast:0 row_mask:0xf bank_mask:0xf
    v_fmac_f32_dpp v12, v6, v52 row_newbcast:1 row_mask:0xf bank_mask:0xf
    v_fmac_f32_dpp v13, v6, v53 row_newbcast:1 row_mask:0xf bank_mask:0xf
    v_fmac_f32_dpp v14, v6, v54 row_newbcast:1 row_mask:0xf bank_mask:0xf
    v_fmac_f32_dpp v12, v6, v56 row_newbcast:2 row_mask:0xf bank_mask:0xf
    v_fmac_f32_dpp v13, v6, v57 row_newbcast:2 row_mask:0xf bank_mask:0xf
    v_fmac_f32_dpp v14, v6, v58 row_newbcast:2 row_mask:0xf bank_mask:0xf
    v_fmac_f32_dpp v12, v6, v60 row_newbcast:3 row_mask:0xf bank_mask:0xf
    v_fmac_f32_dpp v13, v6, v61 row_newbcast:3 row_mask:0xf bank_mask:0xf
    v_fmac_f32_dpp v14, v6, v62 row_newbcast:3 row_mask:0xf bank_mask:0xf
    s_branch L_x5
L_w5:
    s_branch L_walked
L_x5:
    v_fmac_f32_dpp v12, v6, v64 row_newbcast:4 row_mask:0xf bank_mask:0xf
    v_fmac_f32_dpp v13, v6, v65 row_newbcast:4 row_mask:0xf bank_mask:0xf
    v_fmac_f32_dpp v14, v6, v66 row_newbcast:4 row_mask:0xf bank_mask:0xf
    v_fmac_f32_dpp v12, v6, v68 row_newbcast:5 row_mask:0xf bank_mask:0xf
    v_fmac_f32_dpp v13, v6, v69 row_newbcast:5 row_mask:0xf bank_mask:0xf
    v_fmac_f32_dpp v14, v6, v70 row_newbcast:5 row_mask:0xf bank_mask:0xf
    v_fmac_f32_dpp v12, v6, v72 row_newbcast:6 row_mask:0xf bank_mask:0xf
    v_fmac_f32_dpp v13, v6, v73 row_newbcast:6 row_mask:0xf bank_mask:0xf
    v_fmac_f32_dpp v14, v6, v74 row_newbcast:6 row_mask:0xf bank_mask:0xf
    v_fmac_f32_dpp v12, v6, v76 row_newbcast:7 row_mask:0xf bank_mask:0xf
    v_fmac_f32_dpp v13, v6, v77 row_newbcast:7 row_mask:0xf bank_mask:0xf
    v_fmac_f32_dpp v14, v6, v78 row_newbcast:7 row_mask:0xf bank_mask:0xf
    v_fmac_f32_dpp v12, v6, v80 row_newbcast:8 row_mask:0xf bank_mask:0xf
    v_fmac_f32_dpp v13, v6, v81 row_newbcast:8 row_mask:0xf bank_mask:0xf
    v_fmac_f32_dpp v14, v6, v82 row_newbcast:8 row_mask:0xf bank_mask:0xf
    v_fmac_f32_dpp v12, v6, v84 row_newbcast:9 row_mask:0xf bank_mask:0xf
    v_fmac_f32_dpp v13, v6, v85 row_newbcast:9 row_mask:0xf bank_mask:0xf
    v_fmac_f32_dpp v14, v6, v86 row_newbcast:9 row_mask:0xf bank_mask:0xf
    v_fmac_f32_dpp v12, v6, v88 row_newbcast:10 row_mask:0xf bank_mask:0xf
    v_fmac_f32_dpp v13, v6, v89 row_newbcast:10 row_mask:0xf bank_mask:0xf
    v_fmac_f32_dpp v14, v6, v90 row_newbcast:10 row_mask:0xf bank_mask:0xf
    v_fmac_f32_dpp v12, v6, v92 row_newbcast:11 row_mask:0xf bank_mask:0xf
    v_fmac_f32_dpp v13, v6, v93 row_newbcast:11 row_mask:0xf bank_mask:0xf
    v_fmac_f32_dpp v14, v6, v94 row_newbcast:11 row_mask:0xf bank_mask:0xf
    v_fmac_f32_dpp v12, v6, v96 row_newbcast:12 row_mask:0xf bank_mask:0xf
    v_fmac_f32_dpp v13, v6, v97 row_newbcast:12 row_mask:0xf bank_mask:0xf
    v_fmac_f32_dpp v14, v6, v98 row_newbcast:12 row_mask:0xf bank_mask:0xf
    v_fmac_f32_dpp v12, v6, v100 row_newbcast:13 row_mask:0xf bank_mask:0xf
    v_fmac_f32_dpp v13, v6, v101 row_newbcast:13 row_mask:0xf bank_mask:0xf
    v_fmac_f32_dpp v14, v6, v102 row_newbcast:13 row_mask:0xf bank_mask:0xf
    v_fmac_f32_dpp v12, v6, v104 row_newbcast:14 row_mask:0xf bank_mask:0xf
    v_fmac_f32_dpp v13, v6, v105 row_newbcast:14 row_mask:0xf bank_mask:0xf
    v_fmac_f32_dpp v14, v6, v106 row_newbcast:14 row_mask:0xf bank_mask:0xf
    v_fmac_f32_dpp v12, v6, v108 row_newbcast:15 row_mask:0xf bank_mask:0xf
    v_fmac_f32_dpp v13, v6, v109 row_newbcast:15 row_mask:0xf bank_mask:0xf
    v_fmac_f32_dpp v14, v6, v110 row_newbcast:15 row_mask:0xf bank_mask:0xf
    s_nop 1
    v_add_f32_dpp v8, v8, v8 row_ror:8 row_mask:0xf bank_mask:0xf
    s_nop 1
    v_add_f32_dpp v8, v8, v8 row_ror:4 row_mask:0xf bank_mask:0xf
    s_nop 1
    v_add_f32_dpp v8, v8, v8 row_ror:2 row_mask:0xf bank_mask:0xf
    s_nop 1
    v_add_f32_dpp v8, v8, v8 row_ror:1 row_mask:0xf bank_mask:0xf
    v_mov_b32 v5, v8
    s_nop 1
    v_permlane32_swap_b32 v8, v5
    s_nop 1
    v_add_f32 v8, v8, v5
    v_mov_b32 v5, v8
    s_nop 1
    v_permlane16_swap_b32 v8, v5
    s_nop 1
    v_add_f32 v8, v8, v5
    v_rcp_f32 v8, v8
    v_mov_b32 v20, v12
    v_mov_b32 v21, v13
    v_mov_b32 v22, v14
    s_nop 1
    v_permlane32_swap_b32 v12, v20
    v_permlane32_swap_b32 v13, v21
    v_permlane32_swap_b32 v14, v22
    s_nop 1
    v_add_f32 v12, v12, v20
    v_add_f32 v13, v13, v21
    v_add_f32 v14, v14, v22
    v_mov_b32 v20, v12
    v_mov_b32 v21, v13
    v_mov_b32 v22, v14
    s_nop 1
    v_permlane16_swap_b32 v12, v20
    v_permlane16_swap_b32 v13, v21
    v_permlane16_swap_b32 v14, v22
    s_nop 1
    v_add_f32 v12, v12, v20
    v_add_f32 v13, v13, v21
    v_add_f32 v14, v14, v22
    v_mul_f32 v12, v12, v8
    v_mul_f32 v13, v13, v8
    v_mul_f32 v14, v14, v8
    v_cvt_pk_bf16_f32 v12, v12, v12
    v_cvt_pk_bf16_f32 v13, v13, v13
    v_cvt_pk_bf16_f32 v14, v14, v14
    s_mov_b64 exec, 0xffff
    buffer_store_short v12, v11, s[56:59], s78 offen offset:0
    buffer_store_short v13, v11, s[56:59], s78 offen offset:128
    buffer_store_short v14, v11, s[56:59], s78 offen offset:256
L_end:
    s_endpgm
L_ticket:
    v_lshlrev_b32 v1, 2, v0
    v_mov_b32 v2, 0
    v_lshlrev_b32 v4, 4, v0
    v_mov_b32 v8, -1
    v_mov_b32 v9, -1
    v_mov_b32 v10, -1
    v_mov_b32 v11, -1
    ds_write_b128 v4, v[8:11] offset:256
    ds_write_b128 v4, v[8:11] offset:1280
    ds_write_b128 v4, v[8:11] offset:2304
    s_memrealtime s[80:81]
    s_waitcnt lgkmcnt(0)
    s_barrier
    s_mov_b32 s52, s22
    s_and_b32 s53, s23, 0xffff
    s_mov_b32 s54, 25165824
    s_mov_b32 s55, 0x00020000
    s_mov_b32 s60, s20
    s_and_b32 s61, s21, 0xffff
    s_mov_b32 s62, 256
    s_mov_b32 s63, 0x00020000
    s_max_u32 s69, s80, 1
    s_cmp_lg_u32 s2, 0
    s_cbranch_scc1 L_kd
    v_lshlrev_b32 v5, 8, v0
    s_mov_b32 s80, 23068672
    v_mov_b32 v3, 0
    buffer_store_dwordx2 v[2:3], v5, s[52:55], s80 offen sc0 sc1
    v_mov_b32 v3, s69
    s_mov_b64 exec, 1
    s_waitcnt vmcnt(0)
    buffer_store_dword v3, v2, s[60:63], 0 offen sc0 sc1
    s_mov_b64 exec, -1
L_kd:
    ds_read_b32 v3, v2 offset:128
    s_waitcnt lgkmcnt(0)
    v_readfirstlane_b32 s80, v3
    s_cmp_eq_u32 s80, 0
    s_cbranch_scc1 L_kd
    ds_read_b128 v[8:11], v4 offset:19456
    s_lshl_b32 s80, s2, 11
    s_add_u32 s80, s80, 18874368
    s_waitcnt lgkmcnt(0)
    s_bfm_b64 exec, 48, 0
    buffer_store_dwordx4 v[8:11], v4, s[52:55], s80 offen offset:0 sc0 sc1
    s_mov_b64 exec, -1
L_tg:
    buffer_load_dword v3, v2, s[60:63], 0 offen sc0 sc1
    s_waitcnt vmcnt(0)
    v_readfirstlane_b32 s69, v3
    s_cmp_eq_u32 s69, 0
    s_cbranch_scc1 L_tg
    s_getreg_b32 s81, hwreg(HW_REG_XCC_ID)
    s_and_b32 s81, s81, 15
    v_mov_b32 v16, s81
    v_mov_b32 v17, s69
    s_lshl_b32 s80, s2, 11
    s_mov_b64 exec, 1
    s_lshl_b32 s82, s2, 3
    s_add_u32 s82, s82, 1572864
    buffer_store_dwordx2 v[16:17], v2, s[52:55], s82 offen sc0 sc1
    v_mov_b32 v12, s69
    v_mov_b32 v13, s69
    s_add_u32 s82, s80, 2097152
    buffer_store_dwordx2 v[12:13], v2, s[52:55], s82 offen offset:1024
    s_add_u32 s82, s80, 2621440
    buffer_store_dwordx2 v[12:13], v2, s[52:55], s82 offen offset:1024
    s_mov_b64 exec, -1
    s_mov_b32 s73, s81
    s_lshl_b32 s80, s79, 2
    s_lshr_b32 s74, 0x8a89, s80
    s_and_b32 s74, s74, 15
    s_mov_b32 s75, 0
    s_mov_b32 s95, s69
    s_lshl_b32 s77, s2, 11
    s_lshl_b32 s94, s79, 17
    s_mov_b32 s76, 2097152
    v_mov_b32 v19, 0
    v_lshlrev_b32 v20, 11, v0
    v_mov_b32 v21, v4
L_fl:
    ds_read_b32 v3, v19
    s_waitcnt lgkmcnt(0)
    v_readfirstlane_b32 s80, v3
    s_cmp_eq_u32 s80, 0
    s_cbranch_scc1 L_fl
    ds_read_b128 v[24:27], v21 offset:20480
    ds_read_b128 v[28:31], v21 offset:21504
    ds_read_b128 v[32:35], v21 offset:22528
    ds_read_b128 v[36:39], v21 offset:23552
    s_waitcnt lgkmcnt(0)
    s_nop 0
    v_add_f32_dpp v37, v37, v37 row_ror:8 row_mask:0xf bank_mask:0xf
    v_add_f32_dpp v38, v38, v38 row_ror:8 row_mask:0xf bank_mask:0xf
    s_nop 0
    v_add_f32_dpp v37, v37, v37 row_ror:4 row_mask:0xf bank_mask:0xf
    v_add_f32_dpp v38, v38, v38 row_ror:4 row_mask:0xf bank_mask:0xf
    s_nop 0
    v_add_f32_dpp v37, v37, v37 row_ror:2 row_mask:0xf bank_mask:0xf
    v_add_f32_dpp v38, v38, v38 row_ror:2 row_mask:0xf bank_mask:0xf
    s_nop 0
    v_add_f32_dpp v37, v37, v37 row_ror:1 row_mask:0xf bank_mask:0xf
    v_add_f32_dpp v38, v38, v38 row_ror:1 row_mask:0xf bank_mask:0xf
    v_mov_b32 v40, v36
    v_mov_b32 v41, v36
    s_nop 1
    v_permlane32_swap_b32 v40, v41
    s_nop 1
    v_max_f32 v40, v40, v41
    v_mov_b32 v41, v40
    s_nop 1
    v_permlane16_swap_b32 v40, v41
    s_nop 1
    v_max_f32 v40, v40, v41
    v_sub_f32 v41, v36, v40
    v_exp_f32 v41, v41
    v_mov_b32 v48, v40
    v_mul_f32 v37, v37, v41
    v_mul_f32 v38, v38, v41
    v_mul_f32 v41, 0x58000000, v41
    v_fma_f32 v24, v24, v41, -v38
    v_fma_f32 v25, v25, v41, -v38
    v_fma_f32 v26, v26, v41, -v38
    v_fma_f32 v27, v27, v41, -v38
    v_fma_f32 v28, v28, v41, -v38
    v_fma_f32 v29, v29, v41, -v38
    v_fma_f32 v30, v30, v41, -v38
    v_fma_f32 v31, v31, v41, -v38
    v_fma_f32 v32, v32, v41, -v38
    v_fma_f32 v33, v33, v41, -v38
    v_fma_f32 v34, v34, v41, -v38
    v_fma_f32 v35, v35, v41, -v38
    v_mov_b32 v40, v37
    s_nop 1
    v_permlane32_swap_b32 v37, v40
    v_permlane32_swap_b32 v24, v26
    v_permlane32_swap_b32 v25, v27
    v_permlane32_swap_b32 v28, v30
    v_permlane32_swap_b32 v29, v31
    v_permlane32_swap_b32 v32, v34
    v_permlane32_swap_b32 v33, v35
    s_nop 1
    v_add_f32 v37, v37, v40
    v_add_f32 v24, v24, v26
    v_add_f32 v25, v25, v27
    v_add_f32 v28, v28, v30
    v_add_f32 v29, v29, v31
    v_add_f32 v32, v32, v34
    v_add_f32 v33, v33, v35
    v_mov_b32 v40, v37
    s_nop 1
    v_permlane16_swap_b32 v37, v40
    v_permlane16_swap_b32 v24, v25
    v_permlane16_swap_b32 v28, v29
    v_permlane16_swap_b32 v32, v33
    s_nop 1
    v_add_f32 v49, v37, v40
    v_add_f32 v44, v24, v25
    v_add_f32 v45, v28, v29
    v_add_f32 v46, v32, v33
    v_mov_b32 v8, v44
    v_mov_b32 v9, v45
    v_mov_b32 v10, v46
    v_cndmask_b32 v11, v48, v49, s[66:67]
    s_cmp_eq_u32 s75, 1
    s_cbranch_scc1 L_dep
    s_cmp_lg_u32 s75, 0
    s_cbranch_scc1 L_guard
    s_lshr_b32 s82, s3, 6
    s_lshl_b32 s82, s82, 9
    s_add_u32 s82, s82, 1572864
    s_lshl_b32 s83, s79, 9
    s_add_u32 s83, s83, 1572864
    v_lshlrev_b32 v5, 3, v0
L_reg:
    buffer_load_dwordx2 v[12:13], v5, s[52:55], s83 offen sc0 sc1
    buffer_load_dwordx2 v[14:15], v5, s[52:55], s82 offen sc0 sc1
    s_waitcnt vmcnt(0)
    v_cmp_ne_u32 vcc, s69, v13
    s_cmp_lg_u64 vcc, 0
    s_cbranch_scc1 L_reg
    v_cmp_ne_u32 vcc, s69, v15
    s_cmp_lg_u64 vcc, 0
    s_cbranch_scc1 L_reg
    v_cmp_eq_u32 s[86:87], s73, v12
    s_nop 1
    v_mov_b32 v14, s86
    v_mov_b32 v15, s87
    ds_write_b64 v2, v[14:15] offset:152
    s_waitcnt lgkmcnt(0)
    ds_write_b32 v2, v13 offset:140
    s_branch L_dep
L_guard:
    s_sub_u32 s80, s95, 1
    s_add_u32 s81, s94, s76
L_guard2:
    v_mov_b32 v12, s69
    s_mov_b64 exec, s[86:87]
    buffer_load_dword v12, v20, s[52:55], s81 offen offset:1028 sc0 sc1
    s_mov_b64 exec, -1
    s_waitcnt vmcnt(0)
    v_cmp_eq_u32 vcc, s80, v12
    s_cmp_eq_u64 vcc, 0
    s_cbranch_scc1 L_guard2
L_dep:
    s_add_u32 s75, s75, 1
    s_add_u32 s95, s95, 1
    s_add_u32 s80, s77, s76
    v_mov_b32 v3, s95
    s_waitcnt lgkmcnt(0)
    buffer_store_dwordx4 v[8:11], v4, s[52:55], s80 offen
    s_mov_b64 exec, 1
    s_waitcnt vmcnt(0)
    buffer_store_dword v3, v2, s[52:55], s80 offen offset:1024
    s_mov_b64 exec, -1
    s_xor_b32 s76, s76, 0x80000
    v_add_u32 v21, 4096, v21
    v_add_u32 v19, 4, v19
    s_cmp_lt_u32 s75, s74
    s_cbranch_scc1 L_fl
    s_lshr_b32 s82, s3, 6
    s_lshl_b32 s82, s82, 8
    s_add_u32 s82, s82, 23068672
    s_mov_b64 exec, -1
    s_mov_b32 s70, 1
    s_mov_b32 s71, 0
    s_mov_b32 s72, 1
    v_add_u32 v5, 260, v1
    v_lshlrev_b32 v4, 6, v0
L_rq0:
    s_mov_b64 exec, 1
L_rq:
    ds_read_b32 v3, v2 offset:132
    s_waitcnt lgkmcnt(0)
    v_readfirstlane_b32 s80, v3
    s_cmp_lt_u32 s80, s70
    s_cbranch_scc1 L_rq
    v_mov_b32 v3, 1
    buffer_atomic_add v3, v2, s[52:55], s82 offen sc0 sc1
    s_waitcnt vmcnt(0)
    v_readfirstlane_b32 s71, v3
L_have:
    s_lshr_b32 s80, s71, 6
    s_min_u32 s80, s80, 3
    s_lshl_b32 s80, s80, 2
    s_lshr_b32 s81, 0x3210, s80
    s_lshr_b32 s80, 0x1111, s80
    s_and_b32 s81, s81, 15
    s_and_b32 s80, s80, 15
    s_lshl_b32 s81, s81, 6
    s_and_b32 s83, s71, 63
    s_add_u32 s81, s81, s83
    s_bfm_b64 exec, s80, 0
    v_add_u32 v3, s81, v4
    ds_write_b32 v5, v3
    s_mov_b64 exec, -1
    s_add_u32 s70, s70, s80
    s_lshl_b32 s80, s80, 2
    v_add_u32 v5, s80, v5
    s_cmp_lt_u32 s71, 160
    s_cbranch_scc1 L_rq0
    s_endpgm
L_ctl:
    v_lshlrev_b32 v1, 2, v0
    v_mov_b32 v2, 0
    ds_write_b32 v1, v2 offset:3328
    s_and_b32 s70, s2, 31
    s_lshl_b32 s70, s70, 2
    s_mov_b32 s71, 1
    v_mov_b32 v7, s2
    v_mov_b32 v9, 8
    v_and_b32 v10, 7, v0
    s_mov_b32 exec_lo, 0x0
    s_mov_b32 exec_hi, 0x1f000000
    v_mov_b32 v7, s3
    s_mov_b32 exec_lo, 0x0
    s_mov_b32 exec_hi, 0x700
    v_mov_b32 v9, 3
    s_mov_b32 exec_lo, 0x0
    s_mov_b32 exec_hi, 0xf800
    v_mov_b32 v9, 5
    s_mov_b32 exec_lo, 0x0
    s_mov_b32 exec_hi, 0xf800
    v_add_u32 v10, 9, v10
    s_mov_b64 exec, -1
    v_lshrrev_b32 v8, 6, v7
    v_mad_u32_u24 v10, v8, v9, v10
    v_lshrrev_b32 v9, 3, v0
    v_lshl_add_u32 v10, v9, 5, v10
    v_and_b32 v9, 3, v7
    v_lshl_add_u32 v8, v10, 2, v9
    v_bfe_u32 v9, v7, 2, 4
    v_lshl_add_u32 v8, v8, 4, v9
    v_mul_u32_u24 v9, 384, v8
    v_lshlrev_b32 v8, 7, v8
    s_waitcnt lgkmcnt(0)
    s_barrier
    s_mov_b32 s32, s10
    s_and_b32 s33, s11, 0xffff
    s_mov_b32 s34, 6291456
    s_mov_b32 s35, 0x00020000
    buffer_load_dword v10, v9, s[32:35], 0 offen offset:0
    buffer_load_dword v11, v9, s[32:35], 0 offen offset:128
    buffer_load_dword v12, v9, s[32:35], 0 offen offset:256
    s_mov_b32 s36, s12
    s_and_b32 s37, s13, 0xffff
    s_mov_b32 s38, 6291456
    s_mov_b32 s39, 0x00020000
    buffer_load_dword v13, v9, s[36:39], 0 offen offset:0
    buffer_load_dword v14, v9, s[36:39], 0 offen offset:128
    buffer_load_dword v15, v9, s[36:39], 0 offen offset:256
    s_mov_b32 s40, s14
    s_and_b32 s41, s15, 0xffff
    s_mov_b32 s42, 2097152
    s_mov_b32 s43, 0x00020000
    buffer_load_dword v16, v8, s[40:43], 0 offen offset:0
    s_mov_b32 s44, s16
    s_and_b32 s45, s17, 0xffff
    s_mov_b32 s46, 2097152
    s_mov_b32 s47, 0x00020000
    buffer_load_dword v17, v8, s[44:47], 0 offen offset:0
    s_mov_b32 s60, s20
    s_and_b32 s61, s21, 0xffff
    s_mov_b32 s62, 256
    s_mov_b32 s63, 0x00020000
    s_mov_b32 s52, s22
    s_and_b32 s53, s23, 0xffff
    s_mov_b32 s54, 25165824
    s_mov_b32 s55, 0x00020000
    s_getreg_b32 s76, hwreg(HW_REG_XCC_ID)
    s_and_b32 s76, s76, 15
    s_lshr_b32 s70, s70, 1
    s_and_b32 s75, s2, 31
    s_cmp_eq_u32 s75, 0
    s_cselect_b32 s75, 32, s75
    s_mul_i32 s77, s75, 64
    v_lshlrev_b32 v1, 1, v0
    v_lshlrev_b32 v7, 7, v0
L_c:
    ds_read_b32 v3, v2 offset:3328
    ds_read_b32 v4, v2 offset:144
    s_mov_b64 exec, 1
    s_waitcnt lgkmcnt(0)
    v_add_u32 v3, 1, v3
    buffer_store_short v3, v2, s[60:63], s70 offen offset:128
    s_bfm_b64 exec, 33, 0
    buffer_load_ushort v5, v1, s[60:63], 0 offen offset:128 sc1
    v_readfirstlane_b32 s72, v3
    v_readfirstlane_b32 s81, v4
    s_add_u32 s80, s71, s72
    s_mov_b32 s71, s72
    s_mov_b64 exec, 0xffffffff
    s_waitcnt vmcnt(0)
    v_cmp_ne_u32 vcc, 0, v5
    v_lshlrev_b32 v6, 1, v5
    v_readlane_b32 s86, v5, 32
    v_cmp_le_u32 s[82:83], s80, v6
    s_bcnt1_i32_b64 s73, vcc
    s_cmp_eq_u32 s86, 0
    s_cselect_b32 s86, 1024, s86
    s_bcnt1_i32_b64 s74, s[82:83]
    s_sub_i32 s86, s86, 1003
    s_mul_i32 s80, s73, s86
    s_lshl_b32 s74, s74, 5
    s_cmp_lt_i32 s74, s80
    s_cselect_b32 s86, 1, 0
    s_lshl_b32 s82, s73, 5
    s_add_u32 s74, s74, s82
    s_cmp_lt_i32 s74, s80
    s_cselect_b32 s86, 2, s86
    v_mov_b32 v6, s86
    ds_write_b32 v2, v6 offset:148
    s_cmp_lt_u32 s72, s77
    s_cbranch_scc1 L_cn
    s_memrealtime s[84:85]
    s_add_u32 s77, s77, 2048
    s_lshl_b32 s86, s75, 11
    s_add_u32 s75, s75, 32
    s_cmp_lg_u32 s73, 32
    s_cbranch_scc1 L_cn
    v_add_u32_dpp v5, v5, v5 row_ror:8 row_mask:0xf bank_mask:0xf
    s_nop 1
    v_add_u32_dpp v5, v5, v5 row_ror:4 row_mask:0xf bank_mask:0xf
    s_nop 1
    v_add_u32_dpp v5, v5, v5 row_ror:2 row_mask:0xf bank_mask:0xf
    s_nop 1
    v_add_u32_dpp v5, v5, v5 row_ror:1 row_mask:0xf bank_mask:0xf
    s_nop 1
    v_readlane_b32 s74, v5, 0
    v_readlane_b32 s73, v5, 16
    s_add_u32 s86, s86, 3143680
    s_lshl_b32 s80, s76, 7
    s_add_u32 s80, s80, s86
    s_add_u32 s74, s74, s73
    s_lshl_b32 s74, s74, 2
    s_waitcnt lgkmcnt(0)
    s_mul_i32 s73, s84, 13
    s_sub_u32 s74, s74, s73
    v_mov_b32 v8, s74
    v_mov_b32 v9, s84
    s_mov_b64 exec, 1
    buffer_store_dwordx2 v[8:9], v2, s[52:55], s80 offen offset:2048 sc0 sc1
    s_mov_b64 exec, 0xffff
    buffer_load_dwordx2 v[10:11], v7, s[52:55], s86 offen sc0 sc1
    s_waitcnt vmcnt(0)
    v_readlane_b32 s74, v10, s76
    v_sub_u32 v9, s84, v11
    v_cmp_gt_u32 vcc, 0x1000, v9
    v_sub_u32 v8, s74, v10
    s_nop 0
    v_cndmask_b32 v8, 0, v8, vcc
    s_bitcmp1_b32 vcc_lo, s76
    s_cbranch_scc0 L_cn
    v_add_u32_dpp v8, v8, v8 row_ror:8 row_mask:0xf bank_mask:0xf
    s_nop 1
    v_add_u32_dpp v8, v8, v8 row_ror:4 row_mask:0xf bank_mask:0xf
    s_nop 1
    v_add_u32_dpp v8, v8, v8 row_ror:2 row_mask:0xf bank_mask:0xf
    s_nop 1
    v_add_u32_dpp v8, v8, v8 row_ror:1 row_mask:0xf bank_mask:0xf
    s_nop 1
    s_sub_i32 s80, 64, s75
    s_mul_i32 s80, s80, 1000
    s_add_i32 s80, s80, -2000
    s_max_i32 s80, s80, 0
    v_subrev_u32 v9, s80, v8
    v_add_u32 v8, s80, v8
    v_max_i32 v9, 0, v9
    v_min_i32 v8, 0, v8
    v_add_u32 v8, v8, v9
    v_ashrrev_i32 v8, 9, v8
    v_max_i32 v8, -40, v8
    v_min_i32 v8, 40, v8
    v_add_u32 v8, 0x400, v8
    s_mov_b64 exec, 1
    buffer_store_short v8, v2, s[60:63], 0 offen offset:192
L_cn:
    s_cmp_eq_u32 s81, 0
    s_cbranch_scc1 L_c
    s_endpgm
.section .rodata,"a"
.p2align 6
.amdhsa_kernel standalone__kv_cache_quant_int4_int2_kv_with_per_channel_or_per_token_scales__decode_kernel
  .amdhsa_next_free_vgpr 246
  .amdhsa_next_free_sgpr 102
  .amdhsa_accum_offset 248
  .amdhsa_float_denorm_mode_32 3
  .amdhsa_group_segment_fixed_size 0
  .amdhsa_kernarg_size 80
  .amdhsa_user_sgpr_count 2
  .amdhsa_user_sgpr_kernarg_segment_ptr 1
  .amdhsa_system_sgpr_workgroup_id_x 1
.end_amdhsa_kernel
```

```asm
; @launch grid=(256,1,1) block=(256,1,1) lds=98304
.amdgcn_target "amdgcn-amd-amdhsa--gfx950"
.text
.globl standalone__kv_cache_quant_int4_int2_kv_with_per_channel_or_per_token_scales__decode_kernel
.p2align 12
.type standalone__kv_cache_quant_int4_int2_kv_with_per_channel_or_per_token_scales__decode_kernel,@function
standalone__kv_cache_quant_int4_int2_kv_with_per_channel_or_per_token_scales__decode_kernel:
    s_cmp_ge_u32 s2, 256
    s_cbranch_scc1 L_end
    s_load_dwordx16 s[4:19], s[0:1], 0
    s_load_dwordx4 s[20:23], s[0:1], 64
    s_and_b32 s80, s2, 7
    s_lshr_b32 s2, s2, 3
    s_lshl_b32 s80, s80, 5
    s_or_b32 s2, s2, s80
    s_mov_b32 s3, s2
    v_lshrrev_b32 v229, 6, v0
    v_and_b32 v0, 63, v0
    v_readfirstlane_b32 s68, v229
    s_lshr_b32 s79, s2, 5
    s_and_b32 s92, s2, 31
    s_mov_b32 s66, 0xaaaaaaaa
    s_mov_b32 s67, 0xaaaaaaaa
    s_cmp_eq_u32 s68, 1
    s_cbranch_scc1 L_service
    s_cmp_eq_u32 s68, 2
    s_cbranch_scc1 L_ticket
    s_cmp_eq_u32 s68, 3
    s_cbranch_scc1 L_ctl
    s_mov_b64 vcc, 0
    s_setprio 1
    v_and_b32 v235, 15, v0
    v_lshrrev_b32 v234, 4, v0
    v_mul_u32_u24 v1, 768, v234
    v_lshl_add_u32 v1, v235, 4, v1
    v_lshlrev_b32 v2, 3, v235
    v_bfrev_b32 v231, v235
    v_lshrrev_b32 v231, 28, v231
    v_and_b32 v232, 3, v231
    v_lshl_add_u32 v3, v232, 2, v234
    v_lshlrev_b32 v3, 1, v3
    v_lshrrev_b32 v231, 2, v231
    v_lshl_add_u32 v3, v231, 10, v3
    v_lshlrev_b32 v239, 2, v0
    v_add_u32 v240, 3840, v239
    v_add_u32 v239, 3584, v239
    v_lshlrev_b32 v241, 4, v0
    v_mov_b32 v242, 0
    v_mov_b32 v243, 1
    v_lshlrev_b32 v224, 2, v0
    v_mov_b32 v225, 1
    v_mov_b32 v226, 260
    s_mul_i32 s58, s79, 0
    s_and_b32 s94, s92, 448
    s_add_u32 s94, s94, s58
    s_add_u32 s94, s94, 512
    s_add_u32 s58, s58, s92
    s_and_b32 s58, s58, 511
    s_lshr_b32 s59, s3, 5
    s_lshl_b32 s69, s79, 9
    s_add_u32 s59, s59, 24
    s_lshl_b32 s59, s59, 9
    s_mov_b32 s64, 0xcccccccc
    s_mov_b32 s65, 0xcccccccc
    s_mov_b32 s60, 0x6fd53b95
    s_mov_b32 s62, 0x80000001
    s_mov_b32 s61, 0x6fd53b95
    s_mov_b32 s63, 0x80000001
    s_waitcnt lgkmcnt(0)
    s_mov_b32 s24, s6
    s_and_b32 s25, s7, 0xffff
    s_mov_b32 s26, 805306368
    s_mov_b32 s27, 0x00020000
    s_mov_b32 s48, s4
    s_and_b32 s49, s5, 0xffff
    s_mov_b32 s50, 12288
    s_mov_b32 s51, 0x00020000
    s_mov_b32 s32, s10
    s_and_b32 s33, s11, 0xffff
    s_mov_b32 s34, 6291456
    s_mov_b32 s35, 0x00020000
    s_mov_b32 s36, s12
    s_and_b32 s37, s13, 0xffff
    s_mov_b32 s38, 6291456
    s_mov_b32 s39, 0x00020000
    s_add_u32 s70, s69, s92
    s_mov_b32 s91, 1
    s_lshr_b32 s74, s70, 9
    s_mul_i32 s74, s74, 384
    buffer_load_dwordx2 v[192:193], v2, s[48:51], s74 offen offset:0
    buffer_load_dwordx2 v[194:195], v2, s[48:51], s74 offen offset:128
    buffer_load_dwordx2 v[196:197], v2, s[48:51], s74 offen offset:256
    s_and_b32 s80, s70, 31
    s_sub_u32 s72, s70, s80
    s_lshr_b32 s80, s80, 2
    s_add_u32 s72, s72, s80
    s_mul_i32 s72, s72, 384
    buffer_load_dwordx2 v[132:133], v2, s[32:35], s72 offen offset:0
    buffer_load_dwordx2 v[134:135], v2, s[32:35], s72 offen offset:128
    buffer_load_dwordx2 v[136:137], v2, s[32:35], s72 offen offset:256
    buffer_load_dwordx2 v[138:139], v2, s[36:39], s72 offen offset:0
    buffer_load_dwordx2 v[140:141], v2, s[36:39], s72 offen offset:128
    buffer_load_dwordx2 v[142:143], v2, s[36:39], s72 offen offset:256
    s_mul_i32 s71, s70, 49152
    s_and_b32 s80, s70, 31
    s_mul_i32 s80, s80, 36864
    s_sub_u32 s71, s71, s80
    buffer_load_dwordx4 v[4:7], v1, s[24:27], s71 offen offset:0 nt
    buffer_load_dwordx4 v[8:11], v1, s[24:27], s71 offen offset:256 nt
    buffer_load_dwordx4 v[12:15], v1, s[24:27], s71 offen offset:512 nt
    s_add_u32 s71, s71, 3072
    buffer_load_dwordx4 v[16:19], v1, s[24:27], s71 offen offset:0 nt
    s_add_u32 s72, s72, 3072
    buffer_load_dwordx2 v[156:157], v2, s[32:35], s72 offen offset:0
    buffer_load_dwordx2 v[158:159], v2, s[32:35], s72 offen offset:128
    buffer_load_dwordx2 v[160:161], v2, s[32:35], s72 offen offset:256
    buffer_load_dwordx2 v[162:163], v2, s[36:39], s72 offen offset:0
    buffer_load_dwordx2 v[164:165], v2, s[36:39], s72 offen offset:128
    buffer_load_dwordx2 v[166:167], v2, s[36:39], s72 offen offset:256
    buffer_load_dwordx4 v[20:23], v1, s[24:27], s71 offen offset:256 nt
    buffer_load_dwordx4 v[24:27], v1, s[24:27], s71 offen offset:512 nt
    s_add_u32 s71, s71, 3072
    buffer_load_dwordx4 v[28:31], v1, s[24:27], s71 offen offset:0 nt
    buffer_load_dwordx4 v[32:35], v1, s[24:27], s71 offen offset:256 nt
    buffer_load_dwordx4 v[36:39], v1, s[24:27], s71 offen offset:512 nt
    s_add_u32 s71, s71, 3072
    buffer_load_dwordx4 v[40:43], v1, s[24:27], s71 offen offset:0 nt
    buffer_load_dwordx4 v[44:47], v1, s[24:27], s71 offen offset:256 nt
    buffer_load_dwordx4 v[48:51], v1, s[24:27], s71 offen offset:512 nt
    s_add_u32 s71, s71, 384000
    buffer_load_dwordx4 v[52:55], v1, s[24:27], s71 offen offset:0 nt
    buffer_load_dwordx4 v[56:59], v1, s[24:27], s71 offen offset:256 nt
    buffer_load_dwordx4 v[60:63], v1, s[24:27], s71 offen offset:512 nt
    s_add_u32 s71, s71, 3072
    buffer_load_dwordx4 v[64:67], v1, s[24:27], s71 offen offset:0 nt
    s_add_u32 s72, s72, 3072
    buffer_load_dwordx2 v[168:169], v2, s[32:35], s72 offen offset:0
    buffer_load_dwordx2 v[170:171], v2, s[32:35], s72 offen offset:128
    buffer_load_dwordx2 v[172:173], v2, s[32:35], s72 offen offset:256
    buffer_load_dwordx2 v[174:175], v2, s[36:39], s72 offen offset:0
    buffer_load_dwordx2 v[176:177], v2, s[36:39], s72 offen offset:128
    buffer_load_dwordx2 v[178:179], v2, s[36:39], s72 offen offset:256
    buffer_load_dwordx4 v[68:71], v1, s[24:27], s71 offen offset:256 nt
    buffer_load_dwordx4 v[72:75], v1, s[24:27], s71 offen offset:512 nt
    s_add_u32 s71, s71, 3072
    buffer_load_dwordx4 v[76:79], v1, s[24:27], s71 offen offset:0 nt
    buffer_load_dwordx4 v[80:83], v1, s[24:27], s71 offen offset:256 nt
    buffer_load_dwordx4 v[84:87], v1, s[24:27], s71 offen offset:512 nt
    s_add_u32 s71, s71, 3072
    buffer_load_dwordx4 v[88:91], v1, s[24:27], s71 offen offset:0 nt
    buffer_load_dwordx4 v[92:95], v1, s[24:27], s71 offen offset:256 nt
    buffer_load_dwordx4 v[96:99], v1, s[24:27], s71 offen offset:512 nt
    s_mov_b32 s28, s8
    s_and_b32 s29, s9, 0xffff
    s_mov_b32 s30, 805306368
    s_mov_b32 s31, 0x00020000
    s_mov_b32 s40, s14
    s_and_b32 s41, s15, 0xffff
    s_mov_b32 s42, 2097152
    s_mov_b32 s43, 0x00020000
    s_mov_b32 s44, s16
    s_and_b32 s45, s17, 0xffff
    s_mov_b32 s46, 2097152
    s_mov_b32 s47, 0x00020000
    s_mov_b32 s52, s22
    s_and_b32 s53, s23, 0xffff
    s_mov_b32 s54, 25165824
    s_mov_b32 s55, 0x00020000
    v_mov_b32 v229, s2
    v_and_b32 v231, 15, v0
    v_lshrrev_b32 v230, 5, v229
    v_lshl_add_u32 v231, v230, 4, v231
    v_lshrrev_b32 v232, 4, v0
    v_lshl_add_u32 v231, v232, 7, v231
    s_lshl_b32 s82, s79, 3
    s_mov_b32 s80, 0xf1f6fb00
    s_mov_b32 s81, 0xdde2e7ec
    s_lshr_b64 s[80:81], s[80:81], s82
    s_sext_i32_i8 s80, s80
    s_mov_b32 exec_lo, 0x0
    s_mov_b32 exec_hi, 0x7ff
    v_add_u32 v231, s80, v231
    s_mov_b32 s80, 0x2c37424d
    s_mov_b32 s81, 0xb1621
    s_lshr_b64 s[80:81], s[80:81], s82
    s_sext_i32_i8 s80, s80
    s_mov_b32 exec_lo, 0x0
    s_mov_b32 exec_hi, 0xf800
    v_add_u32 v231, s80, v231
    s_mov_b64 exec, -1
    v_and_b32 v229, 31, v229
    v_lshl_add_u32 v245, v231, 5, v229
    s_mov_b32 s4, 0x10000
    s_mov_b32 s5, 0x10801
    s_cmp_eq_u32 s79, 1
    s_cselect_b32 s4, 0x10000, s4
    s_cselect_b32 s5, 0x14821, s5
    s_cmp_eq_u32 s79, 2
    s_cselect_b32 s4, 0x10000, s4
    s_cselect_b32 s5, 0x10c01, s5
    s_cmp_eq_u32 s79, 4
    s_cselect_b32 s4, 0x10000, s4
    s_cselect_b32 s5, 0x18811, s5
    s_cmp_eq_u32 s79, 5
    s_cselect_b32 s4, 0x10000, s4
    s_cselect_b32 s5, 0x10a01, s5
    s_cmp_eq_u32 s79, 7
    s_cselect_b32 s4, 0x10000, s4
    s_cselect_b32 s5, 0x10809, s5
    s_mov_b32 s7, 0xf149f2ca
    s_mov_b32 s77, 0xf149f2ca
    v_lshlrev_b32 v225, 4, v0
    v_mov_b32 v100, 0
    v_mov_b32 v101, 0
    v_mov_b32 v102, 0
    v_mov_b32 v103, 0
    s_lshl_b32 s78, s3, 11
    s_mov_b64 s[88:89], 0
    v_mov_b32 v216, 0xf149f2ca
    v_mov_b32 v217, 0
    v_mov_b32 v218, 0
    v_mov_b32 v204, 0
    v_mov_b32 v205, 0
    v_mov_b32 v206, 0
    v_mov_b32 v207, 0
    v_mov_b32 v208, 0
    v_mov_b32 v209, 0
    v_mov_b32 v210, 0
    v_mov_b32 v211, 0
    v_mov_b32 v212, 0
    v_mov_b32 v213, 0
    v_mov_b32 v214, 0
    v_mov_b32 v215, 0
    s_barrier
    s_waitcnt vmcnt(36)
    v_lshlrev_b32 v108, 16, v192
    v_and_b32 v109, 0xffff0000, v192
    v_pk_mul_f32 v[108:109], v[108:109], s[60:61]
    v_lshlrev_b32 v110, 16, v193
    v_and_b32 v111, 0xffff0000, v193
    v_pk_mul_f32 v[110:111], v[110:111], s[60:61]
    v_lshlrev_b32 v112, 16, v194
    v_and_b32 v113, 0xffff0000, v194
    v_pk_mul_f32 v[112:113], v[112:113], s[60:61]
    v_lshlrev_b32 v114, 16, v195
    v_and_b32 v115, 0xffff0000, v195
    v_pk_mul_f32 v[114:115], v[114:115], s[60:61]
    v_lshlrev_b32 v116, 16, v196
    v_and_b32 v117, 0xffff0000, v196
    v_pk_mul_f32 v[116:117], v[116:117], s[60:61]
    v_lshlrev_b32 v118, 16, v197
    v_and_b32 v119, 0xffff0000, v197
    v_pk_mul_f32 v[118:119], v[118:119], s[60:61]
    v_lshlrev_b32 v234, 16, v132
    v_and_b32 v235, 0xffff0000, v132
    v_pk_mul_f32 v[120:121], v[234:235], v[108:109]
    v_lshlrev_b32 v234, 16, v138
    v_and_b32 v235, 0xffff0000, v138
    v_pk_mul_f32 v[200:201], v[120:121], v[234:235]
    v_lshlrev_b32 v234, 16, v133
    v_and_b32 v235, 0xffff0000, v133
    v_pk_mul_f32 v[122:123], v[234:235], v[110:111]
    v_lshlrev_b32 v234, 16, v139
    v_and_b32 v235, 0xffff0000, v139
    v_pk_fma_f32 v[200:201], v[122:123], v[234:235], v[200:201]
    v_lshlrev_b32 v234, 16, v134
    v_and_b32 v235, 0xffff0000, v134
    v_pk_mul_f32 v[124:125], v[234:235], v[112:113]
    v_lshlrev_b32 v234, 16, v140
    v_and_b32 v235, 0xffff0000, v140
    v_pk_fma_f32 v[200:201], v[124:125], v[234:235], v[200:201]
    v_lshlrev_b32 v234, 16, v135
    v_and_b32 v235, 0xffff0000, v135
    v_pk_mul_f32 v[126:127], v[234:235], v[114:115]
    v_lshlrev_b32 v234, 16, v141
    v_and_b32 v235, 0xffff0000, v141
    v_pk_fma_f32 v[200:201], v[126:127], v[234:235], v[200:201]
    v_lshlrev_b32 v234, 16, v136
    v_and_b32 v235, 0xffff0000, v136
    v_pk_mul_f32 v[128:129], v[234:235], v[116:117]
    v_lshlrev_b32 v234, 16, v142
    v_and_b32 v235, 0xffff0000, v142
    v_pk_fma_f32 v[200:201], v[128:129], v[234:235], v[200:201]
    v_lshlrev_b32 v234, 16, v137
    v_and_b32 v235, 0xffff0000, v137
    v_pk_mul_f32 v[130:131], v[234:235], v[118:119]
    v_lshlrev_b32 v234, 16, v143
    v_and_b32 v235, 0xffff0000, v143
    v_pk_fma_f32 v[200:201], v[130:131], v[234:235], v[200:201]
    v_pk_mul_f32 v[200:201], v[200:201], s[62:63]
    s_mov_b32 s76, 63
L_loop0:
    s_waitcnt vmcnt(35)
    v_pk_fma_f32 v[198:199], v[120:121], v[4:5], v[200:201]
    v_pk_fma_f32 v[198:199], v[122:123], v[6:7], v[198:199]
    ds_read_b32 v244, v243 offset:147
    s_add_u32 s71, s71, 384000
    s_cbranch_vccnz L_th24_0
L_tb24_0:
    buffer_load_dwordx4 v[4:7], v1, s[24:27], s71 offen offset:0 nt
    v_add_f32_dpp v229, v228, v228 row_ror:8 row_mask:0xf bank_mask:0xc
    s_waitcnt vmcnt(35)
    v_pk_fma_f32 v[198:199], v[124:125], v[8:9], v[198:199]
    v_pk_fma_f32 v[198:199], v[126:127], v[10:11], v[198:199]
    buffer_load_dwordx4 v[8:11], v1, s[24:27], s71 offen offset:256 nt
    v_add_f32_dpp v230, v229, v229 row_shr:4 row_mask:0xf bank_mask:0xa
    s_waitcnt vmcnt(35)
    v_pk_fma_f32 v[198:199], v[128:129], v[12:13], v[198:199]
    v_pk_fma_f32 v[198:199], v[130:131], v[14:15], v[198:199]
    s_waitcnt lgkmcnt(0)
    v_cmp_lt_u32 vcc, v0, v244
    ds_add_u32 v224, v243 offset:3328
    buffer_load_dwordx4 v[12:15], v1, s[24:27], s71 offen offset:512 nt
    v_add_f32_dpp v232, v230, v230 quad_perm:[2,3,0,1] row_mask:0xf bank_mask:0xf
    v_add_f32 v228, v198, v199
    s_waitcnt vmcnt(35)
    v_pk_fma_f32 v[198:199], v[120:121], v[16:17], v[200:201]
    v_pk_fma_f32 v[198:199], v[122:123], v[18:19], v[198:199]
    s_add_u32 s71, s71, 3072
    s_cbranch_vccnz L_th27_0
L_tb27_0:
    buffer_load_dwordx4 v[16:19], v1, s[24:27], s71 offen offset:0 nt
    v_cndmask_b32 v232, v231, v232, s[64:65]
    v_add_f32_dpp v229, v228, v228 row_ror:8 row_mask:0xf bank_mask:0x3
    s_waitcnt vmcnt(29)
    v_pk_fma_f32 v[198:199], v[124:125], v[20:21], v[198:199]
    v_pk_fma_f32 v[198:199], v[126:127], v[22:23], v[198:199]
    s_add_u32 s72, s72, 3072
    buffer_load_dwordx2 v[180:181], v2, s[32:35], s72 offen offset:0
    buffer_load_dwordx2 v[182:183], v2, s[32:35], s72 offen offset:128
    buffer_load_dwordx2 v[184:185], v2, s[32:35], s72 offen offset:256
    buffer_load_dwordx2 v[186:187], v2, s[36:39], s72 offen offset:0
    buffer_load_dwordx2 v[188:189], v2, s[36:39], s72 offen offset:128
    buffer_load_dwordx2 v[190:191], v2, s[36:39], s72 offen offset:256
    buffer_load_dwordx4 v[20:23], v1, s[24:27], s71 offen offset:256 nt
    v_add_f32_dpp v231, v232, v232 quad_perm:[1,0,3,2] row_mask:0xf bank_mask:0xf
    v_lshlrev_b32 v234, 16, v156
    v_and_b32 v235, 0xffff0000, v156
    v_pk_mul_f32 v[144:145], v[234:235], v[108:109]
    v_lshlrev_b32 v234, 16, v162
    v_and_b32 v235, 0xffff0000, v162
    s_waitcnt vmcnt(35)
    v_pk_fma_f32 v[198:199], v[128:129], v[24:25], v[198:199]
    v_pk_fma_f32 v[198:199], v[130:131], v[26:27], v[198:199]
    ds_add_u32 v224, v243 offset:3328
    buffer_load_dwordx4 v[24:27], v1, s[24:27], s71 offen offset:512 nt
    v_cndmask_b32 v233, v233, v231, s[66:67]
    v_mul_f32 v233, 0x58000000, v233
    ds_write_b32 v239, v233
    v_add_u32 v239, 256, v239
    v_add_f32 v228, v198, v199
    v_pk_mul_f32 v[202:203], v[144:145], v[234:235]
    v_lshlrev_b32 v234, 16, v157
    v_and_b32 v235, 0xffff0000, v157
    v_pk_mul_f32 v[146:147], v[234:235], v[110:111]
    v_lshlrev_b32 v234, 16, v163
    s_waitcnt vmcnt(35)
    v_pk_fma_f32 v[198:199], v[120:121], v[28:29], v[200:201]
    v_pk_fma_f32 v[198:199], v[122:123], v[30:31], v[198:199]
    s_add_u32 s71, s71, 3072
    s_cbranch_vccnz L_th30_0
L_tb30_0:
    buffer_load_dwordx4 v[28:31], v1, s[24:27], s71 offen offset:0 nt
    v_add_f32_dpp v229, v228, v228 row_ror:8 row_mask:0xf bank_mask:0xc
    v_and_b32 v235, 0xffff0000, v163
    v_pk_fma_f32 v[202:203], v[146:147], v[234:235], v[202:203]
    v_lshlrev_b32 v234, 16, v158
    v_and_b32 v235, 0xffff0000, v158
    v_pk_mul_f32 v[148:149], v[234:235], v[112:113]
    s_waitcnt vmcnt(35)
    v_pk_fma_f32 v[198:199], v[124:125], v[32:33], v[198:199]
    v_pk_fma_f32 v[198:199], v[126:127], v[34:35], v[198:199]
    buffer_load_dwordx4 v[32:35], v1, s[24:27], s71 offen offset:256 nt
    v_add_f32_dpp v230, v229, v229 row_shl:4 row_mask:0xf bank_mask:0x5
    v_lshlrev_b32 v234, 16, v164
    v_and_b32 v235, 0xffff0000, v164
    v_pk_fma_f32 v[202:203], v[148:149], v[234:235], v[202:203]
    v_lshlrev_b32 v234, 16, v159
    v_and_b32 v235, 0xffff0000, v159
    s_waitcnt vmcnt(35)
    v_pk_fma_f32 v[198:199], v[128:129], v[36:37], v[198:199]
    v_pk_fma_f32 v[198:199], v[130:131], v[38:39], v[198:199]
    ds_add_u32 v224, v243 offset:3328
    buffer_load_dwordx4 v[36:39], v1, s[24:27], s71 offen offset:512 nt
    v_add_f32 v228, v198, v199
    v_pk_mul_f32 v[150:151], v[234:235], v[114:115]
    v_lshlrev_b32 v234, 16, v165
    v_and_b32 v235, 0xffff0000, v165
    v_pk_fma_f32 v[202:203], v[150:151], v[234:235], v[202:203]
    v_lshlrev_b32 v234, 16, v160
    s_waitcnt vmcnt(35)
    v_pk_fma_f32 v[198:199], v[120:121], v[40:41], v[200:201]
    v_pk_fma_f32 v[198:199], v[122:123], v[42:43], v[198:199]
    s_add_u32 s71, s71, 3072
    s_cbranch_vccnz L_th33_0
L_tb33_0:
    buffer_load_dwordx4 v[40:43], v1, s[24:27], s71 offen offset:0 nt
    v_add_f32_dpp v229, v228, v228 row_ror:8 row_mask:0xf bank_mask:0x3
    v_and_b32 v235, 0xffff0000, v160
    v_pk_mul_f32 v[152:153], v[234:235], v[116:117]
    v_lshlrev_b32 v234, 16, v166
    v_and_b32 v235, 0xffff0000, v166
    v_pk_fma_f32 v[202:203], v[152:153], v[234:235], v[202:203]
    s_waitcnt vmcnt(35)
    v_pk_fma_f32 v[198:199], v[124:125], v[44:45], v[198:199]
    v_pk_fma_f32 v[198:199], v[126:127], v[46:47], v[198:199]
    buffer_load_dwordx4 v[44:47], v1, s[24:27], s71 offen offset:256 nt
    v_lshlrev_b32 v234, 16, v161
    v_and_b32 v235, 0xffff0000, v161
    v_pk_mul_f32 v[154:155], v[234:235], v[118:119]
    v_lshlrev_b32 v234, 16, v167
    v_and_b32 v235, 0xffff0000, v167
    s_waitcnt vmcnt(35)
    v_pk_fma_f32 v[198:199], v[128:129], v[48:49], v[198:199]
    v_pk_fma_f32 v[198:199], v[130:131], v[50:51], v[198:199]
    ds_add_u32 v224, v243 offset:3328
    buffer_load_dwordx4 v[48:51], v1, s[24:27], s71 offen offset:512 nt
    v_add_f32 v228, v198, v199
    v_pk_fma_f32 v[202:203], v[154:155], v[234:235], v[202:203]
    v_pk_mul_f32 v[202:203], v[202:203], s[62:63]
    s_waitcnt vmcnt(35)
    v_pk_fma_f32 v[198:199], v[144:145], v[52:53], v[202:203]
    v_pk_fma_f32 v[198:199], v[146:147], v[54:55], v[198:199]
    ds_read_b32 v244, v243 offset:147
    v_readlane_b32 s70, v245, s91
    s_add_u32 s91, s91, 1
    s_lshr_b32 s74, s70, 9
    s_mul_i32 s74, s74, 384
    buffer_load_dwordx2 v[192:193], v2, s[48:51], s74 offen offset:0
    buffer_load_dwordx2 v[194:195], v2, s[48:51], s74 offen offset:128
    buffer_load_dwordx2 v[196:197], v2, s[48:51], s74 offen offset:256
    s_add_u32 s71, s71, 384000
    s_cbranch_vccnz L_th36_0
L_tb36_0:
    buffer_load_dwordx4 v[52:55], v1, s[24:27], s71 offen offset:0 nt
    v_add_f32_dpp v229, v228, v228 row_ror:8 row_mask:0xf bank_mask:0xc
    s_waitcnt vmcnt(38)
    v_pk_fma_f32 v[198:199], v[148:149], v[56:57], v[198:199]
    v_pk_fma_f32 v[198:199], v[150:151], v[58:59], v[198:199]
    buffer_load_dwordx4 v[56:59], v1, s[24:27], s71 offen offset:256 nt
    v_add_f32_dpp v230, v229, v229 row_shr:4 row_mask:0xf bank_mask:0xa
    s_waitcnt vmcnt(38)
    v_pk_fma_f32 v[198:199], v[152:153], v[60:61], v[198:199]
    v_pk_fma_f32 v[198:199], v[154:155], v[62:63], v[198:199]
    s_waitcnt lgkmcnt(0)
    v_cmp_lt_u32 vcc, v0, v244
    ds_add_u32 v224, v243 offset:3328
    buffer_load_dwordx4 v[60:63], v1, s[24:27], s71 offen offset:512 nt
    v_add_f32_dpp v231, v230, v230 quad_perm:[2,3,0,1] row_mask:0xf bank_mask:0xf
    v_add_f32 v228, v198, v199
    s_waitcnt vmcnt(38)
    v_pk_fma_f32 v[198:199], v[144:145], v[64:65], v[202:203]
    v_pk_fma_f32 v[198:199], v[146:147], v[66:67], v[198:199]
    s_add_u32 s71, s71, 3072
    s_cbranch_vccnz L_th39_0
L_tb39_0:
    buffer_load_dwordx4 v[64:67], v1, s[24:27], s71 offen offset:0 nt
    v_add_f32_dpp v229, v228, v228 row_ror:8 row_mask:0xf bank_mask:0x3
    s_waitcnt vmcnt(32)
    v_pk_fma_f32 v[198:199], v[148:149], v[68:69], v[198:199]
    v_pk_fma_f32 v[198:199], v[150:151], v[70:71], v[198:199]
    s_and_b32 s80, s70, 31
    s_sub_u32 s72, s70, s80
    s_lshr_b32 s80, s80, 2
    s_add_u32 s72, s72, s80
    s_mul_i32 s72, s72, 384
    buffer_load_dwordx2 v[132:133], v2, s[32:35], s72 offen offset:0
    buffer_load_dwordx2 v[134:135], v2, s[32:35], s72 offen offset:128
    buffer_load_dwordx2 v[136:137], v2, s[32:35], s72 offen offset:256
    buffer_load_dwordx2 v[138:139], v2, s[36:39], s72 offen offset:0
    buffer_load_dwordx2 v[140:141], v2, s[36:39], s72 offen offset:128
    buffer_load_dwordx2 v[142:143], v2, s[36:39], s72 offen offset:256
    buffer_load_dwordx4 v[68:71], v1, s[24:27], s71 offen offset:256 nt
    v_lshlrev_b32 v234, 16, v168
    v_and_b32 v235, 0xffff0000, v168
    v_pk_mul_f32 v[120:121], v[234:235], v[108:109]
    v_lshlrev_b32 v234, 16, v174
    v_and_b32 v235, 0xffff0000, v174
    s_waitcnt vmcnt(38)
    v_pk_fma_f32 v[198:199], v[152:153], v[72:73], v[198:199]
    v_pk_fma_f32 v[198:199], v[154:155], v[74:75], v[198:199]
    ds_add_u32 v224, v243 offset:3328
    buffer_load_dwordx4 v[72:75], v1, s[24:27], s71 offen offset:512 nt
    v_add_f32 v228, v198, v199
    v_pk_mul_f32 v[200:201], v[120:121], v[234:235]
    v_lshlrev_b32 v234, 16, v169
    v_and_b32 v235, 0xffff0000, v169
    v_pk_mul_f32 v[122:123], v[234:235], v[110:111]
    v_lshlrev_b32 v234, 16, v175
    s_waitcnt vmcnt(38)
    v_pk_fma_f32 v[198:199], v[144:145], v[76:77], v[202:203]
    v_pk_fma_f32 v[198:199], v[146:147], v[78:79], v[198:199]
    s_add_u32 s71, s71, 3072
    s_cbranch_vccnz L_th42_0
L_tb42_0:
    buffer_load_dwordx4 v[76:79], v1, s[24:27], s71 offen offset:0 nt
    v_add_f32_dpp v229, v228, v228 row_ror:8 row_mask:0xf bank_mask:0xc
    v_and_b32 v235, 0xffff0000, v175
    v_pk_fma_f32 v[200:201], v[122:123], v[234:235], v[200:201]
    v_lshlrev_b32 v234, 16, v170
    v_and_b32 v235, 0xffff0000, v170
    v_pk_mul_f32 v[124:125], v[234:235], v[112:113]
    s_waitcnt vmcnt(38)
    v_pk_fma_f32 v[198:199], v[148:149], v[80:81], v[198:199]
    v_pk_fma_f32 v[198:199], v[150:151], v[82:83], v[198:199]
    buffer_load_dwordx4 v[80:83], v1, s[24:27], s71 offen offset:256 nt
    v_add_f32_dpp v230, v229, v229 row_shl:4 row_mask:0xf bank_mask:0x5
    v_lshlrev_b32 v234, 16, v176
    v_and_b32 v235, 0xffff0000, v176
    v_pk_fma_f32 v[200:201], v[124:125], v[234:235], v[200:201]
    v_lshlrev_b32 v234, 16, v171
    v_and_b32 v235, 0xffff0000, v171
    s_waitcnt vmcnt(38)
    v_pk_fma_f32 v[198:199], v[152:153], v[84:85], v[198:199]
    v_pk_fma_f32 v[198:199], v[154:155], v[86:87], v[198:199]
    ds_add_u32 v224, v243 offset:3328
    buffer_load_dwordx4 v[84:87], v1, s[24:27], s71 offen offset:512 nt
    v_add_f32 v228, v198, v199
    v_pk_mul_f32 v[126:127], v[234:235], v[114:115]
    v_lshlrev_b32 v234, 16, v177
    v_and_b32 v235, 0xffff0000, v177
    v_pk_fma_f32 v[200:201], v[126:127], v[234:235], v[200:201]
    v_lshlrev_b32 v234, 16, v172
    s_waitcnt vmcnt(38)
    v_pk_fma_f32 v[198:199], v[144:145], v[88:89], v[202:203]
    v_pk_fma_f32 v[198:199], v[146:147], v[90:91], v[198:199]
    s_add_u32 s71, s71, 3072
    s_cbranch_vccnz L_th45_0
L_tb45_0:
    buffer_load_dwordx4 v[88:91], v1, s[24:27], s71 offen offset:0 nt
    v_add_f32_dpp v229, v228, v228 row_ror:8 row_mask:0xf bank_mask:0x3
    v_and_b32 v235, 0xffff0000, v172
    v_pk_mul_f32 v[128:129], v[234:235], v[116:117]
    v_lshlrev_b32 v234, 16, v178
    v_and_b32 v235, 0xffff0000, v178
    v_pk_fma_f32 v[200:201], v[128:129], v[234:235], v[200:201]
    s_waitcnt vmcnt(38)
    v_pk_fma_f32 v[198:199], v[148:149], v[92:93], v[198:199]
    v_pk_fma_f32 v[198:199], v[150:151], v[94:95], v[198:199]
    buffer_load_dwordx4 v[92:95], v1, s[24:27], s71 offen offset:256 nt
    v_lshlrev_b32 v234, 16, v173
    v_and_b32 v235, 0xffff0000, v173
    v_pk_mul_f32 v[130:131], v[234:235], v[118:119]
    v_lshlrev_b32 v234, 16, v179
    v_and_b32 v235, 0xffff0000, v179
    s_waitcnt vmcnt(38)
    v_pk_fma_f32 v[198:199], v[152:153], v[96:97], v[198:199]
    v_pk_fma_f32 v[198:199], v[154:155], v[98:99], v[198:199]
    ds_add_u32 v224, v243 offset:3328
    buffer_load_dwordx4 v[96:99], v1, s[24:27], s71 offen offset:512 nt
    v_add_f32 v228, v198, v199
    v_pk_fma_f32 v[200:201], v[130:131], v[234:235], v[200:201]
    v_pk_mul_f32 v[200:201], v[200:201], s[62:63]
    s_waitcnt vmcnt(38)
    v_pk_fma_f32 v[198:199], v[120:121], v[4:5], v[200:201]
    v_pk_fma_f32 v[198:199], v[122:123], v[6:7], v[198:199]
    ds_read_b32 v244, v243 offset:147
    s_mul_i32 s71, s70, 49152
    s_and_b32 s80, s70, 31
    s_mul_i32 s80, s80, 36864
    s_sub_u32 s71, s71, s80
    s_cbranch_vccnz L_th0_0
L_tb0_0:
    buffer_load_dwordx4 v[4:7], v1, s[24:27], s71 offen offset:0 nt
    v_add_f32_dpp v229, v228, v228 row_ror:8 row_mask:0xf bank_mask:0xc
    s_waitcnt vmcnt(38)
    v_pk_fma_f32 v[198:199], v[124:125], v[8:9], v[198:199]
    v_pk_fma_f32 v[198:199], v[126:127], v[10:11], v[198:199]
    buffer_load_dwordx4 v[8:11], v1, s[24:27], s71 offen offset:256 nt
    v_add_f32_dpp v230, v229, v229 row_shr:4 row_mask:0xf bank_mask:0xa
    s_waitcnt vmcnt(38)
    v_pk_fma_f32 v[198:199], v[128:129], v[12:13], v[198:199]
    v_pk_fma_f32 v[198:199], v[130:131], v[14:15], v[198:199]
    s_waitcnt lgkmcnt(0)
    v_cmp_lt_u32 vcc, v0, v244
    ds_add_u32 v224, v243 offset:3328
    buffer_load_dwordx4 v[12:15], v1, s[24:27], s71 offen offset:512 nt
    v_add_f32_dpp v232, v230, v230 quad_perm:[2,3,0,1] row_mask:0xf bank_mask:0xf
    v_add_f32 v228, v198, v199
    s_waitcnt vmcnt(38)
    v_pk_fma_f32 v[198:199], v[120:121], v[16:17], v[200:201]
    v_pk_fma_f32 v[198:199], v[122:123], v[18:19], v[198:199]
    s_add_u32 s71, s71, 3072
    s_cbranch_vccnz L_th3_0
L_tb3_0:
    buffer_load_dwordx4 v[16:19], v1, s[24:27], s71 offen offset:0 nt
    v_cndmask_b32 v232, v231, v232, s[64:65]
    v_add_f32_dpp v229, v228, v228 row_ror:8 row_mask:0xf bank_mask:0x3
    s_waitcnt vmcnt(32)
    v_pk_fma_f32 v[198:199], v[124:125], v[20:21], v[198:199]
    v_pk_fma_f32 v[198:199], v[126:127], v[22:23], v[198:199]
    s_add_u32 s72, s72, 3072
    buffer_load_dwordx2 v[156:157], v2, s[32:35], s72 offen offset:0
    buffer_load_dwordx2 v[158:159], v2, s[32:35], s72 offen offset:128
    buffer_load_dwordx2 v[160:161], v2, s[32:35], s72 offen offset:256
    buffer_load_dwordx2 v[162:163], v2, s[36:39], s72 offen offset:0
    buffer_load_dwordx2 v[164:165], v2, s[36:39], s72 offen offset:128
    buffer_load_dwordx2 v[166:167], v2, s[36:39], s72 offen offset:256
    buffer_load_dwordx4 v[20:23], v1, s[24:27], s71 offen offset:256 nt
    v_add_f32_dpp v233, v232, v232 quad_perm:[1,0,3,2] row_mask:0xf bank_mask:0xf
    v_lshlrev_b32 v234, 16, v180
    v_and_b32 v235, 0xffff0000, v180
    v_pk_mul_f32 v[144:145], v[234:235], v[108:109]
    v_lshlrev_b32 v234, 16, v186
    v_and_b32 v235, 0xffff0000, v186
    s_waitcnt vmcnt(38)
    v_pk_fma_f32 v[198:199], v[128:129], v[24:25], v[198:199]
    v_pk_fma_f32 v[198:199], v[130:131], v[26:27], v[198:199]
    ds_add_u32 v224, v243 offset:3328
    buffer_load_dwordx4 v[24:27], v1, s[24:27], s71 offen offset:512 nt
    v_add_f32 v228, v198, v199
    v_pk_mul_f32 v[202:203], v[144:145], v[234:235]
    v_lshlrev_b32 v234, 16, v181
    v_and_b32 v235, 0xffff0000, v181
    v_pk_mul_f32 v[146:147], v[234:235], v[110:111]
    v_lshlrev_b32 v234, 16, v187
    s_waitcnt vmcnt(38)
    v_pk_fma_f32 v[198:199], v[120:121], v[28:29], v[200:201]
    v_pk_fma_f32 v[198:199], v[122:123], v[30:31], v[198:199]
    s_add_u32 s71, s71, 3072
    s_cbranch_vccnz L_th6_0
L_tb6_0:
    buffer_load_dwordx4 v[28:31], v1, s[24:27], s71 offen offset:0 nt
    v_add_f32_dpp v229, v228, v228 row_ror:8 row_mask:0xf bank_mask:0xc
    v_and_b32 v235, 0xffff0000, v187
    v_pk_fma_f32 v[202:203], v[146:147], v[234:235], v[202:203]
    v_lshlrev_b32 v234, 16, v182
    v_and_b32 v235, 0xffff0000, v182
    v_pk_mul_f32 v[148:149], v[234:235], v[112:113]
    s_waitcnt vmcnt(38)
    v_pk_fma_f32 v[198:199], v[124:125], v[32:33], v[198:199]
    v_pk_fma_f32 v[198:199], v[126:127], v[34:35], v[198:199]
    buffer_load_dwordx4 v[32:35], v1, s[24:27], s71 offen offset:256 nt
    v_add_f32_dpp v230, v229, v229 row_shl:4 row_mask:0xf bank_mask:0x5
    v_lshlrev_b32 v234, 16, v188
    v_and_b32 v235, 0xffff0000, v188
    v_pk_fma_f32 v[202:203], v[148:149], v[234:235], v[202:203]
    v_lshlrev_b32 v234, 16, v183
    v_and_b32 v235, 0xffff0000, v183
    s_waitcnt vmcnt(38)
    s_branch L_x0
L_w0:
    s_branch L_w1
L_x0:
    v_pk_fma_f32 v[198:199], v[128:129], v[36:37], v[198:199]
    v_pk_fma_f32 v[198:199], v[130:131], v[38:39], v[198:199]
    ds_add_u32 v224, v243 offset:3328
    buffer_load_dwordx4 v[36:39], v1, s[24:27], s71 offen offset:512 nt
    v_add_f32 v228, v198, v199
    v_pk_mul_f32 v[150:151], v[234:235], v[114:115]
    v_lshlrev_b32 v234, 16, v189
    v_and_b32 v235, 0xffff0000, v189
    v_pk_fma_f32 v[202:203], v[150:151], v[234:235], v[202:203]
    v_lshlrev_b32 v234, 16, v184
    s_waitcnt vmcnt(38)
    v_pk_fma_f32 v[198:199], v[120:121], v[40:41], v[200:201]
    v_pk_fma_f32 v[198:199], v[122:123], v[42:43], v[198:199]
    s_add_u32 s71, s71, 3072
    s_cbranch_vccnz L_th9_0
L_tb9_0:
    buffer_load_dwordx4 v[40:43], v1, s[24:27], s71 offen offset:0 nt
    v_add_f32_dpp v229, v228, v228 row_ror:8 row_mask:0xf bank_mask:0x3
    v_and_b32 v235, 0xffff0000, v184
    v_pk_mul_f32 v[152:153], v[234:235], v[116:117]
    v_lshlrev_b32 v234, 16, v190
    v_and_b32 v235, 0xffff0000, v190
    v_pk_fma_f32 v[202:203], v[152:153], v[234:235], v[202:203]
    s_waitcnt vmcnt(38)
    v_pk_fma_f32 v[198:199], v[124:125], v[44:45], v[198:199]
    v_pk_fma_f32 v[198:199], v[126:127], v[46:47], v[198:199]
    buffer_load_dwordx4 v[44:47], v1, s[24:27], s71 offen offset:256 nt
    v_lshlrev_b32 v234, 16, v185
    v_and_b32 v235, 0xffff0000, v185
    v_pk_mul_f32 v[154:155], v[234:235], v[118:119]
    v_lshlrev_b32 v234, 16, v191
    v_and_b32 v235, 0xffff0000, v191
    s_waitcnt vmcnt(38)
    v_pk_fma_f32 v[198:199], v[128:129], v[48:49], v[198:199]
    v_pk_fma_f32 v[198:199], v[130:131], v[50:51], v[198:199]
    ds_add_u32 v224, v243 offset:3328
    buffer_load_dwordx4 v[48:51], v1, s[24:27], s71 offen offset:512 nt
    v_add_f32 v228, v198, v199
    v_pk_fma_f32 v[202:203], v[154:155], v[234:235], v[202:203]
    v_pk_mul_f32 v[202:203], v[202:203], s[62:63]
    s_waitcnt vmcnt(35)
    v_pk_fma_f32 v[198:199], v[144:145], v[52:53], v[202:203]
    v_pk_fma_f32 v[198:199], v[146:147], v[54:55], v[198:199]
    ds_read_b32 v244, v243 offset:147
    s_add_u32 s71, s71, 384000
    s_cbranch_vccnz L_th12_0
L_tb12_0:
    buffer_load_dwordx4 v[52:55], v1, s[24:27], s71 offen offset:0 nt
    v_add_f32_dpp v229, v228, v228 row_ror:8 row_mask:0xf bank_mask:0xc
    v_lshlrev_b32 v108, 16, v192
    v_and_b32 v109, 0xffff0000, v192
    v_pk_mul_f32 v[108:109], v[108:109], s[60:61]
    v_lshlrev_b32 v110, 16, v193
    v_and_b32 v111, 0xffff0000, v193
    s_waitcnt vmcnt(35)
    v_pk_fma_f32 v[198:199], v[148:149], v[56:57], v[198:199]
    v_pk_fma_f32 v[198:199], v[150:151], v[58:59], v[198:199]
    buffer_load_dwordx4 v[56:59], v1, s[24:27], s71 offen offset:256 nt
    v_add_f32_dpp v230, v229, v229 row_shr:4 row_mask:0xf bank_mask:0xa
    v_pk_mul_f32 v[110:111], v[110:111], s[60:61]
    v_lshlrev_b32 v112, 16, v194
    v_and_b32 v113, 0xffff0000, v194
    v_pk_mul_f32 v[112:113], v[112:113], s[60:61]
    v_lshlrev_b32 v114, 16, v195
    s_waitcnt vmcnt(35)
    v_pk_fma_f32 v[198:199], v[152:153], v[60:61], v[198:199]
    v_pk_fma_f32 v[198:199], v[154:155], v[62:63], v[198:199]
    s_waitcnt lgkmcnt(0)
    v_cmp_lt_u32 vcc, v0, v244
    ds_add_u32 v224, v243 offset:3328
    buffer_load_dwordx4 v[60:63], v1, s[24:27], s71 offen offset:512 nt
    v_add_f32_dpp v231, v230, v230 quad_perm:[2,3,0,1] row_mask:0xf bank_mask:0xf
    v_add_f32 v228, v198, v199
    v_and_b32 v115, 0xffff0000, v195
    v_pk_mul_f32 v[114:115], v[114:115], s[60:61]
    v_lshlrev_b32 v116, 16, v196
    v_and_b32 v117, 0xffff0000, v196
    v_pk_mul_f32 v[116:117], v[116:117], s[60:61]
    s_waitcnt vmcnt(35)
    v_pk_fma_f32 v[198:199], v[144:145], v[64:65], v[202:203]
    v_pk_fma_f32 v[198:199], v[146:147], v[66:67], v[198:199]
    s_add_u32 s71, s71, 3072
    s_cbranch_vccnz L_th15_0
L_tb15_0:
    buffer_load_dwordx4 v[64:67], v1, s[24:27], s71 offen offset:0 nt
    v_add_f32_dpp v229, v228, v228 row_ror:8 row_mask:0xf bank_mask:0x3
    v_lshlrev_b32 v118, 16, v197
    v_and_b32 v119, 0xffff0000, v197
    v_pk_mul_f32 v[118:119], v[118:119], s[60:61]
    s_waitcnt vmcnt(29)
    v_pk_fma_f32 v[198:199], v[148:149], v[68:69], v[198:199]
    v_pk_fma_f32 v[198:199], v[150:151], v[70:71], v[198:199]
    s_add_u32 s72, s72, 3072
    buffer_load_dwordx2 v[168:169], v2, s[32:35], s72 offen offset:0
    buffer_load_dwordx2 v[170:171], v2, s[32:35], s72 offen offset:128
    buffer_load_dwordx2 v[172:173], v2, s[32:35], s72 offen offset:256
    buffer_load_dwordx2 v[174:175], v2, s[36:39], s72 offen offset:0
    buffer_load_dwordx2 v[176:177], v2, s[36:39], s72 offen offset:128
    buffer_load_dwordx2 v[178:179], v2, s[36:39], s72 offen offset:256
    buffer_load_dwordx4 v[68:71], v1, s[24:27], s71 offen offset:256 nt
    v_lshlrev_b32 v234, 16, v132
    v_and_b32 v235, 0xffff0000, v132
    v_pk_mul_f32 v[120:121], v[234:235], v[108:109]
    v_lshlrev_b32 v234, 16, v138
    v_and_b32 v235, 0xffff0000, v138
    s_waitcnt vmcnt(35)
    v_pk_fma_f32 v[198:199], v[152:153], v[72:73], v[198:199]
    v_pk_fma_f32 v[198:199], v[154:155], v[74:75], v[198:199]
    ds_add_u32 v224, v243 offset:3328
    buffer_load_dwordx4 v[72:75], v1, s[24:27], s71 offen offset:512 nt
    v_add_f32 v228, v198, v199
    v_pk_mul_f32 v[200:201], v[120:121], v[234:235]
    v_lshlrev_b32 v234, 16, v133
    v_and_b32 v235, 0xffff0000, v133
    v_pk_mul_f32 v[122:123], v[234:235], v[110:111]
    v_lshlrev_b32 v234, 16, v139
    s_waitcnt vmcnt(35)
    v_pk_fma_f32 v[198:199], v[144:145], v[76:77], v[202:203]
    v_pk_fma_f32 v[198:199], v[146:147], v[78:79], v[198:199]
    s_add_u32 s71, s71, 3072
    s_cbranch_vccnz L_th18_0
L_tb18_0:
    buffer_load_dwordx4 v[76:79], v1, s[24:27], s71 offen offset:0 nt
    v_add_f32_dpp v229, v228, v228 row_ror:8 row_mask:0xf bank_mask:0xc
    v_and_b32 v235, 0xffff0000, v139
    v_pk_fma_f32 v[200:201], v[122:123], v[234:235], v[200:201]
    v_lshlrev_b32 v234, 16, v134
    v_and_b32 v235, 0xffff0000, v134
    v_pk_mul_f32 v[124:125], v[234:235], v[112:113]
    s_waitcnt vmcnt(35)
    v_pk_fma_f32 v[198:199], v[148:149], v[80:81], v[198:199]
    v_pk_fma_f32 v[198:199], v[150:151], v[82:83], v[198:199]
    buffer_load_dwordx4 v[80:83], v1, s[24:27], s71 offen offset:256 nt
    v_add_f32_dpp v230, v229, v229 row_shl:4 row_mask:0xf bank_mask:0x5
    v_lshlrev_b32 v234, 16, v140
    v_and_b32 v235, 0xffff0000, v140
    v_pk_fma_f32 v[200:201], v[124:125], v[234:235], v[200:201]
    v_lshlrev_b32 v234, 16, v135
    v_and_b32 v235, 0xffff0000, v135
    s_waitcnt vmcnt(35)
    v_pk_fma_f32 v[198:199], v[152:153], v[84:85], v[198:199]
    v_pk_fma_f32 v[198:199], v[154:155], v[86:87], v[198:199]
    ds_add_u32 v224, v243 offset:3328
    buffer_load_dwordx4 v[84:87], v1, s[24:27], s71 offen offset:512 nt
    v_add_f32 v228, v198, v199
    v_pk_mul_f32 v[126:127], v[234:235], v[114:115]
    v_lshlrev_b32 v234, 16, v141
    v_and_b32 v235, 0xffff0000, v141
    v_pk_fma_f32 v[200:201], v[126:127], v[234:235], v[200:201]
    v_lshlrev_b32 v234, 16, v136
    s_waitcnt vmcnt(35)
    v_pk_fma_f32 v[198:199], v[144:145], v[88:89], v[202:203]
    v_pk_fma_f32 v[198:199], v[146:147], v[90:91], v[198:199]
    s_add_u32 s71, s71, 3072
    s_cbranch_vccnz L_th21_0
L_tb21_0:
    buffer_load_dwordx4 v[88:91], v1, s[24:27], s71 offen offset:0 nt
    v_add_f32_dpp v229, v228, v228 row_ror:8 row_mask:0xf bank_mask:0x3
    v_and_b32 v235, 0xffff0000, v136
    v_pk_mul_f32 v[128:129], v[234:235], v[116:117]
    v_lshlrev_b32 v234, 16, v142
    v_and_b32 v235, 0xffff0000, v142
    v_pk_fma_f32 v[200:201], v[128:129], v[234:235], v[200:201]
    s_waitcnt vmcnt(35)
    v_pk_fma_f32 v[198:199], v[148:149], v[92:93], v[198:199]
    v_pk_fma_f32 v[198:199], v[150:151], v[94:95], v[198:199]
    buffer_load_dwordx4 v[92:95], v1, s[24:27], s71 offen offset:256 nt
    v_lshlrev_b32 v234, 16, v137
    v_and_b32 v235, 0xffff0000, v137
    v_pk_mul_f32 v[130:131], v[234:235], v[118:119]
    v_lshlrev_b32 v234, 16, v143
    v_and_b32 v235, 0xffff0000, v143
    s_waitcnt vmcnt(35)
    v_pk_fma_f32 v[198:199], v[152:153], v[96:97], v[198:199]
    v_pk_fma_f32 v[198:199], v[154:155], v[98:99], v[198:199]
    ds_add_u32 v224, v243 offset:3328
    buffer_load_dwordx4 v[96:99], v1, s[24:27], s71 offen offset:512 nt
    v_add_f32 v228, v198, v199
    v_pk_fma_f32 v[200:201], v[130:131], v[234:235], v[200:201]
    v_pk_mul_f32 v[200:201], v[200:201], s[62:63]
    s_sub_u32 s76, s76, 1
    s_cmp_lg_u32 s76, 0
    s_cbranch_scc1 L_loop0
    s_waitcnt vmcnt(35)
    v_pk_fma_f32 v[198:199], v[120:121], v[4:5], v[200:201]
    v_pk_fma_f32 v[198:199], v[122:123], v[6:7], v[198:199]
    ds_read_b32 v244, v243 offset:147
    s_add_u32 s71, s71, 384000
    s_cbranch_vccnz L_th24_1
L_tb24_1:
    buffer_load_dwordx4 v[4:7], v1, s[24:27], s71 offen offset:0 nt
    v_add_f32_dpp v229, v228, v228 row_ror:8 row_mask:0xf bank_mask:0xc
    s_waitcnt vmcnt(35)
    v_pk_fma_f32 v[198:199], v[124:125], v[8:9], v[198:199]
    v_pk_fma_f32 v[198:199], v[126:127], v[10:11], v[198:199]
    buffer_load_dwordx4 v[8:11], v1, s[24:27], s71 offen offset:256 nt
    v_add_f32_dpp v230, v229, v229 row_shr:4 row_mask:0xf bank_mask:0xa
    s_waitcnt vmcnt(35)
    v_pk_fma_f32 v[198:199], v[128:129], v[12:13], v[198:199]
    v_pk_fma_f32 v[198:199], v[130:131], v[14:15], v[198:199]
    s_waitcnt lgkmcnt(0)
    v_cmp_lt_u32 vcc, v0, v244
    ds_add_u32 v224, v243 offset:3328
    buffer_load_dwordx4 v[12:15], v1, s[24:27], s71 offen offset:512 nt
    v_add_f32_dpp v232, v230, v230 quad_perm:[2,3,0,1] row_mask:0xf bank_mask:0xf
    v_add_f32 v228, v198, v199
    s_waitcnt vmcnt(35)
    v_pk_fma_f32 v[198:199], v[120:121], v[16:17], v[200:201]
    v_pk_fma_f32 v[198:199], v[122:123], v[18:19], v[198:199]
    s_add_u32 s71, s71, 3072
    s_cbranch_vccnz L_th27_1
L_tb27_1:
    buffer_load_dwordx4 v[16:19], v1, s[24:27], s71 offen offset:0 nt
    v_cndmask_b32 v232, v231, v232, s[64:65]
    v_add_f32_dpp v229, v228, v228 row_ror:8 row_mask:0xf bank_mask:0x3
    s_waitcnt vmcnt(29)
    v_pk_fma_f32 v[198:199], v[124:125], v[20:21], v[198:199]
    v_pk_fma_f32 v[198:199], v[126:127], v[22:23], v[198:199]
    s_add_u32 s72, s72, 3072
    buffer_load_dwordx2 v[180:181], v2, s[32:35], s72 offen offset:0
    buffer_load_dwordx2 v[182:183], v2, s[32:35], s72 offen offset:128
    buffer_load_dwordx2 v[184:185], v2, s[32:35], s72 offen offset:256
    buffer_load_dwordx2 v[186:187], v2, s[36:39], s72 offen offset:0
    buffer_load_dwordx2 v[188:189], v2, s[36:39], s72 offen offset:128
    buffer_load_dwordx2 v[190:191], v2, s[36:39], s72 offen offset:256
    buffer_load_dwordx4 v[20:23], v1, s[24:27], s71 offen offset:256 nt
    v_add_f32_dpp v231, v232, v232 quad_perm:[1,0,3,2] row_mask:0xf bank_mask:0xf
    v_lshlrev_b32 v234, 16, v156
    v_and_b32 v235, 0xffff0000, v156
    v_pk_mul_f32 v[144:145], v[234:235], v[108:109]
    v_lshlrev_b32 v234, 16, v162
    v_and_b32 v235, 0xffff0000, v162
    s_waitcnt vmcnt(35)
    v_pk_fma_f32 v[198:199], v[128:129], v[24:25], v[198:199]
    v_pk_fma_f32 v[198:199], v[130:131], v[26:27], v[198:199]
    ds_add_u32 v224, v243 offset:3328
    buffer_load_dwordx4 v[24:27], v1, s[24:27], s71 offen offset:512 nt
    v_cndmask_b32 v233, v233, v231, s[66:67]
    v_mul_f32 v233, 0x58000000, v233
    ds_write_b32 v239, v233
    v_add_u32 v239, 256, v239
    v_add_f32 v228, v198, v199
    v_pk_mul_f32 v[202:203], v[144:145], v[234:235]
    v_lshlrev_b32 v234, 16, v157
    v_and_b32 v235, 0xffff0000, v157
    v_pk_mul_f32 v[146:147], v[234:235], v[110:111]
    v_lshlrev_b32 v234, 16, v163
    s_waitcnt vmcnt(35)
    v_pk_fma_f32 v[198:199], v[120:121], v[28:29], v[200:201]
    v_pk_fma_f32 v[198:199], v[122:123], v[30:31], v[198:199]
    s_add_u32 s71, s71, 3072
    s_cbranch_vccnz L_th30_1
L_tb30_1:
    buffer_load_dwordx4 v[28:31], v1, s[24:27], s71 offen offset:0 nt
    v_add_f32_dpp v229, v228, v228 row_ror:8 row_mask:0xf bank_mask:0xc
    v_and_b32 v235, 0xffff0000, v163
    v_pk_fma_f32 v[202:203], v[146:147], v[234:235], v[202:203]
    v_lshlrev_b32 v234, 16, v158
    v_and_b32 v235, 0xffff0000, v158
    v_pk_mul_f32 v[148:149], v[234:235], v[112:113]
    s_waitcnt vmcnt(35)
    v_pk_fma_f32 v[198:199], v[124:125], v[32:33], v[198:199]
    v_pk_fma_f32 v[198:199], v[126:127], v[34:35], v[198:199]
    buffer_load_dwordx4 v[32:35], v1, s[24:27], s71 offen offset:256 nt
    v_add_f32_dpp v230, v229, v229 row_shl:4 row_mask:0xf bank_mask:0x5
    v_lshlrev_b32 v234, 16, v164
    v_and_b32 v235, 0xffff0000, v164
    v_pk_fma_f32 v[202:203], v[148:149], v[234:235], v[202:203]
    v_lshlrev_b32 v234, 16, v159
    v_and_b32 v235, 0xffff0000, v159
    s_waitcnt vmcnt(35)
    v_pk_fma_f32 v[198:199], v[128:129], v[36:37], v[198:199]
    v_pk_fma_f32 v[198:199], v[130:131], v[38:39], v[198:199]
    ds_add_u32 v224, v243 offset:3328
    buffer_load_dwordx4 v[36:39], v1, s[24:27], s71 offen offset:512 nt
    v_add_f32 v228, v198, v199
    v_pk_mul_f32 v[150:151], v[234:235], v[114:115]
    v_lshlrev_b32 v234, 16, v165
    v_and_b32 v235, 0xffff0000, v165
    v_pk_fma_f32 v[202:203], v[150:151], v[234:235], v[202:203]
    v_lshlrev_b32 v234, 16, v160
    s_waitcnt vmcnt(35)
    v_pk_fma_f32 v[198:199], v[120:121], v[40:41], v[200:201]
    v_pk_fma_f32 v[198:199], v[122:123], v[42:43], v[198:199]
    s_add_u32 s71, s71, 3072
    s_cbranch_vccnz L_th33_1
L_tb33_1:
    buffer_load_dwordx4 v[40:43], v1, s[24:27], s71 offen offset:0 nt
    v_add_f32_dpp v229, v228, v228 row_ror:8 row_mask:0xf bank_mask:0x3
    v_and_b32 v235, 0xffff0000, v160
    v_pk_mul_f32 v[152:153], v[234:235], v[116:117]
    v_lshlrev_b32 v234, 16, v166
    v_and_b32 v235, 0xffff0000, v166
    v_pk_fma_f32 v[202:203], v[152:153], v[234:235], v[202:203]
    s_waitcnt vmcnt(35)
    v_pk_fma_f32 v[198:199], v[124:125], v[44:45], v[198:199]
    v_pk_fma_f32 v[198:199], v[126:127], v[46:47], v[198:199]
    buffer_load_dwordx4 v[44:47], v1, s[24:27], s71 offen offset:256 nt
    v_lshlrev_b32 v234, 16, v161
    v_and_b32 v235, 0xffff0000, v161
    v_pk_mul_f32 v[154:155], v[234:235], v[118:119]
    v_lshlrev_b32 v234, 16, v167
    v_and_b32 v235, 0xffff0000, v167
    s_waitcnt vmcnt(35)
    v_pk_fma_f32 v[198:199], v[128:129], v[48:49], v[198:199]
    v_pk_fma_f32 v[198:199], v[130:131], v[50:51], v[198:199]
    ds_add_u32 v224, v243 offset:3328
    buffer_load_dwordx4 v[48:51], v1, s[24:27], s71 offen offset:512 nt
    v_add_f32 v228, v198, v199
    v_pk_fma_f32 v[202:203], v[154:155], v[234:235], v[202:203]
    v_pk_mul_f32 v[202:203], v[202:203], s[62:63]
    s_waitcnt vmcnt(35)
    v_pk_fma_f32 v[198:199], v[144:145], v[52:53], v[202:203]
    v_pk_fma_f32 v[198:199], v[146:147], v[54:55], v[198:199]
    ds_read_b32 v244, v243 offset:147
    s_mov_b32 s91, 0
    v_readlane_b32 s70, v245, s91
    s_add_u32 s91, s91, 1
    s_and_b32 s80, s70, 31
    s_mul_i32 s80, s80, 96
    s_lshl_b32 s73, s70, 7
    s_sub_u32 s73, s73, s80
    buffer_load_ushort v220, v3, s[40:43], s73 offen
    buffer_load_ushort v221, v3, s[44:47], s73 offen
    s_add_u32 s71, s71, 384000
    s_cbranch_vccnz L_th36_1
L_tb36_1:
    buffer_load_dwordx4 v[52:55], v1, s[24:27], s71 offen offset:0 nt
    v_add_f32_dpp v229, v228, v228 row_ror:8 row_mask:0xf bank_mask:0xc
    s_waitcnt vmcnt(37)
    v_pk_fma_f32 v[198:199], v[148:149], v[56:57], v[198:199]
    v_pk_fma_f32 v[198:199], v[150:151], v[58:59], v[198:199]
    buffer_load_dwordx4 v[56:59], v1, s[24:27], s71 offen offset:256 nt
    v_add_f32_dpp v230, v229, v229 row_shr:4 row_mask:0xf bank_mask:0xa
    s_waitcnt vmcnt(37)
    v_pk_fma_f32 v[198:199], v[152:153], v[60:61], v[198:199]
    v_pk_fma_f32 v[198:199], v[154:155], v[62:63], v[198:199]
    s_waitcnt lgkmcnt(0)
    v_cmp_lt_u32 vcc, v0, v244
    ds_add_u32 v224, v243 offset:3328
    buffer_load_dwordx4 v[60:63], v1, s[24:27], s71 offen offset:512 nt
    v_add_f32_dpp v231, v230, v230 quad_perm:[2,3,0,1] row_mask:0xf bank_mask:0xf
    v_add_f32 v228, v198, v199
    s_waitcnt vmcnt(37)
    v_pk_fma_f32 v[198:199], v[144:145], v[64:65], v[202:203]
    v_pk_fma_f32 v[198:199], v[146:147], v[66:67], v[198:199]
    s_add_u32 s71, s71, 3072
    s_cbranch_vccnz L_th39_1
L_tb39_1:
    buffer_load_dwordx4 v[64:67], v1, s[24:27], s71 offen offset:0 nt
    v_add_f32_dpp v229, v228, v228 row_ror:8 row_mask:0xf bank_mask:0x3
    s_waitcnt vmcnt(31)
    v_pk_fma_f32 v[198:199], v[148:149], v[68:69], v[198:199]
    v_pk_fma_f32 v[198:199], v[150:151], v[70:71], v[198:199]
    buffer_load_dwordx4 v[68:71], v1, s[24:27], s71 offen offset:256 nt
    v_lshlrev_b32 v234, 16, v168
    v_and_b32 v235, 0xffff0000, v168
    v_pk_mul_f32 v[120:121], v[234:235], v[108:109]
    v_lshlrev_b32 v234, 16, v174
    v_and_b32 v235, 0xffff0000, v174
    s_waitcnt vmcnt(31)
    v_pk_fma_f32 v[198:199], v[152:153], v[72:73], v[198:199]
    v_pk_fma_f32 v[198:199], v[154:155], v[74:75], v[198:199]
    ds_add_u32 v224, v243 offset:3328
    buffer_load_dwordx4 v[72:75], v1, s[24:27], s71 offen offset:512 nt
    v_add_f32 v228, v198, v199
    v_pk_mul_f32 v[200:201], v[120:121], v[234:235]
    v_lshlrev_b32 v234, 16, v169
    v_and_b32 v235, 0xffff0000, v169
    v_pk_mul_f32 v[122:123], v[234:235], v[110:111]
    v_lshlrev_b32 v234, 16, v175
    s_waitcnt vmcnt(31)
    v_pk_fma_f32 v[198:199], v[144:145], v[76:77], v[202:203]
    v_pk_fma_f32 v[198:199], v[146:147], v[78:79], v[198:199]
    s_add_u32 s71, s71, 3072
    s_cbranch_vccnz L_th42_1
L_tb42_1:
    buffer_load_dwordx4 v[76:79], v1, s[24:27], s71 offen offset:0 nt
    v_add_f32_dpp v229, v228, v228 row_ror:8 row_mask:0xf bank_mask:0xc
    v_and_b32 v235, 0xffff0000, v175
    v_pk_fma_f32 v[200:201], v[122:123], v[234:235], v[200:201]
    v_lshlrev_b32 v234, 16, v170
    v_and_b32 v235, 0xffff0000, v170
    v_pk_mul_f32 v[124:125], v[234:235], v[112:113]
    s_waitcnt vmcnt(31)
    v_pk_fma_f32 v[198:199], v[148:149], v[80:81], v[198:199]
    v_pk_fma_f32 v[198:199], v[150:151], v[82:83], v[198:199]
    buffer_load_dwordx4 v[80:83], v1, s[24:27], s71 offen offset:256 nt
    v_add_f32_dpp v230, v229, v229 row_shl:4 row_mask:0xf bank_mask:0x5
    v_lshlrev_b32 v234, 16, v176
    v_and_b32 v235, 0xffff0000, v176
    v_pk_fma_f32 v[200:201], v[124:125], v[234:235], v[200:201]
    v_lshlrev_b32 v234, 16, v171
    v_and_b32 v235, 0xffff0000, v171
    s_waitcnt vmcnt(31)
    v_pk_fma_f32 v[198:199], v[152:153], v[84:85], v[198:199]
    v_pk_fma_f32 v[198:199], v[154:155], v[86:87], v[198:199]
    ds_add_u32 v224, v243 offset:3328
    buffer_load_dwordx4 v[84:87], v1, s[24:27], s71 offen offset:512 nt
    v_add_f32 v228, v198, v199
    v_pk_mul_f32 v[126:127], v[234:235], v[114:115]
    v_lshlrev_b32 v234, 16, v177
    v_and_b32 v235, 0xffff0000, v177
    v_pk_fma_f32 v[200:201], v[126:127], v[234:235], v[200:201]
    v_lshlrev_b32 v234, 16, v172
    s_waitcnt vmcnt(31)
    v_pk_fma_f32 v[198:199], v[144:145], v[88:89], v[202:203]
    v_pk_fma_f32 v[198:199], v[146:147], v[90:91], v[198:199]
    s_add_u32 s71, s71, 3072
    s_cbranch_vccnz L_th45_1
L_tb45_1:
    buffer_load_dwordx4 v[88:91], v1, s[24:27], s71 offen offset:0 nt
    v_add_f32_dpp v229, v228, v228 row_ror:8 row_mask:0xf bank_mask:0x3
    v_and_b32 v235, 0xffff0000, v172
    v_pk_mul_f32 v[128:129], v[234:235], v[116:117]
    v_lshlrev_b32 v234, 16, v178
    v_and_b32 v235, 0xffff0000, v178
    v_pk_fma_f32 v[200:201], v[128:129], v[234:235], v[200:201]
    s_waitcnt vmcnt(31)
    v_pk_fma_f32 v[198:199], v[148:149], v[92:93], v[198:199]
    v_pk_fma_f32 v[198:199], v[150:151], v[94:95], v[198:199]
    buffer_load_dwordx4 v[92:95], v1, s[24:27], s71 offen offset:256 nt
    v_lshlrev_b32 v234, 16, v173
    v_and_b32 v235, 0xffff0000, v173
    v_pk_mul_f32 v[130:131], v[234:235], v[118:119]
    v_lshlrev_b32 v234, 16, v179
    v_and_b32 v235, 0xffff0000, v179
    s_waitcnt vmcnt(31)
    v_pk_fma_f32 v[198:199], v[152:153], v[96:97], v[198:199]
    v_pk_fma_f32 v[198:199], v[154:155], v[98:99], v[198:199]
    ds_add_u32 v224, v243 offset:3328
    buffer_load_dwordx4 v[96:99], v1, s[24:27], s71 offen offset:512 nt
    v_add_f32 v228, v198, v199
    v_pk_fma_f32 v[200:201], v[130:131], v[234:235], v[200:201]
    v_pk_mul_f32 v[200:201], v[200:201], s[62:63]
    s_waitcnt vmcnt(31)
    v_pk_fma_f32 v[198:199], v[120:121], v[4:5], v[200:201]
    v_pk_fma_f32 v[198:199], v[122:123], v[6:7], v[198:199]
    ds_read_b32 v244, v243 offset:147
    s_mul_i32 s71, s70, 49152
    s_and_b32 s80, s70, 31
    s_mul_i32 s80, s80, 36864
    s_sub_u32 s71, s71, s80
    s_cbranch_vccnz L_th0_1
L_tb0_1:
    buffer_load_dwordx4 v[4:7], v1, s[28:31], s71 offen offset:0 nt
    v_add_f32_dpp v229, v228, v228 row_ror:8 row_mask:0xf bank_mask:0xc
    s_waitcnt vmcnt(31)
    v_pk_fma_f32 v[198:199], v[124:125], v[8:9], v[198:199]
    v_pk_fma_f32 v[198:199], v[126:127], v[10:11], v[198:199]
    buffer_load_dwordx4 v[8:11], v1, s[28:31], s71 offen offset:256 nt
    v_add_f32_dpp v230, v229, v229 row_shr:4 row_mask:0xf bank_mask:0xa
    s_waitcnt vmcnt(31)
    v_pk_fma_f32 v[198:199], v[128:129], v[12:13], v[198:199]
    v_pk_fma_f32 v[198:199], v[130:131], v[14:15], v[198:199]
    s_waitcnt lgkmcnt(0)
    v_cmp_lt_u32 vcc, v0, v244
    ds_add_u32 v224, v243 offset:3328
    buffer_load_dwordx4 v[12:15], v1, s[28:31], s71 offen offset:512 nt
    v_add_f32_dpp v232, v230, v230 quad_perm:[2,3,0,1] row_mask:0xf bank_mask:0xf
    v_add_f32 v228, v198, v199
    s_waitcnt vmcnt(31)
    v_pk_fma_f32 v[198:199], v[120:121], v[16:17], v[200:201]
    v_pk_fma_f32 v[198:199], v[122:123], v[18:19], v[198:199]
    s_add_u32 s71, s71, 3072
    s_cbranch_vccnz L_th3_1
L_tb3_1:
    buffer_load_dwordx4 v[16:19], v1, s[28:31], s71 offen offset:0 nt
    v_cndmask_b32 v232, v231, v232, s[64:65]
    v_add_f32_dpp v229, v228, v228 row_ror:8 row_mask:0xf bank_mask:0x3
    s_waitcnt vmcnt(25)
    v_pk_fma_f32 v[198:199], v[124:125], v[20:21], v[198:199]
    v_pk_fma_f32 v[198:199], v[126:127], v[22:23], v[198:199]
    buffer_load_dwordx4 v[20:23], v1, s[28:31], s71 offen offset:256 nt
    v_add_f32_dpp v233, v232, v232 quad_perm:[1,0,3,2] row_mask:0xf bank_mask:0xf
    v_lshlrev_b32 v234, 16, v180
    v_and_b32 v235, 0xffff0000, v180
    v_pk_mul_f32 v[144:145], v[234:235], v[108:109]
    v_lshlrev_b32 v234, 16, v186
    v_and_b32 v235, 0xffff0000, v186
    s_waitcnt vmcnt(25)
    v_pk_fma_f32 v[198:199], v[128:129], v[24:25], v[198:199]
    v_pk_fma_f32 v[198:199], v[130:131], v[26:27], v[198:199]
    ds_add_u32 v224, v243 offset:3328
    buffer_load_dwordx4 v[24:27], v1, s[28:31], s71 offen offset:512 nt
    v_add_f32 v228, v198, v199
    v_pk_mul_f32 v[202:203], v[144:145], v[234:235]
    v_lshlrev_b32 v234, 16, v181
    v_and_b32 v235, 0xffff0000, v181
    v_pk_mul_f32 v[146:147], v[234:235], v[110:111]
    v_lshlrev_b32 v234, 16, v187
    s_waitcnt vmcnt(25)
    v_pk_fma_f32 v[198:199], v[120:121], v[28:29], v[200:201]
    v_pk_fma_f32 v[198:199], v[122:123], v[30:31], v[198:199]
    s_add_u32 s71, s71, 3072
    s_cbranch_vccnz L_th6_1
L_tb6_1:
    buffer_load_dwordx4 v[28:31], v1, s[28:31], s71 offen offset:0 nt
    v_add_f32_dpp v229, v228, v228 row_ror:8 row_mask:0xf bank_mask:0xc
    v_and_b32 v235, 0xffff0000, v187
    v_pk_fma_f32 v[202:203], v[146:147], v[234:235], v[202:203]
    v_lshlrev_b32 v234, 16, v182
    v_and_b32 v235, 0xffff0000, v182
    v_pk_mul_f32 v[148:149], v[234:235], v[112:113]
    s_waitcnt vmcnt(25)
    v_pk_fma_f32 v[198:199], v[124:125], v[32:33], v[198:199]
    v_pk_fma_f32 v[198:199], v[126:127], v[34:35], v[198:199]
    buffer_load_dwordx4 v[32:35], v1, s[28:31], s71 offen offset:256 nt
    v_add_f32_dpp v230, v229, v229 row_shl:4 row_mask:0xf bank_mask:0x5
    v_lshlrev_b32 v234, 16, v188
    v_and_b32 v235, 0xffff0000, v188
    v_pk_fma_f32 v[202:203], v[148:149], v[234:235], v[202:203]
    v_lshlrev_b32 v234, 16, v183
    v_and_b32 v235, 0xffff0000, v183
    s_waitcnt vmcnt(25)
    v_pk_fma_f32 v[198:199], v[128:129], v[36:37], v[198:199]
    v_pk_fma_f32 v[198:199], v[130:131], v[38:39], v[198:199]
    ds_add_u32 v224, v243 offset:3328
    buffer_load_dwordx4 v[36:39], v1, s[28:31], s71 offen offset:512 nt
    v_add_f32 v228, v198, v199
    v_pk_mul_f32 v[150:151], v[234:235], v[114:115]
    v_lshlrev_b32 v234, 16, v189
    v_and_b32 v235, 0xffff0000, v189
    v_pk_fma_f32 v[202:203], v[150:151], v[234:235], v[202:203]
    v_lshlrev_b32 v234, 16, v184
    s_waitcnt vmcnt(25)
    v_pk_fma_f32 v[198:199], v[120:121], v[40:41], v[200:201]
    v_pk_fma_f32 v[198:199], v[122:123], v[42:43], v[198:199]
    s_add_u32 s71, s71, 3072
    s_cbranch_vccnz L_th9_1
L_tb9_1:
    buffer_load_dwordx4 v[40:43], v1, s[28:31], s71 offen offset:0 nt
    v_add_f32_dpp v229, v228, v228 row_ror:8 row_mask:0xf bank_mask:0x3
    v_and_b32 v235, 0xffff0000, v184
    v_pk_mul_f32 v[152:153], v[234:235], v[116:117]
    v_lshlrev_b32 v234, 16, v190
    v_and_b32 v235, 0xffff0000, v190
    v_pk_fma_f32 v[202:203], v[152:153], v[234:235], v[202:203]
    s_waitcnt vmcnt(25)
    v_pk_fma_f32 v[198:199], v[124:125], v[44:45], v[198:199]
    v_pk_fma_f32 v[198:199], v[126:127], v[46:47], v[198:199]
    buffer_load_dwordx4 v[44:47], v1, s[28:31], s71 offen offset:256 nt
    v_lshlrev_b32 v234, 16, v185
    v_and_b32 v235, 0xffff0000, v185
    v_pk_mul_f32 v[154:155], v[234:235], v[118:119]
    v_lshlrev_b32 v234, 16, v191
    v_and_b32 v235, 0xffff0000, v191
    s_waitcnt vmcnt(25)
    v_pk_fma_f32 v[198:199], v[128:129], v[48:49], v[198:199]
    v_pk_fma_f32 v[198:199], v[130:131], v[50:51], v[198:199]
    ds_add_u32 v224, v243 offset:3328
    buffer_load_dwordx4 v[48:51], v1, s[28:31], s71 offen offset:512 nt
    v_add_f32 v228, v198, v199
    v_pk_fma_f32 v[202:203], v[154:155], v[234:235], v[202:203]
    v_pk_mul_f32 v[202:203], v[202:203], s[62:63]
    s_waitcnt vmcnt(23)
    v_pk_fma_f32 v[198:199], v[144:145], v[52:53], v[202:203]
    v_pk_fma_f32 v[198:199], v[146:147], v[54:55], v[198:199]
    ds_read_b32 v244, v243 offset:147
    s_add_u32 s71, s71, 384000
    s_cbranch_vccnz L_th12_1
L_tb12_1:
    buffer_load_dwordx4 v[52:55], v1, s[28:31], s71 offen offset:0 nt
    v_add_f32_dpp v229, v228, v228 row_ror:8 row_mask:0xf bank_mask:0xc
    s_waitcnt vmcnt(23)
    v_pk_fma_f32 v[198:199], v[148:149], v[56:57], v[198:199]
    v_pk_fma_f32 v[198:199], v[150:151], v[58:59], v[198:199]
    buffer_load_dwordx4 v[56:59], v1, s[28:31], s71 offen offset:256 nt
    v_add_f32_dpp v230, v229, v229 row_shr:4 row_mask:0xf bank_mask:0xa
    s_waitcnt vmcnt(23)
    v_pk_fma_f32 v[198:199], v[152:153], v[60:61], v[198:199]
    v_pk_fma_f32 v[198:199], v[154:155], v[62:63], v[198:199]
    s_waitcnt lgkmcnt(0)
    v_cmp_lt_u32 vcc, v0, v244
    ds_add_u32 v224, v243 offset:3328
    buffer_load_dwordx4 v[60:63], v1, s[28:31], s71 offen offset:512 nt
    v_add_f32_dpp v231, v230, v230 quad_perm:[2,3,0,1] row_mask:0xf bank_mask:0xf
    v_add_f32 v228, v198, v199
    s_waitcnt vmcnt(23)
    v_pk_fma_f32 v[198:199], v[144:145], v[64:65], v[202:203]
    v_pk_fma_f32 v[198:199], v[146:147], v[66:67], v[198:199]
    s_add_u32 s71, s71, 3072
    s_cbranch_vccnz L_th15_1
L_tb15_1:
    buffer_load_dwordx4 v[64:67], v1, s[28:31], s71 offen offset:0 nt
    v_add_f32_dpp v229, v228, v228 row_ror:8 row_mask:0xf bank_mask:0x3
    s_waitcnt vmcnt(23)
    v_pk_fma_f32 v[198:199], v[148:149], v[68:69], v[198:199]
    v_pk_fma_f32 v[198:199], v[150:151], v[70:71], v[198:199]
    buffer_load_dwordx4 v[68:71], v1, s[28:31], s71 offen offset:256 nt
    s_waitcnt vmcnt(23)
    v_pk_fma_f32 v[198:199], v[152:153], v[72:73], v[198:199]
    v_pk_fma_f32 v[198:199], v[154:155], v[74:75], v[198:199]
    ds_add_u32 v224, v243 offset:3328
    buffer_load_dwordx4 v[72:75], v1, s[28:31], s71 offen offset:512 nt
    v_add_f32 v228, v198, v199
    s_waitcnt vmcnt(23)
    v_pk_fma_f32 v[198:199], v[144:145], v[76:77], v[202:203]
    v_pk_fma_f32 v[198:199], v[146:147], v[78:79], v[198:199]
    s_add_u32 s71, s71, 3072
    s_cbranch_vccnz L_th18_1
L_tb18_1:
    buffer_load_dwordx4 v[76:79], v1, s[28:31], s71 offen offset:0 nt
    v_add_f32_dpp v229, v228, v228 row_ror:8 row_mask:0xf bank_mask:0xc
    s_waitcnt vmcnt(23)
    v_pk_fma_f32 v[198:199], v[148:149], v[80:81], v[198:199]
    v_pk_fma_f32 v[198:199], v[150:151], v[82:83], v[198:199]
    buffer_load_dwordx4 v[80:83], v1, s[28:31], s71 offen offset:256 nt
    v_add_f32_dpp v230, v229, v229 row_shl:4 row_mask:0xf bank_mask:0x5
    s_waitcnt vmcnt(23)
    v_pk_fma_f32 v[198:199], v[152:153], v[84:85], v[198:199]
    v_pk_fma_f32 v[198:199], v[154:155], v[86:87], v[198:199]
    ds_add_u32 v224, v243 offset:3328
    buffer_load_dwordx4 v[84:87], v1, s[28:31], s71 offen offset:512 nt
    v_add_f32 v228, v198, v199
    s_waitcnt vmcnt(23)
    v_pk_fma_f32 v[198:199], v[144:145], v[88:89], v[202:203]
    v_pk_fma_f32 v[198:199], v[146:147], v[90:91], v[198:199]
    s_add_u32 s71, s71, 3072
    s_cbranch_vccnz L_th21_1
L_tb21_1:
    buffer_load_dwordx4 v[88:91], v1, s[28:31], s71 offen offset:0 nt
    v_add_f32_dpp v229, v228, v228 row_ror:8 row_mask:0xf bank_mask:0x3
    s_branch L_x1
L_w1:
    s_branch L_w2
L_x1:
    s_waitcnt vmcnt(23)
    v_pk_fma_f32 v[198:199], v[148:149], v[92:93], v[198:199]
    v_pk_fma_f32 v[198:199], v[150:151], v[94:95], v[198:199]
    buffer_load_dwordx4 v[92:95], v1, s[28:31], s71 offen offset:256 nt
    s_waitcnt vmcnt(23)
    v_pk_fma_f32 v[198:199], v[152:153], v[96:97], v[198:199]
    v_pk_fma_f32 v[198:199], v[154:155], v[98:99], v[198:199]
    ds_add_u32 v224, v243 offset:3328
    buffer_load_dwordx4 v[96:99], v1, s[28:31], s71 offen offset:512 nt
    v_add_f32 v228, v198, v199
    s_nop 1
    v_add_f32_dpp v229, v228, v228 row_ror:8 row_mask:0xf bank_mask:0xc
    s_nop 1
    v_add_f32_dpp v230, v229, v229 row_shr:4 row_mask:0xf bank_mask:0xa
    s_nop 1
    v_add_f32_dpp v232, v230, v230 quad_perm:[2,3,0,1] row_mask:0xf bank_mask:0xf
    s_nop 1
    v_cndmask_b32 v232, v231, v232, s[64:65]
    s_nop 1
    v_add_f32_dpp v231, v232, v232 quad_perm:[1,0,3,2] row_mask:0xf bank_mask:0xf
    s_nop 1
    v_cndmask_b32 v233, v233, v231, s[66:67]
    v_mul_f32 v233, 0x58000000, v233
    ds_write_b32 v239, v233
    v_add_u32 v239, 256, v239
    s_mov_b64 exec, 1
    ds_add_u32 v243, v243 offset:127
    s_mov_b64 exec, -1
    ds_read_b32 v223, v240
    v_add_u32 v240, 256, v240
    v_lshlrev_b32 v220, 16, v220
    v_lshlrev_b32 v221, 16, v221
    s_waitcnt lgkmcnt(0)
    v_max_f32_dpp v234, v223, v223 row_ror:8 row_mask:0xf bank_mask:0xf
    s_nop 1
    v_max_f32_dpp v234, v234, v234 row_ror:4 row_mask:0xf bank_mask:0xf
    s_nop 1
    v_max_f32_dpp v234, v234, v234 row_ror:2 row_mask:0xf bank_mask:0xf
    s_nop 1
    v_max_f32_dpp v234, v234, v234 row_ror:1 row_mask:0xf bank_mask:0xf
    v_mov_b32 v228, v216
    v_max3_f32 v234, v234, v228, s77
    v_sub_f32 v235, v228, v234
    v_sub_f32 v229, v223, v234
    v_exp_f32 v235, v235
    v_exp_f32 v229, v229
    s_nop 0
    v_mul_f32 v222, v229, v220
    v_mul_f32 v230, v222, v221
    v_mul_f32 v238, 0x71800000, v222
    s_nop 0
    s_mov_b32 s76, 63
L_loop1:
    v_mov_b32_dpp v236, v238 row_newbcast:0 row_mask:0xf bank_mask:0xf
    s_waitcnt vmcnt(23)
    v_pk_fma_f32 v[204:205], v[236:237], v[4:5], v[204:205] op_sel_hi:[0,1,1]
    v_pk_fma_f32 v[206:207], v[236:237], v[6:7], v[206:207] op_sel_hi:[0,1,1]
    s_nop 1
    ds_read_b32 v244, v243 offset:147
    s_add_u32 s71, s71, 384000
    s_cbranch_vccnz L_th24_2
L_tb24_2:
    buffer_load_dwordx4 v[4:7], v1, s[28:31], s71 offen offset:0 nt
    s_bitcmp0_b32 s4, 0
    s_cbranch_scc1 L_nofl2
    s_mov_b64 exec, 1
    ds_add_u32 v242, v243
    s_mov_b64 exec, -1
    v_add_u32 v241, 4096, v241
    v_add_u32 v242, 4, v242
L_nofl2:
    s_waitcnt vmcnt(23)
    v_pk_fma_f32 v[208:209], v[236:237], v[8:9], v[208:209] op_sel_hi:[0,1,1]
    v_pk_fma_f32 v[210:211], v[236:237], v[10:11], v[210:211] op_sel_hi:[0,1,1]
    s_nop 1
    buffer_load_dwordx4 v[8:11], v1, s[28:31], s71 offen offset:256 nt
    v_pk_mul_f32 v[212:213], v[212:213], v[234:235] op_sel:[0,1] op_sel_hi:[1,1]
    v_pk_mul_f32 v[214:215], v[214:215], v[234:235] op_sel:[0,1] op_sel_hi:[1,1]
    v_mov_b32 v216, v234
    s_waitcnt vmcnt(23)
    v_pk_fma_f32 v[212:213], v[236:237], v[12:13], v[212:213] op_sel_hi:[0,1,1]
    v_pk_fma_f32 v[214:215], v[236:237], v[14:15], v[214:215] op_sel_hi:[0,1,1]
    s_nop 1
    s_waitcnt lgkmcnt(0)
    v_cmp_lt_u32 vcc, v0, v244
    ds_add_u32 v224, v243 offset:3328
    buffer_load_dwordx4 v[12:15], v1, s[28:31], s71 offen offset:512 nt
    v_fma_f32 v217, v217, v235, v229
    v_mov_b32_dpp v236, v238 row_newbcast:8 row_mask:0xf bank_mask:0xf
    s_waitcnt vmcnt(23)
    v_pk_fma_f32 v[204:205], v[236:237], v[16:17], v[204:205] op_sel_hi:[0,1,1]
    v_pk_fma_f32 v[206:207], v[236:237], v[18:19], v[206:207] op_sel_hi:[0,1,1]
    s_nop 1
    s_add_u32 s71, s71, 3072
    s_cbranch_vccnz L_th27_2
L_tb27_2:
    buffer_load_dwordx4 v[16:19], v1, s[28:31], s71 offen offset:0 nt
    v_fma_f32 v218, v218, v235, v230
    s_waitcnt vmcnt(23)
    v_pk_fma_f32 v[208:209], v[236:237], v[20:21], v[208:209] op_sel_hi:[0,1,1]
    v_pk_fma_f32 v[210:211], v[236:237], v[22:23], v[210:211] op_sel_hi:[0,1,1]
    s_nop 1
    buffer_load_dwordx4 v[20:23], v1, s[28:31], s71 offen offset:256 nt
    ds_read_b32 v223, v240
    v_add_u32 v240, 256, v240
    s_waitcnt vmcnt(23)
    v_pk_fma_f32 v[212:213], v[236:237], v[24:25], v[212:213] op_sel_hi:[0,1,1]
    v_pk_fma_f32 v[214:215], v[236:237], v[26:27], v[214:215] op_sel_hi:[0,1,1]
    s_nop 1
    ds_add_u32 v224, v243 offset:3328
    buffer_load_dwordx4 v[24:27], v1, s[28:31], s71 offen offset:512 nt
    v_mov_b32_dpp v236, v238 row_newbcast:4 row_mask:0xf bank_mask:0xf
    s_waitcnt vmcnt(23)
    v_pk_fma_f32 v[204:205], v[236:237], v[28:29], v[204:205] op_sel_hi:[0,1,1]
    v_pk_fma_f32 v[206:207], v[236:237], v[30:31], v[206:207] op_sel_hi:[0,1,1]
    s_nop 1
    s_add_u32 s71, s71, 3072
    s_cbranch_vccnz L_th30_2
L_tb30_2:
    buffer_load_dwordx4 v[28:31], v1, s[28:31], s71 offen offset:0 nt
    ds_write_b128 v241, v[216:219] offset:23552
    s_waitcnt vmcnt(23)
    v_pk_fma_f32 v[208:209], v[236:237], v[32:33], v[208:209] op_sel_hi:[0,1,1]
    v_pk_fma_f32 v[210:211], v[236:237], v[34:35], v[210:211] op_sel_hi:[0,1,1]
    s_nop 1
    buffer_load_dwordx4 v[32:35], v1, s[28:31], s71 offen offset:256 nt
    s_waitcnt vmcnt(23)
    v_pk_fma_f32 v[212:213], v[236:237], v[36:37], v[212:213] op_sel_hi:[0,1,1]
    v_pk_fma_f32 v[214:215], v[236:237], v[38:39], v[214:215] op_sel_hi:[0,1,1]
    s_nop 1
    ds_add_u32 v224, v243 offset:3328
    buffer_load_dwordx4 v[36:39], v1, s[28:31], s71 offen offset:512 nt
    v_mov_b32_dpp v236, v238 row_newbcast:12 row_mask:0xf bank_mask:0xf
    s_waitcnt vmcnt(23)
    v_pk_fma_f32 v[204:205], v[236:237], v[40:41], v[204:205] op_sel_hi:[0,1,1]
    v_pk_fma_f32 v[206:207], v[236:237], v[42:43], v[206:207] op_sel_hi:[0,1,1]
    s_nop 1
    s_add_u32 s71, s71, 3072
    s_cbranch_vccnz L_th33_2
L_tb33_2:
    buffer_load_dwordx4 v[40:43], v1, s[28:31], s71 offen offset:0 nt
    s_waitcnt vmcnt(23)
    v_pk_fma_f32 v[208:209], v[236:237], v[44:45], v[208:209] op_sel_hi:[0,1,1]
    v_pk_fma_f32 v[210:211], v[236:237], v[46:47], v[210:211] op_sel_hi:[0,1,1]
    s_nop 1
    buffer_load_dwordx4 v[44:47], v1, s[28:31], s71 offen offset:256 nt
    s_waitcnt vmcnt(23)
    v_pk_fma_f32 v[212:213], v[236:237], v[48:49], v[212:213] op_sel_hi:[0,1,1]
    v_pk_fma_f32 v[214:215], v[236:237], v[50:51], v[214:215] op_sel_hi:[0,1,1]
    s_nop 1
    ds_add_u32 v224, v243 offset:3328
    buffer_load_dwordx4 v[48:51], v1, s[28:31], s71 offen offset:512 nt
    v_mov_b32_dpp v236, v238 row_newbcast:2 row_mask:0xf bank_mask:0xf
    s_waitcnt vmcnt(23)
    v_pk_fma_f32 v[204:205], v[236:237], v[52:53], v[204:205] op_sel_hi:[0,1,1]
    v_pk_fma_f32 v[206:207], v[236:237], v[54:55], v[206:207] op_sel_hi:[0,1,1]
    s_nop 1
    ds_read_b32 v244, v243 offset:147
    v_readlane_b32 s70, v245, s91
    s_add_u32 s91, s91, 1
    s_and_b32 s80, s70, 31
    s_mul_i32 s80, s80, 96
    s_lshl_b32 s73, s70, 7
    s_sub_u32 s73, s73, s80
    buffer_load_ushort v220, v3, s[40:43], s73 offen
    buffer_load_ushort v221, v3, s[44:47], s73 offen
    s_add_u32 s71, s71, 384000
    s_cbranch_vccnz L_th36_2
L_tb36_2:
    buffer_load_dwordx4 v[52:55], v1, s[28:31], s71 offen offset:0 nt
    s_waitcnt vmcnt(25)
    v_pk_fma_f32 v[208:209], v[236:237], v[56:57], v[208:209] op_sel_hi:[0,1,1]
    v_pk_fma_f32 v[210:211], v[236:237], v[58:59], v[210:211] op_sel_hi:[0,1,1]
    s_nop 1
    buffer_load_dwordx4 v[56:59], v1, s[28:31], s71 offen offset:256 nt
    s_waitcnt vmcnt(25)
    v_pk_fma_f32 v[212:213], v[236:237], v[60:61], v[212:213] op_sel_hi:[0,1,1]
    v_pk_fma_f32 v[214:215], v[236:237], v[62:63], v[214:215] op_sel_hi:[0,1,1]
    s_nop 1
    s_waitcnt lgkmcnt(0)
    v_cmp_lt_u32 vcc, v0, v244
    ds_add_u32 v224, v243 offset:3328
    buffer_load_dwordx4 v[60:63], v1, s[28:31], s71 offen offset:512 nt
    v_mov_b32_dpp v236, v238 row_newbcast:10 row_mask:0xf bank_mask:0xf
    s_waitcnt vmcnt(25)
    v_pk_fma_f32 v[204:205], v[236:237], v[64:65], v[204:205] op_sel_hi:[0,1,1]
    v_pk_fma_f32 v[206:207], v[236:237], v[66:67], v[206:207] op_sel_hi:[0,1,1]
    s_nop 1
    s_add_u32 s71, s71, 3072
    s_cbranch_vccnz L_th39_2
L_tb39_2:
    buffer_load_dwordx4 v[64:67], v1, s[28:31], s71 offen offset:0 nt
    s_waitcnt vmcnt(25)
    v_pk_fma_f32 v[208:209], v[236:237], v[68:69], v[208:209] op_sel_hi:[0,1,1]
    v_pk_fma_f32 v[210:211], v[236:237], v[70:71], v[210:211] op_sel_hi:[0,1,1]
    s_nop 1
    buffer_load_dwordx4 v[68:71], v1, s[28:31], s71 offen offset:256 nt
    s_waitcnt vmcnt(25)
    v_pk_fma_f32 v[212:213], v[236:237], v[72:73], v[212:213] op_sel_hi:[0,1,1]
    v_pk_fma_f32 v[214:215], v[236:237], v[74:75], v[214:215] op_sel_hi:[0,1,1]
    s_nop 1
    ds_add_u32 v224, v243 offset:3328
    buffer_load_dwordx4 v[72:75], v1, s[28:31], s71 offen offset:512 nt
    v_mov_b32_dpp v236, v238 row_newbcast:6 row_mask:0xf bank_mask:0xf
    s_waitcnt vmcnt(25)
    v_pk_fma_f32 v[204:205], v[236:237], v[76:77], v[204:205] op_sel_hi:[0,1,1]
    v_pk_fma_f32 v[206:207], v[236:237], v[78:79], v[206:207] op_sel_hi:[0,1,1]
    s_nop 1
    s_add_u32 s71, s71, 3072
    s_cbranch_vccnz L_th42_2
L_tb42_2:
    buffer_load_dwordx4 v[76:79], v1, s[28:31], s71 offen offset:0 nt
    s_waitcnt vmcnt(25)
    v_pk_fma_f32 v[208:209], v[236:237], v[80:81], v[208:209] op_sel_hi:[0,1,1]
    v_pk_fma_f32 v[210:211], v[236:237], v[82:83], v[210:211] op_sel_hi:[0,1,1]
    s_nop 1
    buffer_load_dwordx4 v[80:83], v1, s[28:31], s71 offen offset:256 nt
    s_waitcnt vmcnt(25)
    v_pk_fma_f32 v[212:213], v[236:237], v[84:85], v[212:213] op_sel_hi:[0,1,1]
    v_pk_fma_f32 v[214:215], v[236:237], v[86:87], v[214:215] op_sel_hi:[0,1,1]
    s_nop 1
    ds_add_u32 v224, v243 offset:3328
    buffer_load_dwordx4 v[84:87], v1, s[28:31], s71 offen offset:512 nt
    v_mov_b32_dpp v236, v238 row_newbcast:14 row_mask:0xf bank_mask:0xf
    s_waitcnt vmcnt(25)
    v_pk_fma_f32 v[204:205], v[236:237], v[88:89], v[204:205] op_sel_hi:[0,1,1]
    v_pk_fma_f32 v[206:207], v[236:237], v[90:91], v[206:207] op_sel_hi:[0,1,1]
    s_nop 1
    s_add_u32 s71, s71, 3072
    s_cbranch_vccnz L_th45_2
L_tb45_2:
    buffer_load_dwordx4 v[88:91], v1, s[28:31], s71 offen offset:0 nt
    s_waitcnt vmcnt(25)
    v_pk_fma_f32 v[208:209], v[236:237], v[92:93], v[208:209] op_sel_hi:[0,1,1]
    v_pk_fma_f32 v[210:211], v[236:237], v[94:95], v[210:211] op_sel_hi:[0,1,1]
    s_nop 1
    buffer_load_dwordx4 v[92:95], v1, s[28:31], s71 offen offset:256 nt
    s_cmp_eq_u32 s76, 16
    s_cbranch_scc1 L_getm2
L_gotm2:
    s_waitcnt vmcnt(25)
    v_pk_fma_f32 v[212:213], v[236:237], v[96:97], v[212:213] op_sel_hi:[0,1,1]
    v_pk_fma_f32 v[214:215], v[236:237], v[98:99], v[214:215] op_sel_hi:[0,1,1]
    s_nop 1
    ds_add_u32 v224, v243 offset:3328
    buffer_load_dwordx4 v[96:99], v1, s[28:31], s71 offen offset:512 nt
    v_mov_b32_dpp v236, v238 row_newbcast:1 row_mask:0xf bank_mask:0xf
    s_waitcnt vmcnt(25)
    v_pk_fma_f32 v[204:205], v[236:237], v[4:5], v[204:205] op_sel_hi:[0,1,1]
    v_pk_fma_f32 v[206:207], v[236:237], v[6:7], v[206:207] op_sel_hi:[0,1,1]
    s_nop 1
    ds_read_b32 v244, v243 offset:147
    s_mul_i32 s71, s70, 49152
    s_and_b32 s80, s70, 31
    s_mul_i32 s80, s80, 36864
    s_sub_u32 s71, s71, s80
    s_cbranch_vccnz L_th0_2
L_tb0_2:
    buffer_load_dwordx4 v[4:7], v1, s[28:31], s71 offen offset:0 nt
    s_waitcnt vmcnt(25)
    v_pk_fma_f32 v[208:209], v[236:237], v[8:9], v[208:209] op_sel_hi:[0,1,1]
    v_pk_fma_f32 v[210:211], v[236:237], v[10:11], v[210:211] op_sel_hi:[0,1,1]
    s_nop 1
    buffer_load_dwordx4 v[8:11], v1, s[28:31], s71 offen offset:256 nt
    s_waitcnt vmcnt(25)
    v_pk_fma_f32 v[212:213], v[236:237], v[12:13], v[212:213] op_sel_hi:[0,1,1]
    v_pk_fma_f32 v[214:215], v[236:237], v[14:15], v[214:215] op_sel_hi:[0,1,1]
    s_nop 1
    s_waitcnt lgkmcnt(0)
    v_cmp_lt_u32 vcc, v0, v244
    ds_add_u32 v224, v243 offset:3328
    buffer_load_dwordx4 v[12:15], v1, s[28:31], s71 offen offset:512 nt
    v_max_f32_dpp v234, v223, v223 row_ror:8 row_mask:0xf bank_mask:0xf
    v_mov_b32_dpp v236, v238 row_newbcast:9 row_mask:0xf bank_mask:0xf
    s_waitcnt vmcnt(25)
    v_pk_fma_f32 v[204:205], v[236:237], v[16:17], v[204:205] op_sel_hi:[0,1,1]
    v_pk_fma_f32 v[206:207], v[236:237], v[18:19], v[206:207] op_sel_hi:[0,1,1]
    s_nop 1
    s_add_u32 s71, s71, 3072
    s_cbranch_vccnz L_th3_2
L_tb3_2:
    buffer_load_dwordx4 v[16:19], v1, s[28:31], s71 offen offset:0 nt
    v_max_f32_dpp v234, v234, v234 row_ror:4 row_mask:0xf bank_mask:0xf
    s_waitcnt vmcnt(25)
    v_pk_fma_f32 v[208:209], v[236:237], v[20:21], v[208:209] op_sel_hi:[0,1,1]
    v_pk_fma_f32 v[210:211], v[236:237], v[22:23], v[210:211] op_sel_hi:[0,1,1]
    s_nop 1
    buffer_load_dwordx4 v[20:23], v1, s[28:31], s71 offen offset:256 nt
    v_max_f32_dpp v234, v234, v234 row_ror:2 row_mask:0xf bank_mask:0xf
    s_waitcnt vmcnt(25)
    v_pk_fma_f32 v[212:213], v[236:237], v[24:25], v[212:213] op_sel_hi:[0,1,1]
    v_pk_fma_f32 v[214:215], v[236:237], v[26:27], v[214:215] op_sel_hi:[0,1,1]
    s_nop 1
    ds_add_u32 v224, v243 offset:3328
    buffer_load_dwordx4 v[24:27], v1, s[28:31], s71 offen offset:512 nt
    v_max_f32_dpp v234, v234, v234 row_ror:1 row_mask:0xf bank_mask:0xf
    v_mov_b32_dpp v236, v238 row_newbcast:5 row_mask:0xf bank_mask:0xf
    s_waitcnt vmcnt(25)
    v_pk_fma_f32 v[204:205], v[236:237], v[28:29], v[204:205] op_sel_hi:[0,1,1]
    v_pk_fma_f32 v[206:207], v[236:237], v[30:31], v[206:207] op_sel_hi:[0,1,1]
    s_nop 1
    s_add_u32 s71, s71, 3072
    s_cbranch_vccnz L_th6_2
L_tb6_2:
    buffer_load_dwordx4 v[28:31], v1, s[28:31], s71 offen offset:0 nt
    s_lshr_b64 s[4:5], s[4:5], 1
    s_bitcmp1_b32 s4, 0
    s_cselect_b32 s6, s7, 0x7f7fffff
    v_min_f32 v228, s6, v216
    s_waitcnt vmcnt(25)
    v_pk_fma_f32 v[208:209], v[236:237], v[32:33], v[208:209] op_sel_hi:[0,1,1]
    v_pk_fma_f32 v[210:211], v[236:237], v[34:35], v[210:211] op_sel_hi:[0,1,1]
    s_nop 1
    buffer_load_dwordx4 v[32:35], v1, s[28:31], s71 offen offset:256 nt
    v_max3_f32 v234, v234, v228, s77
    s_waitcnt vmcnt(25)
    v_pk_fma_f32 v[212:213], v[236:237], v[36:37], v[212:213] op_sel_hi:[0,1,1]
    v_pk_fma_f32 v[214:215], v[236:237], v[38:39], v[214:215] op_sel_hi:[0,1,1]
    s_nop 1
    ds_add_u32 v224, v243 offset:3328
    buffer_load_dwordx4 v[36:39], v1, s[28:31], s71 offen offset:512 nt
    v_sub_f32 v235, v228, v234
    v_sub_f32 v229, v223, v234
    v_mov_b32_dpp v236, v238 row_newbcast:13 row_mask:0xf bank_mask:0xf
    s_waitcnt vmcnt(25)
    v_pk_fma_f32 v[204:205], v[236:237], v[40:41], v[204:205] op_sel_hi:[0,1,1]
    v_pk_fma_f32 v[206:207], v[236:237], v[42:43], v[206:207] op_sel_hi:[0,1,1]
    s_nop 1
    s_add_u32 s71, s71, 3072
    s_cbranch_vccnz L_th9_2
L_tb9_2:
    buffer_load_dwordx4 v[40:43], v1, s[28:31], s71 offen offset:0 nt
    v_exp_f32 v235, v235
    s_waitcnt vmcnt(25)
    v_pk_fma_f32 v[208:209], v[236:237], v[44:45], v[208:209] op_sel_hi:[0,1,1]
    v_pk_fma_f32 v[210:211], v[236:237], v[46:47], v[210:211] op_sel_hi:[0,1,1]
    s_nop 1
    buffer_load_dwordx4 v[44:47], v1, s[28:31], s71 offen offset:256 nt
    v_exp_f32 v229, v229
    s_waitcnt vmcnt(25)
    v_pk_fma_f32 v[212:213], v[236:237], v[48:49], v[212:213] op_sel_hi:[0,1,1]
    v_pk_fma_f32 v[214:215], v[236:237], v[50:51], v[214:215] op_sel_hi:[0,1,1]
    s_nop 1
    ds_add_u32 v224, v243 offset:3328
    buffer_load_dwordx4 v[48:51], v1, s[28:31], s71 offen offset:512 nt
    v_mov_b32_dpp v236, v238 row_newbcast:3 row_mask:0xf bank_mask:0xf
    s_waitcnt vmcnt(23)
    v_pk_fma_f32 v[204:205], v[236:237], v[52:53], v[204:205] op_sel_hi:[0,1,1]
    v_pk_fma_f32 v[206:207], v[236:237], v[54:55], v[206:207] op_sel_hi:[0,1,1]
    s_nop 1
    ds_read_b32 v244, v243 offset:147
    s_add_u32 s71, s71, 384000
    s_cbranch_vccnz L_th12_2
L_tb12_2:
    buffer_load_dwordx4 v[52:55], v1, s[28:31], s71 offen offset:0 nt
    v_lshlrev_b32 v220, 16, v220
    s_waitcnt vmcnt(23)
    v_pk_fma_f32 v[208:209], v[236:237], v[56:57], v[208:209] op_sel_hi:[0,1,1]
    v_pk_fma_f32 v[210:211], v[236:237], v[58:59], v[210:211] op_sel_hi:[0,1,1]
    s_nop 1
    buffer_load_dwordx4 v[56:59], v1, s[28:31], s71 offen offset:256 nt
    v_lshlrev_b32 v221, 16, v221
    s_waitcnt vmcnt(23)
    v_pk_fma_f32 v[212:213], v[236:237], v[60:61], v[212:213] op_sel_hi:[0,1,1]
    v_pk_fma_f32 v[214:215], v[236:237], v[62:63], v[214:215] op_sel_hi:[0,1,1]
    s_nop 1
    s_waitcnt lgkmcnt(0)
    v_cmp_lt_u32 vcc, v0, v244
    ds_add_u32 v224, v243 offset:3328
    buffer_load_dwordx4 v[60:63], v1, s[28:31], s71 offen offset:512 nt
    v_mov_b32_dpp v236, v238 row_newbcast:11 row_mask:0xf bank_mask:0xf
    s_waitcnt vmcnt(23)
    v_pk_fma_f32 v[204:205], v[236:237], v[64:65], v[204:205] op_sel_hi:[0,1,1]
    v_pk_fma_f32 v[206:207], v[236:237], v[66:67], v[206:207] op_sel_hi:[0,1,1]
    s_nop 1
    s_add_u32 s71, s71, 3072
    s_cbranch_vccnz L_th15_2
L_tb15_2:
    buffer_load_dwordx4 v[64:67], v1, s[28:31], s71 offen offset:0 nt
    v_mul_f32 v222, v229, v220
    s_waitcnt vmcnt(23)
    v_pk_fma_f32 v[208:209], v[236:237], v[68:69], v[208:209] op_sel_hi:[0,1,1]
    v_pk_fma_f32 v[210:211], v[236:237], v[70:71], v[210:211] op_sel_hi:[0,1,1]
    s_nop 1
    buffer_load_dwordx4 v[68:71], v1, s[28:31], s71 offen offset:256 nt
    v_mul_f32 v230, v222, v221
    s_waitcnt vmcnt(23)
    v_pk_fma_f32 v[212:213], v[236:237], v[72:73], v[212:213] op_sel_hi:[0,1,1]
    v_pk_fma_f32 v[214:215], v[236:237], v[74:75], v[214:215] op_sel_hi:[0,1,1]
    s_nop 1
    ds_add_u32 v224, v243 offset:3328
    buffer_load_dwordx4 v[72:75], v1, s[28:31], s71 offen offset:512 nt
    v_mov_b32_dpp v236, v238 row_newbcast:7 row_mask:0xf bank_mask:0xf
    s_waitcnt vmcnt(23)
    v_pk_fma_f32 v[204:205], v[236:237], v[76:77], v[204:205] op_sel_hi:[0,1,1]
    v_pk_fma_f32 v[206:207], v[236:237], v[78:79], v[206:207] op_sel_hi:[0,1,1]
    s_nop 1
    s_add_u32 s71, s71, 3072
    s_cbranch_vccnz L_th18_2
L_tb18_2:
    buffer_load_dwordx4 v[76:79], v1, s[28:31], s71 offen offset:0 nt
    s_waitcnt vmcnt(23)
    v_pk_fma_f32 v[208:209], v[236:237], v[80:81], v[208:209] op_sel_hi:[0,1,1]
    v_pk_fma_f32 v[210:211], v[236:237], v[82:83], v[210:211] op_sel_hi:[0,1,1]
    s_nop 1
    buffer_load_dwordx4 v[80:83], v1, s[28:31], s71 offen offset:256 nt
    s_waitcnt vmcnt(23)
    v_pk_fma_f32 v[212:213], v[236:237], v[84:85], v[212:213] op_sel_hi:[0,1,1]
    v_pk_fma_f32 v[214:215], v[236:237], v[86:87], v[214:215] op_sel_hi:[0,1,1]
    s_nop 1
    ds_add_u32 v224, v243 offset:3328
    buffer_load_dwordx4 v[84:87], v1, s[28:31], s71 offen offset:512 nt
    v_mov_b32_dpp v236, v238 row_newbcast:15 row_mask:0xf bank_mask:0xf
    s_waitcnt vmcnt(23)
    v_pk_fma_f32 v[204:205], v[236:237], v[88:89], v[204:205] op_sel_hi:[0,1,1]
    v_pk_fma_f32 v[206:207], v[236:237], v[90:91], v[206:207] op_sel_hi:[0,1,1]
    s_nop 1
    s_add_u32 s71, s71, 3072
    s_cbranch_vccnz L_th21_2
L_tb21_2:
    buffer_load_dwordx4 v[88:91], v1, s[28:31], s71 offen offset:0 nt
    ds_write_b128 v241, v[204:207] offset:20480
    v_mul_f32 v238, 0x71800000, v222
    s_waitcnt vmcnt(23)
    v_pk_fma_f32 v[208:209], v[236:237], v[92:93], v[208:209] op_sel_hi:[0,1,1]
    v_pk_fma_f32 v[210:211], v[236:237], v[94:95], v[210:211] op_sel_hi:[0,1,1]
    s_nop 1
    buffer_load_dwordx4 v[92:95], v1, s[28:31], s71 offen offset:256 nt
    ds_write_b128 v241, v[208:211] offset:21504
    v_pk_mul_f32 v[204:205], v[204:205], v[234:235] op_sel:[0,1] op_sel_hi:[1,1]
    v_pk_mul_f32 v[206:207], v[206:207], v[234:235] op_sel:[0,1] op_sel_hi:[1,1]
    s_waitcnt vmcnt(23)
    v_pk_fma_f32 v[212:213], v[236:237], v[96:97], v[212:213] op_sel_hi:[0,1,1]
    v_pk_fma_f32 v[214:215], v[236:237], v[98:99], v[214:215] op_sel_hi:[0,1,1]
    s_nop 1
    ds_add_u32 v224, v243 offset:3328
    buffer_load_dwordx4 v[96:99], v1, s[28:31], s71 offen offset:512 nt
    ds_write_b128 v241, v[212:215] offset:22528
    v_pk_mul_f32 v[208:209], v[208:209], v[234:235] op_sel:[0,1] op_sel_hi:[1,1]
    v_pk_mul_f32 v[210:211], v[210:211], v[234:235] op_sel:[0,1] op_sel_hi:[1,1]
    s_sub_u32 s76, s76, 1
    s_cmp_lg_u32 s76, 0
    s_cbranch_scc1 L_loop1
    v_mov_b32_dpp v236, v238 row_newbcast:0 row_mask:0xf bank_mask:0xf
    s_waitcnt vmcnt(23)
    v_pk_fma_f32 v[204:205], v[236:237], v[4:5], v[204:205] op_sel_hi:[0,1,1]
    v_pk_fma_f32 v[206:207], v[236:237], v[6:7], v[206:207] op_sel_hi:[0,1,1]
    s_nop 1
    ds_read_b32 v244, v243 offset:147
    s_add_u32 s71, s71, 384000
    s_cbranch_vccnz L_th24_3
L_tb24_3:
    buffer_load_dwordx4 v[4:7], v1, s[28:31], s71 offen offset:0 nt
    s_bitcmp0_b32 s4, 0
    s_cbranch_scc1 L_nofl3
    s_mov_b64 exec, 1
    ds_add_u32 v242, v243
    s_mov_b64 exec, -1
    v_add_u32 v241, 4096, v241
    v_add_u32 v242, 4, v242
L_nofl3:
    s_waitcnt vmcnt(23)
    v_pk_fma_f32 v[208:209], v[236:237], v[8:9], v[208:209] op_sel_hi:[0,1,1]
    v_pk_fma_f32 v[210:211], v[236:237], v[10:11], v[210:211] op_sel_hi:[0,1,1]
    s_nop 1
    buffer_load_dwordx4 v[8:11], v1, s[28:31], s71 offen offset:256 nt
    v_pk_mul_f32 v[212:213], v[212:213], v[234:235] op_sel:[0,1] op_sel_hi:[1,1]
    v_pk_mul_f32 v[214:215], v[214:215], v[234:235] op_sel:[0,1] op_sel_hi:[1,1]
    v_mov_b32 v216, v234
    s_waitcnt vmcnt(23)
    v_pk_fma_f32 v[212:213], v[236:237], v[12:13], v[212:213] op_sel_hi:[0,1,1]
    v_pk_fma_f32 v[214:215], v[236:237], v[14:15], v[214:215] op_sel_hi:[0,1,1]
    s_nop 1
    s_waitcnt lgkmcnt(0)
    v_cmp_lt_u32 vcc, v0, v244
    ds_add_u32 v224, v243 offset:3328
    buffer_load_dwordx4 v[12:15], v1, s[28:31], s71 offen offset:512 nt
    v_fma_f32 v217, v217, v235, v229
    v_mov_b32_dpp v236, v238 row_newbcast:8 row_mask:0xf bank_mask:0xf
    s_waitcnt vmcnt(23)
    v_pk_fma_f32 v[204:205], v[236:237], v[16:17], v[204:205] op_sel_hi:[0,1,1]
    v_pk_fma_f32 v[206:207], v[236:237], v[18:19], v[206:207] op_sel_hi:[0,1,1]
    s_nop 1
    s_add_u32 s71, s71, 3072
    s_cbranch_vccnz L_th27_3
L_tb27_3:
    buffer_load_dwordx4 v[16:19], v1, s[28:31], s71 offen offset:0 nt
    v_fma_f32 v218, v218, v235, v230
    s_waitcnt vmcnt(23)
    v_pk_fma_f32 v[208:209], v[236:237], v[20:21], v[208:209] op_sel_hi:[0,1,1]
    v_pk_fma_f32 v[210:211], v[236:237], v[22:23], v[210:211] op_sel_hi:[0,1,1]
    s_nop 1
    buffer_load_dwordx4 v[20:23], v1, s[28:31], s71 offen offset:256 nt
    s_mov_b64 exec, s[88:89]
    buffer_store_dwordx4 v[100:103], v225, s[52:55], s78 offen offset:0
    s_mov_b64 exec, -1
    s_waitcnt vmcnt(23)
    v_pk_fma_f32 v[212:213], v[236:237], v[24:25], v[212:213] op_sel_hi:[0,1,1]
    v_pk_fma_f32 v[214:215], v[236:237], v[26:27], v[214:215] op_sel_hi:[0,1,1]
    s_nop 1
    ds_add_u32 v224, v243 offset:3328
    buffer_load_dwordx4 v[24:27], v1, s[28:31], s71 offen offset:512 nt
    v_add_f32_dpp v218, v218, v218 row_ror:8 row_mask:0xf bank_mask:0xf
    v_mov_b32_dpp v236, v238 row_newbcast:4 row_mask:0xf bank_mask:0xf
    s_waitcnt vmcnt(23)
    v_pk_fma_f32 v[204:205], v[236:237], v[28:29], v[204:205] op_sel_hi:[0,1,1]
    v_pk_fma_f32 v[206:207], v[236:237], v[30:31], v[206:207] op_sel_hi:[0,1,1]
    s_nop 1
    s_add_u32 s71, s71, 3072
    s_cbranch_vccnz L_th30_3
L_tb30_3:
    buffer_load_dwordx4 v[28:31], v1, s[28:31], s71 offen offset:0 nt
    v_add_f32_dpp v218, v218, v218 row_ror:4 row_mask:0xf bank_mask:0xf
    s_waitcnt vmcnt(23)
    v_pk_fma_f32 v[208:209], v[236:237], v[32:33], v[208:209] op_sel_hi:[0,1,1]
    v_pk_fma_f32 v[210:211], v[236:237], v[34:35], v[210:211] op_sel_hi:[0,1,1]
    s_nop 1
    buffer_load_dwordx4 v[32:35], v1, s[28:31], s71 offen offset:256 nt
    v_add_f32_dpp v218, v218, v218 row_ror:2 row_mask:0xf bank_mask:0xf
    s_waitcnt vmcnt(23)
    v_pk_fma_f32 v[212:213], v[236:237], v[36:37], v[212:213] op_sel_hi:[0,1,1]
    v_pk_fma_f32 v[214:215], v[236:237], v[38:39], v[214:215] op_sel_hi:[0,1,1]
    s_nop 1
    ds_add_u32 v224, v243 offset:3328
    buffer_load_dwordx4 v[36:39], v1, s[28:31], s71 offen offset:512 nt
    v_add_f32_dpp v218, v218, v218 row_ror:1 row_mask:0xf bank_mask:0xf
    v_mov_b32_dpp v236, v238 row_newbcast:12 row_mask:0xf bank_mask:0xf
    s_waitcnt vmcnt(23)
    v_pk_fma_f32 v[204:205], v[236:237], v[40:41], v[204:205] op_sel_hi:[0,1,1]
    v_pk_fma_f32 v[206:207], v[236:237], v[42:43], v[206:207] op_sel_hi:[0,1,1]
    s_nop 1
    s_add_u32 s71, s71, 3072
    s_cbranch_vccnz L_th33_3
L_tb33_3:
    buffer_load_dwordx4 v[40:43], v1, s[28:31], s71 offen offset:0 nt
    v_mov_b32 v234, v218
    s_waitcnt vmcnt(23)
    v_pk_fma_f32 v[208:209], v[236:237], v[44:45], v[208:209] op_sel_hi:[0,1,1]
    v_pk_fma_f32 v[210:211], v[236:237], v[46:47], v[210:211] op_sel_hi:[0,1,1]
    s_nop 1
    buffer_load_dwordx4 v[44:47], v1, s[28:31], s71 offen offset:256 nt
    v_permlane32_swap_b32 v218, v234
    s_waitcnt vmcnt(23)
    v_pk_fma_f32 v[212:213], v[236:237], v[48:49], v[212:213] op_sel_hi:[0,1,1]
    v_pk_fma_f32 v[214:215], v[236:237], v[50:51], v[214:215] op_sel_hi:[0,1,1]
    s_nop 1
    ds_add_u32 v224, v243 offset:3328
    buffer_load_dwordx4 v[48:51], v1, s[28:31], s71 offen offset:512 nt
    v_add_f32 v218, v218, v234
    v_mov_b32_dpp v236, v238 row_newbcast:2 row_mask:0xf bank_mask:0xf
    s_waitcnt vmcnt(23)
    v_pk_fma_f32 v[204:205], v[236:237], v[52:53], v[204:205] op_sel_hi:[0,1,1]
    v_pk_fma_f32 v[206:207], v[236:237], v[54:55], v[206:207] op_sel_hi:[0,1,1]
    s_nop 1
    ds_read_b32 v244, v243 offset:147
    s_add_u32 s71, s71, 384000
    s_cbranch_vccnz L_th36_3
L_tb36_3:
    buffer_load_dwordx4 v[52:55], v1, s[28:31], s71 offen offset:0 nt
    v_mov_b32 v234, v218
    s_waitcnt vmcnt(23)
    v_pk_fma_f32 v[208:209], v[236:237], v[56:57], v[208:209] op_sel_hi:[0,1,1]
    v_pk_fma_f32 v[210:211], v[236:237], v[58:59], v[210:211] op_sel_hi:[0,1,1]
    s_nop 1
    buffer_load_dwordx4 v[56:59], v1, s[28:31], s71 offen offset:256 nt
    v_permlane16_swap_b32 v218, v234
    s_waitcnt vmcnt(23)
    v_pk_fma_f32 v[212:213], v[236:237], v[60:61], v[212:213] op_sel_hi:[0,1,1]
    v_pk_fma_f32 v[214:215], v[236:237], v[62:63], v[214:215] op_sel_hi:[0,1,1]
    s_nop 1
    s_waitcnt lgkmcnt(0)
    v_cmp_lt_u32 vcc, v0, v244
    ds_add_u32 v224, v243 offset:3328
    buffer_load_dwordx4 v[60:63], v1, s[28:31], s71 offen offset:512 nt
    v_add_f32 v218, v218, v234
    v_mov_b32_dpp v236, v238 row_newbcast:10 row_mask:0xf bank_mask:0xf
    s_waitcnt vmcnt(23)
    v_pk_fma_f32 v[204:205], v[236:237], v[64:65], v[204:205] op_sel_hi:[0,1,1]
    v_pk_fma_f32 v[206:207], v[236:237], v[66:67], v[206:207] op_sel_hi:[0,1,1]
    s_nop 1
    s_add_u32 s71, s71, 3072
    s_cbranch_vccnz L_th39_3
L_tb39_3:
    buffer_load_dwordx4 v[64:67], v1, s[28:31], s71 offen offset:0 nt
    v_mov_b32 v103, s93
    v_lshlrev_b32 v235, 4, v0
    s_lshl_b32 s78, s3, 11
    s_mov_b32 s6, 0x58000000
    s_waitcnt vmcnt(23)
    v_pk_fma_f32 v[208:209], v[236:237], v[68:69], v[208:209] op_sel_hi:[0,1,1]
    v_pk_fma_f32 v[210:211], v[236:237], v[70:71], v[210:211] op_sel_hi:[0,1,1]
    s_nop 1
    buffer_load_dwordx4 v[68:71], v1, s[28:31], s71 offen offset:256 nt
    s_waitcnt vmcnt(23)
    v_pk_fma_f32 v[212:213], v[236:237], v[72:73], v[212:213] op_sel_hi:[0,1,1]
    v_pk_fma_f32 v[214:215], v[236:237], v[74:75], v[214:215] op_sel_hi:[0,1,1]
    s_nop 1
    ds_add_u32 v224, v243 offset:3328
    buffer_load_dwordx4 v[72:75], v1, s[28:31], s71 offen offset:512 nt
    v_mov_b32_dpp v236, v238 row_newbcast:6 row_mask:0xf bank_mask:0xf
    s_waitcnt vmcnt(23)
    v_pk_fma_f32 v[204:205], v[236:237], v[76:77], v[204:205] op_sel_hi:[0,1,1]
    v_pk_fma_f32 v[206:207], v[236:237], v[78:79], v[206:207] op_sel_hi:[0,1,1]
    s_nop 1
    s_add_u32 s71, s71, 3072
    s_cbranch_vccnz L_th42_3
L_tb42_3:
    buffer_load_dwordx4 v[76:79], v1, s[28:31], s71 offen offset:0 nt
    s_waitcnt vmcnt(23)
    v_pk_fma_f32 v[208:209], v[236:237], v[80:81], v[208:209] op_sel_hi:[0,1,1]
    v_pk_fma_f32 v[210:211], v[236:237], v[82:83], v[210:211] op_sel_hi:[0,1,1]
    s_nop 1
    buffer_load_dwordx4 v[80:83], v1, s[28:31], s71 offen offset:256 nt
    s_waitcnt vmcnt(23)
    v_pk_fma_f32 v[212:213], v[236:237], v[84:85], v[212:213] op_sel_hi:[0,1,1]
    v_pk_fma_f32 v[214:215], v[236:237], v[86:87], v[214:215] op_sel_hi:[0,1,1]
    s_nop 1
    ds_add_u32 v224, v243 offset:3328
    buffer_load_dwordx4 v[84:87], v1, s[28:31], s71 offen offset:512 nt
    v_mov_b32_dpp v236, v238 row_newbcast:14 row_mask:0xf bank_mask:0xf
    s_waitcnt vmcnt(23)
    v_pk_fma_f32 v[204:205], v[236:237], v[88:89], v[204:205] op_sel_hi:[0,1,1]
    v_pk_fma_f32 v[206:207], v[236:237], v[90:91], v[206:207] op_sel_hi:[0,1,1]
    s_nop 1
    s_add_u32 s71, s71, 3072
    s_cbranch_vccnz L_th45_3
L_tb45_3:
    buffer_load_dwordx4 v[88:91], v1, s[28:31], s71 offen offset:0 nt
    s_waitcnt vmcnt(23)
    v_pk_fma_f32 v[208:209], v[236:237], v[92:93], v[208:209] op_sel_hi:[0,1,1]
    v_pk_fma_f32 v[210:211], v[236:237], v[94:95], v[210:211] op_sel_hi:[0,1,1]
    s_nop 1
    buffer_load_dwordx4 v[92:95], v1, s[28:31], s71 offen offset:256 nt
    s_waitcnt vmcnt(23)
    v_pk_fma_f32 v[212:213], v[236:237], v[96:97], v[212:213] op_sel_hi:[0,1,1]
    v_pk_fma_f32 v[214:215], v[236:237], v[98:99], v[214:215] op_sel_hi:[0,1,1]
    s_nop 1
    ds_add_u32 v224, v243 offset:3328
    buffer_load_dwordx4 v[96:99], v1, s[28:31], s71 offen offset:512 nt
    ds_write_b32 v243, v243 offset:143
    v_mov_b32_dpp v236, v238 row_newbcast:1 row_mask:0xf bank_mask:0xf
    s_waitcnt vmcnt(23)
    v_pk_fma_f32 v[204:205], v[236:237], v[4:5], v[204:205] op_sel_hi:[0,1,1]
    v_pk_fma_f32 v[206:207], v[236:237], v[6:7], v[206:207] op_sel_hi:[0,1,1]
    s_waitcnt vmcnt(22)
    v_pk_fma_f32 v[208:209], v[236:237], v[8:9], v[208:209] op_sel_hi:[0,1,1]
    v_pk_fma_f32 v[210:211], v[236:237], v[10:11], v[210:211] op_sel_hi:[0,1,1]
    s_waitcnt vmcnt(21)
    v_pk_fma_f32 v[212:213], v[236:237], v[12:13], v[212:213] op_sel_hi:[0,1,1]
    v_pk_fma_f32 v[214:215], v[236:237], v[14:15], v[214:215] op_sel_hi:[0,1,1]
    v_mov_b32_dpp v236, v238 row_newbcast:9 row_mask:0xf bank_mask:0xf
    s_waitcnt vmcnt(20)
    v_pk_fma_f32 v[204:205], v[236:237], v[16:17], v[204:205] op_sel_hi:[0,1,1]
    v_pk_fma_f32 v[206:207], v[236:237], v[18:19], v[206:207] op_sel_hi:[0,1,1]
    s_waitcnt vmcnt(19)
    v_pk_fma_f32 v[208:209], v[236:237], v[20:21], v[208:209] op_sel_hi:[0,1,1]
    v_pk_fma_f32 v[210:211], v[236:237], v[22:23], v[210:211] op_sel_hi:[0,1,1]
    s_waitcnt vmcnt(18)
    v_pk_fma_f32 v[212:213], v[236:237], v[24:25], v[212:213] op_sel_hi:[0,1,1]
    v_pk_fma_f32 v[214:215], v[236:237], v[26:27], v[214:215] op_sel_hi:[0,1,1]
    v_mov_b32_dpp v236, v238 row_newbcast:5 row_mask:0xf bank_mask:0xf
    s_waitcnt vmcnt(17)
    v_pk_fma_f32 v[204:205], v[236:237], v[28:29], v[204:205] op_sel_hi:[0,1,1]
    v_pk_fma_f32 v[206:207], v[236:237], v[30:31], v[206:207] op_sel_hi:[0,1,1]
    s_waitcnt vmcnt(16)
    v_pk_fma_f32 v[208:209], v[236:237], v[32:33], v[208:209] op_sel_hi:[0,1,1]
    v_pk_fma_f32 v[210:211], v[236:237], v[34:35], v[210:211] op_sel_hi:[0,1,1]
    s_waitcnt vmcnt(15)
    v_pk_fma_f32 v[212:213], v[236:237], v[36:37], v[212:213] op_sel_hi:[0,1,1]
    v_pk_fma_f32 v[214:215], v[236:237], v[38:39], v[214:215] op_sel_hi:[0,1,1]
    s_branch L_x2
L_w2:
    s_branch L_w3
L_x2:
    v_mov_b32_dpp v236, v238 row_newbcast:13 row_mask:0xf bank_mask:0xf
    s_waitcnt vmcnt(14)
    v_pk_fma_f32 v[204:205], v[236:237], v[40:41], v[204:205] op_sel_hi:[0,1,1]
    v_pk_fma_f32 v[206:207], v[236:237], v[42:43], v[206:207] op_sel_hi:[0,1,1]
    s_waitcnt vmcnt(13)
    v_pk_fma_f32 v[208:209], v[236:237], v[44:45], v[208:209] op_sel_hi:[0,1,1]
    v_pk_fma_f32 v[210:211], v[236:237], v[46:47], v[210:211] op_sel_hi:[0,1,1]
    s_waitcnt vmcnt(12)
    v_pk_fma_f32 v[212:213], v[236:237], v[48:49], v[212:213] op_sel_hi:[0,1,1]
    v_pk_fma_f32 v[214:215], v[236:237], v[50:51], v[214:215] op_sel_hi:[0,1,1]
    v_mov_b32_dpp v236, v238 row_newbcast:3 row_mask:0xf bank_mask:0xf
    s_waitcnt vmcnt(11)
    v_pk_fma_f32 v[204:205], v[236:237], v[52:53], v[204:205] op_sel_hi:[0,1,1]
    v_pk_fma_f32 v[206:207], v[236:237], v[54:55], v[206:207] op_sel_hi:[0,1,1]
    s_waitcnt vmcnt(10)
    v_pk_fma_f32 v[208:209], v[236:237], v[56:57], v[208:209] op_sel_hi:[0,1,1]
    v_pk_fma_f32 v[210:211], v[236:237], v[58:59], v[210:211] op_sel_hi:[0,1,1]
    s_waitcnt vmcnt(9)
    v_pk_fma_f32 v[212:213], v[236:237], v[60:61], v[212:213] op_sel_hi:[0,1,1]
    v_pk_fma_f32 v[214:215], v[236:237], v[62:63], v[214:215] op_sel_hi:[0,1,1]
    v_mov_b32_dpp v236, v238 row_newbcast:11 row_mask:0xf bank_mask:0xf
    s_waitcnt vmcnt(8)
    v_pk_fma_f32 v[204:205], v[236:237], v[64:65], v[204:205] op_sel_hi:[0,1,1]
    v_pk_fma_f32 v[206:207], v[236:237], v[66:67], v[206:207] op_sel_hi:[0,1,1]
    s_waitcnt vmcnt(7)
    v_pk_fma_f32 v[208:209], v[236:237], v[68:69], v[208:209] op_sel_hi:[0,1,1]
    v_pk_fma_f32 v[210:211], v[236:237], v[70:71], v[210:211] op_sel_hi:[0,1,1]
    s_waitcnt vmcnt(6)
    v_pk_fma_f32 v[212:213], v[236:237], v[72:73], v[212:213] op_sel_hi:[0,1,1]
    v_pk_fma_f32 v[214:215], v[236:237], v[74:75], v[214:215] op_sel_hi:[0,1,1]
    v_mov_b32_dpp v236, v238 row_newbcast:7 row_mask:0xf bank_mask:0xf
    s_waitcnt vmcnt(5)
    v_pk_fma_f32 v[204:205], v[236:237], v[76:77], v[204:205] op_sel_hi:[0,1,1]
    v_pk_fma_f32 v[206:207], v[236:237], v[78:79], v[206:207] op_sel_hi:[0,1,1]
    s_waitcnt vmcnt(4)
    v_pk_fma_f32 v[208:209], v[236:237], v[80:81], v[208:209] op_sel_hi:[0,1,1]
    v_pk_fma_f32 v[210:211], v[236:237], v[82:83], v[210:211] op_sel_hi:[0,1,1]
    s_waitcnt vmcnt(3)
    v_pk_fma_f32 v[212:213], v[236:237], v[84:85], v[212:213] op_sel_hi:[0,1,1]
    v_pk_fma_f32 v[214:215], v[236:237], v[86:87], v[214:215] op_sel_hi:[0,1,1]
    v_mov_b32_dpp v236, v238 row_newbcast:15 row_mask:0xf bank_mask:0xf
    s_waitcnt vmcnt(2)
    v_pk_fma_f32 v[204:205], v[236:237], v[88:89], v[204:205] op_sel_hi:[0,1,1]
    v_pk_fma_f32 v[206:207], v[236:237], v[90:91], v[206:207] op_sel_hi:[0,1,1]
    s_waitcnt vmcnt(1)
    v_pk_fma_f32 v[208:209], v[236:237], v[92:93], v[208:209] op_sel_hi:[0,1,1]
    v_pk_fma_f32 v[210:211], v[236:237], v[94:95], v[210:211] op_sel_hi:[0,1,1]
    v_permlane32_swap_b32 v204, v206
    v_permlane32_swap_b32 v205, v207
    v_add_f32 v204, v204, v206
    v_add_f32 v205, v205, v207
    v_permlane32_swap_b32 v208, v210
    v_permlane32_swap_b32 v209, v211
    v_add_f32 v208, v208, v210
    v_add_f32 v209, v209, v211
    v_permlane16_swap_b32 v204, v205
    v_add_f32 v204, v204, v205
    v_fma_f32 v100, v204, s6, -v218
    v_permlane16_swap_b32 v208, v209
    v_add_f32 v208, v208, v209
    v_fma_f32 v101, v208, s6, -v218
    s_waitcnt vmcnt(0)
    v_pk_fma_f32 v[212:213], v[236:237], v[96:97], v[212:213] op_sel_hi:[0,1,1]
    v_pk_fma_f32 v[214:215], v[236:237], v[98:99], v[214:215] op_sel_hi:[0,1,1]
    s_nop 1
    v_permlane32_swap_b32 v212, v214
    v_permlane32_swap_b32 v213, v215
    v_add_f32 v212, v212, v214
    v_add_f32 v213, v213, v215
    s_nop 1
    v_permlane16_swap_b32 v212, v213
    v_add_f32 v212, v212, v213
    v_fma_f32 v102, v212, s6, -v218
    s_mov_b64 exec, s[88:89]
    buffer_store_dwordx4 v[100:103], v225, s[52:55], s78 offen offset:0
    s_not_b64 exec, exec
    buffer_store_dwordx4 v[100:103], v225, s[52:55], s78 offen offset:0 sc0 sc1
    s_mov_b64 exec, -1
L_final:
    s_endpgm
L_th24_0:
    s_waitcnt vmcnt(32)
    s_cmp_eq_u32 vcc_lo, 1
    s_cbranch_scc1 L_tb24_0
    s_waitcnt vmcnt(23)
    s_branch L_tb24_0
L_th27_0:
    s_waitcnt vmcnt(26)
    s_cmp_eq_u32 vcc_lo, 1
    s_cbranch_scc1 L_tb27_0
    s_waitcnt vmcnt(23)
    s_branch L_tb27_0
L_th30_0:
    s_waitcnt vmcnt(32)
    s_cmp_eq_u32 vcc_lo, 1
    s_cbranch_scc1 L_tb30_0
    s_waitcnt vmcnt(29)
    s_branch L_tb30_0
L_th33_0:
    s_waitcnt vmcnt(32)
    s_cmp_eq_u32 vcc_lo, 1
    s_cbranch_scc1 L_tb33_0
    s_waitcnt vmcnt(29)
    s_branch L_tb33_0
L_th36_0:
    s_waitcnt vmcnt(35)
    s_cmp_eq_u32 vcc_lo, 1
    s_cbranch_scc1 L_tb36_0
    s_waitcnt vmcnt(26)
    s_branch L_tb36_0
L_th39_0:
    s_waitcnt vmcnt(29)
    s_cmp_eq_u32 vcc_lo, 1
    s_cbranch_scc1 L_tb39_0
    s_waitcnt vmcnt(26)
    s_branch L_tb39_0
L_th42_0:
    s_waitcnt vmcnt(35)
    s_cmp_eq_u32 vcc_lo, 1
    s_cbranch_scc1 L_tb42_0
    s_waitcnt vmcnt(32)
    s_branch L_tb42_0
L_th45_0:
    s_waitcnt vmcnt(35)
    s_cmp_eq_u32 vcc_lo, 1
    s_cbranch_scc1 L_tb45_0
    s_waitcnt vmcnt(32)
    s_branch L_tb45_0
L_th0_0:
    s_waitcnt vmcnt(35)
    s_cmp_eq_u32 vcc_lo, 1
    s_cbranch_scc1 L_tb0_0
    s_waitcnt vmcnt(26)
    s_branch L_tb0_0
L_th3_0:
    s_waitcnt vmcnt(29)
    s_cmp_eq_u32 vcc_lo, 1
    s_cbranch_scc1 L_tb3_0
    s_waitcnt vmcnt(26)
    s_branch L_tb3_0
L_th6_0:
    s_waitcnt vmcnt(35)
    s_cmp_eq_u32 vcc_lo, 1
    s_cbranch_scc1 L_tb6_0
    s_waitcnt vmcnt(29)
    s_branch L_tb6_0
L_th9_0:
    s_waitcnt vmcnt(32)
    s_cmp_eq_u32 vcc_lo, 1
    s_cbranch_scc1 L_tb9_0
    s_waitcnt vmcnt(29)
    s_branch L_tb9_0
L_th12_0:
    s_waitcnt vmcnt(32)
    s_cmp_eq_u32 vcc_lo, 1
    s_cbranch_scc1 L_tb12_0
    s_waitcnt vmcnt(23)
    s_branch L_tb12_0
L_th15_0:
    s_waitcnt vmcnt(26)
    s_cmp_eq_u32 vcc_lo, 1
    s_cbranch_scc1 L_tb15_0
    s_waitcnt vmcnt(23)
    s_branch L_tb15_0
L_th18_0:
    s_waitcnt vmcnt(32)
    s_cmp_eq_u32 vcc_lo, 1
    s_cbranch_scc1 L_tb18_0
    s_waitcnt vmcnt(29)
    s_branch L_tb18_0
L_th21_0:
    s_waitcnt vmcnt(32)
    s_cmp_eq_u32 vcc_lo, 1
    s_cbranch_scc1 L_tb21_0
    s_waitcnt vmcnt(29)
    s_branch L_tb21_0
L_th24_1:
    s_waitcnt vmcnt(32)
    s_cmp_eq_u32 vcc_lo, 1
    s_cbranch_scc1 L_tb24_1
    s_waitcnt vmcnt(23)
    s_branch L_tb24_1
L_th27_1:
    s_waitcnt vmcnt(26)
    s_cmp_eq_u32 vcc_lo, 1
    s_cbranch_scc1 L_tb27_1
    s_waitcnt vmcnt(23)
    s_branch L_tb27_1
L_th30_1:
    s_waitcnt vmcnt(32)
    s_cmp_eq_u32 vcc_lo, 1
    s_cbranch_scc1 L_tb30_1
    s_waitcnt vmcnt(29)
    s_branch L_tb30_1
L_th33_1:
    s_waitcnt vmcnt(32)
    s_cmp_eq_u32 vcc_lo, 1
    s_cbranch_scc1 L_tb33_1
    s_waitcnt vmcnt(29)
    s_branch L_tb33_1
L_th36_1:
    s_waitcnt vmcnt(34)
    s_cmp_eq_u32 vcc_lo, 1
    s_cbranch_scc1 L_tb36_1
    s_waitcnt vmcnt(25)
    s_branch L_tb36_1
L_th39_1:
    s_waitcnt vmcnt(28)
    s_cmp_eq_u32 vcc_lo, 1
    s_cbranch_scc1 L_tb39_1
    s_waitcnt vmcnt(25)
    s_branch L_tb39_1
L_th42_1:
    s_waitcnt vmcnt(28)
    s_cmp_eq_u32 vcc_lo, 1
    s_cbranch_scc1 L_tb42_1
    s_waitcnt vmcnt(25)
    s_branch L_tb42_1
L_th45_1:
    s_waitcnt vmcnt(28)
    s_cmp_eq_u32 vcc_lo, 1
    s_cbranch_scc1 L_tb45_1
    s_waitcnt vmcnt(25)
    s_branch L_tb45_1
L_th0_1:
    s_waitcnt vmcnt(28)
    s_cmp_eq_u32 vcc_lo, 1
    s_cbranch_scc1 L_tb0_1
    s_waitcnt vmcnt(19)
    s_branch L_tb0_1
L_th3_1:
    s_waitcnt vmcnt(22)
    s_cmp_eq_u32 vcc_lo, 1
    s_cbranch_scc1 L_tb3_1
    s_waitcnt vmcnt(19)
    s_branch L_tb3_1
L_th6_1:
    s_waitcnt vmcnt(22)
    s_cmp_eq_u32 vcc_lo, 1
    s_cbranch_scc1 L_tb6_1
    s_waitcnt vmcnt(17)
    s_branch L_tb6_1
L_th9_1:
    s_waitcnt vmcnt(20)
    s_cmp_eq_u32 vcc_lo, 1
    s_cbranch_scc1 L_tb9_1
    s_waitcnt vmcnt(17)
    s_branch L_tb9_1
L_th12_1:
    s_waitcnt vmcnt(20)
    s_cmp_eq_u32 vcc_lo, 1
    s_cbranch_scc1 L_tb12_1
    s_waitcnt vmcnt(17)
    s_branch L_tb12_1
L_th15_1:
    s_waitcnt vmcnt(20)
    s_cmp_eq_u32 vcc_lo, 1
    s_cbranch_scc1 L_tb15_1
    s_waitcnt vmcnt(17)
    s_branch L_tb15_1
L_th18_1:
    s_waitcnt vmcnt(20)
    s_cmp_eq_u32 vcc_lo, 1
    s_cbranch_scc1 L_tb18_1
    s_waitcnt vmcnt(17)
    s_branch L_tb18_1
L_th21_1:
    s_waitcnt vmcnt(20)
    s_cmp_eq_u32 vcc_lo, 1
    s_cbranch_scc1 L_tb21_1
    s_waitcnt vmcnt(17)
    s_branch L_tb21_1
L_th24_2:
    s_nop 11
    s_waitcnt vmcnt(20)
    s_cmp_eq_u32 vcc_lo, 1
    s_cbranch_scc1 L_tb24_2
    s_waitcnt vmcnt(17)
    s_branch L_tb24_2
L_th27_2:
    s_nop 11
    s_waitcnt vmcnt(20)
    s_cmp_eq_u32 vcc_lo, 1
    s_cbranch_scc1 L_tb27_2
    s_waitcnt vmcnt(17)
    s_branch L_tb27_2
L_th30_2:
    s_nop 11
    s_waitcnt vmcnt(20)
    s_cmp_eq_u32 vcc_lo, 1
    s_cbranch_scc1 L_tb30_2
    s_waitcnt vmcnt(17)
    s_branch L_tb30_2
L_th33_2:
    s_nop 11
    s_waitcnt vmcnt(20)
    s_cmp_eq_u32 vcc_lo, 1
    s_cbranch_scc1 L_tb33_2
    s_waitcnt vmcnt(17)
    s_branch L_tb33_2
L_th36_2:
    s_nop 11
    s_waitcnt vmcnt(22)
    s_cmp_eq_u32 vcc_lo, 1
    s_cbranch_scc1 L_tb36_2
    s_waitcnt vmcnt(19)
    s_branch L_tb36_2
L_th39_2:
    s_nop 11
    s_waitcnt vmcnt(22)
    s_cmp_eq_u32 vcc_lo, 1
    s_cbranch_scc1 L_tb39_2
    s_waitcnt vmcnt(19)
    s_branch L_tb39_2
L_th42_2:
    s_nop 11
    s_waitcnt vmcnt(22)
    s_cmp_eq_u32 vcc_lo, 1
    s_cbranch_scc1 L_tb42_2
    s_waitcnt vmcnt(19)
    s_branch L_tb42_2
L_th45_2:
    s_nop 11
    s_waitcnt vmcnt(22)
    s_cmp_eq_u32 vcc_lo, 1
    s_cbranch_scc1 L_tb45_2
    s_waitcnt vmcnt(19)
    s_branch L_tb45_2
L_getm2:
    ds_read_b32 v227, v243 offset:139
    ds_read_b32 v226, v243 offset:159
    s_waitcnt lgkmcnt(0)
    v_readfirstlane_b32 s93, v227
    v_readfirstlane_b32 s77, v226
    s_cmp_eq_u32 s93, 0
    s_cbranch_scc1 L_getm2
    ds_read_b32 v226, v243 offset:151
    s_waitcnt lgkmcnt(0)
    v_readfirstlane_b32 s88, v226
    s_cmp_eq_u32 s88, -1
    s_cselect_b64 s[88:89], -1, 0
    s_branch L_gotm2
L_th0_2:
    s_nop 11
    s_waitcnt vmcnt(22)
    s_cmp_eq_u32 vcc_lo, 1
    s_cbranch_scc1 L_tb0_2
    s_waitcnt vmcnt(19)
    s_branch L_tb0_2
L_th3_2:
    s_nop 11
    s_waitcnt vmcnt(22)
    s_cmp_eq_u32 vcc_lo, 1
    s_cbranch_scc1 L_tb3_2
    s_waitcnt vmcnt(19)
    s_branch L_tb3_2
L_th6_2:
    s_nop 11
    s_waitcnt vmcnt(22)
    s_cmp_eq_u32 vcc_lo, 1
    s_cbranch_scc1 L_tb6_2
    s_waitcnt vmcnt(17)
    s_branch L_tb6_2
L_th9_2:
    s_nop 11
    s_waitcnt vmcnt(20)
    s_cmp_eq_u32 vcc_lo, 1
    s_cbranch_scc1 L_tb9_2
    s_waitcnt vmcnt(17)
    s_branch L_tb9_2
L_th12_2:
    s_nop 11
    s_waitcnt vmcnt(20)
    s_cmp_eq_u32 vcc_lo, 1
    s_cbranch_scc1 L_tb12_2
    s_waitcnt vmcnt(17)
    s_branch L_tb12_2
L_th15_2:
    s_nop 11
    s_waitcnt vmcnt(20)
    s_cmp_eq_u32 vcc_lo, 1
    s_cbranch_scc1 L_tb15_2
    s_waitcnt vmcnt(17)
    s_branch L_tb15_2
L_th18_2:
    s_nop 11
    s_waitcnt vmcnt(20)
    s_cmp_eq_u32 vcc_lo, 1
    s_cbranch_scc1 L_tb18_2
    s_waitcnt vmcnt(17)
    s_branch L_tb18_2
L_th21_2:
    s_nop 11
    s_waitcnt vmcnt(20)
    s_cmp_eq_u32 vcc_lo, 1
    s_cbranch_scc1 L_tb21_2
    s_waitcnt vmcnt(17)
    s_branch L_tb21_2
L_th24_3:
    s_nop 11
    s_waitcnt vmcnt(20)
    s_cmp_eq_u32 vcc_lo, 1
    s_cbranch_scc1 L_tb24_3
    s_waitcnt vmcnt(17)
    s_branch L_tb24_3
L_th27_3:
    s_nop 11
    s_waitcnt vmcnt(20)
    s_cmp_eq_u32 vcc_lo, 1
    s_cbranch_scc1 L_tb27_3
    s_waitcnt vmcnt(17)
    s_branch L_tb27_3
L_th30_3:
    s_nop 11
    s_waitcnt vmcnt(20)
    s_cmp_eq_u32 vcc_lo, 1
    s_cbranch_scc1 L_tb30_3
    s_waitcnt vmcnt(17)
    s_branch L_tb30_3
L_th33_3:
    s_nop 11
    s_waitcnt vmcnt(20)
    s_cmp_eq_u32 vcc_lo, 1
    s_cbranch_scc1 L_tb33_3
    s_waitcnt vmcnt(17)
    s_branch L_tb33_3
L_th36_3:
    s_nop 11
    s_waitcnt vmcnt(20)
    s_cmp_eq_u32 vcc_lo, 1
    s_cbranch_scc1 L_tb36_3
    s_waitcnt vmcnt(17)
    s_branch L_tb36_3
L_th39_3:
    s_nop 11
    s_waitcnt vmcnt(20)
    s_cmp_eq_u32 vcc_lo, 1
    s_cbranch_scc1 L_tb39_3
    s_waitcnt vmcnt(17)
    s_branch L_tb39_3
L_th42_3:
    s_nop 11
    s_waitcnt vmcnt(20)
    s_cmp_eq_u32 vcc_lo, 1
    s_cbranch_scc1 L_tb42_3
    s_waitcnt vmcnt(17)
    s_branch L_tb42_3
L_th45_3:
    s_nop 11
    s_waitcnt vmcnt(20)
    s_cmp_eq_u32 vcc_lo, 1
    s_cbranch_scc1 L_tb45_3
    s_waitcnt vmcnt(17)
    s_branch L_tb45_3
L_service:
    v_lshlrev_b32 v5, 2, v0
    v_mov_b32 v3, 0
    ds_write_b32 v5, v3 offset:0
    v_lshlrev_b32 v1, 4, v0
    v_lshlrev_b32 v28, 11, v0
    v_mov_b32 v9, 0xf149f2ca
    v_cndmask_b32 v9, v9, v3, s[66:67]
    v_and_b32 v5, 15, v0
    v_lshrrev_b32 v6, 4, v0
    v_lshl_add_u32 v11, v5, 2, v6
    v_lshlrev_b32 v11, 1, v11
    s_getreg_b32 s72, hwreg(HW_REG_XCC_ID)
    s_and_b32 s72, s72, 15
    s_waitcnt lgkmcnt(0)
    s_barrier
    s_branch L_w0
L_walked:
    s_mov_b32 s52, s22
    s_and_b32 s53, s23, 0xffff
    s_mov_b32 s54, 25165824
    s_mov_b32 s55, 0x00020000
    s_mov_b32 s56, s18
    s_and_b32 s57, s19, 0xffff
    s_mov_b32 s58, 12288
    s_mov_b32 s59, 0x00020000
    s_mov_b32 s96, s79
    s_and_b32 s82, s79, 3
    s_lshl_b32 s82, s82, 4
    v_mov_b32 v10, 0
    s_mov_b32 s80, 0x2010200
    s_mov_b32 s81, 0x2030202
    s_cmp_ge_u32 s79, 4
    s_cmov_b32 s80, 0x2050204
    s_cmov_b32 s81, 0x2070206
    s_lshr_b64 s[80:81], s[80:81], s82
    v_writelane_b32 v10, s80, 0
    s_mov_b32 s80, 0x2090208
    s_mov_b32 s81, 0x20b020a
    s_cmp_ge_u32 s79, 4
    s_cmov_b32 s80, 0x20d020c
    s_cmov_b32 s81, 0x20f020e
    s_lshr_b64 s[80:81], s[80:81], s82
    v_writelane_b32 v10, s80, 1
    s_mov_b32 s80, 0x4b00170
    s_mov_b32 s81, 0x5720551
    s_cmp_ge_u32 s79, 4
    s_cmov_b32 s80, 0x5330892
    s_cmov_b32 s81, 0x8740574
    s_lshr_b64 s[80:81], s[80:81], s82
    v_writelane_b32 v10, s80, 2
    s_mov_b32 s80, 0xd100b5
    s_mov_b32 s81, 0x8b60032
    s_cmp_ge_u32 s79, 4
    s_cmov_b32 s80, 0x5400f3
    s_cmov_b32 s81, 0x91508b7
    s_lshr_b64 s[80:81], s[80:81], s82
    v_writelane_b32 v10, s80, 3
    s_mov_b32 s80, 0x4750000
    s_mov_b32 s81, 0x4b6
    s_cmp_ge_u32 s79, 4
    s_cmov_b32 s80, 0x4b70c96
    s_cmov_b32 s81, 0xcb70000
    s_lshr_b64 s[80:81], s[80:81], s82
    v_writelane_b32 v10, s80, 4
    s_mov_b32 s80, 0x560000
    s_mov_b32 s81, 0x0
    s_cmp_ge_u32 s79, 4
    s_cmov_b32 s80, 0x37
    s_cmov_b32 s81, 0x0
    s_lshr_b64 s[80:81], s[80:81], s82
    v_writelane_b32 v10, s80, 5
    v_and_b32 v10, 0xffff, v10
L_tag:
    ds_read_b32 v5, v3 offset:140
    ds_read_b64 v[16:17], v3 offset:152
    s_waitcnt lgkmcnt(0)
    v_readfirstlane_b32 s69, v5
    s_cmp_eq_u32 s69, 0
    s_cbranch_scc1 L_tag
    v_readfirstlane_b32 s86, v16
    v_readfirstlane_b32 s87, v17
    s_bfm_b64 s[84:85], s92, 0
    s_bcnt1_i32_b64 s70, s[86:87]
    s_and_b64 s[84:85], s[84:85], s[86:87]
    s_bcnt1_i32_b64 s71, s[84:85]
    s_mov_b32 s73, s71
L_round:
    s_min_u32 s80, s71, 63
    v_readlane_b32 s97, v10, s80
    s_lshl_b32 s80, s71, 2
    v_mov_b32 v4, s80
    s_cmp_eq_u32 s97, 0
    s_cbranch_scc1 L_last
L_poll:
    ds_read_b32 v5, v4 offset:0
    s_waitcnt lgkmcnt(0)
    v_readfirstlane_b32 s80, v5
    s_cmp_eq_u32 s80, 0
    s_cbranch_scc1 L_poll
    s_add_u32 s95, s69, s71
    s_add_u32 s95, s95, 1
    s_and_b32 s80, s71, 1
    s_lshl_b32 s80, s80, 19
    s_add_u32 s80, s80, 2097152
    s_lshl_b32 s77, s2, 11
    s_add_u32 s77, s77, s80
    s_lshl_b32 s75, s96, 16
    s_add_u32 s75, s75, s80
L_all:
    v_mov_b32 v16, s95
    s_mov_b64 exec, s[86:87]
    buffer_load_dword v16, v28, s[52:55], s75 offen offset:1024 sc0 sc1
    s_mov_b64 exec, -1
    s_waitcnt vmcnt(0)
    v_cmp_ne_u32 vcc, s95, v16
    s_cmp_lg_u64 vcc, 0
    s_cbranch_scc1 L_all
    s_mov_b32 s74, 0
    s_mov_b64 s[84:85], s[86:87]
L_merge:
    v_mov_b32 v7, 0xf149f2ca
    v_mov_b32 v8, 0
    v_mov_b32 v12, 0
    v_mov_b32 v13, 0
    v_mov_b32 v14, 0
L_chunk:
    v_mov_b32 v48, 0
    v_mov_b32 v49, 0
    v_mov_b32 v50, 0
    v_mov_b32 v51, v9
    v_mov_b32 v52, 0
    v_mov_b32 v53, 0
    v_mov_b32 v54, 0
    v_mov_b32 v55, v9
    v_mov_b32 v56, 0
    v_mov_b32 v57, 0
    v_mov_b32 v58, 0
    v_mov_b32 v59, v9
    v_mov_b32 v60, 0
    v_mov_b32 v61, 0
    v_mov_b32 v62, 0
    v_mov_b32 v63, v9
    v_mov_b32 v64, 0
    v_mov_b32 v65, 0
    v_mov_b32 v66, 0
    v_mov_b32 v67, v9
    v_mov_b32 v68, 0
    v_mov_b32 v69, 0
    v_mov_b32 v70, 0
    v_mov_b32 v71, v9
    v_mov_b32 v72, 0
    v_mov_b32 v73, 0
    v_mov_b32 v74, 0
    v_mov_b32 v75, v9
    v_mov_b32 v76, 0
    v_mov_b32 v77, 0
    v_mov_b32 v78, 0
    v_mov_b32 v79, v9
    v_mov_b32 v80, 0
    v_mov_b32 v81, 0
    v_mov_b32 v82, 0
    v_mov_b32 v83, v9
    v_mov_b32 v84, 0
    v_mov_b32 v85, 0
    v_mov_b32 v86, 0
    v_mov_b32 v87, v9
    v_mov_b32 v88, 0
    v_mov_b32 v89, 0
    v_mov_b32 v90, 0
    v_mov_b32 v91, v9
    v_mov_b32 v92, 0
    v_mov_b32 v93, 0
    v_mov_b32 v94, 0
    v_mov_b32 v95, v9
    v_mov_b32 v96, 0
    v_mov_b32 v97, 0
    v_mov_b32 v98, 0
    v_mov_b32 v99, v9
    v_mov_b32 v100, 0
    v_mov_b32 v101, 0
    v_mov_b32 v102, 0
    v_mov_b32 v103, v9
    v_mov_b32 v104, 0
    v_mov_b32 v105, 0
    v_mov_b32 v106, 0
    v_mov_b32 v107, v9
    v_mov_b32 v108, 0
    v_mov_b32 v109, 0
    v_mov_b32 v110, 0
    v_mov_b32 v111, v9
    v_mov_b32 v112, 0
    v_mov_b32 v113, 0
    v_mov_b32 v114, 0
    v_mov_b32 v115, v9
    v_mov_b32 v116, 0
    v_mov_b32 v117, 0
    v_mov_b32 v118, 0
    v_mov_b32 v119, v9
    v_mov_b32 v120, 0
    v_mov_b32 v121, 0
    v_mov_b32 v122, 0
    v_mov_b32 v123, v9
    v_mov_b32 v124, 0
    v_mov_b32 v125, 0
    v_mov_b32 v126, 0
    v_mov_b32 v127, v9
    v_mov_b32 v128, 0
    v_mov_b32 v129, 0
    v_mov_b32 v130, 0
    v_mov_b32 v131, v9
    v_mov_b32 v132, 0
    v_mov_b32 v133, 0
    v_mov_b32 v134, 0
    v_mov_b32 v135, v9
    v_mov_b32 v136, 0
    v_mov_b32 v137, 0
    v_mov_b32 v138, 0
    v_mov_b32 v139, v9
    v_mov_b32 v140, 0
    v_mov_b32 v141, 0
    v_mov_b32 v142, 0
    v_mov_b32 v143, v9
    v_mov_b32 v144, 0
    v_mov_b32 v145, 0
    v_mov_b32 v146, 0
    v_mov_b32 v147, v9
    v_mov_b32 v148, 0
    v_mov_b32 v149, 0
    v_mov_b32 v150, 0
    v_mov_b32 v151, v9
    v_mov_b32 v152, 0
    v_mov_b32 v153, 0
    v_mov_b32 v154, 0
    v_mov_b32 v155, v9
    v_mov_b32 v156, 0
    v_mov_b32 v157, 0
    v_mov_b32 v158, 0
    v_mov_b32 v159, v9
    v_mov_b32 v160, 0
    v_mov_b32 v161, 0
    v_mov_b32 v162, 0
    v_mov_b32 v163, v9
    v_mov_b32 v164, 0
    v_mov_b32 v165, 0
    v_mov_b32 v166, 0
    v_mov_b32 v167, v9
    v_mov_b32 v168, 0
    v_mov_b32 v169, 0
    v_mov_b32 v170, 0
    v_mov_b32 v171, v9
    v_mov_b32 v172, 0
    v_mov_b32 v173, 0
    v_mov_b32 v174, 0
    v_mov_b32 v175, v9
    s_ff1_i32_b64 s80, s[84:85]
    s_bitset0_b64 s[84:85], s80
    s_lshl_b32 s81, s80, 11
    s_add_u32 s81, s81, s75
    s_cmp_ge_i32 s80, 0
    s_cselect_b64 exec, -1, 0
    buffer_load_dwordx4 v[48:51], v1, s[52:55], s81 offen sc0 sc1
    s_ff1_i32_b64 s80, s[84:85]
    s_bitset0_b64 s[84:85], s80
    s_lshl_b32 s81, s80, 11
    s_add_u32 s81, s81, s75
    s_cmp_ge_i32 s80, 0
    s_cselect_b64 exec, -1, 0
    buffer_load_dwordx4 v[52:55], v1, s[52:55], s81 offen sc0 sc1
    s_ff1_i32_b64 s80, s[84:85]
    s_bitset0_b64 s[84:85], s80
    s_lshl_b32 s81, s80, 11
    s_add_u32 s81, s81, s75
    s_cmp_ge_i32 s80, 0
    s_cselect_b64 exec, -1, 0
    buffer_load_dwordx4 v[56:59], v1, s[52:55], s81 offen sc0 sc1
    s_ff1_i32_b64 s80, s[84:85]
    s_bitset0_b64 s[84:85], s80
    s_lshl_b32 s81, s80, 11
    s_add_u32 s81, s81, s75
    s_cmp_ge_i32 s80, 0
    s_cselect_b64 exec, -1, 0
    buffer_load_dwordx4 v[60:63], v1, s[52:55], s81 offen sc0 sc1
    s_ff1_i32_b64 s80, s[84:85]
    s_bitset0_b64 s[84:85], s80
    s_lshl_b32 s81, s80, 11
    s_add_u32 s81, s81, s75
    s_cmp_ge_i32 s80, 0
    s_cselect_b64 exec, -1, 0
    buffer_load_dwordx4 v[64:67], v1, s[52:55], s81 offen sc0 sc1
    s_ff1_i32_b64 s80, s[84:85]
    s_bitset0_b64 s[84:85], s80
    s_lshl_b32 s81, s80, 11
    s_add_u32 s81, s81, s75
    s_cmp_ge_i32 s80, 0
    s_cselect_b64 exec, -1, 0
    buffer_load_dwordx4 v[68:71], v1, s[52:55], s81 offen sc0 sc1
    s_ff1_i32_b64 s80, s[84:85]
    s_bitset0_b64 s[84:85], s80
    s_lshl_b32 s81, s80, 11
    s_add_u32 s81, s81, s75
    s_cmp_ge_i32 s80, 0
    s_cselect_b64 exec, -1, 0
    buffer_load_dwordx4 v[72:75], v1, s[52:55], s81 offen sc0 sc1
    s_ff1_i32_b64 s80, s[84:85]
    s_bitset0_b64 s[84:85], s80
    s_lshl_b32 s81, s80, 11
    s_add_u32 s81, s81, s75
    s_cmp_ge_i32 s80, 0
    s_cselect_b64 exec, -1, 0
    buffer_load_dwordx4 v[76:79], v1, s[52:55], s81 offen sc0 sc1
    s_ff1_i32_b64 s80, s[84:85]
    s_bitset0_b64 s[84:85], s80
    s_lshl_b32 s81, s80, 11
    s_add_u32 s81, s81, s75
    s_cmp_ge_i32 s80, 0
    s_cbranch_scc0 L_got
    s_cselect_b64 exec, -1, 0
    buffer_load_dwordx4 v[80:83], v1, s[52:55], s81 offen sc0 sc1
    s_ff1_i32_b64 s80, s[84:85]
    s_bitset0_b64 s[84:85], s80
    s_lshl_b32 s81, s80, 11
    s_add_u32 s81, s81, s75
    s_cmp_ge_i32 s80, 0
    s_cselect_b64 exec, -1, 0
    buffer_load_dwordx4 v[84:87], v1, s[52:55], s81 offen sc0 sc1
    s_ff1_i32_b64 s80, s[84:85]
    s_bitset0_b64 s[84:85], s80
    s_lshl_b32 s81, s80, 11
    s_add_u32 s81, s81, s75
    s_cmp_ge_i32 s80, 0
    s_cselect_b64 exec, -1, 0
    buffer_load_dwordx4 v[88:91], v1, s[52:55], s81 offen sc0 sc1
    s_ff1_i32_b64 s80, s[84:85]
    s_bitset0_b64 s[84:85], s80
    s_lshl_b32 s81, s80, 11
    s_add_u32 s81, s81, s75
    s_cmp_ge_i32 s80, 0
    s_cselect_b64 exec, -1, 0
    buffer_load_dwordx4 v[92:95], v1, s[52:55], s81 offen sc0 sc1
    s_ff1_i32_b64 s80, s[84:85]
    s_bitset0_b64 s[84:85], s80
    s_lshl_b32 s81, s80, 11
    s_add_u32 s81, s81, s75
    s_cmp_ge_i32 s80, 0
    s_cselect_b64 exec, -1, 0
    buffer_load_dwordx4 v[96:99], v1, s[52:55], s81 offen sc0 sc1
    s_ff1_i32_b64 s80, s[84:85]
    s_bitset0_b64 s[84:85], s80
    s_lshl_b32 s81, s80, 11
    s_add_u32 s81, s81, s75
    s_cmp_ge_i32 s80, 0
    s_cselect_b64 exec, -1, 0
    buffer_load_dwordx4 v[100:103], v1, s[52:55], s81 offen sc0 sc1
    s_ff1_i32_b64 s80, s[84:85]
    s_bitset0_b64 s[84:85], s80
    s_lshl_b32 s81, s80, 11
    s_add_u32 s81, s81, s75
    s_cmp_ge_i32 s80, 0
    s_cselect_b64 exec, -1, 0
    buffer_load_dwordx4 v[104:107], v1, s[52:55], s81 offen sc0 sc1
    s_ff1_i32_b64 s80, s[84:85]
    s_bitset0_b64 s[84:85], s80
    s_lshl_b32 s81, s80, 11
    s_add_u32 s81, s81, s75
    s_cmp_ge_i32 s80, 0
    s_cselect_b64 exec, -1, 0
    buffer_load_dwordx4 v[108:111], v1, s[52:55], s81 offen sc0 sc1
    s_ff1_i32_b64 s80, s[84:85]
    s_bitset0_b64 s[84:85], s80
    s_lshl_b32 s81, s80, 11
    s_add_u32 s81, s81, s75
    s_cmp_ge_i32 s80, 0
    s_cbranch_scc0 L_got
    s_cselect_b64 exec, -1, 0
    buffer_load_dwordx4 v[112:115], v1, s[52:55], s81 offen sc0 sc1
    s_ff1_i32_b64 s80, s[84:85]
    s_bitset0_b64 s[84:85], s80
    s_lshl_b32 s81, s80, 11
    s_add_u32 s81, s81, s75
    s_cmp_ge_i32 s80, 0
    s_cselect_b64 exec, -1, 0
    buffer_load_dwordx4 v[116:119], v1, s[52:55], s81 offen sc0 sc1
    s_ff1_i32_b64 s80, s[84:85]
    s_bitset0_b64 s[84:85], s80
    s_lshl_b32 s81, s80, 11
    s_add_u32 s81, s81, s75
    s_cmp_ge_i32 s80, 0
    s_cselect_b64 exec, -1, 0
    buffer_load_dwordx4 v[120:123], v1, s[52:55], s81 offen sc0 sc1
    s_ff1_i32_b64 s80, s[84:85]
    s_bitset0_b64 s[84:85], s80
    s_lshl_b32 s81, s80, 11
    s_add_u32 s81, s81, s75
    s_cmp_ge_i32 s80, 0
    s_cselect_b64 exec, -1, 0
    buffer_load_dwordx4 v[124:127], v1, s[52:55], s81 offen sc0 sc1
    s_ff1_i32_b64 s80, s[84:85]
    s_bitset0_b64 s[84:85], s80
    s_lshl_b32 s81, s80, 11
    s_add_u32 s81, s81, s75
    s_cmp_ge_i32 s80, 0
    s_cselect_b64 exec, -1, 0
    buffer_load_dwordx4 v[128:131], v1, s[52:55], s81 offen sc0 sc1
    s_ff1_i32_b64 s80, s[84:85]
    s_bitset0_b64 s[84:85], s80
    s_lshl_b32 s81, s80, 11
    s_add_u32 s81, s81, s75
    s_cmp_ge_i32 s80, 0
    s_cselect_b64 exec, -1, 0
    buffer_load_dwordx4 v[132:135], v1, s[52:55], s81 offen sc0 sc1
    s_ff1_i32_b64 s80, s[84:85]
    s_bitset0_b64 s[84:85], s80
    s_lshl_b32 s81, s80, 11
    s_add_u32 s81, s81, s75
    s_cmp_ge_i32 s80, 0
    s_cselect_b64 exec, -1, 0
    buffer_load_dwordx4 v[136:139], v1, s[52:55], s81 offen sc0 sc1
    s_ff1_i32_b64 s80, s[84:85]
    s_bitset0_b64 s[84:85], s80
    s_lshl_b32 s81, s80, 11
    s_add_u32 s81, s81, s75
    s_cmp_ge_i32 s80, 0
    s_cselect_b64 exec, -1, 0
    buffer_load_dwordx4 v[140:143], v1, s[52:55], s81 offen sc0 sc1
    s_ff1_i32_b64 s80, s[84:85]
    s_bitset0_b64 s[84:85], s80
    s_lshl_b32 s81, s80, 11
    s_add_u32 s81, s81, s75
    s_cmp_ge_i32 s80, 0
    s_cbranch_scc0 L_got
    s_cselect_b64 exec, -1, 0
    buffer_load_dwordx4 v[144:147], v1, s[52:55], s81 offen sc0 sc1
    s_ff1_i32_b64 s80, s[84:85]
    s_bitset0_b64 s[84:85], s80
    s_lshl_b32 s81, s80, 11
    s_add_u32 s81, s81, s75
    s_cmp_ge_i32 s80, 0
    s_cselect_b64 exec, -1, 0
    buffer_load_dwordx4 v[148:151], v1, s[52:55], s81 offen sc0 sc1
    s_ff1_i32_b64 s80, s[84:85]
    s_bitset0_b64 s[84:85], s80
    s_lshl_b32 s81, s80, 11
    s_add_u32 s81, s81, s75
    s_cmp_ge_i32 s80, 0
    s_cselect_b64 exec, -1, 0
    buffer_load_dwordx4 v[152:155], v1, s[52:55], s81 offen sc0 sc1
    s_ff1_i32_b64 s80, s[84:85]
    s_bitset0_b64 s[84:85], s80
    s_lshl_b32 s81, s80, 11
    s_add_u32 s81, s81, s75
    s_cmp_ge_i32 s80, 0
    s_cselect_b64 exec, -1, 0
    buffer_load_dwordx4 v[156:159], v1, s[52:55], s81 offen sc0 sc1
    s_ff1_i32_b64 s80, s[84:85]
    s_bitset0_b64 s[84:85], s80
    s_lshl_b32 s81, s80, 11
    s_add_u32 s81, s81, s75
    s_cmp_ge_i32 s80, 0
    s_cselect_b64 exec, -1, 0
    buffer_load_dwordx4 v[160:163], v1, s[52:55], s81 offen sc0 sc1
    s_ff1_i32_b64 s80, s[84:85]
    s_bitset0_b64 s[84:85], s80
    s_lshl_b32 s81, s80, 11
    s_add_u32 s81, s81, s75
    s_cmp_ge_i32 s80, 0
    s_cselect_b64 exec, -1, 0
    buffer_load_dwordx4 v[164:167], v1, s[52:55], s81 offen sc0 sc1
    s_ff1_i32_b64 s80, s[84:85]
    s_bitset0_b64 s[84:85], s80
    s_lshl_b32 s81, s80, 11
    s_add_u32 s81, s81, s75
    s_cmp_ge_i32 s80, 0
    s_cselect_b64 exec, -1, 0
    buffer_load_dwordx4 v[168:171], v1, s[52:55], s81 offen sc0 sc1
    s_ff1_i32_b64 s80, s[84:85]
    s_bitset0_b64 s[84:85], s80
    s_lshl_b32 s81, s80, 11
    s_add_u32 s81, s81, s75
    s_cmp_ge_i32 s80, 0
    s_cselect_b64 exec, -1, 0
    buffer_load_dwordx4 v[172:175], v1, s[52:55], s81 offen sc0 sc1
L_got:
    s_mov_b64 exec, -1
    s_waitcnt vmcnt(0)
    v_max_f32 v5, v51, v55
    v_max3_f32 v5, v5, v59, v63
    v_max3_f32 v5, v5, v67, v71
    v_max3_f32 v5, v5, v75, v79
    v_max3_f32 v5, v5, v83, v87
    v_max3_f32 v5, v5, v91, v95
    v_max3_f32 v5, v5, v99, v103
    v_max3_f32 v5, v5, v107, v111
    v_max3_f32 v5, v5, v115, v119
    v_max3_f32 v5, v5, v123, v127
    v_max3_f32 v5, v5, v131, v135
    v_max3_f32 v5, v5, v139, v143
    v_max3_f32 v5, v5, v147, v151
    v_max3_f32 v5, v5, v155, v159
    v_max3_f32 v5, v5, v163, v167
    s_branch L_x3
L_w3:
    s_branch L_w4
L_x3:
    v_max3_f32 v5, v5, v171, v175
    s_nop 1
    v_max_f32_dpp v6, v5, v7 quad_perm:[0,0,2,2] row_mask:0xf bank_mask:0xf
    v_sub_f32 v5, v7, v6
    v_exp_f32 v5, v5
    v_mov_b32 v7, v6
    v_mul_f32 v8, v8, v5
    v_mul_f32 v12, v12, v5
    v_mul_f32 v13, v13, v5
    v_mul_f32 v14, v14, v5
    v_sub_f32_dpp v20, v51, v6 quad_perm:[0,0,2,2] row_mask:0xf bank_mask:0xf
    v_sub_f32_dpp v21, v55, v6 quad_perm:[0,0,2,2] row_mask:0xf bank_mask:0xf
    v_sub_f32_dpp v22, v59, v6 quad_perm:[0,0,2,2] row_mask:0xf bank_mask:0xf
    v_sub_f32_dpp v23, v63, v6 quad_perm:[0,0,2,2] row_mask:0xf bank_mask:0xf
    v_sub_f32_dpp v24, v67, v6 quad_perm:[0,0,2,2] row_mask:0xf bank_mask:0xf
    v_sub_f32_dpp v25, v71, v6 quad_perm:[0,0,2,2] row_mask:0xf bank_mask:0xf
    v_sub_f32_dpp v26, v75, v6 quad_perm:[0,0,2,2] row_mask:0xf bank_mask:0xf
    v_sub_f32_dpp v27, v79, v6 quad_perm:[0,0,2,2] row_mask:0xf bank_mask:0xf
    v_exp_f32 v20, v20
    v_exp_f32 v21, v21
    v_exp_f32 v22, v22
    v_exp_f32 v23, v23
    v_exp_f32 v24, v24
    v_exp_f32 v25, v25
    v_exp_f32 v26, v26
    v_exp_f32 v27, v27
    s_nop 0
    v_fmac_f32 v12, v20, v48
    v_fmac_f32 v13, v20, v49
    v_fmac_f32 v14, v20, v50
    v_fmac_f32 v8, v20, v51
    v_fmac_f32 v12, v21, v52
    v_fmac_f32 v13, v21, v53
    v_fmac_f32 v14, v21, v54
    v_fmac_f32 v8, v21, v55
    v_fmac_f32 v12, v22, v56
    v_fmac_f32 v13, v22, v57
    v_fmac_f32 v14, v22, v58
    v_fmac_f32 v8, v22, v59
    v_fmac_f32 v12, v23, v60
    v_fmac_f32 v13, v23, v61
    v_fmac_f32 v14, v23, v62
    v_fmac_f32 v8, v23, v63
    v_fmac_f32 v12, v24, v64
    v_fmac_f32 v13, v24, v65
    v_fmac_f32 v14, v24, v66
    v_fmac_f32 v8, v24, v67
    v_fmac_f32 v12, v25, v68
    v_fmac_f32 v13, v25, v69
    v_fmac_f32 v14, v25, v70
    v_fmac_f32 v8, v25, v71
    v_fmac_f32 v12, v26, v72
    v_fmac_f32 v13, v26, v73
    v_fmac_f32 v14, v26, v74
    v_fmac_f32 v8, v26, v75
    v_fmac_f32 v12, v27, v76
    v_fmac_f32 v13, v27, v77
    v_fmac_f32 v14, v27, v78
    v_fmac_f32 v8, v27, v79
    v_sub_f32_dpp v20, v83, v6 quad_perm:[0,0,2,2] row_mask:0xf bank_mask:0xf
    v_sub_f32_dpp v21, v87, v6 quad_perm:[0,0,2,2] row_mask:0xf bank_mask:0xf
    v_sub_f32_dpp v22, v91, v6 quad_perm:[0,0,2,2] row_mask:0xf bank_mask:0xf
    v_sub_f32_dpp v23, v95, v6 quad_perm:[0,0,2,2] row_mask:0xf bank_mask:0xf
    v_sub_f32_dpp v24, v99, v6 quad_perm:[0,0,2,2] row_mask:0xf bank_mask:0xf
    v_sub_f32_dpp v25, v103, v6 quad_perm:[0,0,2,2] row_mask:0xf bank_mask:0xf
    v_sub_f32_dpp v26, v107, v6 quad_perm:[0,0,2,2] row_mask:0xf bank_mask:0xf
    v_sub_f32_dpp v27, v111, v6 quad_perm:[0,0,2,2] row_mask:0xf bank_mask:0xf
    v_exp_f32 v20, v20
    v_exp_f32 v21, v21
    v_exp_f32 v22, v22
    v_exp_f32 v23, v23
    v_exp_f32 v24, v24
    v_exp_f32 v25, v25
    v_exp_f32 v26, v26
    v_exp_f32 v27, v27
    s_nop 0
    v_fmac_f32 v12, v20, v80
    v_fmac_f32 v13, v20, v81
    v_fmac_f32 v14, v20, v82
    v_fmac_f32 v8, v20, v83
    v_fmac_f32 v12, v21, v84
    v_fmac_f32 v13, v21, v85
    v_fmac_f32 v14, v21, v86
    v_fmac_f32 v8, v21, v87
    v_fmac_f32 v12, v22, v88
    v_fmac_f32 v13, v22, v89
    v_fmac_f32 v14, v22, v90
    v_fmac_f32 v8, v22, v91
    v_fmac_f32 v12, v23, v92
    v_fmac_f32 v13, v23, v93
    v_fmac_f32 v14, v23, v94
    v_fmac_f32 v8, v23, v95
    v_fmac_f32 v12, v24, v96
    v_fmac_f32 v13, v24, v97
    v_fmac_f32 v14, v24, v98
    v_fmac_f32 v8, v24, v99
    v_fmac_f32 v12, v25, v100
    v_fmac_f32 v13, v25, v101
    v_fmac_f32 v14, v25, v102
    v_fmac_f32 v8, v25, v103
    v_fmac_f32 v12, v26, v104
    v_fmac_f32 v13, v26, v105
    v_fmac_f32 v14, v26, v106
    v_fmac_f32 v8, v26, v107
    v_fmac_f32 v12, v27, v108
    v_fmac_f32 v13, v27, v109
    v_fmac_f32 v14, v27, v110
    v_fmac_f32 v8, v27, v111
    v_sub_f32_dpp v20, v115, v6 quad_perm:[0,0,2,2] row_mask:0xf bank_mask:0xf
    v_sub_f32_dpp v21, v119, v6 quad_perm:[0,0,2,2] row_mask:0xf bank_mask:0xf
    v_sub_f32_dpp v22, v123, v6 quad_perm:[0,0,2,2] row_mask:0xf bank_mask:0xf
    v_sub_f32_dpp v23, v127, v6 quad_perm:[0,0,2,2] row_mask:0xf bank_mask:0xf
    v_sub_f32_dpp v24, v131, v6 quad_perm:[0,0,2,2] row_mask:0xf bank_mask:0xf
    v_sub_f32_dpp v25, v135, v6 quad_perm:[0,0,2,2] row_mask:0xf bank_mask:0xf
    v_sub_f32_dpp v26, v139, v6 quad_perm:[0,0,2,2] row_mask:0xf bank_mask:0xf
    v_sub_f32_dpp v27, v143, v6 quad_perm:[0,0,2,2] row_mask:0xf bank_mask:0xf
    v_exp_f32 v20, v20
    v_exp_f32 v21, v21
    v_exp_f32 v22, v22
    v_exp_f32 v23, v23
    v_exp_f32 v24, v24
    v_exp_f32 v25, v25
    v_exp_f32 v26, v26
    v_exp_f32 v27, v27
    s_nop 0
    v_fmac_f32 v12, v20, v112
    v_fmac_f32 v13, v20, v113
    v_fmac_f32 v14, v20, v114
    v_fmac_f32 v8, v20, v115
    v_fmac_f32 v12, v21, v116
    v_fmac_f32 v13, v21, v117
    v_fmac_f32 v14, v21, v118
    v_fmac_f32 v8, v21, v119
    v_fmac_f32 v12, v22, v120
    v_fmac_f32 v13, v22, v121
    v_fmac_f32 v14, v22, v122
    v_fmac_f32 v8, v22, v123
    v_fmac_f32 v12, v23, v124
    v_fmac_f32 v13, v23, v125
    v_fmac_f32 v14, v23, v126
    v_fmac_f32 v8, v23, v127
    v_fmac_f32 v12, v24, v128
    v_fmac_f32 v13, v24, v129
    v_fmac_f32 v14, v24, v130
    v_fmac_f32 v8, v24, v131
    v_fmac_f32 v12, v25, v132
    v_fmac_f32 v13, v25, v133
    v_fmac_f32 v14, v25, v134
    v_fmac_f32 v8, v25, v135
    v_fmac_f32 v12, v26, v136
    v_fmac_f32 v13, v26, v137
    v_fmac_f32 v14, v26, v138
    v_fmac_f32 v8, v26, v139
    v_fmac_f32 v12, v27, v140
    v_fmac_f32 v13, v27, v141
    v_fmac_f32 v14, v27, v142
    v_fmac_f32 v8, v27, v143
    v_sub_f32_dpp v20, v147, v6 quad_perm:[0,0,2,2] row_mask:0xf bank_mask:0xf
    v_sub_f32_dpp v21, v151, v6 quad_perm:[0,0,2,2] row_mask:0xf bank_mask:0xf
    v_sub_f32_dpp v22, v155, v6 quad_perm:[0,0,2,2] row_mask:0xf bank_mask:0xf
    v_sub_f32_dpp v23, v159, v6 quad_perm:[0,0,2,2] row_mask:0xf bank_mask:0xf
    v_sub_f32_dpp v24, v163, v6 quad_perm:[0,0,2,2] row_mask:0xf bank_mask:0xf
    v_sub_f32_dpp v25, v167, v6 quad_perm:[0,0,2,2] row_mask:0xf bank_mask:0xf
    v_sub_f32_dpp v26, v171, v6 quad_perm:[0,0,2,2] row_mask:0xf bank_mask:0xf
    v_sub_f32_dpp v27, v175, v6 quad_perm:[0,0,2,2] row_mask:0xf bank_mask:0xf
    v_exp_f32 v20, v20
    v_exp_f32 v21, v21
    v_exp_f32 v22, v22
    v_exp_f32 v23, v23
    v_exp_f32 v24, v24
    v_exp_f32 v25, v25
    v_exp_f32 v26, v26
    v_exp_f32 v27, v27
    s_nop 0
    v_fmac_f32 v12, v20, v144
    v_fmac_f32 v13, v20, v145
    v_fmac_f32 v14, v20, v146
    v_fmac_f32 v8, v20, v147
    v_fmac_f32 v12, v21, v148
    v_fmac_f32 v13, v21, v149
    v_fmac_f32 v14, v21, v150
    v_fmac_f32 v8, v21, v151
    v_fmac_f32 v12, v22, v152
    v_fmac_f32 v13, v22, v153
    v_fmac_f32 v14, v22, v154
    v_fmac_f32 v8, v22, v155
    v_fmac_f32 v12, v23, v156
    v_fmac_f32 v13, v23, v157
    v_fmac_f32 v14, v23, v158
    v_fmac_f32 v8, v23, v159
    v_fmac_f32 v12, v24, v160
    v_fmac_f32 v13, v24, v161
    v_fmac_f32 v14, v24, v162
    v_fmac_f32 v8, v24, v163
    v_fmac_f32 v12, v25, v164
    v_fmac_f32 v13, v25, v165
    v_fmac_f32 v14, v25, v166
    v_fmac_f32 v8, v25, v167
    v_fmac_f32 v12, v26, v168
    v_fmac_f32 v13, v26, v169
    v_fmac_f32 v14, v26, v170
    v_fmac_f32 v8, v26, v171
    v_fmac_f32 v12, v27, v172
    v_fmac_f32 v13, v27, v173
    v_fmac_f32 v14, v27, v174
    v_fmac_f32 v8, v27, v175
    s_cmp_lg_u64 s[84:85], 0
    s_cbranch_scc1 L_chunk
    s_cmp_lg_u32 s74, 0
    s_cbranch_scc1 L_fin
    v_cndmask_b32 v15, v7, v8, s[66:67]
    v_mov_b32 v5, s95
    s_and_b32 s79, s97, 31
    s_lshr_b32 s80, s97, 10
    s_lshl_b32 s80, s80, 3
    s_and_b32 s83, s72, 7
    s_add_u32 s80, s80, s83
    s_bfm_b64 s[88:89], 1, s80
    s_bfe_u32 s83, s97, 0x50005
    s_mul_i32 s83, s83, s70
    s_cmp_lg_u32 s83, 512
    s_cbranch_scc1 L_rec
    s_mov_b64 exec, 1
    buffer_store_dword v5, v3, s[52:55], s77 offen offset:1028
    s_mov_b64 exec, -1
    s_branch L_fin
L_rec:
    s_lshl_b32 s83, s83, 16
    s_or_b32 s89, s89, s83
    v_mov_b32 v16, s88
    v_mov_b32 v17, s89
    s_lshl_b32 s75, s79, 17
    s_add_u32 s75, s75, 4194304
    s_lshl_b32 s80, s80, 11
    s_add_u32 s80, s80, s75
    buffer_store_dwordx4 v[12:15], v1, s[52:55], s80 offen sc0 sc1
    s_mov_b64 exec, 1
    buffer_store_dword v5, v3, s[52:55], s77 offen offset:1028
    s_lshl_b32 s80, s79, 8
    s_add_u32 s80, s80, 23076864
    s_waitcnt vmcnt(0)
    buffer_atomic_add_x2 v[16:17], v3, s[52:55], s80 offen sc0 sc1
    s_waitcnt vmcnt(0)
    s_mov_b64 exec, -1
    v_readfirstlane_b32 s84, v16
    v_readfirstlane_b32 s85, v17
    s_add_u32 s84, s84, s88
    s_add_u32 s85, s85, s89
    s_lshr_b32 s80, s85, 16
    s_cmp_lg_u32 s80, 512
    s_cbranch_scc1 L_next
    s_mov_b32 s74, 1
    s_and_b32 s85, s85, 0xffff
    s_branch L_merge
L_fin:
    s_nop 1
    v_mov_b32_dpp v5, v8 quad_perm:[1,1,3,3] row_mask:0xf bank_mask:0xf
    v_rcp_f32 v5, v5
    s_mul_i32 s80, s79, 384
    v_mul_f32 v12, v12, v5
    v_mul_f32 v13, v13, v5
    v_mul_f32 v14, v14, v5
    v_cvt_pk_bf16_f32 v12, v12, v12
    v_cvt_pk_bf16_f32 v13, v13, v13
    v_cvt_pk_bf16_f32 v14, v14, v14
    buffer_store_short v12, v11, s[56:59], s80 offen offset:0
    buffer_store_short v13, v11, s[56:59], s80 offen offset:128
    buffer_store_short v14, v11, s[56:59], s80 offen offset:256
L_next:
    s_add_u32 s71, s71, s70
    s_branch L_round
L_last:
    s_lshl_b32 s75, s96, 9
    s_add_u32 s75, s75, 1572864
    v_lshrrev_b32 v6, 1, v0
    v_lshlrev_b32 v28, 4, v6
L_inf:
    buffer_load_dwordx4 v[48:51], v28, s[52:55], s75 offen sc0 sc1
    s_waitcnt vmcnt(0)
    v_cmp_ne_u32 vcc, s69, v49
    s_cmp_lg_u64 vcc, 0
    s_cbranch_scc1 L_inf
    v_mov_b32 v7, v50
    s_nop 1
    v_max_f32_dpp v7, v7, v7 row_ror:8 row_mask:0xf bank_mask:0xf
    s_nop 1
    v_max_f32_dpp v7, v7, v7 row_ror:4 row_mask:0xf bank_mask:0xf
    s_nop 1
    v_max_f32_dpp v7, v7, v7 row_ror:2 row_mask:0xf bank_mask:0xf
    s_nop 1
    v_max_f32_dpp v7, v7, v7 row_ror:1 row_mask:0xf bank_mask:0xf
    v_mov_b32 v5, v7
    s_nop 1
    v_permlane32_swap_b32 v7, v5
    s_nop 1
    v_max_f32 v7, v7, v5
    v_mov_b32 v5, v7
    s_nop 1
    v_permlane16_swap_b32 v7, v5
    s_nop 1
    v_max_f32 v7, v7, v5
    v_sub_f32 v20, v50, v7
    v_exp_f32 v20, v20
    s_nop 0
    v_mul_f32 v8, v20, v51
    s_nop 1
    v_add_f32_dpp v8, v8, v8 row_ror:8 row_mask:0xf bank_mask:0xf
    s_nop 1
    v_add_f32_dpp v8, v8, v8 row_ror:4 row_mask:0xf bank_mask:0xf
    s_nop 1
    v_add_f32_dpp v8, v8, v8 row_ror:2 row_mask:0xf bank_mask:0xf
    s_nop 1
    v_add_f32_dpp v8, v8, v8 row_ror:1 row_mask:0xf bank_mask:0xf
    v_mov_b32 v5, v8
    s_nop 1
    v_permlane32_swap_b32 v8, v5
    s_nop 1
    v_add_f32 v8, v8, v5
    v_mov_b32 v5, v8
    s_nop 1
    v_permlane16_swap_b32 v8, v5
    s_nop 1
    v_add_f32 v8, v8, v5
    v_rcp_f32 v8, v8
    v_and_b32 v5, 1, v0
    v_mul_f32 v8, 2.0, v8
    v_mul_f32 v20, v20, v8
    v_lshlrev_b32 v28, 11, v6
    v_lshl_add_u32 v28, v5, 4, v28
    s_lshl_b32 s75, s96, 16
    s_lshl_b32 s80, s92, 5
    s_add_u32 s75, s75, s80
    v_mov_b32 v51, 0
    v_mov_b32 v55, 0
    v_mov_b32 v59, 0
    v_mov_b32 v63, 0
    v_mov_b32 v12, 0
    v_mov_b32 v13, 0
    v_mov_b32 v14, 0
    v_bfe_u32 v6, v0, 4, 1
    v_lshrrev_b32 v11, 5, v0
    v_lshl_add_u32 v11, v6, 1, v11
    v_lshlrev_b32 v11, 7, v11
    v_lshl_add_u32 v11, v5, 3, v11
    s_and_b32 s80, s92, 7
    s_lshl_b32 s80, s80, 4
    s_lshr_b32 s81, s92, 3
    s_lshl_b32 s81, s81, 1
    s_add_u32 s80, s80, s81
    s_add_u32 s79, s96, 24
    s_mul_i32 s78, s79, 384
    s_add_u32 s78, s78, s80
    s_mov_b64 s[24:25], -1
    s_mov_b32 s32, 0x00030003
    s_mov_b32 s33, 0x00000003
L_dt:
    ds_read_b32 v5, v3 offset:144
    s_waitcnt lgkmcnt(0)
    v_readfirstlane_b32 s80, v5
    s_cmp_eq_u32 s80, 0
    s_cbranch_scc1 L_dt
L_pa:
    buffer_load_dwordx4 v[48:51], v28, s[52:55], s75 offen offset:0 sc0 sc1
    s_waitcnt vmcnt(0)
    v_cmpx_eq_u32 vcc, s69, v51
    v_fmac_f32 v12, v20, v48
    v_fmac_f32 v13, v20, v49
    v_fmac_f32 v14, v20, v50
    s_andn2_b64 s[24:25], s[24:25], vcc
    s_mov_b64 exec, s[24:25]
    s_bcnt1_i32_b64 s80, s[24:25]
    s_cmp_gt_u32 s80, 0
    s_cbranch_scc1 L_pa
L_pd:
    s_mov_b64 exec, -1
    v_mov_b32 v15, v14
    v_permlane32_swap_b32 v12, v13
    s_nop 0
    v_permlane32_swap_b32 v14, v15
    v_add_f32 v12, v12, v13
    v_add_f32 v14, v14, v15
    s_nop 1
    v_permlane16_swap_b32 v12, v14
    v_add_f32 v12, v12, v14
    s_nop 1
    v_add_f32_dpp v12, v12, v12 row_ror:8 row_mask:0xf bank_mask:0xf
    s_nop 1
    v_add_f32_dpp v12, v12, v12 row_ror:4 row_mask:0xf bank_mask:0xf
    s_nop 1
    v_add_f32_dpp v12, v12, v12 row_ror:2 row_mask:0xf bank_mask:0xf
    s_mov_b64 exec, s[32:33]
    v_cvt_pk_bf16_f32 v12, v12, v12
    buffer_store_short v12, v11, s[56:59], s78 offen
L_end:
    s_endpgm
L_ticket:
    v_lshlrev_b32 v1, 2, v0
    v_mov_b32 v2, 0
    v_lshlrev_b32 v4, 4, v0
    v_mov_b32 v8, -1
    v_mov_b32 v9, -1
    v_mov_b32 v10, -1
    v_mov_b32 v11, -1
    ds_write_b128 v4, v[8:11] offset:256
    ds_write_b128 v4, v[8:11] offset:1280
    ds_write_b128 v4, v[8:11] offset:2304
    s_memrealtime s[80:81]
    s_waitcnt lgkmcnt(0)
    s_barrier
    s_mov_b32 s52, s22
    s_and_b32 s53, s23, 0xffff
    s_mov_b32 s54, 25165824
    s_mov_b32 s55, 0x00020000
    s_mov_b32 s60, s20
    s_and_b32 s61, s21, 0xffff
    s_mov_b32 s62, 256
    s_mov_b32 s63, 0x00020000
    s_max_u32 s69, s80, 1
    s_cmp_lg_u32 s2, 0
    s_cbranch_scc1 L_kd
    v_lshlrev_b32 v5, 8, v0
    s_mov_b32 s80, 23068672
    v_mov_b32 v3, 0
    buffer_store_dwordx2 v[2:3], v5, s[52:55], s80 offen sc0 sc1
    v_mov_b32 v3, s69
    s_mov_b64 exec, 1
    s_waitcnt vmcnt(0)
    buffer_store_dword v3, v2, s[60:63], 0 offen sc0 sc1
    s_mov_b64 exec, -1
L_kd:
    ds_read_b32 v3, v2 offset:128
    s_waitcnt lgkmcnt(0)
    v_readfirstlane_b32 s80, v3
    s_cmp_eq_u32 s80, 0
    s_cbranch_scc1 L_kd
    ds_read_b128 v[24:27], v4 offset:16128
    ds_read_b128 v[28:31], v4 offset:17152
    ds_read_b128 v[32:35], v4 offset:18176
    ds_read_b128 v[36:39], v4 offset:19200
    s_waitcnt lgkmcnt(0)
    v_max_f32 v18, v24, v25
    v_max3_f32 v18, v18, v26, v27
    v_max3_f32 v18, v18, v28, v29
    v_max3_f32 v18, v18, v30, v31
    v_max3_f32 v18, v18, v32, v33
    v_max3_f32 v18, v18, v34, v35
    v_max3_f32 v18, v18, v36, v37
    v_max3_f32 v18, v18, v38, v39
    s_nop 1
    v_max_f32_dpp v18, v18, v18 row_ror:8 row_mask:0xf bank_mask:0xf
    s_nop 1
    v_max_f32_dpp v18, v18, v18 row_ror:4 row_mask:0xf bank_mask:0xf
    s_nop 1
    v_max_f32_dpp v18, v18, v18 row_ror:2 row_mask:0xf bank_mask:0xf
    s_nop 1
    v_max_f32_dpp v18, v18, v18 row_ror:1 row_mask:0xf bank_mask:0xf
    v_mov_b32 v3, v18
    s_nop 1
    v_permlane32_swap_b32 v18, v3
    s_nop 1
    v_max_f32 v18, v18, v3
    v_mov_b32 v3, v18
    s_nop 1
    v_permlane16_swap_b32 v18, v3
    s_nop 1
    v_max_f32 v18, v18, v3
    v_sub_f32 v24, v24, v18
    v_sub_f32 v25, v25, v18
    v_sub_f32 v26, v26, v18
    v_sub_f32 v27, v27, v18
    v_sub_f32 v28, v28, v18
    v_sub_f32 v29, v29, v18
    v_sub_f32 v30, v30, v18
    v_sub_f32 v31, v31, v18
    v_sub_f32 v32, v32, v18
    v_sub_f32 v33, v33, v18
    v_sub_f32 v34, v34, v18
    v_sub_f32 v35, v35, v18
    v_sub_f32 v36, v36, v18
    v_sub_f32 v37, v37, v18
    v_sub_f32 v38, v38, v18
    v_sub_f32 v39, v39, v18
    v_exp_f32 v24, v24
    v_exp_f32 v25, v25
    v_exp_f32 v26, v26
    v_exp_f32 v27, v27
    v_exp_f32 v28, v28
    v_exp_f32 v29, v29
    v_exp_f32 v30, v30
    v_exp_f32 v31, v31
    v_exp_f32 v32, v32
    v_exp_f32 v33, v33
    v_exp_f32 v34, v34
    v_exp_f32 v35, v35
    v_exp_f32 v36, v36
    v_exp_f32 v37, v37
    v_exp_f32 v38, v38
    v_exp_f32 v39, v39
    ds_write_b32 v2, v18 offset:160
    v_add_f32 v19, v24, v25
    v_add_f32 v19, v19, v26
    v_add_f32 v19, v19, v27
    v_add_f32 v19, v19, v28
    v_add_f32 v19, v19, v29
    v_add_f32 v19, v19, v30
    v_add_f32 v19, v19, v31
    v_add_f32 v19, v19, v32
    v_add_f32 v19, v19, v33
    v_add_f32 v19, v19, v34
    v_add_f32 v19, v19, v35
    v_add_f32 v19, v19, v36
    v_add_f32 v19, v19, v37
    v_add_f32 v19, v19, v38
    v_add_f32 v19, v19, v39
    s_nop 1
    v_add_f32_dpp v19, v19, v19 row_ror:8 row_mask:0xf bank_mask:0xf
    s_nop 1
    v_add_f32_dpp v19, v19, v19 row_ror:4 row_mask:0xf bank_mask:0xf
    s_nop 1
    v_add_f32_dpp v19, v19, v19 row_ror:2 row_mask:0xf bank_mask:0xf
    s_nop 1
    v_add_f32_dpp v19, v19, v19 row_ror:1 row_mask:0xf bank_mask:0xf
    v_mov_b32 v3, v19
    s_nop 1
    v_permlane32_swap_b32 v19, v3
    s_nop 1
    v_add_f32 v19, v19, v3
    v_mov_b32 v3, v19
    s_nop 1
    v_permlane16_swap_b32 v19, v3
    s_nop 1
    v_add_f32 v19, v19, v3
    s_lshl_b32 s80, s2, 11
    s_add_u32 s80, s80, 18874368
    s_waitcnt lgkmcnt(0)
    s_mov_b64 exec, -1
L_tg:
    buffer_load_dword v3, v2, s[60:63], 0 offen sc0 sc1
    s_waitcnt vmcnt(0)
    v_readfirstlane_b32 s69, v3
    s_cmp_eq_u32 s69, 0
    s_cbranch_scc1 L_tg
    s_getreg_b32 s81, hwreg(HW_REG_XCC_ID)
    s_and_b32 s81, s81, 15
    v_mov_b32 v16, s81
    v_mov_b32 v17, s69
    s_lshl_b32 s80, s2, 11
    s_mov_b64 exec, 1
    s_lshl_b32 s82, s2, 4
    s_add_u32 s82, s82, 1572864
    buffer_store_dwordx4 v[16:19], v2, s[52:55], s82 offen sc0 sc1
    v_mov_b32 v12, s69
    v_mov_b32 v13, s69
    s_add_u32 s82, s80, 2097152
    buffer_store_dwordx2 v[12:13], v2, s[52:55], s82 offen offset:1024
    s_add_u32 s82, s80, 2621440
    buffer_store_dwordx2 v[12:13], v2, s[52:55], s82 offen offset:1024
    s_mov_b64 exec, -1
    s_mov_b32 s73, s81
    s_lshl_b32 s80, s79, 2
    s_lshr_b32 s74, 0x54564564, s80
    s_and_b32 s74, s74, 15
    s_mov_b32 s75, 0
    s_mov_b32 s95, s69
    s_lshl_b32 s77, s2, 11
    s_lshl_b32 s94, s79, 16
    s_mov_b32 s76, 2097152
    v_mov_b32 v19, 0
    v_lshlrev_b32 v20, 11, v0
    v_mov_b32 v21, v4
L_fl:
    ds_read_b32 v3, v19
    s_waitcnt lgkmcnt(0)
    v_readfirstlane_b32 s80, v3
    s_cmp_eq_u32 s80, 0
    s_cbranch_scc1 L_fl
    ds_read_b128 v[24:27], v21 offset:20480
    ds_read_b128 v[28:31], v21 offset:21504
    ds_read_b128 v[32:35], v21 offset:22528
    ds_read_b128 v[36:39], v21 offset:23552
    s_waitcnt lgkmcnt(0)
    s_nop 0
    v_add_f32_dpp v37, v37, v37 row_ror:8 row_mask:0xf bank_mask:0xf
    v_add_f32_dpp v38, v38, v38 row_ror:8 row_mask:0xf bank_mask:0xf
    s_nop 0
    v_add_f32_dpp v37, v37, v37 row_ror:4 row_mask:0xf bank_mask:0xf
    v_add_f32_dpp v38, v38, v38 row_ror:4 row_mask:0xf bank_mask:0xf
    s_nop 0
    v_add_f32_dpp v37, v37, v37 row_ror:2 row_mask:0xf bank_mask:0xf
    v_add_f32_dpp v38, v38, v38 row_ror:2 row_mask:0xf bank_mask:0xf
    s_nop 0
    v_add_f32_dpp v37, v37, v37 row_ror:1 row_mask:0xf bank_mask:0xf
    v_add_f32_dpp v38, v38, v38 row_ror:1 row_mask:0xf bank_mask:0xf
    v_mov_b32 v40, v36
    v_mov_b32 v41, v36
    s_nop 1
    v_permlane32_swap_b32 v40, v41
    s_nop 1
    v_max_f32 v40, v40, v41
    v_mov_b32 v41, v40
    s_nop 1
    v_permlane16_swap_b32 v40, v41
    s_nop 1
    v_max_f32 v40, v40, v41
    v_sub_f32 v41, v36, v40
    v_exp_f32 v41, v41
    v_mov_b32 v48, v40
    v_mul_f32 v37, v37, v41
    v_mul_f32 v38, v38, v41
    v_mul_f32 v41, 0x58000000, v41
    v_fma_f32 v24, v24, v41, -v38
    v_fma_f32 v25, v25, v41, -v38
    v_fma_f32 v26, v26, v41, -v38
    v_fma_f32 v27, v27, v41, -v38
    v_fma_f32 v28, v28, v41, -v38
    v_fma_f32 v29, v29, v41, -v38
    v_fma_f32 v30, v30, v41, -v38
    v_fma_f32 v31, v31, v41, -v38
    v_fma_f32 v32, v32, v41, -v38
    v_fma_f32 v33, v33, v41, -v38
    v_fma_f32 v34, v34, v41, -v38
    v_fma_f32 v35, v35, v41, -v38
    v_mov_b32 v40, v37
    s_nop 1
    v_permlane32_swap_b32 v37, v40
    v_permlane32_swap_b32 v24, v26
    v_permlane32_swap_b32 v25, v27
    v_permlane32_swap_b32 v28, v30
    v_permlane32_swap_b32 v29, v31
    v_permlane32_swap_b32 v32, v34
    v_permlane32_swap_b32 v33, v35
    s_nop 1
    v_add_f32 v37, v37, v40
    v_add_f32 v24, v24, v26
    v_add_f32 v25, v25, v27
    v_add_f32 v28, v28, v30
    v_add_f32 v29, v29, v31
    v_add_f32 v32, v32, v34
    v_add_f32 v33, v33, v35
    v_mov_b32 v40, v37
    s_nop 1
    v_permlane16_swap_b32 v37, v40
    v_permlane16_swap_b32 v24, v25
    v_permlane16_swap_b32 v28, v29
    v_permlane16_swap_b32 v32, v33
    s_nop 1
    v_add_f32 v49, v37, v40
    v_add_f32 v44, v24, v25
    v_add_f32 v45, v28, v29
    v_add_f32 v46, v32, v33
    v_mov_b32 v8, v44
    v_mov_b32 v9, v45
    v_mov_b32 v10, v46
    v_cndmask_b32 v11, v48, v49, s[66:67]
    s_cmp_eq_u32 s75, 1
    s_cbranch_scc1 L_dep
    s_cmp_lg_u32 s75, 0
    s_cbranch_scc1 L_guard
    s_lshr_b32 s82, s3, 5
    s_lshl_b32 s83, s79, 9
    s_add_u32 s83, s83, 1572864
    s_bfm_b64 exec, 32, 0
L_reg:
    buffer_load_dwordx2 v[12:13], v4, s[52:55], s83 offen sc0 sc1
    s_waitcnt vmcnt(0)
    v_cmp_ne_u32 vcc, s69, v13
    s_cmp_lg_u64 vcc, 0
    s_cbranch_scc1 L_reg
    v_cmp_eq_u32 s[86:87], s73, v12
    s_nop 1
    v_mov_b32 v14, s86
    v_mov_b32 v15, s87
    ds_write_b64 v2, v[14:15] offset:152
    s_waitcnt lgkmcnt(0)
    ds_write_b32 v2, v13 offset:140
    s_mov_b64 exec, -1
    s_branch L_dep
L_guard:
    s_sub_u32 s80, s95, 1
    s_add_u32 s81, s94, s76
L_guard2:
    v_mov_b32 v12, s69
    s_mov_b64 exec, s[86:87]
    buffer_load_dword v12, v20, s[52:55], s81 offen offset:1028 sc0 sc1
    s_mov_b64 exec, -1
    s_waitcnt vmcnt(0)
    v_cmp_eq_u32 vcc, s80, v12
    s_cmp_eq_u64 vcc, 0
    s_cbranch_scc1 L_guard2
L_dep:
    s_add_u32 s75, s75, 1
    s_add_u32 s95, s95, 1
    s_add_u32 s80, s77, s76
    v_mov_b32 v3, s95
    s_waitcnt lgkmcnt(0)
    buffer_store_dwordx4 v[8:11], v4, s[52:55], s80 offen
    s_mov_b64 exec, 1
    s_waitcnt vmcnt(0)
    buffer_store_dword v3, v2, s[52:55], s80 offen offset:1024
    s_mov_b64 exec, -1
    s_xor_b32 s76, s76, 0x80000
    v_add_u32 v21, 4096, v21
    v_add_u32 v19, 4, v19
    s_cmp_lt_u32 s75, s74
    s_cbranch_scc1 L_fl
    s_endpgm
L_ctl:
    v_lshlrev_b32 v1, 2, v0
    v_mov_b32 v2, 0
    ds_write_b32 v1, v2 offset:3328
    s_and_b32 s70, s2, 31
    s_lshl_b32 s70, s70, 2
    s_mov_b32 s71, 1
    v_mov_b32 v7, s2
    v_and_b32 v10, 15, v0
    v_lshrrev_b32 v8, 5, v7
    v_lshl_add_u32 v10, v8, 4, v10
    v_lshrrev_b32 v9, 4, v0
    v_lshl_add_u32 v10, v9, 7, v10
    s_lshl_b32 s82, s79, 3
    s_mov_b32 s80, 0xf1f6fb00
    s_mov_b32 s81, 0xdde2e7ec
    s_lshr_b64 s[80:81], s[80:81], s82
    s_sext_i32_i8 s80, s80
    s_mov_b32 exec_lo, 0x0
    s_mov_b32 exec_hi, 0x7ff
    v_add_u32 v10, s80, v10
    s_mov_b32 s80, 0x2c37424d
    s_mov_b32 s81, 0xb1621
    s_lshr_b64 s[80:81], s[80:81], s82
    s_sext_i32_i8 s80, s80
    s_mov_b32 exec_lo, 0x0
    s_mov_b32 exec_hi, 0xf800
    v_add_u32 v10, s80, v10
    s_mov_b64 exec, -1
    v_and_b32 v9, 3, v7
    v_lshl_add_u32 v8, v10, 2, v9
    v_bfe_u32 v9, v7, 2, 3
    v_lshl_add_u32 v8, v8, 3, v9
    v_mul_u32_u24 v9, 384, v8
    v_lshlrev_b32 v8, 7, v8
    s_waitcnt lgkmcnt(0)
    s_barrier
    s_mov_b32 s32, s10
    s_and_b32 s33, s11, 0xffff
    s_mov_b32 s34, 6291456
    s_mov_b32 s35, 0x00020000
    buffer_load_dword v10, v9, s[32:35], 0 offen offset:0
    buffer_load_dword v11, v9, s[32:35], 0 offen offset:128
    buffer_load_dword v12, v9, s[32:35], 0 offen offset:256
    s_mov_b32 s36, s12
    s_and_b32 s37, s13, 0xffff
    s_mov_b32 s38, 6291456
    s_mov_b32 s39, 0x00020000
    buffer_load_dword v13, v9, s[36:39], 0 offen offset:0
    buffer_load_dword v14, v9, s[36:39], 0 offen offset:128
    buffer_load_dword v15, v9, s[36:39], 0 offen offset:256
    s_mov_b32 s40, s14
    s_and_b32 s41, s15, 0xffff
    s_mov_b32 s42, 2097152
    s_mov_b32 s43, 0x00020000
    buffer_load_dword v16, v8, s[40:43], 0 offen offset:0
    s_mov_b32 s44, s16
    s_and_b32 s45, s17, 0xffff
    s_mov_b32 s46, 2097152
    s_mov_b32 s47, 0x00020000
    buffer_load_dword v17, v8, s[44:47], 0 offen offset:0
    s_mov_b32 s60, s20
    s_and_b32 s61, s21, 0xffff
    s_mov_b32 s62, 256
    s_mov_b32 s63, 0x00020000
    s_mov_b32 s52, s22
    s_and_b32 s53, s23, 0xffff
    s_mov_b32 s54, 25165824
    s_mov_b32 s55, 0x00020000
    s_getreg_b32 s76, hwreg(HW_REG_XCC_ID)
    s_and_b32 s76, s76, 15
    s_lshr_b32 s70, s70, 1
    s_and_b32 s75, s2, 31
    s_cmp_eq_u32 s75, 0
    s_cselect_b32 s75, 32, s75
    s_mul_i32 s77, s75, 64
    v_lshlrev_b32 v1, 1, v0
    v_lshlrev_b32 v7, 7, v0
L_c:
    ds_read_b32 v3, v2 offset:3328
    ds_read_b32 v4, v2 offset:144
    s_mov_b64 exec, 1
    s_waitcnt lgkmcnt(0)
    v_add_u32 v3, 1, v3
    buffer_store_short v3, v2, s[60:63], s70 offen offset:128
    s_bfm_b64 exec, 33, 0
    buffer_load_ushort v5, v1, s[60:63], 0 offen offset:128 sc1
    v_readfirstlane_b32 s72, v3
    v_readfirstlane_b32 s81, v4
    s_add_u32 s80, s71, s72
    s_mov_b32 s71, s72
    s_mov_b64 exec, 0xffffffff
    s_waitcnt vmcnt(0)
    v_cmp_ne_u32 vcc, 0, v5
    v_lshlrev_b32 v6, 1, v5
    v_readlane_b32 s86, v5, 32
    v_cmp_le_u32 s[82:83], s80, v6
    s_bcnt1_i32_b64 s73, vcc
    s_cmp_eq_u32 s86, 0
    s_cselect_b32 s86, 1024, s86
    s_bcnt1_i32_b64 s74, s[82:83]
    s_sub_i32 s86, s86, 1003
    s_mul_i32 s80, s73, s86
    s_lshl_b32 s74, s74, 5
    s_cmp_lt_i32 s74, s80
    s_cselect_b32 s86, 1, 0
    s_lshl_b32 s82, s73, 5
    s_add_u32 s74, s74, s82
    s_cmp_lt_i32 s74, s80
    s_cselect_b32 s86, 2, s86
    v_mov_b32 v6, s86
    ds_write_b32 v2, v6 offset:148
    s_cmp_lt_u32 s72, s77
    s_cbranch_scc1 L_cn
    s_memrealtime s[84:85]
    s_add_u32 s77, s77, 2048
    s_lshl_b32 s86, s75, 11
    s_add_u32 s75, s75, 32
    s_cmp_lg_u32 s73, 32
    s_cbranch_scc1 L_cn
    v_add_u32_dpp v5, v5, v5 row_ror:8 row_mask:0xf bank_mask:0xf
    s_nop 1
    v_add_u32_dpp v5, v5, v5 row_ror:4 row_mask:0xf bank_mask:0xf
    s_nop 1
    v_add_u32_dpp v5, v5, v5 row_ror:2 row_mask:0xf bank_mask:0xf
    s_branch L_x4
L_w4:
    s_branch L_walked
L_x4:
    s_nop 1
    v_add_u32_dpp v5, v5, v5 row_ror:1 row_mask:0xf bank_mask:0xf
    s_nop 1
    v_readlane_b32 s74, v5, 0
    v_readlane_b32 s73, v5, 16
    s_add_u32 s86, s86, 3143680
    s_lshl_b32 s80, s76, 7
    s_add_u32 s80, s80, s86
    s_add_u32 s74, s74, s73
    s_lshl_b32 s74, s74, 2
    s_waitcnt lgkmcnt(0)
    s_mul_i32 s73, s84, 13
    s_sub_u32 s74, s74, s73
    v_mov_b32 v8, s74
    v_mov_b32 v9, s84
    s_mov_b64 exec, 1
    buffer_store_dwordx2 v[8:9], v2, s[52:55], s80 offen offset:2048 sc0 sc1
    s_mov_b64 exec, 0xffff
    buffer_load_dwordx2 v[10:11], v7, s[52:55], s86 offen sc0 sc1
    s_waitcnt vmcnt(0)
    v_sub_u32 v9, s84, v11
    v_cmp_gt_u32 vcc, 0x1000, v9
    v_sub_u32 v8, s74, v10
    s_bitset0_b32 vcc_lo, s76
    v_cndmask_b32 v8, 0, v8, vcc
    s_nop 1
    v_add_u32_dpp v8, v8, v8 row_ror:8 row_mask:0xf bank_mask:0xf
    s_nop 1
    v_add_u32_dpp v8, v8, v8 row_ror:4 row_mask:0xf bank_mask:0xf
    s_nop 1
    v_add_u32_dpp v8, v8, v8 row_ror:2 row_mask:0xf bank_mask:0xf
    s_nop 1
    v_add_u32_dpp v8, v8, v8 row_ror:1 row_mask:0xf bank_mask:0xf
    s_nop 1
    v_ashrrev_i32 v8, 9, v8
    v_max_i32 v8, -5, v8
    v_min_i32 v8, 40, v8
    v_add_u32 v8, 0x400, v8
    s_mov_b64 exec, 1
    buffer_store_short v8, v2, s[60:63], 0 offen offset:192
L_cn:
    s_cmp_eq_u32 s81, 0
    s_cbranch_scc1 L_c
    s_endpgm
.section .rodata,"a"
.p2align 6
.amdhsa_kernel standalone__kv_cache_quant_int4_int2_kv_with_per_channel_or_per_token_scales__decode_kernel
  .amdhsa_next_free_vgpr 246
  .amdhsa_next_free_sgpr 102
  .amdhsa_accum_offset 248
  .amdhsa_float_denorm_mode_32 3
  .amdhsa_group_segment_fixed_size 0
  .amdhsa_kernarg_size 80
  .amdhsa_user_sgpr_count 2
  .amdhsa_user_sgpr_kernarg_segment_ptr 1
  .amdhsa_system_sgpr_workgroup_id_x 1
.end_amdhsa_kernel
```

```asm
; @launch grid=(256,1,1) block=(256,1,1) lds=98304
.amdgcn_target "amdgcn-amd-amdhsa--gfx950"
.text
.globl standalone__kv_cache_quant_int4_int2_kv_with_per_channel_or_per_token_scales__decode_kernel
.p2align 12
.type standalone__kv_cache_quant_int4_int2_kv_with_per_channel_or_per_token_scales__decode_kernel,@function
standalone__kv_cache_quant_int4_int2_kv_with_per_channel_or_per_token_scales__decode_kernel:
    s_cmp_ge_u32 s2, 256
    s_cbranch_scc1 L_end
    s_load_dwordx16 s[4:19], s[0:1], 0
    s_load_dwordx4 s[20:23], s[0:1], 64
    s_and_b32 s80, s2, 7
    s_lshr_b32 s2, s2, 3
    s_lshl_b32 s80, s80, 5
    s_or_b32 s2, s2, s80
    s_mov_b32 s3, s2
    v_lshrrev_b32 v229, 6, v0
    v_and_b32 v0, 63, v0
    v_readfirstlane_b32 s68, v229
    s_lshr_b32 s79, s2, 5
    s_and_b32 s92, s2, 31
    s_mov_b32 s66, 0xaaaaaaaa
    s_mov_b32 s67, 0xaaaaaaaa
    s_cmp_eq_u32 s68, 1
    s_cbranch_scc1 L_service
    s_cmp_eq_u32 s68, 2
    s_cbranch_scc1 L_ticket
    s_cmp_eq_u32 s68, 3
    s_cbranch_scc1 L_ctl
    s_mov_b64 vcc, 0
    s_setprio 1
    v_and_b32 v235, 15, v0
    v_lshrrev_b32 v234, 4, v0
    v_mul_u32_u24 v1, 768, v234
    v_lshl_add_u32 v1, v235, 4, v1
    v_lshlrev_b32 v2, 3, v235
    v_bfrev_b32 v231, v235
    v_lshrrev_b32 v231, 28, v231
    v_and_b32 v232, 3, v231
    v_lshl_add_u32 v3, v232, 2, v234
    v_lshlrev_b32 v3, 1, v3
    v_lshrrev_b32 v231, 2, v231
    v_lshl_add_u32 v3, v231, 10, v3
    v_lshlrev_b32 v239, 2, v0
    v_add_u32 v240, 3840, v239
    v_add_u32 v239, 3584, v239
    v_lshlrev_b32 v241, 4, v0
    v_mov_b32 v242, 0
    v_mov_b32 v243, 1
    v_lshlrev_b32 v224, 2, v0
    v_mov_b32 v225, 1
    v_mov_b32 v226, 260
    s_mul_i32 s58, s79, 0
    s_and_b32 s94, s92, 448
    s_add_u32 s94, s94, s58
    s_add_u32 s94, s94, 512
    s_add_u32 s58, s58, s92
    s_and_b32 s58, s58, 511
    s_lshr_b32 s59, s3, 5
    s_lshl_b32 s69, s79, 9
    s_add_u32 s59, s59, 24
    s_lshl_b32 s59, s59, 9
    s_mov_b32 s64, 0xcccccccc
    s_mov_b32 s65, 0xcccccccc
    s_mov_b32 s60, 0x6fd53b95
    s_mov_b32 s62, 0x80000001
    s_mov_b32 s61, 0x6fd53b95
    s_mov_b32 s63, 0x80000001
    s_waitcnt lgkmcnt(0)
    s_mov_b32 s24, s6
    s_and_b32 s25, s7, 0xffff
    s_mov_b32 s26, 805306368
    s_mov_b32 s27, 0x00020000
    s_mov_b32 s48, s4
    s_and_b32 s49, s5, 0xffff
    s_mov_b32 s50, 12288
    s_mov_b32 s51, 0x00020000
    s_mov_b32 s32, s10
    s_and_b32 s33, s11, 0xffff
    s_mov_b32 s34, 6291456
    s_mov_b32 s35, 0x00020000
    s_mov_b32 s36, s12
    s_and_b32 s37, s13, 0xffff
    s_mov_b32 s38, 6291456
    s_mov_b32 s39, 0x00020000
    s_add_u32 s70, s69, s92
    s_mov_b32 s91, 1
    s_lshr_b32 s74, s70, 9
    s_mul_i32 s74, s74, 384
    buffer_load_dwordx2 v[192:193], v2, s[48:51], s74 offen offset:0
    buffer_load_dwordx2 v[194:195], v2, s[48:51], s74 offen offset:128
    buffer_load_dwordx2 v[196:197], v2, s[48:51], s74 offen offset:256
    s_and_b32 s80, s70, 31
    s_sub_u32 s72, s70, s80
    s_lshr_b32 s80, s80, 2
    s_add_u32 s72, s72, s80
    s_mul_i32 s72, s72, 384
    buffer_load_dwordx2 v[132:133], v2, s[32:35], s72 offen offset:0
    buffer_load_dwordx2 v[134:135], v2, s[32:35], s72 offen offset:128
    buffer_load_dwordx2 v[136:137], v2, s[32:35], s72 offen offset:256
    buffer_load_dwordx2 v[138:139], v2, s[36:39], s72 offen offset:0
    buffer_load_dwordx2 v[140:141], v2, s[36:39], s72 offen offset:128
    buffer_load_dwordx2 v[142:143], v2, s[36:39], s72 offen offset:256
    s_mul_i32 s71, s70, 49152
    s_and_b32 s80, s70, 31
    s_mul_i32 s80, s80, 36864
    s_sub_u32 s71, s71, s80
    buffer_load_dwordx4 v[4:7], v1, s[24:27], s71 offen offset:0 nt
    buffer_load_dwordx4 v[8:11], v1, s[24:27], s71 offen offset:256 nt
    buffer_load_dwordx4 v[12:15], v1, s[24:27], s71 offen offset:512 nt
    s_add_u32 s71, s71, 3072
    buffer_load_dwordx4 v[16:19], v1, s[24:27], s71 offen offset:0 nt
    s_add_u32 s72, s72, 3072
    buffer_load_dwordx2 v[156:157], v2, s[32:35], s72 offen offset:0
    buffer_load_dwordx2 v[158:159], v2, s[32:35], s72 offen offset:128
    buffer_load_dwordx2 v[160:161], v2, s[32:35], s72 offen offset:256
    buffer_load_dwordx2 v[162:163], v2, s[36:39], s72 offen offset:0
    buffer_load_dwordx2 v[164:165], v2, s[36:39], s72 offen offset:128
    buffer_load_dwordx2 v[166:167], v2, s[36:39], s72 offen offset:256
    buffer_load_dwordx4 v[20:23], v1, s[24:27], s71 offen offset:256 nt
    buffer_load_dwordx4 v[24:27], v1, s[24:27], s71 offen offset:512 nt
    s_add_u32 s71, s71, 3072
    buffer_load_dwordx4 v[28:31], v1, s[24:27], s71 offen offset:0 nt
    buffer_load_dwordx4 v[32:35], v1, s[24:27], s71 offen offset:256 nt
    buffer_load_dwordx4 v[36:39], v1, s[24:27], s71 offen offset:512 nt
    s_add_u32 s71, s71, 3072
    buffer_load_dwordx4 v[40:43], v1, s[24:27], s71 offen offset:0 nt
    buffer_load_dwordx4 v[44:47], v1, s[24:27], s71 offen offset:256 nt
    buffer_load_dwordx4 v[48:51], v1, s[24:27], s71 offen offset:512 nt
    s_add_u32 s71, s71, 384000
    buffer_load_dwordx4 v[52:55], v1, s[24:27], s71 offen offset:0 nt
    buffer_load_dwordx4 v[56:59], v1, s[24:27], s71 offen offset:256 nt
    buffer_load_dwordx4 v[60:63], v1, s[24:27], s71 offen offset:512 nt
    s_add_u32 s71, s71, 3072
    buffer_load_dwordx4 v[64:67], v1, s[24:27], s71 offen offset:0 nt
    s_add_u32 s72, s72, 3072
    buffer_load_dwordx2 v[168:169], v2, s[32:35], s72 offen offset:0
    buffer_load_dwordx2 v[170:171], v2, s[32:35], s72 offen offset:128
    buffer_load_dwordx2 v[172:173], v2, s[32:35], s72 offen offset:256
    buffer_load_dwordx2 v[174:175], v2, s[36:39], s72 offen offset:0
    buffer_load_dwordx2 v[176:177], v2, s[36:39], s72 offen offset:128
    buffer_load_dwordx2 v[178:179], v2, s[36:39], s72 offen offset:256
    buffer_load_dwordx4 v[68:71], v1, s[24:27], s71 offen offset:256 nt
    buffer_load_dwordx4 v[72:75], v1, s[24:27], s71 offen offset:512 nt
    s_add_u32 s71, s71, 3072
    buffer_load_dwordx4 v[76:79], v1, s[24:27], s71 offen offset:0 nt
    buffer_load_dwordx4 v[80:83], v1, s[24:27], s71 offen offset:256 nt
    buffer_load_dwordx4 v[84:87], v1, s[24:27], s71 offen offset:512 nt
    s_add_u32 s71, s71, 3072
    buffer_load_dwordx4 v[88:91], v1, s[24:27], s71 offen offset:0 nt
    buffer_load_dwordx4 v[92:95], v1, s[24:27], s71 offen offset:256 nt
    buffer_load_dwordx4 v[96:99], v1, s[24:27], s71 offen offset:512 nt
    s_mov_b32 s28, s8
    s_and_b32 s29, s9, 0xffff
    s_mov_b32 s30, 805306368
    s_mov_b32 s31, 0x00020000
    s_mov_b32 s40, s14
    s_and_b32 s41, s15, 0xffff
    s_mov_b32 s42, 2097152
    s_mov_b32 s43, 0x00020000
    s_mov_b32 s44, s16
    s_and_b32 s45, s17, 0xffff
    s_mov_b32 s46, 2097152
    s_mov_b32 s47, 0x00020000
    s_mov_b32 s52, s22
    s_and_b32 s53, s23, 0xffff
    s_mov_b32 s54, 25165824
    s_mov_b32 s55, 0x00020000
    v_mov_b32 v229, s2
    v_and_b32 v231, 15, v0
    v_lshrrev_b32 v230, 5, v229
    v_lshl_add_u32 v231, v230, 4, v231
    v_lshrrev_b32 v232, 4, v0
    v_lshl_add_u32 v231, v232, 7, v231
    s_lshl_b32 s82, s79, 3
    s_mov_b32 s80, 0xeff4fa00
    s_mov_b32 s81, 0xdbe0e5ea
    s_lshr_b64 s[80:81], s[80:81], s82
    s_sext_i32_i8 s80, s80
    s_mov_b32 exec_lo, 0x0
    s_mov_b32 exec_hi, 0x3ff
    v_add_u32 v231, s80, v231
    s_mov_b32 s80, 0xeff43d4c
    s_mov_b32 s81, 0xdbe0e5ea
    s_lshr_b64 s[80:81], s[80:81], s82
    s_sext_i32_i8 s80, s80
    s_mov_b32 exec_lo, 0x0
    s_mov_b32 exec_hi, 0x400
    v_add_u32 v231, s80, v231
    s_mov_b32 s80, 0x2c37424d
    s_mov_b32 s81, 0xb1621
    s_lshr_b64 s[80:81], s[80:81], s82
    s_sext_i32_i8 s80, s80
    s_mov_b32 exec_lo, 0x0
    s_mov_b32 exec_hi, 0xf800
    v_add_u32 v231, s80, v231
    s_mov_b64 exec, -1
    v_and_b32 v229, 31, v229
    v_lshl_add_u32 v245, v231, 5, v229
    s_mov_b32 s4, 0x10000
    s_mov_b32 s5, 0x10401
    s_cmp_eq_u32 s79, 1
    s_cselect_b32 s4, 0x10000, s4
    s_cselect_b32 s5, 0x14441, s5
    s_cmp_eq_u32 s79, 2
    s_cselect_b32 s4, 0x10000, s4
    s_cselect_b32 s5, 0x10801, s5
    s_cmp_eq_u32 s79, 3
    s_cselect_b32 s4, 0x10000, s4
    s_cselect_b32 s5, 0x10803, s5
    s_cmp_eq_u32 s79, 4
    s_cselect_b32 s4, 0x10000, s4
    s_cselect_b32 s5, 0x18841, s5
    s_cmp_eq_u32 s79, 5
    s_cselect_b32 s4, 0x10000, s4
    s_cselect_b32 s5, 0x10801, s5
    s_cmp_eq_u32 s79, 6
    s_cselect_b32 s4, 0x10000, s4
    s_cselect_b32 s5, 0x10801, s5
    s_cmp_eq_u32 s79, 7
    s_cselect_b32 s4, 0x10000, s4
    s_cselect_b32 s5, 0x10821, s5
    s_mov_b32 s7, 0xf149f2ca
    s_mov_b32 s77, 0xf149f2ca
    v_lshlrev_b32 v225, 4, v0
    v_mov_b32 v100, 0
    v_mov_b32 v101, 0
    v_mov_b32 v102, 0
    v_mov_b32 v103, 0
    s_lshl_b32 s78, s3, 11
    s_mov_b64 s[88:89], 0
    v_mov_b32 v216, 0xf149f2ca
    v_mov_b32 v217, 0
    v_mov_b32 v218, 0
    v_mov_b32 v204, 0
    v_mov_b32 v205, 0
    v_mov_b32 v206, 0
    v_mov_b32 v207, 0
    v_mov_b32 v208, 0
    v_mov_b32 v209, 0
    v_mov_b32 v210, 0
    v_mov_b32 v211, 0
    v_mov_b32 v212, 0
    v_mov_b32 v213, 0
    v_mov_b32 v214, 0
    v_mov_b32 v215, 0
    s_barrier
    s_waitcnt vmcnt(36)
    v_lshlrev_b32 v108, 16, v192
    v_and_b32 v109, 0xffff0000, v192
    v_pk_mul_f32 v[108:109], v[108:109], s[60:61]
    v_lshlrev_b32 v110, 16, v193
    v_and_b32 v111, 0xffff0000, v193
    v_pk_mul_f32 v[110:111], v[110:111], s[60:61]
    v_lshlrev_b32 v112, 16, v194
    v_and_b32 v113, 0xffff0000, v194
    v_pk_mul_f32 v[112:113], v[112:113], s[60:61]
    v_lshlrev_b32 v114, 16, v195
    v_and_b32 v115, 0xffff0000, v195
    v_pk_mul_f32 v[114:115], v[114:115], s[60:61]
    v_lshlrev_b32 v116, 16, v196
    v_and_b32 v117, 0xffff0000, v196
    v_pk_mul_f32 v[116:117], v[116:117], s[60:61]
    v_lshlrev_b32 v118, 16, v197
    v_and_b32 v119, 0xffff0000, v197
    v_pk_mul_f32 v[118:119], v[118:119], s[60:61]
    v_lshlrev_b32 v234, 16, v132
    v_and_b32 v235, 0xffff0000, v132
    v_pk_mul_f32 v[120:121], v[234:235], v[108:109]
    v_lshlrev_b32 v234, 16, v138
    v_and_b32 v235, 0xffff0000, v138
    v_pk_mul_f32 v[200:201], v[120:121], v[234:235]
    v_lshlrev_b32 v234, 16, v133
    v_and_b32 v235, 0xffff0000, v133
    v_pk_mul_f32 v[122:123], v[234:235], v[110:111]
    v_lshlrev_b32 v234, 16, v139
    v_and_b32 v235, 0xffff0000, v139
    v_pk_fma_f32 v[200:201], v[122:123], v[234:235], v[200:201]
    v_lshlrev_b32 v234, 16, v134
    v_and_b32 v235, 0xffff0000, v134
    v_pk_mul_f32 v[124:125], v[234:235], v[112:113]
    v_lshlrev_b32 v234, 16, v140
    v_and_b32 v235, 0xffff0000, v140
    v_pk_fma_f32 v[200:201], v[124:125], v[234:235], v[200:201]
    v_lshlrev_b32 v234, 16, v135
    v_and_b32 v235, 0xffff0000, v135
    v_pk_mul_f32 v[126:127], v[234:235], v[114:115]
    v_lshlrev_b32 v234, 16, v141
    v_and_b32 v235, 0xffff0000, v141
    v_pk_fma_f32 v[200:201], v[126:127], v[234:235], v[200:201]
    v_lshlrev_b32 v234, 16, v136
    v_and_b32 v235, 0xffff0000, v136
    v_pk_mul_f32 v[128:129], v[234:235], v[116:117]
    v_lshlrev_b32 v234, 16, v142
    v_and_b32 v235, 0xffff0000, v142
    v_pk_fma_f32 v[200:201], v[128:129], v[234:235], v[200:201]
    v_lshlrev_b32 v234, 16, v137
    v_and_b32 v235, 0xffff0000, v137
    v_pk_mul_f32 v[130:131], v[234:235], v[118:119]
    v_lshlrev_b32 v234, 16, v143
    v_and_b32 v235, 0xffff0000, v143
    v_pk_fma_f32 v[200:201], v[130:131], v[234:235], v[200:201]
    v_pk_mul_f32 v[200:201], v[200:201], s[62:63]
    s_mov_b32 s76, 63
L_loop0:
    s_waitcnt vmcnt(35)
    v_pk_fma_f32 v[198:199], v[120:121], v[4:5], v[200:201]
    v_pk_fma_f32 v[198:199], v[122:123], v[6:7], v[198:199]
    ds_read_b32 v244, v243 offset:147
    s_add_u32 s71, s71, 384000
    s_cbranch_vccnz L_th24_0
L_tb24_0:
    buffer_load_dwordx4 v[4:7], v1, s[24:27], s71 offen offset:0 nt
    v_add_f32_dpp v229, v228, v228 row_ror:8 row_mask:0xf bank_mask:0xc
    s_waitcnt vmcnt(35)
    v_pk_fma_f32 v[198:199], v[124:125], v[8:9], v[198:199]
    v_pk_fma_f32 v[198:199], v[126:127], v[10:11], v[198:199]
    buffer_load_dwordx4 v[8:11], v1, s[24:27], s71 offen offset:256 nt
    v_add_f32_dpp v230, v229, v229 row_shr:4 row_mask:0xf bank_mask:0xa
    s_waitcnt vmcnt(35)
    v_pk_fma_f32 v[198:199], v[128:129], v[12:13], v[198:199]
    v_pk_fma_f32 v[198:199], v[130:131], v[14:15], v[198:199]
    s_waitcnt lgkmcnt(0)
    v_cmp_lt_u32 vcc, v0, v244
    ds_add_u32 v224, v243 offset:3328
    buffer_load_dwordx4 v[12:15], v1, s[24:27], s71 offen offset:512 nt
    v_add_f32_dpp v232, v230, v230 quad_perm:[2,3,0,1] row_mask:0xf bank_mask:0xf
    v_add_f32 v228, v198, v199
    s_waitcnt vmcnt(35)
    v_pk_fma_f32 v[198:199], v[120:121], v[16:17], v[200:201]
    v_pk_fma_f32 v[198:199], v[122:123], v[18:19], v[198:199]
    s_add_u32 s71, s71, 3072
    s_cbranch_vccnz L_th27_0
L_tb27_0:
    buffer_load_dwordx4 v[16:19], v1, s[24:27], s71 offen offset:0 nt
    v_cndmask_b32 v232, v231, v232, s[64:65]
    v_add_f32_dpp v229, v228, v228 row_ror:8 row_mask:0xf bank_mask:0x3
    s_waitcnt vmcnt(29)
    v_pk_fma_f32 v[198:199], v[124:125], v[20:21], v[198:199]
    v_pk_fma_f32 v[198:199], v[126:127], v[22:23], v[198:199]
    s_add_u32 s72, s72, 3072
    buffer_load_dwordx2 v[180:181], v2, s[32:35], s72 offen offset:0
    buffer_load_dwordx2 v[182:183], v2, s[32:35], s72 offen offset:128
    buffer_load_dwordx2 v[184:185], v2, s[32:35], s72 offen offset:256
    buffer_load_dwordx2 v[186:187], v2, s[36:39], s72 offen offset:0
    buffer_load_dwordx2 v[188:189], v2, s[36:39], s72 offen offset:128
    buffer_load_dwordx2 v[190:191], v2, s[36:39], s72 offen offset:256
    buffer_load_dwordx4 v[20:23], v1, s[24:27], s71 offen offset:256 nt
    v_add_f32_dpp v231, v232, v232 quad_perm:[1,0,3,2] row_mask:0xf bank_mask:0xf
    v_lshlrev_b32 v234, 16, v156
    v_and_b32 v235, 0xffff0000, v156
    v_pk_mul_f32 v[144:145], v[234:235], v[108:109]
    v_lshlrev_b32 v234, 16, v162
    v_and_b32 v235, 0xffff0000, v162
    s_waitcnt vmcnt(35)
    v_pk_fma_f32 v[198:199], v[128:129], v[24:25], v[198:199]
    v_pk_fma_f32 v[198:199], v[130:131], v[26:27], v[198:199]
    ds_add_u32 v224, v243 offset:3328
    buffer_load_dwordx4 v[24:27], v1, s[24:27], s71 offen offset:512 nt
    v_cndmask_b32 v233, v233, v231, s[66:67]
    v_mul_f32 v233, 0x58000000, v233
    ds_write_b32 v239, v233
    v_add_u32 v239, 256, v239
    v_add_f32 v228, v198, v199
    v_pk_mul_f32 v[202:203], v[144:145], v[234:235]
    v_lshlrev_b32 v234, 16, v157
    v_and_b32 v235, 0xffff0000, v157
    v_pk_mul_f32 v[146:147], v[234:235], v[110:111]
    v_lshlrev_b32 v234, 16, v163
    s_waitcnt vmcnt(35)
    v_pk_fma_f32 v[198:199], v[120:121], v[28:29], v[200:201]
    v_pk_fma_f32 v[198:199], v[122:123], v[30:31], v[198:199]
    s_add_u32 s71, s71, 3072
    s_cbranch_vccnz L_th30_0
L_tb30_0:
    buffer_load_dwordx4 v[28:31], v1, s[24:27], s71 offen offset:0 nt
    v_add_f32_dpp v229, v228, v228 row_ror:8 row_mask:0xf bank_mask:0xc
    v_and_b32 v235, 0xffff0000, v163
    v_pk_fma_f32 v[202:203], v[146:147], v[234:235], v[202:203]
    v_lshlrev_b32 v234, 16, v158
    v_and_b32 v235, 0xffff0000, v158
    v_pk_mul_f32 v[148:149], v[234:235], v[112:113]
    s_waitcnt vmcnt(35)
    v_pk_fma_f32 v[198:199], v[124:125], v[32:33], v[198:199]
    v_pk_fma_f32 v[198:199], v[126:127], v[34:35], v[198:199]
    buffer_load_dwordx4 v[32:35], v1, s[24:27], s71 offen offset:256 nt
    v_add_f32_dpp v230, v229, v229 row_shl:4 row_mask:0xf bank_mask:0x5
    v_lshlrev_b32 v234, 16, v164
    v_and_b32 v235, 0xffff0000, v164
    v_pk_fma_f32 v[202:203], v[148:149], v[234:235], v[202:203]
    v_lshlrev_b32 v234, 16, v159
    v_and_b32 v235, 0xffff0000, v159
    s_waitcnt vmcnt(35)
    v_pk_fma_f32 v[198:199], v[128:129], v[36:37], v[198:199]
    v_pk_fma_f32 v[198:199], v[130:131], v[38:39], v[198:199]
    ds_add_u32 v224, v243 offset:3328
    buffer_load_dwordx4 v[36:39], v1, s[24:27], s71 offen offset:512 nt
    v_add_f32 v228, v198, v199
    v_pk_mul_f32 v[150:151], v[234:235], v[114:115]
    v_lshlrev_b32 v234, 16, v165
    v_and_b32 v235, 0xffff0000, v165
    v_pk_fma_f32 v[202:203], v[150:151], v[234:235], v[202:203]
    v_lshlrev_b32 v234, 16, v160
    s_waitcnt vmcnt(35)
    v_pk_fma_f32 v[198:199], v[120:121], v[40:41], v[200:201]
    v_pk_fma_f32 v[198:199], v[122:123], v[42:43], v[198:199]
    s_add_u32 s71, s71, 3072
    s_cbranch_vccnz L_th33_0
L_tb33_0:
    buffer_load_dwordx4 v[40:43], v1, s[24:27], s71 offen offset:0 nt
    v_add_f32_dpp v229, v228, v228 row_ror:8 row_mask:0xf bank_mask:0x3
    v_and_b32 v235, 0xffff0000, v160
    v_pk_mul_f32 v[152:153], v[234:235], v[116:117]
    v_lshlrev_b32 v234, 16, v166
    v_and_b32 v235, 0xffff0000, v166
    v_pk_fma_f32 v[202:203], v[152:153], v[234:235], v[202:203]
    s_waitcnt vmcnt(35)
    v_pk_fma_f32 v[198:199], v[124:125], v[44:45], v[198:199]
    v_pk_fma_f32 v[198:199], v[126:127], v[46:47], v[198:199]
    buffer_load_dwordx4 v[44:47], v1, s[24:27], s71 offen offset:256 nt
    v_lshlrev_b32 v234, 16, v161
    v_and_b32 v235, 0xffff0000, v161
    v_pk_mul_f32 v[154:155], v[234:235], v[118:119]
    v_lshlrev_b32 v234, 16, v167
    v_and_b32 v235, 0xffff0000, v167
    s_waitcnt vmcnt(35)
    v_pk_fma_f32 v[198:199], v[128:129], v[48:49], v[198:199]
    v_pk_fma_f32 v[198:199], v[130:131], v[50:51], v[198:199]
    ds_add_u32 v224, v243 offset:3328
    buffer_load_dwordx4 v[48:51], v1, s[24:27], s71 offen offset:512 nt
    v_add_f32 v228, v198, v199
    v_pk_fma_f32 v[202:203], v[154:155], v[234:235], v[202:203]
    v_pk_mul_f32 v[202:203], v[202:203], s[62:63]
    s_waitcnt vmcnt(35)
    v_pk_fma_f32 v[198:199], v[144:145], v[52:53], v[202:203]
    v_pk_fma_f32 v[198:199], v[146:147], v[54:55], v[198:199]
    ds_read_b32 v244, v243 offset:147
    v_readlane_b32 s70, v245, s91
    s_add_u32 s91, s91, 1
    s_lshr_b32 s74, s70, 9
    s_mul_i32 s74, s74, 384
    buffer_load_dwordx2 v[192:193], v2, s[48:51], s74 offen offset:0
    buffer_load_dwordx2 v[194:195], v2, s[48:51], s74 offen offset:128
    buffer_load_dwordx2 v[196:197], v2, s[48:51], s74 offen offset:256
    s_add_u32 s71, s71, 384000
    s_cbranch_vccnz L_th36_0
L_tb36_0:
    buffer_load_dwordx4 v[52:55], v1, s[24:27], s71 offen offset:0 nt
    v_add_f32_dpp v229, v228, v228 row_ror:8 row_mask:0xf bank_mask:0xc
    s_waitcnt vmcnt(38)
    v_pk_fma_f32 v[198:199], v[148:149], v[56:57], v[198:199]
    v_pk_fma_f32 v[198:199], v[150:151], v[58:59], v[198:199]
    buffer_load_dwordx4 v[56:59], v1, s[24:27], s71 offen offset:256 nt
    v_add_f32_dpp v230, v229, v229 row_shr:4 row_mask:0xf bank_mask:0xa
    s_waitcnt vmcnt(38)
    v_pk_fma_f32 v[198:199], v[152:153], v[60:61], v[198:199]
    v_pk_fma_f32 v[198:199], v[154:155], v[62:63], v[198:199]
    s_waitcnt lgkmcnt(0)
    v_cmp_lt_u32 vcc, v0, v244
    ds_add_u32 v224, v243 offset:3328
    buffer_load_dwordx4 v[60:63], v1, s[24:27], s71 offen offset:512 nt
    v_add_f32_dpp v231, v230, v230 quad_perm:[2,3,0,1] row_mask:0xf bank_mask:0xf
    v_add_f32 v228, v198, v199
    s_waitcnt vmcnt(38)
    v_pk_fma_f32 v[198:199], v[144:145], v[64:65], v[202:203]
    v_pk_fma_f32 v[198:199], v[146:147], v[66:67], v[198:199]
    s_add_u32 s71, s71, 3072
    s_cbranch_vccnz L_th39_0
L_tb39_0:
    buffer_load_dwordx4 v[64:67], v1, s[24:27], s71 offen offset:0 nt
    v_add_f32_dpp v229, v228, v228 row_ror:8 row_mask:0xf bank_mask:0x3
    s_waitcnt vmcnt(32)
    v_pk_fma_f32 v[198:199], v[148:149], v[68:69], v[198:199]
    v_pk_fma_f32 v[198:199], v[150:151], v[70:71], v[198:199]
    s_and_b32 s80, s70, 31
    s_sub_u32 s72, s70, s80
    s_lshr_b32 s80, s80, 2
    s_add_u32 s72, s72, s80
    s_mul_i32 s72, s72, 384
    buffer_load_dwordx2 v[132:133], v2, s[32:35], s72 offen offset:0
    buffer_load_dwordx2 v[134:135], v2, s[32:35], s72 offen offset:128
    buffer_load_dwordx2 v[136:137], v2, s[32:35], s72 offen offset:256
    buffer_load_dwordx2 v[138:139], v2, s[36:39], s72 offen offset:0
    buffer_load_dwordx2 v[140:141], v2, s[36:39], s72 offen offset:128
    buffer_load_dwordx2 v[142:143], v2, s[36:39], s72 offen offset:256
    buffer_load_dwordx4 v[68:71], v1, s[24:27], s71 offen offset:256 nt
    v_lshlrev_b32 v234, 16, v168
    v_and_b32 v235, 0xffff0000, v168
    v_pk_mul_f32 v[120:121], v[234:235], v[108:109]
    v_lshlrev_b32 v234, 16, v174
    v_and_b32 v235, 0xffff0000, v174
    s_waitcnt vmcnt(38)
    v_pk_fma_f32 v[198:199], v[152:153], v[72:73], v[198:199]
    v_pk_fma_f32 v[198:199], v[154:155], v[74:75], v[198:199]
    ds_add_u32 v224, v243 offset:3328
    buffer_load_dwordx4 v[72:75], v1, s[24:27], s71 offen offset:512 nt
    v_add_f32 v228, v198, v199
    v_pk_mul_f32 v[200:201], v[120:121], v[234:235]
    v_lshlrev_b32 v234, 16, v169
    v_and_b32 v235, 0xffff0000, v169
    v_pk_mul_f32 v[122:123], v[234:235], v[110:111]
    v_lshlrev_b32 v234, 16, v175
    s_waitcnt vmcnt(38)
    v_pk_fma_f32 v[198:199], v[144:145], v[76:77], v[202:203]
    v_pk_fma_f32 v[198:199], v[146:147], v[78:79], v[198:199]
    s_add_u32 s71, s71, 3072
    s_cbranch_vccnz L_th42_0
L_tb42_0:
    buffer_load_dwordx4 v[76:79], v1, s[24:27], s71 offen offset:0 nt
    v_add_f32_dpp v229, v228, v228 row_ror:8 row_mask:0xf bank_mask:0xc
    v_and_b32 v235, 0xffff0000, v175
    v_pk_fma_f32 v[200:201], v[122:123], v[234:235], v[200:201]
    v_lshlrev_b32 v234, 16, v170
    v_and_b32 v235, 0xffff0000, v170
    v_pk_mul_f32 v[124:125], v[234:235], v[112:113]
    s_waitcnt vmcnt(38)
    v_pk_fma_f32 v[198:199], v[148:149], v[80:81], v[198:199]
    v_pk_fma_f32 v[198:199], v[150:151], v[82:83], v[198:199]
    buffer_load_dwordx4 v[80:83], v1, s[24:27], s71 offen offset:256 nt
    v_add_f32_dpp v230, v229, v229 row_shl:4 row_mask:0xf bank_mask:0x5
    v_lshlrev_b32 v234, 16, v176
    v_and_b32 v235, 0xffff0000, v176
    v_pk_fma_f32 v[200:201], v[124:125], v[234:235], v[200:201]
    v_lshlrev_b32 v234, 16, v171
    v_and_b32 v235, 0xffff0000, v171
    s_waitcnt vmcnt(38)
    v_pk_fma_f32 v[198:199], v[152:153], v[84:85], v[198:199]
    v_pk_fma_f32 v[198:199], v[154:155], v[86:87], v[198:199]
    ds_add_u32 v224, v243 offset:3328
    buffer_load_dwordx4 v[84:87], v1, s[24:27], s71 offen offset:512 nt
    v_add_f32 v228, v198, v199
    v_pk_mul_f32 v[126:127], v[234:235], v[114:115]
    v_lshlrev_b32 v234, 16, v177
    v_and_b32 v235, 0xffff0000, v177
    v_pk_fma_f32 v[200:201], v[126:127], v[234:235], v[200:201]
    v_lshlrev_b32 v234, 16, v172
    s_waitcnt vmcnt(38)
    v_pk_fma_f32 v[198:199], v[144:145], v[88:89], v[202:203]
    v_pk_fma_f32 v[198:199], v[146:147], v[90:91], v[198:199]
    s_add_u32 s71, s71, 3072
    s_cbranch_vccnz L_th45_0
L_tb45_0:
    buffer_load_dwordx4 v[88:91], v1, s[24:27], s71 offen offset:0 nt
    v_add_f32_dpp v229, v228, v228 row_ror:8 row_mask:0xf bank_mask:0x3
    v_and_b32 v235, 0xffff0000, v172
    v_pk_mul_f32 v[128:129], v[234:235], v[116:117]
    v_lshlrev_b32 v234, 16, v178
    v_and_b32 v235, 0xffff0000, v178
    v_pk_fma_f32 v[200:201], v[128:129], v[234:235], v[200:201]
    s_waitcnt vmcnt(38)
    v_pk_fma_f32 v[198:199], v[148:149], v[92:93], v[198:199]
    v_pk_fma_f32 v[198:199], v[150:151], v[94:95], v[198:199]
    buffer_load_dwordx4 v[92:95], v1, s[24:27], s71 offen offset:256 nt
    v_lshlrev_b32 v234, 16, v173
    v_and_b32 v235, 0xffff0000, v173
    v_pk_mul_f32 v[130:131], v[234:235], v[118:119]
    v_lshlrev_b32 v234, 16, v179
    v_and_b32 v235, 0xffff0000, v179
    s_waitcnt vmcnt(38)
    v_pk_fma_f32 v[198:199], v[152:153], v[96:97], v[198:199]
    v_pk_fma_f32 v[198:199], v[154:155], v[98:99], v[198:199]
    ds_add_u32 v224, v243 offset:3328
    buffer_load_dwordx4 v[96:99], v1, s[24:27], s71 offen offset:512 nt
    v_add_f32 v228, v198, v199
    v_pk_fma_f32 v[200:201], v[130:131], v[234:235], v[200:201]
    v_pk_mul_f32 v[200:201], v[200:201], s[62:63]
    s_waitcnt vmcnt(38)
    v_pk_fma_f32 v[198:199], v[120:121], v[4:5], v[200:201]
    v_pk_fma_f32 v[198:199], v[122:123], v[6:7], v[198:199]
    ds_read_b32 v244, v243 offset:147
    s_mul_i32 s71, s70, 49152
    s_and_b32 s80, s70, 31
    s_mul_i32 s80, s80, 36864
    s_sub_u32 s71, s71, s80
    s_cbranch_vccnz L_th0_0
L_tb0_0:
    buffer_load_dwordx4 v[4:7], v1, s[24:27], s71 offen offset:0 nt
    v_add_f32_dpp v229, v228, v228 row_ror:8 row_mask:0xf bank_mask:0xc
    s_waitcnt vmcnt(38)
    v_pk_fma_f32 v[198:199], v[124:125], v[8:9], v[198:199]
    v_pk_fma_f32 v[198:199], v[126:127], v[10:11], v[198:199]
    buffer_load_dwordx4 v[8:11], v1, s[24:27], s71 offen offset:256 nt
    v_add_f32_dpp v230, v229, v229 row_shr:4 row_mask:0xf bank_mask:0xa
    s_waitcnt vmcnt(38)
    v_pk_fma_f32 v[198:199], v[128:129], v[12:13], v[198:199]
    v_pk_fma_f32 v[198:199], v[130:131], v[14:15], v[198:199]
    s_waitcnt lgkmcnt(0)
    v_cmp_lt_u32 vcc, v0, v244
    ds_add_u32 v224, v243 offset:3328
    buffer_load_dwordx4 v[12:15], v1, s[24:27], s71 offen offset:512 nt
    v_add_f32_dpp v232, v230, v230 quad_perm:[2,3,0,1] row_mask:0xf bank_mask:0xf
    v_add_f32 v228, v198, v199
    s_waitcnt vmcnt(38)
    v_pk_fma_f32 v[198:199], v[120:121], v[16:17], v[200:201]
    v_pk_fma_f32 v[198:199], v[122:123], v[18:19], v[198:199]
    s_add_u32 s71, s71, 3072
    s_cbranch_vccnz L_th3_0
L_tb3_0:
    buffer_load_dwordx4 v[16:19], v1, s[24:27], s71 offen offset:0 nt
    v_cndmask_b32 v232, v231, v232, s[64:65]
    v_add_f32_dpp v229, v228, v228 row_ror:8 row_mask:0xf bank_mask:0x3
    s_waitcnt vmcnt(32)
    v_pk_fma_f32 v[198:199], v[124:125], v[20:21], v[198:199]
    v_pk_fma_f32 v[198:199], v[126:127], v[22:23], v[198:199]
    s_add_u32 s72, s72, 3072
    buffer_load_dwordx2 v[156:157], v2, s[32:35], s72 offen offset:0
    buffer_load_dwordx2 v[158:159], v2, s[32:35], s72 offen offset:128
    buffer_load_dwordx2 v[160:161], v2, s[32:35], s72 offen offset:256
    buffer_load_dwordx2 v[162:163], v2, s[36:39], s72 offen offset:0
    buffer_load_dwordx2 v[164:165], v2, s[36:39], s72 offen offset:128
    buffer_load_dwordx2 v[166:167], v2, s[36:39], s72 offen offset:256
    buffer_load_dwordx4 v[20:23], v1, s[24:27], s71 offen offset:256 nt
    v_add_f32_dpp v233, v232, v232 quad_perm:[1,0,3,2] row_mask:0xf bank_mask:0xf
    v_lshlrev_b32 v234, 16, v180
    v_and_b32 v235, 0xffff0000, v180
    v_pk_mul_f32 v[144:145], v[234:235], v[108:109]
    v_lshlrev_b32 v234, 16, v186
    v_and_b32 v235, 0xffff0000, v186
    s_waitcnt vmcnt(38)
    v_pk_fma_f32 v[198:199], v[128:129], v[24:25], v[198:199]
    v_pk_fma_f32 v[198:199], v[130:131], v[26:27], v[198:199]
    ds_add_u32 v224, v243 offset:3328
    buffer_load_dwordx4 v[24:27], v1, s[24:27], s71 offen offset:512 nt
    v_add_f32 v228, v198, v199
    v_pk_mul_f32 v[202:203], v[144:145], v[234:235]
    v_lshlrev_b32 v234, 16, v181
    v_and_b32 v235, 0xffff0000, v181
    v_pk_mul_f32 v[146:147], v[234:235], v[110:111]
    v_lshlrev_b32 v234, 16, v187
    s_waitcnt vmcnt(38)
    v_pk_fma_f32 v[198:199], v[120:121], v[28:29], v[200:201]
    v_pk_fma_f32 v[198:199], v[122:123], v[30:31], v[198:199]
    s_add_u32 s71, s71, 3072
    s_cbranch_vccnz L_th6_0
L_tb6_0:
    buffer_load_dwordx4 v[28:31], v1, s[24:27], s71 offen offset:0 nt
    v_add_f32_dpp v229, v228, v228 row_ror:8 row_mask:0xf bank_mask:0xc
    v_and_b32 v235, 0xffff0000, v187
    v_pk_fma_f32 v[202:203], v[146:147], v[234:235], v[202:203]
    v_lshlrev_b32 v234, 16, v182
    v_and_b32 v235, 0xffff0000, v182
    s_branch L_x0
L_w0:
    s_branch L_w1
L_x0:
    v_pk_mul_f32 v[148:149], v[234:235], v[112:113]
    s_waitcnt vmcnt(38)
    v_pk_fma_f32 v[198:199], v[124:125], v[32:33], v[198:199]
    v_pk_fma_f32 v[198:199], v[126:127], v[34:35], v[198:199]
    buffer_load_dwordx4 v[32:35], v1, s[24:27], s71 offen offset:256 nt
    v_add_f32_dpp v230, v229, v229 row_shl:4 row_mask:0xf bank_mask:0x5
    v_lshlrev_b32 v234, 16, v188
    v_and_b32 v235, 0xffff0000, v188
    v_pk_fma_f32 v[202:203], v[148:149], v[234:235], v[202:203]
    v_lshlrev_b32 v234, 16, v183
    v_and_b32 v235, 0xffff0000, v183
    s_waitcnt vmcnt(38)
    v_pk_fma_f32 v[198:199], v[128:129], v[36:37], v[198:199]
    v_pk_fma_f32 v[198:199], v[130:131], v[38:39], v[198:199]
    ds_add_u32 v224, v243 offset:3328
    buffer_load_dwordx4 v[36:39], v1, s[24:27], s71 offen offset:512 nt
    v_add_f32 v228, v198, v199
    v_pk_mul_f32 v[150:151], v[234:235], v[114:115]
    v_lshlrev_b32 v234, 16, v189
    v_and_b32 v235, 0xffff0000, v189
    v_pk_fma_f32 v[202:203], v[150:151], v[234:235], v[202:203]
    v_lshlrev_b32 v234, 16, v184
    s_waitcnt vmcnt(38)
    v_pk_fma_f32 v[198:199], v[120:121], v[40:41], v[200:201]
    v_pk_fma_f32 v[198:199], v[122:123], v[42:43], v[198:199]
    s_add_u32 s71, s71, 3072
    s_cbranch_vccnz L_th9_0
L_tb9_0:
    buffer_load_dwordx4 v[40:43], v1, s[24:27], s71 offen offset:0 nt
    v_add_f32_dpp v229, v228, v228 row_ror:8 row_mask:0xf bank_mask:0x3
    v_and_b32 v235, 0xffff0000, v184
    v_pk_mul_f32 v[152:153], v[234:235], v[116:117]
    v_lshlrev_b32 v234, 16, v190
    v_and_b32 v235, 0xffff0000, v190
    v_pk_fma_f32 v[202:203], v[152:153], v[234:235], v[202:203]
    s_waitcnt vmcnt(38)
    v_pk_fma_f32 v[198:199], v[124:125], v[44:45], v[198:199]
    v_pk_fma_f32 v[198:199], v[126:127], v[46:47], v[198:199]
    buffer_load_dwordx4 v[44:47], v1, s[24:27], s71 offen offset:256 nt
    v_lshlrev_b32 v234, 16, v185
    v_and_b32 v235, 0xffff0000, v185
    v_pk_mul_f32 v[154:155], v[234:235], v[118:119]
    v_lshlrev_b32 v234, 16, v191
    v_and_b32 v235, 0xffff0000, v191
    s_waitcnt vmcnt(38)
    v_pk_fma_f32 v[198:199], v[128:129], v[48:49], v[198:199]
    v_pk_fma_f32 v[198:199], v[130:131], v[50:51], v[198:199]
    ds_add_u32 v224, v243 offset:3328
    buffer_load_dwordx4 v[48:51], v1, s[24:27], s71 offen offset:512 nt
    v_add_f32 v228, v198, v199
    v_pk_fma_f32 v[202:203], v[154:155], v[234:235], v[202:203]
    v_pk_mul_f32 v[202:203], v[202:203], s[62:63]
    s_waitcnt vmcnt(35)
    v_pk_fma_f32 v[198:199], v[144:145], v[52:53], v[202:203]
    v_pk_fma_f32 v[198:199], v[146:147], v[54:55], v[198:199]
    ds_read_b32 v244, v243 offset:147
    s_add_u32 s71, s71, 384000
    s_cbranch_vccnz L_th12_0
L_tb12_0:
    buffer_load_dwordx4 v[52:55], v1, s[24:27], s71 offen offset:0 nt
    v_add_f32_dpp v229, v228, v228 row_ror:8 row_mask:0xf bank_mask:0xc
    v_lshlrev_b32 v108, 16, v192
    v_and_b32 v109, 0xffff0000, v192
    v_pk_mul_f32 v[108:109], v[108:109], s[60:61]
    v_lshlrev_b32 v110, 16, v193
    v_and_b32 v111, 0xffff0000, v193
    s_waitcnt vmcnt(35)
    v_pk_fma_f32 v[198:199], v[148:149], v[56:57], v[198:199]
    v_pk_fma_f32 v[198:199], v[150:151], v[58:59], v[198:199]
    buffer_load_dwordx4 v[56:59], v1, s[24:27], s71 offen offset:256 nt
    v_add_f32_dpp v230, v229, v229 row_shr:4 row_mask:0xf bank_mask:0xa
    v_pk_mul_f32 v[110:111], v[110:111], s[60:61]
    v_lshlrev_b32 v112, 16, v194
    v_and_b32 v113, 0xffff0000, v194
    v_pk_mul_f32 v[112:113], v[112:113], s[60:61]
    v_lshlrev_b32 v114, 16, v195
    s_waitcnt vmcnt(35)
    v_pk_fma_f32 v[198:199], v[152:153], v[60:61], v[198:199]
    v_pk_fma_f32 v[198:199], v[154:155], v[62:63], v[198:199]
    s_waitcnt lgkmcnt(0)
    v_cmp_lt_u32 vcc, v0, v244
    ds_add_u32 v224, v243 offset:3328
    buffer_load_dwordx4 v[60:63], v1, s[24:27], s71 offen offset:512 nt
    v_add_f32_dpp v231, v230, v230 quad_perm:[2,3,0,1] row_mask:0xf bank_mask:0xf
    v_add_f32 v228, v198, v199
    v_and_b32 v115, 0xffff0000, v195
    v_pk_mul_f32 v[114:115], v[114:115], s[60:61]
    v_lshlrev_b32 v116, 16, v196
    v_and_b32 v117, 0xffff0000, v196
    v_pk_mul_f32 v[116:117], v[116:117], s[60:61]
    s_waitcnt vmcnt(35)
    v_pk_fma_f32 v[198:199], v[144:145], v[64:65], v[202:203]
    v_pk_fma_f32 v[198:199], v[146:147], v[66:67], v[198:199]
    s_add_u32 s71, s71, 3072
    s_cbranch_vccnz L_th15_0
L_tb15_0:
    buffer_load_dwordx4 v[64:67], v1, s[24:27], s71 offen offset:0 nt
    v_add_f32_dpp v229, v228, v228 row_ror:8 row_mask:0xf bank_mask:0x3
    v_lshlrev_b32 v118, 16, v197
    v_and_b32 v119, 0xffff0000, v197
    v_pk_mul_f32 v[118:119], v[118:119], s[60:61]
    s_waitcnt vmcnt(29)
    v_pk_fma_f32 v[198:199], v[148:149], v[68:69], v[198:199]
    v_pk_fma_f32 v[198:199], v[150:151], v[70:71], v[198:199]
    s_add_u32 s72, s72, 3072
    buffer_load_dwordx2 v[168:169], v2, s[32:35], s72 offen offset:0
    buffer_load_dwordx2 v[170:171], v2, s[32:35], s72 offen offset:128
    buffer_load_dwordx2 v[172:173], v2, s[32:35], s72 offen offset:256
    buffer_load_dwordx2 v[174:175], v2, s[36:39], s72 offen offset:0
    buffer_load_dwordx2 v[176:177], v2, s[36:39], s72 offen offset:128
    buffer_load_dwordx2 v[178:179], v2, s[36:39], s72 offen offset:256
    buffer_load_dwordx4 v[68:71], v1, s[24:27], s71 offen offset:256 nt
    v_lshlrev_b32 v234, 16, v132
    v_and_b32 v235, 0xffff0000, v132
    v_pk_mul_f32 v[120:121], v[234:235], v[108:109]
    v_lshlrev_b32 v234, 16, v138
    v_and_b32 v235, 0xffff0000, v138
    s_waitcnt vmcnt(35)
    v_pk_fma_f32 v[198:199], v[152:153], v[72:73], v[198:199]
    v_pk_fma_f32 v[198:199], v[154:155], v[74:75], v[198:199]
    ds_add_u32 v224, v243 offset:3328
    buffer_load_dwordx4 v[72:75], v1, s[24:27], s71 offen offset:512 nt
    v_add_f32 v228, v198, v199
    v_pk_mul_f32 v[200:201], v[120:121], v[234:235]
    v_lshlrev_b32 v234, 16, v133
    v_and_b32 v235, 0xffff0000, v133
    v_pk_mul_f32 v[122:123], v[234:235], v[110:111]
    v_lshlrev_b32 v234, 16, v139
    s_waitcnt vmcnt(35)
    v_pk_fma_f32 v[198:199], v[144:145], v[76:77], v[202:203]
    v_pk_fma_f32 v[198:199], v[146:147], v[78:79], v[198:199]
    s_add_u32 s71, s71, 3072
    s_cbranch_vccnz L_th18_0
L_tb18_0:
    buffer_load_dwordx4 v[76:79], v1, s[24:27], s71 offen offset:0 nt
    v_add_f32_dpp v229, v228, v228 row_ror:8 row_mask:0xf bank_mask:0xc
    v_and_b32 v235, 0xffff0000, v139
    v_pk_fma_f32 v[200:201], v[122:123], v[234:235], v[200:201]
    v_lshlrev_b32 v234, 16, v134
    v_and_b32 v235, 0xffff0000, v134
    v_pk_mul_f32 v[124:125], v[234:235], v[112:113]
    s_waitcnt vmcnt(35)
    v_pk_fma_f32 v[198:199], v[148:149], v[80:81], v[198:199]
    v_pk_fma_f32 v[198:199], v[150:151], v[82:83], v[198:199]
    buffer_load_dwordx4 v[80:83], v1, s[24:27], s71 offen offset:256 nt
    v_add_f32_dpp v230, v229, v229 row_shl:4 row_mask:0xf bank_mask:0x5
    v_lshlrev_b32 v234, 16, v140
    v_and_b32 v235, 0xffff0000, v140
    v_pk_fma_f32 v[200:201], v[124:125], v[234:235], v[200:201]
    v_lshlrev_b32 v234, 16, v135
    v_and_b32 v235, 0xffff0000, v135
    s_waitcnt vmcnt(35)
    v_pk_fma_f32 v[198:199], v[152:153], v[84:85], v[198:199]
    v_pk_fma_f32 v[198:199], v[154:155], v[86:87], v[198:199]
    ds_add_u32 v224, v243 offset:3328
    buffer_load_dwordx4 v[84:87], v1, s[24:27], s71 offen offset:512 nt
    v_add_f32 v228, v198, v199
    v_pk_mul_f32 v[126:127], v[234:235], v[114:115]
    v_lshlrev_b32 v234, 16, v141
    v_and_b32 v235, 0xffff0000, v141
    v_pk_fma_f32 v[200:201], v[126:127], v[234:235], v[200:201]
    v_lshlrev_b32 v234, 16, v136
    s_waitcnt vmcnt(35)
    v_pk_fma_f32 v[198:199], v[144:145], v[88:89], v[202:203]
    v_pk_fma_f32 v[198:199], v[146:147], v[90:91], v[198:199]
    s_add_u32 s71, s71, 3072
    s_cbranch_vccnz L_th21_0
L_tb21_0:
    buffer_load_dwordx4 v[88:91], v1, s[24:27], s71 offen offset:0 nt
    v_add_f32_dpp v229, v228, v228 row_ror:8 row_mask:0xf bank_mask:0x3
    v_and_b32 v235, 0xffff0000, v136
    v_pk_mul_f32 v[128:129], v[234:235], v[116:117]
    v_lshlrev_b32 v234, 16, v142
    v_and_b32 v235, 0xffff0000, v142
    v_pk_fma_f32 v[200:201], v[128:129], v[234:235], v[200:201]
    s_waitcnt vmcnt(35)
    v_pk_fma_f32 v[198:199], v[148:149], v[92:93], v[198:199]
    v_pk_fma_f32 v[198:199], v[150:151], v[94:95], v[198:199]
    buffer_load_dwordx4 v[92:95], v1, s[24:27], s71 offen offset:256 nt
    v_lshlrev_b32 v234, 16, v137
    v_and_b32 v235, 0xffff0000, v137
    v_pk_mul_f32 v[130:131], v[234:235], v[118:119]
    v_lshlrev_b32 v234, 16, v143
    v_and_b32 v235, 0xffff0000, v143
    s_waitcnt vmcnt(35)
    v_pk_fma_f32 v[198:199], v[152:153], v[96:97], v[198:199]
    v_pk_fma_f32 v[198:199], v[154:155], v[98:99], v[198:199]
    ds_add_u32 v224, v243 offset:3328
    buffer_load_dwordx4 v[96:99], v1, s[24:27], s71 offen offset:512 nt
    v_add_f32 v228, v198, v199
    v_pk_fma_f32 v[200:201], v[130:131], v[234:235], v[200:201]
    v_pk_mul_f32 v[200:201], v[200:201], s[62:63]
    s_sub_u32 s76, s76, 1
    s_cmp_lg_u32 s76, 0
    s_cbranch_scc1 L_loop0
    s_waitcnt vmcnt(35)
    v_pk_fma_f32 v[198:199], v[120:121], v[4:5], v[200:201]
    v_pk_fma_f32 v[198:199], v[122:123], v[6:7], v[198:199]
    ds_read_b32 v244, v243 offset:147
    s_add_u32 s71, s71, 384000
    s_cbranch_vccnz L_th24_1
L_tb24_1:
    buffer_load_dwordx4 v[4:7], v1, s[24:27], s71 offen offset:0 nt
    v_add_f32_dpp v229, v228, v228 row_ror:8 row_mask:0xf bank_mask:0xc
    s_waitcnt vmcnt(35)
    v_pk_fma_f32 v[198:199], v[124:125], v[8:9], v[198:199]
    v_pk_fma_f32 v[198:199], v[126:127], v[10:11], v[198:199]
    buffer_load_dwordx4 v[8:11], v1, s[24:27], s71 offen offset:256 nt
    v_add_f32_dpp v230, v229, v229 row_shr:4 row_mask:0xf bank_mask:0xa
    s_waitcnt vmcnt(35)
    v_pk_fma_f32 v[198:199], v[128:129], v[12:13], v[198:199]
    v_pk_fma_f32 v[198:199], v[130:131], v[14:15], v[198:199]
    s_waitcnt lgkmcnt(0)
    v_cmp_lt_u32 vcc, v0, v244
    ds_add_u32 v224, v243 offset:3328
    buffer_load_dwordx4 v[12:15], v1, s[24:27], s71 offen offset:512 nt
    v_add_f32_dpp v232, v230, v230 quad_perm:[2,3,0,1] row_mask:0xf bank_mask:0xf
    v_add_f32 v228, v198, v199
    s_waitcnt vmcnt(35)
    v_pk_fma_f32 v[198:199], v[120:121], v[16:17], v[200:201]
    v_pk_fma_f32 v[198:199], v[122:123], v[18:19], v[198:199]
    s_add_u32 s71, s71, 3072
    s_cbranch_vccnz L_th27_1
L_tb27_1:
    buffer_load_dwordx4 v[16:19], v1, s[24:27], s71 offen offset:0 nt
    v_cndmask_b32 v232, v231, v232, s[64:65]
    v_add_f32_dpp v229, v228, v228 row_ror:8 row_mask:0xf bank_mask:0x3
    s_waitcnt vmcnt(29)
    v_pk_fma_f32 v[198:199], v[124:125], v[20:21], v[198:199]
    v_pk_fma_f32 v[198:199], v[126:127], v[22:23], v[198:199]
    s_add_u32 s72, s72, 3072
    buffer_load_dwordx2 v[180:181], v2, s[32:35], s72 offen offset:0
    buffer_load_dwordx2 v[182:183], v2, s[32:35], s72 offen offset:128
    buffer_load_dwordx2 v[184:185], v2, s[32:35], s72 offen offset:256
    buffer_load_dwordx2 v[186:187], v2, s[36:39], s72 offen offset:0
    buffer_load_dwordx2 v[188:189], v2, s[36:39], s72 offen offset:128
    buffer_load_dwordx2 v[190:191], v2, s[36:39], s72 offen offset:256
    buffer_load_dwordx4 v[20:23], v1, s[24:27], s71 offen offset:256 nt
    v_add_f32_dpp v231, v232, v232 quad_perm:[1,0,3,2] row_mask:0xf bank_mask:0xf
    v_lshlrev_b32 v234, 16, v156
    v_and_b32 v235, 0xffff0000, v156
    v_pk_mul_f32 v[144:145], v[234:235], v[108:109]
    v_lshlrev_b32 v234, 16, v162
    v_and_b32 v235, 0xffff0000, v162
    s_waitcnt vmcnt(35)
    v_pk_fma_f32 v[198:199], v[128:129], v[24:25], v[198:199]
    v_pk_fma_f32 v[198:199], v[130:131], v[26:27], v[198:199]
    ds_add_u32 v224, v243 offset:3328
    buffer_load_dwordx4 v[24:27], v1, s[24:27], s71 offen offset:512 nt
    v_cndmask_b32 v233, v233, v231, s[66:67]
    v_mul_f32 v233, 0x58000000, v233
    ds_write_b32 v239, v233
    v_add_u32 v239, 256, v239
    v_add_f32 v228, v198, v199
    v_pk_mul_f32 v[202:203], v[144:145], v[234:235]
    v_lshlrev_b32 v234, 16, v157
    v_and_b32 v235, 0xffff0000, v157
    v_pk_mul_f32 v[146:147], v[234:235], v[110:111]
    v_lshlrev_b32 v234, 16, v163
    s_waitcnt vmcnt(35)
    v_pk_fma_f32 v[198:199], v[120:121], v[28:29], v[200:201]
    v_pk_fma_f32 v[198:199], v[122:123], v[30:31], v[198:199]
    s_add_u32 s71, s71, 3072
    s_cbranch_vccnz L_th30_1
L_tb30_1:
    buffer_load_dwordx4 v[28:31], v1, s[24:27], s71 offen offset:0 nt
    v_add_f32_dpp v229, v228, v228 row_ror:8 row_mask:0xf bank_mask:0xc
    v_and_b32 v235, 0xffff0000, v163
    v_pk_fma_f32 v[202:203], v[146:147], v[234:235], v[202:203]
    v_lshlrev_b32 v234, 16, v158
    v_and_b32 v235, 0xffff0000, v158
    v_pk_mul_f32 v[148:149], v[234:235], v[112:113]
    s_waitcnt vmcnt(35)
    v_pk_fma_f32 v[198:199], v[124:125], v[32:33], v[198:199]
    v_pk_fma_f32 v[198:199], v[126:127], v[34:35], v[198:199]
    buffer_load_dwordx4 v[32:35], v1, s[24:27], s71 offen offset:256 nt
    v_add_f32_dpp v230, v229, v229 row_shl:4 row_mask:0xf bank_mask:0x5
    v_lshlrev_b32 v234, 16, v164
    v_and_b32 v235, 0xffff0000, v164
    v_pk_fma_f32 v[202:203], v[148:149], v[234:235], v[202:203]
    v_lshlrev_b32 v234, 16, v159
    v_and_b32 v235, 0xffff0000, v159
    s_waitcnt vmcnt(35)
    v_pk_fma_f32 v[198:199], v[128:129], v[36:37], v[198:199]
    v_pk_fma_f32 v[198:199], v[130:131], v[38:39], v[198:199]
    ds_add_u32 v224, v243 offset:3328
    buffer_load_dwordx4 v[36:39], v1, s[24:27], s71 offen offset:512 nt
    v_add_f32 v228, v198, v199
    v_pk_mul_f32 v[150:151], v[234:235], v[114:115]
    v_lshlrev_b32 v234, 16, v165
    v_and_b32 v235, 0xffff0000, v165
    v_pk_fma_f32 v[202:203], v[150:151], v[234:235], v[202:203]
    v_lshlrev_b32 v234, 16, v160
    s_waitcnt vmcnt(35)
    v_pk_fma_f32 v[198:199], v[120:121], v[40:41], v[200:201]
    v_pk_fma_f32 v[198:199], v[122:123], v[42:43], v[198:199]
    s_add_u32 s71, s71, 3072
    s_cbranch_vccnz L_th33_1
L_tb33_1:
    buffer_load_dwordx4 v[40:43], v1, s[24:27], s71 offen offset:0 nt
    v_add_f32_dpp v229, v228, v228 row_ror:8 row_mask:0xf bank_mask:0x3
    v_and_b32 v235, 0xffff0000, v160
    v_pk_mul_f32 v[152:153], v[234:235], v[116:117]
    v_lshlrev_b32 v234, 16, v166
    v_and_b32 v235, 0xffff0000, v166
    v_pk_fma_f32 v[202:203], v[152:153], v[234:235], v[202:203]
    s_waitcnt vmcnt(35)
    v_pk_fma_f32 v[198:199], v[124:125], v[44:45], v[198:199]
    v_pk_fma_f32 v[198:199], v[126:127], v[46:47], v[198:199]
    buffer_load_dwordx4 v[44:47], v1, s[24:27], s71 offen offset:256 nt
    v_lshlrev_b32 v234, 16, v161
    v_and_b32 v235, 0xffff0000, v161
    v_pk_mul_f32 v[154:155], v[234:235], v[118:119]
    v_lshlrev_b32 v234, 16, v167
    v_and_b32 v235, 0xffff0000, v167
    s_waitcnt vmcnt(35)
    v_pk_fma_f32 v[198:199], v[128:129], v[48:49], v[198:199]
    v_pk_fma_f32 v[198:199], v[130:131], v[50:51], v[198:199]
    ds_add_u32 v224, v243 offset:3328
    buffer_load_dwordx4 v[48:51], v1, s[24:27], s71 offen offset:512 nt
    v_add_f32 v228, v198, v199
    v_pk_fma_f32 v[202:203], v[154:155], v[234:235], v[202:203]
    v_pk_mul_f32 v[202:203], v[202:203], s[62:63]
    s_waitcnt vmcnt(35)
    v_pk_fma_f32 v[198:199], v[144:145], v[52:53], v[202:203]
    v_pk_fma_f32 v[198:199], v[146:147], v[54:55], v[198:199]
    ds_read_b32 v244, v243 offset:147
    s_mov_b32 s91, 0
    v_readlane_b32 s70, v245, s91
    s_add_u32 s91, s91, 1
    s_and_b32 s80, s70, 31
    s_mul_i32 s80, s80, 96
    s_lshl_b32 s73, s70, 7
    s_sub_u32 s73, s73, s80
    buffer_load_ushort v220, v3, s[40:43], s73 offen
    buffer_load_ushort v221, v3, s[44:47], s73 offen
    s_add_u32 s71, s71, 384000
    s_cbranch_vccnz L_th36_1
L_tb36_1:
    buffer_load_dwordx4 v[52:55], v1, s[24:27], s71 offen offset:0 nt
    v_add_f32_dpp v229, v228, v228 row_ror:8 row_mask:0xf bank_mask:0xc
    s_waitcnt vmcnt(37)
    v_pk_fma_f32 v[198:199], v[148:149], v[56:57], v[198:199]
    v_pk_fma_f32 v[198:199], v[150:151], v[58:59], v[198:199]
    buffer_load_dwordx4 v[56:59], v1, s[24:27], s71 offen offset:256 nt
    v_add_f32_dpp v230, v229, v229 row_shr:4 row_mask:0xf bank_mask:0xa
    s_waitcnt vmcnt(37)
    v_pk_fma_f32 v[198:199], v[152:153], v[60:61], v[198:199]
    v_pk_fma_f32 v[198:199], v[154:155], v[62:63], v[198:199]
    s_waitcnt lgkmcnt(0)
    v_cmp_lt_u32 vcc, v0, v244
    ds_add_u32 v224, v243 offset:3328
    buffer_load_dwordx4 v[60:63], v1, s[24:27], s71 offen offset:512 nt
    v_add_f32_dpp v231, v230, v230 quad_perm:[2,3,0,1] row_mask:0xf bank_mask:0xf
    v_add_f32 v228, v198, v199
    s_waitcnt vmcnt(37)
    v_pk_fma_f32 v[198:199], v[144:145], v[64:65], v[202:203]
    v_pk_fma_f32 v[198:199], v[146:147], v[66:67], v[198:199]
    s_add_u32 s71, s71, 3072
    s_cbranch_vccnz L_th39_1
L_tb39_1:
    buffer_load_dwordx4 v[64:67], v1, s[24:27], s71 offen offset:0 nt
    v_add_f32_dpp v229, v228, v228 row_ror:8 row_mask:0xf bank_mask:0x3
    s_waitcnt vmcnt(31)
    v_pk_fma_f32 v[198:199], v[148:149], v[68:69], v[198:199]
    v_pk_fma_f32 v[198:199], v[150:151], v[70:71], v[198:199]
    buffer_load_dwordx4 v[68:71], v1, s[24:27], s71 offen offset:256 nt
    v_lshlrev_b32 v234, 16, v168
    v_and_b32 v235, 0xffff0000, v168
    v_pk_mul_f32 v[120:121], v[234:235], v[108:109]
    v_lshlrev_b32 v234, 16, v174
    v_and_b32 v235, 0xffff0000, v174
    s_waitcnt vmcnt(31)
    v_pk_fma_f32 v[198:199], v[152:153], v[72:73], v[198:199]
    v_pk_fma_f32 v[198:199], v[154:155], v[74:75], v[198:199]
    ds_add_u32 v224, v243 offset:3328
    buffer_load_dwordx4 v[72:75], v1, s[24:27], s71 offen offset:512 nt
    v_add_f32 v228, v198, v199
    v_pk_mul_f32 v[200:201], v[120:121], v[234:235]
    v_lshlrev_b32 v234, 16, v169
    v_and_b32 v235, 0xffff0000, v169
    v_pk_mul_f32 v[122:123], v[234:235], v[110:111]
    v_lshlrev_b32 v234, 16, v175
    s_waitcnt vmcnt(31)
    v_pk_fma_f32 v[198:199], v[144:145], v[76:77], v[202:203]
    v_pk_fma_f32 v[198:199], v[146:147], v[78:79], v[198:199]
    s_add_u32 s71, s71, 3072
    s_cbranch_vccnz L_th42_1
L_tb42_1:
    buffer_load_dwordx4 v[76:79], v1, s[24:27], s71 offen offset:0 nt
    v_add_f32_dpp v229, v228, v228 row_ror:8 row_mask:0xf bank_mask:0xc
    v_and_b32 v235, 0xffff0000, v175
    v_pk_fma_f32 v[200:201], v[122:123], v[234:235], v[200:201]
    v_lshlrev_b32 v234, 16, v170
    v_and_b32 v235, 0xffff0000, v170
    v_pk_mul_f32 v[124:125], v[234:235], v[112:113]
    s_waitcnt vmcnt(31)
    v_pk_fma_f32 v[198:199], v[148:149], v[80:81], v[198:199]
    v_pk_fma_f32 v[198:199], v[150:151], v[82:83], v[198:199]
    buffer_load_dwordx4 v[80:83], v1, s[24:27], s71 offen offset:256 nt
    v_add_f32_dpp v230, v229, v229 row_shl:4 row_mask:0xf bank_mask:0x5
    v_lshlrev_b32 v234, 16, v176
    v_and_b32 v235, 0xffff0000, v176
    v_pk_fma_f32 v[200:201], v[124:125], v[234:235], v[200:201]
    v_lshlrev_b32 v234, 16, v171
    v_and_b32 v235, 0xffff0000, v171
    s_waitcnt vmcnt(31)
    v_pk_fma_f32 v[198:199], v[152:153], v[84:85], v[198:199]
    v_pk_fma_f32 v[198:199], v[154:155], v[86:87], v[198:199]
    ds_add_u32 v224, v243 offset:3328
    buffer_load_dwordx4 v[84:87], v1, s[24:27], s71 offen offset:512 nt
    v_add_f32 v228, v198, v199
    v_pk_mul_f32 v[126:127], v[234:235], v[114:115]
    v_lshlrev_b32 v234, 16, v177
    v_and_b32 v235, 0xffff0000, v177
    v_pk_fma_f32 v[200:201], v[126:127], v[234:235], v[200:201]
    v_lshlrev_b32 v234, 16, v172
    s_waitcnt vmcnt(31)
    v_pk_fma_f32 v[198:199], v[144:145], v[88:89], v[202:203]
    v_pk_fma_f32 v[198:199], v[146:147], v[90:91], v[198:199]
    s_add_u32 s71, s71, 3072
    s_cbranch_vccnz L_th45_1
L_tb45_1:
    buffer_load_dwordx4 v[88:91], v1, s[24:27], s71 offen offset:0 nt
    v_add_f32_dpp v229, v228, v228 row_ror:8 row_mask:0xf bank_mask:0x3
    v_and_b32 v235, 0xffff0000, v172
    v_pk_mul_f32 v[128:129], v[234:235], v[116:117]
    v_lshlrev_b32 v234, 16, v178
    v_and_b32 v235, 0xffff0000, v178
    v_pk_fma_f32 v[200:201], v[128:129], v[234:235], v[200:201]
    s_waitcnt vmcnt(31)
    v_pk_fma_f32 v[198:199], v[148:149], v[92:93], v[198:199]
    v_pk_fma_f32 v[198:199], v[150:151], v[94:95], v[198:199]
    buffer_load_dwordx4 v[92:95], v1, s[24:27], s71 offen offset:256 nt
    v_lshlrev_b32 v234, 16, v173
    v_and_b32 v235, 0xffff0000, v173
    v_pk_mul_f32 v[130:131], v[234:235], v[118:119]
    v_lshlrev_b32 v234, 16, v179
    v_and_b32 v235, 0xffff0000, v179
    s_waitcnt vmcnt(31)
    v_pk_fma_f32 v[198:199], v[152:153], v[96:97], v[198:199]
    v_pk_fma_f32 v[198:199], v[154:155], v[98:99], v[198:199]
    ds_add_u32 v224, v243 offset:3328
    buffer_load_dwordx4 v[96:99], v1, s[24:27], s71 offen offset:512 nt
    v_add_f32 v228, v198, v199
    v_pk_fma_f32 v[200:201], v[130:131], v[234:235], v[200:201]
    v_pk_mul_f32 v[200:201], v[200:201], s[62:63]
    s_waitcnt vmcnt(31)
    v_pk_fma_f32 v[198:199], v[120:121], v[4:5], v[200:201]
    v_pk_fma_f32 v[198:199], v[122:123], v[6:7], v[198:199]
    ds_read_b32 v244, v243 offset:147
    s_mul_i32 s71, s70, 49152
    s_and_b32 s80, s70, 31
    s_mul_i32 s80, s80, 36864
    s_sub_u32 s71, s71, s80
    s_cbranch_vccnz L_th0_1
L_tb0_1:
    buffer_load_dwordx4 v[4:7], v1, s[28:31], s71 offen offset:0 nt
    v_add_f32_dpp v229, v228, v228 row_ror:8 row_mask:0xf bank_mask:0xc
    s_waitcnt vmcnt(31)
    v_pk_fma_f32 v[198:199], v[124:125], v[8:9], v[198:199]
    v_pk_fma_f32 v[198:199], v[126:127], v[10:11], v[198:199]
    buffer_load_dwordx4 v[8:11], v1, s[28:31], s71 offen offset:256 nt
    v_add_f32_dpp v230, v229, v229 row_shr:4 row_mask:0xf bank_mask:0xa
    s_waitcnt vmcnt(31)
    v_pk_fma_f32 v[198:199], v[128:129], v[12:13], v[198:199]
    v_pk_fma_f32 v[198:199], v[130:131], v[14:15], v[198:199]
    s_waitcnt lgkmcnt(0)
    v_cmp_lt_u32 vcc, v0, v244
    ds_add_u32 v224, v243 offset:3328
    buffer_load_dwordx4 v[12:15], v1, s[28:31], s71 offen offset:512 nt
    v_add_f32_dpp v232, v230, v230 quad_perm:[2,3,0,1] row_mask:0xf bank_mask:0xf
    v_add_f32 v228, v198, v199
    s_waitcnt vmcnt(31)
    v_pk_fma_f32 v[198:199], v[120:121], v[16:17], v[200:201]
    v_pk_fma_f32 v[198:199], v[122:123], v[18:19], v[198:199]
    s_add_u32 s71, s71, 3072
    s_cbranch_vccnz L_th3_1
L_tb3_1:
    buffer_load_dwordx4 v[16:19], v1, s[28:31], s71 offen offset:0 nt
    v_cndmask_b32 v232, v231, v232, s[64:65]
    v_add_f32_dpp v229, v228, v228 row_ror:8 row_mask:0xf bank_mask:0x3
    s_waitcnt vmcnt(25)
    v_pk_fma_f32 v[198:199], v[124:125], v[20:21], v[198:199]
    v_pk_fma_f32 v[198:199], v[126:127], v[22:23], v[198:199]
    buffer_load_dwordx4 v[20:23], v1, s[28:31], s71 offen offset:256 nt
    v_add_f32_dpp v233, v232, v232 quad_perm:[1,0,3,2] row_mask:0xf bank_mask:0xf
    v_lshlrev_b32 v234, 16, v180
    v_and_b32 v235, 0xffff0000, v180
    v_pk_mul_f32 v[144:145], v[234:235], v[108:109]
    v_lshlrev_b32 v234, 16, v186
    v_and_b32 v235, 0xffff0000, v186
    s_waitcnt vmcnt(25)
    v_pk_fma_f32 v[198:199], v[128:129], v[24:25], v[198:199]
    v_pk_fma_f32 v[198:199], v[130:131], v[26:27], v[198:199]
    ds_add_u32 v224, v243 offset:3328
    buffer_load_dwordx4 v[24:27], v1, s[28:31], s71 offen offset:512 nt
    v_add_f32 v228, v198, v199
    v_pk_mul_f32 v[202:203], v[144:145], v[234:235]
    v_lshlrev_b32 v234, 16, v181
    v_and_b32 v235, 0xffff0000, v181
    v_pk_mul_f32 v[146:147], v[234:235], v[110:111]
    v_lshlrev_b32 v234, 16, v187
    s_waitcnt vmcnt(25)
    v_pk_fma_f32 v[198:199], v[120:121], v[28:29], v[200:201]
    v_pk_fma_f32 v[198:199], v[122:123], v[30:31], v[198:199]
    s_add_u32 s71, s71, 3072
    s_cbranch_vccnz L_th6_1
L_tb6_1:
    buffer_load_dwordx4 v[28:31], v1, s[28:31], s71 offen offset:0 nt
    v_add_f32_dpp v229, v228, v228 row_ror:8 row_mask:0xf bank_mask:0xc
    v_and_b32 v235, 0xffff0000, v187
    v_pk_fma_f32 v[202:203], v[146:147], v[234:235], v[202:203]
    v_lshlrev_b32 v234, 16, v182
    v_and_b32 v235, 0xffff0000, v182
    v_pk_mul_f32 v[148:149], v[234:235], v[112:113]
    s_waitcnt vmcnt(25)
    v_pk_fma_f32 v[198:199], v[124:125], v[32:33], v[198:199]
    v_pk_fma_f32 v[198:199], v[126:127], v[34:35], v[198:199]
    buffer_load_dwordx4 v[32:35], v1, s[28:31], s71 offen offset:256 nt
    v_add_f32_dpp v230, v229, v229 row_shl:4 row_mask:0xf bank_mask:0x5
    v_lshlrev_b32 v234, 16, v188
    v_and_b32 v235, 0xffff0000, v188
    v_pk_fma_f32 v[202:203], v[148:149], v[234:235], v[202:203]
    v_lshlrev_b32 v234, 16, v183
    v_and_b32 v235, 0xffff0000, v183
    s_waitcnt vmcnt(25)
    v_pk_fma_f32 v[198:199], v[128:129], v[36:37], v[198:199]
    v_pk_fma_f32 v[198:199], v[130:131], v[38:39], v[198:199]
    ds_add_u32 v224, v243 offset:3328
    buffer_load_dwordx4 v[36:39], v1, s[28:31], s71 offen offset:512 nt
    v_add_f32 v228, v198, v199
    v_pk_mul_f32 v[150:151], v[234:235], v[114:115]
    v_lshlrev_b32 v234, 16, v189
    v_and_b32 v235, 0xffff0000, v189
    v_pk_fma_f32 v[202:203], v[150:151], v[234:235], v[202:203]
    v_lshlrev_b32 v234, 16, v184
    s_waitcnt vmcnt(25)
    v_pk_fma_f32 v[198:199], v[120:121], v[40:41], v[200:201]
    v_pk_fma_f32 v[198:199], v[122:123], v[42:43], v[198:199]
    s_add_u32 s71, s71, 3072
    s_cbranch_vccnz L_th9_1
L_tb9_1:
    buffer_load_dwordx4 v[40:43], v1, s[28:31], s71 offen offset:0 nt
    v_add_f32_dpp v229, v228, v228 row_ror:8 row_mask:0xf bank_mask:0x3
    v_and_b32 v235, 0xffff0000, v184
    v_pk_mul_f32 v[152:153], v[234:235], v[116:117]
    v_lshlrev_b32 v234, 16, v190
    v_and_b32 v235, 0xffff0000, v190
    v_pk_fma_f32 v[202:203], v[152:153], v[234:235], v[202:203]
    s_waitcnt vmcnt(25)
    v_pk_fma_f32 v[198:199], v[124:125], v[44:45], v[198:199]
    v_pk_fma_f32 v[198:199], v[126:127], v[46:47], v[198:199]
    buffer_load_dwordx4 v[44:47], v1, s[28:31], s71 offen offset:256 nt
    v_lshlrev_b32 v234, 16, v185
    v_and_b32 v235, 0xffff0000, v185
    v_pk_mul_f32 v[154:155], v[234:235], v[118:119]
    v_lshlrev_b32 v234, 16, v191
    v_and_b32 v235, 0xffff0000, v191
    s_waitcnt vmcnt(25)
    v_pk_fma_f32 v[198:199], v[128:129], v[48:49], v[198:199]
    v_pk_fma_f32 v[198:199], v[130:131], v[50:51], v[198:199]
    ds_add_u32 v224, v243 offset:3328
    buffer_load_dwordx4 v[48:51], v1, s[28:31], s71 offen offset:512 nt
    v_add_f32 v228, v198, v199
    v_pk_fma_f32 v[202:203], v[154:155], v[234:235], v[202:203]
    v_pk_mul_f32 v[202:203], v[202:203], s[62:63]
    s_waitcnt vmcnt(23)
    v_pk_fma_f32 v[198:199], v[144:145], v[52:53], v[202:203]
    v_pk_fma_f32 v[198:199], v[146:147], v[54:55], v[198:199]
    ds_read_b32 v244, v243 offset:147
    s_add_u32 s71, s71, 384000
    s_cbranch_vccnz L_th12_1
L_tb12_1:
    buffer_load_dwordx4 v[52:55], v1, s[28:31], s71 offen offset:0 nt
    v_add_f32_dpp v229, v228, v228 row_ror:8 row_mask:0xf bank_mask:0xc
    s_waitcnt vmcnt(23)
    v_pk_fma_f32 v[198:199], v[148:149], v[56:57], v[198:199]
    v_pk_fma_f32 v[198:199], v[150:151], v[58:59], v[198:199]
    buffer_load_dwordx4 v[56:59], v1, s[28:31], s71 offen offset:256 nt
    v_add_f32_dpp v230, v229, v229 row_shr:4 row_mask:0xf bank_mask:0xa
    s_waitcnt vmcnt(23)
    v_pk_fma_f32 v[198:199], v[152:153], v[60:61], v[198:199]
    v_pk_fma_f32 v[198:199], v[154:155], v[62:63], v[198:199]
    s_waitcnt lgkmcnt(0)
    v_cmp_lt_u32 vcc, v0, v244
    ds_add_u32 v224, v243 offset:3328
    buffer_load_dwordx4 v[60:63], v1, s[28:31], s71 offen offset:512 nt
    v_add_f32_dpp v231, v230, v230 quad_perm:[2,3,0,1] row_mask:0xf bank_mask:0xf
    v_add_f32 v228, v198, v199
    s_waitcnt vmcnt(23)
    v_pk_fma_f32 v[198:199], v[144:145], v[64:65], v[202:203]
    v_pk_fma_f32 v[198:199], v[146:147], v[66:67], v[198:199]
    s_add_u32 s71, s71, 3072
    s_cbranch_vccnz L_th15_1
L_tb15_1:
    buffer_load_dwordx4 v[64:67], v1, s[28:31], s71 offen offset:0 nt
    v_add_f32_dpp v229, v228, v228 row_ror:8 row_mask:0xf bank_mask:0x3
    s_waitcnt vmcnt(23)
    v_pk_fma_f32 v[198:199], v[148:149], v[68:69], v[198:199]
    v_pk_fma_f32 v[198:199], v[150:151], v[70:71], v[198:199]
    buffer_load_dwordx4 v[68:71], v1, s[28:31], s71 offen offset:256 nt
    s_waitcnt vmcnt(23)
    v_pk_fma_f32 v[198:199], v[152:153], v[72:73], v[198:199]
    v_pk_fma_f32 v[198:199], v[154:155], v[74:75], v[198:199]
    ds_add_u32 v224, v243 offset:3328
    buffer_load_dwordx4 v[72:75], v1, s[28:31], s71 offen offset:512 nt
    v_add_f32 v228, v198, v199
    s_waitcnt vmcnt(23)
    v_pk_fma_f32 v[198:199], v[144:145], v[76:77], v[202:203]
    v_pk_fma_f32 v[198:199], v[146:147], v[78:79], v[198:199]
    s_add_u32 s71, s71, 3072
    s_cbranch_vccnz L_th18_1
L_tb18_1:
    buffer_load_dwordx4 v[76:79], v1, s[28:31], s71 offen offset:0 nt
    v_add_f32_dpp v229, v228, v228 row_ror:8 row_mask:0xf bank_mask:0xc
    s_waitcnt vmcnt(23)
    v_pk_fma_f32 v[198:199], v[148:149], v[80:81], v[198:199]
    v_pk_fma_f32 v[198:199], v[150:151], v[82:83], v[198:199]
    buffer_load_dwordx4 v[80:83], v1, s[28:31], s71 offen offset:256 nt
    v_add_f32_dpp v230, v229, v229 row_shl:4 row_mask:0xf bank_mask:0x5
    s_waitcnt vmcnt(23)
    v_pk_fma_f32 v[198:199], v[152:153], v[84:85], v[198:199]
    s_branch L_x1
L_w1:
    s_branch L_w2
L_x1:
    v_pk_fma_f32 v[198:199], v[154:155], v[86:87], v[198:199]
    ds_add_u32 v224, v243 offset:3328
    buffer_load_dwordx4 v[84:87], v1, s[28:31], s71 offen offset:512 nt
    v_add_f32 v228, v198, v199
    s_waitcnt vmcnt(23)
    v_pk_fma_f32 v[198:199], v[144:145], v[88:89], v[202:203]
    v_pk_fma_f32 v[198:199], v[146:147], v[90:91], v[198:199]
    s_add_u32 s71, s71, 3072
    s_cbranch_vccnz L_th21_1
L_tb21_1:
    buffer_load_dwordx4 v[88:91], v1, s[28:31], s71 offen offset:0 nt
    v_add_f32_dpp v229, v228, v228 row_ror:8 row_mask:0xf bank_mask:0x3
    s_waitcnt vmcnt(23)
    v_pk_fma_f32 v[198:199], v[148:149], v[92:93], v[198:199]
    v_pk_fma_f32 v[198:199], v[150:151], v[94:95], v[198:199]
    buffer_load_dwordx4 v[92:95], v1, s[28:31], s71 offen offset:256 nt
    s_waitcnt vmcnt(23)
    v_pk_fma_f32 v[198:199], v[152:153], v[96:97], v[198:199]
    v_pk_fma_f32 v[198:199], v[154:155], v[98:99], v[198:199]
    ds_add_u32 v224, v243 offset:3328
    buffer_load_dwordx4 v[96:99], v1, s[28:31], s71 offen offset:512 nt
    v_add_f32 v228, v198, v199
    s_nop 1
    v_add_f32_dpp v229, v228, v228 row_ror:8 row_mask:0xf bank_mask:0xc
    s_nop 1
    v_add_f32_dpp v230, v229, v229 row_shr:4 row_mask:0xf bank_mask:0xa
    s_nop 1
    v_add_f32_dpp v232, v230, v230 quad_perm:[2,3,0,1] row_mask:0xf bank_mask:0xf
    s_nop 1
    v_cndmask_b32 v232, v231, v232, s[64:65]
    s_nop 1
    v_add_f32_dpp v231, v232, v232 quad_perm:[1,0,3,2] row_mask:0xf bank_mask:0xf
    s_nop 1
    v_cndmask_b32 v233, v233, v231, s[66:67]
    v_mul_f32 v233, 0x58000000, v233
    ds_write_b32 v239, v233
    v_add_u32 v239, 256, v239
    s_mov_b64 exec, 1
    ds_add_u32 v243, v243 offset:127
    s_mov_b64 exec, -1
    ds_read_b32 v223, v240
    v_add_u32 v240, 256, v240
    v_lshlrev_b32 v220, 16, v220
    v_lshlrev_b32 v221, 16, v221
    s_waitcnt lgkmcnt(0)
    v_max_f32_dpp v234, v223, v223 row_ror:8 row_mask:0xf bank_mask:0xf
    s_nop 1
    v_max_f32_dpp v234, v234, v234 row_ror:4 row_mask:0xf bank_mask:0xf
    s_nop 1
    v_max_f32_dpp v234, v234, v234 row_ror:2 row_mask:0xf bank_mask:0xf
    s_nop 1
    v_max_f32_dpp v234, v234, v234 row_ror:1 row_mask:0xf bank_mask:0xf
    v_mov_b32 v228, v216
    v_max3_f32 v234, v234, v228, s77
    v_sub_f32 v235, v228, v234
    v_sub_f32 v229, v223, v234
    v_exp_f32 v235, v235
    v_exp_f32 v229, v229
    s_nop 0
    v_mul_f32 v222, v229, v220
    v_mul_f32 v230, v222, v221
    v_mul_f32 v238, 0x71800000, v222
    s_nop 0
    s_mov_b32 s76, 63
L_loop1:
    v_mov_b32_dpp v236, v238 row_newbcast:0 row_mask:0xf bank_mask:0xf
    s_waitcnt vmcnt(23)
    v_pk_fma_f32 v[204:205], v[236:237], v[4:5], v[204:205] op_sel_hi:[0,1,1]
    v_pk_fma_f32 v[206:207], v[236:237], v[6:7], v[206:207] op_sel_hi:[0,1,1]
    s_nop 1
    ds_read_b32 v244, v243 offset:147
    s_add_u32 s71, s71, 384000
    s_cbranch_vccnz L_th24_2
L_tb24_2:
    buffer_load_dwordx4 v[4:7], v1, s[28:31], s71 offen offset:0 nt
    s_bitcmp0_b32 s4, 0
    s_cbranch_scc1 L_nofl2
    s_mov_b64 exec, 1
    ds_add_u32 v242, v243
    s_mov_b64 exec, -1
    v_add_u32 v241, 4096, v241
    v_add_u32 v242, 4, v242
L_nofl2:
    s_waitcnt vmcnt(23)
    v_pk_fma_f32 v[208:209], v[236:237], v[8:9], v[208:209] op_sel_hi:[0,1,1]
    v_pk_fma_f32 v[210:211], v[236:237], v[10:11], v[210:211] op_sel_hi:[0,1,1]
    s_nop 1
    buffer_load_dwordx4 v[8:11], v1, s[28:31], s71 offen offset:256 nt
    v_pk_mul_f32 v[212:213], v[212:213], v[234:235] op_sel:[0,1] op_sel_hi:[1,1]
    v_pk_mul_f32 v[214:215], v[214:215], v[234:235] op_sel:[0,1] op_sel_hi:[1,1]
    v_mov_b32 v216, v234
    s_waitcnt vmcnt(23)
    v_pk_fma_f32 v[212:213], v[236:237], v[12:13], v[212:213] op_sel_hi:[0,1,1]
    v_pk_fma_f32 v[214:215], v[236:237], v[14:15], v[214:215] op_sel_hi:[0,1,1]
    s_nop 1
    s_waitcnt lgkmcnt(0)
    v_cmp_lt_u32 vcc, v0, v244
    ds_add_u32 v224, v243 offset:3328
    buffer_load_dwordx4 v[12:15], v1, s[28:31], s71 offen offset:512 nt
    v_fma_f32 v217, v217, v235, v229
    v_mov_b32_dpp v236, v238 row_newbcast:8 row_mask:0xf bank_mask:0xf
    s_waitcnt vmcnt(23)
    v_pk_fma_f32 v[204:205], v[236:237], v[16:17], v[204:205] op_sel_hi:[0,1,1]
    v_pk_fma_f32 v[206:207], v[236:237], v[18:19], v[206:207] op_sel_hi:[0,1,1]
    s_nop 1
    s_add_u32 s71, s71, 3072
    s_cbranch_vccnz L_th27_2
L_tb27_2:
    buffer_load_dwordx4 v[16:19], v1, s[28:31], s71 offen offset:0 nt
    v_fma_f32 v218, v218, v235, v230
    s_waitcnt vmcnt(23)
    v_pk_fma_f32 v[208:209], v[236:237], v[20:21], v[208:209] op_sel_hi:[0,1,1]
    v_pk_fma_f32 v[210:211], v[236:237], v[22:23], v[210:211] op_sel_hi:[0,1,1]
    s_nop 1
    buffer_load_dwordx4 v[20:23], v1, s[28:31], s71 offen offset:256 nt
    ds_read_b32 v223, v240
    v_add_u32 v240, 256, v240
    s_waitcnt vmcnt(23)
    v_pk_fma_f32 v[212:213], v[236:237], v[24:25], v[212:213] op_sel_hi:[0,1,1]
    v_pk_fma_f32 v[214:215], v[236:237], v[26:27], v[214:215] op_sel_hi:[0,1,1]
    s_nop 1
    ds_add_u32 v224, v243 offset:3328
    buffer_load_dwordx4 v[24:27], v1, s[28:31], s71 offen offset:512 nt
    v_mov_b32_dpp v236, v238 row_newbcast:4 row_mask:0xf bank_mask:0xf
    s_waitcnt vmcnt(23)
    v_pk_fma_f32 v[204:205], v[236:237], v[28:29], v[204:205] op_sel_hi:[0,1,1]
    v_pk_fma_f32 v[206:207], v[236:237], v[30:31], v[206:207] op_sel_hi:[0,1,1]
    s_nop 1
    s_add_u32 s71, s71, 3072
    s_cbranch_vccnz L_th30_2
L_tb30_2:
    buffer_load_dwordx4 v[28:31], v1, s[28:31], s71 offen offset:0 nt
    ds_write_b128 v241, v[216:219] offset:23552
    s_waitcnt vmcnt(23)
    v_pk_fma_f32 v[208:209], v[236:237], v[32:33], v[208:209] op_sel_hi:[0,1,1]
    v_pk_fma_f32 v[210:211], v[236:237], v[34:35], v[210:211] op_sel_hi:[0,1,1]
    s_nop 1
    buffer_load_dwordx4 v[32:35], v1, s[28:31], s71 offen offset:256 nt
    s_waitcnt vmcnt(23)
    v_pk_fma_f32 v[212:213], v[236:237], v[36:37], v[212:213] op_sel_hi:[0,1,1]
    v_pk_fma_f32 v[214:215], v[236:237], v[38:39], v[214:215] op_sel_hi:[0,1,1]
    s_nop 1
    ds_add_u32 v224, v243 offset:3328
    buffer_load_dwordx4 v[36:39], v1, s[28:31], s71 offen offset:512 nt
    v_mov_b32_dpp v236, v238 row_newbcast:12 row_mask:0xf bank_mask:0xf
    s_waitcnt vmcnt(23)
    v_pk_fma_f32 v[204:205], v[236:237], v[40:41], v[204:205] op_sel_hi:[0,1,1]
    v_pk_fma_f32 v[206:207], v[236:237], v[42:43], v[206:207] op_sel_hi:[0,1,1]
    s_nop 1
    s_add_u32 s71, s71, 3072
    s_cbranch_vccnz L_th33_2
L_tb33_2:
    buffer_load_dwordx4 v[40:43], v1, s[28:31], s71 offen offset:0 nt
    s_waitcnt vmcnt(23)
    v_pk_fma_f32 v[208:209], v[236:237], v[44:45], v[208:209] op_sel_hi:[0,1,1]
    v_pk_fma_f32 v[210:211], v[236:237], v[46:47], v[210:211] op_sel_hi:[0,1,1]
    s_nop 1
    buffer_load_dwordx4 v[44:47], v1, s[28:31], s71 offen offset:256 nt
    s_waitcnt vmcnt(23)
    v_pk_fma_f32 v[212:213], v[236:237], v[48:49], v[212:213] op_sel_hi:[0,1,1]
    v_pk_fma_f32 v[214:215], v[236:237], v[50:51], v[214:215] op_sel_hi:[0,1,1]
    s_nop 1
    ds_add_u32 v224, v243 offset:3328
    buffer_load_dwordx4 v[48:51], v1, s[28:31], s71 offen offset:512 nt
    v_mov_b32_dpp v236, v238 row_newbcast:2 row_mask:0xf bank_mask:0xf
    s_waitcnt vmcnt(23)
    v_pk_fma_f32 v[204:205], v[236:237], v[52:53], v[204:205] op_sel_hi:[0,1,1]
    v_pk_fma_f32 v[206:207], v[236:237], v[54:55], v[206:207] op_sel_hi:[0,1,1]
    s_nop 1
    ds_read_b32 v244, v243 offset:147
    v_readlane_b32 s70, v245, s91
    s_add_u32 s91, s91, 1
    s_and_b32 s80, s70, 31
    s_mul_i32 s80, s80, 96
    s_lshl_b32 s73, s70, 7
    s_sub_u32 s73, s73, s80
    buffer_load_ushort v220, v3, s[40:43], s73 offen
    buffer_load_ushort v221, v3, s[44:47], s73 offen
    s_add_u32 s71, s71, 384000
    s_cbranch_vccnz L_th36_2
L_tb36_2:
    buffer_load_dwordx4 v[52:55], v1, s[28:31], s71 offen offset:0 nt
    s_waitcnt vmcnt(25)
    v_pk_fma_f32 v[208:209], v[236:237], v[56:57], v[208:209] op_sel_hi:[0,1,1]
    v_pk_fma_f32 v[210:211], v[236:237], v[58:59], v[210:211] op_sel_hi:[0,1,1]
    s_nop 1
    buffer_load_dwordx4 v[56:59], v1, s[28:31], s71 offen offset:256 nt
    s_waitcnt vmcnt(25)
    v_pk_fma_f32 v[212:213], v[236:237], v[60:61], v[212:213] op_sel_hi:[0,1,1]
    v_pk_fma_f32 v[214:215], v[236:237], v[62:63], v[214:215] op_sel_hi:[0,1,1]
    s_nop 1
    s_waitcnt lgkmcnt(0)
    v_cmp_lt_u32 vcc, v0, v244
    ds_add_u32 v224, v243 offset:3328
    buffer_load_dwordx4 v[60:63], v1, s[28:31], s71 offen offset:512 nt
    v_mov_b32_dpp v236, v238 row_newbcast:10 row_mask:0xf bank_mask:0xf
    s_waitcnt vmcnt(25)
    v_pk_fma_f32 v[204:205], v[236:237], v[64:65], v[204:205] op_sel_hi:[0,1,1]
    v_pk_fma_f32 v[206:207], v[236:237], v[66:67], v[206:207] op_sel_hi:[0,1,1]
    s_nop 1
    s_add_u32 s71, s71, 3072
    s_cbranch_vccnz L_th39_2
L_tb39_2:
    buffer_load_dwordx4 v[64:67], v1, s[28:31], s71 offen offset:0 nt
    s_waitcnt vmcnt(25)
    v_pk_fma_f32 v[208:209], v[236:237], v[68:69], v[208:209] op_sel_hi:[0,1,1]
    v_pk_fma_f32 v[210:211], v[236:237], v[70:71], v[210:211] op_sel_hi:[0,1,1]
    s_nop 1
    buffer_load_dwordx4 v[68:71], v1, s[28:31], s71 offen offset:256 nt
    s_waitcnt vmcnt(25)
    v_pk_fma_f32 v[212:213], v[236:237], v[72:73], v[212:213] op_sel_hi:[0,1,1]
    v_pk_fma_f32 v[214:215], v[236:237], v[74:75], v[214:215] op_sel_hi:[0,1,1]
    s_nop 1
    ds_add_u32 v224, v243 offset:3328
    buffer_load_dwordx4 v[72:75], v1, s[28:31], s71 offen offset:512 nt
    v_mov_b32_dpp v236, v238 row_newbcast:6 row_mask:0xf bank_mask:0xf
    s_waitcnt vmcnt(25)
    v_pk_fma_f32 v[204:205], v[236:237], v[76:77], v[204:205] op_sel_hi:[0,1,1]
    v_pk_fma_f32 v[206:207], v[236:237], v[78:79], v[206:207] op_sel_hi:[0,1,1]
    s_nop 1
    s_add_u32 s71, s71, 3072
    s_cbranch_vccnz L_th42_2
L_tb42_2:
    buffer_load_dwordx4 v[76:79], v1, s[28:31], s71 offen offset:0 nt
    s_waitcnt vmcnt(25)
    v_pk_fma_f32 v[208:209], v[236:237], v[80:81], v[208:209] op_sel_hi:[0,1,1]
    v_pk_fma_f32 v[210:211], v[236:237], v[82:83], v[210:211] op_sel_hi:[0,1,1]
    s_nop 1
    buffer_load_dwordx4 v[80:83], v1, s[28:31], s71 offen offset:256 nt
    s_waitcnt vmcnt(25)
    v_pk_fma_f32 v[212:213], v[236:237], v[84:85], v[212:213] op_sel_hi:[0,1,1]
    v_pk_fma_f32 v[214:215], v[236:237], v[86:87], v[214:215] op_sel_hi:[0,1,1]
    s_nop 1
    ds_add_u32 v224, v243 offset:3328
    buffer_load_dwordx4 v[84:87], v1, s[28:31], s71 offen offset:512 nt
    v_mov_b32_dpp v236, v238 row_newbcast:14 row_mask:0xf bank_mask:0xf
    s_waitcnt vmcnt(25)
    v_pk_fma_f32 v[204:205], v[236:237], v[88:89], v[204:205] op_sel_hi:[0,1,1]
    v_pk_fma_f32 v[206:207], v[236:237], v[90:91], v[206:207] op_sel_hi:[0,1,1]
    s_nop 1
    s_add_u32 s71, s71, 3072
    s_cbranch_vccnz L_th45_2
L_tb45_2:
    buffer_load_dwordx4 v[88:91], v1, s[28:31], s71 offen offset:0 nt
    s_waitcnt vmcnt(25)
    v_pk_fma_f32 v[208:209], v[236:237], v[92:93], v[208:209] op_sel_hi:[0,1,1]
    v_pk_fma_f32 v[210:211], v[236:237], v[94:95], v[210:211] op_sel_hi:[0,1,1]
    s_nop 1
    buffer_load_dwordx4 v[92:95], v1, s[28:31], s71 offen offset:256 nt
    s_cmp_eq_u32 s76, 16
    s_cbranch_scc1 L_getm2
L_gotm2:
    s_waitcnt vmcnt(25)
    v_pk_fma_f32 v[212:213], v[236:237], v[96:97], v[212:213] op_sel_hi:[0,1,1]
    v_pk_fma_f32 v[214:215], v[236:237], v[98:99], v[214:215] op_sel_hi:[0,1,1]
    s_nop 1
    ds_add_u32 v224, v243 offset:3328
    buffer_load_dwordx4 v[96:99], v1, s[28:31], s71 offen offset:512 nt
    v_mov_b32_dpp v236, v238 row_newbcast:1 row_mask:0xf bank_mask:0xf
    s_waitcnt vmcnt(25)
    v_pk_fma_f32 v[204:205], v[236:237], v[4:5], v[204:205] op_sel_hi:[0,1,1]
    v_pk_fma_f32 v[206:207], v[236:237], v[6:7], v[206:207] op_sel_hi:[0,1,1]
    s_nop 1
    ds_read_b32 v244, v243 offset:147
    s_mul_i32 s71, s70, 49152
    s_and_b32 s80, s70, 31
    s_mul_i32 s80, s80, 36864
    s_sub_u32 s71, s71, s80
    s_cbranch_vccnz L_th0_2
L_tb0_2:
    buffer_load_dwordx4 v[4:7], v1, s[28:31], s71 offen offset:0 nt
    s_waitcnt vmcnt(25)
    v_pk_fma_f32 v[208:209], v[236:237], v[8:9], v[208:209] op_sel_hi:[0,1,1]
    v_pk_fma_f32 v[210:211], v[236:237], v[10:11], v[210:211] op_sel_hi:[0,1,1]
    s_nop 1
    buffer_load_dwordx4 v[8:11], v1, s[28:31], s71 offen offset:256 nt
    s_waitcnt vmcnt(25)
    v_pk_fma_f32 v[212:213], v[236:237], v[12:13], v[212:213] op_sel_hi:[0,1,1]
    v_pk_fma_f32 v[214:215], v[236:237], v[14:15], v[214:215] op_sel_hi:[0,1,1]
    s_nop 1
    s_waitcnt lgkmcnt(0)
    v_cmp_lt_u32 vcc, v0, v244
    ds_add_u32 v224, v243 offset:3328
    buffer_load_dwordx4 v[12:15], v1, s[28:31], s71 offen offset:512 nt
    v_max_f32_dpp v234, v223, v223 row_ror:8 row_mask:0xf bank_mask:0xf
    v_mov_b32_dpp v236, v238 row_newbcast:9 row_mask:0xf bank_mask:0xf
    s_waitcnt vmcnt(25)
    v_pk_fma_f32 v[204:205], v[236:237], v[16:17], v[204:205] op_sel_hi:[0,1,1]
    v_pk_fma_f32 v[206:207], v[236:237], v[18:19], v[206:207] op_sel_hi:[0,1,1]
    s_nop 1
    s_add_u32 s71, s71, 3072
    s_cbranch_vccnz L_th3_2
L_tb3_2:
    buffer_load_dwordx4 v[16:19], v1, s[28:31], s71 offen offset:0 nt
    v_max_f32_dpp v234, v234, v234 row_ror:4 row_mask:0xf bank_mask:0xf
    s_waitcnt vmcnt(25)
    v_pk_fma_f32 v[208:209], v[236:237], v[20:21], v[208:209] op_sel_hi:[0,1,1]
    v_pk_fma_f32 v[210:211], v[236:237], v[22:23], v[210:211] op_sel_hi:[0,1,1]
    s_nop 1
    buffer_load_dwordx4 v[20:23], v1, s[28:31], s71 offen offset:256 nt
    v_max_f32_dpp v234, v234, v234 row_ror:2 row_mask:0xf bank_mask:0xf
    s_waitcnt vmcnt(25)
    v_pk_fma_f32 v[212:213], v[236:237], v[24:25], v[212:213] op_sel_hi:[0,1,1]
    v_pk_fma_f32 v[214:215], v[236:237], v[26:27], v[214:215] op_sel_hi:[0,1,1]
    s_nop 1
    ds_add_u32 v224, v243 offset:3328
    buffer_load_dwordx4 v[24:27], v1, s[28:31], s71 offen offset:512 nt
    v_max_f32_dpp v234, v234, v234 row_ror:1 row_mask:0xf bank_mask:0xf
    v_mov_b32_dpp v236, v238 row_newbcast:5 row_mask:0xf bank_mask:0xf
    s_waitcnt vmcnt(25)
    v_pk_fma_f32 v[204:205], v[236:237], v[28:29], v[204:205] op_sel_hi:[0,1,1]
    v_pk_fma_f32 v[206:207], v[236:237], v[30:31], v[206:207] op_sel_hi:[0,1,1]
    s_nop 1
    s_add_u32 s71, s71, 3072
    s_cbranch_vccnz L_th6_2
L_tb6_2:
    buffer_load_dwordx4 v[28:31], v1, s[28:31], s71 offen offset:0 nt
    s_lshr_b64 s[4:5], s[4:5], 1
    s_bitcmp1_b32 s4, 0
    s_cselect_b32 s6, s7, 0x7f7fffff
    v_min_f32 v228, s6, v216
    s_waitcnt vmcnt(25)
    v_pk_fma_f32 v[208:209], v[236:237], v[32:33], v[208:209] op_sel_hi:[0,1,1]
    v_pk_fma_f32 v[210:211], v[236:237], v[34:35], v[210:211] op_sel_hi:[0,1,1]
    s_nop 1
    buffer_load_dwordx4 v[32:35], v1, s[28:31], s71 offen offset:256 nt
    v_max3_f32 v234, v234, v228, s77
    s_waitcnt vmcnt(25)
    v_pk_fma_f32 v[212:213], v[236:237], v[36:37], v[212:213] op_sel_hi:[0,1,1]
    v_pk_fma_f32 v[214:215], v[236:237], v[38:39], v[214:215] op_sel_hi:[0,1,1]
    s_nop 1
    ds_add_u32 v224, v243 offset:3328
    buffer_load_dwordx4 v[36:39], v1, s[28:31], s71 offen offset:512 nt
    v_sub_f32 v235, v228, v234
    v_sub_f32 v229, v223, v234
    v_mov_b32_dpp v236, v238 row_newbcast:13 row_mask:0xf bank_mask:0xf
    s_waitcnt vmcnt(25)
    v_pk_fma_f32 v[204:205], v[236:237], v[40:41], v[204:205] op_sel_hi:[0,1,1]
    v_pk_fma_f32 v[206:207], v[236:237], v[42:43], v[206:207] op_sel_hi:[0,1,1]
    s_nop 1
    s_add_u32 s71, s71, 3072
    s_cbranch_vccnz L_th9_2
L_tb9_2:
    buffer_load_dwordx4 v[40:43], v1, s[28:31], s71 offen offset:0 nt
    v_exp_f32 v235, v235
    s_waitcnt vmcnt(25)
    v_pk_fma_f32 v[208:209], v[236:237], v[44:45], v[208:209] op_sel_hi:[0,1,1]
    v_pk_fma_f32 v[210:211], v[236:237], v[46:47], v[210:211] op_sel_hi:[0,1,1]
    s_nop 1
    buffer_load_dwordx4 v[44:47], v1, s[28:31], s71 offen offset:256 nt
    v_exp_f32 v229, v229
    s_waitcnt vmcnt(25)
    v_pk_fma_f32 v[212:213], v[236:237], v[48:49], v[212:213] op_sel_hi:[0,1,1]
    v_pk_fma_f32 v[214:215], v[236:237], v[50:51], v[214:215] op_sel_hi:[0,1,1]
    s_nop 1
    ds_add_u32 v224, v243 offset:3328
    buffer_load_dwordx4 v[48:51], v1, s[28:31], s71 offen offset:512 nt
    v_mov_b32_dpp v236, v238 row_newbcast:3 row_mask:0xf bank_mask:0xf
    s_waitcnt vmcnt(23)
    v_pk_fma_f32 v[204:205], v[236:237], v[52:53], v[204:205] op_sel_hi:[0,1,1]
    v_pk_fma_f32 v[206:207], v[236:237], v[54:55], v[206:207] op_sel_hi:[0,1,1]
    s_nop 1
    ds_read_b32 v244, v243 offset:147
    s_add_u32 s71, s71, 384000
    s_cbranch_vccnz L_th12_2
L_tb12_2:
    buffer_load_dwordx4 v[52:55], v1, s[28:31], s71 offen offset:0 nt
    v_lshlrev_b32 v220, 16, v220
    s_waitcnt vmcnt(23)
    v_pk_fma_f32 v[208:209], v[236:237], v[56:57], v[208:209] op_sel_hi:[0,1,1]
    v_pk_fma_f32 v[210:211], v[236:237], v[58:59], v[210:211] op_sel_hi:[0,1,1]
    s_nop 1
    buffer_load_dwordx4 v[56:59], v1, s[28:31], s71 offen offset:256 nt
    v_lshlrev_b32 v221, 16, v221
    s_waitcnt vmcnt(23)
    v_pk_fma_f32 v[212:213], v[236:237], v[60:61], v[212:213] op_sel_hi:[0,1,1]
    v_pk_fma_f32 v[214:215], v[236:237], v[62:63], v[214:215] op_sel_hi:[0,1,1]
    s_nop 1
    s_waitcnt lgkmcnt(0)
    v_cmp_lt_u32 vcc, v0, v244
    ds_add_u32 v224, v243 offset:3328
    buffer_load_dwordx4 v[60:63], v1, s[28:31], s71 offen offset:512 nt
    v_mov_b32_dpp v236, v238 row_newbcast:11 row_mask:0xf bank_mask:0xf
    s_waitcnt vmcnt(23)
    v_pk_fma_f32 v[204:205], v[236:237], v[64:65], v[204:205] op_sel_hi:[0,1,1]
    v_pk_fma_f32 v[206:207], v[236:237], v[66:67], v[206:207] op_sel_hi:[0,1,1]
    s_nop 1
    s_add_u32 s71, s71, 3072
    s_cbranch_vccnz L_th15_2
L_tb15_2:
    buffer_load_dwordx4 v[64:67], v1, s[28:31], s71 offen offset:0 nt
    v_mul_f32 v222, v229, v220
    s_waitcnt vmcnt(23)
    v_pk_fma_f32 v[208:209], v[236:237], v[68:69], v[208:209] op_sel_hi:[0,1,1]
    v_pk_fma_f32 v[210:211], v[236:237], v[70:71], v[210:211] op_sel_hi:[0,1,1]
    s_nop 1
    buffer_load_dwordx4 v[68:71], v1, s[28:31], s71 offen offset:256 nt
    v_mul_f32 v230, v222, v221
    s_waitcnt vmcnt(23)
    v_pk_fma_f32 v[212:213], v[236:237], v[72:73], v[212:213] op_sel_hi:[0,1,1]
    v_pk_fma_f32 v[214:215], v[236:237], v[74:75], v[214:215] op_sel_hi:[0,1,1]
    s_nop 1
    ds_add_u32 v224, v243 offset:3328
    buffer_load_dwordx4 v[72:75], v1, s[28:31], s71 offen offset:512 nt
    v_mov_b32_dpp v236, v238 row_newbcast:7 row_mask:0xf bank_mask:0xf
    s_waitcnt vmcnt(23)
    v_pk_fma_f32 v[204:205], v[236:237], v[76:77], v[204:205] op_sel_hi:[0,1,1]
    v_pk_fma_f32 v[206:207], v[236:237], v[78:79], v[206:207] op_sel_hi:[0,1,1]
    s_nop 1
    s_add_u32 s71, s71, 3072
    s_cbranch_vccnz L_th18_2
L_tb18_2:
    buffer_load_dwordx4 v[76:79], v1, s[28:31], s71 offen offset:0 nt
    s_waitcnt vmcnt(23)
    v_pk_fma_f32 v[208:209], v[236:237], v[80:81], v[208:209] op_sel_hi:[0,1,1]
    v_pk_fma_f32 v[210:211], v[236:237], v[82:83], v[210:211] op_sel_hi:[0,1,1]
    s_nop 1
    buffer_load_dwordx4 v[80:83], v1, s[28:31], s71 offen offset:256 nt
    s_waitcnt vmcnt(23)
    v_pk_fma_f32 v[212:213], v[236:237], v[84:85], v[212:213] op_sel_hi:[0,1,1]
    v_pk_fma_f32 v[214:215], v[236:237], v[86:87], v[214:215] op_sel_hi:[0,1,1]
    s_nop 1
    ds_add_u32 v224, v243 offset:3328
    buffer_load_dwordx4 v[84:87], v1, s[28:31], s71 offen offset:512 nt
    v_mov_b32_dpp v236, v238 row_newbcast:15 row_mask:0xf bank_mask:0xf
    s_waitcnt vmcnt(23)
    v_pk_fma_f32 v[204:205], v[236:237], v[88:89], v[204:205] op_sel_hi:[0,1,1]
    v_pk_fma_f32 v[206:207], v[236:237], v[90:91], v[206:207] op_sel_hi:[0,1,1]
    s_nop 1
    s_add_u32 s71, s71, 3072
    s_cbranch_vccnz L_th21_2
L_tb21_2:
    buffer_load_dwordx4 v[88:91], v1, s[28:31], s71 offen offset:0 nt
    ds_write_b128 v241, v[204:207] offset:20480
    v_mul_f32 v238, 0x71800000, v222
    s_waitcnt vmcnt(23)
    v_pk_fma_f32 v[208:209], v[236:237], v[92:93], v[208:209] op_sel_hi:[0,1,1]
    v_pk_fma_f32 v[210:211], v[236:237], v[94:95], v[210:211] op_sel_hi:[0,1,1]
    s_nop 1
    buffer_load_dwordx4 v[92:95], v1, s[28:31], s71 offen offset:256 nt
    ds_write_b128 v241, v[208:211] offset:21504
    v_pk_mul_f32 v[204:205], v[204:205], v[234:235] op_sel:[0,1] op_sel_hi:[1,1]
    v_pk_mul_f32 v[206:207], v[206:207], v[234:235] op_sel:[0,1] op_sel_hi:[1,1]
    s_waitcnt vmcnt(23)
    v_pk_fma_f32 v[212:213], v[236:237], v[96:97], v[212:213] op_sel_hi:[0,1,1]
    v_pk_fma_f32 v[214:215], v[236:237], v[98:99], v[214:215] op_sel_hi:[0,1,1]
    s_nop 1
    ds_add_u32 v224, v243 offset:3328
    buffer_load_dwordx4 v[96:99], v1, s[28:31], s71 offen offset:512 nt
    ds_write_b128 v241, v[212:215] offset:22528
    v_pk_mul_f32 v[208:209], v[208:209], v[234:235] op_sel:[0,1] op_sel_hi:[1,1]
    v_pk_mul_f32 v[210:211], v[210:211], v[234:235] op_sel:[0,1] op_sel_hi:[1,1]
    s_sub_u32 s76, s76, 1
    s_cmp_lg_u32 s76, 0
    s_cbranch_scc1 L_loop1
    v_mov_b32_dpp v236, v238 row_newbcast:0 row_mask:0xf bank_mask:0xf
    s_waitcnt vmcnt(23)
    v_pk_fma_f32 v[204:205], v[236:237], v[4:5], v[204:205] op_sel_hi:[0,1,1]
    v_pk_fma_f32 v[206:207], v[236:237], v[6:7], v[206:207] op_sel_hi:[0,1,1]
    s_nop 1
    ds_read_b32 v244, v243 offset:147
    s_add_u32 s71, s71, 384000
    s_cbranch_vccnz L_th24_3
L_tb24_3:
    buffer_load_dwordx4 v[4:7], v1, s[28:31], s71 offen offset:0 nt
    s_bitcmp0_b32 s4, 0
    s_cbranch_scc1 L_nofl3
    s_mov_b64 exec, 1
    ds_add_u32 v242, v243
    s_mov_b64 exec, -1
    v_add_u32 v241, 4096, v241
    v_add_u32 v242, 4, v242
L_nofl3:
    s_waitcnt vmcnt(23)
    v_pk_fma_f32 v[208:209], v[236:237], v[8:9], v[208:209] op_sel_hi:[0,1,1]
    v_pk_fma_f32 v[210:211], v[236:237], v[10:11], v[210:211] op_sel_hi:[0,1,1]
    s_nop 1
    buffer_load_dwordx4 v[8:11], v1, s[28:31], s71 offen offset:256 nt
    v_pk_mul_f32 v[212:213], v[212:213], v[234:235] op_sel:[0,1] op_sel_hi:[1,1]
    v_pk_mul_f32 v[214:215], v[214:215], v[234:235] op_sel:[0,1] op_sel_hi:[1,1]
    v_mov_b32 v216, v234
    s_waitcnt vmcnt(23)
    v_pk_fma_f32 v[212:213], v[236:237], v[12:13], v[212:213] op_sel_hi:[0,1,1]
    v_pk_fma_f32 v[214:215], v[236:237], v[14:15], v[214:215] op_sel_hi:[0,1,1]
    s_nop 1
    s_waitcnt lgkmcnt(0)
    v_cmp_lt_u32 vcc, v0, v244
    ds_add_u32 v224, v243 offset:3328
    buffer_load_dwordx4 v[12:15], v1, s[28:31], s71 offen offset:512 nt
    v_fma_f32 v217, v217, v235, v229
    v_mov_b32_dpp v236, v238 row_newbcast:8 row_mask:0xf bank_mask:0xf
    s_waitcnt vmcnt(23)
    v_pk_fma_f32 v[204:205], v[236:237], v[16:17], v[204:205] op_sel_hi:[0,1,1]
    v_pk_fma_f32 v[206:207], v[236:237], v[18:19], v[206:207] op_sel_hi:[0,1,1]
    s_nop 1
    s_add_u32 s71, s71, 3072
    s_cbranch_vccnz L_th27_3
L_tb27_3:
    buffer_load_dwordx4 v[16:19], v1, s[28:31], s71 offen offset:0 nt
    v_fma_f32 v218, v218, v235, v230
    s_waitcnt vmcnt(23)
    v_pk_fma_f32 v[208:209], v[236:237], v[20:21], v[208:209] op_sel_hi:[0,1,1]
    v_pk_fma_f32 v[210:211], v[236:237], v[22:23], v[210:211] op_sel_hi:[0,1,1]
    s_nop 1
    buffer_load_dwordx4 v[20:23], v1, s[28:31], s71 offen offset:256 nt
    s_mov_b64 exec, s[88:89]
    buffer_store_dwordx4 v[100:103], v225, s[52:55], s78 offen offset:0
    s_mov_b64 exec, -1
    s_waitcnt vmcnt(23)
    v_pk_fma_f32 v[212:213], v[236:237], v[24:25], v[212:213] op_sel_hi:[0,1,1]
    v_pk_fma_f32 v[214:215], v[236:237], v[26:27], v[214:215] op_sel_hi:[0,1,1]
    s_nop 1
    ds_add_u32 v224, v243 offset:3328
    buffer_load_dwordx4 v[24:27], v1, s[28:31], s71 offen offset:512 nt
    v_add_f32_dpp v218, v218, v218 row_ror:8 row_mask:0xf bank_mask:0xf
    v_mov_b32_dpp v236, v238 row_newbcast:4 row_mask:0xf bank_mask:0xf
    s_waitcnt vmcnt(23)
    v_pk_fma_f32 v[204:205], v[236:237], v[28:29], v[204:205] op_sel_hi:[0,1,1]
    v_pk_fma_f32 v[206:207], v[236:237], v[30:31], v[206:207] op_sel_hi:[0,1,1]
    s_nop 1
    s_add_u32 s71, s71, 3072
    s_cbranch_vccnz L_th30_3
L_tb30_3:
    buffer_load_dwordx4 v[28:31], v1, s[28:31], s71 offen offset:0 nt
    v_add_f32_dpp v218, v218, v218 row_ror:4 row_mask:0xf bank_mask:0xf
    s_waitcnt vmcnt(23)
    v_pk_fma_f32 v[208:209], v[236:237], v[32:33], v[208:209] op_sel_hi:[0,1,1]
    v_pk_fma_f32 v[210:211], v[236:237], v[34:35], v[210:211] op_sel_hi:[0,1,1]
    s_nop 1
    buffer_load_dwordx4 v[32:35], v1, s[28:31], s71 offen offset:256 nt
    v_add_f32_dpp v218, v218, v218 row_ror:2 row_mask:0xf bank_mask:0xf
    s_waitcnt vmcnt(23)
    v_pk_fma_f32 v[212:213], v[236:237], v[36:37], v[212:213] op_sel_hi:[0,1,1]
    v_pk_fma_f32 v[214:215], v[236:237], v[38:39], v[214:215] op_sel_hi:[0,1,1]
    s_nop 1
    ds_add_u32 v224, v243 offset:3328
    buffer_load_dwordx4 v[36:39], v1, s[28:31], s71 offen offset:512 nt
    v_add_f32_dpp v218, v218, v218 row_ror:1 row_mask:0xf bank_mask:0xf
    v_mov_b32_dpp v236, v238 row_newbcast:12 row_mask:0xf bank_mask:0xf
    s_waitcnt vmcnt(23)
    v_pk_fma_f32 v[204:205], v[236:237], v[40:41], v[204:205] op_sel_hi:[0,1,1]
    v_pk_fma_f32 v[206:207], v[236:237], v[42:43], v[206:207] op_sel_hi:[0,1,1]
    s_nop 1
    s_add_u32 s71, s71, 3072
    s_cbranch_vccnz L_th33_3
L_tb33_3:
    buffer_load_dwordx4 v[40:43], v1, s[28:31], s71 offen offset:0 nt
    v_mov_b32 v234, v218
    s_waitcnt vmcnt(23)
    v_pk_fma_f32 v[208:209], v[236:237], v[44:45], v[208:209] op_sel_hi:[0,1,1]
    v_pk_fma_f32 v[210:211], v[236:237], v[46:47], v[210:211] op_sel_hi:[0,1,1]
    s_nop 1
    buffer_load_dwordx4 v[44:47], v1, s[28:31], s71 offen offset:256 nt
    v_permlane32_swap_b32 v218, v234
    s_waitcnt vmcnt(23)
    v_pk_fma_f32 v[212:213], v[236:237], v[48:49], v[212:213] op_sel_hi:[0,1,1]
    v_pk_fma_f32 v[214:215], v[236:237], v[50:51], v[214:215] op_sel_hi:[0,1,1]
    s_nop 1
    ds_add_u32 v224, v243 offset:3328
    buffer_load_dwordx4 v[48:51], v1, s[28:31], s71 offen offset:512 nt
    v_add_f32 v218, v218, v234
    v_mov_b32_dpp v236, v238 row_newbcast:2 row_mask:0xf bank_mask:0xf
    s_waitcnt vmcnt(23)
    v_pk_fma_f32 v[204:205], v[236:237], v[52:53], v[204:205] op_sel_hi:[0,1,1]
    v_pk_fma_f32 v[206:207], v[236:237], v[54:55], v[206:207] op_sel_hi:[0,1,1]
    s_nop 1
    ds_read_b32 v244, v243 offset:147
    s_add_u32 s71, s71, 384000
    s_cbranch_vccnz L_th36_3
L_tb36_3:
    buffer_load_dwordx4 v[52:55], v1, s[28:31], s71 offen offset:0 nt
    v_mov_b32 v234, v218
    s_waitcnt vmcnt(23)
    v_pk_fma_f32 v[208:209], v[236:237], v[56:57], v[208:209] op_sel_hi:[0,1,1]
    v_pk_fma_f32 v[210:211], v[236:237], v[58:59], v[210:211] op_sel_hi:[0,1,1]
    s_nop 1
    buffer_load_dwordx4 v[56:59], v1, s[28:31], s71 offen offset:256 nt
    v_permlane16_swap_b32 v218, v234
    s_waitcnt vmcnt(23)
    v_pk_fma_f32 v[212:213], v[236:237], v[60:61], v[212:213] op_sel_hi:[0,1,1]
    v_pk_fma_f32 v[214:215], v[236:237], v[62:63], v[214:215] op_sel_hi:[0,1,1]
    s_nop 1
    s_waitcnt lgkmcnt(0)
    v_cmp_lt_u32 vcc, v0, v244
    ds_add_u32 v224, v243 offset:3328
    buffer_load_dwordx4 v[60:63], v1, s[28:31], s71 offen offset:512 nt
    v_add_f32 v218, v218, v234
    v_mov_b32_dpp v236, v238 row_newbcast:10 row_mask:0xf bank_mask:0xf
    s_waitcnt vmcnt(23)
    v_pk_fma_f32 v[204:205], v[236:237], v[64:65], v[204:205] op_sel_hi:[0,1,1]
    v_pk_fma_f32 v[206:207], v[236:237], v[66:67], v[206:207] op_sel_hi:[0,1,1]
    s_nop 1
    s_add_u32 s71, s71, 3072
    s_cbranch_vccnz L_th39_3
L_tb39_3:
    buffer_load_dwordx4 v[64:67], v1, s[28:31], s71 offen offset:0 nt
    v_mov_b32 v103, s93
    v_lshlrev_b32 v235, 4, v0
    s_lshl_b32 s78, s3, 11
    s_mov_b32 s6, 0x58000000
    s_waitcnt vmcnt(23)
    v_pk_fma_f32 v[208:209], v[236:237], v[68:69], v[208:209] op_sel_hi:[0,1,1]
    v_pk_fma_f32 v[210:211], v[236:237], v[70:71], v[210:211] op_sel_hi:[0,1,1]
    s_nop 1
    buffer_load_dwordx4 v[68:71], v1, s[28:31], s71 offen offset:256 nt
    s_waitcnt vmcnt(23)
    v_pk_fma_f32 v[212:213], v[236:237], v[72:73], v[212:213] op_sel_hi:[0,1,1]
    v_pk_fma_f32 v[214:215], v[236:237], v[74:75], v[214:215] op_sel_hi:[0,1,1]
    s_nop 1
    ds_add_u32 v224, v243 offset:3328
    buffer_load_dwordx4 v[72:75], v1, s[28:31], s71 offen offset:512 nt
    v_mov_b32_dpp v236, v238 row_newbcast:6 row_mask:0xf bank_mask:0xf
    s_waitcnt vmcnt(23)
    v_pk_fma_f32 v[204:205], v[236:237], v[76:77], v[204:205] op_sel_hi:[0,1,1]
    v_pk_fma_f32 v[206:207], v[236:237], v[78:79], v[206:207] op_sel_hi:[0,1,1]
    s_nop 1
    s_add_u32 s71, s71, 3072
    s_cbranch_vccnz L_th42_3
L_tb42_3:
    buffer_load_dwordx4 v[76:79], v1, s[28:31], s71 offen offset:0 nt
    s_waitcnt vmcnt(23)
    v_pk_fma_f32 v[208:209], v[236:237], v[80:81], v[208:209] op_sel_hi:[0,1,1]
    v_pk_fma_f32 v[210:211], v[236:237], v[82:83], v[210:211] op_sel_hi:[0,1,1]
    s_nop 1
    buffer_load_dwordx4 v[80:83], v1, s[28:31], s71 offen offset:256 nt
    s_waitcnt vmcnt(23)
    v_pk_fma_f32 v[212:213], v[236:237], v[84:85], v[212:213] op_sel_hi:[0,1,1]
    v_pk_fma_f32 v[214:215], v[236:237], v[86:87], v[214:215] op_sel_hi:[0,1,1]
    s_nop 1
    ds_add_u32 v224, v243 offset:3328
    buffer_load_dwordx4 v[84:87], v1, s[28:31], s71 offen offset:512 nt
    v_mov_b32_dpp v236, v238 row_newbcast:14 row_mask:0xf bank_mask:0xf
    s_waitcnt vmcnt(23)
    v_pk_fma_f32 v[204:205], v[236:237], v[88:89], v[204:205] op_sel_hi:[0,1,1]
    v_pk_fma_f32 v[206:207], v[236:237], v[90:91], v[206:207] op_sel_hi:[0,1,1]
    s_nop 1
    s_add_u32 s71, s71, 3072
    s_cbranch_vccnz L_th45_3
L_tb45_3:
    buffer_load_dwordx4 v[88:91], v1, s[28:31], s71 offen offset:0 nt
    s_waitcnt vmcnt(23)
    v_pk_fma_f32 v[208:209], v[236:237], v[92:93], v[208:209] op_sel_hi:[0,1,1]
    v_pk_fma_f32 v[210:211], v[236:237], v[94:95], v[210:211] op_sel_hi:[0,1,1]
    s_nop 1
    buffer_load_dwordx4 v[92:95], v1, s[28:31], s71 offen offset:256 nt
    s_waitcnt vmcnt(23)
    v_pk_fma_f32 v[212:213], v[236:237], v[96:97], v[212:213] op_sel_hi:[0,1,1]
    v_pk_fma_f32 v[214:215], v[236:237], v[98:99], v[214:215] op_sel_hi:[0,1,1]
    s_nop 1
    ds_add_u32 v224, v243 offset:3328
    buffer_load_dwordx4 v[96:99], v1, s[28:31], s71 offen offset:512 nt
    ds_write_b32 v243, v243 offset:143
    v_mov_b32_dpp v236, v238 row_newbcast:1 row_mask:0xf bank_mask:0xf
    s_waitcnt vmcnt(23)
    v_pk_fma_f32 v[204:205], v[236:237], v[4:5], v[204:205] op_sel_hi:[0,1,1]
    v_pk_fma_f32 v[206:207], v[236:237], v[6:7], v[206:207] op_sel_hi:[0,1,1]
    s_waitcnt vmcnt(22)
    v_pk_fma_f32 v[208:209], v[236:237], v[8:9], v[208:209] op_sel_hi:[0,1,1]
    v_pk_fma_f32 v[210:211], v[236:237], v[10:11], v[210:211] op_sel_hi:[0,1,1]
    s_waitcnt vmcnt(21)
    v_pk_fma_f32 v[212:213], v[236:237], v[12:13], v[212:213] op_sel_hi:[0,1,1]
    v_pk_fma_f32 v[214:215], v[236:237], v[14:15], v[214:215] op_sel_hi:[0,1,1]
    v_mov_b32_dpp v236, v238 row_newbcast:9 row_mask:0xf bank_mask:0xf
    s_waitcnt vmcnt(20)
    v_pk_fma_f32 v[204:205], v[236:237], v[16:17], v[204:205] op_sel_hi:[0,1,1]
    v_pk_fma_f32 v[206:207], v[236:237], v[18:19], v[206:207] op_sel_hi:[0,1,1]
    s_waitcnt vmcnt(19)
    v_pk_fma_f32 v[208:209], v[236:237], v[20:21], v[208:209] op_sel_hi:[0,1,1]
    v_pk_fma_f32 v[210:211], v[236:237], v[22:23], v[210:211] op_sel_hi:[0,1,1]
    s_waitcnt vmcnt(18)
    s_branch L_x2
L_w2:
    s_branch L_w3
L_x2:
    v_pk_fma_f32 v[212:213], v[236:237], v[24:25], v[212:213] op_sel_hi:[0,1,1]
    v_pk_fma_f32 v[214:215], v[236:237], v[26:27], v[214:215] op_sel_hi:[0,1,1]
    v_mov_b32_dpp v236, v238 row_newbcast:5 row_mask:0xf bank_mask:0xf
    s_waitcnt vmcnt(17)
    v_pk_fma_f32 v[204:205], v[236:237], v[28:29], v[204:205] op_sel_hi:[0,1,1]
    v_pk_fma_f32 v[206:207], v[236:237], v[30:31], v[206:207] op_sel_hi:[0,1,1]
    s_waitcnt vmcnt(16)
    v_pk_fma_f32 v[208:209], v[236:237], v[32:33], v[208:209] op_sel_hi:[0,1,1]
    v_pk_fma_f32 v[210:211], v[236:237], v[34:35], v[210:211] op_sel_hi:[0,1,1]
    s_waitcnt vmcnt(15)
    v_pk_fma_f32 v[212:213], v[236:237], v[36:37], v[212:213] op_sel_hi:[0,1,1]
    v_pk_fma_f32 v[214:215], v[236:237], v[38:39], v[214:215] op_sel_hi:[0,1,1]
    v_mov_b32_dpp v236, v238 row_newbcast:13 row_mask:0xf bank_mask:0xf
    s_waitcnt vmcnt(14)
    v_pk_fma_f32 v[204:205], v[236:237], v[40:41], v[204:205] op_sel_hi:[0,1,1]
    v_pk_fma_f32 v[206:207], v[236:237], v[42:43], v[206:207] op_sel_hi:[0,1,1]
    s_waitcnt vmcnt(13)
    v_pk_fma_f32 v[208:209], v[236:237], v[44:45], v[208:209] op_sel_hi:[0,1,1]
    v_pk_fma_f32 v[210:211], v[236:237], v[46:47], v[210:211] op_sel_hi:[0,1,1]
    s_waitcnt vmcnt(12)
    v_pk_fma_f32 v[212:213], v[236:237], v[48:49], v[212:213] op_sel_hi:[0,1,1]
    v_pk_fma_f32 v[214:215], v[236:237], v[50:51], v[214:215] op_sel_hi:[0,1,1]
    v_mov_b32_dpp v236, v238 row_newbcast:3 row_mask:0xf bank_mask:0xf
    s_waitcnt vmcnt(11)
    v_pk_fma_f32 v[204:205], v[236:237], v[52:53], v[204:205] op_sel_hi:[0,1,1]
    v_pk_fma_f32 v[206:207], v[236:237], v[54:55], v[206:207] op_sel_hi:[0,1,1]
    s_waitcnt vmcnt(10)
    v_pk_fma_f32 v[208:209], v[236:237], v[56:57], v[208:209] op_sel_hi:[0,1,1]
    v_pk_fma_f32 v[210:211], v[236:237], v[58:59], v[210:211] op_sel_hi:[0,1,1]
    s_waitcnt vmcnt(9)
    v_pk_fma_f32 v[212:213], v[236:237], v[60:61], v[212:213] op_sel_hi:[0,1,1]
    v_pk_fma_f32 v[214:215], v[236:237], v[62:63], v[214:215] op_sel_hi:[0,1,1]
    v_mov_b32_dpp v236, v238 row_newbcast:11 row_mask:0xf bank_mask:0xf
    s_waitcnt vmcnt(8)
    v_pk_fma_f32 v[204:205], v[236:237], v[64:65], v[204:205] op_sel_hi:[0,1,1]
    v_pk_fma_f32 v[206:207], v[236:237], v[66:67], v[206:207] op_sel_hi:[0,1,1]
    s_waitcnt vmcnt(7)
    v_pk_fma_f32 v[208:209], v[236:237], v[68:69], v[208:209] op_sel_hi:[0,1,1]
    v_pk_fma_f32 v[210:211], v[236:237], v[70:71], v[210:211] op_sel_hi:[0,1,1]
    s_waitcnt vmcnt(6)
    v_pk_fma_f32 v[212:213], v[236:237], v[72:73], v[212:213] op_sel_hi:[0,1,1]
    v_pk_fma_f32 v[214:215], v[236:237], v[74:75], v[214:215] op_sel_hi:[0,1,1]
    v_mov_b32_dpp v236, v238 row_newbcast:7 row_mask:0xf bank_mask:0xf
    s_waitcnt vmcnt(5)
    v_pk_fma_f32 v[204:205], v[236:237], v[76:77], v[204:205] op_sel_hi:[0,1,1]
    v_pk_fma_f32 v[206:207], v[236:237], v[78:79], v[206:207] op_sel_hi:[0,1,1]
    s_waitcnt vmcnt(4)
    v_pk_fma_f32 v[208:209], v[236:237], v[80:81], v[208:209] op_sel_hi:[0,1,1]
    v_pk_fma_f32 v[210:211], v[236:237], v[82:83], v[210:211] op_sel_hi:[0,1,1]
    s_waitcnt vmcnt(3)
    v_pk_fma_f32 v[212:213], v[236:237], v[84:85], v[212:213] op_sel_hi:[0,1,1]
    v_pk_fma_f32 v[214:215], v[236:237], v[86:87], v[214:215] op_sel_hi:[0,1,1]
    v_mov_b32_dpp v236, v238 row_newbcast:15 row_mask:0xf bank_mask:0xf
    s_waitcnt vmcnt(2)
    v_pk_fma_f32 v[204:205], v[236:237], v[88:89], v[204:205] op_sel_hi:[0,1,1]
    v_pk_fma_f32 v[206:207], v[236:237], v[90:91], v[206:207] op_sel_hi:[0,1,1]
    s_waitcnt vmcnt(1)
    v_pk_fma_f32 v[208:209], v[236:237], v[92:93], v[208:209] op_sel_hi:[0,1,1]
    v_pk_fma_f32 v[210:211], v[236:237], v[94:95], v[210:211] op_sel_hi:[0,1,1]
    v_permlane32_swap_b32 v204, v206
    v_permlane32_swap_b32 v205, v207
    v_add_f32 v204, v204, v206
    v_add_f32 v205, v205, v207
    v_permlane32_swap_b32 v208, v210
    v_permlane32_swap_b32 v209, v211
    v_add_f32 v208, v208, v210
    v_add_f32 v209, v209, v211
    v_permlane16_swap_b32 v204, v205
    v_add_f32 v204, v204, v205
    v_fma_f32 v100, v204, s6, -v218
    v_permlane16_swap_b32 v208, v209
    v_add_f32 v208, v208, v209
    v_fma_f32 v101, v208, s6, -v218
    s_waitcnt vmcnt(0)
    v_pk_fma_f32 v[212:213], v[236:237], v[96:97], v[212:213] op_sel_hi:[0,1,1]
    v_pk_fma_f32 v[214:215], v[236:237], v[98:99], v[214:215] op_sel_hi:[0,1,1]
    s_nop 1
    v_permlane32_swap_b32 v212, v214
    v_permlane32_swap_b32 v213, v215
    v_add_f32 v212, v212, v214
    v_add_f32 v213, v213, v215
    s_nop 1
    v_permlane16_swap_b32 v212, v213
    v_add_f32 v212, v212, v213
    v_fma_f32 v102, v212, s6, -v218
    s_mov_b64 exec, s[88:89]
    buffer_store_dwordx4 v[100:103], v225, s[52:55], s78 offen offset:0
    s_not_b64 exec, exec
    buffer_store_dwordx4 v[100:103], v225, s[52:55], s78 offen offset:0 sc0 sc1
    s_mov_b64 exec, -1
L_final:
    s_endpgm
L_th24_0:
    s_waitcnt vmcnt(32)
    s_cmp_eq_u32 vcc_lo, 1
    s_cbranch_scc1 L_tb24_0
    s_waitcnt vmcnt(23)
    s_branch L_tb24_0
L_th27_0:
    s_waitcnt vmcnt(26)
    s_cmp_eq_u32 vcc_lo, 1
    s_cbranch_scc1 L_tb27_0
    s_waitcnt vmcnt(23)
    s_branch L_tb27_0
L_th30_0:
    s_waitcnt vmcnt(32)
    s_cmp_eq_u32 vcc_lo, 1
    s_cbranch_scc1 L_tb30_0
    s_waitcnt vmcnt(29)
    s_branch L_tb30_0
L_th33_0:
    s_waitcnt vmcnt(32)
    s_cmp_eq_u32 vcc_lo, 1
    s_cbranch_scc1 L_tb33_0
    s_waitcnt vmcnt(29)
    s_branch L_tb33_0
L_th36_0:
    s_waitcnt vmcnt(35)
    s_cmp_eq_u32 vcc_lo, 1
    s_cbranch_scc1 L_tb36_0
    s_waitcnt vmcnt(26)
    s_branch L_tb36_0
L_th39_0:
    s_waitcnt vmcnt(29)
    s_cmp_eq_u32 vcc_lo, 1
    s_cbranch_scc1 L_tb39_0
    s_waitcnt vmcnt(26)
    s_branch L_tb39_0
L_th42_0:
    s_waitcnt vmcnt(35)
    s_cmp_eq_u32 vcc_lo, 1
    s_cbranch_scc1 L_tb42_0
    s_waitcnt vmcnt(32)
    s_branch L_tb42_0
L_th45_0:
    s_waitcnt vmcnt(35)
    s_cmp_eq_u32 vcc_lo, 1
    s_cbranch_scc1 L_tb45_0
    s_waitcnt vmcnt(32)
    s_branch L_tb45_0
L_th0_0:
    s_waitcnt vmcnt(35)
    s_cmp_eq_u32 vcc_lo, 1
    s_cbranch_scc1 L_tb0_0
    s_waitcnt vmcnt(26)
    s_branch L_tb0_0
L_th3_0:
    s_waitcnt vmcnt(29)
    s_cmp_eq_u32 vcc_lo, 1
    s_cbranch_scc1 L_tb3_0
    s_waitcnt vmcnt(26)
    s_branch L_tb3_0
L_th6_0:
    s_waitcnt vmcnt(35)
    s_cmp_eq_u32 vcc_lo, 1
    s_cbranch_scc1 L_tb6_0
    s_waitcnt vmcnt(29)
    s_branch L_tb6_0
L_th9_0:
    s_waitcnt vmcnt(32)
    s_cmp_eq_u32 vcc_lo, 1
    s_cbranch_scc1 L_tb9_0
    s_waitcnt vmcnt(29)
    s_branch L_tb9_0
L_th12_0:
    s_waitcnt vmcnt(32)
    s_cmp_eq_u32 vcc_lo, 1
    s_cbranch_scc1 L_tb12_0
    s_waitcnt vmcnt(23)
    s_branch L_tb12_0
L_th15_0:
    s_waitcnt vmcnt(26)
    s_cmp_eq_u32 vcc_lo, 1
    s_cbranch_scc1 L_tb15_0
    s_waitcnt vmcnt(23)
    s_branch L_tb15_0
L_th18_0:
    s_waitcnt vmcnt(32)
    s_cmp_eq_u32 vcc_lo, 1
    s_cbranch_scc1 L_tb18_0
    s_waitcnt vmcnt(29)
    s_branch L_tb18_0
L_th21_0:
    s_waitcnt vmcnt(32)
    s_cmp_eq_u32 vcc_lo, 1
    s_cbranch_scc1 L_tb21_0
    s_waitcnt vmcnt(29)
    s_branch L_tb21_0
L_th24_1:
    s_waitcnt vmcnt(32)
    s_cmp_eq_u32 vcc_lo, 1
    s_cbranch_scc1 L_tb24_1
    s_waitcnt vmcnt(23)
    s_branch L_tb24_1
L_th27_1:
    s_waitcnt vmcnt(26)
    s_cmp_eq_u32 vcc_lo, 1
    s_cbranch_scc1 L_tb27_1
    s_waitcnt vmcnt(23)
    s_branch L_tb27_1
L_th30_1:
    s_waitcnt vmcnt(32)
    s_cmp_eq_u32 vcc_lo, 1
    s_cbranch_scc1 L_tb30_1
    s_waitcnt vmcnt(29)
    s_branch L_tb30_1
L_th33_1:
    s_waitcnt vmcnt(32)
    s_cmp_eq_u32 vcc_lo, 1
    s_cbranch_scc1 L_tb33_1
    s_waitcnt vmcnt(29)
    s_branch L_tb33_1
L_th36_1:
    s_waitcnt vmcnt(34)
    s_cmp_eq_u32 vcc_lo, 1
    s_cbranch_scc1 L_tb36_1
    s_waitcnt vmcnt(25)
    s_branch L_tb36_1
L_th39_1:
    s_waitcnt vmcnt(28)
    s_cmp_eq_u32 vcc_lo, 1
    s_cbranch_scc1 L_tb39_1
    s_waitcnt vmcnt(25)
    s_branch L_tb39_1
L_th42_1:
    s_waitcnt vmcnt(28)
    s_cmp_eq_u32 vcc_lo, 1
    s_cbranch_scc1 L_tb42_1
    s_waitcnt vmcnt(25)
    s_branch L_tb42_1
L_th45_1:
    s_waitcnt vmcnt(28)
    s_cmp_eq_u32 vcc_lo, 1
    s_cbranch_scc1 L_tb45_1
    s_waitcnt vmcnt(25)
    s_branch L_tb45_1
L_th0_1:
    s_waitcnt vmcnt(28)
    s_cmp_eq_u32 vcc_lo, 1
    s_cbranch_scc1 L_tb0_1
    s_waitcnt vmcnt(19)
    s_branch L_tb0_1
L_th3_1:
    s_waitcnt vmcnt(22)
    s_cmp_eq_u32 vcc_lo, 1
    s_cbranch_scc1 L_tb3_1
    s_waitcnt vmcnt(19)
    s_branch L_tb3_1
L_th6_1:
    s_waitcnt vmcnt(22)
    s_cmp_eq_u32 vcc_lo, 1
    s_cbranch_scc1 L_tb6_1
    s_waitcnt vmcnt(17)
    s_branch L_tb6_1
L_th9_1:
    s_waitcnt vmcnt(20)
    s_cmp_eq_u32 vcc_lo, 1
    s_cbranch_scc1 L_tb9_1
    s_waitcnt vmcnt(17)
    s_branch L_tb9_1
L_th12_1:
    s_waitcnt vmcnt(20)
    s_cmp_eq_u32 vcc_lo, 1
    s_cbranch_scc1 L_tb12_1
    s_waitcnt vmcnt(17)
    s_branch L_tb12_1
L_th15_1:
    s_waitcnt vmcnt(20)
    s_cmp_eq_u32 vcc_lo, 1
    s_cbranch_scc1 L_tb15_1
    s_waitcnt vmcnt(17)
    s_branch L_tb15_1
L_th18_1:
    s_waitcnt vmcnt(20)
    s_cmp_eq_u32 vcc_lo, 1
    s_cbranch_scc1 L_tb18_1
    s_waitcnt vmcnt(17)
    s_branch L_tb18_1
L_th21_1:
    s_waitcnt vmcnt(20)
    s_cmp_eq_u32 vcc_lo, 1
    s_cbranch_scc1 L_tb21_1
    s_waitcnt vmcnt(17)
    s_branch L_tb21_1
L_th24_2:
    s_nop 11
    s_waitcnt vmcnt(20)
    s_cmp_eq_u32 vcc_lo, 1
    s_cbranch_scc1 L_tb24_2
    s_waitcnt vmcnt(17)
    s_branch L_tb24_2
L_th27_2:
    s_nop 11
    s_waitcnt vmcnt(20)
    s_cmp_eq_u32 vcc_lo, 1
    s_cbranch_scc1 L_tb27_2
    s_waitcnt vmcnt(17)
    s_branch L_tb27_2
L_th30_2:
    s_nop 11
    s_waitcnt vmcnt(20)
    s_cmp_eq_u32 vcc_lo, 1
    s_cbranch_scc1 L_tb30_2
    s_waitcnt vmcnt(17)
    s_branch L_tb30_2
L_th33_2:
    s_nop 11
    s_waitcnt vmcnt(20)
    s_cmp_eq_u32 vcc_lo, 1
    s_cbranch_scc1 L_tb33_2
    s_waitcnt vmcnt(17)
    s_branch L_tb33_2
L_th36_2:
    s_nop 11
    s_waitcnt vmcnt(22)
    s_cmp_eq_u32 vcc_lo, 1
    s_cbranch_scc1 L_tb36_2
    s_waitcnt vmcnt(19)
    s_branch L_tb36_2
L_th39_2:
    s_nop 11
    s_waitcnt vmcnt(22)
    s_cmp_eq_u32 vcc_lo, 1
    s_cbranch_scc1 L_tb39_2
    s_waitcnt vmcnt(19)
    s_branch L_tb39_2
L_th42_2:
    s_nop 11
    s_waitcnt vmcnt(22)
    s_cmp_eq_u32 vcc_lo, 1
    s_cbranch_scc1 L_tb42_2
    s_waitcnt vmcnt(19)
    s_branch L_tb42_2
L_th45_2:
    s_nop 11
    s_waitcnt vmcnt(22)
    s_cmp_eq_u32 vcc_lo, 1
    s_cbranch_scc1 L_tb45_2
    s_waitcnt vmcnt(19)
    s_branch L_tb45_2
L_getm2:
    ds_read_b32 v227, v243 offset:139
    ds_read_b32 v226, v243 offset:159
    s_waitcnt lgkmcnt(0)
    v_readfirstlane_b32 s93, v227
    v_readfirstlane_b32 s77, v226
    s_cmp_eq_u32 s93, 0
    s_cbranch_scc1 L_getm2
    ds_read_b32 v226, v243 offset:151
    s_waitcnt lgkmcnt(0)
    v_readfirstlane_b32 s88, v226
    s_cmp_eq_u32 s88, -1
    s_cselect_b64 s[88:89], -1, 0
    s_branch L_gotm2
L_th0_2:
    s_nop 11
    s_waitcnt vmcnt(22)
    s_cmp_eq_u32 vcc_lo, 1
    s_cbranch_scc1 L_tb0_2
    s_waitcnt vmcnt(19)
    s_branch L_tb0_2
L_th3_2:
    s_nop 11
    s_waitcnt vmcnt(22)
    s_cmp_eq_u32 vcc_lo, 1
    s_cbranch_scc1 L_tb3_2
    s_waitcnt vmcnt(19)
    s_branch L_tb3_2
L_th6_2:
    s_nop 11
    s_waitcnt vmcnt(22)
    s_cmp_eq_u32 vcc_lo, 1
    s_cbranch_scc1 L_tb6_2
    s_waitcnt vmcnt(17)
    s_branch L_tb6_2
L_th9_2:
    s_nop 11
    s_waitcnt vmcnt(20)
    s_cmp_eq_u32 vcc_lo, 1
    s_cbranch_scc1 L_tb9_2
    s_waitcnt vmcnt(17)
    s_branch L_tb9_2
L_th12_2:
    s_nop 11
    s_waitcnt vmcnt(20)
    s_cmp_eq_u32 vcc_lo, 1
    s_cbranch_scc1 L_tb12_2
    s_waitcnt vmcnt(17)
    s_branch L_tb12_2
L_th15_2:
    s_nop 11
    s_waitcnt vmcnt(20)
    s_cmp_eq_u32 vcc_lo, 1
    s_cbranch_scc1 L_tb15_2
    s_waitcnt vmcnt(17)
    s_branch L_tb15_2
L_th18_2:
    s_nop 11
    s_waitcnt vmcnt(20)
    s_cmp_eq_u32 vcc_lo, 1
    s_cbranch_scc1 L_tb18_2
    s_waitcnt vmcnt(17)
    s_branch L_tb18_2
L_th21_2:
    s_nop 11
    s_waitcnt vmcnt(20)
    s_cmp_eq_u32 vcc_lo, 1
    s_cbranch_scc1 L_tb21_2
    s_waitcnt vmcnt(17)
    s_branch L_tb21_2
L_th24_3:
    s_nop 11
    s_waitcnt vmcnt(20)
    s_cmp_eq_u32 vcc_lo, 1
    s_cbranch_scc1 L_tb24_3
    s_waitcnt vmcnt(17)
    s_branch L_tb24_3
L_th27_3:
    s_nop 11
    s_waitcnt vmcnt(20)
    s_cmp_eq_u32 vcc_lo, 1
    s_cbranch_scc1 L_tb27_3
    s_waitcnt vmcnt(17)
    s_branch L_tb27_3
L_th30_3:
    s_nop 11
    s_waitcnt vmcnt(20)
    s_cmp_eq_u32 vcc_lo, 1
    s_cbranch_scc1 L_tb30_3
    s_waitcnt vmcnt(17)
    s_branch L_tb30_3
L_th33_3:
    s_nop 11
    s_waitcnt vmcnt(20)
    s_cmp_eq_u32 vcc_lo, 1
    s_cbranch_scc1 L_tb33_3
    s_waitcnt vmcnt(17)
    s_branch L_tb33_3
L_th36_3:
    s_nop 11
    s_waitcnt vmcnt(20)
    s_cmp_eq_u32 vcc_lo, 1
    s_cbranch_scc1 L_tb36_3
    s_waitcnt vmcnt(17)
    s_branch L_tb36_3
L_th39_3:
    s_nop 11
    s_waitcnt vmcnt(20)
    s_cmp_eq_u32 vcc_lo, 1
    s_cbranch_scc1 L_tb39_3
    s_waitcnt vmcnt(17)
    s_branch L_tb39_3
L_th42_3:
    s_nop 11
    s_waitcnt vmcnt(20)
    s_cmp_eq_u32 vcc_lo, 1
    s_cbranch_scc1 L_tb42_3
    s_waitcnt vmcnt(17)
    s_branch L_tb42_3
L_th45_3:
    s_nop 11
    s_waitcnt vmcnt(20)
    s_cmp_eq_u32 vcc_lo, 1
    s_cbranch_scc1 L_tb45_3
    s_waitcnt vmcnt(17)
    s_branch L_tb45_3
L_service:
    v_lshlrev_b32 v5, 2, v0
    v_mov_b32 v3, 0
    ds_write_b32 v5, v3 offset:0
    v_lshlrev_b32 v1, 4, v0
    v_lshlrev_b32 v28, 11, v0
    v_mov_b32 v9, 0xf149f2ca
    v_cndmask_b32 v9, v9, v3, s[66:67]
    v_and_b32 v5, 15, v0
    v_lshrrev_b32 v6, 4, v0
    v_lshl_add_u32 v11, v5, 2, v6
    v_lshlrev_b32 v11, 1, v11
    s_getreg_b32 s72, hwreg(HW_REG_XCC_ID)
    s_and_b32 s72, s72, 15
    s_waitcnt lgkmcnt(0)
    s_barrier
    s_branch L_w0
L_walked:
    s_mov_b32 s52, s22
    s_and_b32 s53, s23, 0xffff
    s_mov_b32 s54, 25165824
    s_mov_b32 s55, 0x00020000
    s_mov_b32 s56, s18
    s_and_b32 s57, s19, 0xffff
    s_mov_b32 s58, 12288
    s_mov_b32 s59, 0x00020000
    s_mov_b32 s96, s79
    s_and_b32 s82, s79, 3
    s_lshl_b32 s82, s82, 4
    v_mov_b32 v10, 0
    s_mov_b32 s80, 0x2010200
    s_mov_b32 s81, 0x2030202
    s_cmp_ge_u32 s79, 4
    s_cmov_b32 s80, 0x2050204
    s_cmov_b32 s81, 0x2070206
    s_lshr_b64 s[80:81], s[80:81], s82
    v_writelane_b32 v10, s80, 0
    s_mov_b32 s80, 0x2090208
    s_mov_b32 s81, 0x20b020a
    s_cmp_ge_u32 s79, 4
    s_cmov_b32 s80, 0x20d020c
    s_cmov_b32 s81, 0x20f020e
    s_lshr_b64 s[80:81], s[80:81], s82
    v_writelane_b32 v10, s80, 1
    s_mov_b32 s80, 0x4d00150
    s_mov_b32 s81, 0x8310571
    s_cmp_ge_u32 s79, 4
    s_cmov_b32 s80, 0x57304d2
    s_cmov_b32 s81, 0x4b40174
    s_lshr_b64 s[80:81], s[80:81], s82
    v_writelane_b32 v10, s80, 2
    s_mov_b32 s80, 0x9100d5
    s_mov_b32 s81, 0x15204b6
    s_cmp_ge_u32 s79, 4
    s_cmov_b32 s80, 0x4b700b3
    s_cmov_b32 s81, 0x8d508b7
    s_lshr_b64 s[80:81], s[80:81], s82
    v_writelane_b32 v10, s80, 3
    s_mov_b32 s80, 0x4950000
    s_mov_b32 s81, 0x8b60000
    s_cmp_ge_u32 s79, 4
    s_cmov_b32 s80, 0xc96
    s_cmov_b32 s81, 0xcb70000
    s_lshr_b64 s[80:81], s[80:81], s82
    v_writelane_b32 v10, s80, 4
    s_mov_b32 s80, 0x560000
    s_mov_b32 s81, 0x0
    s_cmp_ge_u32 s79, 4
    s_cmov_b32 s80, 0x37
    s_cmov_b32 s81, 0x0
    s_lshr_b64 s[80:81], s[80:81], s82
    v_writelane_b32 v10, s80, 5
    v_and_b32 v10, 0xffff, v10
L_tag:
    ds_read_b32 v5, v3 offset:140
    ds_read_b64 v[16:17], v3 offset:152
    s_waitcnt lgkmcnt(0)
    v_readfirstlane_b32 s69, v5
    s_cmp_eq_u32 s69, 0
    s_cbranch_scc1 L_tag
    v_readfirstlane_b32 s86, v16
    v_readfirstlane_b32 s87, v17
    s_bfm_b64 s[84:85], s92, 0
    s_bcnt1_i32_b64 s70, s[86:87]
    s_and_b64 s[84:85], s[84:85], s[86:87]
    s_bcnt1_i32_b64 s71, s[84:85]
    s_mov_b32 s73, s71
L_round:
    s_min_u32 s80, s71, 63
    v_readlane_b32 s97, v10, s80
    s_lshl_b32 s80, s71, 2
    v_mov_b32 v4, s80
    s_cmp_eq_u32 s97, 0
    s_cbranch_scc1 L_last
L_poll:
    ds_read_b32 v5, v4 offset:0
    s_waitcnt lgkmcnt(0)
    v_readfirstlane_b32 s80, v5
    s_cmp_eq_u32 s80, 0
    s_cbranch_scc1 L_poll
    s_add_u32 s95, s69, s71
    s_add_u32 s95, s95, 1
    s_and_b32 s80, s71, 1
    s_lshl_b32 s80, s80, 19
    s_add_u32 s80, s80, 2097152
    s_lshl_b32 s77, s2, 11
    s_add_u32 s77, s77, s80
    s_lshl_b32 s75, s96, 16
    s_add_u32 s75, s75, s80
L_all:
    v_mov_b32 v16, s95
    s_mov_b64 exec, s[86:87]
    buffer_load_dword v16, v28, s[52:55], s75 offen offset:1024 sc0 sc1
    s_mov_b64 exec, -1
    s_waitcnt vmcnt(0)
    v_cmp_ne_u32 vcc, s95, v16
    s_cmp_lg_u64 vcc, 0
    s_cbranch_scc1 L_all
    s_mov_b32 s74, 0
    s_mov_b64 s[84:85], s[86:87]
L_merge:
    v_mov_b32 v7, 0xf149f2ca
    v_mov_b32 v8, 0
    v_mov_b32 v12, 0
    v_mov_b32 v13, 0
    v_mov_b32 v14, 0
L_chunk:
    v_mov_b32 v48, 0
    v_mov_b32 v49, 0
    v_mov_b32 v50, 0
    v_mov_b32 v51, v9
    v_mov_b32 v52, 0
    v_mov_b32 v53, 0
    v_mov_b32 v54, 0
    v_mov_b32 v55, v9
    v_mov_b32 v56, 0
    v_mov_b32 v57, 0
    v_mov_b32 v58, 0
    v_mov_b32 v59, v9
    v_mov_b32 v60, 0
    v_mov_b32 v61, 0
    v_mov_b32 v62, 0
    v_mov_b32 v63, v9
    v_mov_b32 v64, 0
    v_mov_b32 v65, 0
    v_mov_b32 v66, 0
    v_mov_b32 v67, v9
    v_mov_b32 v68, 0
    v_mov_b32 v69, 0
    v_mov_b32 v70, 0
    v_mov_b32 v71, v9
    v_mov_b32 v72, 0
    v_mov_b32 v73, 0
    v_mov_b32 v74, 0
    v_mov_b32 v75, v9
    v_mov_b32 v76, 0
    v_mov_b32 v77, 0
    v_mov_b32 v78, 0
    v_mov_b32 v79, v9
    v_mov_b32 v80, 0
    v_mov_b32 v81, 0
    v_mov_b32 v82, 0
    v_mov_b32 v83, v9
    v_mov_b32 v84, 0
    v_mov_b32 v85, 0
    v_mov_b32 v86, 0
    v_mov_b32 v87, v9
    v_mov_b32 v88, 0
    v_mov_b32 v89, 0
    v_mov_b32 v90, 0
    v_mov_b32 v91, v9
    v_mov_b32 v92, 0
    v_mov_b32 v93, 0
    v_mov_b32 v94, 0
    v_mov_b32 v95, v9
    v_mov_b32 v96, 0
    v_mov_b32 v97, 0
    v_mov_b32 v98, 0
    v_mov_b32 v99, v9
    v_mov_b32 v100, 0
    v_mov_b32 v101, 0
    v_mov_b32 v102, 0
    v_mov_b32 v103, v9
    v_mov_b32 v104, 0
    v_mov_b32 v105, 0
    v_mov_b32 v106, 0
    v_mov_b32 v107, v9
    v_mov_b32 v108, 0
    v_mov_b32 v109, 0
    v_mov_b32 v110, 0
    v_mov_b32 v111, v9
    v_mov_b32 v112, 0
    v_mov_b32 v113, 0
    v_mov_b32 v114, 0
    v_mov_b32 v115, v9
    v_mov_b32 v116, 0
    v_mov_b32 v117, 0
    v_mov_b32 v118, 0
    v_mov_b32 v119, v9
    v_mov_b32 v120, 0
    v_mov_b32 v121, 0
    v_mov_b32 v122, 0
    v_mov_b32 v123, v9
    v_mov_b32 v124, 0
    v_mov_b32 v125, 0
    v_mov_b32 v126, 0
    v_mov_b32 v127, v9
    v_mov_b32 v128, 0
    v_mov_b32 v129, 0
    v_mov_b32 v130, 0
    v_mov_b32 v131, v9
    v_mov_b32 v132, 0
    v_mov_b32 v133, 0
    v_mov_b32 v134, 0
    v_mov_b32 v135, v9
    v_mov_b32 v136, 0
    v_mov_b32 v137, 0
    v_mov_b32 v138, 0
    v_mov_b32 v139, v9
    v_mov_b32 v140, 0
    v_mov_b32 v141, 0
    v_mov_b32 v142, 0
    v_mov_b32 v143, v9
    v_mov_b32 v144, 0
    v_mov_b32 v145, 0
    v_mov_b32 v146, 0
    v_mov_b32 v147, v9
    v_mov_b32 v148, 0
    v_mov_b32 v149, 0
    v_mov_b32 v150, 0
    v_mov_b32 v151, v9
    v_mov_b32 v152, 0
    v_mov_b32 v153, 0
    v_mov_b32 v154, 0
    v_mov_b32 v155, v9
    v_mov_b32 v156, 0
    v_mov_b32 v157, 0
    v_mov_b32 v158, 0
    v_mov_b32 v159, v9
    v_mov_b32 v160, 0
    v_mov_b32 v161, 0
    v_mov_b32 v162, 0
    v_mov_b32 v163, v9
    v_mov_b32 v164, 0
    v_mov_b32 v165, 0
    v_mov_b32 v166, 0
    v_mov_b32 v167, v9
    v_mov_b32 v168, 0
    v_mov_b32 v169, 0
    v_mov_b32 v170, 0
    v_mov_b32 v171, v9
    v_mov_b32 v172, 0
    v_mov_b32 v173, 0
    v_mov_b32 v174, 0
    v_mov_b32 v175, v9
    s_ff1_i32_b64 s80, s[84:85]
    s_bitset0_b64 s[84:85], s80
    s_lshl_b32 s81, s80, 11
    s_add_u32 s81, s81, s75
    s_cmp_ge_i32 s80, 0
    s_cselect_b64 exec, -1, 0
    buffer_load_dwordx4 v[48:51], v1, s[52:55], s81 offen sc0 sc1
    s_ff1_i32_b64 s80, s[84:85]
    s_bitset0_b64 s[84:85], s80
    s_lshl_b32 s81, s80, 11
    s_add_u32 s81, s81, s75
    s_cmp_ge_i32 s80, 0
    s_cselect_b64 exec, -1, 0
    buffer_load_dwordx4 v[52:55], v1, s[52:55], s81 offen sc0 sc1
    s_ff1_i32_b64 s80, s[84:85]
    s_bitset0_b64 s[84:85], s80
    s_lshl_b32 s81, s80, 11
    s_add_u32 s81, s81, s75
    s_cmp_ge_i32 s80, 0
    s_cselect_b64 exec, -1, 0
    buffer_load_dwordx4 v[56:59], v1, s[52:55], s81 offen sc0 sc1
    s_ff1_i32_b64 s80, s[84:85]
    s_bitset0_b64 s[84:85], s80
    s_lshl_b32 s81, s80, 11
    s_add_u32 s81, s81, s75
    s_cmp_ge_i32 s80, 0
    s_cselect_b64 exec, -1, 0
    buffer_load_dwordx4 v[60:63], v1, s[52:55], s81 offen sc0 sc1
    s_ff1_i32_b64 s80, s[84:85]
    s_bitset0_b64 s[84:85], s80
    s_lshl_b32 s81, s80, 11
    s_add_u32 s81, s81, s75
    s_cmp_ge_i32 s80, 0
    s_cselect_b64 exec, -1, 0
    buffer_load_dwordx4 v[64:67], v1, s[52:55], s81 offen sc0 sc1
    s_ff1_i32_b64 s80, s[84:85]
    s_bitset0_b64 s[84:85], s80
    s_lshl_b32 s81, s80, 11
    s_add_u32 s81, s81, s75
    s_cmp_ge_i32 s80, 0
    s_cselect_b64 exec, -1, 0
    buffer_load_dwordx4 v[68:71], v1, s[52:55], s81 offen sc0 sc1
    s_ff1_i32_b64 s80, s[84:85]
    s_bitset0_b64 s[84:85], s80
    s_lshl_b32 s81, s80, 11
    s_add_u32 s81, s81, s75
    s_cmp_ge_i32 s80, 0
    s_cselect_b64 exec, -1, 0
    buffer_load_dwordx4 v[72:75], v1, s[52:55], s81 offen sc0 sc1
    s_ff1_i32_b64 s80, s[84:85]
    s_bitset0_b64 s[84:85], s80
    s_lshl_b32 s81, s80, 11
    s_add_u32 s81, s81, s75
    s_cmp_ge_i32 s80, 0
    s_cselect_b64 exec, -1, 0
    buffer_load_dwordx4 v[76:79], v1, s[52:55], s81 offen sc0 sc1
    s_ff1_i32_b64 s80, s[84:85]
    s_bitset0_b64 s[84:85], s80
    s_lshl_b32 s81, s80, 11
    s_add_u32 s81, s81, s75
    s_cmp_ge_i32 s80, 0
    s_cbranch_scc0 L_got
    s_cselect_b64 exec, -1, 0
    buffer_load_dwordx4 v[80:83], v1, s[52:55], s81 offen sc0 sc1
    s_ff1_i32_b64 s80, s[84:85]
    s_bitset0_b64 s[84:85], s80
    s_lshl_b32 s81, s80, 11
    s_add_u32 s81, s81, s75
    s_cmp_ge_i32 s80, 0
    s_cselect_b64 exec, -1, 0
    buffer_load_dwordx4 v[84:87], v1, s[52:55], s81 offen sc0 sc1
    s_ff1_i32_b64 s80, s[84:85]
    s_bitset0_b64 s[84:85], s80
    s_lshl_b32 s81, s80, 11
    s_add_u32 s81, s81, s75
    s_cmp_ge_i32 s80, 0
    s_cselect_b64 exec, -1, 0
    buffer_load_dwordx4 v[88:91], v1, s[52:55], s81 offen sc0 sc1
    s_ff1_i32_b64 s80, s[84:85]
    s_bitset0_b64 s[84:85], s80
    s_lshl_b32 s81, s80, 11
    s_add_u32 s81, s81, s75
    s_cmp_ge_i32 s80, 0
    s_cselect_b64 exec, -1, 0
    buffer_load_dwordx4 v[92:95], v1, s[52:55], s81 offen sc0 sc1
    s_ff1_i32_b64 s80, s[84:85]
    s_bitset0_b64 s[84:85], s80
    s_lshl_b32 s81, s80, 11
    s_add_u32 s81, s81, s75
    s_cmp_ge_i32 s80, 0
    s_cselect_b64 exec, -1, 0
    buffer_load_dwordx4 v[96:99], v1, s[52:55], s81 offen sc0 sc1
    s_ff1_i32_b64 s80, s[84:85]
    s_bitset0_b64 s[84:85], s80
    s_lshl_b32 s81, s80, 11
    s_add_u32 s81, s81, s75
    s_cmp_ge_i32 s80, 0
    s_cselect_b64 exec, -1, 0
    buffer_load_dwordx4 v[100:103], v1, s[52:55], s81 offen sc0 sc1
    s_ff1_i32_b64 s80, s[84:85]
    s_bitset0_b64 s[84:85], s80
    s_lshl_b32 s81, s80, 11
    s_add_u32 s81, s81, s75
    s_cmp_ge_i32 s80, 0
    s_cselect_b64 exec, -1, 0
    buffer_load_dwordx4 v[104:107], v1, s[52:55], s81 offen sc0 sc1
    s_ff1_i32_b64 s80, s[84:85]
    s_bitset0_b64 s[84:85], s80
    s_lshl_b32 s81, s80, 11
    s_add_u32 s81, s81, s75
    s_cmp_ge_i32 s80, 0
    s_cselect_b64 exec, -1, 0
    buffer_load_dwordx4 v[108:111], v1, s[52:55], s81 offen sc0 sc1
    s_ff1_i32_b64 s80, s[84:85]
    s_bitset0_b64 s[84:85], s80
    s_lshl_b32 s81, s80, 11
    s_add_u32 s81, s81, s75
    s_cmp_ge_i32 s80, 0
    s_cbranch_scc0 L_got
    s_cselect_b64 exec, -1, 0
    buffer_load_dwordx4 v[112:115], v1, s[52:55], s81 offen sc0 sc1
    s_ff1_i32_b64 s80, s[84:85]
    s_bitset0_b64 s[84:85], s80
    s_lshl_b32 s81, s80, 11
    s_add_u32 s81, s81, s75
    s_cmp_ge_i32 s80, 0
    s_cselect_b64 exec, -1, 0
    buffer_load_dwordx4 v[116:119], v1, s[52:55], s81 offen sc0 sc1
    s_ff1_i32_b64 s80, s[84:85]
    s_bitset0_b64 s[84:85], s80
    s_lshl_b32 s81, s80, 11
    s_add_u32 s81, s81, s75
    s_cmp_ge_i32 s80, 0
    s_cselect_b64 exec, -1, 0
    buffer_load_dwordx4 v[120:123], v1, s[52:55], s81 offen sc0 sc1
    s_ff1_i32_b64 s80, s[84:85]
    s_bitset0_b64 s[84:85], s80
    s_lshl_b32 s81, s80, 11
    s_add_u32 s81, s81, s75
    s_cmp_ge_i32 s80, 0
    s_cselect_b64 exec, -1, 0
    buffer_load_dwordx4 v[124:127], v1, s[52:55], s81 offen sc0 sc1
    s_ff1_i32_b64 s80, s[84:85]
    s_bitset0_b64 s[84:85], s80
    s_lshl_b32 s81, s80, 11
    s_add_u32 s81, s81, s75
    s_cmp_ge_i32 s80, 0
    s_cselect_b64 exec, -1, 0
    buffer_load_dwordx4 v[128:131], v1, s[52:55], s81 offen sc0 sc1
    s_ff1_i32_b64 s80, s[84:85]
    s_bitset0_b64 s[84:85], s80
    s_lshl_b32 s81, s80, 11
    s_add_u32 s81, s81, s75
    s_cmp_ge_i32 s80, 0
    s_cselect_b64 exec, -1, 0
    buffer_load_dwordx4 v[132:135], v1, s[52:55], s81 offen sc0 sc1
    s_ff1_i32_b64 s80, s[84:85]
    s_bitset0_b64 s[84:85], s80
    s_lshl_b32 s81, s80, 11
    s_add_u32 s81, s81, s75
    s_cmp_ge_i32 s80, 0
    s_cselect_b64 exec, -1, 0
    buffer_load_dwordx4 v[136:139], v1, s[52:55], s81 offen sc0 sc1
    s_ff1_i32_b64 s80, s[84:85]
    s_bitset0_b64 s[84:85], s80
    s_lshl_b32 s81, s80, 11
    s_add_u32 s81, s81, s75
    s_cmp_ge_i32 s80, 0
    s_cselect_b64 exec, -1, 0
    buffer_load_dwordx4 v[140:143], v1, s[52:55], s81 offen sc0 sc1
    s_ff1_i32_b64 s80, s[84:85]
    s_bitset0_b64 s[84:85], s80
    s_lshl_b32 s81, s80, 11
    s_add_u32 s81, s81, s75
    s_cmp_ge_i32 s80, 0
    s_cbranch_scc0 L_got
    s_cselect_b64 exec, -1, 0
    buffer_load_dwordx4 v[144:147], v1, s[52:55], s81 offen sc0 sc1
    s_ff1_i32_b64 s80, s[84:85]
    s_bitset0_b64 s[84:85], s80
    s_lshl_b32 s81, s80, 11
    s_add_u32 s81, s81, s75
    s_cmp_ge_i32 s80, 0
    s_cselect_b64 exec, -1, 0
    buffer_load_dwordx4 v[148:151], v1, s[52:55], s81 offen sc0 sc1
    s_ff1_i32_b64 s80, s[84:85]
    s_bitset0_b64 s[84:85], s80
    s_lshl_b32 s81, s80, 11
    s_add_u32 s81, s81, s75
    s_cmp_ge_i32 s80, 0
    s_cselect_b64 exec, -1, 0
    buffer_load_dwordx4 v[152:155], v1, s[52:55], s81 offen sc0 sc1
    s_ff1_i32_b64 s80, s[84:85]
    s_bitset0_b64 s[84:85], s80
    s_lshl_b32 s81, s80, 11
    s_add_u32 s81, s81, s75
    s_cmp_ge_i32 s80, 0
    s_cselect_b64 exec, -1, 0
    buffer_load_dwordx4 v[156:159], v1, s[52:55], s81 offen sc0 sc1
    s_ff1_i32_b64 s80, s[84:85]
    s_bitset0_b64 s[84:85], s80
    s_lshl_b32 s81, s80, 11
    s_add_u32 s81, s81, s75
    s_cmp_ge_i32 s80, 0
    s_cselect_b64 exec, -1, 0
    buffer_load_dwordx4 v[160:163], v1, s[52:55], s81 offen sc0 sc1
    s_ff1_i32_b64 s80, s[84:85]
    s_bitset0_b64 s[84:85], s80
    s_lshl_b32 s81, s80, 11
    s_add_u32 s81, s81, s75
    s_cmp_ge_i32 s80, 0
    s_cselect_b64 exec, -1, 0
    buffer_load_dwordx4 v[164:167], v1, s[52:55], s81 offen sc0 sc1
    s_ff1_i32_b64 s80, s[84:85]
    s_bitset0_b64 s[84:85], s80
    s_lshl_b32 s81, s80, 11
    s_add_u32 s81, s81, s75
    s_cmp_ge_i32 s80, 0
    s_cselect_b64 exec, -1, 0
    buffer_load_dwordx4 v[168:171], v1, s[52:55], s81 offen sc0 sc1
    s_ff1_i32_b64 s80, s[84:85]
    s_bitset0_b64 s[84:85], s80
    s_lshl_b32 s81, s80, 11
    s_add_u32 s81, s81, s75
    s_cmp_ge_i32 s80, 0
    s_cselect_b64 exec, -1, 0
    buffer_load_dwordx4 v[172:175], v1, s[52:55], s81 offen sc0 sc1
L_got:
    s_mov_b64 exec, -1
    s_waitcnt vmcnt(0)
    v_max_f32 v5, v51, v55
    v_max3_f32 v5, v5, v59, v63
    v_max3_f32 v5, v5, v67, v71
    v_max3_f32 v5, v5, v75, v79
    v_max3_f32 v5, v5, v83, v87
    s_branch L_x3
L_w3:
    s_branch L_w4
L_x3:
    v_max3_f32 v5, v5, v91, v95
    v_max3_f32 v5, v5, v99, v103
    v_max3_f32 v5, v5, v107, v111
    v_max3_f32 v5, v5, v115, v119
    v_max3_f32 v5, v5, v123, v127
    v_max3_f32 v5, v5, v131, v135
    v_max3_f32 v5, v5, v139, v143
    v_max3_f32 v5, v5, v147, v151
    v_max3_f32 v5, v5, v155, v159
    v_max3_f32 v5, v5, v163, v167
    v_max3_f32 v5, v5, v171, v175
    s_nop 1
    v_max_f32_dpp v6, v5, v7 quad_perm:[0,0,2,2] row_mask:0xf bank_mask:0xf
    v_sub_f32 v5, v7, v6
    v_exp_f32 v5, v5
    v_mov_b32 v7, v6
    v_mul_f32 v8, v8, v5
    v_mul_f32 v12, v12, v5
    v_mul_f32 v13, v13, v5
    v_mul_f32 v14, v14, v5
    v_sub_f32_dpp v20, v51, v6 quad_perm:[0,0,2,2] row_mask:0xf bank_mask:0xf
    v_sub_f32_dpp v21, v55, v6 quad_perm:[0,0,2,2] row_mask:0xf bank_mask:0xf
    v_sub_f32_dpp v22, v59, v6 quad_perm:[0,0,2,2] row_mask:0xf bank_mask:0xf
    v_sub_f32_dpp v23, v63, v6 quad_perm:[0,0,2,2] row_mask:0xf bank_mask:0xf
    v_sub_f32_dpp v24, v67, v6 quad_perm:[0,0,2,2] row_mask:0xf bank_mask:0xf
    v_sub_f32_dpp v25, v71, v6 quad_perm:[0,0,2,2] row_mask:0xf bank_mask:0xf
    v_sub_f32_dpp v26, v75, v6 quad_perm:[0,0,2,2] row_mask:0xf bank_mask:0xf
    v_sub_f32_dpp v27, v79, v6 quad_perm:[0,0,2,2] row_mask:0xf bank_mask:0xf
    v_exp_f32 v20, v20
    v_exp_f32 v21, v21
    v_exp_f32 v22, v22
    v_exp_f32 v23, v23
    v_exp_f32 v24, v24
    v_exp_f32 v25, v25
    v_exp_f32 v26, v26
    v_exp_f32 v27, v27
    s_nop 0
    v_fmac_f32 v12, v20, v48
    v_fmac_f32 v13, v20, v49
    v_fmac_f32 v14, v20, v50
    v_fmac_f32 v8, v20, v51
    v_fmac_f32 v12, v21, v52
    v_fmac_f32 v13, v21, v53
    v_fmac_f32 v14, v21, v54
    v_fmac_f32 v8, v21, v55
    v_fmac_f32 v12, v22, v56
    v_fmac_f32 v13, v22, v57
    v_fmac_f32 v14, v22, v58
    v_fmac_f32 v8, v22, v59
    v_fmac_f32 v12, v23, v60
    v_fmac_f32 v13, v23, v61
    v_fmac_f32 v14, v23, v62
    v_fmac_f32 v8, v23, v63
    v_fmac_f32 v12, v24, v64
    v_fmac_f32 v13, v24, v65
    v_fmac_f32 v14, v24, v66
    v_fmac_f32 v8, v24, v67
    v_fmac_f32 v12, v25, v68
    v_fmac_f32 v13, v25, v69
    v_fmac_f32 v14, v25, v70
    v_fmac_f32 v8, v25, v71
    v_fmac_f32 v12, v26, v72
    v_fmac_f32 v13, v26, v73
    v_fmac_f32 v14, v26, v74
    v_fmac_f32 v8, v26, v75
    v_fmac_f32 v12, v27, v76
    v_fmac_f32 v13, v27, v77
    v_fmac_f32 v14, v27, v78
    v_fmac_f32 v8, v27, v79
    v_sub_f32_dpp v20, v83, v6 quad_perm:[0,0,2,2] row_mask:0xf bank_mask:0xf
    v_sub_f32_dpp v21, v87, v6 quad_perm:[0,0,2,2] row_mask:0xf bank_mask:0xf
    v_sub_f32_dpp v22, v91, v6 quad_perm:[0,0,2,2] row_mask:0xf bank_mask:0xf
    v_sub_f32_dpp v23, v95, v6 quad_perm:[0,0,2,2] row_mask:0xf bank_mask:0xf
    v_sub_f32_dpp v24, v99, v6 quad_perm:[0,0,2,2] row_mask:0xf bank_mask:0xf
    v_sub_f32_dpp v25, v103, v6 quad_perm:[0,0,2,2] row_mask:0xf bank_mask:0xf
    v_sub_f32_dpp v26, v107, v6 quad_perm:[0,0,2,2] row_mask:0xf bank_mask:0xf
    v_sub_f32_dpp v27, v111, v6 quad_perm:[0,0,2,2] row_mask:0xf bank_mask:0xf
    v_exp_f32 v20, v20
    v_exp_f32 v21, v21
    v_exp_f32 v22, v22
    v_exp_f32 v23, v23
    v_exp_f32 v24, v24
    v_exp_f32 v25, v25
    v_exp_f32 v26, v26
    v_exp_f32 v27, v27
    s_nop 0
    v_fmac_f32 v12, v20, v80
    v_fmac_f32 v13, v20, v81
    v_fmac_f32 v14, v20, v82
    v_fmac_f32 v8, v20, v83
    v_fmac_f32 v12, v21, v84
    v_fmac_f32 v13, v21, v85
    v_fmac_f32 v14, v21, v86
    v_fmac_f32 v8, v21, v87
    v_fmac_f32 v12, v22, v88
    v_fmac_f32 v13, v22, v89
    v_fmac_f32 v14, v22, v90
    v_fmac_f32 v8, v22, v91
    v_fmac_f32 v12, v23, v92
    v_fmac_f32 v13, v23, v93
    v_fmac_f32 v14, v23, v94
    v_fmac_f32 v8, v23, v95
    v_fmac_f32 v12, v24, v96
    v_fmac_f32 v13, v24, v97
    v_fmac_f32 v14, v24, v98
    v_fmac_f32 v8, v24, v99
    v_fmac_f32 v12, v25, v100
    v_fmac_f32 v13, v25, v101
    v_fmac_f32 v14, v25, v102
    v_fmac_f32 v8, v25, v103
    v_fmac_f32 v12, v26, v104
    v_fmac_f32 v13, v26, v105
    v_fmac_f32 v14, v26, v106
    v_fmac_f32 v8, v26, v107
    v_fmac_f32 v12, v27, v108
    v_fmac_f32 v13, v27, v109
    v_fmac_f32 v14, v27, v110
    v_fmac_f32 v8, v27, v111
    v_sub_f32_dpp v20, v115, v6 quad_perm:[0,0,2,2] row_mask:0xf bank_mask:0xf
    v_sub_f32_dpp v21, v119, v6 quad_perm:[0,0,2,2] row_mask:0xf bank_mask:0xf
    v_sub_f32_dpp v22, v123, v6 quad_perm:[0,0,2,2] row_mask:0xf bank_mask:0xf
    v_sub_f32_dpp v23, v127, v6 quad_perm:[0,0,2,2] row_mask:0xf bank_mask:0xf
    v_sub_f32_dpp v24, v131, v6 quad_perm:[0,0,2,2] row_mask:0xf bank_mask:0xf
    v_sub_f32_dpp v25, v135, v6 quad_perm:[0,0,2,2] row_mask:0xf bank_mask:0xf
    v_sub_f32_dpp v26, v139, v6 quad_perm:[0,0,2,2] row_mask:0xf bank_mask:0xf
    v_sub_f32_dpp v27, v143, v6 quad_perm:[0,0,2,2] row_mask:0xf bank_mask:0xf
    v_exp_f32 v20, v20
    v_exp_f32 v21, v21
    v_exp_f32 v22, v22
    v_exp_f32 v23, v23
    v_exp_f32 v24, v24
    v_exp_f32 v25, v25
    v_exp_f32 v26, v26
    v_exp_f32 v27, v27
    s_nop 0
    v_fmac_f32 v12, v20, v112
    v_fmac_f32 v13, v20, v113
    v_fmac_f32 v14, v20, v114
    v_fmac_f32 v8, v20, v115
    v_fmac_f32 v12, v21, v116
    v_fmac_f32 v13, v21, v117
    v_fmac_f32 v14, v21, v118
    v_fmac_f32 v8, v21, v119
    v_fmac_f32 v12, v22, v120
    v_fmac_f32 v13, v22, v121
    v_fmac_f32 v14, v22, v122
    v_fmac_f32 v8, v22, v123
    v_fmac_f32 v12, v23, v124
    v_fmac_f32 v13, v23, v125
    v_fmac_f32 v14, v23, v126
    v_fmac_f32 v8, v23, v127
    v_fmac_f32 v12, v24, v128
    v_fmac_f32 v13, v24, v129
    v_fmac_f32 v14, v24, v130
    v_fmac_f32 v8, v24, v131
    v_fmac_f32 v12, v25, v132
    v_fmac_f32 v13, v25, v133
    v_fmac_f32 v14, v25, v134
    v_fmac_f32 v8, v25, v135
    v_fmac_f32 v12, v26, v136
    v_fmac_f32 v13, v26, v137
    v_fmac_f32 v14, v26, v138
    v_fmac_f32 v8, v26, v139
    v_fmac_f32 v12, v27, v140
    v_fmac_f32 v13, v27, v141
    v_fmac_f32 v14, v27, v142
    v_fmac_f32 v8, v27, v143
    v_sub_f32_dpp v20, v147, v6 quad_perm:[0,0,2,2] row_mask:0xf bank_mask:0xf
    v_sub_f32_dpp v21, v151, v6 quad_perm:[0,0,2,2] row_mask:0xf bank_mask:0xf
    v_sub_f32_dpp v22, v155, v6 quad_perm:[0,0,2,2] row_mask:0xf bank_mask:0xf
    v_sub_f32_dpp v23, v159, v6 quad_perm:[0,0,2,2] row_mask:0xf bank_mask:0xf
    v_sub_f32_dpp v24, v163, v6 quad_perm:[0,0,2,2] row_mask:0xf bank_mask:0xf
    v_sub_f32_dpp v25, v167, v6 quad_perm:[0,0,2,2] row_mask:0xf bank_mask:0xf
    v_sub_f32_dpp v26, v171, v6 quad_perm:[0,0,2,2] row_mask:0xf bank_mask:0xf
    v_sub_f32_dpp v27, v175, v6 quad_perm:[0,0,2,2] row_mask:0xf bank_mask:0xf
    v_exp_f32 v20, v20
    v_exp_f32 v21, v21
    v_exp_f32 v22, v22
    v_exp_f32 v23, v23
    v_exp_f32 v24, v24
    v_exp_f32 v25, v25
    v_exp_f32 v26, v26
    v_exp_f32 v27, v27
    s_nop 0
    v_fmac_f32 v12, v20, v144
    v_fmac_f32 v13, v20, v145
    v_fmac_f32 v14, v20, v146
    v_fmac_f32 v8, v20, v147
    v_fmac_f32 v12, v21, v148
    v_fmac_f32 v13, v21, v149
    v_fmac_f32 v14, v21, v150
    v_fmac_f32 v8, v21, v151
    v_fmac_f32 v12, v22, v152
    v_fmac_f32 v13, v22, v153
    v_fmac_f32 v14, v22, v154
    v_fmac_f32 v8, v22, v155
    v_fmac_f32 v12, v23, v156
    v_fmac_f32 v13, v23, v157
    v_fmac_f32 v14, v23, v158
    v_fmac_f32 v8, v23, v159
    v_fmac_f32 v12, v24, v160
    v_fmac_f32 v13, v24, v161
    v_fmac_f32 v14, v24, v162
    v_fmac_f32 v8, v24, v163
    v_fmac_f32 v12, v25, v164
    v_fmac_f32 v13, v25, v165
    v_fmac_f32 v14, v25, v166
    v_fmac_f32 v8, v25, v167
    v_fmac_f32 v12, v26, v168
    v_fmac_f32 v13, v26, v169
    v_fmac_f32 v14, v26, v170
    v_fmac_f32 v8, v26, v171
    v_fmac_f32 v12, v27, v172
    v_fmac_f32 v13, v27, v173
    v_fmac_f32 v14, v27, v174
    v_fmac_f32 v8, v27, v175
    s_cmp_lg_u64 s[84:85], 0
    s_cbranch_scc1 L_chunk
    s_cmp_lg_u32 s74, 0
    s_cbranch_scc1 L_fin
    v_cndmask_b32 v15, v7, v8, s[66:67]
    v_mov_b32 v5, s95
    s_and_b32 s79, s97, 31
    s_lshr_b32 s80, s97, 10
    s_lshl_b32 s80, s80, 3
    s_and_b32 s83, s72, 7
    s_add_u32 s80, s80, s83
    s_bfm_b64 s[88:89], 1, s80
    s_bfe_u32 s83, s97, 0x50005
    s_mul_i32 s83, s83, s70
    s_cmp_lg_u32 s83, 512
    s_cbranch_scc1 L_rec
    s_mov_b64 exec, 1
    buffer_store_dword v5, v3, s[52:55], s77 offen offset:1028
    s_mov_b64 exec, -1
    s_branch L_fin
L_rec:
    s_lshl_b32 s83, s83, 16
    s_or_b32 s89, s89, s83
    v_mov_b32 v16, s88
    v_mov_b32 v17, s89
    s_lshl_b32 s75, s79, 17
    s_add_u32 s75, s75, 4194304
    s_lshl_b32 s80, s80, 11
    s_add_u32 s80, s80, s75
    buffer_store_dwordx4 v[12:15], v1, s[52:55], s80 offen sc0 sc1
    s_mov_b64 exec, 1
    buffer_store_dword v5, v3, s[52:55], s77 offen offset:1028
    s_lshl_b32 s80, s79, 8
    s_add_u32 s80, s80, 23076864
    s_waitcnt vmcnt(0)
    buffer_atomic_add_x2 v[16:17], v3, s[52:55], s80 offen sc0 sc1
    s_waitcnt vmcnt(0)
    s_mov_b64 exec, -1
    v_readfirstlane_b32 s84, v16
    v_readfirstlane_b32 s85, v17
    s_add_u32 s84, s84, s88
    s_add_u32 s85, s85, s89
    s_lshr_b32 s80, s85, 16
    s_cmp_lg_u32 s80, 512
    s_cbranch_scc1 L_next
    s_mov_b32 s74, 1
    s_and_b32 s85, s85, 0xffff
    s_branch L_merge
L_fin:
    s_nop 1
    v_mov_b32_dpp v5, v8 quad_perm:[1,1,3,3] row_mask:0xf bank_mask:0xf
    v_rcp_f32 v5, v5
    s_mul_i32 s80, s79, 384
    v_mul_f32 v12, v12, v5
    v_mul_f32 v13, v13, v5
    v_mul_f32 v14, v14, v5
    v_cvt_pk_bf16_f32 v12, v12, v12
    v_cvt_pk_bf16_f32 v13, v13, v13
    v_cvt_pk_bf16_f32 v14, v14, v14
    buffer_store_short v12, v11, s[56:59], s80 offen offset:0
    buffer_store_short v13, v11, s[56:59], s80 offen offset:128
    buffer_store_short v14, v11, s[56:59], s80 offen offset:256
L_next:
    s_add_u32 s71, s71, s70
    s_branch L_round
L_last:
    s_lshl_b32 s75, s96, 9
    s_add_u32 s75, s75, 1572864
    v_lshrrev_b32 v6, 1, v0
    v_lshlrev_b32 v28, 4, v6
L_inf:
    buffer_load_dwordx4 v[48:51], v28, s[52:55], s75 offen sc0 sc1
    s_waitcnt vmcnt(0)
    v_cmp_ne_u32 vcc, s69, v49
    s_cmp_lg_u64 vcc, 0
    s_cbranch_scc1 L_inf
    v_mov_b32 v7, v50
    s_nop 1
    v_max_f32_dpp v7, v7, v7 row_ror:8 row_mask:0xf bank_mask:0xf
    s_nop 1
    v_max_f32_dpp v7, v7, v7 row_ror:4 row_mask:0xf bank_mask:0xf
    s_nop 1
    v_max_f32_dpp v7, v7, v7 row_ror:2 row_mask:0xf bank_mask:0xf
    s_nop 1
    v_max_f32_dpp v7, v7, v7 row_ror:1 row_mask:0xf bank_mask:0xf
    v_mov_b32 v5, v7
    s_nop 1
    v_permlane32_swap_b32 v7, v5
    s_nop 1
    v_max_f32 v7, v7, v5
    v_mov_b32 v5, v7
    s_nop 1
    v_permlane16_swap_b32 v7, v5
    s_nop 1
    v_max_f32 v7, v7, v5
    v_sub_f32 v20, v50, v7
    v_exp_f32 v20, v20
    s_nop 0
    v_mul_f32 v8, v20, v51
    s_nop 1
    v_add_f32_dpp v8, v8, v8 row_ror:8 row_mask:0xf bank_mask:0xf
    s_nop 1
    v_add_f32_dpp v8, v8, v8 row_ror:4 row_mask:0xf bank_mask:0xf
    s_nop 1
    v_add_f32_dpp v8, v8, v8 row_ror:2 row_mask:0xf bank_mask:0xf
    s_nop 1
    v_add_f32_dpp v8, v8, v8 row_ror:1 row_mask:0xf bank_mask:0xf
    v_mov_b32 v5, v8
    s_nop 1
    v_permlane32_swap_b32 v8, v5
    s_nop 1
    v_add_f32 v8, v8, v5
    v_mov_b32 v5, v8
    s_nop 1
    v_permlane16_swap_b32 v8, v5
    s_nop 1
    v_add_f32 v8, v8, v5
    v_rcp_f32 v8, v8
    v_and_b32 v5, 1, v0
    v_mul_f32 v8, 2.0, v8
    v_mul_f32 v20, v20, v8
    v_lshlrev_b32 v28, 11, v6
    v_lshl_add_u32 v28, v5, 4, v28
    s_lshl_b32 s75, s96, 16
    s_lshl_b32 s80, s92, 5
    s_add_u32 s75, s75, s80
    v_mov_b32 v51, 0
    v_mov_b32 v55, 0
    v_mov_b32 v59, 0
    v_mov_b32 v63, 0
    v_mov_b32 v12, 0
    v_mov_b32 v13, 0
    v_mov_b32 v14, 0
    v_bfe_u32 v6, v0, 4, 1
    v_lshrrev_b32 v11, 5, v0
    v_lshl_add_u32 v11, v6, 1, v11
    v_lshlrev_b32 v11, 7, v11
    v_lshl_add_u32 v11, v5, 3, v11
    s_and_b32 s80, s92, 7
    s_lshl_b32 s80, s80, 4
    s_lshr_b32 s81, s92, 3
    s_lshl_b32 s81, s81, 1
    s_add_u32 s80, s80, s81
    s_add_u32 s79, s96, 24
    s_mul_i32 s78, s79, 384
    s_add_u32 s78, s78, s80
    s_mov_b64 s[24:25], -1
    s_mov_b32 s32, 0x00030003
    s_mov_b32 s33, 0x00000003
L_dt:
    ds_read_b32 v5, v3 offset:144
    s_waitcnt lgkmcnt(0)
    v_readfirstlane_b32 s80, v5
    s_cmp_eq_u32 s80, 0
    s_cbranch_scc1 L_dt
L_pa:
    buffer_load_dwordx4 v[48:51], v28, s[52:55], s75 offen offset:0 sc0 sc1
    s_waitcnt vmcnt(0)
    v_cmpx_eq_u32 vcc, s69, v51
    v_fmac_f32 v12, v20, v48
    v_fmac_f32 v13, v20, v49
    v_fmac_f32 v14, v20, v50
    s_andn2_b64 s[24:25], s[24:25], vcc
    s_mov_b64 exec, s[24:25]
    s_bcnt1_i32_b64 s80, s[24:25]
    s_cmp_gt_u32 s80, 0
    s_cbranch_scc1 L_pa
L_pd:
    s_mov_b64 exec, -1
    v_mov_b32 v15, v14
    v_permlane32_swap_b32 v12, v13
    s_nop 0
    v_permlane32_swap_b32 v14, v15
    v_add_f32 v12, v12, v13
    v_add_f32 v14, v14, v15
    s_nop 1
    v_permlane16_swap_b32 v12, v14
    v_add_f32 v12, v12, v14
    s_nop 1
    v_add_f32_dpp v12, v12, v12 row_ror:8 row_mask:0xf bank_mask:0xf
    s_nop 1
    v_add_f32_dpp v12, v12, v12 row_ror:4 row_mask:0xf bank_mask:0xf
    s_nop 1
    v_add_f32_dpp v12, v12, v12 row_ror:2 row_mask:0xf bank_mask:0xf
    s_mov_b64 exec, s[32:33]
    v_cvt_pk_bf16_f32 v12, v12, v12
    buffer_store_short v12, v11, s[56:59], s78 offen
L_end:
    s_endpgm
L_ticket:
    v_lshlrev_b32 v1, 2, v0
    v_mov_b32 v2, 0
    v_lshlrev_b32 v4, 4, v0
    v_mov_b32 v8, -1
    v_mov_b32 v9, -1
    v_mov_b32 v10, -1
    v_mov_b32 v11, -1
    ds_write_b128 v4, v[8:11] offset:256
    ds_write_b128 v4, v[8:11] offset:1280
    ds_write_b128 v4, v[8:11] offset:2304
    s_memrealtime s[80:81]
    s_waitcnt lgkmcnt(0)
    s_barrier
    s_mov_b32 s52, s22
    s_and_b32 s53, s23, 0xffff
    s_mov_b32 s54, 25165824
    s_mov_b32 s55, 0x00020000
    s_mov_b32 s60, s20
    s_and_b32 s61, s21, 0xffff
    s_mov_b32 s62, 256
    s_mov_b32 s63, 0x00020000
    s_max_u32 s69, s80, 1
    s_cmp_lg_u32 s2, 0
    s_cbranch_scc1 L_kd
    v_lshlrev_b32 v5, 8, v0
    s_mov_b32 s80, 23068672
    v_mov_b32 v3, 0
    buffer_store_dwordx2 v[2:3], v5, s[52:55], s80 offen sc0 sc1
    v_mov_b32 v3, s69
    s_mov_b64 exec, 1
    s_waitcnt vmcnt(0)
    buffer_store_dword v3, v2, s[60:63], 0 offen sc0 sc1
    s_mov_b64 exec, -1
L_kd:
    ds_read_b32 v3, v2 offset:128
    s_waitcnt lgkmcnt(0)
    v_readfirstlane_b32 s80, v3
    s_cmp_eq_u32 s80, 0
    s_cbranch_scc1 L_kd
    ds_read_b128 v[24:27], v4 offset:16128
    ds_read_b128 v[28:31], v4 offset:17152
    ds_read_b128 v[32:35], v4 offset:18176
    ds_read_b128 v[36:39], v4 offset:19200
    s_waitcnt lgkmcnt(0)
    v_max_f32 v18, v24, v25
    v_max3_f32 v18, v18, v26, v27
    v_max3_f32 v18, v18, v28, v29
    v_max3_f32 v18, v18, v30, v31
    v_max3_f32 v18, v18, v32, v33
    v_max3_f32 v18, v18, v34, v35
    v_max3_f32 v18, v18, v36, v37
    v_max3_f32 v18, v18, v38, v39
    s_nop 1
    v_max_f32_dpp v18, v18, v18 row_ror:8 row_mask:0xf bank_mask:0xf
    s_nop 1
    v_max_f32_dpp v18, v18, v18 row_ror:4 row_mask:0xf bank_mask:0xf
    s_nop 1
    v_max_f32_dpp v18, v18, v18 row_ror:2 row_mask:0xf bank_mask:0xf
    s_nop 1
    v_max_f32_dpp v18, v18, v18 row_ror:1 row_mask:0xf bank_mask:0xf
    v_mov_b32 v3, v18
    s_nop 1
    v_permlane32_swap_b32 v18, v3
    s_nop 1
    v_max_f32 v18, v18, v3
    v_mov_b32 v3, v18
    s_nop 1
    v_permlane16_swap_b32 v18, v3
    s_nop 1
    v_max_f32 v18, v18, v3
    v_sub_f32 v24, v24, v18
    v_sub_f32 v25, v25, v18
    v_sub_f32 v26, v26, v18
    v_sub_f32 v27, v27, v18
    v_sub_f32 v28, v28, v18
    v_sub_f32 v29, v29, v18
    v_sub_f32 v30, v30, v18
    v_sub_f32 v31, v31, v18
    v_sub_f32 v32, v32, v18
    v_sub_f32 v33, v33, v18
    v_sub_f32 v34, v34, v18
    v_sub_f32 v35, v35, v18
    v_sub_f32 v36, v36, v18
    v_sub_f32 v37, v37, v18
    v_sub_f32 v38, v38, v18
    v_sub_f32 v39, v39, v18
    v_exp_f32 v24, v24
    v_exp_f32 v25, v25
    v_exp_f32 v26, v26
    v_exp_f32 v27, v27
    v_exp_f32 v28, v28
    v_exp_f32 v29, v29
    v_exp_f32 v30, v30
    v_exp_f32 v31, v31
    v_exp_f32 v32, v32
    v_exp_f32 v33, v33
    v_exp_f32 v34, v34
    v_exp_f32 v35, v35
    v_exp_f32 v36, v36
    v_exp_f32 v37, v37
    v_exp_f32 v38, v38
    v_exp_f32 v39, v39
    ds_write_b32 v2, v18 offset:160
    v_add_f32 v19, v24, v25
    v_add_f32 v19, v19, v26
    v_add_f32 v19, v19, v27
    v_add_f32 v19, v19, v28
    v_add_f32 v19, v19, v29
    v_add_f32 v19, v19, v30
    v_add_f32 v19, v19, v31
    v_add_f32 v19, v19, v32
    v_add_f32 v19, v19, v33
    v_add_f32 v19, v19, v34
    v_add_f32 v19, v19, v35
    v_add_f32 v19, v19, v36
    v_add_f32 v19, v19, v37
    v_add_f32 v19, v19, v38
    v_add_f32 v19, v19, v39
    s_nop 1
    v_add_f32_dpp v19, v19, v19 row_ror:8 row_mask:0xf bank_mask:0xf
    s_nop 1
    v_add_f32_dpp v19, v19, v19 row_ror:4 row_mask:0xf bank_mask:0xf
    s_nop 1
    v_add_f32_dpp v19, v19, v19 row_ror:2 row_mask:0xf bank_mask:0xf
    s_nop 1
    v_add_f32_dpp v19, v19, v19 row_ror:1 row_mask:0xf bank_mask:0xf
    v_mov_b32 v3, v19
    s_nop 1
    v_permlane32_swap_b32 v19, v3
    s_nop 1
    v_add_f32 v19, v19, v3
    v_mov_b32 v3, v19
    s_nop 1
    v_permlane16_swap_b32 v19, v3
    s_nop 1
    v_add_f32 v19, v19, v3
    s_lshl_b32 s80, s2, 11
    s_add_u32 s80, s80, 18874368
    s_waitcnt lgkmcnt(0)
    s_mov_b64 exec, -1
L_tg:
    buffer_load_dword v3, v2, s[60:63], 0 offen sc0 sc1
    s_waitcnt vmcnt(0)
    v_readfirstlane_b32 s69, v3
    s_cmp_eq_u32 s69, 0
    s_cbranch_scc1 L_tg
    s_getreg_b32 s81, hwreg(HW_REG_XCC_ID)
    s_and_b32 s81, s81, 15
    v_mov_b32 v16, s81
    v_mov_b32 v17, s69
    s_lshl_b32 s80, s2, 11
    s_mov_b64 exec, 1
    s_lshl_b32 s82, s2, 4
    s_add_u32 s82, s82, 1572864
    buffer_store_dwordx4 v[16:19], v2, s[52:55], s82 offen sc0 sc1
    v_mov_b32 v12, s69
    v_mov_b32 v13, s69
    s_add_u32 s82, s80, 2097152
    buffer_store_dwordx2 v[12:13], v2, s[52:55], s82 offen offset:1024
    s_add_u32 s82, s80, 2621440
    buffer_store_dwordx2 v[12:13], v2, s[52:55], s82 offen offset:1024
    s_mov_b64 exec, -1
    s_mov_b32 s73, s81
    s_lshl_b32 s80, s79, 2
    s_lshr_b32 s74, 0x54465464, s80
    s_and_b32 s74, s74, 15
    s_mov_b32 s75, 0
    s_mov_b32 s95, s69
    s_lshl_b32 s77, s2, 11
    s_lshl_b32 s94, s79, 16
    s_mov_b32 s76, 2097152
    v_mov_b32 v19, 0
    v_lshlrev_b32 v20, 11, v0
    v_mov_b32 v21, v4
L_fl:
    ds_read_b32 v3, v19
    s_waitcnt lgkmcnt(0)
    v_readfirstlane_b32 s80, v3
    s_cmp_eq_u32 s80, 0
    s_cbranch_scc1 L_fl
    ds_read_b128 v[24:27], v21 offset:20480
    ds_read_b128 v[28:31], v21 offset:21504
    ds_read_b128 v[32:35], v21 offset:22528
    ds_read_b128 v[36:39], v21 offset:23552
    s_waitcnt lgkmcnt(0)
    s_nop 0
    v_add_f32_dpp v37, v37, v37 row_ror:8 row_mask:0xf bank_mask:0xf
    v_add_f32_dpp v38, v38, v38 row_ror:8 row_mask:0xf bank_mask:0xf
    s_nop 0
    v_add_f32_dpp v37, v37, v37 row_ror:4 row_mask:0xf bank_mask:0xf
    v_add_f32_dpp v38, v38, v38 row_ror:4 row_mask:0xf bank_mask:0xf
    s_nop 0
    v_add_f32_dpp v37, v37, v37 row_ror:2 row_mask:0xf bank_mask:0xf
    v_add_f32_dpp v38, v38, v38 row_ror:2 row_mask:0xf bank_mask:0xf
    s_nop 0
    v_add_f32_dpp v37, v37, v37 row_ror:1 row_mask:0xf bank_mask:0xf
    v_add_f32_dpp v38, v38, v38 row_ror:1 row_mask:0xf bank_mask:0xf
    v_mov_b32 v40, v36
    v_mov_b32 v41, v36
    s_nop 1
    v_permlane32_swap_b32 v40, v41
    s_nop 1
    v_max_f32 v40, v40, v41
    v_mov_b32 v41, v40
    s_nop 1
    v_permlane16_swap_b32 v40, v41
    s_nop 1
    v_max_f32 v40, v40, v41
    v_sub_f32 v41, v36, v40
    v_exp_f32 v41, v41
    v_mov_b32 v48, v40
    v_mul_f32 v37, v37, v41
    v_mul_f32 v38, v38, v41
    v_mul_f32 v41, 0x58000000, v41
    v_fma_f32 v24, v24, v41, -v38
    v_fma_f32 v25, v25, v41, -v38
    v_fma_f32 v26, v26, v41, -v38
    v_fma_f32 v27, v27, v41, -v38
    v_fma_f32 v28, v28, v41, -v38
    v_fma_f32 v29, v29, v41, -v38
    v_fma_f32 v30, v30, v41, -v38
    v_fma_f32 v31, v31, v41, -v38
    v_fma_f32 v32, v32, v41, -v38
    v_fma_f32 v33, v33, v41, -v38
    v_fma_f32 v34, v34, v41, -v38
    v_fma_f32 v35, v35, v41, -v38
    v_mov_b32 v40, v37
    s_nop 1
    v_permlane32_swap_b32 v37, v40
    v_permlane32_swap_b32 v24, v26
    v_permlane32_swap_b32 v25, v27
    v_permlane32_swap_b32 v28, v30
    v_permlane32_swap_b32 v29, v31
    v_permlane32_swap_b32 v32, v34
    v_permlane32_swap_b32 v33, v35
    s_nop 1
    v_add_f32 v37, v37, v40
    v_add_f32 v24, v24, v26
    v_add_f32 v25, v25, v27
    v_add_f32 v28, v28, v30
    v_add_f32 v29, v29, v31
    v_add_f32 v32, v32, v34
    v_add_f32 v33, v33, v35
    v_mov_b32 v40, v37
    s_nop 1
    v_permlane16_swap_b32 v37, v40
    v_permlane16_swap_b32 v24, v25
    v_permlane16_swap_b32 v28, v29
    v_permlane16_swap_b32 v32, v33
    s_nop 1
    v_add_f32 v49, v37, v40
    v_add_f32 v44, v24, v25
    v_add_f32 v45, v28, v29
    v_add_f32 v46, v32, v33
    v_mov_b32 v8, v44
    v_mov_b32 v9, v45
    v_mov_b32 v10, v46
    v_cndmask_b32 v11, v48, v49, s[66:67]
    s_cmp_eq_u32 s75, 1
    s_cbranch_scc1 L_dep
    s_cmp_lg_u32 s75, 0
    s_cbranch_scc1 L_guard
    s_lshr_b32 s82, s3, 5
    s_lshl_b32 s83, s79, 9
    s_add_u32 s83, s83, 1572864
    s_bfm_b64 exec, 32, 0
L_reg:
    buffer_load_dwordx2 v[12:13], v4, s[52:55], s83 offen sc0 sc1
    s_waitcnt vmcnt(0)
    v_cmp_ne_u32 vcc, s69, v13
    s_cmp_lg_u64 vcc, 0
    s_cbranch_scc1 L_reg
    v_cmp_eq_u32 s[86:87], s73, v12
    s_nop 1
    v_mov_b32 v14, s86
    v_mov_b32 v15, s87
    ds_write_b64 v2, v[14:15] offset:152
    s_waitcnt lgkmcnt(0)
    ds_write_b32 v2, v13 offset:140
    s_mov_b64 exec, -1
    s_branch L_dep
L_guard:
    s_sub_u32 s80, s95, 1
    s_add_u32 s81, s94, s76
L_guard2:
    v_mov_b32 v12, s69
    s_mov_b64 exec, s[86:87]
    buffer_load_dword v12, v20, s[52:55], s81 offen offset:1028 sc0 sc1
    s_mov_b64 exec, -1
    s_waitcnt vmcnt(0)
    v_cmp_eq_u32 vcc, s80, v12
    s_cmp_eq_u64 vcc, 0
    s_cbranch_scc1 L_guard2
L_dep:
    s_add_u32 s75, s75, 1
    s_add_u32 s95, s95, 1
    s_add_u32 s80, s77, s76
    v_mov_b32 v3, s95
    s_waitcnt lgkmcnt(0)
    buffer_store_dwordx4 v[8:11], v4, s[52:55], s80 offen
    s_mov_b64 exec, 1
    s_waitcnt vmcnt(0)
    buffer_store_dword v3, v2, s[52:55], s80 offen offset:1024
    s_mov_b64 exec, -1
    s_xor_b32 s76, s76, 0x80000
    v_add_u32 v21, 4096, v21
    v_add_u32 v19, 4, v19
    s_cmp_lt_u32 s75, s74
    s_cbranch_scc1 L_fl
    s_endpgm
L_ctl:
    v_lshlrev_b32 v1, 2, v0
    v_mov_b32 v2, 0
    ds_write_b32 v1, v2 offset:3328
    s_and_b32 s70, s2, 31
    s_lshl_b32 s70, s70, 2
    s_mov_b32 s71, 1
    v_mov_b32 v7, s2
    v_and_b32 v10, 15, v0
    v_lshrrev_b32 v8, 5, v7
    v_lshl_add_u32 v10, v8, 4, v10
    v_lshrrev_b32 v9, 4, v0
    v_lshl_add_u32 v10, v9, 7, v10
    s_lshl_b32 s82, s79, 3
    s_mov_b32 s80, 0xeff4fa00
    s_mov_b32 s81, 0xdbe0e5ea
    s_lshr_b64 s[80:81], s[80:81], s82
    s_sext_i32_i8 s80, s80
    s_mov_b32 exec_lo, 0x0
    s_mov_b32 exec_hi, 0x3ff
    v_add_u32 v10, s80, v10
    s_mov_b32 s80, 0xeff43d4c
    s_mov_b32 s81, 0xdbe0e5ea
    s_lshr_b64 s[80:81], s[80:81], s82
    s_sext_i32_i8 s80, s80
    s_mov_b32 exec_lo, 0x0
    s_mov_b32 exec_hi, 0x400
    v_add_u32 v10, s80, v10
    s_mov_b32 s80, 0x2c37424d
    s_mov_b32 s81, 0xb1621
    s_lshr_b64 s[80:81], s[80:81], s82
    s_sext_i32_i8 s80, s80
    s_mov_b32 exec_lo, 0x0
    s_mov_b32 exec_hi, 0xf800
    v_add_u32 v10, s80, v10
    s_mov_b64 exec, -1
    v_mul_u32_u24 v30, 1572864, v10
    v_and_b32 v9, 3, v7
    v_lshl_add_u32 v8, v10, 2, v9
    v_bfe_u32 v9, v7, 2, 3
    v_lshl_add_u32 v8, v8, 3, v9
    v_mul_u32_u24 v9, 384, v8
    v_lshlrev_b32 v8, 7, v8
    s_waitcnt lgkmcnt(0)
    s_mov_b32 s32, s10
    s_and_b32 s33, s11, 0xffff
    s_mov_b32 s34, 6291456
    s_mov_b32 s35, 0x00020000
    buffer_load_dword v10, v9, s[32:35], 0 offen offset:0
    buffer_load_dword v11, v9, s[32:35], 0 offen offset:128
    buffer_load_dword v12, v9, s[32:35], 0 offen offset:256
    s_mov_b32 s36, s12
    s_and_b32 s37, s13, 0xffff
    s_mov_b32 s38, 6291456
    s_mov_b32 s39, 0x00020000
    buffer_load_dword v13, v9, s[36:39], 0 offen offset:0
    buffer_load_dword v14, v9, s[36:39], 0 offen offset:128
    buffer_load_dword v15, v9, s[36:39], 0 offen offset:256
    s_mov_b32 s40, s14
    s_and_b32 s41, s15, 0xffff
    s_mov_b32 s42, 2097152
    s_mov_b32 s43, 0x00020000
    buffer_load_dword v16, v8, s[40:43], 0 offen offset:0
    s_mov_b32 s44, s16
    s_and_b32 s45, s17, 0xffff
    s_mov_b32 s46, 2097152
    s_mov_b32 s47, 0x00020000
    buffer_load_dword v17, v8, s[44:47], 0 offen offset:0
    s_barrier
    s_mov_b32 s60, s20
    s_and_b32 s61, s21, 0xffff
    s_mov_b32 s62, 256
    s_mov_b32 s63, 0x00020000
    s_mov_b32 s52, s22
    s_and_b32 s53, s23, 0xffff
    s_mov_b32 s54, 25165824
    s_mov_b32 s55, 0x00020000
    s_getreg_b32 s76, hwreg(HW_REG_XCC_ID)
    s_and_b32 s76, s76, 15
    s_lshr_b32 s70, s70, 1
    s_and_b32 s75, s2, 31
    s_cmp_eq_u32 s75, 0
    s_cselect_b32 s75, 32, s75
    s_mul_i32 s77, s75, 64
    v_lshlrev_b32 v1, 1, v0
    v_lshlrev_b32 v7, 7, v0
    s_mov_b32 s24, s6
    s_and_b32 s25, s7, 0xffff
    s_mov_b32 s26, 805306368
    s_mov_b32 s27, 0x00020000
    s_mov_b32 s28, s8
    s_and_b32 s29, s9, 0xffff
    s_mov_b32 s30, 805306368
    s_mov_b32 s31, 0x00020000
    s_and_b32 s88, s2, 31
    s_lshl_b32 s89, s88, 4
    s_sub_i32 s89, s89, 63
    s_mov_b32 s90, 1572800
L_c:
    ds_read_b32 v3, v2 offset:3328
    ds_read_b32 v4, v2 offset:144
    s_mov_b64 exec, 1
    s_waitcnt lgkmcnt(0)
    v_add_u32 v3, 1, v3
    buffer_store_short v3, v2, s[60:63], s70 offen offset:128
    s_branch L_x4
L_w4:
    s_branch L_walked
L_x4:
    s_bfm_b64 exec, 33, 0
    buffer_load_ushort v5, v1, s[60:63], 0 offen offset:128 sc1
    v_readfirstlane_b32 s72, v3
    v_readfirstlane_b32 s81, v4
    s_add_u32 s80, s71, s72
    s_mov_b32 s71, s72
    s_mov_b64 exec, 0xffffffff
    s_waitcnt vmcnt(0)
    v_cmp_ne_u32 vcc, 0, v5
    v_lshlrev_b32 v6, 1, v5
    v_readlane_b32 s86, v5, 32
    v_cmp_le_u32 s[82:83], s80, v6
    s_bcnt1_i32_b64 s73, vcc
    s_cmp_eq_u32 s86, 0
    s_cselect_b32 s86, 1024, s86
    s_bcnt1_i32_b64 s74, s[82:83]
    s_sub_i32 s86, s86, 1003
    s_mul_i32 s80, s73, s86
    s_lshl_b32 s74, s74, 5
    s_cmp_lt_i32 s74, s80
    s_cselect_b32 s86, 1, 0
    s_lshl_b32 s82, s73, 5
    s_add_u32 s74, s74, s82
    s_cmp_lt_i32 s74, s80
    s_cselect_b32 s86, 2, s86
    v_mov_b32 v6, s86
    ds_write_b32 v2, v6 offset:148
    s_cmp_lt_i32 s72, s89
    s_cbranch_scc1 L_ntp
    s_lshl_b64 exec, 1, s88
    s_cmp_ge_u32 s88, 64
    s_cbranch_scc1 L_tpv
    buffer_load_dword v31, v30, s[24:27], 0 offen
    buffer_load_dword v32, v30, s[24:27], s90 offen
    s_branch L_tpd
L_tpv:
    buffer_load_dword v31, v30, s[28:31], 0 offen
    buffer_load_dword v32, v30, s[28:31], s90 offen
L_tpd:
    s_add_u32 s88, s88, 32
    s_add_i32 s89, s89, 512
    s_cmp_ge_u32 s88, 128
    s_cselect_b32 s89, 0x7fffffff, s89
    s_mov_b64 exec, 0xffffffff
L_ntp:
    s_cmp_lt_u32 s72, s77
    s_cbranch_scc1 L_cn
    s_memrealtime s[84:85]
    s_add_u32 s77, s77, 2048
    s_lshl_b32 s86, s75, 11
    s_add_u32 s75, s75, 32
    s_cmp_lg_u32 s73, 32
    s_cbranch_scc1 L_cn
    v_add_u32_dpp v5, v5, v5 row_ror:8 row_mask:0xf bank_mask:0xf
    s_nop 1
    v_add_u32_dpp v5, v5, v5 row_ror:4 row_mask:0xf bank_mask:0xf
    s_nop 1
    v_add_u32_dpp v5, v5, v5 row_ror:2 row_mask:0xf bank_mask:0xf
    s_nop 1
    v_add_u32_dpp v5, v5, v5 row_ror:1 row_mask:0xf bank_mask:0xf
    s_nop 1
    v_readlane_b32 s74, v5, 0
    v_readlane_b32 s73, v5, 16
    s_add_u32 s86, s86, 3143680
    s_lshl_b32 s80, s76, 7
    s_add_u32 s80, s80, s86
    s_add_u32 s74, s74, s73
    s_lshl_b32 s74, s74, 2
    s_waitcnt lgkmcnt(0)
    s_mul_i32 s73, s84, 13
    s_sub_u32 s74, s74, s73
    v_mov_b32 v8, s74
    v_mov_b32 v9, s84
    s_mov_b64 exec, 1
    buffer_store_dwordx2 v[8:9], v2, s[52:55], s80 offen offset:2048 sc0 sc1
    s_mov_b64 exec, 0xffff
    buffer_load_dwordx2 v[10:11], v7, s[52:55], s86 offen sc0 sc1
    s_waitcnt vmcnt(0)
    v_sub_u32 v9, s84, v11
    v_cmp_gt_u32 vcc, 0x1000, v9
    v_sub_u32 v8, s74, v10
    s_bitset0_b32 vcc_lo, s76
    v_cndmask_b32 v8, 0, v8, vcc
    s_nop 1
    v_add_u32_dpp v8, v8, v8 row_ror:8 row_mask:0xf bank_mask:0xf
    s_nop 1
    v_add_u32_dpp v8, v8, v8 row_ror:4 row_mask:0xf bank_mask:0xf
    s_nop 1
    v_add_u32_dpp v8, v8, v8 row_ror:2 row_mask:0xf bank_mask:0xf
    s_nop 1
    v_add_u32_dpp v8, v8, v8 row_ror:1 row_mask:0xf bank_mask:0xf
    s_nop 1
    v_ashrrev_i32 v8, 9, v8
    v_max_i32 v8, -5, v8
    v_min_i32 v8, 40, v8
    v_add_u32 v8, 0x400, v8
    s_mov_b64 exec, 1
    buffer_store_short v8, v2, s[60:63], 0 offen offset:192
L_cn:
    s_cmp_eq_u32 s81, 0
    s_cbranch_scc1 L_c
    s_endpgm
.section .rodata,"a"
.p2align 6
.amdhsa_kernel standalone__kv_cache_quant_int4_int2_kv_with_per_channel_or_per_token_scales__decode_kernel
  .amdhsa_next_free_vgpr 246
  .amdhsa_next_free_sgpr 102
  .amdhsa_accum_offset 248
  .amdhsa_float_denorm_mode_32 3
  .amdhsa_group_segment_fixed_size 0
  .amdhsa_kernarg_size 80
  .amdhsa_user_sgpr_count 2
  .amdhsa_user_sgpr_kernarg_segment_ptr 1
  .amdhsa_system_sgpr_workgroup_id_x 1
.end_amdhsa_kernel
```

```asm
; @launch grid=(256,1,1) block=(256,1,1) lds=98304
.amdgcn_target "amdgcn-amd-amdhsa--gfx950"
.text
.globl standalone__kv_cache_quant_int4_int2_kv_with_per_channel_or_per_token_scales__decode_kernel
.p2align 12
.type standalone__kv_cache_quant_int4_int2_kv_with_per_channel_or_per_token_scales__decode_kernel,@function
standalone__kv_cache_quant_int4_int2_kv_with_per_channel_or_per_token_scales__decode_kernel:
    s_cmp_ge_u32 s2, 256
    s_cbranch_scc1 L_end
    s_load_dwordx16 s[4:19], s[0:1], 0
    s_load_dwordx4 s[20:23], s[0:1], 64
    s_and_b32 s80, s2, 7
    s_lshr_b32 s2, s2, 3
    s_lshl_b32 s80, s80, 5
    s_or_b32 s2, s2, s80
    s_mov_b32 s3, s2
    v_lshrrev_b32 v229, 6, v0
    v_and_b32 v0, 63, v0
    v_readfirstlane_b32 s68, v229
    s_lshr_b32 s79, s2, 5
    s_and_b32 s92, s2, 31
    s_mov_b32 s66, 0xaaaaaaaa
    s_mov_b32 s67, 0xaaaaaaaa
    s_cmp_eq_u32 s68, 1
    s_cbranch_scc1 L_service
    s_cmp_eq_u32 s68, 2
    s_cbranch_scc1 L_ticket
    s_cmp_eq_u32 s68, 3
    s_cbranch_scc1 L_ctl
    s_mov_b64 vcc, 0
    s_setprio 1
    v_and_b32 v235, 15, v0
    v_lshrrev_b32 v234, 4, v0
    v_mul_u32_u24 v1, 768, v234
    v_lshl_add_u32 v1, v235, 4, v1
    v_lshlrev_b32 v2, 3, v235
    v_bfrev_b32 v231, v235
    v_lshrrev_b32 v231, 28, v231
    v_and_b32 v232, 3, v231
    v_lshl_add_u32 v3, v232, 2, v234
    v_lshlrev_b32 v3, 1, v3
    v_lshrrev_b32 v231, 2, v231
    v_lshl_add_u32 v3, v231, 10, v3
    v_lshlrev_b32 v239, 2, v0
    v_add_u32 v240, 3840, v239
    v_add_u32 v239, 3584, v239
    v_lshlrev_b32 v241, 4, v0
    v_mov_b32 v242, 0
    v_mov_b32 v243, 1
    v_lshlrev_b32 v224, 2, v0
    v_mov_b32 v225, 1
    v_mov_b32 v226, 260
    s_mul_i32 s58, s79, 0
    s_and_b32 s94, s92, 448
    s_add_u32 s94, s94, s58
    s_add_u32 s94, s94, 512
    s_add_u32 s58, s58, s92
    s_and_b32 s58, s58, 511
    s_lshr_b32 s59, s3, 5
    s_lshl_b32 s69, s79, 9
    s_add_u32 s59, s59, 24
    s_lshl_b32 s59, s59, 9
    s_mov_b32 s64, 0xcccccccc
    s_mov_b32 s65, 0xcccccccc
    s_mov_b32 s60, 0x6fd53b95
    s_mov_b32 s62, 0x80000001
    s_mov_b32 s61, 0x6fd53b95
    s_mov_b32 s63, 0x80000001
    s_waitcnt lgkmcnt(0)
    s_mov_b32 s24, s6
    s_and_b32 s25, s7, 0xffff
    s_mov_b32 s26, 805306368
    s_mov_b32 s27, 0x00020000
    s_mov_b32 s48, s4
    s_and_b32 s49, s5, 0xffff
    s_mov_b32 s50, 12288
    s_mov_b32 s51, 0x00020000
    s_mov_b32 s32, s10
    s_and_b32 s33, s11, 0xffff
    s_mov_b32 s34, 6291456
    s_mov_b32 s35, 0x00020000
    s_mov_b32 s36, s12
    s_and_b32 s37, s13, 0xffff
    s_mov_b32 s38, 6291456
    s_mov_b32 s39, 0x00020000
    s_add_u32 s70, s69, s92
    s_mov_b32 s91, 1
    s_lshr_b32 s74, s70, 9
    s_mul_i32 s74, s74, 384
    buffer_load_dwordx2 v[192:193], v2, s[48:51], s74 offen offset:0
    buffer_load_dwordx2 v[194:195], v2, s[48:51], s74 offen offset:128
    buffer_load_dwordx2 v[196:197], v2, s[48:51], s74 offen offset:256
    s_and_b32 s80, s70, 31
    s_sub_u32 s72, s70, s80
    s_lshr_b32 s80, s80, 2
    s_add_u32 s72, s72, s80
    s_mul_i32 s72, s72, 384
    buffer_load_dwordx2 v[132:133], v2, s[32:35], s72 offen offset:0
    buffer_load_dwordx2 v[134:135], v2, s[32:35], s72 offen offset:128
    buffer_load_dwordx2 v[136:137], v2, s[32:35], s72 offen offset:256
    buffer_load_dwordx2 v[138:139], v2, s[36:39], s72 offen offset:0
    buffer_load_dwordx2 v[140:141], v2, s[36:39], s72 offen offset:128
    buffer_load_dwordx2 v[142:143], v2, s[36:39], s72 offen offset:256
    s_mul_i32 s71, s70, 49152
    s_and_b32 s80, s70, 31
    s_mul_i32 s80, s80, 36864
    s_sub_u32 s71, s71, s80
    buffer_load_dwordx4 v[4:7], v1, s[24:27], s71 offen offset:0 nt
    buffer_load_dwordx4 v[8:11], v1, s[24:27], s71 offen offset:256 nt
    buffer_load_dwordx4 v[12:15], v1, s[24:27], s71 offen offset:512 nt
    s_add_u32 s71, s71, 3072
    buffer_load_dwordx4 v[16:19], v1, s[24:27], s71 offen offset:0 nt
    s_add_u32 s72, s72, 3072
    buffer_load_dwordx2 v[156:157], v2, s[32:35], s72 offen offset:0
    buffer_load_dwordx2 v[158:159], v2, s[32:35], s72 offen offset:128
    buffer_load_dwordx2 v[160:161], v2, s[32:35], s72 offen offset:256
    buffer_load_dwordx2 v[162:163], v2, s[36:39], s72 offen offset:0
    buffer_load_dwordx2 v[164:165], v2, s[36:39], s72 offen offset:128
    buffer_load_dwordx2 v[166:167], v2, s[36:39], s72 offen offset:256
    buffer_load_dwordx4 v[20:23], v1, s[24:27], s71 offen offset:256 nt
    buffer_load_dwordx4 v[24:27], v1, s[24:27], s71 offen offset:512 nt
    s_add_u32 s71, s71, 3072
    buffer_load_dwordx4 v[28:31], v1, s[24:27], s71 offen offset:0 nt
    buffer_load_dwordx4 v[32:35], v1, s[24:27], s71 offen offset:256 nt
    buffer_load_dwordx4 v[36:39], v1, s[24:27], s71 offen offset:512 nt
    s_add_u32 s71, s71, 3072
    buffer_load_dwordx4 v[40:43], v1, s[24:27], s71 offen offset:0 nt
    buffer_load_dwordx4 v[44:47], v1, s[24:27], s71 offen offset:256 nt
    buffer_load_dwordx4 v[48:51], v1, s[24:27], s71 offen offset:512 nt
    s_add_u32 s71, s71, 384000
    buffer_load_dwordx4 v[52:55], v1, s[24:27], s71 offen offset:0 nt
    buffer_load_dwordx4 v[56:59], v1, s[24:27], s71 offen offset:256 nt
    buffer_load_dwordx4 v[60:63], v1, s[24:27], s71 offen offset:512 nt
    s_add_u32 s71, s71, 3072
    buffer_load_dwordx4 v[64:67], v1, s[24:27], s71 offen offset:0 nt
    s_add_u32 s72, s72, 3072
    buffer_load_dwordx2 v[168:169], v2, s[32:35], s72 offen offset:0
    buffer_load_dwordx2 v[170:171], v2, s[32:35], s72 offen offset:128
    buffer_load_dwordx2 v[172:173], v2, s[32:35], s72 offen offset:256
    buffer_load_dwordx2 v[174:175], v2, s[36:39], s72 offen offset:0
    buffer_load_dwordx2 v[176:177], v2, s[36:39], s72 offen offset:128
    buffer_load_dwordx2 v[178:179], v2, s[36:39], s72 offen offset:256
    buffer_load_dwordx4 v[68:71], v1, s[24:27], s71 offen offset:256 nt
    buffer_load_dwordx4 v[72:75], v1, s[24:27], s71 offen offset:512 nt
    s_add_u32 s71, s71, 3072
    buffer_load_dwordx4 v[76:79], v1, s[24:27], s71 offen offset:0 nt
    buffer_load_dwordx4 v[80:83], v1, s[24:27], s71 offen offset:256 nt
    buffer_load_dwordx4 v[84:87], v1, s[24:27], s71 offen offset:512 nt
    s_add_u32 s71, s71, 3072
    buffer_load_dwordx4 v[88:91], v1, s[24:27], s71 offen offset:0 nt
    buffer_load_dwordx4 v[92:95], v1, s[24:27], s71 offen offset:256 nt
    buffer_load_dwordx4 v[96:99], v1, s[24:27], s71 offen offset:512 nt
    s_mov_b32 s28, s8
    s_and_b32 s29, s9, 0xffff
    s_mov_b32 s30, 805306368
    s_mov_b32 s31, 0x00020000
    s_mov_b32 s40, s14
    s_and_b32 s41, s15, 0xffff
    s_mov_b32 s42, 2097152
    s_mov_b32 s43, 0x00020000
    s_mov_b32 s44, s16
    s_and_b32 s45, s17, 0xffff
    s_mov_b32 s46, 2097152
    s_mov_b32 s47, 0x00020000
    s_mov_b32 s52, s22
    s_and_b32 s53, s23, 0xffff
    s_mov_b32 s54, 25165824
    s_mov_b32 s55, 0x00020000
    v_mov_b32 v229, s2
    v_and_b32 v231, 15, v0
    v_lshrrev_b32 v230, 5, v229
    v_lshl_add_u32 v231, v230, 4, v231
    v_lshrrev_b32 v232, 4, v0
    v_lshl_add_u32 v231, v232, 7, v231
    s_lshl_b32 s82, s79, 3
    s_mov_b32 s80, 0xeff4fa00
    s_mov_b32 s81, 0xdbe0e5ea
    s_lshr_b64 s[80:81], s[80:81], s82
    s_sext_i32_i8 s80, s80
    s_mov_b32 exec_lo, 0x0
    s_mov_b32 exec_hi, 0x3ff
    v_add_u32 v231, s80, v231
    s_mov_b32 s80, 0xeff43d4c
    s_mov_b32 s81, 0xdbe0e5ea
    s_lshr_b64 s[80:81], s[80:81], s82
    s_sext_i32_i8 s80, s80
    s_mov_b32 exec_lo, 0x0
    s_mov_b32 exec_hi, 0x400
    v_add_u32 v231, s80, v231
    s_mov_b32 s80, 0x2c37424d
    s_mov_b32 s81, 0xb1621
    s_lshr_b64 s[80:81], s[80:81], s82
    s_sext_i32_i8 s80, s80
    s_mov_b32 exec_lo, 0x0
    s_mov_b32 exec_hi, 0xf800
    v_add_u32 v231, s80, v231
    s_mov_b64 exec, -1
    v_and_b32 v229, 31, v229
    v_lshl_add_u32 v245, v231, 5, v229
    s_mov_b32 s4, 0x10000
    s_mov_b32 s5, 0x10401
    s_cmp_eq_u32 s79, 1
    s_cselect_b32 s4, 0x10000, s4
    s_cselect_b32 s5, 0x14441, s5
    s_cmp_eq_u32 s79, 2
    s_cselect_b32 s4, 0x10000, s4
    s_cselect_b32 s5, 0x10801, s5
    s_cmp_eq_u32 s79, 3
    s_cselect_b32 s4, 0x10000, s4
    s_cselect_b32 s5, 0x10803, s5
    s_cmp_eq_u32 s79, 4
    s_cselect_b32 s4, 0x10000, s4
    s_cselect_b32 s5, 0x18841, s5
    s_cmp_eq_u32 s79, 5
    s_cselect_b32 s4, 0x10000, s4
    s_cselect_b32 s5, 0x10801, s5
    s_cmp_eq_u32 s79, 6
    s_cselect_b32 s4, 0x10000, s4
    s_cselect_b32 s5, 0x10801, s5
    s_cmp_eq_u32 s79, 7
    s_cselect_b32 s4, 0x10000, s4
    s_cselect_b32 s5, 0x10821, s5
    s_mov_b32 s7, 0xf149f2ca
    s_mov_b32 s77, 0xf149f2ca
    v_lshlrev_b32 v225, 4, v0
    v_mov_b32 v100, 0
    v_mov_b32 v101, 0
    v_mov_b32 v102, 0
    v_mov_b32 v103, 0
    s_lshl_b32 s78, s3, 11
    s_mov_b64 s[88:89], 0
    v_mov_b32 v216, 0xf149f2ca
    v_mov_b32 v217, 0
    v_mov_b32 v218, 0
    v_mov_b32 v204, 0
    v_mov_b32 v205, 0
    v_mov_b32 v206, 0
    v_mov_b32 v207, 0
    v_mov_b32 v208, 0
    v_mov_b32 v209, 0
    v_mov_b32 v210, 0
    v_mov_b32 v211, 0
    v_mov_b32 v212, 0
    v_mov_b32 v213, 0
    v_mov_b32 v214, 0
    v_mov_b32 v215, 0
    s_barrier
    s_waitcnt vmcnt(36)
    v_lshlrev_b32 v108, 16, v192
    v_and_b32 v109, 0xffff0000, v192
    v_pk_mul_f32 v[108:109], v[108:109], s[60:61]
    v_lshlrev_b32 v110, 16, v193
    v_and_b32 v111, 0xffff0000, v193
    v_pk_mul_f32 v[110:111], v[110:111], s[60:61]
    v_lshlrev_b32 v112, 16, v194
    v_and_b32 v113, 0xffff0000, v194
    v_pk_mul_f32 v[112:113], v[112:113], s[60:61]
    v_lshlrev_b32 v114, 16, v195
    v_and_b32 v115, 0xffff0000, v195
    v_pk_mul_f32 v[114:115], v[114:115], s[60:61]
    v_lshlrev_b32 v116, 16, v196
    v_and_b32 v117, 0xffff0000, v196
    v_pk_mul_f32 v[116:117], v[116:117], s[60:61]
    v_lshlrev_b32 v118, 16, v197
    v_and_b32 v119, 0xffff0000, v197
    v_pk_mul_f32 v[118:119], v[118:119], s[60:61]
    v_lshlrev_b32 v234, 16, v132
    v_and_b32 v235, 0xffff0000, v132
    v_pk_mul_f32 v[120:121], v[234:235], v[108:109]
    v_lshlrev_b32 v234, 16, v138
    v_and_b32 v235, 0xffff0000, v138
    v_pk_mul_f32 v[200:201], v[120:121], v[234:235]
    v_lshlrev_b32 v234, 16, v133
    v_and_b32 v235, 0xffff0000, v133
    v_pk_mul_f32 v[122:123], v[234:235], v[110:111]
    v_lshlrev_b32 v234, 16, v139
    v_and_b32 v235, 0xffff0000, v139
    v_pk_fma_f32 v[200:201], v[122:123], v[234:235], v[200:201]
    v_lshlrev_b32 v234, 16, v134
    v_and_b32 v235, 0xffff0000, v134
    v_pk_mul_f32 v[124:125], v[234:235], v[112:113]
    v_lshlrev_b32 v234, 16, v140
    v_and_b32 v235, 0xffff0000, v140
    v_pk_fma_f32 v[200:201], v[124:125], v[234:235], v[200:201]
    v_lshlrev_b32 v234, 16, v135
    v_and_b32 v235, 0xffff0000, v135
    v_pk_mul_f32 v[126:127], v[234:235], v[114:115]
    v_lshlrev_b32 v234, 16, v141
    v_and_b32 v235, 0xffff0000, v141
    v_pk_fma_f32 v[200:201], v[126:127], v[234:235], v[200:201]
    v_lshlrev_b32 v234, 16, v136
    v_and_b32 v235, 0xffff0000, v136
    v_pk_mul_f32 v[128:129], v[234:235], v[116:117]
    v_lshlrev_b32 v234, 16, v142
    v_and_b32 v235, 0xffff0000, v142
    v_pk_fma_f32 v[200:201], v[128:129], v[234:235], v[200:201]
    v_lshlrev_b32 v234, 16, v137
    v_and_b32 v235, 0xffff0000, v137
    v_pk_mul_f32 v[130:131], v[234:235], v[118:119]
    v_lshlrev_b32 v234, 16, v143
    v_and_b32 v235, 0xffff0000, v143
    v_pk_fma_f32 v[200:201], v[130:131], v[234:235], v[200:201]
    v_pk_mul_f32 v[200:201], v[200:201], s[62:63]
    s_mov_b32 s76, 63
L_loop0:
    s_waitcnt vmcnt(35)
    v_pk_fma_f32 v[198:199], v[120:121], v[4:5], v[200:201]
    v_pk_fma_f32 v[198:199], v[122:123], v[6:7], v[198:199]
    ds_read_b32 v244, v243 offset:147
    s_add_u32 s71, s71, 384000
    s_cbranch_vccnz L_th24_0
L_tb24_0:
    buffer_load_dwordx4 v[4:7], v1, s[24:27], s71 offen offset:0 nt
    v_add_f32_dpp v229, v228, v228 row_ror:8 row_mask:0xf bank_mask:0xc
    s_waitcnt vmcnt(35)
    v_pk_fma_f32 v[198:199], v[124:125], v[8:9], v[198:199]
    v_pk_fma_f32 v[198:199], v[126:127], v[10:11], v[198:199]
    buffer_load_dwordx4 v[8:11], v1, s[24:27], s71 offen offset:256 nt
    v_add_f32_dpp v230, v229, v229 row_shr:4 row_mask:0xf bank_mask:0xa
    s_waitcnt vmcnt(35)
    v_pk_fma_f32 v[198:199], v[128:129], v[12:13], v[198:199]
    v_pk_fma_f32 v[198:199], v[130:131], v[14:15], v[198:199]
    s_waitcnt lgkmcnt(0)
    v_cmp_lt_u32 vcc, v0, v244
    ds_add_u32 v224, v243 offset:3328
    buffer_load_dwordx4 v[12:15], v1, s[24:27], s71 offen offset:512 nt
    v_add_f32_dpp v232, v230, v230 quad_perm:[2,3,0,1] row_mask:0xf bank_mask:0xf
    v_add_f32 v228, v198, v199
    s_waitcnt vmcnt(35)
    v_pk_fma_f32 v[198:199], v[120:121], v[16:17], v[200:201]
    v_pk_fma_f32 v[198:199], v[122:123], v[18:19], v[198:199]
    s_add_u32 s71, s71, 3072
    s_cbranch_vccnz L_th27_0
L_tb27_0:
    buffer_load_dwordx4 v[16:19], v1, s[24:27], s71 offen offset:0 nt
    v_cndmask_b32 v232, v231, v232, s[64:65]
    v_add_f32_dpp v229, v228, v228 row_ror:8 row_mask:0xf bank_mask:0x3
    s_waitcnt vmcnt(29)
    v_pk_fma_f32 v[198:199], v[124:125], v[20:21], v[198:199]
    v_pk_fma_f32 v[198:199], v[126:127], v[22:23], v[198:199]
    s_add_u32 s72, s72, 3072
    buffer_load_dwordx2 v[180:181], v2, s[32:35], s72 offen offset:0
    buffer_load_dwordx2 v[182:183], v2, s[32:35], s72 offen offset:128
    buffer_load_dwordx2 v[184:185], v2, s[32:35], s72 offen offset:256
    buffer_load_dwordx2 v[186:187], v2, s[36:39], s72 offen offset:0
    buffer_load_dwordx2 v[188:189], v2, s[36:39], s72 offen offset:128
    buffer_load_dwordx2 v[190:191], v2, s[36:39], s72 offen offset:256
    buffer_load_dwordx4 v[20:23], v1, s[24:27], s71 offen offset:256 nt
    v_add_f32_dpp v231, v232, v232 quad_perm:[1,0,3,2] row_mask:0xf bank_mask:0xf
    v_lshlrev_b32 v234, 16, v156
    v_and_b32 v235, 0xffff0000, v156
    v_pk_mul_f32 v[144:145], v[234:235], v[108:109]
    v_lshlrev_b32 v234, 16, v162
    v_and_b32 v235, 0xffff0000, v162
    s_waitcnt vmcnt(35)
    v_pk_fma_f32 v[198:199], v[128:129], v[24:25], v[198:199]
    v_pk_fma_f32 v[198:199], v[130:131], v[26:27], v[198:199]
    ds_add_u32 v224, v243 offset:3328
    buffer_load_dwordx4 v[24:27], v1, s[24:27], s71 offen offset:512 nt
    v_cndmask_b32 v233, v233, v231, s[66:67]
    v_mul_f32 v233, 0x58000000, v233
    ds_write_b32 v239, v233
    v_add_u32 v239, 256, v239
    v_add_f32 v228, v198, v199
    v_pk_mul_f32 v[202:203], v[144:145], v[234:235]
    v_lshlrev_b32 v234, 16, v157
    v_and_b32 v235, 0xffff0000, v157
    v_pk_mul_f32 v[146:147], v[234:235], v[110:111]
    v_lshlrev_b32 v234, 16, v163
    s_waitcnt vmcnt(35)
    v_pk_fma_f32 v[198:199], v[120:121], v[28:29], v[200:201]
    v_pk_fma_f32 v[198:199], v[122:123], v[30:31], v[198:199]
    s_add_u32 s71, s71, 3072
    s_cbranch_vccnz L_th30_0
L_tb30_0:
    buffer_load_dwordx4 v[28:31], v1, s[24:27], s71 offen offset:0 nt
    v_add_f32_dpp v229, v228, v228 row_ror:8 row_mask:0xf bank_mask:0xc
    v_and_b32 v235, 0xffff0000, v163
    v_pk_fma_f32 v[202:203], v[146:147], v[234:235], v[202:203]
    v_lshlrev_b32 v234, 16, v158
    v_and_b32 v235, 0xffff0000, v158
    v_pk_mul_f32 v[148:149], v[234:235], v[112:113]
    s_waitcnt vmcnt(35)
    v_pk_fma_f32 v[198:199], v[124:125], v[32:33], v[198:199]
    v_pk_fma_f32 v[198:199], v[126:127], v[34:35], v[198:199]
    buffer_load_dwordx4 v[32:35], v1, s[24:27], s71 offen offset:256 nt
    v_add_f32_dpp v230, v229, v229 row_shl:4 row_mask:0xf bank_mask:0x5
    v_lshlrev_b32 v234, 16, v164
    v_and_b32 v235, 0xffff0000, v164
    v_pk_fma_f32 v[202:203], v[148:149], v[234:235], v[202:203]
    v_lshlrev_b32 v234, 16, v159
    v_and_b32 v235, 0xffff0000, v159
    s_waitcnt vmcnt(35)
    v_pk_fma_f32 v[198:199], v[128:129], v[36:37], v[198:199]
    v_pk_fma_f32 v[198:199], v[130:131], v[38:39], v[198:199]
    ds_add_u32 v224, v243 offset:3328
    buffer_load_dwordx4 v[36:39], v1, s[24:27], s71 offen offset:512 nt
    v_add_f32 v228, v198, v199
    v_pk_mul_f32 v[150:151], v[234:235], v[114:115]
    v_lshlrev_b32 v234, 16, v165
    v_and_b32 v235, 0xffff0000, v165
    v_pk_fma_f32 v[202:203], v[150:151], v[234:235], v[202:203]
    v_lshlrev_b32 v234, 16, v160
    s_waitcnt vmcnt(35)
    v_pk_fma_f32 v[198:199], v[120:121], v[40:41], v[200:201]
    v_pk_fma_f32 v[198:199], v[122:123], v[42:43], v[198:199]
    s_add_u32 s71, s71, 3072
    s_cbranch_vccnz L_th33_0
L_tb33_0:
    buffer_load_dwordx4 v[40:43], v1, s[24:27], s71 offen offset:0 nt
    v_add_f32_dpp v229, v228, v228 row_ror:8 row_mask:0xf bank_mask:0x3
    v_and_b32 v235, 0xffff0000, v160
    v_pk_mul_f32 v[152:153], v[234:235], v[116:117]
    v_lshlrev_b32 v234, 16, v166
    v_and_b32 v235, 0xffff0000, v166
    v_pk_fma_f32 v[202:203], v[152:153], v[234:235], v[202:203]
    s_waitcnt vmcnt(35)
    v_pk_fma_f32 v[198:199], v[124:125], v[44:45], v[198:199]
    v_pk_fma_f32 v[198:199], v[126:127], v[46:47], v[198:199]
    buffer_load_dwordx4 v[44:47], v1, s[24:27], s71 offen offset:256 nt
    v_lshlrev_b32 v234, 16, v161
    v_and_b32 v235, 0xffff0000, v161
    v_pk_mul_f32 v[154:155], v[234:235], v[118:119]
    v_lshlrev_b32 v234, 16, v167
    v_and_b32 v235, 0xffff0000, v167
    s_waitcnt vmcnt(35)
    v_pk_fma_f32 v[198:199], v[128:129], v[48:49], v[198:199]
    v_pk_fma_f32 v[198:199], v[130:131], v[50:51], v[198:199]
    ds_add_u32 v224, v243 offset:3328
    buffer_load_dwordx4 v[48:51], v1, s[24:27], s71 offen offset:512 nt
    v_add_f32 v228, v198, v199
    v_pk_fma_f32 v[202:203], v[154:155], v[234:235], v[202:203]
    v_pk_mul_f32 v[202:203], v[202:203], s[62:63]
    s_waitcnt vmcnt(35)
    v_pk_fma_f32 v[198:199], v[144:145], v[52:53], v[202:203]
    v_pk_fma_f32 v[198:199], v[146:147], v[54:55], v[198:199]
    ds_read_b32 v244, v243 offset:147
    v_readlane_b32 s70, v245, s91
    s_add_u32 s91, s91, 1
    s_lshr_b32 s74, s70, 9
    s_mul_i32 s74, s74, 384
    buffer_load_dwordx2 v[192:193], v2, s[48:51], s74 offen offset:0
    buffer_load_dwordx2 v[194:195], v2, s[48:51], s74 offen offset:128
    buffer_load_dwordx2 v[196:197], v2, s[48:51], s74 offen offset:256
    s_add_u32 s71, s71, 384000
    s_cbranch_vccnz L_th36_0
L_tb36_0:
    buffer_load_dwordx4 v[52:55], v1, s[24:27], s71 offen offset:0 nt
    v_add_f32_dpp v229, v228, v228 row_ror:8 row_mask:0xf bank_mask:0xc
    s_waitcnt vmcnt(38)
    v_pk_fma_f32 v[198:199], v[148:149], v[56:57], v[198:199]
    v_pk_fma_f32 v[198:199], v[150:151], v[58:59], v[198:199]
    buffer_load_dwordx4 v[56:59], v1, s[24:27], s71 offen offset:256 nt
    v_add_f32_dpp v230, v229, v229 row_shr:4 row_mask:0xf bank_mask:0xa
    s_waitcnt vmcnt(38)
    v_pk_fma_f32 v[198:199], v[152:153], v[60:61], v[198:199]
    v_pk_fma_f32 v[198:199], v[154:155], v[62:63], v[198:199]
    s_waitcnt lgkmcnt(0)
    v_cmp_lt_u32 vcc, v0, v244
    ds_add_u32 v224, v243 offset:3328
    buffer_load_dwordx4 v[60:63], v1, s[24:27], s71 offen offset:512 nt
    v_add_f32_dpp v231, v230, v230 quad_perm:[2,3,0,1] row_mask:0xf bank_mask:0xf
    v_add_f32 v228, v198, v199
    s_waitcnt vmcnt(38)
    v_pk_fma_f32 v[198:199], v[144:145], v[64:65], v[202:203]
    v_pk_fma_f32 v[198:199], v[146:147], v[66:67], v[198:199]
    s_add_u32 s71, s71, 3072
    s_cbranch_vccnz L_th39_0
L_tb39_0:
    buffer_load_dwordx4 v[64:67], v1, s[24:27], s71 offen offset:0 nt
    v_add_f32_dpp v229, v228, v228 row_ror:8 row_mask:0xf bank_mask:0x3
    s_waitcnt vmcnt(32)
    v_pk_fma_f32 v[198:199], v[148:149], v[68:69], v[198:199]
    v_pk_fma_f32 v[198:199], v[150:151], v[70:71], v[198:199]
    s_and_b32 s80, s70, 31
    s_sub_u32 s72, s70, s80
    s_lshr_b32 s80, s80, 2
    s_add_u32 s72, s72, s80
    s_mul_i32 s72, s72, 384
    buffer_load_dwordx2 v[132:133], v2, s[32:35], s72 offen offset:0
    buffer_load_dwordx2 v[134:135], v2, s[32:35], s72 offen offset:128
    buffer_load_dwordx2 v[136:137], v2, s[32:35], s72 offen offset:256
    buffer_load_dwordx2 v[138:139], v2, s[36:39], s72 offen offset:0
    buffer_load_dwordx2 v[140:141], v2, s[36:39], s72 offen offset:128
    buffer_load_dwordx2 v[142:143], v2, s[36:39], s72 offen offset:256
    buffer_load_dwordx4 v[68:71], v1, s[24:27], s71 offen offset:256 nt
    v_lshlrev_b32 v234, 16, v168
    v_and_b32 v235, 0xffff0000, v168
    v_pk_mul_f32 v[120:121], v[234:235], v[108:109]
    v_lshlrev_b32 v234, 16, v174
    v_and_b32 v235, 0xffff0000, v174
    s_waitcnt vmcnt(38)
    v_pk_fma_f32 v[198:199], v[152:153], v[72:73], v[198:199]
    v_pk_fma_f32 v[198:199], v[154:155], v[74:75], v[198:199]
    ds_add_u32 v224, v243 offset:3328
    buffer_load_dwordx4 v[72:75], v1, s[24:27], s71 offen offset:512 nt
    v_add_f32 v228, v198, v199
    v_pk_mul_f32 v[200:201], v[120:121], v[234:235]
    v_lshlrev_b32 v234, 16, v169
    v_and_b32 v235, 0xffff0000, v169
    v_pk_mul_f32 v[122:123], v[234:235], v[110:111]
    v_lshlrev_b32 v234, 16, v175
    s_waitcnt vmcnt(38)
    v_pk_fma_f32 v[198:199], v[144:145], v[76:77], v[202:203]
    v_pk_fma_f32 v[198:199], v[146:147], v[78:79], v[198:199]
    s_add_u32 s71, s71, 3072
    s_cbranch_vccnz L_th42_0
L_tb42_0:
    buffer_load_dwordx4 v[76:79], v1, s[24:27], s71 offen offset:0 nt
    v_add_f32_dpp v229, v228, v228 row_ror:8 row_mask:0xf bank_mask:0xc
    v_and_b32 v235, 0xffff0000, v175
    v_pk_fma_f32 v[200:201], v[122:123], v[234:235], v[200:201]
    v_lshlrev_b32 v234, 16, v170
    v_and_b32 v235, 0xffff0000, v170
    v_pk_mul_f32 v[124:125], v[234:235], v[112:113]
    s_waitcnt vmcnt(38)
    v_pk_fma_f32 v[198:199], v[148:149], v[80:81], v[198:199]
    v_pk_fma_f32 v[198:199], v[150:151], v[82:83], v[198:199]
    buffer_load_dwordx4 v[80:83], v1, s[24:27], s71 offen offset:256 nt
    v_add_f32_dpp v230, v229, v229 row_shl:4 row_mask:0xf bank_mask:0x5
    v_lshlrev_b32 v234, 16, v176
    v_and_b32 v235, 0xffff0000, v176
    v_pk_fma_f32 v[200:201], v[124:125], v[234:235], v[200:201]
    v_lshlrev_b32 v234, 16, v171
    v_and_b32 v235, 0xffff0000, v171
    s_waitcnt vmcnt(38)
    v_pk_fma_f32 v[198:199], v[152:153], v[84:85], v[198:199]
    v_pk_fma_f32 v[198:199], v[154:155], v[86:87], v[198:199]
    ds_add_u32 v224, v243 offset:3328
    buffer_load_dwordx4 v[84:87], v1, s[24:27], s71 offen offset:512 nt
    v_add_f32 v228, v198, v199
    v_pk_mul_f32 v[126:127], v[234:235], v[114:115]
    v_lshlrev_b32 v234, 16, v177
    v_and_b32 v235, 0xffff0000, v177
    v_pk_fma_f32 v[200:201], v[126:127], v[234:235], v[200:201]
    v_lshlrev_b32 v234, 16, v172
    s_waitcnt vmcnt(38)
    v_pk_fma_f32 v[198:199], v[144:145], v[88:89], v[202:203]
    v_pk_fma_f32 v[198:199], v[146:147], v[90:91], v[198:199]
    s_add_u32 s71, s71, 3072
    s_cbranch_vccnz L_th45_0
L_tb45_0:
    buffer_load_dwordx4 v[88:91], v1, s[24:27], s71 offen offset:0 nt
    v_add_f32_dpp v229, v228, v228 row_ror:8 row_mask:0xf bank_mask:0x3
    v_and_b32 v235, 0xffff0000, v172
    v_pk_mul_f32 v[128:129], v[234:235], v[116:117]
    v_lshlrev_b32 v234, 16, v178
    v_and_b32 v235, 0xffff0000, v178
    v_pk_fma_f32 v[200:201], v[128:129], v[234:235], v[200:201]
    s_waitcnt vmcnt(38)
    v_pk_fma_f32 v[198:199], v[148:149], v[92:93], v[198:199]
    v_pk_fma_f32 v[198:199], v[150:151], v[94:95], v[198:199]
    buffer_load_dwordx4 v[92:95], v1, s[24:27], s71 offen offset:256 nt
    v_lshlrev_b32 v234, 16, v173
    v_and_b32 v235, 0xffff0000, v173
    v_pk_mul_f32 v[130:131], v[234:235], v[118:119]
    v_lshlrev_b32 v234, 16, v179
    v_and_b32 v235, 0xffff0000, v179
    s_waitcnt vmcnt(38)
    v_pk_fma_f32 v[198:199], v[152:153], v[96:97], v[198:199]
    v_pk_fma_f32 v[198:199], v[154:155], v[98:99], v[198:199]
    ds_add_u32 v224, v243 offset:3328
    buffer_load_dwordx4 v[96:99], v1, s[24:27], s71 offen offset:512 nt
    v_add_f32 v228, v198, v199
    v_pk_fma_f32 v[200:201], v[130:131], v[234:235], v[200:201]
    v_pk_mul_f32 v[200:201], v[200:201], s[62:63]
    s_waitcnt vmcnt(38)
    v_pk_fma_f32 v[198:199], v[120:121], v[4:5], v[200:201]
    v_pk_fma_f32 v[198:199], v[122:123], v[6:7], v[198:199]
    ds_read_b32 v244, v243 offset:147
    s_mul_i32 s71, s70, 49152
    s_and_b32 s80, s70, 31
    s_mul_i32 s80, s80, 36864
    s_sub_u32 s71, s71, s80
    s_cbranch_vccnz L_th0_0
L_tb0_0:
    buffer_load_dwordx4 v[4:7], v1, s[24:27], s71 offen offset:0 nt
    v_add_f32_dpp v229, v228, v228 row_ror:8 row_mask:0xf bank_mask:0xc
    s_waitcnt vmcnt(38)
    v_pk_fma_f32 v[198:199], v[124:125], v[8:9], v[198:199]
    v_pk_fma_f32 v[198:199], v[126:127], v[10:11], v[198:199]
    buffer_load_dwordx4 v[8:11], v1, s[24:27], s71 offen offset:256 nt
    v_add_f32_dpp v230, v229, v229 row_shr:4 row_mask:0xf bank_mask:0xa
    s_waitcnt vmcnt(38)
    v_pk_fma_f32 v[198:199], v[128:129], v[12:13], v[198:199]
    v_pk_fma_f32 v[198:199], v[130:131], v[14:15], v[198:199]
    s_waitcnt lgkmcnt(0)
    v_cmp_lt_u32 vcc, v0, v244
    ds_add_u32 v224, v243 offset:3328
    buffer_load_dwordx4 v[12:15], v1, s[24:27], s71 offen offset:512 nt
    v_add_f32_dpp v232, v230, v230 quad_perm:[2,3,0,1] row_mask:0xf bank_mask:0xf
    v_add_f32 v228, v198, v199
    s_waitcnt vmcnt(38)
    v_pk_fma_f32 v[198:199], v[120:121], v[16:17], v[200:201]
    v_pk_fma_f32 v[198:199], v[122:123], v[18:19], v[198:199]
    s_add_u32 s71, s71, 3072
    s_cbranch_vccnz L_th3_0
L_tb3_0:
    buffer_load_dwordx4 v[16:19], v1, s[24:27], s71 offen offset:0 nt
    v_cndmask_b32 v232, v231, v232, s[64:65]
    v_add_f32_dpp v229, v228, v228 row_ror:8 row_mask:0xf bank_mask:0x3
    s_waitcnt vmcnt(32)
    v_pk_fma_f32 v[198:199], v[124:125], v[20:21], v[198:199]
    v_pk_fma_f32 v[198:199], v[126:127], v[22:23], v[198:199]
    s_add_u32 s72, s72, 3072
    buffer_load_dwordx2 v[156:157], v2, s[32:35], s72 offen offset:0
    buffer_load_dwordx2 v[158:159], v2, s[32:35], s72 offen offset:128
    buffer_load_dwordx2 v[160:161], v2, s[32:35], s72 offen offset:256
    buffer_load_dwordx2 v[162:163], v2, s[36:39], s72 offen offset:0
    buffer_load_dwordx2 v[164:165], v2, s[36:39], s72 offen offset:128
    buffer_load_dwordx2 v[166:167], v2, s[36:39], s72 offen offset:256
    buffer_load_dwordx4 v[20:23], v1, s[24:27], s71 offen offset:256 nt
    v_add_f32_dpp v233, v232, v232 quad_perm:[1,0,3,2] row_mask:0xf bank_mask:0xf
    v_lshlrev_b32 v234, 16, v180
    v_and_b32 v235, 0xffff0000, v180
    v_pk_mul_f32 v[144:145], v[234:235], v[108:109]
    v_lshlrev_b32 v234, 16, v186
    v_and_b32 v235, 0xffff0000, v186
    s_waitcnt vmcnt(38)
    v_pk_fma_f32 v[198:199], v[128:129], v[24:25], v[198:199]
    v_pk_fma_f32 v[198:199], v[130:131], v[26:27], v[198:199]
    ds_add_u32 v224, v243 offset:3328
    buffer_load_dwordx4 v[24:27], v1, s[24:27], s71 offen offset:512 nt
    v_add_f32 v228, v198, v199
    v_pk_mul_f32 v[202:203], v[144:145], v[234:235]
    v_lshlrev_b32 v234, 16, v181
    v_and_b32 v235, 0xffff0000, v181
    v_pk_mul_f32 v[146:147], v[234:235], v[110:111]
    v_lshlrev_b32 v234, 16, v187
    s_waitcnt vmcnt(38)
    v_pk_fma_f32 v[198:199], v[120:121], v[28:29], v[200:201]
    v_pk_fma_f32 v[198:199], v[122:123], v[30:31], v[198:199]
    s_add_u32 s71, s71, 3072
    s_cbranch_vccnz L_th6_0
L_tb6_0:
    buffer_load_dwordx4 v[28:31], v1, s[24:27], s71 offen offset:0 nt
    v_add_f32_dpp v229, v228, v228 row_ror:8 row_mask:0xf bank_mask:0xc
    v_and_b32 v235, 0xffff0000, v187
    v_pk_fma_f32 v[202:203], v[146:147], v[234:235], v[202:203]
    v_lshlrev_b32 v234, 16, v182
    v_and_b32 v235, 0xffff0000, v182
    s_branch L_x0
L_w0:
    s_branch L_w1
L_x0:
    v_pk_mul_f32 v[148:149], v[234:235], v[112:113]
    s_waitcnt vmcnt(38)
    v_pk_fma_f32 v[198:199], v[124:125], v[32:33], v[198:199]
    v_pk_fma_f32 v[198:199], v[126:127], v[34:35], v[198:199]
    buffer_load_dwordx4 v[32:35], v1, s[24:27], s71 offen offset:256 nt
    v_add_f32_dpp v230, v229, v229 row_shl:4 row_mask:0xf bank_mask:0x5
    v_lshlrev_b32 v234, 16, v188
    v_and_b32 v235, 0xffff0000, v188
    v_pk_fma_f32 v[202:203], v[148:149], v[234:235], v[202:203]
    v_lshlrev_b32 v234, 16, v183
    v_and_b32 v235, 0xffff0000, v183
    s_waitcnt vmcnt(38)
    v_pk_fma_f32 v[198:199], v[128:129], v[36:37], v[198:199]
    v_pk_fma_f32 v[198:199], v[130:131], v[38:39], v[198:199]
    ds_add_u32 v224, v243 offset:3328
    buffer_load_dwordx4 v[36:39], v1, s[24:27], s71 offen offset:512 nt
    v_add_f32 v228, v198, v199
    v_pk_mul_f32 v[150:151], v[234:235], v[114:115]
    v_lshlrev_b32 v234, 16, v189
    v_and_b32 v235, 0xffff0000, v189
    v_pk_fma_f32 v[202:203], v[150:151], v[234:235], v[202:203]
    v_lshlrev_b32 v234, 16, v184
    s_waitcnt vmcnt(38)
    v_pk_fma_f32 v[198:199], v[120:121], v[40:41], v[200:201]
    v_pk_fma_f32 v[198:199], v[122:123], v[42:43], v[198:199]
    s_add_u32 s71, s71, 3072
    s_cbranch_vccnz L_th9_0
L_tb9_0:
    buffer_load_dwordx4 v[40:43], v1, s[24:27], s71 offen offset:0 nt
    v_add_f32_dpp v229, v228, v228 row_ror:8 row_mask:0xf bank_mask:0x3
    v_and_b32 v235, 0xffff0000, v184
    v_pk_mul_f32 v[152:153], v[234:235], v[116:117]
    v_lshlrev_b32 v234, 16, v190
    v_and_b32 v235, 0xffff0000, v190
    v_pk_fma_f32 v[202:203], v[152:153], v[234:235], v[202:203]
    s_waitcnt vmcnt(38)
    v_pk_fma_f32 v[198:199], v[124:125], v[44:45], v[198:199]
    v_pk_fma_f32 v[198:199], v[126:127], v[46:47], v[198:199]
    buffer_load_dwordx4 v[44:47], v1, s[24:27], s71 offen offset:256 nt
    v_lshlrev_b32 v234, 16, v185
    v_and_b32 v235, 0xffff0000, v185
    v_pk_mul_f32 v[154:155], v[234:235], v[118:119]
    v_lshlrev_b32 v234, 16, v191
    v_and_b32 v235, 0xffff0000, v191
    s_waitcnt vmcnt(38)
    v_pk_fma_f32 v[198:199], v[128:129], v[48:49], v[198:199]
    v_pk_fma_f32 v[198:199], v[130:131], v[50:51], v[198:199]
    ds_add_u32 v224, v243 offset:3328
    buffer_load_dwordx4 v[48:51], v1, s[24:27], s71 offen offset:512 nt
    v_add_f32 v228, v198, v199
    v_pk_fma_f32 v[202:203], v[154:155], v[234:235], v[202:203]
    v_pk_mul_f32 v[202:203], v[202:203], s[62:63]
    s_waitcnt vmcnt(35)
    v_pk_fma_f32 v[198:199], v[144:145], v[52:53], v[202:203]
    v_pk_fma_f32 v[198:199], v[146:147], v[54:55], v[198:199]
    ds_read_b32 v244, v243 offset:147
    s_add_u32 s71, s71, 384000
    s_cbranch_vccnz L_th12_0
L_tb12_0:
    buffer_load_dwordx4 v[52:55], v1, s[24:27], s71 offen offset:0 nt
    v_add_f32_dpp v229, v228, v228 row_ror:8 row_mask:0xf bank_mask:0xc
    v_lshlrev_b32 v108, 16, v192
    v_and_b32 v109, 0xffff0000, v192
    v_pk_mul_f32 v[108:109], v[108:109], s[60:61]
    v_lshlrev_b32 v110, 16, v193
    v_and_b32 v111, 0xffff0000, v193
    s_waitcnt vmcnt(35)
    v_pk_fma_f32 v[198:199], v[148:149], v[56:57], v[198:199]
    v_pk_fma_f32 v[198:199], v[150:151], v[58:59], v[198:199]
    buffer_load_dwordx4 v[56:59], v1, s[24:27], s71 offen offset:256 nt
    v_add_f32_dpp v230, v229, v229 row_shr:4 row_mask:0xf bank_mask:0xa
    v_pk_mul_f32 v[110:111], v[110:111], s[60:61]
    v_lshlrev_b32 v112, 16, v194
    v_and_b32 v113, 0xffff0000, v194
    v_pk_mul_f32 v[112:113], v[112:113], s[60:61]
    v_lshlrev_b32 v114, 16, v195
    s_waitcnt vmcnt(35)
    v_pk_fma_f32 v[198:199], v[152:153], v[60:61], v[198:199]
    v_pk_fma_f32 v[198:199], v[154:155], v[62:63], v[198:199]
    s_waitcnt lgkmcnt(0)
    v_cmp_lt_u32 vcc, v0, v244
    ds_add_u32 v224, v243 offset:3328
    buffer_load_dwordx4 v[60:63], v1, s[24:27], s71 offen offset:512 nt
    v_add_f32_dpp v231, v230, v230 quad_perm:[2,3,0,1] row_mask:0xf bank_mask:0xf
    v_add_f32 v228, v198, v199
    v_and_b32 v115, 0xffff0000, v195
    v_pk_mul_f32 v[114:115], v[114:115], s[60:61]
    v_lshlrev_b32 v116, 16, v196
    v_and_b32 v117, 0xffff0000, v196
    v_pk_mul_f32 v[116:117], v[116:117], s[60:61]
    s_waitcnt vmcnt(35)
    v_pk_fma_f32 v[198:199], v[144:145], v[64:65], v[202:203]
    v_pk_fma_f32 v[198:199], v[146:147], v[66:67], v[198:199]
    s_add_u32 s71, s71, 3072
    s_cbranch_vccnz L_th15_0
L_tb15_0:
    buffer_load_dwordx4 v[64:67], v1, s[24:27], s71 offen offset:0 nt
    v_add_f32_dpp v229, v228, v228 row_ror:8 row_mask:0xf bank_mask:0x3
    v_lshlrev_b32 v118, 16, v197
    v_and_b32 v119, 0xffff0000, v197
    v_pk_mul_f32 v[118:119], v[118:119], s[60:61]
    s_waitcnt vmcnt(29)
    v_pk_fma_f32 v[198:199], v[148:149], v[68:69], v[198:199]
    v_pk_fma_f32 v[198:199], v[150:151], v[70:71], v[198:199]
    s_add_u32 s72, s72, 3072
    buffer_load_dwordx2 v[168:169], v2, s[32:35], s72 offen offset:0
    buffer_load_dwordx2 v[170:171], v2, s[32:35], s72 offen offset:128
    buffer_load_dwordx2 v[172:173], v2, s[32:35], s72 offen offset:256
    buffer_load_dwordx2 v[174:175], v2, s[36:39], s72 offen offset:0
    buffer_load_dwordx2 v[176:177], v2, s[36:39], s72 offen offset:128
    buffer_load_dwordx2 v[178:179], v2, s[36:39], s72 offen offset:256
    buffer_load_dwordx4 v[68:71], v1, s[24:27], s71 offen offset:256 nt
    v_lshlrev_b32 v234, 16, v132
    v_and_b32 v235, 0xffff0000, v132
    v_pk_mul_f32 v[120:121], v[234:235], v[108:109]
    v_lshlrev_b32 v234, 16, v138
    v_and_b32 v235, 0xffff0000, v138
    s_waitcnt vmcnt(35)
    v_pk_fma_f32 v[198:199], v[152:153], v[72:73], v[198:199]
    v_pk_fma_f32 v[198:199], v[154:155], v[74:75], v[198:199]
    ds_add_u32 v224, v243 offset:3328
    buffer_load_dwordx4 v[72:75], v1, s[24:27], s71 offen offset:512 nt
    v_add_f32 v228, v198, v199
    v_pk_mul_f32 v[200:201], v[120:121], v[234:235]
    v_lshlrev_b32 v234, 16, v133
    v_and_b32 v235, 0xffff0000, v133
    v_pk_mul_f32 v[122:123], v[234:235], v[110:111]
    v_lshlrev_b32 v234, 16, v139
    s_waitcnt vmcnt(35)
    v_pk_fma_f32 v[198:199], v[144:145], v[76:77], v[202:203]
    v_pk_fma_f32 v[198:199], v[146:147], v[78:79], v[198:199]
    s_add_u32 s71, s71, 3072
    s_cbranch_vccnz L_th18_0
L_tb18_0:
    buffer_load_dwordx4 v[76:79], v1, s[24:27], s71 offen offset:0 nt
    v_add_f32_dpp v229, v228, v228 row_ror:8 row_mask:0xf bank_mask:0xc
    v_and_b32 v235, 0xffff0000, v139
    v_pk_fma_f32 v[200:201], v[122:123], v[234:235], v[200:201]
    v_lshlrev_b32 v234, 16, v134
    v_and_b32 v235, 0xffff0000, v134
    v_pk_mul_f32 v[124:125], v[234:235], v[112:113]
    s_waitcnt vmcnt(35)
    v_pk_fma_f32 v[198:199], v[148:149], v[80:81], v[198:199]
    v_pk_fma_f32 v[198:199], v[150:151], v[82:83], v[198:199]
    buffer_load_dwordx4 v[80:83], v1, s[24:27], s71 offen offset:256 nt
    v_add_f32_dpp v230, v229, v229 row_shl:4 row_mask:0xf bank_mask:0x5
    v_lshlrev_b32 v234, 16, v140
    v_and_b32 v235, 0xffff0000, v140
    v_pk_fma_f32 v[200:201], v[124:125], v[234:235], v[200:201]
    v_lshlrev_b32 v234, 16, v135
    v_and_b32 v235, 0xffff0000, v135
    s_waitcnt vmcnt(35)
    v_pk_fma_f32 v[198:199], v[152:153], v[84:85], v[198:199]
    v_pk_fma_f32 v[198:199], v[154:155], v[86:87], v[198:199]
    ds_add_u32 v224, v243 offset:3328
    buffer_load_dwordx4 v[84:87], v1, s[24:27], s71 offen offset:512 nt
    v_add_f32 v228, v198, v199
    v_pk_mul_f32 v[126:127], v[234:235], v[114:115]
    v_lshlrev_b32 v234, 16, v141
    v_and_b32 v235, 0xffff0000, v141
    v_pk_fma_f32 v[200:201], v[126:127], v[234:235], v[200:201]
    v_lshlrev_b32 v234, 16, v136
    s_waitcnt vmcnt(35)
    v_pk_fma_f32 v[198:199], v[144:145], v[88:89], v[202:203]
    v_pk_fma_f32 v[198:199], v[146:147], v[90:91], v[198:199]
    s_add_u32 s71, s71, 3072
    s_cbranch_vccnz L_th21_0
L_tb21_0:
    buffer_load_dwordx4 v[88:91], v1, s[24:27], s71 offen offset:0 nt
    v_add_f32_dpp v229, v228, v228 row_ror:8 row_mask:0xf bank_mask:0x3
    v_and_b32 v235, 0xffff0000, v136
    v_pk_mul_f32 v[128:129], v[234:235], v[116:117]
    v_lshlrev_b32 v234, 16, v142
    v_and_b32 v235, 0xffff0000, v142
    v_pk_fma_f32 v[200:201], v[128:129], v[234:235], v[200:201]
    s_waitcnt vmcnt(35)
    v_pk_fma_f32 v[198:199], v[148:149], v[92:93], v[198:199]
    v_pk_fma_f32 v[198:199], v[150:151], v[94:95], v[198:199]
    buffer_load_dwordx4 v[92:95], v1, s[24:27], s71 offen offset:256 nt
    v_lshlrev_b32 v234, 16, v137
    v_and_b32 v235, 0xffff0000, v137
    v_pk_mul_f32 v[130:131], v[234:235], v[118:119]
    v_lshlrev_b32 v234, 16, v143
    v_and_b32 v235, 0xffff0000, v143
    s_waitcnt vmcnt(35)
    v_pk_fma_f32 v[198:199], v[152:153], v[96:97], v[198:199]
    v_pk_fma_f32 v[198:199], v[154:155], v[98:99], v[198:199]
    ds_add_u32 v224, v243 offset:3328
    buffer_load_dwordx4 v[96:99], v1, s[24:27], s71 offen offset:512 nt
    v_add_f32 v228, v198, v199
    v_pk_fma_f32 v[200:201], v[130:131], v[234:235], v[200:201]
    v_pk_mul_f32 v[200:201], v[200:201], s[62:63]
    s_sub_u32 s76, s76, 1
    s_cmp_lg_u32 s76, 0
    s_cbranch_scc1 L_loop0
    s_waitcnt vmcnt(35)
    v_pk_fma_f32 v[198:199], v[120:121], v[4:5], v[200:201]
    v_pk_fma_f32 v[198:199], v[122:123], v[6:7], v[198:199]
    ds_read_b32 v244, v243 offset:147
    s_add_u32 s71, s71, 384000
    s_cbranch_vccnz L_th24_1
L_tb24_1:
    buffer_load_dwordx4 v[4:7], v1, s[24:27], s71 offen offset:0 nt
    v_add_f32_dpp v229, v228, v228 row_ror:8 row_mask:0xf bank_mask:0xc
    s_waitcnt vmcnt(35)
    v_pk_fma_f32 v[198:199], v[124:125], v[8:9], v[198:199]
    v_pk_fma_f32 v[198:199], v[126:127], v[10:11], v[198:199]
    buffer_load_dwordx4 v[8:11], v1, s[24:27], s71 offen offset:256 nt
    v_add_f32_dpp v230, v229, v229 row_shr:4 row_mask:0xf bank_mask:0xa
    s_waitcnt vmcnt(35)
    v_pk_fma_f32 v[198:199], v[128:129], v[12:13], v[198:199]
    v_pk_fma_f32 v[198:199], v[130:131], v[14:15], v[198:199]
    s_waitcnt lgkmcnt(0)
    v_cmp_lt_u32 vcc, v0, v244
    ds_add_u32 v224, v243 offset:3328
    buffer_load_dwordx4 v[12:15], v1, s[24:27], s71 offen offset:512 nt
    v_add_f32_dpp v232, v230, v230 quad_perm:[2,3,0,1] row_mask:0xf bank_mask:0xf
    v_add_f32 v228, v198, v199
    s_waitcnt vmcnt(35)
    v_pk_fma_f32 v[198:199], v[120:121], v[16:17], v[200:201]
    v_pk_fma_f32 v[198:199], v[122:123], v[18:19], v[198:199]
    s_add_u32 s71, s71, 3072
    s_cbranch_vccnz L_th27_1
L_tb27_1:
    buffer_load_dwordx4 v[16:19], v1, s[24:27], s71 offen offset:0 nt
    v_cndmask_b32 v232, v231, v232, s[64:65]
    v_add_f32_dpp v229, v228, v228 row_ror:8 row_mask:0xf bank_mask:0x3
    s_waitcnt vmcnt(29)
    v_pk_fma_f32 v[198:199], v[124:125], v[20:21], v[198:199]
    v_pk_fma_f32 v[198:199], v[126:127], v[22:23], v[198:199]
    s_add_u32 s72, s72, 3072
    buffer_load_dwordx2 v[180:181], v2, s[32:35], s72 offen offset:0
    buffer_load_dwordx2 v[182:183], v2, s[32:35], s72 offen offset:128
    buffer_load_dwordx2 v[184:185], v2, s[32:35], s72 offen offset:256
    buffer_load_dwordx2 v[186:187], v2, s[36:39], s72 offen offset:0
    buffer_load_dwordx2 v[188:189], v2, s[36:39], s72 offen offset:128
    buffer_load_dwordx2 v[190:191], v2, s[36:39], s72 offen offset:256
    buffer_load_dwordx4 v[20:23], v1, s[24:27], s71 offen offset:256 nt
    v_add_f32_dpp v231, v232, v232 quad_perm:[1,0,3,2] row_mask:0xf bank_mask:0xf
    v_lshlrev_b32 v234, 16, v156
    v_and_b32 v235, 0xffff0000, v156
    v_pk_mul_f32 v[144:145], v[234:235], v[108:109]
    v_lshlrev_b32 v234, 16, v162
    v_and_b32 v235, 0xffff0000, v162
    s_waitcnt vmcnt(35)
    v_pk_fma_f32 v[198:199], v[128:129], v[24:25], v[198:199]
    v_pk_fma_f32 v[198:199], v[130:131], v[26:27], v[198:199]
    ds_add_u32 v224, v243 offset:3328
    buffer_load_dwordx4 v[24:27], v1, s[24:27], s71 offen offset:512 nt
    v_cndmask_b32 v233, v233, v231, s[66:67]
    v_mul_f32 v233, 0x58000000, v233
    ds_write_b32 v239, v233
    v_add_u32 v239, 256, v239
    v_add_f32 v228, v198, v199
    v_pk_mul_f32 v[202:203], v[144:145], v[234:235]
    v_lshlrev_b32 v234, 16, v157
    v_and_b32 v235, 0xffff0000, v157
    v_pk_mul_f32 v[146:147], v[234:235], v[110:111]
    v_lshlrev_b32 v234, 16, v163
    s_waitcnt vmcnt(35)
    v_pk_fma_f32 v[198:199], v[120:121], v[28:29], v[200:201]
    v_pk_fma_f32 v[198:199], v[122:123], v[30:31], v[198:199]
    s_add_u32 s71, s71, 3072
    s_cbranch_vccnz L_th30_1
L_tb30_1:
    buffer_load_dwordx4 v[28:31], v1, s[24:27], s71 offen offset:0 nt
    v_add_f32_dpp v229, v228, v228 row_ror:8 row_mask:0xf bank_mask:0xc
    v_and_b32 v235, 0xffff0000, v163
    v_pk_fma_f32 v[202:203], v[146:147], v[234:235], v[202:203]
    v_lshlrev_b32 v234, 16, v158
    v_and_b32 v235, 0xffff0000, v158
    v_pk_mul_f32 v[148:149], v[234:235], v[112:113]
    s_waitcnt vmcnt(35)
    v_pk_fma_f32 v[198:199], v[124:125], v[32:33], v[198:199]
    v_pk_fma_f32 v[198:199], v[126:127], v[34:35], v[198:199]
    buffer_load_dwordx4 v[32:35], v1, s[24:27], s71 offen offset:256 nt
    v_add_f32_dpp v230, v229, v229 row_shl:4 row_mask:0xf bank_mask:0x5
    v_lshlrev_b32 v234, 16, v164
    v_and_b32 v235, 0xffff0000, v164
    v_pk_fma_f32 v[202:203], v[148:149], v[234:235], v[202:203]
    v_lshlrev_b32 v234, 16, v159
    v_and_b32 v235, 0xffff0000, v159
    s_waitcnt vmcnt(35)
    v_pk_fma_f32 v[198:199], v[128:129], v[36:37], v[198:199]
    v_pk_fma_f32 v[198:199], v[130:131], v[38:39], v[198:199]
    ds_add_u32 v224, v243 offset:3328
    buffer_load_dwordx4 v[36:39], v1, s[24:27], s71 offen offset:512 nt
    v_add_f32 v228, v198, v199
    v_pk_mul_f32 v[150:151], v[234:235], v[114:115]
    v_lshlrev_b32 v234, 16, v165
    v_and_b32 v235, 0xffff0000, v165
    v_pk_fma_f32 v[202:203], v[150:151], v[234:235], v[202:203]
    v_lshlrev_b32 v234, 16, v160
    s_waitcnt vmcnt(35)
    v_pk_fma_f32 v[198:199], v[120:121], v[40:41], v[200:201]
    v_pk_fma_f32 v[198:199], v[122:123], v[42:43], v[198:199]
    s_add_u32 s71, s71, 3072
    s_cbranch_vccnz L_th33_1
L_tb33_1:
    buffer_load_dwordx4 v[40:43], v1, s[24:27], s71 offen offset:0 nt
    v_add_f32_dpp v229, v228, v228 row_ror:8 row_mask:0xf bank_mask:0x3
    v_and_b32 v235, 0xffff0000, v160
    v_pk_mul_f32 v[152:153], v[234:235], v[116:117]
    v_lshlrev_b32 v234, 16, v166
    v_and_b32 v235, 0xffff0000, v166
    v_pk_fma_f32 v[202:203], v[152:153], v[234:235], v[202:203]
    s_waitcnt vmcnt(35)
    v_pk_fma_f32 v[198:199], v[124:125], v[44:45], v[198:199]
    v_pk_fma_f32 v[198:199], v[126:127], v[46:47], v[198:199]
    buffer_load_dwordx4 v[44:47], v1, s[24:27], s71 offen offset:256 nt
    v_lshlrev_b32 v234, 16, v161
    v_and_b32 v235, 0xffff0000, v161
    v_pk_mul_f32 v[154:155], v[234:235], v[118:119]
    v_lshlrev_b32 v234, 16, v167
    v_and_b32 v235, 0xffff0000, v167
    s_waitcnt vmcnt(35)
    v_pk_fma_f32 v[198:199], v[128:129], v[48:49], v[198:199]
    v_pk_fma_f32 v[198:199], v[130:131], v[50:51], v[198:199]
    ds_add_u32 v224, v243 offset:3328
    buffer_load_dwordx4 v[48:51], v1, s[24:27], s71 offen offset:512 nt
    v_add_f32 v228, v198, v199
    v_pk_fma_f32 v[202:203], v[154:155], v[234:235], v[202:203]
    v_pk_mul_f32 v[202:203], v[202:203], s[62:63]
    s_waitcnt vmcnt(35)
    v_pk_fma_f32 v[198:199], v[144:145], v[52:53], v[202:203]
    v_pk_fma_f32 v[198:199], v[146:147], v[54:55], v[198:199]
    ds_read_b32 v244, v243 offset:147
    s_mov_b32 s91, 0
    v_readlane_b32 s70, v245, s91
    s_add_u32 s91, s91, 1
    s_and_b32 s80, s70, 31
    s_mul_i32 s80, s80, 96
    s_lshl_b32 s73, s70, 7
    s_sub_u32 s73, s73, s80
    buffer_load_ushort v220, v3, s[40:43], s73 offen
    buffer_load_ushort v221, v3, s[44:47], s73 offen
    s_add_u32 s71, s71, 384000
    s_cbranch_vccnz L_th36_1
L_tb36_1:
    buffer_load_dwordx4 v[52:55], v1, s[24:27], s71 offen offset:0 nt
    v_add_f32_dpp v229, v228, v228 row_ror:8 row_mask:0xf bank_mask:0xc
    s_waitcnt vmcnt(37)
    v_pk_fma_f32 v[198:199], v[148:149], v[56:57], v[198:199]
    v_pk_fma_f32 v[198:199], v[150:151], v[58:59], v[198:199]
    buffer_load_dwordx4 v[56:59], v1, s[24:27], s71 offen offset:256 nt
    v_add_f32_dpp v230, v229, v229 row_shr:4 row_mask:0xf bank_mask:0xa
    s_waitcnt vmcnt(37)
    v_pk_fma_f32 v[198:199], v[152:153], v[60:61], v[198:199]
    v_pk_fma_f32 v[198:199], v[154:155], v[62:63], v[198:199]
    s_waitcnt lgkmcnt(0)
    v_cmp_lt_u32 vcc, v0, v244
    ds_add_u32 v224, v243 offset:3328
    buffer_load_dwordx4 v[60:63], v1, s[24:27], s71 offen offset:512 nt
    v_add_f32_dpp v231, v230, v230 quad_perm:[2,3,0,1] row_mask:0xf bank_mask:0xf
    v_add_f32 v228, v198, v199
    s_waitcnt vmcnt(37)
    v_pk_fma_f32 v[198:199], v[144:145], v[64:65], v[202:203]
    v_pk_fma_f32 v[198:199], v[146:147], v[66:67], v[198:199]
    s_add_u32 s71, s71, 3072
    s_cbranch_vccnz L_th39_1
L_tb39_1:
    buffer_load_dwordx4 v[64:67], v1, s[24:27], s71 offen offset:0 nt
    v_add_f32_dpp v229, v228, v228 row_ror:8 row_mask:0xf bank_mask:0x3
    s_waitcnt vmcnt(31)
    v_pk_fma_f32 v[198:199], v[148:149], v[68:69], v[198:199]
    v_pk_fma_f32 v[198:199], v[150:151], v[70:71], v[198:199]
    buffer_load_dwordx4 v[68:71], v1, s[24:27], s71 offen offset:256 nt
    v_lshlrev_b32 v234, 16, v168
    v_and_b32 v235, 0xffff0000, v168
    v_pk_mul_f32 v[120:121], v[234:235], v[108:109]
    v_lshlrev_b32 v234, 16, v174
    v_and_b32 v235, 0xffff0000, v174
    s_waitcnt vmcnt(31)
    v_pk_fma_f32 v[198:199], v[152:153], v[72:73], v[198:199]
    v_pk_fma_f32 v[198:199], v[154:155], v[74:75], v[198:199]
    ds_add_u32 v224, v243 offset:3328
    buffer_load_dwordx4 v[72:75], v1, s[24:27], s71 offen offset:512 nt
    v_add_f32 v228, v198, v199
    v_pk_mul_f32 v[200:201], v[120:121], v[234:235]
    v_lshlrev_b32 v234, 16, v169
    v_and_b32 v235, 0xffff0000, v169
    v_pk_mul_f32 v[122:123], v[234:235], v[110:111]
    v_lshlrev_b32 v234, 16, v175
    s_waitcnt vmcnt(31)
    v_pk_fma_f32 v[198:199], v[144:145], v[76:77], v[202:203]
    v_pk_fma_f32 v[198:199], v[146:147], v[78:79], v[198:199]
    s_add_u32 s71, s71, 3072
    s_cbranch_vccnz L_th42_1
L_tb42_1:
    buffer_load_dwordx4 v[76:79], v1, s[24:27], s71 offen offset:0 nt
    v_add_f32_dpp v229, v228, v228 row_ror:8 row_mask:0xf bank_mask:0xc
    v_and_b32 v235, 0xffff0000, v175
    v_pk_fma_f32 v[200:201], v[122:123], v[234:235], v[200:201]
    v_lshlrev_b32 v234, 16, v170
    v_and_b32 v235, 0xffff0000, v170
    v_pk_mul_f32 v[124:125], v[234:235], v[112:113]
    s_waitcnt vmcnt(31)
    v_pk_fma_f32 v[198:199], v[148:149], v[80:81], v[198:199]
    v_pk_fma_f32 v[198:199], v[150:151], v[82:83], v[198:199]
    buffer_load_dwordx4 v[80:83], v1, s[24:27], s71 offen offset:256 nt
    v_add_f32_dpp v230, v229, v229 row_shl:4 row_mask:0xf bank_mask:0x5
    v_lshlrev_b32 v234, 16, v176
    v_and_b32 v235, 0xffff0000, v176
    v_pk_fma_f32 v[200:201], v[124:125], v[234:235], v[200:201]
    v_lshlrev_b32 v234, 16, v171
    v_and_b32 v235, 0xffff0000, v171
    s_waitcnt vmcnt(31)
    v_pk_fma_f32 v[198:199], v[152:153], v[84:85], v[198:199]
    v_pk_fma_f32 v[198:199], v[154:155], v[86:87], v[198:199]
    ds_add_u32 v224, v243 offset:3328
    buffer_load_dwordx4 v[84:87], v1, s[24:27], s71 offen offset:512 nt
    v_add_f32 v228, v198, v199
    v_pk_mul_f32 v[126:127], v[234:235], v[114:115]
    v_lshlrev_b32 v234, 16, v177
    v_and_b32 v235, 0xffff0000, v177
    v_pk_fma_f32 v[200:201], v[126:127], v[234:235], v[200:201]
    v_lshlrev_b32 v234, 16, v172
    s_waitcnt vmcnt(31)
    v_pk_fma_f32 v[198:199], v[144:145], v[88:89], v[202:203]
    v_pk_fma_f32 v[198:199], v[146:147], v[90:91], v[198:199]
    s_add_u32 s71, s71, 3072
    s_cbranch_vccnz L_th45_1
L_tb45_1:
    buffer_load_dwordx4 v[88:91], v1, s[24:27], s71 offen offset:0 nt
    v_add_f32_dpp v229, v228, v228 row_ror:8 row_mask:0xf bank_mask:0x3
    v_and_b32 v235, 0xffff0000, v172
    v_pk_mul_f32 v[128:129], v[234:235], v[116:117]
    v_lshlrev_b32 v234, 16, v178
    v_and_b32 v235, 0xffff0000, v178
    v_pk_fma_f32 v[200:201], v[128:129], v[234:235], v[200:201]
    s_waitcnt vmcnt(31)
    v_pk_fma_f32 v[198:199], v[148:149], v[92:93], v[198:199]
    v_pk_fma_f32 v[198:199], v[150:151], v[94:95], v[198:199]
    buffer_load_dwordx4 v[92:95], v1, s[24:27], s71 offen offset:256 nt
    v_lshlrev_b32 v234, 16, v173
    v_and_b32 v235, 0xffff0000, v173
    v_pk_mul_f32 v[130:131], v[234:235], v[118:119]
    v_lshlrev_b32 v234, 16, v179
    v_and_b32 v235, 0xffff0000, v179
    s_waitcnt vmcnt(31)
    v_pk_fma_f32 v[198:199], v[152:153], v[96:97], v[198:199]
    v_pk_fma_f32 v[198:199], v[154:155], v[98:99], v[198:199]
    ds_add_u32 v224, v243 offset:3328
    buffer_load_dwordx4 v[96:99], v1, s[24:27], s71 offen offset:512 nt
    v_add_f32 v228, v198, v199
    v_pk_fma_f32 v[200:201], v[130:131], v[234:235], v[200:201]
    v_pk_mul_f32 v[200:201], v[200:201], s[62:63]
    s_waitcnt vmcnt(31)
    v_pk_fma_f32 v[198:199], v[120:121], v[4:5], v[200:201]
    v_pk_fma_f32 v[198:199], v[122:123], v[6:7], v[198:199]
    ds_read_b32 v244, v243 offset:147
    s_mul_i32 s71, s70, 49152
    s_and_b32 s80, s70, 31
    s_mul_i32 s80, s80, 36864
    s_sub_u32 s71, s71, s80
    s_cbranch_vccnz L_th0_1
L_tb0_1:
    buffer_load_dwordx4 v[4:7], v1, s[28:31], s71 offen offset:0 nt
    v_add_f32_dpp v229, v228, v228 row_ror:8 row_mask:0xf bank_mask:0xc
    s_waitcnt vmcnt(31)
    v_pk_fma_f32 v[198:199], v[124:125], v[8:9], v[198:199]
    v_pk_fma_f32 v[198:199], v[126:127], v[10:11], v[198:199]
    buffer_load_dwordx4 v[8:11], v1, s[28:31], s71 offen offset:256 nt
    v_add_f32_dpp v230, v229, v229 row_shr:4 row_mask:0xf bank_mask:0xa
    s_waitcnt vmcnt(31)
    v_pk_fma_f32 v[198:199], v[128:129], v[12:13], v[198:199]
    v_pk_fma_f32 v[198:199], v[130:131], v[14:15], v[198:199]
    s_waitcnt lgkmcnt(0)
    v_cmp_lt_u32 vcc, v0, v244
    ds_add_u32 v224, v243 offset:3328
    buffer_load_dwordx4 v[12:15], v1, s[28:31], s71 offen offset:512 nt
    v_add_f32_dpp v232, v230, v230 quad_perm:[2,3,0,1] row_mask:0xf bank_mask:0xf
    v_add_f32 v228, v198, v199
    s_waitcnt vmcnt(31)
    v_pk_fma_f32 v[198:199], v[120:121], v[16:17], v[200:201]
    v_pk_fma_f32 v[198:199], v[122:123], v[18:19], v[198:199]
    s_add_u32 s71, s71, 3072
    s_cbranch_vccnz L_th3_1
L_tb3_1:
    buffer_load_dwordx4 v[16:19], v1, s[28:31], s71 offen offset:0 nt
    v_cndmask_b32 v232, v231, v232, s[64:65]
    v_add_f32_dpp v229, v228, v228 row_ror:8 row_mask:0xf bank_mask:0x3
    s_waitcnt vmcnt(25)
    v_pk_fma_f32 v[198:199], v[124:125], v[20:21], v[198:199]
    v_pk_fma_f32 v[198:199], v[126:127], v[22:23], v[198:199]
    buffer_load_dwordx4 v[20:23], v1, s[28:31], s71 offen offset:256 nt
    v_add_f32_dpp v233, v232, v232 quad_perm:[1,0,3,2] row_mask:0xf bank_mask:0xf
    v_lshlrev_b32 v234, 16, v180
    v_and_b32 v235, 0xffff0000, v180
    v_pk_mul_f32 v[144:145], v[234:235], v[108:109]
    v_lshlrev_b32 v234, 16, v186
    v_and_b32 v235, 0xffff0000, v186
    s_waitcnt vmcnt(25)
    v_pk_fma_f32 v[198:199], v[128:129], v[24:25], v[198:199]
    v_pk_fma_f32 v[198:199], v[130:131], v[26:27], v[198:199]
    ds_add_u32 v224, v243 offset:3328
    buffer_load_dwordx4 v[24:27], v1, s[28:31], s71 offen offset:512 nt
    v_add_f32 v228, v198, v199
    v_pk_mul_f32 v[202:203], v[144:145], v[234:235]
    v_lshlrev_b32 v234, 16, v181
    v_and_b32 v235, 0xffff0000, v181
    v_pk_mul_f32 v[146:147], v[234:235], v[110:111]
    v_lshlrev_b32 v234, 16, v187
    s_waitcnt vmcnt(25)
    v_pk_fma_f32 v[198:199], v[120:121], v[28:29], v[200:201]
    v_pk_fma_f32 v[198:199], v[122:123], v[30:31], v[198:199]
    s_add_u32 s71, s71, 3072
    s_cbranch_vccnz L_th6_1
L_tb6_1:
    buffer_load_dwordx4 v[28:31], v1, s[28:31], s71 offen offset:0 nt
    v_add_f32_dpp v229, v228, v228 row_ror:8 row_mask:0xf bank_mask:0xc
    v_and_b32 v235, 0xffff0000, v187
    v_pk_fma_f32 v[202:203], v[146:147], v[234:235], v[202:203]
    v_lshlrev_b32 v234, 16, v182
    v_and_b32 v235, 0xffff0000, v182
    v_pk_mul_f32 v[148:149], v[234:235], v[112:113]
    s_waitcnt vmcnt(25)
    v_pk_fma_f32 v[198:199], v[124:125], v[32:33], v[198:199]
    v_pk_fma_f32 v[198:199], v[126:127], v[34:35], v[198:199]
    buffer_load_dwordx4 v[32:35], v1, s[28:31], s71 offen offset:256 nt
    v_add_f32_dpp v230, v229, v229 row_shl:4 row_mask:0xf bank_mask:0x5
    v_lshlrev_b32 v234, 16, v188
    v_and_b32 v235, 0xffff0000, v188
    v_pk_fma_f32 v[202:203], v[148:149], v[234:235], v[202:203]
    v_lshlrev_b32 v234, 16, v183
    v_and_b32 v235, 0xffff0000, v183
    s_waitcnt vmcnt(25)
    v_pk_fma_f32 v[198:199], v[128:129], v[36:37], v[198:199]
    v_pk_fma_f32 v[198:199], v[130:131], v[38:39], v[198:199]
    ds_add_u32 v224, v243 offset:3328
    buffer_load_dwordx4 v[36:39], v1, s[28:31], s71 offen offset:512 nt
    v_add_f32 v228, v198, v199
    v_pk_mul_f32 v[150:151], v[234:235], v[114:115]
    v_lshlrev_b32 v234, 16, v189
    v_and_b32 v235, 0xffff0000, v189
    v_pk_fma_f32 v[202:203], v[150:151], v[234:235], v[202:203]
    v_lshlrev_b32 v234, 16, v184
    s_waitcnt vmcnt(25)
    v_pk_fma_f32 v[198:199], v[120:121], v[40:41], v[200:201]
    v_pk_fma_f32 v[198:199], v[122:123], v[42:43], v[198:199]
    s_add_u32 s71, s71, 3072
    s_cbranch_vccnz L_th9_1
L_tb9_1:
    buffer_load_dwordx4 v[40:43], v1, s[28:31], s71 offen offset:0 nt
    v_add_f32_dpp v229, v228, v228 row_ror:8 row_mask:0xf bank_mask:0x3
    v_and_b32 v235, 0xffff0000, v184
    v_pk_mul_f32 v[152:153], v[234:235], v[116:117]
    v_lshlrev_b32 v234, 16, v190
    v_and_b32 v235, 0xffff0000, v190
    v_pk_fma_f32 v[202:203], v[152:153], v[234:235], v[202:203]
    s_waitcnt vmcnt(25)
    v_pk_fma_f32 v[198:199], v[124:125], v[44:45], v[198:199]
    v_pk_fma_f32 v[198:199], v[126:127], v[46:47], v[198:199]
    buffer_load_dwordx4 v[44:47], v1, s[28:31], s71 offen offset:256 nt
    v_lshlrev_b32 v234, 16, v185
    v_and_b32 v235, 0xffff0000, v185
    v_pk_mul_f32 v[154:155], v[234:235], v[118:119]
    v_lshlrev_b32 v234, 16, v191
    v_and_b32 v235, 0xffff0000, v191
    s_waitcnt vmcnt(25)
    v_pk_fma_f32 v[198:199], v[128:129], v[48:49], v[198:199]
    v_pk_fma_f32 v[198:199], v[130:131], v[50:51], v[198:199]
    ds_add_u32 v224, v243 offset:3328
    buffer_load_dwordx4 v[48:51], v1, s[28:31], s71 offen offset:512 nt
    v_add_f32 v228, v198, v199
    v_pk_fma_f32 v[202:203], v[154:155], v[234:235], v[202:203]
    v_pk_mul_f32 v[202:203], v[202:203], s[62:63]
    s_waitcnt vmcnt(23)
    v_pk_fma_f32 v[198:199], v[144:145], v[52:53], v[202:203]
    v_pk_fma_f32 v[198:199], v[146:147], v[54:55], v[198:199]
    ds_read_b32 v244, v243 offset:147
    s_add_u32 s71, s71, 384000
    s_cbranch_vccnz L_th12_1
L_tb12_1:
    buffer_load_dwordx4 v[52:55], v1, s[28:31], s71 offen offset:0 nt
    v_add_f32_dpp v229, v228, v228 row_ror:8 row_mask:0xf bank_mask:0xc
    s_waitcnt vmcnt(23)
    v_pk_fma_f32 v[198:199], v[148:149], v[56:57], v[198:199]
    v_pk_fma_f32 v[198:199], v[150:151], v[58:59], v[198:199]
    buffer_load_dwordx4 v[56:59], v1, s[28:31], s71 offen offset:256 nt
    v_add_f32_dpp v230, v229, v229 row_shr:4 row_mask:0xf bank_mask:0xa
    s_waitcnt vmcnt(23)
    v_pk_fma_f32 v[198:199], v[152:153], v[60:61], v[198:199]
    v_pk_fma_f32 v[198:199], v[154:155], v[62:63], v[198:199]
    s_waitcnt lgkmcnt(0)
    v_cmp_lt_u32 vcc, v0, v244
    ds_add_u32 v224, v243 offset:3328
    buffer_load_dwordx4 v[60:63], v1, s[28:31], s71 offen offset:512 nt
    v_add_f32_dpp v231, v230, v230 quad_perm:[2,3,0,1] row_mask:0xf bank_mask:0xf
    v_add_f32 v228, v198, v199
    s_waitcnt vmcnt(23)
    v_pk_fma_f32 v[198:199], v[144:145], v[64:65], v[202:203]
    v_pk_fma_f32 v[198:199], v[146:147], v[66:67], v[198:199]
    s_add_u32 s71, s71, 3072
    s_cbranch_vccnz L_th15_1
L_tb15_1:
    buffer_load_dwordx4 v[64:67], v1, s[28:31], s71 offen offset:0 nt
    v_add_f32_dpp v229, v228, v228 row_ror:8 row_mask:0xf bank_mask:0x3
    s_waitcnt vmcnt(23)
    v_pk_fma_f32 v[198:199], v[148:149], v[68:69], v[198:199]
    v_pk_fma_f32 v[198:199], v[150:151], v[70:71], v[198:199]
    buffer_load_dwordx4 v[68:71], v1, s[28:31], s71 offen offset:256 nt
    s_waitcnt vmcnt(23)
    v_pk_fma_f32 v[198:199], v[152:153], v[72:73], v[198:199]
    v_pk_fma_f32 v[198:199], v[154:155], v[74:75], v[198:199]
    ds_add_u32 v224, v243 offset:3328
    buffer_load_dwordx4 v[72:75], v1, s[28:31], s71 offen offset:512 nt
    v_add_f32 v228, v198, v199
    s_waitcnt vmcnt(23)
    v_pk_fma_f32 v[198:199], v[144:145], v[76:77], v[202:203]
    v_pk_fma_f32 v[198:199], v[146:147], v[78:79], v[198:199]
    s_add_u32 s71, s71, 3072
    s_cbranch_vccnz L_th18_1
L_tb18_1:
    buffer_load_dwordx4 v[76:79], v1, s[28:31], s71 offen offset:0 nt
    v_add_f32_dpp v229, v228, v228 row_ror:8 row_mask:0xf bank_mask:0xc
    s_waitcnt vmcnt(23)
    v_pk_fma_f32 v[198:199], v[148:149], v[80:81], v[198:199]
    v_pk_fma_f32 v[198:199], v[150:151], v[82:83], v[198:199]
    buffer_load_dwordx4 v[80:83], v1, s[28:31], s71 offen offset:256 nt
    v_add_f32_dpp v230, v229, v229 row_shl:4 row_mask:0xf bank_mask:0x5
    s_waitcnt vmcnt(23)
    v_pk_fma_f32 v[198:199], v[152:153], v[84:85], v[198:199]
    s_branch L_x1
L_w1:
    s_branch L_w2
L_x1:
    v_pk_fma_f32 v[198:199], v[154:155], v[86:87], v[198:199]
    ds_add_u32 v224, v243 offset:3328
    buffer_load_dwordx4 v[84:87], v1, s[28:31], s71 offen offset:512 nt
    v_add_f32 v228, v198, v199
    s_waitcnt vmcnt(23)
    v_pk_fma_f32 v[198:199], v[144:145], v[88:89], v[202:203]
    v_pk_fma_f32 v[198:199], v[146:147], v[90:91], v[198:199]
    s_add_u32 s71, s71, 3072
    s_cbranch_vccnz L_th21_1
L_tb21_1:
    buffer_load_dwordx4 v[88:91], v1, s[28:31], s71 offen offset:0 nt
    v_add_f32_dpp v229, v228, v228 row_ror:8 row_mask:0xf bank_mask:0x3
    s_waitcnt vmcnt(23)
    v_pk_fma_f32 v[198:199], v[148:149], v[92:93], v[198:199]
    v_pk_fma_f32 v[198:199], v[150:151], v[94:95], v[198:199]
    buffer_load_dwordx4 v[92:95], v1, s[28:31], s71 offen offset:256 nt
    s_waitcnt vmcnt(23)
    v_pk_fma_f32 v[198:199], v[152:153], v[96:97], v[198:199]
    v_pk_fma_f32 v[198:199], v[154:155], v[98:99], v[198:199]
    ds_add_u32 v224, v243 offset:3328
    buffer_load_dwordx4 v[96:99], v1, s[28:31], s71 offen offset:512 nt
    v_add_f32 v228, v198, v199
    s_nop 1
    v_add_f32_dpp v229, v228, v228 row_ror:8 row_mask:0xf bank_mask:0xc
    s_nop 1
    v_add_f32_dpp v230, v229, v229 row_shr:4 row_mask:0xf bank_mask:0xa
    s_nop 1
    v_add_f32_dpp v232, v230, v230 quad_perm:[2,3,0,1] row_mask:0xf bank_mask:0xf
    s_nop 1
    v_cndmask_b32 v232, v231, v232, s[64:65]
    s_nop 1
    v_add_f32_dpp v231, v232, v232 quad_perm:[1,0,3,2] row_mask:0xf bank_mask:0xf
    s_nop 1
    v_cndmask_b32 v233, v233, v231, s[66:67]
    v_mul_f32 v233, 0x58000000, v233
    ds_write_b32 v239, v233
    v_add_u32 v239, 256, v239
    s_mov_b64 exec, 1
    ds_add_u32 v243, v243 offset:127
    s_mov_b64 exec, -1
    ds_read_b32 v223, v240
    v_add_u32 v240, 256, v240
    v_lshlrev_b32 v220, 16, v220
    v_lshlrev_b32 v221, 16, v221
    s_waitcnt lgkmcnt(0)
    v_max_f32_dpp v234, v223, v223 row_ror:8 row_mask:0xf bank_mask:0xf
    s_nop 1
    v_max_f32_dpp v234, v234, v234 row_ror:4 row_mask:0xf bank_mask:0xf
    s_nop 1
    v_max_f32_dpp v234, v234, v234 row_ror:2 row_mask:0xf bank_mask:0xf
    s_nop 1
    v_max_f32_dpp v234, v234, v234 row_ror:1 row_mask:0xf bank_mask:0xf
    v_mov_b32 v228, v216
    v_max3_f32 v234, v234, v228, s77
    v_sub_f32 v235, v228, v234
    v_sub_f32 v229, v223, v234
    v_exp_f32 v235, v235
    v_exp_f32 v229, v229
    s_nop 0
    v_mul_f32 v222, v229, v220
    v_mul_f32 v230, v222, v221
    v_mul_f32 v238, 0x71800000, v222
    s_nop 0
    s_mov_b32 s76, 63
L_loop1:
    v_mov_b32_dpp v236, v238 row_newbcast:0 row_mask:0xf bank_mask:0xf
    s_waitcnt vmcnt(23)
    v_pk_fma_f32 v[204:205], v[236:237], v[4:5], v[204:205] op_sel_hi:[0,1,1]
    v_pk_fma_f32 v[206:207], v[236:237], v[6:7], v[206:207] op_sel_hi:[0,1,1]
    s_nop 1
    ds_read_b32 v244, v243 offset:147
    s_add_u32 s71, s71, 384000
    s_cbranch_vccnz L_th24_2
L_tb24_2:
    buffer_load_dwordx4 v[4:7], v1, s[28:31], s71 offen offset:0 nt
    s_bitcmp0_b32 s4, 0
    s_cbranch_scc1 L_nofl2
    s_mov_b64 exec, 1
    ds_add_u32 v242, v243
    s_mov_b64 exec, -1
    v_add_u32 v241, 4096, v241
    v_add_u32 v242, 4, v242
L_nofl2:
    s_waitcnt vmcnt(23)
    v_pk_fma_f32 v[208:209], v[236:237], v[8:9], v[208:209] op_sel_hi:[0,1,1]
    v_pk_fma_f32 v[210:211], v[236:237], v[10:11], v[210:211] op_sel_hi:[0,1,1]
    s_nop 1
    buffer_load_dwordx4 v[8:11], v1, s[28:31], s71 offen offset:256 nt
    v_pk_mul_f32 v[212:213], v[212:213], v[234:235] op_sel:[0,1] op_sel_hi:[1,1]
    v_pk_mul_f32 v[214:215], v[214:215], v[234:235] op_sel:[0,1] op_sel_hi:[1,1]
    v_mov_b32 v216, v234
    s_waitcnt vmcnt(23)
    v_pk_fma_f32 v[212:213], v[236:237], v[12:13], v[212:213] op_sel_hi:[0,1,1]
    v_pk_fma_f32 v[214:215], v[236:237], v[14:15], v[214:215] op_sel_hi:[0,1,1]
    s_nop 1
    s_waitcnt lgkmcnt(0)
    v_cmp_lt_u32 vcc, v0, v244
    ds_add_u32 v224, v243 offset:3328
    buffer_load_dwordx4 v[12:15], v1, s[28:31], s71 offen offset:512 nt
    v_fma_f32 v217, v217, v235, v229
    v_mov_b32_dpp v236, v238 row_newbcast:8 row_mask:0xf bank_mask:0xf
    s_waitcnt vmcnt(23)
    v_pk_fma_f32 v[204:205], v[236:237], v[16:17], v[204:205] op_sel_hi:[0,1,1]
    v_pk_fma_f32 v[206:207], v[236:237], v[18:19], v[206:207] op_sel_hi:[0,1,1]
    s_nop 1
    s_add_u32 s71, s71, 3072
    s_cbranch_vccnz L_th27_2
L_tb27_2:
    buffer_load_dwordx4 v[16:19], v1, s[28:31], s71 offen offset:0 nt
    v_fma_f32 v218, v218, v235, v230
    s_waitcnt vmcnt(23)
    v_pk_fma_f32 v[208:209], v[236:237], v[20:21], v[208:209] op_sel_hi:[0,1,1]
    v_pk_fma_f32 v[210:211], v[236:237], v[22:23], v[210:211] op_sel_hi:[0,1,1]
    s_nop 1
    buffer_load_dwordx4 v[20:23], v1, s[28:31], s71 offen offset:256 nt
    ds_read_b32 v223, v240
    v_add_u32 v240, 256, v240
    s_waitcnt vmcnt(23)
    v_pk_fma_f32 v[212:213], v[236:237], v[24:25], v[212:213] op_sel_hi:[0,1,1]
    v_pk_fma_f32 v[214:215], v[236:237], v[26:27], v[214:215] op_sel_hi:[0,1,1]
    s_nop 1
    ds_add_u32 v224, v243 offset:3328
    buffer_load_dwordx4 v[24:27], v1, s[28:31], s71 offen offset:512 nt
    v_mov_b32_dpp v236, v238 row_newbcast:4 row_mask:0xf bank_mask:0xf
    s_waitcnt vmcnt(23)
    v_pk_fma_f32 v[204:205], v[236:237], v[28:29], v[204:205] op_sel_hi:[0,1,1]
    v_pk_fma_f32 v[206:207], v[236:237], v[30:31], v[206:207] op_sel_hi:[0,1,1]
    s_nop 1
    s_add_u32 s71, s71, 3072
    s_cbranch_vccnz L_th30_2
L_tb30_2:
    buffer_load_dwordx4 v[28:31], v1, s[28:31], s71 offen offset:0 nt
    ds_write_b128 v241, v[216:219] offset:23552
    s_waitcnt vmcnt(23)
    v_pk_fma_f32 v[208:209], v[236:237], v[32:33], v[208:209] op_sel_hi:[0,1,1]
    v_pk_fma_f32 v[210:211], v[236:237], v[34:35], v[210:211] op_sel_hi:[0,1,1]
    s_nop 1
    buffer_load_dwordx4 v[32:35], v1, s[28:31], s71 offen offset:256 nt
    s_waitcnt vmcnt(23)
    v_pk_fma_f32 v[212:213], v[236:237], v[36:37], v[212:213] op_sel_hi:[0,1,1]
    v_pk_fma_f32 v[214:215], v[236:237], v[38:39], v[214:215] op_sel_hi:[0,1,1]
    s_nop 1
    ds_add_u32 v224, v243 offset:3328
    buffer_load_dwordx4 v[36:39], v1, s[28:31], s71 offen offset:512 nt
    v_mov_b32_dpp v236, v238 row_newbcast:12 row_mask:0xf bank_mask:0xf
    s_waitcnt vmcnt(23)
    v_pk_fma_f32 v[204:205], v[236:237], v[40:41], v[204:205] op_sel_hi:[0,1,1]
    v_pk_fma_f32 v[206:207], v[236:237], v[42:43], v[206:207] op_sel_hi:[0,1,1]
    s_nop 1
    s_add_u32 s71, s71, 3072
    s_cbranch_vccnz L_th33_2
L_tb33_2:
    buffer_load_dwordx4 v[40:43], v1, s[28:31], s71 offen offset:0 nt
    s_waitcnt vmcnt(23)
    v_pk_fma_f32 v[208:209], v[236:237], v[44:45], v[208:209] op_sel_hi:[0,1,1]
    v_pk_fma_f32 v[210:211], v[236:237], v[46:47], v[210:211] op_sel_hi:[0,1,1]
    s_nop 1
    buffer_load_dwordx4 v[44:47], v1, s[28:31], s71 offen offset:256 nt
    s_waitcnt vmcnt(23)
    v_pk_fma_f32 v[212:213], v[236:237], v[48:49], v[212:213] op_sel_hi:[0,1,1]
    v_pk_fma_f32 v[214:215], v[236:237], v[50:51], v[214:215] op_sel_hi:[0,1,1]
    s_nop 1
    ds_add_u32 v224, v243 offset:3328
    buffer_load_dwordx4 v[48:51], v1, s[28:31], s71 offen offset:512 nt
    v_mov_b32_dpp v236, v238 row_newbcast:2 row_mask:0xf bank_mask:0xf
    s_waitcnt vmcnt(23)
    v_pk_fma_f32 v[204:205], v[236:237], v[52:53], v[204:205] op_sel_hi:[0,1,1]
    v_pk_fma_f32 v[206:207], v[236:237], v[54:55], v[206:207] op_sel_hi:[0,1,1]
    s_nop 1
    ds_read_b32 v244, v243 offset:147
    v_readlane_b32 s70, v245, s91
    s_add_u32 s91, s91, 1
    s_and_b32 s80, s70, 31
    s_mul_i32 s80, s80, 96
    s_lshl_b32 s73, s70, 7
    s_sub_u32 s73, s73, s80
    buffer_load_ushort v220, v3, s[40:43], s73 offen
    buffer_load_ushort v221, v3, s[44:47], s73 offen
    s_add_u32 s71, s71, 384000
    s_cbranch_vccnz L_th36_2
L_tb36_2:
    buffer_load_dwordx4 v[52:55], v1, s[28:31], s71 offen offset:0 nt
    s_waitcnt vmcnt(25)
    v_pk_fma_f32 v[208:209], v[236:237], v[56:57], v[208:209] op_sel_hi:[0,1,1]
    v_pk_fma_f32 v[210:211], v[236:237], v[58:59], v[210:211] op_sel_hi:[0,1,1]
    s_nop 1
    buffer_load_dwordx4 v[56:59], v1, s[28:31], s71 offen offset:256 nt
    s_waitcnt vmcnt(25)
    v_pk_fma_f32 v[212:213], v[236:237], v[60:61], v[212:213] op_sel_hi:[0,1,1]
    v_pk_fma_f32 v[214:215], v[236:237], v[62:63], v[214:215] op_sel_hi:[0,1,1]
    s_nop 1
    s_waitcnt lgkmcnt(0)
    v_cmp_lt_u32 vcc, v0, v244
    ds_add_u32 v224, v243 offset:3328
    buffer_load_dwordx4 v[60:63], v1, s[28:31], s71 offen offset:512 nt
    v_mov_b32_dpp v236, v238 row_newbcast:10 row_mask:0xf bank_mask:0xf
    s_waitcnt vmcnt(25)
    v_pk_fma_f32 v[204:205], v[236:237], v[64:65], v[204:205] op_sel_hi:[0,1,1]
    v_pk_fma_f32 v[206:207], v[236:237], v[66:67], v[206:207] op_sel_hi:[0,1,1]
    s_nop 1
    s_add_u32 s71, s71, 3072
    s_cbranch_vccnz L_th39_2
L_tb39_2:
    buffer_load_dwordx4 v[64:67], v1, s[28:31], s71 offen offset:0 nt
    s_waitcnt vmcnt(25)
    v_pk_fma_f32 v[208:209], v[236:237], v[68:69], v[208:209] op_sel_hi:[0,1,1]
    v_pk_fma_f32 v[210:211], v[236:237], v[70:71], v[210:211] op_sel_hi:[0,1,1]
    s_nop 1
    buffer_load_dwordx4 v[68:71], v1, s[28:31], s71 offen offset:256 nt
    s_waitcnt vmcnt(25)
    v_pk_fma_f32 v[212:213], v[236:237], v[72:73], v[212:213] op_sel_hi:[0,1,1]
    v_pk_fma_f32 v[214:215], v[236:237], v[74:75], v[214:215] op_sel_hi:[0,1,1]
    s_nop 1
    ds_add_u32 v224, v243 offset:3328
    buffer_load_dwordx4 v[72:75], v1, s[28:31], s71 offen offset:512 nt
    v_mov_b32_dpp v236, v238 row_newbcast:6 row_mask:0xf bank_mask:0xf
    s_waitcnt vmcnt(25)
    v_pk_fma_f32 v[204:205], v[236:237], v[76:77], v[204:205] op_sel_hi:[0,1,1]
    v_pk_fma_f32 v[206:207], v[236:237], v[78:79], v[206:207] op_sel_hi:[0,1,1]
    s_nop 1
    s_add_u32 s71, s71, 3072
    s_cbranch_vccnz L_th42_2
L_tb42_2:
    buffer_load_dwordx4 v[76:79], v1, s[28:31], s71 offen offset:0 nt
    s_waitcnt vmcnt(25)
    v_pk_fma_f32 v[208:209], v[236:237], v[80:81], v[208:209] op_sel_hi:[0,1,1]
    v_pk_fma_f32 v[210:211], v[236:237], v[82:83], v[210:211] op_sel_hi:[0,1,1]
    s_nop 1
    buffer_load_dwordx4 v[80:83], v1, s[28:31], s71 offen offset:256 nt
    s_waitcnt vmcnt(25)
    v_pk_fma_f32 v[212:213], v[236:237], v[84:85], v[212:213] op_sel_hi:[0,1,1]
    v_pk_fma_f32 v[214:215], v[236:237], v[86:87], v[214:215] op_sel_hi:[0,1,1]
    s_nop 1
    ds_add_u32 v224, v243 offset:3328
    buffer_load_dwordx4 v[84:87], v1, s[28:31], s71 offen offset:512 nt
    v_mov_b32_dpp v236, v238 row_newbcast:14 row_mask:0xf bank_mask:0xf
    s_waitcnt vmcnt(25)
    v_pk_fma_f32 v[204:205], v[236:237], v[88:89], v[204:205] op_sel_hi:[0,1,1]
    v_pk_fma_f32 v[206:207], v[236:237], v[90:91], v[206:207] op_sel_hi:[0,1,1]
    s_nop 1
    s_add_u32 s71, s71, 3072
    s_cbranch_vccnz L_th45_2
L_tb45_2:
    buffer_load_dwordx4 v[88:91], v1, s[28:31], s71 offen offset:0 nt
    s_waitcnt vmcnt(25)
    v_pk_fma_f32 v[208:209], v[236:237], v[92:93], v[208:209] op_sel_hi:[0,1,1]
    v_pk_fma_f32 v[210:211], v[236:237], v[94:95], v[210:211] op_sel_hi:[0,1,1]
    s_nop 1
    buffer_load_dwordx4 v[92:95], v1, s[28:31], s71 offen offset:256 nt
    s_cmp_eq_u32 s76, 16
    s_cbranch_scc1 L_getm2
L_gotm2:
    s_waitcnt vmcnt(25)
    v_pk_fma_f32 v[212:213], v[236:237], v[96:97], v[212:213] op_sel_hi:[0,1,1]
    v_pk_fma_f32 v[214:215], v[236:237], v[98:99], v[214:215] op_sel_hi:[0,1,1]
    s_nop 1
    ds_add_u32 v224, v243 offset:3328
    buffer_load_dwordx4 v[96:99], v1, s[28:31], s71 offen offset:512 nt
    v_mov_b32_dpp v236, v238 row_newbcast:1 row_mask:0xf bank_mask:0xf
    s_waitcnt vmcnt(25)
    v_pk_fma_f32 v[204:205], v[236:237], v[4:5], v[204:205] op_sel_hi:[0,1,1]
    v_pk_fma_f32 v[206:207], v[236:237], v[6:7], v[206:207] op_sel_hi:[0,1,1]
    s_nop 1
    ds_read_b32 v244, v243 offset:147
    s_mul_i32 s71, s70, 49152
    s_and_b32 s80, s70, 31
    s_mul_i32 s80, s80, 36864
    s_sub_u32 s71, s71, s80
    s_cbranch_vccnz L_th0_2
L_tb0_2:
    buffer_load_dwordx4 v[4:7], v1, s[28:31], s71 offen offset:0 nt
    s_waitcnt vmcnt(25)
    v_pk_fma_f32 v[208:209], v[236:237], v[8:9], v[208:209] op_sel_hi:[0,1,1]
    v_pk_fma_f32 v[210:211], v[236:237], v[10:11], v[210:211] op_sel_hi:[0,1,1]
    s_nop 1
    buffer_load_dwordx4 v[8:11], v1, s[28:31], s71 offen offset:256 nt
    s_waitcnt vmcnt(25)
    v_pk_fma_f32 v[212:213], v[236:237], v[12:13], v[212:213] op_sel_hi:[0,1,1]
    v_pk_fma_f32 v[214:215], v[236:237], v[14:15], v[214:215] op_sel_hi:[0,1,1]
    s_nop 1
    s_waitcnt lgkmcnt(0)
    v_cmp_lt_u32 vcc, v0, v244
    ds_add_u32 v224, v243 offset:3328
    buffer_load_dwordx4 v[12:15], v1, s[28:31], s71 offen offset:512 nt
    v_max_f32_dpp v234, v223, v223 row_ror:8 row_mask:0xf bank_mask:0xf
    v_mov_b32_dpp v236, v238 row_newbcast:9 row_mask:0xf bank_mask:0xf
    s_waitcnt vmcnt(25)
    v_pk_fma_f32 v[204:205], v[236:237], v[16:17], v[204:205] op_sel_hi:[0,1,1]
    v_pk_fma_f32 v[206:207], v[236:237], v[18:19], v[206:207] op_sel_hi:[0,1,1]
    s_nop 1
    s_add_u32 s71, s71, 3072
    s_cbranch_vccnz L_th3_2
L_tb3_2:
    buffer_load_dwordx4 v[16:19], v1, s[28:31], s71 offen offset:0 nt
    v_max_f32_dpp v234, v234, v234 row_ror:4 row_mask:0xf bank_mask:0xf
    s_waitcnt vmcnt(25)
    v_pk_fma_f32 v[208:209], v[236:237], v[20:21], v[208:209] op_sel_hi:[0,1,1]
    v_pk_fma_f32 v[210:211], v[236:237], v[22:23], v[210:211] op_sel_hi:[0,1,1]
    s_nop 1
    buffer_load_dwordx4 v[20:23], v1, s[28:31], s71 offen offset:256 nt
    v_max_f32_dpp v234, v234, v234 row_ror:2 row_mask:0xf bank_mask:0xf
    s_waitcnt vmcnt(25)
    v_pk_fma_f32 v[212:213], v[236:237], v[24:25], v[212:213] op_sel_hi:[0,1,1]
    v_pk_fma_f32 v[214:215], v[236:237], v[26:27], v[214:215] op_sel_hi:[0,1,1]
    s_nop 1
    ds_add_u32 v224, v243 offset:3328
    buffer_load_dwordx4 v[24:27], v1, s[28:31], s71 offen offset:512 nt
    v_max_f32_dpp v234, v234, v234 row_ror:1 row_mask:0xf bank_mask:0xf
    v_mov_b32_dpp v236, v238 row_newbcast:5 row_mask:0xf bank_mask:0xf
    s_waitcnt vmcnt(25)
    v_pk_fma_f32 v[204:205], v[236:237], v[28:29], v[204:205] op_sel_hi:[0,1,1]
    v_pk_fma_f32 v[206:207], v[236:237], v[30:31], v[206:207] op_sel_hi:[0,1,1]
    s_nop 1
    s_add_u32 s71, s71, 3072
    s_cbranch_vccnz L_th6_2
L_tb6_2:
    buffer_load_dwordx4 v[28:31], v1, s[28:31], s71 offen offset:0 nt
    s_lshr_b64 s[4:5], s[4:5], 1
    s_bitcmp1_b32 s4, 0
    s_cselect_b32 s6, s7, 0x7f7fffff
    v_min_f32 v228, s6, v216
    s_waitcnt vmcnt(25)
    v_pk_fma_f32 v[208:209], v[236:237], v[32:33], v[208:209] op_sel_hi:[0,1,1]
    v_pk_fma_f32 v[210:211], v[236:237], v[34:35], v[210:211] op_sel_hi:[0,1,1]
    s_nop 1
    buffer_load_dwordx4 v[32:35], v1, s[28:31], s71 offen offset:256 nt
    v_max3_f32 v234, v234, v228, s77
    s_waitcnt vmcnt(25)
    v_pk_fma_f32 v[212:213], v[236:237], v[36:37], v[212:213] op_sel_hi:[0,1,1]
    v_pk_fma_f32 v[214:215], v[236:237], v[38:39], v[214:215] op_sel_hi:[0,1,1]
    s_nop 1
    ds_add_u32 v224, v243 offset:3328
    buffer_load_dwordx4 v[36:39], v1, s[28:31], s71 offen offset:512 nt
    v_sub_f32 v235, v228, v234
    v_sub_f32 v229, v223, v234
    v_mov_b32_dpp v236, v238 row_newbcast:13 row_mask:0xf bank_mask:0xf
    s_waitcnt vmcnt(25)
    v_pk_fma_f32 v[204:205], v[236:237], v[40:41], v[204:205] op_sel_hi:[0,1,1]
    v_pk_fma_f32 v[206:207], v[236:237], v[42:43], v[206:207] op_sel_hi:[0,1,1]
    s_nop 1
    s_add_u32 s71, s71, 3072
    s_cbranch_vccnz L_th9_2
L_tb9_2:
    buffer_load_dwordx4 v[40:43], v1, s[28:31], s71 offen offset:0 nt
    v_exp_f32 v235, v235
    s_waitcnt vmcnt(25)
    v_pk_fma_f32 v[208:209], v[236:237], v[44:45], v[208:209] op_sel_hi:[0,1,1]
    v_pk_fma_f32 v[210:211], v[236:237], v[46:47], v[210:211] op_sel_hi:[0,1,1]
    s_nop 1
    buffer_load_dwordx4 v[44:47], v1, s[28:31], s71 offen offset:256 nt
    v_exp_f32 v229, v229
    s_waitcnt vmcnt(25)
    v_pk_fma_f32 v[212:213], v[236:237], v[48:49], v[212:213] op_sel_hi:[0,1,1]
    v_pk_fma_f32 v[214:215], v[236:237], v[50:51], v[214:215] op_sel_hi:[0,1,1]
    s_nop 1
    ds_add_u32 v224, v243 offset:3328
    buffer_load_dwordx4 v[48:51], v1, s[28:31], s71 offen offset:512 nt
    v_mov_b32_dpp v236, v238 row_newbcast:3 row_mask:0xf bank_mask:0xf
    s_waitcnt vmcnt(23)
    v_pk_fma_f32 v[204:205], v[236:237], v[52:53], v[204:205] op_sel_hi:[0,1,1]
    v_pk_fma_f32 v[206:207], v[236:237], v[54:55], v[206:207] op_sel_hi:[0,1,1]
    s_nop 1
    ds_read_b32 v244, v243 offset:147
    s_add_u32 s71, s71, 384000
    s_cbranch_vccnz L_th12_2
L_tb12_2:
    buffer_load_dwordx4 v[52:55], v1, s[28:31], s71 offen offset:0 nt
    v_lshlrev_b32 v220, 16, v220
    s_waitcnt vmcnt(23)
    v_pk_fma_f32 v[208:209], v[236:237], v[56:57], v[208:209] op_sel_hi:[0,1,1]
    v_pk_fma_f32 v[210:211], v[236:237], v[58:59], v[210:211] op_sel_hi:[0,1,1]
    s_nop 1
    buffer_load_dwordx4 v[56:59], v1, s[28:31], s71 offen offset:256 nt
    v_lshlrev_b32 v221, 16, v221
    s_waitcnt vmcnt(23)
    v_pk_fma_f32 v[212:213], v[236:237], v[60:61], v[212:213] op_sel_hi:[0,1,1]
    v_pk_fma_f32 v[214:215], v[236:237], v[62:63], v[214:215] op_sel_hi:[0,1,1]
    s_nop 1
    s_waitcnt lgkmcnt(0)
    v_cmp_lt_u32 vcc, v0, v244
    ds_add_u32 v224, v243 offset:3328
    buffer_load_dwordx4 v[60:63], v1, s[28:31], s71 offen offset:512 nt
    v_mov_b32_dpp v236, v238 row_newbcast:11 row_mask:0xf bank_mask:0xf
    s_waitcnt vmcnt(23)
    v_pk_fma_f32 v[204:205], v[236:237], v[64:65], v[204:205] op_sel_hi:[0,1,1]
    v_pk_fma_f32 v[206:207], v[236:237], v[66:67], v[206:207] op_sel_hi:[0,1,1]
    s_nop 1
    s_add_u32 s71, s71, 3072
    s_cbranch_vccnz L_th15_2
L_tb15_2:
    buffer_load_dwordx4 v[64:67], v1, s[28:31], s71 offen offset:0 nt
    v_mul_f32 v222, v229, v220
    s_waitcnt vmcnt(23)
    v_pk_fma_f32 v[208:209], v[236:237], v[68:69], v[208:209] op_sel_hi:[0,1,1]
    v_pk_fma_f32 v[210:211], v[236:237], v[70:71], v[210:211] op_sel_hi:[0,1,1]
    s_nop 1
    buffer_load_dwordx4 v[68:71], v1, s[28:31], s71 offen offset:256 nt
    v_mul_f32 v230, v222, v221
    s_waitcnt vmcnt(23)
    v_pk_fma_f32 v[212:213], v[236:237], v[72:73], v[212:213] op_sel_hi:[0,1,1]
    v_pk_fma_f32 v[214:215], v[236:237], v[74:75], v[214:215] op_sel_hi:[0,1,1]
    s_nop 1
    ds_add_u32 v224, v243 offset:3328
    buffer_load_dwordx4 v[72:75], v1, s[28:31], s71 offen offset:512 nt
    v_mov_b32_dpp v236, v238 row_newbcast:7 row_mask:0xf bank_mask:0xf
    s_waitcnt vmcnt(23)
    v_pk_fma_f32 v[204:205], v[236:237], v[76:77], v[204:205] op_sel_hi:[0,1,1]
    v_pk_fma_f32 v[206:207], v[236:237], v[78:79], v[206:207] op_sel_hi:[0,1,1]
    s_nop 1
    s_add_u32 s71, s71, 3072
    s_cbranch_vccnz L_th18_2
L_tb18_2:
    buffer_load_dwordx4 v[76:79], v1, s[28:31], s71 offen offset:0 nt
    s_waitcnt vmcnt(23)
    v_pk_fma_f32 v[208:209], v[236:237], v[80:81], v[208:209] op_sel_hi:[0,1,1]
    v_pk_fma_f32 v[210:211], v[236:237], v[82:83], v[210:211] op_sel_hi:[0,1,1]
    s_nop 1
    buffer_load_dwordx4 v[80:83], v1, s[28:31], s71 offen offset:256 nt
    s_waitcnt vmcnt(23)
    v_pk_fma_f32 v[212:213], v[236:237], v[84:85], v[212:213] op_sel_hi:[0,1,1]
    v_pk_fma_f32 v[214:215], v[236:237], v[86:87], v[214:215] op_sel_hi:[0,1,1]
    s_nop 1
    ds_add_u32 v224, v243 offset:3328
    buffer_load_dwordx4 v[84:87], v1, s[28:31], s71 offen offset:512 nt
    v_mov_b32_dpp v236, v238 row_newbcast:15 row_mask:0xf bank_mask:0xf
    s_waitcnt vmcnt(23)
    v_pk_fma_f32 v[204:205], v[236:237], v[88:89], v[204:205] op_sel_hi:[0,1,1]
    v_pk_fma_f32 v[206:207], v[236:237], v[90:91], v[206:207] op_sel_hi:[0,1,1]
    s_nop 1
    s_add_u32 s71, s71, 3072
    s_cbranch_vccnz L_th21_2
L_tb21_2:
    buffer_load_dwordx4 v[88:91], v1, s[28:31], s71 offen offset:0 nt
    ds_write_b128 v241, v[204:207] offset:20480
    v_mul_f32 v238, 0x71800000, v222
    s_waitcnt vmcnt(23)
    v_pk_fma_f32 v[208:209], v[236:237], v[92:93], v[208:209] op_sel_hi:[0,1,1]
    v_pk_fma_f32 v[210:211], v[236:237], v[94:95], v[210:211] op_sel_hi:[0,1,1]
    s_nop 1
    buffer_load_dwordx4 v[92:95], v1, s[28:31], s71 offen offset:256 nt
    ds_write_b128 v241, v[208:211] offset:21504
    v_pk_mul_f32 v[204:205], v[204:205], v[234:235] op_sel:[0,1] op_sel_hi:[1,1]
    v_pk_mul_f32 v[206:207], v[206:207], v[234:235] op_sel:[0,1] op_sel_hi:[1,1]
    s_waitcnt vmcnt(23)
    v_pk_fma_f32 v[212:213], v[236:237], v[96:97], v[212:213] op_sel_hi:[0,1,1]
    v_pk_fma_f32 v[214:215], v[236:237], v[98:99], v[214:215] op_sel_hi:[0,1,1]
    s_nop 1
    ds_add_u32 v224, v243 offset:3328
    buffer_load_dwordx4 v[96:99], v1, s[28:31], s71 offen offset:512 nt
    ds_write_b128 v241, v[212:215] offset:22528
    v_pk_mul_f32 v[208:209], v[208:209], v[234:235] op_sel:[0,1] op_sel_hi:[1,1]
    v_pk_mul_f32 v[210:211], v[210:211], v[234:235] op_sel:[0,1] op_sel_hi:[1,1]
    s_sub_u32 s76, s76, 1
    s_cmp_lg_u32 s76, 0
    s_cbranch_scc1 L_loop1
    v_mov_b32_dpp v236, v238 row_newbcast:0 row_mask:0xf bank_mask:0xf
    s_waitcnt vmcnt(23)
    v_pk_fma_f32 v[204:205], v[236:237], v[4:5], v[204:205] op_sel_hi:[0,1,1]
    v_pk_fma_f32 v[206:207], v[236:237], v[6:7], v[206:207] op_sel_hi:[0,1,1]
    s_nop 1
    ds_read_b32 v244, v243 offset:147
    s_add_u32 s71, s71, 384000
    s_cbranch_vccnz L_th24_3
L_tb24_3:
    buffer_load_dwordx4 v[4:7], v1, s[28:31], s71 offen offset:0 nt
    s_bitcmp0_b32 s4, 0
    s_cbranch_scc1 L_nofl3
    s_mov_b64 exec, 1
    ds_add_u32 v242, v243
    s_mov_b64 exec, -1
    v_add_u32 v241, 4096, v241
    v_add_u32 v242, 4, v242
L_nofl3:
    s_waitcnt vmcnt(23)
    v_pk_fma_f32 v[208:209], v[236:237], v[8:9], v[208:209] op_sel_hi:[0,1,1]
    v_pk_fma_f32 v[210:211], v[236:237], v[10:11], v[210:211] op_sel_hi:[0,1,1]
    s_nop 1
    buffer_load_dwordx4 v[8:11], v1, s[28:31], s71 offen offset:256 nt
    v_pk_mul_f32 v[212:213], v[212:213], v[234:235] op_sel:[0,1] op_sel_hi:[1,1]
    v_pk_mul_f32 v[214:215], v[214:215], v[234:235] op_sel:[0,1] op_sel_hi:[1,1]
    v_mov_b32 v216, v234
    s_waitcnt vmcnt(23)
    v_pk_fma_f32 v[212:213], v[236:237], v[12:13], v[212:213] op_sel_hi:[0,1,1]
    v_pk_fma_f32 v[214:215], v[236:237], v[14:15], v[214:215] op_sel_hi:[0,1,1]
    s_nop 1
    s_waitcnt lgkmcnt(0)
    v_cmp_lt_u32 vcc, v0, v244
    ds_add_u32 v224, v243 offset:3328
    buffer_load_dwordx4 v[12:15], v1, s[28:31], s71 offen offset:512 nt
    v_fma_f32 v217, v217, v235, v229
    v_mov_b32_dpp v236, v238 row_newbcast:8 row_mask:0xf bank_mask:0xf
    s_waitcnt vmcnt(23)
    v_pk_fma_f32 v[204:205], v[236:237], v[16:17], v[204:205] op_sel_hi:[0,1,1]
    v_pk_fma_f32 v[206:207], v[236:237], v[18:19], v[206:207] op_sel_hi:[0,1,1]
    s_nop 1
    s_add_u32 s71, s71, 3072
    s_cbranch_vccnz L_th27_3
L_tb27_3:
    buffer_load_dwordx4 v[16:19], v1, s[28:31], s71 offen offset:0 nt
    v_fma_f32 v218, v218, v235, v230
    s_waitcnt vmcnt(23)
    v_pk_fma_f32 v[208:209], v[236:237], v[20:21], v[208:209] op_sel_hi:[0,1,1]
    v_pk_fma_f32 v[210:211], v[236:237], v[22:23], v[210:211] op_sel_hi:[0,1,1]
    s_nop 1
    buffer_load_dwordx4 v[20:23], v1, s[28:31], s71 offen offset:256 nt
    s_mov_b64 exec, s[88:89]
    buffer_store_dwordx4 v[100:103], v225, s[52:55], s78 offen offset:0
    s_mov_b64 exec, -1
    s_waitcnt vmcnt(23)
    v_pk_fma_f32 v[212:213], v[236:237], v[24:25], v[212:213] op_sel_hi:[0,1,1]
    v_pk_fma_f32 v[214:215], v[236:237], v[26:27], v[214:215] op_sel_hi:[0,1,1]
    s_nop 1
    ds_add_u32 v224, v243 offset:3328
    buffer_load_dwordx4 v[24:27], v1, s[28:31], s71 offen offset:512 nt
    v_add_f32_dpp v218, v218, v218 row_ror:8 row_mask:0xf bank_mask:0xf
    v_mov_b32_dpp v236, v238 row_newbcast:4 row_mask:0xf bank_mask:0xf
    s_waitcnt vmcnt(23)
    v_pk_fma_f32 v[204:205], v[236:237], v[28:29], v[204:205] op_sel_hi:[0,1,1]
    v_pk_fma_f32 v[206:207], v[236:237], v[30:31], v[206:207] op_sel_hi:[0,1,1]
    s_nop 1
    s_add_u32 s71, s71, 3072
    s_cbranch_vccnz L_th30_3
L_tb30_3:
    buffer_load_dwordx4 v[28:31], v1, s[28:31], s71 offen offset:0 nt
    v_add_f32_dpp v218, v218, v218 row_ror:4 row_mask:0xf bank_mask:0xf
    s_waitcnt vmcnt(23)
    v_pk_fma_f32 v[208:209], v[236:237], v[32:33], v[208:209] op_sel_hi:[0,1,1]
    v_pk_fma_f32 v[210:211], v[236:237], v[34:35], v[210:211] op_sel_hi:[0,1,1]
    s_nop 1
    buffer_load_dwordx4 v[32:35], v1, s[28:31], s71 offen offset:256 nt
    v_add_f32_dpp v218, v218, v218 row_ror:2 row_mask:0xf bank_mask:0xf
    s_waitcnt vmcnt(23)
    v_pk_fma_f32 v[212:213], v[236:237], v[36:37], v[212:213] op_sel_hi:[0,1,1]
    v_pk_fma_f32 v[214:215], v[236:237], v[38:39], v[214:215] op_sel_hi:[0,1,1]
    s_nop 1
    ds_add_u32 v224, v243 offset:3328
    buffer_load_dwordx4 v[36:39], v1, s[28:31], s71 offen offset:512 nt
    v_add_f32_dpp v218, v218, v218 row_ror:1 row_mask:0xf bank_mask:0xf
    v_mov_b32_dpp v236, v238 row_newbcast:12 row_mask:0xf bank_mask:0xf
    s_waitcnt vmcnt(23)
    v_pk_fma_f32 v[204:205], v[236:237], v[40:41], v[204:205] op_sel_hi:[0,1,1]
    v_pk_fma_f32 v[206:207], v[236:237], v[42:43], v[206:207] op_sel_hi:[0,1,1]
    s_nop 1
    s_add_u32 s71, s71, 3072
    s_cbranch_vccnz L_th33_3
L_tb33_3:
    buffer_load_dwordx4 v[40:43], v1, s[28:31], s71 offen offset:0 nt
    v_mov_b32 v234, v218
    s_waitcnt vmcnt(23)
    v_pk_fma_f32 v[208:209], v[236:237], v[44:45], v[208:209] op_sel_hi:[0,1,1]
    v_pk_fma_f32 v[210:211], v[236:237], v[46:47], v[210:211] op_sel_hi:[0,1,1]
    s_nop 1
    buffer_load_dwordx4 v[44:47], v1, s[28:31], s71 offen offset:256 nt
    v_permlane32_swap_b32 v218, v234
    s_waitcnt vmcnt(23)
    v_pk_fma_f32 v[212:213], v[236:237], v[48:49], v[212:213] op_sel_hi:[0,1,1]
    v_pk_fma_f32 v[214:215], v[236:237], v[50:51], v[214:215] op_sel_hi:[0,1,1]
    s_nop 1
    ds_add_u32 v224, v243 offset:3328
    buffer_load_dwordx4 v[48:51], v1, s[28:31], s71 offen offset:512 nt
    v_add_f32 v218, v218, v234
    v_mov_b32_dpp v236, v238 row_newbcast:2 row_mask:0xf bank_mask:0xf
    s_waitcnt vmcnt(23)
    v_pk_fma_f32 v[204:205], v[236:237], v[52:53], v[204:205] op_sel_hi:[0,1,1]
    v_pk_fma_f32 v[206:207], v[236:237], v[54:55], v[206:207] op_sel_hi:[0,1,1]
    s_nop 1
    ds_read_b32 v244, v243 offset:147
    s_add_u32 s71, s71, 384000
    s_cbranch_vccnz L_th36_3
L_tb36_3:
    buffer_load_dwordx4 v[52:55], v1, s[28:31], s71 offen offset:0 nt
    v_mov_b32 v234, v218
    s_waitcnt vmcnt(23)
    v_pk_fma_f32 v[208:209], v[236:237], v[56:57], v[208:209] op_sel_hi:[0,1,1]
    v_pk_fma_f32 v[210:211], v[236:237], v[58:59], v[210:211] op_sel_hi:[0,1,1]
    s_nop 1
    buffer_load_dwordx4 v[56:59], v1, s[28:31], s71 offen offset:256 nt
    v_permlane16_swap_b32 v218, v234
    s_waitcnt vmcnt(23)
    v_pk_fma_f32 v[212:213], v[236:237], v[60:61], v[212:213] op_sel_hi:[0,1,1]
    v_pk_fma_f32 v[214:215], v[236:237], v[62:63], v[214:215] op_sel_hi:[0,1,1]
    s_nop 1
    s_waitcnt lgkmcnt(0)
    v_cmp_lt_u32 vcc, v0, v244
    ds_add_u32 v224, v243 offset:3328
    buffer_load_dwordx4 v[60:63], v1, s[28:31], s71 offen offset:512 nt
    v_add_f32 v218, v218, v234
    v_mov_b32_dpp v236, v238 row_newbcast:10 row_mask:0xf bank_mask:0xf
    s_waitcnt vmcnt(23)
    v_pk_fma_f32 v[204:205], v[236:237], v[64:65], v[204:205] op_sel_hi:[0,1,1]
    v_pk_fma_f32 v[206:207], v[236:237], v[66:67], v[206:207] op_sel_hi:[0,1,1]
    s_nop 1
    s_add_u32 s71, s71, 3072
    s_cbranch_vccnz L_th39_3
L_tb39_3:
    buffer_load_dwordx4 v[64:67], v1, s[28:31], s71 offen offset:0 nt
    v_mov_b32 v103, s93
    v_lshlrev_b32 v235, 4, v0
    s_lshl_b32 s78, s3, 11
    s_mov_b32 s6, 0x58000000
    s_waitcnt vmcnt(23)
    v_pk_fma_f32 v[208:209], v[236:237], v[68:69], v[208:209] op_sel_hi:[0,1,1]
    v_pk_fma_f32 v[210:211], v[236:237], v[70:71], v[210:211] op_sel_hi:[0,1,1]
    s_nop 1
    buffer_load_dwordx4 v[68:71], v1, s[28:31], s71 offen offset:256 nt
    s_waitcnt vmcnt(23)
    v_pk_fma_f32 v[212:213], v[236:237], v[72:73], v[212:213] op_sel_hi:[0,1,1]
    v_pk_fma_f32 v[214:215], v[236:237], v[74:75], v[214:215] op_sel_hi:[0,1,1]
    s_nop 1
    ds_add_u32 v224, v243 offset:3328
    buffer_load_dwordx4 v[72:75], v1, s[28:31], s71 offen offset:512 nt
    v_mov_b32_dpp v236, v238 row_newbcast:6 row_mask:0xf bank_mask:0xf
    s_waitcnt vmcnt(23)
    v_pk_fma_f32 v[204:205], v[236:237], v[76:77], v[204:205] op_sel_hi:[0,1,1]
    v_pk_fma_f32 v[206:207], v[236:237], v[78:79], v[206:207] op_sel_hi:[0,1,1]
    s_nop 1
    s_add_u32 s71, s71, 3072
    s_cbranch_vccnz L_th42_3
L_tb42_3:
    buffer_load_dwordx4 v[76:79], v1, s[28:31], s71 offen offset:0 nt
    s_waitcnt vmcnt(23)
    v_pk_fma_f32 v[208:209], v[236:237], v[80:81], v[208:209] op_sel_hi:[0,1,1]
    v_pk_fma_f32 v[210:211], v[236:237], v[82:83], v[210:211] op_sel_hi:[0,1,1]
    s_nop 1
    buffer_load_dwordx4 v[80:83], v1, s[28:31], s71 offen offset:256 nt
    s_waitcnt vmcnt(23)
    v_pk_fma_f32 v[212:213], v[236:237], v[84:85], v[212:213] op_sel_hi:[0,1,1]
    v_pk_fma_f32 v[214:215], v[236:237], v[86:87], v[214:215] op_sel_hi:[0,1,1]
    s_nop 1
    ds_add_u32 v224, v243 offset:3328
    buffer_load_dwordx4 v[84:87], v1, s[28:31], s71 offen offset:512 nt
    v_mov_b32_dpp v236, v238 row_newbcast:14 row_mask:0xf bank_mask:0xf
    s_waitcnt vmcnt(23)
    v_pk_fma_f32 v[204:205], v[236:237], v[88:89], v[204:205] op_sel_hi:[0,1,1]
    v_pk_fma_f32 v[206:207], v[236:237], v[90:91], v[206:207] op_sel_hi:[0,1,1]
    s_nop 1
    s_add_u32 s71, s71, 3072
    s_cbranch_vccnz L_th45_3
L_tb45_3:
    buffer_load_dwordx4 v[88:91], v1, s[28:31], s71 offen offset:0 nt
    s_waitcnt vmcnt(23)
    v_pk_fma_f32 v[208:209], v[236:237], v[92:93], v[208:209] op_sel_hi:[0,1,1]
    v_pk_fma_f32 v[210:211], v[236:237], v[94:95], v[210:211] op_sel_hi:[0,1,1]
    s_nop 1
    buffer_load_dwordx4 v[92:95], v1, s[28:31], s71 offen offset:256 nt
    s_waitcnt vmcnt(23)
    v_pk_fma_f32 v[212:213], v[236:237], v[96:97], v[212:213] op_sel_hi:[0,1,1]
    v_pk_fma_f32 v[214:215], v[236:237], v[98:99], v[214:215] op_sel_hi:[0,1,1]
    s_nop 1
    ds_add_u32 v224, v243 offset:3328
    buffer_load_dwordx4 v[96:99], v1, s[28:31], s71 offen offset:512 nt
    ds_write_b32 v243, v243 offset:143
    v_mov_b32_dpp v236, v238 row_newbcast:1 row_mask:0xf bank_mask:0xf
    s_waitcnt vmcnt(23)
    v_pk_fma_f32 v[204:205], v[236:237], v[4:5], v[204:205] op_sel_hi:[0,1,1]
    v_pk_fma_f32 v[206:207], v[236:237], v[6:7], v[206:207] op_sel_hi:[0,1,1]
    s_waitcnt vmcnt(22)
    v_pk_fma_f32 v[208:209], v[236:237], v[8:9], v[208:209] op_sel_hi:[0,1,1]
    v_pk_fma_f32 v[210:211], v[236:237], v[10:11], v[210:211] op_sel_hi:[0,1,1]
    s_waitcnt vmcnt(21)
    v_pk_fma_f32 v[212:213], v[236:237], v[12:13], v[212:213] op_sel_hi:[0,1,1]
    v_pk_fma_f32 v[214:215], v[236:237], v[14:15], v[214:215] op_sel_hi:[0,1,1]
    v_mov_b32_dpp v236, v238 row_newbcast:9 row_mask:0xf bank_mask:0xf
    s_waitcnt vmcnt(20)
    v_pk_fma_f32 v[204:205], v[236:237], v[16:17], v[204:205] op_sel_hi:[0,1,1]
    v_pk_fma_f32 v[206:207], v[236:237], v[18:19], v[206:207] op_sel_hi:[0,1,1]
    s_waitcnt vmcnt(19)
    v_pk_fma_f32 v[208:209], v[236:237], v[20:21], v[208:209] op_sel_hi:[0,1,1]
    v_pk_fma_f32 v[210:211], v[236:237], v[22:23], v[210:211] op_sel_hi:[0,1,1]
    s_waitcnt vmcnt(18)
    s_branch L_x2
L_w2:
    s_branch L_w3
L_x2:
    v_pk_fma_f32 v[212:213], v[236:237], v[24:25], v[212:213] op_sel_hi:[0,1,1]
    v_pk_fma_f32 v[214:215], v[236:237], v[26:27], v[214:215] op_sel_hi:[0,1,1]
    v_mov_b32_dpp v236, v238 row_newbcast:5 row_mask:0xf bank_mask:0xf
    s_waitcnt vmcnt(17)
    v_pk_fma_f32 v[204:205], v[236:237], v[28:29], v[204:205] op_sel_hi:[0,1,1]
    v_pk_fma_f32 v[206:207], v[236:237], v[30:31], v[206:207] op_sel_hi:[0,1,1]
    s_waitcnt vmcnt(16)
    v_pk_fma_f32 v[208:209], v[236:237], v[32:33], v[208:209] op_sel_hi:[0,1,1]
    v_pk_fma_f32 v[210:211], v[236:237], v[34:35], v[210:211] op_sel_hi:[0,1,1]
    s_waitcnt vmcnt(15)
    v_pk_fma_f32 v[212:213], v[236:237], v[36:37], v[212:213] op_sel_hi:[0,1,1]
    v_pk_fma_f32 v[214:215], v[236:237], v[38:39], v[214:215] op_sel_hi:[0,1,1]
    v_mov_b32_dpp v236, v238 row_newbcast:13 row_mask:0xf bank_mask:0xf
    s_waitcnt vmcnt(14)
    v_pk_fma_f32 v[204:205], v[236:237], v[40:41], v[204:205] op_sel_hi:[0,1,1]
    v_pk_fma_f32 v[206:207], v[236:237], v[42:43], v[206:207] op_sel_hi:[0,1,1]
    s_waitcnt vmcnt(13)
    v_pk_fma_f32 v[208:209], v[236:237], v[44:45], v[208:209] op_sel_hi:[0,1,1]
    v_pk_fma_f32 v[210:211], v[236:237], v[46:47], v[210:211] op_sel_hi:[0,1,1]
    s_waitcnt vmcnt(12)
    v_pk_fma_f32 v[212:213], v[236:237], v[48:49], v[212:213] op_sel_hi:[0,1,1]
    v_pk_fma_f32 v[214:215], v[236:237], v[50:51], v[214:215] op_sel_hi:[0,1,1]
    v_mov_b32_dpp v236, v238 row_newbcast:3 row_mask:0xf bank_mask:0xf
    s_waitcnt vmcnt(11)
    v_pk_fma_f32 v[204:205], v[236:237], v[52:53], v[204:205] op_sel_hi:[0,1,1]
    v_pk_fma_f32 v[206:207], v[236:237], v[54:55], v[206:207] op_sel_hi:[0,1,1]
    s_waitcnt vmcnt(10)
    v_pk_fma_f32 v[208:209], v[236:237], v[56:57], v[208:209] op_sel_hi:[0,1,1]
    v_pk_fma_f32 v[210:211], v[236:237], v[58:59], v[210:211] op_sel_hi:[0,1,1]
    s_waitcnt vmcnt(9)
    v_pk_fma_f32 v[212:213], v[236:237], v[60:61], v[212:213] op_sel_hi:[0,1,1]
    v_pk_fma_f32 v[214:215], v[236:237], v[62:63], v[214:215] op_sel_hi:[0,1,1]
    v_mov_b32_dpp v236, v238 row_newbcast:11 row_mask:0xf bank_mask:0xf
    s_waitcnt vmcnt(8)
    v_pk_fma_f32 v[204:205], v[236:237], v[64:65], v[204:205] op_sel_hi:[0,1,1]
    v_pk_fma_f32 v[206:207], v[236:237], v[66:67], v[206:207] op_sel_hi:[0,1,1]
    s_waitcnt vmcnt(7)
    v_pk_fma_f32 v[208:209], v[236:237], v[68:69], v[208:209] op_sel_hi:[0,1,1]
    v_pk_fma_f32 v[210:211], v[236:237], v[70:71], v[210:211] op_sel_hi:[0,1,1]
    s_waitcnt vmcnt(6)
    v_pk_fma_f32 v[212:213], v[236:237], v[72:73], v[212:213] op_sel_hi:[0,1,1]
    v_pk_fma_f32 v[214:215], v[236:237], v[74:75], v[214:215] op_sel_hi:[0,1,1]
    v_mov_b32_dpp v236, v238 row_newbcast:7 row_mask:0xf bank_mask:0xf
    s_waitcnt vmcnt(5)
    v_pk_fma_f32 v[204:205], v[236:237], v[76:77], v[204:205] op_sel_hi:[0,1,1]
    v_pk_fma_f32 v[206:207], v[236:237], v[78:79], v[206:207] op_sel_hi:[0,1,1]
    s_waitcnt vmcnt(4)
    v_pk_fma_f32 v[208:209], v[236:237], v[80:81], v[208:209] op_sel_hi:[0,1,1]
    v_pk_fma_f32 v[210:211], v[236:237], v[82:83], v[210:211] op_sel_hi:[0,1,1]
    s_waitcnt vmcnt(3)
    v_pk_fma_f32 v[212:213], v[236:237], v[84:85], v[212:213] op_sel_hi:[0,1,1]
    v_pk_fma_f32 v[214:215], v[236:237], v[86:87], v[214:215] op_sel_hi:[0,1,1]
    v_mov_b32_dpp v236, v238 row_newbcast:15 row_mask:0xf bank_mask:0xf
    s_waitcnt vmcnt(2)
    v_pk_fma_f32 v[204:205], v[236:237], v[88:89], v[204:205] op_sel_hi:[0,1,1]
    v_pk_fma_f32 v[206:207], v[236:237], v[90:91], v[206:207] op_sel_hi:[0,1,1]
    s_waitcnt vmcnt(1)
    v_pk_fma_f32 v[208:209], v[236:237], v[92:93], v[208:209] op_sel_hi:[0,1,1]
    v_pk_fma_f32 v[210:211], v[236:237], v[94:95], v[210:211] op_sel_hi:[0,1,1]
    v_permlane32_swap_b32 v204, v206
    v_permlane32_swap_b32 v205, v207
    v_add_f32 v204, v204, v206
    v_add_f32 v205, v205, v207
    v_permlane32_swap_b32 v208, v210
    v_permlane32_swap_b32 v209, v211
    v_add_f32 v208, v208, v210
    v_add_f32 v209, v209, v211
    v_permlane16_swap_b32 v204, v205
    v_add_f32 v204, v204, v205
    v_fma_f32 v100, v204, s6, -v218
    v_permlane16_swap_b32 v208, v209
    v_add_f32 v208, v208, v209
    v_fma_f32 v101, v208, s6, -v218
    s_waitcnt vmcnt(0)
    v_pk_fma_f32 v[212:213], v[236:237], v[96:97], v[212:213] op_sel_hi:[0,1,1]
    v_pk_fma_f32 v[214:215], v[236:237], v[98:99], v[214:215] op_sel_hi:[0,1,1]
    s_nop 1
    v_permlane32_swap_b32 v212, v214
    v_permlane32_swap_b32 v213, v215
    v_add_f32 v212, v212, v214
    v_add_f32 v213, v213, v215
    s_nop 1
    v_permlane16_swap_b32 v212, v213
    v_add_f32 v212, v212, v213
    v_fma_f32 v102, v212, s6, -v218
    s_mov_b64 exec, s[88:89]
    buffer_store_dwordx4 v[100:103], v225, s[52:55], s78 offen offset:0
    s_not_b64 exec, exec
    buffer_store_dwordx4 v[100:103], v225, s[52:55], s78 offen offset:0 sc0 sc1
    s_mov_b64 exec, -1
L_final:
    s_endpgm
L_th24_0:
    s_waitcnt vmcnt(32)
    s_cmp_eq_u32 vcc_lo, 1
    s_cbranch_scc1 L_tb24_0
    s_waitcnt vmcnt(23)
    s_branch L_tb24_0
L_th27_0:
    s_waitcnt vmcnt(26)
    s_cmp_eq_u32 vcc_lo, 1
    s_cbranch_scc1 L_tb27_0
    s_waitcnt vmcnt(23)
    s_branch L_tb27_0
L_th30_0:
    s_waitcnt vmcnt(32)
    s_cmp_eq_u32 vcc_lo, 1
    s_cbranch_scc1 L_tb30_0
    s_waitcnt vmcnt(29)
    s_branch L_tb30_0
L_th33_0:
    s_waitcnt vmcnt(32)
    s_cmp_eq_u32 vcc_lo, 1
    s_cbranch_scc1 L_tb33_0
    s_waitcnt vmcnt(29)
    s_branch L_tb33_0
L_th36_0:
    s_waitcnt vmcnt(35)
    s_cmp_eq_u32 vcc_lo, 1
    s_cbranch_scc1 L_tb36_0
    s_waitcnt vmcnt(26)
    s_branch L_tb36_0
L_th39_0:
    s_waitcnt vmcnt(29)
    s_cmp_eq_u32 vcc_lo, 1
    s_cbranch_scc1 L_tb39_0
    s_waitcnt vmcnt(26)
    s_branch L_tb39_0
L_th42_0:
    s_waitcnt vmcnt(35)
    s_cmp_eq_u32 vcc_lo, 1
    s_cbranch_scc1 L_tb42_0
    s_waitcnt vmcnt(32)
    s_branch L_tb42_0
L_th45_0:
    s_waitcnt vmcnt(35)
    s_cmp_eq_u32 vcc_lo, 1
    s_cbranch_scc1 L_tb45_0
    s_waitcnt vmcnt(32)
    s_branch L_tb45_0
L_th0_0:
    s_waitcnt vmcnt(35)
    s_cmp_eq_u32 vcc_lo, 1
    s_cbranch_scc1 L_tb0_0
    s_waitcnt vmcnt(26)
    s_branch L_tb0_0
L_th3_0:
    s_waitcnt vmcnt(29)
    s_cmp_eq_u32 vcc_lo, 1
    s_cbranch_scc1 L_tb3_0
    s_waitcnt vmcnt(26)
    s_branch L_tb3_0
L_th6_0:
    s_waitcnt vmcnt(35)
    s_cmp_eq_u32 vcc_lo, 1
    s_cbranch_scc1 L_tb6_0
    s_waitcnt vmcnt(29)
    s_branch L_tb6_0
L_th9_0:
    s_waitcnt vmcnt(32)
    s_cmp_eq_u32 vcc_lo, 1
    s_cbranch_scc1 L_tb9_0
    s_waitcnt vmcnt(29)
    s_branch L_tb9_0
L_th12_0:
    s_waitcnt vmcnt(32)
    s_cmp_eq_u32 vcc_lo, 1
    s_cbranch_scc1 L_tb12_0
    s_waitcnt vmcnt(23)
    s_branch L_tb12_0
L_th15_0:
    s_waitcnt vmcnt(26)
    s_cmp_eq_u32 vcc_lo, 1
    s_cbranch_scc1 L_tb15_0
    s_waitcnt vmcnt(23)
    s_branch L_tb15_0
L_th18_0:
    s_waitcnt vmcnt(32)
    s_cmp_eq_u32 vcc_lo, 1
    s_cbranch_scc1 L_tb18_0
    s_waitcnt vmcnt(29)
    s_branch L_tb18_0
L_th21_0:
    s_waitcnt vmcnt(32)
    s_cmp_eq_u32 vcc_lo, 1
    s_cbranch_scc1 L_tb21_0
    s_waitcnt vmcnt(29)
    s_branch L_tb21_0
L_th24_1:
    s_waitcnt vmcnt(32)
    s_cmp_eq_u32 vcc_lo, 1
    s_cbranch_scc1 L_tb24_1
    s_waitcnt vmcnt(23)
    s_branch L_tb24_1
L_th27_1:
    s_waitcnt vmcnt(26)
    s_cmp_eq_u32 vcc_lo, 1
    s_cbranch_scc1 L_tb27_1
    s_waitcnt vmcnt(23)
    s_branch L_tb27_1
L_th30_1:
    s_waitcnt vmcnt(32)
    s_cmp_eq_u32 vcc_lo, 1
    s_cbranch_scc1 L_tb30_1
    s_waitcnt vmcnt(29)
    s_branch L_tb30_1
L_th33_1:
    s_waitcnt vmcnt(32)
    s_cmp_eq_u32 vcc_lo, 1
    s_cbranch_scc1 L_tb33_1
    s_waitcnt vmcnt(29)
    s_branch L_tb33_1
L_th36_1:
    s_waitcnt vmcnt(34)
    s_cmp_eq_u32 vcc_lo, 1
    s_cbranch_scc1 L_tb36_1
    s_waitcnt vmcnt(25)
    s_branch L_tb36_1
L_th39_1:
    s_waitcnt vmcnt(28)
    s_cmp_eq_u32 vcc_lo, 1
    s_cbranch_scc1 L_tb39_1
    s_waitcnt vmcnt(25)
    s_branch L_tb39_1
L_th42_1:
    s_waitcnt vmcnt(28)
    s_cmp_eq_u32 vcc_lo, 1
    s_cbranch_scc1 L_tb42_1
    s_waitcnt vmcnt(25)
    s_branch L_tb42_1
L_th45_1:
    s_waitcnt vmcnt(28)
    s_cmp_eq_u32 vcc_lo, 1
    s_cbranch_scc1 L_tb45_1
    s_waitcnt vmcnt(25)
    s_branch L_tb45_1
L_th0_1:
    s_waitcnt vmcnt(28)
    s_cmp_eq_u32 vcc_lo, 1
    s_cbranch_scc1 L_tb0_1
    s_waitcnt vmcnt(19)
    s_branch L_tb0_1
L_th3_1:
    s_waitcnt vmcnt(22)
    s_cmp_eq_u32 vcc_lo, 1
    s_cbranch_scc1 L_tb3_1
    s_waitcnt vmcnt(19)
    s_branch L_tb3_1
L_th6_1:
    s_waitcnt vmcnt(22)
    s_cmp_eq_u32 vcc_lo, 1
    s_cbranch_scc1 L_tb6_1
    s_waitcnt vmcnt(17)
    s_branch L_tb6_1
L_th9_1:
    s_waitcnt vmcnt(20)
    s_cmp_eq_u32 vcc_lo, 1
    s_cbranch_scc1 L_tb9_1
    s_waitcnt vmcnt(17)
    s_branch L_tb9_1
L_th12_1:
    s_waitcnt vmcnt(20)
    s_cmp_eq_u32 vcc_lo, 1
    s_cbranch_scc1 L_tb12_1
    s_waitcnt vmcnt(17)
    s_branch L_tb12_1
L_th15_1:
    s_waitcnt vmcnt(20)
    s_cmp_eq_u32 vcc_lo, 1
    s_cbranch_scc1 L_tb15_1
    s_waitcnt vmcnt(17)
    s_branch L_tb15_1
L_th18_1:
    s_waitcnt vmcnt(20)
    s_cmp_eq_u32 vcc_lo, 1
    s_cbranch_scc1 L_tb18_1
    s_waitcnt vmcnt(17)
    s_branch L_tb18_1
L_th21_1:
    s_waitcnt vmcnt(20)
    s_cmp_eq_u32 vcc_lo, 1
    s_cbranch_scc1 L_tb21_1
    s_waitcnt vmcnt(17)
    s_branch L_tb21_1
L_th24_2:
    s_nop 11
    s_waitcnt vmcnt(20)
    s_cmp_eq_u32 vcc_lo, 1
    s_cbranch_scc1 L_tb24_2
    s_waitcnt vmcnt(17)
    s_branch L_tb24_2
L_th27_2:
    s_nop 11
    s_waitcnt vmcnt(20)
    s_cmp_eq_u32 vcc_lo, 1
    s_cbranch_scc1 L_tb27_2
    s_waitcnt vmcnt(17)
    s_branch L_tb27_2
L_th30_2:
    s_nop 11
    s_waitcnt vmcnt(20)
    s_cmp_eq_u32 vcc_lo, 1
    s_cbranch_scc1 L_tb30_2
    s_waitcnt vmcnt(17)
    s_branch L_tb30_2
L_th33_2:
    s_nop 11
    s_waitcnt vmcnt(20)
    s_cmp_eq_u32 vcc_lo, 1
    s_cbranch_scc1 L_tb33_2
    s_waitcnt vmcnt(17)
    s_branch L_tb33_2
L_th36_2:
    s_nop 11
    s_waitcnt vmcnt(22)
    s_cmp_eq_u32 vcc_lo, 1
    s_cbranch_scc1 L_tb36_2
    s_waitcnt vmcnt(19)
    s_branch L_tb36_2
L_th39_2:
    s_nop 11
    s_waitcnt vmcnt(22)
    s_cmp_eq_u32 vcc_lo, 1
    s_cbranch_scc1 L_tb39_2
    s_waitcnt vmcnt(19)
    s_branch L_tb39_2
L_th42_2:
    s_nop 11
    s_waitcnt vmcnt(22)
    s_cmp_eq_u32 vcc_lo, 1
    s_cbranch_scc1 L_tb42_2
    s_waitcnt vmcnt(19)
    s_branch L_tb42_2
L_th45_2:
    s_nop 11
    s_waitcnt vmcnt(22)
    s_cmp_eq_u32 vcc_lo, 1
    s_cbranch_scc1 L_tb45_2
    s_waitcnt vmcnt(19)
    s_branch L_tb45_2
L_getm2:
    ds_read_b32 v227, v243 offset:139
    ds_read_b32 v226, v243 offset:159
    s_waitcnt lgkmcnt(0)
    v_readfirstlane_b32 s93, v227
    v_readfirstlane_b32 s77, v226
    s_cmp_eq_u32 s93, 0
    s_cbranch_scc1 L_getm2
    ds_read_b32 v226, v243 offset:151
    s_waitcnt lgkmcnt(0)
    v_readfirstlane_b32 s88, v226
    s_cmp_eq_u32 s88, -1
    s_cselect_b64 s[88:89], -1, 0
    s_branch L_gotm2
L_th0_2:
    s_nop 11
    s_waitcnt vmcnt(22)
    s_cmp_eq_u32 vcc_lo, 1
    s_cbranch_scc1 L_tb0_2
    s_waitcnt vmcnt(19)
    s_branch L_tb0_2
L_th3_2:
    s_nop 11
    s_waitcnt vmcnt(22)
    s_cmp_eq_u32 vcc_lo, 1
    s_cbranch_scc1 L_tb3_2
    s_waitcnt vmcnt(19)
    s_branch L_tb3_2
L_th6_2:
    s_nop 11
    s_waitcnt vmcnt(22)
    s_cmp_eq_u32 vcc_lo, 1
    s_cbranch_scc1 L_tb6_2
    s_waitcnt vmcnt(17)
    s_branch L_tb6_2
L_th9_2:
    s_nop 11
    s_waitcnt vmcnt(20)
    s_cmp_eq_u32 vcc_lo, 1
    s_cbranch_scc1 L_tb9_2
    s_waitcnt vmcnt(17)
    s_branch L_tb9_2
L_th12_2:
    s_nop 11
    s_waitcnt vmcnt(20)
    s_cmp_eq_u32 vcc_lo, 1
    s_cbranch_scc1 L_tb12_2
    s_waitcnt vmcnt(17)
    s_branch L_tb12_2
L_th15_2:
    s_nop 11
    s_waitcnt vmcnt(20)
    s_cmp_eq_u32 vcc_lo, 1
    s_cbranch_scc1 L_tb15_2
    s_waitcnt vmcnt(17)
    s_branch L_tb15_2
L_th18_2:
    s_nop 11
    s_waitcnt vmcnt(20)
    s_cmp_eq_u32 vcc_lo, 1
    s_cbranch_scc1 L_tb18_2
    s_waitcnt vmcnt(17)
    s_branch L_tb18_2
L_th21_2:
    s_nop 11
    s_waitcnt vmcnt(20)
    s_cmp_eq_u32 vcc_lo, 1
    s_cbranch_scc1 L_tb21_2
    s_waitcnt vmcnt(17)
    s_branch L_tb21_2
L_th24_3:
    s_nop 11
    s_waitcnt vmcnt(20)
    s_cmp_eq_u32 vcc_lo, 1
    s_cbranch_scc1 L_tb24_3
    s_waitcnt vmcnt(17)
    s_branch L_tb24_3
L_th27_3:
    s_nop 11
    s_waitcnt vmcnt(20)
    s_cmp_eq_u32 vcc_lo, 1
    s_cbranch_scc1 L_tb27_3
    s_waitcnt vmcnt(17)
    s_branch L_tb27_3
L_th30_3:
    s_nop 11
    s_waitcnt vmcnt(20)
    s_cmp_eq_u32 vcc_lo, 1
    s_cbranch_scc1 L_tb30_3
    s_waitcnt vmcnt(17)
    s_branch L_tb30_3
L_th33_3:
    s_nop 11
    s_waitcnt vmcnt(20)
    s_cmp_eq_u32 vcc_lo, 1
    s_cbranch_scc1 L_tb33_3
    s_waitcnt vmcnt(17)
    s_branch L_tb33_3
L_th36_3:
    s_nop 11
    s_waitcnt vmcnt(20)
    s_cmp_eq_u32 vcc_lo, 1
    s_cbranch_scc1 L_tb36_3
    s_waitcnt vmcnt(17)
    s_branch L_tb36_3
L_th39_3:
    s_nop 11
    s_waitcnt vmcnt(20)
    s_cmp_eq_u32 vcc_lo, 1
    s_cbranch_scc1 L_tb39_3
    s_waitcnt vmcnt(17)
    s_branch L_tb39_3
L_th42_3:
    s_nop 11
    s_waitcnt vmcnt(20)
    s_cmp_eq_u32 vcc_lo, 1
    s_cbranch_scc1 L_tb42_3
    s_waitcnt vmcnt(17)
    s_branch L_tb42_3
L_th45_3:
    s_nop 11
    s_waitcnt vmcnt(20)
    s_cmp_eq_u32 vcc_lo, 1
    s_cbranch_scc1 L_tb45_3
    s_waitcnt vmcnt(17)
    s_branch L_tb45_3
L_service:
    v_lshlrev_b32 v5, 2, v0
    v_mov_b32 v3, 0
    ds_write_b32 v5, v3 offset:0
    v_lshlrev_b32 v1, 4, v0
    v_lshlrev_b32 v28, 11, v0
    v_mov_b32 v9, 0xf149f2ca
    v_cndmask_b32 v9, v9, v3, s[66:67]
    v_and_b32 v5, 15, v0
    v_lshrrev_b32 v6, 4, v0
    v_lshl_add_u32 v11, v5, 2, v6
    v_lshlrev_b32 v11, 1, v11
    s_getreg_b32 s72, hwreg(HW_REG_XCC_ID)
    s_and_b32 s72, s72, 15
    s_waitcnt lgkmcnt(0)
    s_barrier
    s_branch L_w0
L_walked:
    s_mov_b32 s52, s22
    s_and_b32 s53, s23, 0xffff
    s_mov_b32 s54, 25165824
    s_mov_b32 s55, 0x00020000
    s_mov_b32 s56, s18
    s_and_b32 s57, s19, 0xffff
    s_mov_b32 s58, 12288
    s_mov_b32 s59, 0x00020000
    s_mov_b32 s96, s79
    s_and_b32 s82, s79, 3
    s_lshl_b32 s82, s82, 4
    v_mov_b32 v10, 0
    s_mov_b32 s80, 0x2010200
    s_mov_b32 s81, 0x2030202
    s_cmp_ge_u32 s79, 4
    s_cmov_b32 s80, 0x2050204
    s_cmov_b32 s81, 0x2070206
    s_lshr_b64 s[80:81], s[80:81], s82
    v_writelane_b32 v10, s80, 0
    s_mov_b32 s80, 0x2090208
    s_mov_b32 s81, 0x20b020a
    s_cmp_ge_u32 s79, 4
    s_cmov_b32 s80, 0x20d020c
    s_cmov_b32 s81, 0x20f020e
    s_lshr_b64 s[80:81], s[80:81], s82
    v_writelane_b32 v10, s80, 1
    s_mov_b32 s80, 0x4d00150
    s_mov_b32 s81, 0x8310571
    s_cmp_ge_u32 s79, 4
    s_cmov_b32 s80, 0x57304d2
    s_cmov_b32 s81, 0x4b40174
    s_lshr_b64 s[80:81], s[80:81], s82
    v_writelane_b32 v10, s80, 2
    s_mov_b32 s80, 0x9100d5
    s_mov_b32 s81, 0x15204b6
    s_cmp_ge_u32 s79, 4
    s_cmov_b32 s80, 0x4b700b3
    s_cmov_b32 s81, 0x8d508b7
    s_lshr_b64 s[80:81], s[80:81], s82
    v_writelane_b32 v10, s80, 3
    s_mov_b32 s80, 0x4950000
    s_mov_b32 s81, 0x8b60000
    s_cmp_ge_u32 s79, 4
    s_cmov_b32 s80, 0xc96
    s_cmov_b32 s81, 0xcb70000
    s_lshr_b64 s[80:81], s[80:81], s82
    v_writelane_b32 v10, s80, 4
    s_mov_b32 s80, 0x560000
    s_mov_b32 s81, 0x0
    s_cmp_ge_u32 s79, 4
    s_cmov_b32 s80, 0x37
    s_cmov_b32 s81, 0x0
    s_lshr_b64 s[80:81], s[80:81], s82
    v_writelane_b32 v10, s80, 5
    v_and_b32 v10, 0xffff, v10
L_tag:
    ds_read_b32 v5, v3 offset:140
    ds_read_b64 v[16:17], v3 offset:152
    s_waitcnt lgkmcnt(0)
    v_readfirstlane_b32 s69, v5
    s_cmp_eq_u32 s69, 0
    s_cbranch_scc1 L_tag
    v_readfirstlane_b32 s86, v16
    v_readfirstlane_b32 s87, v17
    s_bfm_b64 s[84:85], s92, 0
    s_bcnt1_i32_b64 s70, s[86:87]
    s_and_b64 s[84:85], s[84:85], s[86:87]
    s_bcnt1_i32_b64 s71, s[84:85]
    s_mov_b32 s73, s71
L_round:
    s_min_u32 s80, s71, 63
    v_readlane_b32 s97, v10, s80
    s_lshl_b32 s80, s71, 2
    v_mov_b32 v4, s80
    s_cmp_eq_u32 s97, 0
    s_cbranch_scc1 L_last
L_poll:
    ds_read_b32 v5, v4 offset:0
    s_waitcnt lgkmcnt(0)
    v_readfirstlane_b32 s80, v5
    s_cmp_eq_u32 s80, 0
    s_cbranch_scc1 L_poll
    s_add_u32 s95, s69, s71
    s_add_u32 s95, s95, 1
    s_and_b32 s80, s71, 1
    s_lshl_b32 s80, s80, 19
    s_add_u32 s80, s80, 2097152
    s_lshl_b32 s77, s2, 11
    s_add_u32 s77, s77, s80
    s_lshl_b32 s75, s96, 16
    s_add_u32 s75, s75, s80
L_all:
    v_mov_b32 v16, s95
    s_mov_b64 exec, s[86:87]
    buffer_load_dword v16, v28, s[52:55], s75 offen offset:1024 sc0 sc1
    s_mov_b64 exec, -1
    s_waitcnt vmcnt(0)
    v_cmp_ne_u32 vcc, s95, v16
    s_cmp_lg_u64 vcc, 0
    s_cbranch_scc1 L_all
    s_mov_b32 s74, 0
    s_mov_b64 s[84:85], s[86:87]
L_merge:
    v_mov_b32 v7, 0xf149f2ca
    v_mov_b32 v8, 0
    v_mov_b32 v12, 0
    v_mov_b32 v13, 0
    v_mov_b32 v14, 0
L_chunk:
    v_mov_b32 v48, 0
    v_mov_b32 v49, 0
    v_mov_b32 v50, 0
    v_mov_b32 v51, v9
    v_mov_b32 v52, 0
    v_mov_b32 v53, 0
    v_mov_b32 v54, 0
    v_mov_b32 v55, v9
    v_mov_b32 v56, 0
    v_mov_b32 v57, 0
    v_mov_b32 v58, 0
    v_mov_b32 v59, v9
    v_mov_b32 v60, 0
    v_mov_b32 v61, 0
    v_mov_b32 v62, 0
    v_mov_b32 v63, v9
    v_mov_b32 v64, 0
    v_mov_b32 v65, 0
    v_mov_b32 v66, 0
    v_mov_b32 v67, v9
    v_mov_b32 v68, 0
    v_mov_b32 v69, 0
    v_mov_b32 v70, 0
    v_mov_b32 v71, v9
    v_mov_b32 v72, 0
    v_mov_b32 v73, 0
    v_mov_b32 v74, 0
    v_mov_b32 v75, v9
    v_mov_b32 v76, 0
    v_mov_b32 v77, 0
    v_mov_b32 v78, 0
    v_mov_b32 v79, v9
    v_mov_b32 v80, 0
    v_mov_b32 v81, 0
    v_mov_b32 v82, 0
    v_mov_b32 v83, v9
    v_mov_b32 v84, 0
    v_mov_b32 v85, 0
    v_mov_b32 v86, 0
    v_mov_b32 v87, v9
    v_mov_b32 v88, 0
    v_mov_b32 v89, 0
    v_mov_b32 v90, 0
    v_mov_b32 v91, v9
    v_mov_b32 v92, 0
    v_mov_b32 v93, 0
    v_mov_b32 v94, 0
    v_mov_b32 v95, v9
    v_mov_b32 v96, 0
    v_mov_b32 v97, 0
    v_mov_b32 v98, 0
    v_mov_b32 v99, v9
    v_mov_b32 v100, 0
    v_mov_b32 v101, 0
    v_mov_b32 v102, 0
    v_mov_b32 v103, v9
    v_mov_b32 v104, 0
    v_mov_b32 v105, 0
    v_mov_b32 v106, 0
    v_mov_b32 v107, v9
    v_mov_b32 v108, 0
    v_mov_b32 v109, 0
    v_mov_b32 v110, 0
    v_mov_b32 v111, v9
    v_mov_b32 v112, 0
    v_mov_b32 v113, 0
    v_mov_b32 v114, 0
    v_mov_b32 v115, v9
    v_mov_b32 v116, 0
    v_mov_b32 v117, 0
    v_mov_b32 v118, 0
    v_mov_b32 v119, v9
    v_mov_b32 v120, 0
    v_mov_b32 v121, 0
    v_mov_b32 v122, 0
    v_mov_b32 v123, v9
    v_mov_b32 v124, 0
    v_mov_b32 v125, 0
    v_mov_b32 v126, 0
    v_mov_b32 v127, v9
    v_mov_b32 v128, 0
    v_mov_b32 v129, 0
    v_mov_b32 v130, 0
    v_mov_b32 v131, v9
    v_mov_b32 v132, 0
    v_mov_b32 v133, 0
    v_mov_b32 v134, 0
    v_mov_b32 v135, v9
    v_mov_b32 v136, 0
    v_mov_b32 v137, 0
    v_mov_b32 v138, 0
    v_mov_b32 v139, v9
    v_mov_b32 v140, 0
    v_mov_b32 v141, 0
    v_mov_b32 v142, 0
    v_mov_b32 v143, v9
    v_mov_b32 v144, 0
    v_mov_b32 v145, 0
    v_mov_b32 v146, 0
    v_mov_b32 v147, v9
    v_mov_b32 v148, 0
    v_mov_b32 v149, 0
    v_mov_b32 v150, 0
    v_mov_b32 v151, v9
    v_mov_b32 v152, 0
    v_mov_b32 v153, 0
    v_mov_b32 v154, 0
    v_mov_b32 v155, v9
    v_mov_b32 v156, 0
    v_mov_b32 v157, 0
    v_mov_b32 v158, 0
    v_mov_b32 v159, v9
    v_mov_b32 v160, 0
    v_mov_b32 v161, 0
    v_mov_b32 v162, 0
    v_mov_b32 v163, v9
    v_mov_b32 v164, 0
    v_mov_b32 v165, 0
    v_mov_b32 v166, 0
    v_mov_b32 v167, v9
    v_mov_b32 v168, 0
    v_mov_b32 v169, 0
    v_mov_b32 v170, 0
    v_mov_b32 v171, v9
    v_mov_b32 v172, 0
    v_mov_b32 v173, 0
    v_mov_b32 v174, 0
    v_mov_b32 v175, v9
    s_ff1_i32_b64 s80, s[84:85]
    s_bitset0_b64 s[84:85], s80
    s_lshl_b32 s81, s80, 11
    s_add_u32 s81, s81, s75
    s_cmp_ge_i32 s80, 0
    s_cselect_b64 exec, -1, 0
    buffer_load_dwordx4 v[48:51], v1, s[52:55], s81 offen sc0 sc1
    s_ff1_i32_b64 s80, s[84:85]
    s_bitset0_b64 s[84:85], s80
    s_lshl_b32 s81, s80, 11
    s_add_u32 s81, s81, s75
    s_cmp_ge_i32 s80, 0
    s_cselect_b64 exec, -1, 0
    buffer_load_dwordx4 v[52:55], v1, s[52:55], s81 offen sc0 sc1
    s_ff1_i32_b64 s80, s[84:85]
    s_bitset0_b64 s[84:85], s80
    s_lshl_b32 s81, s80, 11
    s_add_u32 s81, s81, s75
    s_cmp_ge_i32 s80, 0
    s_cselect_b64 exec, -1, 0
    buffer_load_dwordx4 v[56:59], v1, s[52:55], s81 offen sc0 sc1
    s_ff1_i32_b64 s80, s[84:85]
    s_bitset0_b64 s[84:85], s80
    s_lshl_b32 s81, s80, 11
    s_add_u32 s81, s81, s75
    s_cmp_ge_i32 s80, 0
    s_cselect_b64 exec, -1, 0
    buffer_load_dwordx4 v[60:63], v1, s[52:55], s81 offen sc0 sc1
    s_ff1_i32_b64 s80, s[84:85]
    s_bitset0_b64 s[84:85], s80
    s_lshl_b32 s81, s80, 11
    s_add_u32 s81, s81, s75
    s_cmp_ge_i32 s80, 0
    s_cselect_b64 exec, -1, 0
    buffer_load_dwordx4 v[64:67], v1, s[52:55], s81 offen sc0 sc1
    s_ff1_i32_b64 s80, s[84:85]
    s_bitset0_b64 s[84:85], s80
    s_lshl_b32 s81, s80, 11
    s_add_u32 s81, s81, s75
    s_cmp_ge_i32 s80, 0
    s_cselect_b64 exec, -1, 0
    buffer_load_dwordx4 v[68:71], v1, s[52:55], s81 offen sc0 sc1
    s_ff1_i32_b64 s80, s[84:85]
    s_bitset0_b64 s[84:85], s80
    s_lshl_b32 s81, s80, 11
    s_add_u32 s81, s81, s75
    s_cmp_ge_i32 s80, 0
    s_cselect_b64 exec, -1, 0
    buffer_load_dwordx4 v[72:75], v1, s[52:55], s81 offen sc0 sc1
    s_ff1_i32_b64 s80, s[84:85]
    s_bitset0_b64 s[84:85], s80
    s_lshl_b32 s81, s80, 11
    s_add_u32 s81, s81, s75
    s_cmp_ge_i32 s80, 0
    s_cselect_b64 exec, -1, 0
    buffer_load_dwordx4 v[76:79], v1, s[52:55], s81 offen sc0 sc1
    s_ff1_i32_b64 s80, s[84:85]
    s_bitset0_b64 s[84:85], s80
    s_lshl_b32 s81, s80, 11
    s_add_u32 s81, s81, s75
    s_cmp_ge_i32 s80, 0
    s_cbranch_scc0 L_got
    s_cselect_b64 exec, -1, 0
    buffer_load_dwordx4 v[80:83], v1, s[52:55], s81 offen sc0 sc1
    s_ff1_i32_b64 s80, s[84:85]
    s_bitset0_b64 s[84:85], s80
    s_lshl_b32 s81, s80, 11
    s_add_u32 s81, s81, s75
    s_cmp_ge_i32 s80, 0
    s_cselect_b64 exec, -1, 0
    buffer_load_dwordx4 v[84:87], v1, s[52:55], s81 offen sc0 sc1
    s_ff1_i32_b64 s80, s[84:85]
    s_bitset0_b64 s[84:85], s80
    s_lshl_b32 s81, s80, 11
    s_add_u32 s81, s81, s75
    s_cmp_ge_i32 s80, 0
    s_cselect_b64 exec, -1, 0
    buffer_load_dwordx4 v[88:91], v1, s[52:55], s81 offen sc0 sc1
    s_ff1_i32_b64 s80, s[84:85]
    s_bitset0_b64 s[84:85], s80
    s_lshl_b32 s81, s80, 11
    s_add_u32 s81, s81, s75
    s_cmp_ge_i32 s80, 0
    s_cselect_b64 exec, -1, 0
    buffer_load_dwordx4 v[92:95], v1, s[52:55], s81 offen sc0 sc1
    s_ff1_i32_b64 s80, s[84:85]
    s_bitset0_b64 s[84:85], s80
    s_lshl_b32 s81, s80, 11
    s_add_u32 s81, s81, s75
    s_cmp_ge_i32 s80, 0
    s_cselect_b64 exec, -1, 0
    buffer_load_dwordx4 v[96:99], v1, s[52:55], s81 offen sc0 sc1
    s_ff1_i32_b64 s80, s[84:85]
    s_bitset0_b64 s[84:85], s80
    s_lshl_b32 s81, s80, 11
    s_add_u32 s81, s81, s75
    s_cmp_ge_i32 s80, 0
    s_cselect_b64 exec, -1, 0
    buffer_load_dwordx4 v[100:103], v1, s[52:55], s81 offen sc0 sc1
    s_ff1_i32_b64 s80, s[84:85]
    s_bitset0_b64 s[84:85], s80
    s_lshl_b32 s81, s80, 11
    s_add_u32 s81, s81, s75
    s_cmp_ge_i32 s80, 0
    s_cselect_b64 exec, -1, 0
    buffer_load_dwordx4 v[104:107], v1, s[52:55], s81 offen sc0 sc1
    s_ff1_i32_b64 s80, s[84:85]
    s_bitset0_b64 s[84:85], s80
    s_lshl_b32 s81, s80, 11
    s_add_u32 s81, s81, s75
    s_cmp_ge_i32 s80, 0
    s_cselect_b64 exec, -1, 0
    buffer_load_dwordx4 v[108:111], v1, s[52:55], s81 offen sc0 sc1
    s_ff1_i32_b64 s80, s[84:85]
    s_bitset0_b64 s[84:85], s80
    s_lshl_b32 s81, s80, 11
    s_add_u32 s81, s81, s75
    s_cmp_ge_i32 s80, 0
    s_cbranch_scc0 L_got
    s_cselect_b64 exec, -1, 0
    buffer_load_dwordx4 v[112:115], v1, s[52:55], s81 offen sc0 sc1
    s_ff1_i32_b64 s80, s[84:85]
    s_bitset0_b64 s[84:85], s80
    s_lshl_b32 s81, s80, 11
    s_add_u32 s81, s81, s75
    s_cmp_ge_i32 s80, 0
    s_cselect_b64 exec, -1, 0
    buffer_load_dwordx4 v[116:119], v1, s[52:55], s81 offen sc0 sc1
    s_ff1_i32_b64 s80, s[84:85]
    s_bitset0_b64 s[84:85], s80
    s_lshl_b32 s81, s80, 11
    s_add_u32 s81, s81, s75
    s_cmp_ge_i32 s80, 0
    s_cselect_b64 exec, -1, 0
    buffer_load_dwordx4 v[120:123], v1, s[52:55], s81 offen sc0 sc1
    s_ff1_i32_b64 s80, s[84:85]
    s_bitset0_b64 s[84:85], s80
    s_lshl_b32 s81, s80, 11
    s_add_u32 s81, s81, s75
    s_cmp_ge_i32 s80, 0
    s_cselect_b64 exec, -1, 0
    buffer_load_dwordx4 v[124:127], v1, s[52:55], s81 offen sc0 sc1
    s_ff1_i32_b64 s80, s[84:85]
    s_bitset0_b64 s[84:85], s80
    s_lshl_b32 s81, s80, 11
    s_add_u32 s81, s81, s75
    s_cmp_ge_i32 s80, 0
    s_cselect_b64 exec, -1, 0
    buffer_load_dwordx4 v[128:131], v1, s[52:55], s81 offen sc0 sc1
    s_ff1_i32_b64 s80, s[84:85]
    s_bitset0_b64 s[84:85], s80
    s_lshl_b32 s81, s80, 11
    s_add_u32 s81, s81, s75
    s_cmp_ge_i32 s80, 0
    s_cselect_b64 exec, -1, 0
    buffer_load_dwordx4 v[132:135], v1, s[52:55], s81 offen sc0 sc1
    s_ff1_i32_b64 s80, s[84:85]
    s_bitset0_b64 s[84:85], s80
    s_lshl_b32 s81, s80, 11
    s_add_u32 s81, s81, s75
    s_cmp_ge_i32 s80, 0
    s_cselect_b64 exec, -1, 0
    buffer_load_dwordx4 v[136:139], v1, s[52:55], s81 offen sc0 sc1
    s_ff1_i32_b64 s80, s[84:85]
    s_bitset0_b64 s[84:85], s80
    s_lshl_b32 s81, s80, 11
    s_add_u32 s81, s81, s75
    s_cmp_ge_i32 s80, 0
    s_cselect_b64 exec, -1, 0
    buffer_load_dwordx4 v[140:143], v1, s[52:55], s81 offen sc0 sc1
    s_ff1_i32_b64 s80, s[84:85]
    s_bitset0_b64 s[84:85], s80
    s_lshl_b32 s81, s80, 11
    s_add_u32 s81, s81, s75
    s_cmp_ge_i32 s80, 0
    s_cbranch_scc0 L_got
    s_cselect_b64 exec, -1, 0
    buffer_load_dwordx4 v[144:147], v1, s[52:55], s81 offen sc0 sc1
    s_ff1_i32_b64 s80, s[84:85]
    s_bitset0_b64 s[84:85], s80
    s_lshl_b32 s81, s80, 11
    s_add_u32 s81, s81, s75
    s_cmp_ge_i32 s80, 0
    s_cselect_b64 exec, -1, 0
    buffer_load_dwordx4 v[148:151], v1, s[52:55], s81 offen sc0 sc1
    s_ff1_i32_b64 s80, s[84:85]
    s_bitset0_b64 s[84:85], s80
    s_lshl_b32 s81, s80, 11
    s_add_u32 s81, s81, s75
    s_cmp_ge_i32 s80, 0
    s_cselect_b64 exec, -1, 0
    buffer_load_dwordx4 v[152:155], v1, s[52:55], s81 offen sc0 sc1
    s_ff1_i32_b64 s80, s[84:85]
    s_bitset0_b64 s[84:85], s80
    s_lshl_b32 s81, s80, 11
    s_add_u32 s81, s81, s75
    s_cmp_ge_i32 s80, 0
    s_cselect_b64 exec, -1, 0
    buffer_load_dwordx4 v[156:159], v1, s[52:55], s81 offen sc0 sc1
    s_ff1_i32_b64 s80, s[84:85]
    s_bitset0_b64 s[84:85], s80
    s_lshl_b32 s81, s80, 11
    s_add_u32 s81, s81, s75
    s_cmp_ge_i32 s80, 0
    s_cselect_b64 exec, -1, 0
    buffer_load_dwordx4 v[160:163], v1, s[52:55], s81 offen sc0 sc1
    s_ff1_i32_b64 s80, s[84:85]
    s_bitset0_b64 s[84:85], s80
    s_lshl_b32 s81, s80, 11
    s_add_u32 s81, s81, s75
    s_cmp_ge_i32 s80, 0
    s_cselect_b64 exec, -1, 0
    buffer_load_dwordx4 v[164:167], v1, s[52:55], s81 offen sc0 sc1
    s_ff1_i32_b64 s80, s[84:85]
    s_bitset0_b64 s[84:85], s80
    s_lshl_b32 s81, s80, 11
    s_add_u32 s81, s81, s75
    s_cmp_ge_i32 s80, 0
    s_cselect_b64 exec, -1, 0
    buffer_load_dwordx4 v[168:171], v1, s[52:55], s81 offen sc0 sc1
    s_ff1_i32_b64 s80, s[84:85]
    s_bitset0_b64 s[84:85], s80
    s_lshl_b32 s81, s80, 11
    s_add_u32 s81, s81, s75
    s_cmp_ge_i32 s80, 0
    s_cselect_b64 exec, -1, 0
    buffer_load_dwordx4 v[172:175], v1, s[52:55], s81 offen sc0 sc1
L_got:
    s_mov_b64 exec, -1
    s_waitcnt vmcnt(0)
    v_max_f32 v5, v51, v55
    v_max3_f32 v5, v5, v59, v63
    v_max3_f32 v5, v5, v67, v71
    v_max3_f32 v5, v5, v75, v79
    v_max3_f32 v5, v5, v83, v87
    s_branch L_x3
L_w3:
    s_branch L_w4
L_x3:
    v_max3_f32 v5, v5, v91, v95
    v_max3_f32 v5, v5, v99, v103
    v_max3_f32 v5, v5, v107, v111
    v_max3_f32 v5, v5, v115, v119
    v_max3_f32 v5, v5, v123, v127
    v_max3_f32 v5, v5, v131, v135
    v_max3_f32 v5, v5, v139, v143
    v_max3_f32 v5, v5, v147, v151
    v_max3_f32 v5, v5, v155, v159
    v_max3_f32 v5, v5, v163, v167
    v_max3_f32 v5, v5, v171, v175
    s_nop 1
    v_max_f32_dpp v6, v5, v7 quad_perm:[0,0,2,2] row_mask:0xf bank_mask:0xf
    v_sub_f32 v5, v7, v6
    v_exp_f32 v5, v5
    v_mov_b32 v7, v6
    v_mul_f32 v8, v8, v5
    v_mul_f32 v12, v12, v5
    v_mul_f32 v13, v13, v5
    v_mul_f32 v14, v14, v5
    v_sub_f32_dpp v20, v51, v6 quad_perm:[0,0,2,2] row_mask:0xf bank_mask:0xf
    v_sub_f32_dpp v21, v55, v6 quad_perm:[0,0,2,2] row_mask:0xf bank_mask:0xf
    v_sub_f32_dpp v22, v59, v6 quad_perm:[0,0,2,2] row_mask:0xf bank_mask:0xf
    v_sub_f32_dpp v23, v63, v6 quad_perm:[0,0,2,2] row_mask:0xf bank_mask:0xf
    v_sub_f32_dpp v24, v67, v6 quad_perm:[0,0,2,2] row_mask:0xf bank_mask:0xf
    v_sub_f32_dpp v25, v71, v6 quad_perm:[0,0,2,2] row_mask:0xf bank_mask:0xf
    v_sub_f32_dpp v26, v75, v6 quad_perm:[0,0,2,2] row_mask:0xf bank_mask:0xf
    v_sub_f32_dpp v27, v79, v6 quad_perm:[0,0,2,2] row_mask:0xf bank_mask:0xf
    v_exp_f32 v20, v20
    v_exp_f32 v21, v21
    v_exp_f32 v22, v22
    v_exp_f32 v23, v23
    v_exp_f32 v24, v24
    v_exp_f32 v25, v25
    v_exp_f32 v26, v26
    v_exp_f32 v27, v27
    s_nop 0
    v_fmac_f32 v12, v20, v48
    v_fmac_f32 v13, v20, v49
    v_fmac_f32 v14, v20, v50
    v_fmac_f32 v8, v20, v51
    v_fmac_f32 v12, v21, v52
    v_fmac_f32 v13, v21, v53
    v_fmac_f32 v14, v21, v54
    v_fmac_f32 v8, v21, v55
    v_fmac_f32 v12, v22, v56
    v_fmac_f32 v13, v22, v57
    v_fmac_f32 v14, v22, v58
    v_fmac_f32 v8, v22, v59
    v_fmac_f32 v12, v23, v60
    v_fmac_f32 v13, v23, v61
    v_fmac_f32 v14, v23, v62
    v_fmac_f32 v8, v23, v63
    v_fmac_f32 v12, v24, v64
    v_fmac_f32 v13, v24, v65
    v_fmac_f32 v14, v24, v66
    v_fmac_f32 v8, v24, v67
    v_fmac_f32 v12, v25, v68
    v_fmac_f32 v13, v25, v69
    v_fmac_f32 v14, v25, v70
    v_fmac_f32 v8, v25, v71
    v_fmac_f32 v12, v26, v72
    v_fmac_f32 v13, v26, v73
    v_fmac_f32 v14, v26, v74
    v_fmac_f32 v8, v26, v75
    v_fmac_f32 v12, v27, v76
    v_fmac_f32 v13, v27, v77
    v_fmac_f32 v14, v27, v78
    v_fmac_f32 v8, v27, v79
    v_sub_f32_dpp v20, v83, v6 quad_perm:[0,0,2,2] row_mask:0xf bank_mask:0xf
    v_sub_f32_dpp v21, v87, v6 quad_perm:[0,0,2,2] row_mask:0xf bank_mask:0xf
    v_sub_f32_dpp v22, v91, v6 quad_perm:[0,0,2,2] row_mask:0xf bank_mask:0xf
    v_sub_f32_dpp v23, v95, v6 quad_perm:[0,0,2,2] row_mask:0xf bank_mask:0xf
    v_sub_f32_dpp v24, v99, v6 quad_perm:[0,0,2,2] row_mask:0xf bank_mask:0xf
    v_sub_f32_dpp v25, v103, v6 quad_perm:[0,0,2,2] row_mask:0xf bank_mask:0xf
    v_sub_f32_dpp v26, v107, v6 quad_perm:[0,0,2,2] row_mask:0xf bank_mask:0xf
    v_sub_f32_dpp v27, v111, v6 quad_perm:[0,0,2,2] row_mask:0xf bank_mask:0xf
    v_exp_f32 v20, v20
    v_exp_f32 v21, v21
    v_exp_f32 v22, v22
    v_exp_f32 v23, v23
    v_exp_f32 v24, v24
    v_exp_f32 v25, v25
    v_exp_f32 v26, v26
    v_exp_f32 v27, v27
    s_nop 0
    v_fmac_f32 v12, v20, v80
    v_fmac_f32 v13, v20, v81
    v_fmac_f32 v14, v20, v82
    v_fmac_f32 v8, v20, v83
    v_fmac_f32 v12, v21, v84
    v_fmac_f32 v13, v21, v85
    v_fmac_f32 v14, v21, v86
    v_fmac_f32 v8, v21, v87
    v_fmac_f32 v12, v22, v88
    v_fmac_f32 v13, v22, v89
    v_fmac_f32 v14, v22, v90
    v_fmac_f32 v8, v22, v91
    v_fmac_f32 v12, v23, v92
    v_fmac_f32 v13, v23, v93
    v_fmac_f32 v14, v23, v94
    v_fmac_f32 v8, v23, v95
    v_fmac_f32 v12, v24, v96
    v_fmac_f32 v13, v24, v97
    v_fmac_f32 v14, v24, v98
    v_fmac_f32 v8, v24, v99
    v_fmac_f32 v12, v25, v100
    v_fmac_f32 v13, v25, v101
    v_fmac_f32 v14, v25, v102
    v_fmac_f32 v8, v25, v103
    v_fmac_f32 v12, v26, v104
    v_fmac_f32 v13, v26, v105
    v_fmac_f32 v14, v26, v106
    v_fmac_f32 v8, v26, v107
    v_fmac_f32 v12, v27, v108
    v_fmac_f32 v13, v27, v109
    v_fmac_f32 v14, v27, v110
    v_fmac_f32 v8, v27, v111
    v_sub_f32_dpp v20, v115, v6 quad_perm:[0,0,2,2] row_mask:0xf bank_mask:0xf
    v_sub_f32_dpp v21, v119, v6 quad_perm:[0,0,2,2] row_mask:0xf bank_mask:0xf
    v_sub_f32_dpp v22, v123, v6 quad_perm:[0,0,2,2] row_mask:0xf bank_mask:0xf
    v_sub_f32_dpp v23, v127, v6 quad_perm:[0,0,2,2] row_mask:0xf bank_mask:0xf
    v_sub_f32_dpp v24, v131, v6 quad_perm:[0,0,2,2] row_mask:0xf bank_mask:0xf
    v_sub_f32_dpp v25, v135, v6 quad_perm:[0,0,2,2] row_mask:0xf bank_mask:0xf
    v_sub_f32_dpp v26, v139, v6 quad_perm:[0,0,2,2] row_mask:0xf bank_mask:0xf
    v_sub_f32_dpp v27, v143, v6 quad_perm:[0,0,2,2] row_mask:0xf bank_mask:0xf
    v_exp_f32 v20, v20
    v_exp_f32 v21, v21
    v_exp_f32 v22, v22
    v_exp_f32 v23, v23
    v_exp_f32 v24, v24
    v_exp_f32 v25, v25
    v_exp_f32 v26, v26
    v_exp_f32 v27, v27
    s_nop 0
    v_fmac_f32 v12, v20, v112
    v_fmac_f32 v13, v20, v113
    v_fmac_f32 v14, v20, v114
    v_fmac_f32 v8, v20, v115
    v_fmac_f32 v12, v21, v116
    v_fmac_f32 v13, v21, v117
    v_fmac_f32 v14, v21, v118
    v_fmac_f32 v8, v21, v119
    v_fmac_f32 v12, v22, v120
    v_fmac_f32 v13, v22, v121
    v_fmac_f32 v14, v22, v122
    v_fmac_f32 v8, v22, v123
    v_fmac_f32 v12, v23, v124
    v_fmac_f32 v13, v23, v125
    v_fmac_f32 v14, v23, v126
    v_fmac_f32 v8, v23, v127
    v_fmac_f32 v12, v24, v128
    v_fmac_f32 v13, v24, v129
    v_fmac_f32 v14, v24, v130
    v_fmac_f32 v8, v24, v131
    v_fmac_f32 v12, v25, v132
    v_fmac_f32 v13, v25, v133
    v_fmac_f32 v14, v25, v134
    v_fmac_f32 v8, v25, v135
    v_fmac_f32 v12, v26, v136
    v_fmac_f32 v13, v26, v137
    v_fmac_f32 v14, v26, v138
    v_fmac_f32 v8, v26, v139
    v_fmac_f32 v12, v27, v140
    v_fmac_f32 v13, v27, v141
    v_fmac_f32 v14, v27, v142
    v_fmac_f32 v8, v27, v143
    v_sub_f32_dpp v20, v147, v6 quad_perm:[0,0,2,2] row_mask:0xf bank_mask:0xf
    v_sub_f32_dpp v21, v151, v6 quad_perm:[0,0,2,2] row_mask:0xf bank_mask:0xf
    v_sub_f32_dpp v22, v155, v6 quad_perm:[0,0,2,2] row_mask:0xf bank_mask:0xf
    v_sub_f32_dpp v23, v159, v6 quad_perm:[0,0,2,2] row_mask:0xf bank_mask:0xf
    v_sub_f32_dpp v24, v163, v6 quad_perm:[0,0,2,2] row_mask:0xf bank_mask:0xf
    v_sub_f32_dpp v25, v167, v6 quad_perm:[0,0,2,2] row_mask:0xf bank_mask:0xf
    v_sub_f32_dpp v26, v171, v6 quad_perm:[0,0,2,2] row_mask:0xf bank_mask:0xf
    v_sub_f32_dpp v27, v175, v6 quad_perm:[0,0,2,2] row_mask:0xf bank_mask:0xf
    v_exp_f32 v20, v20
    v_exp_f32 v21, v21
    v_exp_f32 v22, v22
    v_exp_f32 v23, v23
    v_exp_f32 v24, v24
    v_exp_f32 v25, v25
    v_exp_f32 v26, v26
    v_exp_f32 v27, v27
    s_nop 0
    v_fmac_f32 v12, v20, v144
    v_fmac_f32 v13, v20, v145
    v_fmac_f32 v14, v20, v146
    v_fmac_f32 v8, v20, v147
    v_fmac_f32 v12, v21, v148
    v_fmac_f32 v13, v21, v149
    v_fmac_f32 v14, v21, v150
    v_fmac_f32 v8, v21, v151
    v_fmac_f32 v12, v22, v152
    v_fmac_f32 v13, v22, v153
    v_fmac_f32 v14, v22, v154
    v_fmac_f32 v8, v22, v155
    v_fmac_f32 v12, v23, v156
    v_fmac_f32 v13, v23, v157
    v_fmac_f32 v14, v23, v158
    v_fmac_f32 v8, v23, v159
    v_fmac_f32 v12, v24, v160
    v_fmac_f32 v13, v24, v161
    v_fmac_f32 v14, v24, v162
    v_fmac_f32 v8, v24, v163
    v_fmac_f32 v12, v25, v164
    v_fmac_f32 v13, v25, v165
    v_fmac_f32 v14, v25, v166
    v_fmac_f32 v8, v25, v167
    v_fmac_f32 v12, v26, v168
    v_fmac_f32 v13, v26, v169
    v_fmac_f32 v14, v26, v170
    v_fmac_f32 v8, v26, v171
    v_fmac_f32 v12, v27, v172
    v_fmac_f32 v13, v27, v173
    v_fmac_f32 v14, v27, v174
    v_fmac_f32 v8, v27, v175
    s_cmp_lg_u64 s[84:85], 0
    s_cbranch_scc1 L_chunk
    s_cmp_lg_u32 s74, 0
    s_cbranch_scc1 L_fin
    v_cndmask_b32 v15, v7, v8, s[66:67]
    v_mov_b32 v5, s95
    s_and_b32 s79, s97, 31
    s_lshr_b32 s80, s97, 10
    s_lshl_b32 s80, s80, 3
    s_and_b32 s83, s72, 7
    s_add_u32 s80, s80, s83
    s_bfm_b64 s[88:89], 1, s80
    s_bfe_u32 s83, s97, 0x50005
    s_mul_i32 s83, s83, s70
    s_cmp_lg_u32 s83, 512
    s_cbranch_scc1 L_rec
    s_mov_b64 exec, 1
    buffer_store_dword v5, v3, s[52:55], s77 offen offset:1028
    s_mov_b64 exec, -1
    s_branch L_fin
L_rec:
    s_lshl_b32 s83, s83, 16
    s_or_b32 s89, s89, s83
    v_mov_b32 v16, s88
    v_mov_b32 v17, s89
    s_lshl_b32 s75, s79, 17
    s_add_u32 s75, s75, 4194304
    s_lshl_b32 s80, s80, 11
    s_add_u32 s80, s80, s75
    buffer_store_dwordx4 v[12:15], v1, s[52:55], s80 offen sc0 sc1
    s_mov_b64 exec, 1
    buffer_store_dword v5, v3, s[52:55], s77 offen offset:1028
    s_lshl_b32 s80, s79, 8
    s_add_u32 s80, s80, 23076864
    s_waitcnt vmcnt(0)
    buffer_atomic_add_x2 v[16:17], v3, s[52:55], s80 offen sc0 sc1
    s_waitcnt vmcnt(0)
    s_mov_b64 exec, -1
    v_readfirstlane_b32 s84, v16
    v_readfirstlane_b32 s85, v17
    s_add_u32 s84, s84, s88
    s_add_u32 s85, s85, s89
    s_lshr_b32 s80, s85, 16
    s_cmp_lg_u32 s80, 512
    s_cbranch_scc1 L_next
    s_mov_b32 s74, 1
    s_and_b32 s85, s85, 0xffff
    s_branch L_merge
L_fin:
    s_nop 1
    v_mov_b32_dpp v5, v8 quad_perm:[1,1,3,3] row_mask:0xf bank_mask:0xf
    v_rcp_f32 v5, v5
    s_mul_i32 s80, s79, 384
    v_mul_f32 v12, v12, v5
    v_mul_f32 v13, v13, v5
    v_mul_f32 v14, v14, v5
    v_cvt_pk_bf16_f32 v12, v12, v12
    v_cvt_pk_bf16_f32 v13, v13, v13
    v_cvt_pk_bf16_f32 v14, v14, v14
    buffer_store_short v12, v11, s[56:59], s80 offen offset:0
    buffer_store_short v13, v11, s[56:59], s80 offen offset:128
    buffer_store_short v14, v11, s[56:59], s80 offen offset:256
L_next:
    s_add_u32 s71, s71, s70
    s_branch L_round
L_last:
    s_lshl_b32 s75, s96, 9
    s_add_u32 s75, s75, 1572864
    v_lshrrev_b32 v6, 1, v0
    v_lshlrev_b32 v28, 4, v6
L_inf:
    buffer_load_dwordx4 v[48:51], v28, s[52:55], s75 offen sc0 sc1
    s_waitcnt vmcnt(0)
    v_cmp_ne_u32 vcc, s69, v49
    s_cmp_lg_u64 vcc, 0
    s_cbranch_scc1 L_inf
    v_mov_b32 v7, v50
    s_nop 1
    v_max_f32_dpp v7, v7, v7 row_ror:8 row_mask:0xf bank_mask:0xf
    s_nop 1
    v_max_f32_dpp v7, v7, v7 row_ror:4 row_mask:0xf bank_mask:0xf
    s_nop 1
    v_max_f32_dpp v7, v7, v7 row_ror:2 row_mask:0xf bank_mask:0xf
    s_nop 1
    v_max_f32_dpp v7, v7, v7 row_ror:1 row_mask:0xf bank_mask:0xf
    v_mov_b32 v5, v7
    s_nop 1
    v_permlane32_swap_b32 v7, v5
    s_nop 1
    v_max_f32 v7, v7, v5
    v_mov_b32 v5, v7
    s_nop 1
    v_permlane16_swap_b32 v7, v5
    s_nop 1
    v_max_f32 v7, v7, v5
    v_sub_f32 v20, v50, v7
    v_exp_f32 v20, v20
    s_nop 0
    v_mul_f32 v8, v20, v51
    s_nop 1
    v_add_f32_dpp v8, v8, v8 row_ror:8 row_mask:0xf bank_mask:0xf
    s_nop 1
    v_add_f32_dpp v8, v8, v8 row_ror:4 row_mask:0xf bank_mask:0xf
    s_nop 1
    v_add_f32_dpp v8, v8, v8 row_ror:2 row_mask:0xf bank_mask:0xf
    s_nop 1
    v_add_f32_dpp v8, v8, v8 row_ror:1 row_mask:0xf bank_mask:0xf
    v_mov_b32 v5, v8
    s_nop 1
    v_permlane32_swap_b32 v8, v5
    s_nop 1
    v_add_f32 v8, v8, v5
    v_mov_b32 v5, v8
    s_nop 1
    v_permlane16_swap_b32 v8, v5
    s_nop 1
    v_add_f32 v8, v8, v5
    v_rcp_f32 v8, v8
    v_and_b32 v5, 1, v0
    v_mul_f32 v8, 2.0, v8
    v_mul_f32 v20, v20, v8
    v_lshlrev_b32 v28, 11, v6
    v_lshl_add_u32 v28, v5, 4, v28
    s_lshl_b32 s75, s96, 16
    s_lshl_b32 s80, s92, 5
    s_add_u32 s75, s75, s80
    v_mov_b32 v51, 0
    v_mov_b32 v55, 0
    v_mov_b32 v59, 0
    v_mov_b32 v63, 0
    v_mov_b32 v12, 0
    v_mov_b32 v13, 0
    v_mov_b32 v14, 0
    v_bfe_u32 v6, v0, 4, 1
    v_lshrrev_b32 v11, 5, v0
    v_lshl_add_u32 v11, v6, 1, v11
    v_lshlrev_b32 v11, 7, v11
    v_lshl_add_u32 v11, v5, 3, v11
    s_and_b32 s80, s92, 7
    s_lshl_b32 s80, s80, 4
    s_lshr_b32 s81, s92, 3
    s_lshl_b32 s81, s81, 1
    s_add_u32 s80, s80, s81
    s_add_u32 s79, s96, 24
    s_mul_i32 s78, s79, 384
    s_add_u32 s78, s78, s80
    s_mov_b64 s[24:25], -1
    s_mov_b32 s32, 0x00030003
    s_mov_b32 s33, 0x00000003
L_dt:
    ds_read_b32 v5, v3 offset:144
    s_waitcnt lgkmcnt(0)
    v_readfirstlane_b32 s80, v5
    s_cmp_eq_u32 s80, 0
    s_cbranch_scc1 L_dt
L_pa:
    buffer_load_dwordx4 v[48:51], v28, s[52:55], s75 offen offset:0 sc0 sc1
    s_waitcnt vmcnt(0)
    v_cmpx_eq_u32 vcc, s69, v51
    v_fmac_f32 v12, v20, v48
    v_fmac_f32 v13, v20, v49
    v_fmac_f32 v14, v20, v50
    s_andn2_b64 s[24:25], s[24:25], vcc
    s_mov_b64 exec, s[24:25]
    s_bcnt1_i32_b64 s80, s[24:25]
    s_cmp_gt_u32 s80, 0
    s_cbranch_scc1 L_pa
L_pd:
    s_mov_b64 exec, -1
    v_mov_b32 v15, v14
    v_permlane32_swap_b32 v12, v13
    s_nop 0
    v_permlane32_swap_b32 v14, v15
    v_add_f32 v12, v12, v13
    v_add_f32 v14, v14, v15
    s_nop 1
    v_permlane16_swap_b32 v12, v14
    v_add_f32 v12, v12, v14
    s_nop 1
    v_add_f32_dpp v12, v12, v12 row_ror:8 row_mask:0xf bank_mask:0xf
    s_nop 1
    v_add_f32_dpp v12, v12, v12 row_ror:4 row_mask:0xf bank_mask:0xf
    s_nop 1
    v_add_f32_dpp v12, v12, v12 row_ror:2 row_mask:0xf bank_mask:0xf
    s_mov_b64 exec, s[32:33]
    v_cvt_pk_bf16_f32 v12, v12, v12
    buffer_store_short v12, v11, s[56:59], s78 offen
L_end:
    s_endpgm
L_ticket:
    v_lshlrev_b32 v1, 2, v0
    v_mov_b32 v2, 0
    v_lshlrev_b32 v4, 4, v0
    v_mov_b32 v8, -1
    v_mov_b32 v9, -1
    v_mov_b32 v10, -1
    v_mov_b32 v11, -1
    ds_write_b128 v4, v[8:11] offset:256
    ds_write_b128 v4, v[8:11] offset:1280
    ds_write_b128 v4, v[8:11] offset:2304
    s_memrealtime s[80:81]
    s_mul_i32 s24, s79, 25165824
    s_add_u32 s25, s24, 1572800
    s_mul_i32 s26, s79, 196608
    s_mov_b32 s27, 2097152
    s_mov_b32 s28, 4194304
    s_mov_b32 s29, 6291392
    s_mov_b32 s30, 2097088
    s_waitcnt lgkmcnt(0)
    s_load_dword s31, s[6:7], s24
    s_load_dword s32, s[10:11], s26
    s_load_dword s33, s[12:13], s26
    s_load_dword s34, s[4:5], 0
    s_load_dword s35, s[6:7], s25
    s_load_dword s36, s[10:11], 0
    s_load_dword s37, s[12:13], 0
    s_load_dword s38, s[10:11], s27
    s_load_dword s39, s[12:13], s27
    s_load_dword s40, s[10:11], s28
    s_load_dword s41, s[12:13], s28
    s_load_dword s42, s[10:11], s29
    s_load_dword s43, s[12:13], s29
    s_load_dword s44, s[14:15], 0
    s_load_dword s45, s[16:17], 0
    s_load_dword s46, s[14:15], s30
    s_load_dword s47, s[16:17], s30
    s_barrier
    s_mov_b32 s52, s22
    s_and_b32 s53, s23, 0xffff
    s_mov_b32 s54, 25165824
    s_mov_b32 s55, 0x00020000
    s_mov_b32 s60, s20
    s_and_b32 s61, s21, 0xffff
    s_mov_b32 s62, 256
    s_mov_b32 s63, 0x00020000
    s_max_u32 s69, s80, 1
    s_cmp_lg_u32 s2, 0
    s_cbranch_scc1 L_kd
    v_lshlrev_b32 v5, 8, v0
    s_mov_b32 s80, 23068672
    v_mov_b32 v3, 0
    buffer_store_dwordx2 v[2:3], v5, s[52:55], s80 offen sc0 sc1
    v_mov_b32 v3, s69
    s_mov_b64 exec, 1
    s_waitcnt vmcnt(0)
    buffer_store_dword v3, v2, s[60:63], 0 offen sc0 sc1
    s_mov_b64 exec, -1
L_kd:
    ds_read_b32 v3, v2 offset:128
    s_waitcnt lgkmcnt(0)
    v_readfirstlane_b32 s80, v3
    s_cmp_eq_u32 s80, 0
    s_cbranch_scc1 L_kd
    ds_read_b128 v[24:27], v4 offset:16128
    ds_read_b128 v[28:31], v4 offset:17152
    ds_read_b128 v[32:35], v4 offset:18176
    ds_read_b128 v[36:39], v4 offset:19200
    s_waitcnt lgkmcnt(0)
    v_max_f32 v18, v24, v25
    v_max3_f32 v18, v18, v26, v27
    v_max3_f32 v18, v18, v28, v29
    v_max3_f32 v18, v18, v30, v31
    v_max3_f32 v18, v18, v32, v33
    v_max3_f32 v18, v18, v34, v35
    v_max3_f32 v18, v18, v36, v37
    v_max3_f32 v18, v18, v38, v39
    s_nop 1
    v_max_f32_dpp v18, v18, v18 row_ror:8 row_mask:0xf bank_mask:0xf
    s_nop 1
    v_max_f32_dpp v18, v18, v18 row_ror:4 row_mask:0xf bank_mask:0xf
    s_nop 1
    v_max_f32_dpp v18, v18, v18 row_ror:2 row_mask:0xf bank_mask:0xf
    s_nop 1
    v_max_f32_dpp v18, v18, v18 row_ror:1 row_mask:0xf bank_mask:0xf
    v_mov_b32 v3, v18
    s_nop 1
    v_permlane32_swap_b32 v18, v3
    s_nop 1
    v_max_f32 v18, v18, v3
    v_mov_b32 v3, v18
    s_nop 1
    v_permlane16_swap_b32 v18, v3
    s_nop 1
    v_max_f32 v18, v18, v3
    v_sub_f32 v24, v24, v18
    v_sub_f32 v25, v25, v18
    v_sub_f32 v26, v26, v18
    v_sub_f32 v27, v27, v18
    v_sub_f32 v28, v28, v18
    v_sub_f32 v29, v29, v18
    v_sub_f32 v30, v30, v18
    v_sub_f32 v31, v31, v18
    v_sub_f32 v32, v32, v18
    v_sub_f32 v33, v33, v18
    v_sub_f32 v34, v34, v18
    v_sub_f32 v35, v35, v18
    v_sub_f32 v36, v36, v18
    v_sub_f32 v37, v37, v18
    v_sub_f32 v38, v38, v18
    v_sub_f32 v39, v39, v18
    v_exp_f32 v24, v24
    v_exp_f32 v25, v25
    v_exp_f32 v26, v26
    v_exp_f32 v27, v27
    v_exp_f32 v28, v28
    v_exp_f32 v29, v29
    v_exp_f32 v30, v30
    v_exp_f32 v31, v31
    v_exp_f32 v32, v32
    v_exp_f32 v33, v33
    v_exp_f32 v34, v34
    v_exp_f32 v35, v35
    v_exp_f32 v36, v36
    v_exp_f32 v37, v37
    v_exp_f32 v38, v38
    v_exp_f32 v39, v39
    ds_write_b32 v2, v18 offset:160
    v_add_f32 v19, v24, v25
    v_add_f32 v19, v19, v26
    v_add_f32 v19, v19, v27
    v_add_f32 v19, v19, v28
    v_add_f32 v19, v19, v29
    v_add_f32 v19, v19, v30
    v_add_f32 v19, v19, v31
    v_add_f32 v19, v19, v32
    v_add_f32 v19, v19, v33
    v_add_f32 v19, v19, v34
    v_add_f32 v19, v19, v35
    v_add_f32 v19, v19, v36
    v_add_f32 v19, v19, v37
    v_add_f32 v19, v19, v38
    v_add_f32 v19, v19, v39
    s_nop 1
    v_add_f32_dpp v19, v19, v19 row_ror:8 row_mask:0xf bank_mask:0xf
    s_nop 1
    v_add_f32_dpp v19, v19, v19 row_ror:4 row_mask:0xf bank_mask:0xf
    s_nop 1
    v_add_f32_dpp v19, v19, v19 row_ror:2 row_mask:0xf bank_mask:0xf
    s_nop 1
    v_add_f32_dpp v19, v19, v19 row_ror:1 row_mask:0xf bank_mask:0xf
    v_mov_b32 v3, v19
    s_nop 1
    v_permlane32_swap_b32 v19, v3
    s_nop 1
    v_add_f32 v19, v19, v3
    v_mov_b32 v3, v19
    s_nop 1
    v_permlane16_swap_b32 v19, v3
    s_nop 1
    v_add_f32 v19, v19, v3
    s_lshl_b32 s80, s2, 11
    s_add_u32 s80, s80, 18874368
    s_waitcnt lgkmcnt(0)
    s_mov_b64 exec, -1
L_tg:
    buffer_load_dword v3, v2, s[60:63], 0 offen sc0 sc1
    s_waitcnt vmcnt(0)
    v_readfirstlane_b32 s69, v3
    s_cmp_eq_u32 s69, 0
    s_cbranch_scc1 L_tg
    s_getreg_b32 s81, hwreg(HW_REG_XCC_ID)
    s_and_b32 s81, s81, 15
    v_mov_b32 v16, s81
    v_mov_b32 v17, s69
    s_lshl_b32 s80, s2, 11
    s_mov_b64 exec, 1
    s_lshl_b32 s82, s2, 4
    s_add_u32 s82, s82, 1572864
    buffer_store_dwordx4 v[16:19], v2, s[52:55], s82 offen sc0 sc1
    v_mov_b32 v12, s69
    v_mov_b32 v13, s69
    s_add_u32 s82, s80, 2097152
    buffer_store_dwordx2 v[12:13], v2, s[52:55], s82 offen offset:1024
    s_add_u32 s82, s80, 2621440
    buffer_store_dwordx2 v[12:13], v2, s[52:55], s82 offen offset:1024
    s_mov_b64 exec, -1
    s_mov_b32 s73, s81
    s_lshl_b32 s80, s79, 2
    s_lshr_b32 s74, 0x54465464, s80
    s_and_b32 s74, s74, 15
    s_mov_b32 s75, 0
    s_mov_b32 s95, s69
    s_lshl_b32 s77, s2, 11
    s_lshl_b32 s94, s79, 16
    s_mov_b32 s76, 2097152
    v_mov_b32 v19, 0
    v_lshlrev_b32 v20, 11, v0
    v_mov_b32 v21, v4
L_fl:
    ds_read_b32 v3, v19
    s_waitcnt lgkmcnt(0)
    v_readfirstlane_b32 s80, v3
    s_cmp_eq_u32 s80, 0
    s_cbranch_scc1 L_fl
    ds_read_b128 v[24:27], v21 offset:20480
    ds_read_b128 v[28:31], v21 offset:21504
    ds_read_b128 v[32:35], v21 offset:22528
    ds_read_b128 v[36:39], v21 offset:23552
    s_waitcnt lgkmcnt(0)
    s_nop 0
    v_add_f32_dpp v37, v37, v37 row_ror:8 row_mask:0xf bank_mask:0xf
    v_add_f32_dpp v38, v38, v38 row_ror:8 row_mask:0xf bank_mask:0xf
    s_nop 0
    v_add_f32_dpp v37, v37, v37 row_ror:4 row_mask:0xf bank_mask:0xf
    v_add_f32_dpp v38, v38, v38 row_ror:4 row_mask:0xf bank_mask:0xf
    s_nop 0
    v_add_f32_dpp v37, v37, v37 row_ror:2 row_mask:0xf bank_mask:0xf
    v_add_f32_dpp v38, v38, v38 row_ror:2 row_mask:0xf bank_mask:0xf
    s_nop 0
    v_add_f32_dpp v37, v37, v37 row_ror:1 row_mask:0xf bank_mask:0xf
    v_add_f32_dpp v38, v38, v38 row_ror:1 row_mask:0xf bank_mask:0xf
    v_mov_b32 v40, v36
    v_mov_b32 v41, v36
    s_nop 1
    v_permlane32_swap_b32 v40, v41
    s_nop 1
    v_max_f32 v40, v40, v41
    v_mov_b32 v41, v40
    s_nop 1
    v_permlane16_swap_b32 v40, v41
    s_nop 1
    v_max_f32 v40, v40, v41
    v_sub_f32 v41, v36, v40
    v_exp_f32 v41, v41
    v_mov_b32 v48, v40
    v_mul_f32 v37, v37, v41
    v_mul_f32 v38, v38, v41
    v_mul_f32 v41, 0x58000000, v41
    v_fma_f32 v24, v24, v41, -v38
    v_fma_f32 v25, v25, v41, -v38
    v_fma_f32 v26, v26, v41, -v38
    v_fma_f32 v27, v27, v41, -v38
    v_fma_f32 v28, v28, v41, -v38
    v_fma_f32 v29, v29, v41, -v38
    v_fma_f32 v30, v30, v41, -v38
    v_fma_f32 v31, v31, v41, -v38
    v_fma_f32 v32, v32, v41, -v38
    v_fma_f32 v33, v33, v41, -v38
    v_fma_f32 v34, v34, v41, -v38
    v_fma_f32 v35, v35, v41, -v38
    v_mov_b32 v40, v37
    s_nop 1
    v_permlane32_swap_b32 v37, v40
    v_permlane32_swap_b32 v24, v26
    v_permlane32_swap_b32 v25, v27
    v_permlane32_swap_b32 v28, v30
    v_permlane32_swap_b32 v29, v31
    v_permlane32_swap_b32 v32, v34
    v_permlane32_swap_b32 v33, v35
    s_nop 1
    v_add_f32 v37, v37, v40
    v_add_f32 v24, v24, v26
    v_add_f32 v25, v25, v27
    v_add_f32 v28, v28, v30
    v_add_f32 v29, v29, v31
    v_add_f32 v32, v32, v34
    v_add_f32 v33, v33, v35
    v_mov_b32 v40, v37
    s_nop 1
    v_permlane16_swap_b32 v37, v40
    v_permlane16_swap_b32 v24, v25
    v_permlane16_swap_b32 v28, v29
    v_permlane16_swap_b32 v32, v33
    s_nop 1
    v_add_f32 v49, v37, v40
    v_add_f32 v44, v24, v25
    v_add_f32 v45, v28, v29
    v_add_f32 v46, v32, v33
    v_mov_b32 v8, v44
    v_mov_b32 v9, v45
    v_mov_b32 v10, v46
    v_cndmask_b32 v11, v48, v49, s[66:67]
    s_cmp_eq_u32 s75, 1
    s_cbranch_scc1 L_dep
    s_cmp_lg_u32 s75, 0
    s_cbranch_scc1 L_guard
    s_lshr_b32 s82, s3, 5
    s_lshl_b32 s83, s79, 9
    s_add_u32 s83, s83, 1572864
    s_bfm_b64 exec, 32, 0
L_reg:
    buffer_load_dwordx2 v[12:13], v4, s[52:55], s83 offen sc0 sc1
    s_waitcnt vmcnt(0)
    v_cmp_ne_u32 vcc, s69, v13
    s_cmp_lg_u64 vcc, 0
    s_cbranch_scc1 L_reg
    v_cmp_eq_u32 s[86:87], s73, v12
    s_nop 1
    v_mov_b32 v14, s86
    v_mov_b32 v15, s87
    ds_write_b64 v2, v[14:15] offset:152
    s_waitcnt lgkmcnt(0)
    ds_write_b32 v2, v13 offset:140
    s_mov_b64 exec, -1
    s_branch L_dep
L_guard:
    s_sub_u32 s80, s95, 1
    s_add_u32 s81, s94, s76
L_guard2:
    v_mov_b32 v12, s69
    s_mov_b64 exec, s[86:87]
    buffer_load_dword v12, v20, s[52:55], s81 offen offset:1028 sc0 sc1
    s_mov_b64 exec, -1
    s_waitcnt vmcnt(0)
    v_cmp_eq_u32 vcc, s80, v12
    s_cmp_eq_u64 vcc, 0
    s_cbranch_scc1 L_guard2
L_dep:
    s_add_u32 s75, s75, 1
    s_add_u32 s95, s95, 1
    s_add_u32 s80, s77, s76
    v_mov_b32 v3, s95
    s_waitcnt lgkmcnt(0)
    buffer_store_dwordx4 v[8:11], v4, s[52:55], s80 offen
    s_mov_b64 exec, 1
    s_waitcnt vmcnt(0)
    buffer_store_dword v3, v2, s[52:55], s80 offen offset:1024
    s_mov_b64 exec, -1
    s_xor_b32 s76, s76, 0x80000
    v_add_u32 v21, 4096, v21
    v_add_u32 v19, 4, v19
    s_cmp_lt_u32 s75, s74
    s_cbranch_scc1 L_fl
    s_endpgm
L_ctl:
    v_lshlrev_b32 v1, 2, v0
    v_mov_b32 v2, 0
    ds_write_b32 v1, v2 offset:3328
    s_and_b32 s70, s2, 31
    s_lshl_b32 s70, s70, 2
    s_mov_b32 s71, 1
    v_mov_b32 v7, s2
    v_and_b32 v10, 15, v0
    v_lshrrev_b32 v8, 5, v7
    v_lshl_add_u32 v10, v8, 4, v10
    v_lshrrev_b32 v9, 4, v0
    v_lshl_add_u32 v10, v9, 7, v10
    s_lshl_b32 s82, s79, 3
    s_mov_b32 s80, 0xeff4fa00
    s_mov_b32 s81, 0xdbe0e5ea
    s_lshr_b64 s[80:81], s[80:81], s82
    s_sext_i32_i8 s80, s80
    s_mov_b32 exec_lo, 0x0
    s_mov_b32 exec_hi, 0x3ff
    v_add_u32 v10, s80, v10
    s_mov_b32 s80, 0xeff43d4c
    s_mov_b32 s81, 0xdbe0e5ea
    s_lshr_b64 s[80:81], s[80:81], s82
    s_sext_i32_i8 s80, s80
    s_mov_b32 exec_lo, 0x0
    s_mov_b32 exec_hi, 0x400
    v_add_u32 v10, s80, v10
    s_mov_b32 s80, 0x2c37424d
    s_mov_b32 s81, 0xb1621
    s_lshr_b64 s[80:81], s[80:81], s82
    s_sext_i32_i8 s80, s80
    s_mov_b32 exec_lo, 0x0
    s_mov_b32 exec_hi, 0xf800
    v_add_u32 v10, s80, v10
    s_mov_b64 exec, -1
    v_mul_u32_u24 v30, 1572864, v10
    v_and_b32 v9, 3, v7
    v_lshl_add_u32 v8, v10, 2, v9
    v_bfe_u32 v9, v7, 2, 3
    v_lshl_add_u32 v8, v8, 3, v9
    v_mul_u32_u24 v9, 384, v8
    v_lshlrev_b32 v8, 7, v8
    s_waitcnt lgkmcnt(0)
    s_mov_b32 s32, s10
    s_and_b32 s33, s11, 0xffff
    s_mov_b32 s34, 6291456
    s_mov_b32 s35, 0x00020000
    buffer_load_dword v10, v9, s[32:35], 0 offen offset:0
    buffer_load_dword v11, v9, s[32:35], 0 offen offset:128
    buffer_load_dword v12, v9, s[32:35], 0 offen offset:256
    s_mov_b32 s36, s12
    s_and_b32 s37, s13, 0xffff
    s_mov_b32 s38, 6291456
    s_mov_b32 s39, 0x00020000
    buffer_load_dword v13, v9, s[36:39], 0 offen offset:0
    buffer_load_dword v14, v9, s[36:39], 0 offen offset:128
    buffer_load_dword v15, v9, s[36:39], 0 offen offset:256
    s_mov_b32 s40, s14
    s_and_b32 s41, s15, 0xffff
    s_mov_b32 s42, 2097152
    s_mov_b32 s43, 0x00020000
    buffer_load_dword v16, v8, s[40:43], 0 offen offset:0
    s_mov_b32 s44, s16
    s_and_b32 s45, s17, 0xffff
    s_mov_b32 s46, 2097152
    s_mov_b32 s47, 0x00020000
    buffer_load_dword v17, v8, s[44:47], 0 offen offset:0
    s_mov_b32 s52, s22
    s_and_b32 s53, s23, 0xffff
    s_mov_b32 s54, 25165824
    s_branch L_x4
L_w4:
    s_branch L_walked
L_x4:
    s_mov_b32 s55, 0x00020000
    v_lshlrev_b32 v7, 7, v0
    s_lshl_b32 s80, s2, 11
    s_add_u32 s81, s80, 2097152
    s_add_u32 s82, s80, 2621440
    s_mov_b64 exec, 0x1ff
    buffer_load_dword v18, v7, s[52:55], s81 offen
    buffer_load_dword v19, v7, s[52:55], s82 offen
    s_mov_b64 exec, -1
    s_barrier
    s_mov_b32 s60, s20
    s_and_b32 s61, s21, 0xffff
    s_mov_b32 s62, 256
    s_mov_b32 s63, 0x00020000
    s_mov_b32 s52, s22
    s_and_b32 s53, s23, 0xffff
    s_mov_b32 s54, 25165824
    s_mov_b32 s55, 0x00020000
    s_getreg_b32 s76, hwreg(HW_REG_XCC_ID)
    s_and_b32 s76, s76, 15
    s_lshr_b32 s70, s70, 1
    s_and_b32 s75, s2, 31
    s_cmp_eq_u32 s75, 0
    s_cselect_b32 s75, 32, s75
    s_mul_i32 s77, s75, 64
    v_lshlrev_b32 v1, 1, v0
    v_lshlrev_b32 v7, 7, v0
    s_mov_b32 s24, s6
    s_and_b32 s25, s7, 0xffff
    s_mov_b32 s26, 805306368
    s_mov_b32 s27, 0x00020000
    s_mov_b32 s28, s8
    s_and_b32 s29, s9, 0xffff
    s_mov_b32 s30, 805306368
    s_mov_b32 s31, 0x00020000
    s_and_b32 s88, s2, 31
    s_lshl_b32 s89, s88, 4
    s_sub_i32 s89, s89, 63
    s_mov_b32 s90, 1572800
L_c:
    ds_read_b32 v3, v2 offset:3328
    ds_read_b32 v4, v2 offset:144
    s_mov_b64 exec, 1
    s_waitcnt lgkmcnt(0)
    v_add_u32 v3, 1, v3
    buffer_store_short v3, v2, s[60:63], s70 offen offset:128
    s_bfm_b64 exec, 33, 0
    buffer_load_ushort v5, v1, s[60:63], 0 offen offset:128 sc1
    v_readfirstlane_b32 s72, v3
    v_readfirstlane_b32 s81, v4
    s_add_u32 s80, s71, s72
    s_mov_b32 s71, s72
    s_mov_b64 exec, 0xffffffff
    s_waitcnt vmcnt(0)
    v_cmp_ne_u32 vcc, 0, v5
    v_lshlrev_b32 v6, 1, v5
    v_readlane_b32 s86, v5, 32
    v_cmp_le_u32 s[82:83], s80, v6
    s_bcnt1_i32_b64 s73, vcc
    s_cmp_eq_u32 s86, 0
    s_cselect_b32 s86, 1024, s86
    s_bcnt1_i32_b64 s74, s[82:83]
    s_sub_i32 s86, s86, 1003
    s_mul_i32 s80, s73, s86
    s_lshl_b32 s74, s74, 5
    s_cmp_lt_i32 s74, s80
    s_cselect_b32 s86, 1, 0
    s_lshl_b32 s82, s73, 5
    s_add_u32 s74, s74, s82
    s_cmp_lt_i32 s74, s80
    s_cselect_b32 s86, 2, s86
    v_mov_b32 v6, s86
    ds_write_b32 v2, v6 offset:148
    s_cmp_lt_i32 s72, s89
    s_cbranch_scc1 L_ntp
    v_readlane_b32 s87, v30, s88
    s_min_u32 s87, s87, 803733504
    s_cmp_ge_u32 s88, 64
    s_cbranch_scc1 L_tpv
    s_load_dword s90, s[6:7], s87
    s_add_u32 s87, s87, 1572800
    s_load_dword s91, s[6:7], s87
    s_branch L_tpd
L_tpv:
    s_load_dword s90, s[8:9], s87
    s_add_u32 s87, s87, 1572800
    s_load_dword s91, s[8:9], s87
L_tpd:
    s_add_u32 s88, s88, 32
    s_add_i32 s89, s89, 512
    s_cmp_ge_u32 s88, 128
    s_cselect_b32 s89, 0x7fffffff, s89
    s_mov_b64 exec, 0xffffffff
L_ntp:
    s_cmp_lt_u32 s72, s77
    s_cbranch_scc1 L_cn
    s_memrealtime s[84:85]
    s_add_u32 s77, s77, 2048
    s_lshl_b32 s86, s75, 11
    s_add_u32 s75, s75, 32
    s_cmp_lg_u32 s73, 32
    s_cbranch_scc1 L_cn
    v_add_u32_dpp v5, v5, v5 row_ror:8 row_mask:0xf bank_mask:0xf
    s_nop 1
    v_add_u32_dpp v5, v5, v5 row_ror:4 row_mask:0xf bank_mask:0xf
    s_nop 1
    v_add_u32_dpp v5, v5, v5 row_ror:2 row_mask:0xf bank_mask:0xf
    s_nop 1
    v_add_u32_dpp v5, v5, v5 row_ror:1 row_mask:0xf bank_mask:0xf
    s_nop 1
    v_readlane_b32 s74, v5, 0
    v_readlane_b32 s73, v5, 16
    s_add_u32 s86, s86, 3143680
    s_lshl_b32 s80, s76, 7
    s_add_u32 s80, s80, s86
    s_add_u32 s74, s74, s73
    s_lshl_b32 s74, s74, 2
    s_waitcnt lgkmcnt(0)
    s_mul_i32 s73, s84, 13
    s_sub_u32 s74, s74, s73
    v_mov_b32 v8, s74
    v_mov_b32 v9, s84
    s_mov_b64 exec, 1
    buffer_store_dwordx2 v[8:9], v2, s[52:55], s80 offen offset:2048 sc0 sc1
    s_mov_b64 exec, 0xffff
    buffer_load_dwordx2 v[10:11], v7, s[52:55], s86 offen sc0 sc1
    s_waitcnt vmcnt(0)
    v_sub_u32 v9, s84, v11
    v_cmp_gt_u32 vcc, 0x1000, v9
    v_sub_u32 v8, s74, v10
    s_bitset0_b32 vcc_lo, s76
    v_cndmask_b32 v8, 0, v8, vcc
    s_nop 1
    v_add_u32_dpp v8, v8, v8 row_ror:8 row_mask:0xf bank_mask:0xf
    s_nop 1
    v_add_u32_dpp v8, v8, v8 row_ror:4 row_mask:0xf bank_mask:0xf
    s_nop 1
    v_add_u32_dpp v8, v8, v8 row_ror:2 row_mask:0xf bank_mask:0xf
    s_nop 1
    v_add_u32_dpp v8, v8, v8 row_ror:1 row_mask:0xf bank_mask:0xf
    s_nop 1
    v_ashrrev_i32 v8, 9, v8
    v_max_i32 v8, -5, v8
    v_min_i32 v8, 40, v8
    v_add_u32 v8, 0x400, v8
    s_mov_b64 exec, 1
    buffer_store_short v8, v2, s[60:63], 0 offen offset:192
L_cn:
    s_cmp_eq_u32 s81, 0
    s_cbranch_scc1 L_c
    s_endpgm
.section .rodata,"a"
.p2align 6
.amdhsa_kernel standalone__kv_cache_quant_int4_int2_kv_with_per_channel_or_per_token_scales__decode_kernel
  .amdhsa_next_free_vgpr 246
  .amdhsa_next_free_sgpr 102
  .amdhsa_accum_offset 248
  .amdhsa_float_denorm_mode_32 3
  .amdhsa_group_segment_fixed_size 0
  .amdhsa_kernarg_size 80
  .amdhsa_user_sgpr_count 2
  .amdhsa_user_sgpr_kernarg_segment_ptr 1
  .amdhsa_system_sgpr_workgroup_id_x 1
.end_amdhsa_kernel
```

```asm
; @launch grid=(256,1,1) block=(256,1,1) lds=98304
.amdgcn_target "amdgcn-amd-amdhsa--gfx950"
.text
.globl standalone__kv_cache_quant_int4_int2_kv_with_per_channel_or_per_token_scales__decode_kernel
.p2align 12
.type standalone__kv_cache_quant_int4_int2_kv_with_per_channel_or_per_token_scales__decode_kernel,@function
standalone__kv_cache_quant_int4_int2_kv_with_per_channel_or_per_token_scales__decode_kernel:
    s_cmp_ge_u32 s2, 256
    s_cbranch_scc1 L_end
    s_load_dwordx16 s[4:19], s[0:1], 0
    s_load_dwordx4 s[20:23], s[0:1], 64
    s_and_b32 s80, s2, 7
    s_lshr_b32 s2, s2, 3
    s_lshl_b32 s80, s80, 5
    s_or_b32 s2, s2, s80
    s_mov_b32 s3, s2
    v_lshrrev_b32 v229, 6, v0
    v_and_b32 v0, 63, v0
    v_readfirstlane_b32 s68, v229
    s_lshr_b32 s79, s2, 5
    s_and_b32 s92, s2, 31
    s_mov_b32 s66, 0xaaaaaaaa
    s_mov_b32 s67, 0xaaaaaaaa
    s_cmp_eq_u32 s68, 1
    s_cbranch_scc1 L_service
    s_cmp_eq_u32 s68, 2
    s_cbranch_scc1 L_ticket
    s_cmp_eq_u32 s68, 3
    s_cbranch_scc1 L_ctl
    s_mov_b64 vcc, 0
    s_setprio 1
    v_and_b32 v235, 15, v0
    v_lshrrev_b32 v234, 4, v0
    v_mul_u32_u24 v1, 768, v234
    v_lshl_add_u32 v1, v235, 4, v1
    v_lshlrev_b32 v2, 3, v235
    v_bfrev_b32 v231, v235
    v_lshrrev_b32 v231, 28, v231
    v_and_b32 v232, 3, v231
    v_lshl_add_u32 v3, v232, 2, v234
    v_lshlrev_b32 v3, 1, v3
    v_lshrrev_b32 v231, 2, v231
    v_lshl_add_u32 v3, v231, 10, v3
    v_lshlrev_b32 v239, 2, v0
    v_add_u32 v240, 3840, v239
    v_add_u32 v239, 3584, v239
    v_lshlrev_b32 v241, 4, v0
    v_mov_b32 v242, 0
    v_mov_b32 v243, 1
    v_lshlrev_b32 v224, 2, v0
    v_mov_b32 v225, 1
    v_mov_b32 v226, 260
    s_mul_i32 s58, s79, 0
    s_and_b32 s94, s92, 448
    s_add_u32 s94, s94, s58
    s_add_u32 s94, s94, 512
    s_add_u32 s58, s58, s92
    s_and_b32 s58, s58, 511
    s_lshr_b32 s59, s3, 5
    s_lshl_b32 s69, s79, 9
    s_add_u32 s59, s59, 24
    s_lshl_b32 s59, s59, 9
    s_mov_b32 s64, 0xcccccccc
    s_mov_b32 s65, 0xcccccccc
    s_mov_b32 s60, 0x6fd53b95
    s_mov_b32 s62, 0x80000001
    s_mov_b32 s61, 0x6fd53b95
    s_mov_b32 s63, 0x80000001
    s_and_b32 s80, s92, 3
    s_cmp_eq_u32 s80, 1
    s_mov_b32 s81, 0x11119143
    s_cselect_b32 s81, 0x11659143, s81
    s_cmp_eq_u32 s80, 0
    s_cselect_b32 s81, 0x80659143, s81
    s_andn2_b32 s82, s92, 3
    s_lshr_b32 s81, s81, s82
    s_and_b32 s81, s81, 15
    s_lshl_b32 m0, s81, 1
    s_lshl_b32 s80, s80, 21
    s_max_u32 s80, s80, 64
    s_sub_u32 s80, s80, 64
    s_mul_i32 s82, s79, 25165824
    s_cmp_eq_u32 s81, 1
    s_cselect_b32 s82, s82, 0
    s_add_u32 s80, s80, s82
    v_mov_b32 v236, s80
    s_waitcnt lgkmcnt(0)
    s_movrels_b64 s[84:85], s[4:5]
    global_load_dword v236, v236, s[84:85]
    s_mov_b32 s24, s6
    s_and_b32 s25, s7, 0xffff
    s_mov_b32 s26, 805306368
    s_mov_b32 s27, 0x00020000
    s_mov_b32 s48, s4
    s_and_b32 s49, s5, 0xffff
    s_mov_b32 s50, 12288
    s_mov_b32 s51, 0x00020000
    s_mov_b32 s32, s10
    s_and_b32 s33, s11, 0xffff
    s_mov_b32 s34, 6291456
    s_mov_b32 s35, 0x00020000
    s_mov_b32 s36, s12
    s_and_b32 s37, s13, 0xffff
    s_mov_b32 s38, 6291456
    s_mov_b32 s39, 0x00020000
    s_add_u32 s70, s69, s92
    s_mov_b32 s91, 1
    s_lshr_b32 s74, s70, 9
    s_mul_i32 s74, s74, 384
    buffer_load_dwordx2 v[192:193], v2, s[48:51], s74 offen offset:0
    buffer_load_dwordx2 v[194:195], v2, s[48:51], s74 offen offset:128
    buffer_load_dwordx2 v[196:197], v2, s[48:51], s74 offen offset:256
    s_and_b32 s80, s70, 31
    s_sub_u32 s72, s70, s80
    s_lshr_b32 s80, s80, 2
    s_add_u32 s72, s72, s80
    s_mul_i32 s72, s72, 384
    buffer_load_dwordx2 v[132:133], v2, s[32:35], s72 offen offset:0
    buffer_load_dwordx2 v[134:135], v2, s[32:35], s72 offen offset:128
    buffer_load_dwordx2 v[136:137], v2, s[32:35], s72 offen offset:256
    buffer_load_dwordx2 v[138:139], v2, s[36:39], s72 offen offset:0
    buffer_load_dwordx2 v[140:141], v2, s[36:39], s72 offen offset:128
    buffer_load_dwordx2 v[142:143], v2, s[36:39], s72 offen offset:256
    s_mul_i32 s71, s70, 49152
    s_and_b32 s80, s70, 31
    s_mul_i32 s80, s80, 36864
    s_sub_u32 s71, s71, s80
    buffer_load_dwordx4 v[4:7], v1, s[24:27], s71 offen offset:0 nt
    buffer_load_dwordx4 v[8:11], v1, s[24:27], s71 offen offset:256 nt
    buffer_load_dwordx4 v[12:15], v1, s[24:27], s71 offen offset:512 nt
    s_add_u32 s71, s71, 3072
    buffer_load_dwordx4 v[16:19], v1, s[24:27], s71 offen offset:0 nt
    s_add_u32 s72, s72, 3072
    buffer_load_dwordx2 v[156:157], v2, s[32:35], s72 offen offset:0
    buffer_load_dwordx2 v[158:159], v2, s[32:35], s72 offen offset:128
    buffer_load_dwordx2 v[160:161], v2, s[32:35], s72 offen offset:256
    buffer_load_dwordx2 v[162:163], v2, s[36:39], s72 offen offset:0
    buffer_load_dwordx2 v[164:165], v2, s[36:39], s72 offen offset:128
    buffer_load_dwordx2 v[166:167], v2, s[36:39], s72 offen offset:256
    buffer_load_dwordx4 v[20:23], v1, s[24:27], s71 offen offset:256 nt
    buffer_load_dwordx4 v[24:27], v1, s[24:27], s71 offen offset:512 nt
    s_add_u32 s71, s71, 3072
    buffer_load_dwordx4 v[28:31], v1, s[24:27], s71 offen offset:0 nt
    buffer_load_dwordx4 v[32:35], v1, s[24:27], s71 offen offset:256 nt
    buffer_load_dwordx4 v[36:39], v1, s[24:27], s71 offen offset:512 nt
    s_add_u32 s71, s71, 3072
    buffer_load_dwordx4 v[40:43], v1, s[24:27], s71 offen offset:0 nt
    buffer_load_dwordx4 v[44:47], v1, s[24:27], s71 offen offset:256 nt
    buffer_load_dwordx4 v[48:51], v1, s[24:27], s71 offen offset:512 nt
    s_add_u32 s71, s71, 384000
    buffer_load_dwordx4 v[52:55], v1, s[24:27], s71 offen offset:0 nt
    buffer_load_dwordx4 v[56:59], v1, s[24:27], s71 offen offset:256 nt
    buffer_load_dwordx4 v[60:63], v1, s[24:27], s71 offen offset:512 nt
    s_add_u32 s71, s71, 3072
    buffer_load_dwordx4 v[64:67], v1, s[24:27], s71 offen offset:0 nt
    s_add_u32 s72, s72, 3072
    buffer_load_dwordx2 v[168:169], v2, s[32:35], s72 offen offset:0
    buffer_load_dwordx2 v[170:171], v2, s[32:35], s72 offen offset:128
    buffer_load_dwordx2 v[172:173], v2, s[32:35], s72 offen offset:256
    buffer_load_dwordx2 v[174:175], v2, s[36:39], s72 offen offset:0
    buffer_load_dwordx2 v[176:177], v2, s[36:39], s72 offen offset:128
    buffer_load_dwordx2 v[178:179], v2, s[36:39], s72 offen offset:256
    buffer_load_dwordx4 v[68:71], v1, s[24:27], s71 offen offset:256 nt
    buffer_load_dwordx4 v[72:75], v1, s[24:27], s71 offen offset:512 nt
    s_add_u32 s71, s71, 3072
    buffer_load_dwordx4 v[76:79], v1, s[24:27], s71 offen offset:0 nt
    buffer_load_dwordx4 v[80:83], v1, s[24:27], s71 offen offset:256 nt
    buffer_load_dwordx4 v[84:87], v1, s[24:27], s71 offen offset:512 nt
    s_add_u32 s71, s71, 3072
    buffer_load_dwordx4 v[88:91], v1, s[24:27], s71 offen offset:0 nt
    buffer_load_dwordx4 v[92:95], v1, s[24:27], s71 offen offset:256 nt
    buffer_load_dwordx4 v[96:99], v1, s[24:27], s71 offen offset:512 nt
    s_mov_b32 s28, s8
    s_and_b32 s29, s9, 0xffff
    s_mov_b32 s30, 805306368
    s_mov_b32 s31, 0x00020000
    s_mov_b32 s40, s14
    s_and_b32 s41, s15, 0xffff
    s_mov_b32 s42, 2097152
    s_mov_b32 s43, 0x00020000
    s_mov_b32 s44, s16
    s_and_b32 s45, s17, 0xffff
    s_mov_b32 s46, 2097152
    s_mov_b32 s47, 0x00020000
    s_mov_b32 s52, s22
    s_and_b32 s53, s23, 0xffff
    s_mov_b32 s54, 25165824
    s_mov_b32 s55, 0x00020000
    v_mov_b32 v229, s2
    v_and_b32 v231, 15, v0
    v_lshrrev_b32 v230, 5, v229
    v_lshl_add_u32 v231, v230, 4, v231
    v_lshrrev_b32 v232, 4, v0
    v_lshl_add_u32 v231, v232, 7, v231
    s_lshl_b32 s82, s79, 3
    s_mov_b32 s80, 0xeff4fa00
    s_mov_b32 s81, 0xdbe0e5ea
    s_lshr_b64 s[80:81], s[80:81], s82
    s_sext_i32_i8 s80, s80
    s_mov_b32 exec_lo, 0x0
    s_mov_b32 exec_hi, 0x3ff
    v_add_u32 v231, s80, v231
    s_mov_b32 s80, 0xeff43d4c
    s_mov_b32 s81, 0xdbe0e5ea
    s_lshr_b64 s[80:81], s[80:81], s82
    s_sext_i32_i8 s80, s80
    s_mov_b32 exec_lo, 0x0
    s_mov_b32 exec_hi, 0x400
    v_add_u32 v231, s80, v231
    s_mov_b32 s80, 0x2c37424d
    s_mov_b32 s81, 0xb1621
    s_lshr_b64 s[80:81], s[80:81], s82
    s_sext_i32_i8 s80, s80
    s_mov_b32 exec_lo, 0x0
    s_mov_b32 exec_hi, 0xf800
    v_add_u32 v231, s80, v231
    s_mov_b64 exec, -1
    v_and_b32 v229, 31, v229
    v_lshl_add_u32 v245, v231, 5, v229
    s_mov_b32 s4, 0x10000
    s_mov_b32 s5, 0x10401
    s_cmp_eq_u32 s79, 1
    s_cselect_b32 s4, 0x10000, s4
    s_cselect_b32 s5, 0x14441, s5
    s_cmp_eq_u32 s79, 2
    s_cselect_b32 s4, 0x10000, s4
    s_cselect_b32 s5, 0x10801, s5
    s_cmp_eq_u32 s79, 3
    s_cselect_b32 s4, 0x10000, s4
    s_cselect_b32 s5, 0x10803, s5
    s_cmp_eq_u32 s79, 4
    s_cselect_b32 s4, 0x10000, s4
    s_cselect_b32 s5, 0x18841, s5
    s_cmp_eq_u32 s79, 5
    s_cselect_b32 s4, 0x10000, s4
    s_cselect_b32 s5, 0x10801, s5
    s_cmp_eq_u32 s79, 6
    s_cselect_b32 s4, 0x10000, s4
    s_cselect_b32 s5, 0x10801, s5
    s_cmp_eq_u32 s79, 7
    s_cselect_b32 s4, 0x10000, s4
    s_cselect_b32 s5, 0x10821, s5
    s_mov_b32 s7, 0xf149f2ca
    s_mov_b32 s77, 0xf149f2ca
    v_lshlrev_b32 v225, 4, v0
    v_mov_b32 v100, 0
    v_mov_b32 v101, 0
    v_mov_b32 v102, 0
    v_mov_b32 v103, 0
    s_lshl_b32 s78, s3, 11
    s_mov_b64 s[88:89], 0
    v_mov_b32 v216, 0xf149f2ca
    v_mov_b32 v217, 0
    v_mov_b32 v218, 0
    v_mov_b32 v204, 0
    v_mov_b32 v205, 0
    v_mov_b32 v206, 0
    v_mov_b32 v207, 0
    v_mov_b32 v208, 0
    v_mov_b32 v209, 0
    v_mov_b32 v210, 0
    v_mov_b32 v211, 0
    v_mov_b32 v212, 0
    v_mov_b32 v213, 0
    v_mov_b32 v214, 0
    v_mov_b32 v215, 0
    s_barrier
    s_waitcnt vmcnt(36)
    v_lshlrev_b32 v108, 16, v192
    v_and_b32 v109, 0xffff0000, v192
    v_pk_mul_f32 v[108:109], v[108:109], s[60:61]
    v_lshlrev_b32 v110, 16, v193
    v_and_b32 v111, 0xffff0000, v193
    v_pk_mul_f32 v[110:111], v[110:111], s[60:61]
    v_lshlrev_b32 v112, 16, v194
    v_and_b32 v113, 0xffff0000, v194
    v_pk_mul_f32 v[112:113], v[112:113], s[60:61]
    v_lshlrev_b32 v114, 16, v195
    v_and_b32 v115, 0xffff0000, v195
    v_pk_mul_f32 v[114:115], v[114:115], s[60:61]
    v_lshlrev_b32 v116, 16, v196
    v_and_b32 v117, 0xffff0000, v196
    v_pk_mul_f32 v[116:117], v[116:117], s[60:61]
    v_lshlrev_b32 v118, 16, v197
    v_and_b32 v119, 0xffff0000, v197
    v_pk_mul_f32 v[118:119], v[118:119], s[60:61]
    v_lshlrev_b32 v234, 16, v132
    v_and_b32 v235, 0xffff0000, v132
    v_pk_mul_f32 v[120:121], v[234:235], v[108:109]
    v_lshlrev_b32 v234, 16, v138
    v_and_b32 v235, 0xffff0000, v138
    v_pk_mul_f32 v[200:201], v[120:121], v[234:235]
    v_lshlrev_b32 v234, 16, v133
    v_and_b32 v235, 0xffff0000, v133
    v_pk_mul_f32 v[122:123], v[234:235], v[110:111]
    v_lshlrev_b32 v234, 16, v139
    v_and_b32 v235, 0xffff0000, v139
    v_pk_fma_f32 v[200:201], v[122:123], v[234:235], v[200:201]
    v_lshlrev_b32 v234, 16, v134
    v_and_b32 v235, 0xffff0000, v134
    v_pk_mul_f32 v[124:125], v[234:235], v[112:113]
    v_lshlrev_b32 v234, 16, v140
    v_and_b32 v235, 0xffff0000, v140
    v_pk_fma_f32 v[200:201], v[124:125], v[234:235], v[200:201]
    v_lshlrev_b32 v234, 16, v135
    v_and_b32 v235, 0xffff0000, v135
    v_pk_mul_f32 v[126:127], v[234:235], v[114:115]
    v_lshlrev_b32 v234, 16, v141
    v_and_b32 v235, 0xffff0000, v141
    v_pk_fma_f32 v[200:201], v[126:127], v[234:235], v[200:201]
    v_lshlrev_b32 v234, 16, v136
    v_and_b32 v235, 0xffff0000, v136
    v_pk_mul_f32 v[128:129], v[234:235], v[116:117]
    v_lshlrev_b32 v234, 16, v142
    v_and_b32 v235, 0xffff0000, v142
    v_pk_fma_f32 v[200:201], v[128:129], v[234:235], v[200:201]
    v_lshlrev_b32 v234, 16, v137
    v_and_b32 v235, 0xffff0000, v137
    v_pk_mul_f32 v[130:131], v[234:235], v[118:119]
    v_lshlrev_b32 v234, 16, v143
    v_and_b32 v235, 0xffff0000, v143
    v_pk_fma_f32 v[200:201], v[130:131], v[234:235], v[200:201]
    v_pk_mul_f32 v[200:201], v[200:201], s[62:63]
    s_mov_b32 s76, 63
L_loop0:
    s_waitcnt vmcnt(35)
    v_pk_fma_f32 v[198:199], v[120:121], v[4:5], v[200:201]
    v_pk_fma_f32 v[198:199], v[122:123], v[6:7], v[198:199]
    ds_read_b32 v244, v243 offset:147
    s_add_u32 s71, s71, 384000
    s_cbranch_vccnz L_th24_0
L_tb24_0:
    buffer_load_dwordx4 v[4:7], v1, s[24:27], s71 offen offset:0 nt
    v_add_f32_dpp v229, v228, v228 row_ror:8 row_mask:0xf bank_mask:0xc
    s_waitcnt vmcnt(35)
    v_pk_fma_f32 v[198:199], v[124:125], v[8:9], v[198:199]
    v_pk_fma_f32 v[198:199], v[126:127], v[10:11], v[198:199]
    buffer_load_dwordx4 v[8:11], v1, s[24:27], s71 offen offset:256 nt
    v_add_f32_dpp v230, v229, v229 row_shr:4 row_mask:0xf bank_mask:0xa
    s_waitcnt vmcnt(35)
    v_pk_fma_f32 v[198:199], v[128:129], v[12:13], v[198:199]
    v_pk_fma_f32 v[198:199], v[130:131], v[14:15], v[198:199]
    s_waitcnt lgkmcnt(0)
    v_cmp_lt_u32 vcc, v0, v244
    ds_add_u32 v224, v243 offset:3328
    buffer_load_dwordx4 v[12:15], v1, s[24:27], s71 offen offset:512 nt
    v_add_f32_dpp v232, v230, v230 quad_perm:[2,3,0,1] row_mask:0xf bank_mask:0xf
    v_add_f32 v228, v198, v199
    s_waitcnt vmcnt(35)
    v_pk_fma_f32 v[198:199], v[120:121], v[16:17], v[200:201]
    v_pk_fma_f32 v[198:199], v[122:123], v[18:19], v[198:199]
    s_add_u32 s71, s71, 3072
    s_cbranch_vccnz L_th27_0
L_tb27_0:
    buffer_load_dwordx4 v[16:19], v1, s[24:27], s71 offen offset:0 nt
    v_cndmask_b32 v232, v231, v232, s[64:65]
    v_add_f32_dpp v229, v228, v228 row_ror:8 row_mask:0xf bank_mask:0x3
    s_waitcnt vmcnt(29)
    v_pk_fma_f32 v[198:199], v[124:125], v[20:21], v[198:199]
    v_pk_fma_f32 v[198:199], v[126:127], v[22:23], v[198:199]
    s_add_u32 s72, s72, 3072
    buffer_load_dwordx2 v[180:181], v2, s[32:35], s72 offen offset:0
    buffer_load_dwordx2 v[182:183], v2, s[32:35], s72 offen offset:128
    buffer_load_dwordx2 v[184:185], v2, s[32:35], s72 offen offset:256
    buffer_load_dwordx2 v[186:187], v2, s[36:39], s72 offen offset:0
    buffer_load_dwordx2 v[188:189], v2, s[36:39], s72 offen offset:128
    buffer_load_dwordx2 v[190:191], v2, s[36:39], s72 offen offset:256
    buffer_load_dwordx4 v[20:23], v1, s[24:27], s71 offen offset:256 nt
    v_add_f32_dpp v231, v232, v232 quad_perm:[1,0,3,2] row_mask:0xf bank_mask:0xf
    v_lshlrev_b32 v234, 16, v156
    v_and_b32 v235, 0xffff0000, v156
    v_pk_mul_f32 v[144:145], v[234:235], v[108:109]
    v_lshlrev_b32 v234, 16, v162
    v_and_b32 v235, 0xffff0000, v162
    s_waitcnt vmcnt(35)
    v_pk_fma_f32 v[198:199], v[128:129], v[24:25], v[198:199]
    v_pk_fma_f32 v[198:199], v[130:131], v[26:27], v[198:199]
    ds_add_u32 v224, v243 offset:3328
    buffer_load_dwordx4 v[24:27], v1, s[24:27], s71 offen offset:512 nt
    v_cndmask_b32 v233, v233, v231, s[66:67]
    v_mul_f32 v233, 0x58000000, v233
    ds_write_b32 v239, v233
    v_add_u32 v239, 256, v239
    v_add_f32 v228, v198, v199
    v_pk_mul_f32 v[202:203], v[144:145], v[234:235]
    v_lshlrev_b32 v234, 16, v157
    v_and_b32 v235, 0xffff0000, v157
    v_pk_mul_f32 v[146:147], v[234:235], v[110:111]
    v_lshlrev_b32 v234, 16, v163
    s_waitcnt vmcnt(35)
    v_pk_fma_f32 v[198:199], v[120:121], v[28:29], v[200:201]
    v_pk_fma_f32 v[198:199], v[122:123], v[30:31], v[198:199]
    s_add_u32 s71, s71, 3072
    s_cbranch_vccnz L_th30_0
L_tb30_0:
    buffer_load_dwordx4 v[28:31], v1, s[24:27], s71 offen offset:0 nt
    v_add_f32_dpp v229, v228, v228 row_ror:8 row_mask:0xf bank_mask:0xc
    v_and_b32 v235, 0xffff0000, v163
    v_pk_fma_f32 v[202:203], v[146:147], v[234:235], v[202:203]
    v_lshlrev_b32 v234, 16, v158
    v_and_b32 v235, 0xffff0000, v158
    v_pk_mul_f32 v[148:149], v[234:235], v[112:113]
    s_waitcnt vmcnt(35)
    v_pk_fma_f32 v[198:199], v[124:125], v[32:33], v[198:199]
    v_pk_fma_f32 v[198:199], v[126:127], v[34:35], v[198:199]
    buffer_load_dwordx4 v[32:35], v1, s[24:27], s71 offen offset:256 nt
    v_add_f32_dpp v230, v229, v229 row_shl:4 row_mask:0xf bank_mask:0x5
    v_lshlrev_b32 v234, 16, v164
    v_and_b32 v235, 0xffff0000, v164
    v_pk_fma_f32 v[202:203], v[148:149], v[234:235], v[202:203]
    v_lshlrev_b32 v234, 16, v159
    v_and_b32 v235, 0xffff0000, v159
    s_waitcnt vmcnt(35)
    v_pk_fma_f32 v[198:199], v[128:129], v[36:37], v[198:199]
    v_pk_fma_f32 v[198:199], v[130:131], v[38:39], v[198:199]
    ds_add_u32 v224, v243 offset:3328
    buffer_load_dwordx4 v[36:39], v1, s[24:27], s71 offen offset:512 nt
    v_add_f32 v228, v198, v199
    v_pk_mul_f32 v[150:151], v[234:235], v[114:115]
    v_lshlrev_b32 v234, 16, v165
    v_and_b32 v235, 0xffff0000, v165
    v_pk_fma_f32 v[202:203], v[150:151], v[234:235], v[202:203]
    v_lshlrev_b32 v234, 16, v160
    s_waitcnt vmcnt(35)
    v_pk_fma_f32 v[198:199], v[120:121], v[40:41], v[200:201]
    v_pk_fma_f32 v[198:199], v[122:123], v[42:43], v[198:199]
    s_add_u32 s71, s71, 3072
    s_cbranch_vccnz L_th33_0
L_tb33_0:
    buffer_load_dwordx4 v[40:43], v1, s[24:27], s71 offen offset:0 nt
    v_add_f32_dpp v229, v228, v228 row_ror:8 row_mask:0xf bank_mask:0x3
    v_and_b32 v235, 0xffff0000, v160
    v_pk_mul_f32 v[152:153], v[234:235], v[116:117]
    v_lshlrev_b32 v234, 16, v166
    v_and_b32 v235, 0xffff0000, v166
    v_pk_fma_f32 v[202:203], v[152:153], v[234:235], v[202:203]
    s_waitcnt vmcnt(35)
    v_pk_fma_f32 v[198:199], v[124:125], v[44:45], v[198:199]
    v_pk_fma_f32 v[198:199], v[126:127], v[46:47], v[198:199]
    buffer_load_dwordx4 v[44:47], v1, s[24:27], s71 offen offset:256 nt
    v_lshlrev_b32 v234, 16, v161
    v_and_b32 v235, 0xffff0000, v161
    v_pk_mul_f32 v[154:155], v[234:235], v[118:119]
    v_lshlrev_b32 v234, 16, v167
    v_and_b32 v235, 0xffff0000, v167
    s_waitcnt vmcnt(35)
    v_pk_fma_f32 v[198:199], v[128:129], v[48:49], v[198:199]
    v_pk_fma_f32 v[198:199], v[130:131], v[50:51], v[198:199]
    ds_add_u32 v224, v243 offset:3328
    buffer_load_dwordx4 v[48:51], v1, s[24:27], s71 offen offset:512 nt
    v_add_f32 v228, v198, v199
    v_pk_fma_f32 v[202:203], v[154:155], v[234:235], v[202:203]
    v_pk_mul_f32 v[202:203], v[202:203], s[62:63]
    s_waitcnt vmcnt(35)
    v_pk_fma_f32 v[198:199], v[144:145], v[52:53], v[202:203]
    v_pk_fma_f32 v[198:199], v[146:147], v[54:55], v[198:199]
    ds_read_b32 v244, v243 offset:147
    v_readlane_b32 s70, v245, s91
    s_add_u32 s91, s91, 1
    s_lshr_b32 s74, s70, 9
    s_mul_i32 s74, s74, 384
    buffer_load_dwordx2 v[192:193], v2, s[48:51], s74 offen offset:0
    buffer_load_dwordx2 v[194:195], v2, s[48:51], s74 offen offset:128
    buffer_load_dwordx2 v[196:197], v2, s[48:51], s74 offen offset:256
    s_add_u32 s71, s71, 384000
    s_cbranch_vccnz L_th36_0
L_tb36_0:
    buffer_load_dwordx4 v[52:55], v1, s[24:27], s71 offen offset:0 nt
    v_add_f32_dpp v229, v228, v228 row_ror:8 row_mask:0xf bank_mask:0xc
    s_waitcnt vmcnt(38)
    v_pk_fma_f32 v[198:199], v[148:149], v[56:57], v[198:199]
    v_pk_fma_f32 v[198:199], v[150:151], v[58:59], v[198:199]
    buffer_load_dwordx4 v[56:59], v1, s[24:27], s71 offen offset:256 nt
    v_add_f32_dpp v230, v229, v229 row_shr:4 row_mask:0xf bank_mask:0xa
    s_waitcnt vmcnt(38)
    v_pk_fma_f32 v[198:199], v[152:153], v[60:61], v[198:199]
    v_pk_fma_f32 v[198:199], v[154:155], v[62:63], v[198:199]
    s_waitcnt lgkmcnt(0)
    v_cmp_lt_u32 vcc, v0, v244
    ds_add_u32 v224, v243 offset:3328
    buffer_load_dwordx4 v[60:63], v1, s[24:27], s71 offen offset:512 nt
    v_add_f32_dpp v231, v230, v230 quad_perm:[2,3,0,1] row_mask:0xf bank_mask:0xf
    v_add_f32 v228, v198, v199
    s_waitcnt vmcnt(38)
    v_pk_fma_f32 v[198:199], v[144:145], v[64:65], v[202:203]
    v_pk_fma_f32 v[198:199], v[146:147], v[66:67], v[198:199]
    s_add_u32 s71, s71, 3072
    s_cbranch_vccnz L_th39_0
L_tb39_0:
    buffer_load_dwordx4 v[64:67], v1, s[24:27], s71 offen offset:0 nt
    v_add_f32_dpp v229, v228, v228 row_ror:8 row_mask:0xf bank_mask:0x3
    s_waitcnt vmcnt(32)
    v_pk_fma_f32 v[198:199], v[148:149], v[68:69], v[198:199]
    v_pk_fma_f32 v[198:199], v[150:151], v[70:71], v[198:199]
    s_and_b32 s80, s70, 31
    s_sub_u32 s72, s70, s80
    s_lshr_b32 s80, s80, 2
    s_add_u32 s72, s72, s80
    s_mul_i32 s72, s72, 384
    buffer_load_dwordx2 v[132:133], v2, s[32:35], s72 offen offset:0
    buffer_load_dwordx2 v[134:135], v2, s[32:35], s72 offen offset:128
    buffer_load_dwordx2 v[136:137], v2, s[32:35], s72 offen offset:256
    buffer_load_dwordx2 v[138:139], v2, s[36:39], s72 offen offset:0
    buffer_load_dwordx2 v[140:141], v2, s[36:39], s72 offen offset:128
    buffer_load_dwordx2 v[142:143], v2, s[36:39], s72 offen offset:256
    buffer_load_dwordx4 v[68:71], v1, s[24:27], s71 offen offset:256 nt
    v_lshlrev_b32 v234, 16, v168
    v_and_b32 v235, 0xffff0000, v168
    v_pk_mul_f32 v[120:121], v[234:235], v[108:109]
    v_lshlrev_b32 v234, 16, v174
    v_and_b32 v235, 0xffff0000, v174
    s_waitcnt vmcnt(38)
    v_pk_fma_f32 v[198:199], v[152:153], v[72:73], v[198:199]
    v_pk_fma_f32 v[198:199], v[154:155], v[74:75], v[198:199]
    ds_add_u32 v224, v243 offset:3328
    buffer_load_dwordx4 v[72:75], v1, s[24:27], s71 offen offset:512 nt
    v_add_f32 v228, v198, v199
    v_pk_mul_f32 v[200:201], v[120:121], v[234:235]
    v_lshlrev_b32 v234, 16, v169
    v_and_b32 v235, 0xffff0000, v169
    v_pk_mul_f32 v[122:123], v[234:235], v[110:111]
    v_lshlrev_b32 v234, 16, v175
    s_waitcnt vmcnt(38)
    v_pk_fma_f32 v[198:199], v[144:145], v[76:77], v[202:203]
    v_pk_fma_f32 v[198:199], v[146:147], v[78:79], v[198:199]
    s_add_u32 s71, s71, 3072
    s_cbranch_vccnz L_th42_0
L_tb42_0:
    buffer_load_dwordx4 v[76:79], v1, s[24:27], s71 offen offset:0 nt
    v_add_f32_dpp v229, v228, v228 row_ror:8 row_mask:0xf bank_mask:0xc
    v_and_b32 v235, 0xffff0000, v175
    v_pk_fma_f32 v[200:201], v[122:123], v[234:235], v[200:201]
    v_lshlrev_b32 v234, 16, v170
    v_and_b32 v235, 0xffff0000, v170
    v_pk_mul_f32 v[124:125], v[234:235], v[112:113]
    s_waitcnt vmcnt(38)
    v_pk_fma_f32 v[198:199], v[148:149], v[80:81], v[198:199]
    v_pk_fma_f32 v[198:199], v[150:151], v[82:83], v[198:199]
    buffer_load_dwordx4 v[80:83], v1, s[24:27], s71 offen offset:256 nt
    v_add_f32_dpp v230, v229, v229 row_shl:4 row_mask:0xf bank_mask:0x5
    v_lshlrev_b32 v234, 16, v176
    v_and_b32 v235, 0xffff0000, v176
    v_pk_fma_f32 v[200:201], v[124:125], v[234:235], v[200:201]
    v_lshlrev_b32 v234, 16, v171
    v_and_b32 v235, 0xffff0000, v171
    s_waitcnt vmcnt(38)
    v_pk_fma_f32 v[198:199], v[152:153], v[84:85], v[198:199]
    v_pk_fma_f32 v[198:199], v[154:155], v[86:87], v[198:199]
    ds_add_u32 v224, v243 offset:3328
    buffer_load_dwordx4 v[84:87], v1, s[24:27], s71 offen offset:512 nt
    v_add_f32 v228, v198, v199
    v_pk_mul_f32 v[126:127], v[234:235], v[114:115]
    v_lshlrev_b32 v234, 16, v177
    v_and_b32 v235, 0xffff0000, v177
    v_pk_fma_f32 v[200:201], v[126:127], v[234:235], v[200:201]
    v_lshlrev_b32 v234, 16, v172
    s_waitcnt vmcnt(38)
    v_pk_fma_f32 v[198:199], v[144:145], v[88:89], v[202:203]
    v_pk_fma_f32 v[198:199], v[146:147], v[90:91], v[198:199]
    s_add_u32 s71, s71, 3072
    s_cbranch_vccnz L_th45_0
L_tb45_0:
    buffer_load_dwordx4 v[88:91], v1, s[24:27], s71 offen offset:0 nt
    v_add_f32_dpp v229, v228, v228 row_ror:8 row_mask:0xf bank_mask:0x3
    v_and_b32 v235, 0xffff0000, v172
    v_pk_mul_f32 v[128:129], v[234:235], v[116:117]
    v_lshlrev_b32 v234, 16, v178
    v_and_b32 v235, 0xffff0000, v178
    v_pk_fma_f32 v[200:201], v[128:129], v[234:235], v[200:201]
    s_waitcnt vmcnt(38)
    v_pk_fma_f32 v[198:199], v[148:149], v[92:93], v[198:199]
    v_pk_fma_f32 v[198:199], v[150:151], v[94:95], v[198:199]
    buffer_load_dwordx4 v[92:95], v1, s[24:27], s71 offen offset:256 nt
    v_lshlrev_b32 v234, 16, v173
    v_and_b32 v235, 0xffff0000, v173
    v_pk_mul_f32 v[130:131], v[234:235], v[118:119]
    v_lshlrev_b32 v234, 16, v179
    v_and_b32 v235, 0xffff0000, v179
    s_waitcnt vmcnt(38)
    v_pk_fma_f32 v[198:199], v[152:153], v[96:97], v[198:199]
    v_pk_fma_f32 v[198:199], v[154:155], v[98:99], v[198:199]
    ds_add_u32 v224, v243 offset:3328
    buffer_load_dwordx4 v[96:99], v1, s[24:27], s71 offen offset:512 nt
    v_add_f32 v228, v198, v199
    v_pk_fma_f32 v[200:201], v[130:131], v[234:235], v[200:201]
    v_pk_mul_f32 v[200:201], v[200:201], s[62:63]
    s_waitcnt vmcnt(38)
    v_pk_fma_f32 v[198:199], v[120:121], v[4:5], v[200:201]
    v_pk_fma_f32 v[198:199], v[122:123], v[6:7], v[198:199]
    ds_read_b32 v244, v243 offset:147
    s_mul_i32 s71, s70, 49152
    s_and_b32 s80, s70, 31
    s_mul_i32 s80, s80, 36864
    s_sub_u32 s71, s71, s80
    s_cbranch_vccnz L_th0_0
L_tb0_0:
    buffer_load_dwordx4 v[4:7], v1, s[24:27], s71 offen offset:0 nt
    v_add_f32_dpp v229, v228, v228 row_ror:8 row_mask:0xf bank_mask:0xc
    s_waitcnt vmcnt(38)
    v_pk_fma_f32 v[198:199], v[124:125], v[8:9], v[198:199]
    v_pk_fma_f32 v[198:199], v[126:127], v[10:11], v[198:199]
    buffer_load_dwordx4 v[8:11], v1, s[24:27], s71 offen offset:256 nt
    v_add_f32_dpp v230, v229, v229 row_shr:4 row_mask:0xf bank_mask:0xa
    s_waitcnt vmcnt(38)
    v_pk_fma_f32 v[198:199], v[128:129], v[12:13], v[198:199]
    v_pk_fma_f32 v[198:199], v[130:131], v[14:15], v[198:199]
    s_waitcnt lgkmcnt(0)
    v_cmp_lt_u32 vcc, v0, v244
    ds_add_u32 v224, v243 offset:3328
    buffer_load_dwordx4 v[12:15], v1, s[24:27], s71 offen offset:512 nt
    v_add_f32_dpp v232, v230, v230 quad_perm:[2,3,0,1] row_mask:0xf bank_mask:0xf
    v_add_f32 v228, v198, v199
    s_waitcnt vmcnt(38)
    v_pk_fma_f32 v[198:199], v[120:121], v[16:17], v[200:201]
    v_pk_fma_f32 v[198:199], v[122:123], v[18:19], v[198:199]
    s_add_u32 s71, s71, 3072
    s_cbranch_vccnz L_th3_0
L_tb3_0:
    buffer_load_dwordx4 v[16:19], v1, s[24:27], s71 offen offset:0 nt
    v_cndmask_b32 v232, v231, v232, s[64:65]
    v_add_f32_dpp v229, v228, v228 row_ror:8 row_mask:0xf bank_mask:0x3
    s_waitcnt vmcnt(32)
    v_pk_fma_f32 v[198:199], v[124:125], v[20:21], v[198:199]
    v_pk_fma_f32 v[198:199], v[126:127], v[22:23], v[198:199]
    s_add_u32 s72, s72, 3072
    buffer_load_dwordx2 v[156:157], v2, s[32:35], s72 offen offset:0
    buffer_load_dwordx2 v[158:159], v2, s[32:35], s72 offen offset:128
    buffer_load_dwordx2 v[160:161], v2, s[32:35], s72 offen offset:256
    buffer_load_dwordx2 v[162:163], v2, s[36:39], s72 offen offset:0
    buffer_load_dwordx2 v[164:165], v2, s[36:39], s72 offen offset:128
    buffer_load_dwordx2 v[166:167], v2, s[36:39], s72 offen offset:256
    buffer_load_dwordx4 v[20:23], v1, s[24:27], s71 offen offset:256 nt
    v_add_f32_dpp v233, v232, v232 quad_perm:[1,0,3,2] row_mask:0xf bank_mask:0xf
    v_lshlrev_b32 v234, 16, v180
    v_and_b32 v235, 0xffff0000, v180
    v_pk_mul_f32 v[144:145], v[234:235], v[108:109]
    v_lshlrev_b32 v234, 16, v186
    v_and_b32 v235, 0xffff0000, v186
    s_waitcnt vmcnt(38)
    v_pk_fma_f32 v[198:199], v[128:129], v[24:25], v[198:199]
    v_pk_fma_f32 v[198:199], v[130:131], v[26:27], v[198:199]
    ds_add_u32 v224, v243 offset:3328
    buffer_load_dwordx4 v[24:27], v1, s[24:27], s71 offen offset:512 nt
    v_add_f32 v228, v198, v199
    v_pk_mul_f32 v[202:203], v[144:145], v[234:235]
    s_branch L_x0
L_w0:
    s_branch L_w1
L_x0:
    v_lshlrev_b32 v234, 16, v181
    v_and_b32 v235, 0xffff0000, v181
    v_pk_mul_f32 v[146:147], v[234:235], v[110:111]
    v_lshlrev_b32 v234, 16, v187
    s_waitcnt vmcnt(38)
    v_pk_fma_f32 v[198:199], v[120:121], v[28:29], v[200:201]
    v_pk_fma_f32 v[198:199], v[122:123], v[30:31], v[198:199]
    s_add_u32 s71, s71, 3072
    s_cbranch_vccnz L_th6_0
L_tb6_0:
    buffer_load_dwordx4 v[28:31], v1, s[24:27], s71 offen offset:0 nt
    v_add_f32_dpp v229, v228, v228 row_ror:8 row_mask:0xf bank_mask:0xc
    v_and_b32 v235, 0xffff0000, v187
    v_pk_fma_f32 v[202:203], v[146:147], v[234:235], v[202:203]
    v_lshlrev_b32 v234, 16, v182
    v_and_b32 v235, 0xffff0000, v182
    v_pk_mul_f32 v[148:149], v[234:235], v[112:113]
    s_waitcnt vmcnt(38)
    v_pk_fma_f32 v[198:199], v[124:125], v[32:33], v[198:199]
    v_pk_fma_f32 v[198:199], v[126:127], v[34:35], v[198:199]
    buffer_load_dwordx4 v[32:35], v1, s[24:27], s71 offen offset:256 nt
    v_add_f32_dpp v230, v229, v229 row_shl:4 row_mask:0xf bank_mask:0x5
    v_lshlrev_b32 v234, 16, v188
    v_and_b32 v235, 0xffff0000, v188
    v_pk_fma_f32 v[202:203], v[148:149], v[234:235], v[202:203]
    v_lshlrev_b32 v234, 16, v183
    v_and_b32 v235, 0xffff0000, v183
    s_waitcnt vmcnt(38)
    v_pk_fma_f32 v[198:199], v[128:129], v[36:37], v[198:199]
    v_pk_fma_f32 v[198:199], v[130:131], v[38:39], v[198:199]
    ds_add_u32 v224, v243 offset:3328
    buffer_load_dwordx4 v[36:39], v1, s[24:27], s71 offen offset:512 nt
    v_add_f32 v228, v198, v199
    v_pk_mul_f32 v[150:151], v[234:235], v[114:115]
    v_lshlrev_b32 v234, 16, v189
    v_and_b32 v235, 0xffff0000, v189
    v_pk_fma_f32 v[202:203], v[150:151], v[234:235], v[202:203]
    v_lshlrev_b32 v234, 16, v184
    s_waitcnt vmcnt(38)
    v_pk_fma_f32 v[198:199], v[120:121], v[40:41], v[200:201]
    v_pk_fma_f32 v[198:199], v[122:123], v[42:43], v[198:199]
    s_add_u32 s71, s71, 3072
    s_cbranch_vccnz L_th9_0
L_tb9_0:
    buffer_load_dwordx4 v[40:43], v1, s[24:27], s71 offen offset:0 nt
    v_add_f32_dpp v229, v228, v228 row_ror:8 row_mask:0xf bank_mask:0x3
    v_and_b32 v235, 0xffff0000, v184
    v_pk_mul_f32 v[152:153], v[234:235], v[116:117]
    v_lshlrev_b32 v234, 16, v190
    v_and_b32 v235, 0xffff0000, v190
    v_pk_fma_f32 v[202:203], v[152:153], v[234:235], v[202:203]
    s_waitcnt vmcnt(38)
    v_pk_fma_f32 v[198:199], v[124:125], v[44:45], v[198:199]
    v_pk_fma_f32 v[198:199], v[126:127], v[46:47], v[198:199]
    buffer_load_dwordx4 v[44:47], v1, s[24:27], s71 offen offset:256 nt
    v_lshlrev_b32 v234, 16, v185
    v_and_b32 v235, 0xffff0000, v185
    v_pk_mul_f32 v[154:155], v[234:235], v[118:119]
    v_lshlrev_b32 v234, 16, v191
    v_and_b32 v235, 0xffff0000, v191
    s_waitcnt vmcnt(38)
    v_pk_fma_f32 v[198:199], v[128:129], v[48:49], v[198:199]
    v_pk_fma_f32 v[198:199], v[130:131], v[50:51], v[198:199]
    ds_add_u32 v224, v243 offset:3328
    buffer_load_dwordx4 v[48:51], v1, s[24:27], s71 offen offset:512 nt
    v_add_f32 v228, v198, v199
    v_pk_fma_f32 v[202:203], v[154:155], v[234:235], v[202:203]
    v_pk_mul_f32 v[202:203], v[202:203], s[62:63]
    s_waitcnt vmcnt(35)
    v_pk_fma_f32 v[198:199], v[144:145], v[52:53], v[202:203]
    v_pk_fma_f32 v[198:199], v[146:147], v[54:55], v[198:199]
    ds_read_b32 v244, v243 offset:147
    s_add_u32 s71, s71, 384000
    s_cbranch_vccnz L_th12_0
L_tb12_0:
    buffer_load_dwordx4 v[52:55], v1, s[24:27], s71 offen offset:0 nt
    v_add_f32_dpp v229, v228, v228 row_ror:8 row_mask:0xf bank_mask:0xc
    v_lshlrev_b32 v108, 16, v192
    v_and_b32 v109, 0xffff0000, v192
    v_pk_mul_f32 v[108:109], v[108:109], s[60:61]
    v_lshlrev_b32 v110, 16, v193
    v_and_b32 v111, 0xffff0000, v193
    s_waitcnt vmcnt(35)
    v_pk_fma_f32 v[198:199], v[148:149], v[56:57], v[198:199]
    v_pk_fma_f32 v[198:199], v[150:151], v[58:59], v[198:199]
    buffer_load_dwordx4 v[56:59], v1, s[24:27], s71 offen offset:256 nt
    v_add_f32_dpp v230, v229, v229 row_shr:4 row_mask:0xf bank_mask:0xa
    v_pk_mul_f32 v[110:111], v[110:111], s[60:61]
    v_lshlrev_b32 v112, 16, v194
    v_and_b32 v113, 0xffff0000, v194
    v_pk_mul_f32 v[112:113], v[112:113], s[60:61]
    v_lshlrev_b32 v114, 16, v195
    s_waitcnt vmcnt(35)
    v_pk_fma_f32 v[198:199], v[152:153], v[60:61], v[198:199]
    v_pk_fma_f32 v[198:199], v[154:155], v[62:63], v[198:199]
    s_waitcnt lgkmcnt(0)
    v_cmp_lt_u32 vcc, v0, v244
    ds_add_u32 v224, v243 offset:3328
    buffer_load_dwordx4 v[60:63], v1, s[24:27], s71 offen offset:512 nt
    v_add_f32_dpp v231, v230, v230 quad_perm:[2,3,0,1] row_mask:0xf bank_mask:0xf
    v_add_f32 v228, v198, v199
    v_and_b32 v115, 0xffff0000, v195
    v_pk_mul_f32 v[114:115], v[114:115], s[60:61]
    v_lshlrev_b32 v116, 16, v196
    v_and_b32 v117, 0xffff0000, v196
    v_pk_mul_f32 v[116:117], v[116:117], s[60:61]
    s_waitcnt vmcnt(35)
    v_pk_fma_f32 v[198:199], v[144:145], v[64:65], v[202:203]
    v_pk_fma_f32 v[198:199], v[146:147], v[66:67], v[198:199]
    s_add_u32 s71, s71, 3072
    s_cbranch_vccnz L_th15_0
L_tb15_0:
    buffer_load_dwordx4 v[64:67], v1, s[24:27], s71 offen offset:0 nt
    v_add_f32_dpp v229, v228, v228 row_ror:8 row_mask:0xf bank_mask:0x3
    v_lshlrev_b32 v118, 16, v197
    v_and_b32 v119, 0xffff0000, v197
    v_pk_mul_f32 v[118:119], v[118:119], s[60:61]
    s_waitcnt vmcnt(29)
    v_pk_fma_f32 v[198:199], v[148:149], v[68:69], v[198:199]
    v_pk_fma_f32 v[198:199], v[150:151], v[70:71], v[198:199]
    s_add_u32 s72, s72, 3072
    buffer_load_dwordx2 v[168:169], v2, s[32:35], s72 offen offset:0
    buffer_load_dwordx2 v[170:171], v2, s[32:35], s72 offen offset:128
    buffer_load_dwordx2 v[172:173], v2, s[32:35], s72 offen offset:256
    buffer_load_dwordx2 v[174:175], v2, s[36:39], s72 offen offset:0
    buffer_load_dwordx2 v[176:177], v2, s[36:39], s72 offen offset:128
    buffer_load_dwordx2 v[178:179], v2, s[36:39], s72 offen offset:256
    buffer_load_dwordx4 v[68:71], v1, s[24:27], s71 offen offset:256 nt
    v_lshlrev_b32 v234, 16, v132
    v_and_b32 v235, 0xffff0000, v132
    v_pk_mul_f32 v[120:121], v[234:235], v[108:109]
    v_lshlrev_b32 v234, 16, v138
    v_and_b32 v235, 0xffff0000, v138
    s_waitcnt vmcnt(35)
    v_pk_fma_f32 v[198:199], v[152:153], v[72:73], v[198:199]
    v_pk_fma_f32 v[198:199], v[154:155], v[74:75], v[198:199]
    ds_add_u32 v224, v243 offset:3328
    buffer_load_dwordx4 v[72:75], v1, s[24:27], s71 offen offset:512 nt
    v_add_f32 v228, v198, v199
    v_pk_mul_f32 v[200:201], v[120:121], v[234:235]
    v_lshlrev_b32 v234, 16, v133
    v_and_b32 v235, 0xffff0000, v133
    v_pk_mul_f32 v[122:123], v[234:235], v[110:111]
    v_lshlrev_b32 v234, 16, v139
    s_waitcnt vmcnt(35)
    v_pk_fma_f32 v[198:199], v[144:145], v[76:77], v[202:203]
    v_pk_fma_f32 v[198:199], v[146:147], v[78:79], v[198:199]
    s_add_u32 s71, s71, 3072
    s_cbranch_vccnz L_th18_0
L_tb18_0:
    buffer_load_dwordx4 v[76:79], v1, s[24:27], s71 offen offset:0 nt
    v_add_f32_dpp v229, v228, v228 row_ror:8 row_mask:0xf bank_mask:0xc
    v_and_b32 v235, 0xffff0000, v139
    v_pk_fma_f32 v[200:201], v[122:123], v[234:235], v[200:201]
    v_lshlrev_b32 v234, 16, v134
    v_and_b32 v235, 0xffff0000, v134
    v_pk_mul_f32 v[124:125], v[234:235], v[112:113]
    s_waitcnt vmcnt(35)
    v_pk_fma_f32 v[198:199], v[148:149], v[80:81], v[198:199]
    v_pk_fma_f32 v[198:199], v[150:151], v[82:83], v[198:199]
    buffer_load_dwordx4 v[80:83], v1, s[24:27], s71 offen offset:256 nt
    v_add_f32_dpp v230, v229, v229 row_shl:4 row_mask:0xf bank_mask:0x5
    v_lshlrev_b32 v234, 16, v140
    v_and_b32 v235, 0xffff0000, v140
    v_pk_fma_f32 v[200:201], v[124:125], v[234:235], v[200:201]
    v_lshlrev_b32 v234, 16, v135
    v_and_b32 v235, 0xffff0000, v135
    s_waitcnt vmcnt(35)
    v_pk_fma_f32 v[198:199], v[152:153], v[84:85], v[198:199]
    v_pk_fma_f32 v[198:199], v[154:155], v[86:87], v[198:199]
    ds_add_u32 v224, v243 offset:3328
    buffer_load_dwordx4 v[84:87], v1, s[24:27], s71 offen offset:512 nt
    v_add_f32 v228, v198, v199
    v_pk_mul_f32 v[126:127], v[234:235], v[114:115]
    v_lshlrev_b32 v234, 16, v141
    v_and_b32 v235, 0xffff0000, v141
    v_pk_fma_f32 v[200:201], v[126:127], v[234:235], v[200:201]
    v_lshlrev_b32 v234, 16, v136
    s_waitcnt vmcnt(35)
    v_pk_fma_f32 v[198:199], v[144:145], v[88:89], v[202:203]
    v_pk_fma_f32 v[198:199], v[146:147], v[90:91], v[198:199]
    s_add_u32 s71, s71, 3072
    s_cbranch_vccnz L_th21_0
L_tb21_0:
    buffer_load_dwordx4 v[88:91], v1, s[24:27], s71 offen offset:0 nt
    v_add_f32_dpp v229, v228, v228 row_ror:8 row_mask:0xf bank_mask:0x3
    v_and_b32 v235, 0xffff0000, v136
    v_pk_mul_f32 v[128:129], v[234:235], v[116:117]
    v_lshlrev_b32 v234, 16, v142
    v_and_b32 v235, 0xffff0000, v142
    v_pk_fma_f32 v[200:201], v[128:129], v[234:235], v[200:201]
    s_waitcnt vmcnt(35)
    v_pk_fma_f32 v[198:199], v[148:149], v[92:93], v[198:199]
    v_pk_fma_f32 v[198:199], v[150:151], v[94:95], v[198:199]
    buffer_load_dwordx4 v[92:95], v1, s[24:27], s71 offen offset:256 nt
    v_lshlrev_b32 v234, 16, v137
    v_and_b32 v235, 0xffff0000, v137
    v_pk_mul_f32 v[130:131], v[234:235], v[118:119]
    v_lshlrev_b32 v234, 16, v143
    v_and_b32 v235, 0xffff0000, v143
    s_waitcnt vmcnt(35)
    v_pk_fma_f32 v[198:199], v[152:153], v[96:97], v[198:199]
    v_pk_fma_f32 v[198:199], v[154:155], v[98:99], v[198:199]
    ds_add_u32 v224, v243 offset:3328
    buffer_load_dwordx4 v[96:99], v1, s[24:27], s71 offen offset:512 nt
    v_add_f32 v228, v198, v199
    v_pk_fma_f32 v[200:201], v[130:131], v[234:235], v[200:201]
    v_pk_mul_f32 v[200:201], v[200:201], s[62:63]
    s_sub_u32 s76, s76, 1
    s_cmp_lg_u32 s76, 0
    s_cbranch_scc1 L_loop0
    s_waitcnt vmcnt(35)
    v_pk_fma_f32 v[198:199], v[120:121], v[4:5], v[200:201]
    v_pk_fma_f32 v[198:199], v[122:123], v[6:7], v[198:199]
    ds_read_b32 v244, v243 offset:147
    s_add_u32 s71, s71, 384000
    s_cbranch_vccnz L_th24_1
L_tb24_1:
    buffer_load_dwordx4 v[4:7], v1, s[24:27], s71 offen offset:0 nt
    v_add_f32_dpp v229, v228, v228 row_ror:8 row_mask:0xf bank_mask:0xc
    s_waitcnt vmcnt(35)
    v_pk_fma_f32 v[198:199], v[124:125], v[8:9], v[198:199]
    v_pk_fma_f32 v[198:199], v[126:127], v[10:11], v[198:199]
    buffer_load_dwordx4 v[8:11], v1, s[24:27], s71 offen offset:256 nt
    v_add_f32_dpp v230, v229, v229 row_shr:4 row_mask:0xf bank_mask:0xa
    s_waitcnt vmcnt(35)
    v_pk_fma_f32 v[198:199], v[128:129], v[12:13], v[198:199]
    v_pk_fma_f32 v[198:199], v[130:131], v[14:15], v[198:199]
    s_waitcnt lgkmcnt(0)
    v_cmp_lt_u32 vcc, v0, v244
    ds_add_u32 v224, v243 offset:3328
    buffer_load_dwordx4 v[12:15], v1, s[24:27], s71 offen offset:512 nt
    v_add_f32_dpp v232, v230, v230 quad_perm:[2,3,0,1] row_mask:0xf bank_mask:0xf
    v_add_f32 v228, v198, v199
    s_waitcnt vmcnt(35)
    v_pk_fma_f32 v[198:199], v[120:121], v[16:17], v[200:201]
    v_pk_fma_f32 v[198:199], v[122:123], v[18:19], v[198:199]
    s_add_u32 s71, s71, 3072
    s_cbranch_vccnz L_th27_1
L_tb27_1:
    buffer_load_dwordx4 v[16:19], v1, s[24:27], s71 offen offset:0 nt
    v_cndmask_b32 v232, v231, v232, s[64:65]
    v_add_f32_dpp v229, v228, v228 row_ror:8 row_mask:0xf bank_mask:0x3
    s_waitcnt vmcnt(29)
    v_pk_fma_f32 v[198:199], v[124:125], v[20:21], v[198:199]
    v_pk_fma_f32 v[198:199], v[126:127], v[22:23], v[198:199]
    s_add_u32 s72, s72, 3072
    buffer_load_dwordx2 v[180:181], v2, s[32:35], s72 offen offset:0
    buffer_load_dwordx2 v[182:183], v2, s[32:35], s72 offen offset:128
    buffer_load_dwordx2 v[184:185], v2, s[32:35], s72 offen offset:256
    buffer_load_dwordx2 v[186:187], v2, s[36:39], s72 offen offset:0
    buffer_load_dwordx2 v[188:189], v2, s[36:39], s72 offen offset:128
    buffer_load_dwordx2 v[190:191], v2, s[36:39], s72 offen offset:256
    buffer_load_dwordx4 v[20:23], v1, s[24:27], s71 offen offset:256 nt
    v_add_f32_dpp v231, v232, v232 quad_perm:[1,0,3,2] row_mask:0xf bank_mask:0xf
    v_lshlrev_b32 v234, 16, v156
    v_and_b32 v235, 0xffff0000, v156
    v_pk_mul_f32 v[144:145], v[234:235], v[108:109]
    v_lshlrev_b32 v234, 16, v162
    v_and_b32 v235, 0xffff0000, v162
    s_waitcnt vmcnt(35)
    v_pk_fma_f32 v[198:199], v[128:129], v[24:25], v[198:199]
    v_pk_fma_f32 v[198:199], v[130:131], v[26:27], v[198:199]
    ds_add_u32 v224, v243 offset:3328
    buffer_load_dwordx4 v[24:27], v1, s[24:27], s71 offen offset:512 nt
    v_cndmask_b32 v233, v233, v231, s[66:67]
    v_mul_f32 v233, 0x58000000, v233
    ds_write_b32 v239, v233
    v_add_u32 v239, 256, v239
    v_add_f32 v228, v198, v199
    v_pk_mul_f32 v[202:203], v[144:145], v[234:235]
    v_lshlrev_b32 v234, 16, v157
    v_and_b32 v235, 0xffff0000, v157
    v_pk_mul_f32 v[146:147], v[234:235], v[110:111]
    v_lshlrev_b32 v234, 16, v163
    s_waitcnt vmcnt(35)
    v_pk_fma_f32 v[198:199], v[120:121], v[28:29], v[200:201]
    v_pk_fma_f32 v[198:199], v[122:123], v[30:31], v[198:199]
    s_add_u32 s71, s71, 3072
    s_cbranch_vccnz L_th30_1
L_tb30_1:
    buffer_load_dwordx4 v[28:31], v1, s[24:27], s71 offen offset:0 nt
    v_add_f32_dpp v229, v228, v228 row_ror:8 row_mask:0xf bank_mask:0xc
    v_and_b32 v235, 0xffff0000, v163
    v_pk_fma_f32 v[202:203], v[146:147], v[234:235], v[202:203]
    v_lshlrev_b32 v234, 16, v158
    v_and_b32 v235, 0xffff0000, v158
    v_pk_mul_f32 v[148:149], v[234:235], v[112:113]
    s_waitcnt vmcnt(35)
    v_pk_fma_f32 v[198:199], v[124:125], v[32:33], v[198:199]
    v_pk_fma_f32 v[198:199], v[126:127], v[34:35], v[198:199]
    buffer_load_dwordx4 v[32:35], v1, s[24:27], s71 offen offset:256 nt
    v_add_f32_dpp v230, v229, v229 row_shl:4 row_mask:0xf bank_mask:0x5
    v_lshlrev_b32 v234, 16, v164
    v_and_b32 v235, 0xffff0000, v164
    v_pk_fma_f32 v[202:203], v[148:149], v[234:235], v[202:203]
    v_lshlrev_b32 v234, 16, v159
    v_and_b32 v235, 0xffff0000, v159
    s_waitcnt vmcnt(35)
    v_pk_fma_f32 v[198:199], v[128:129], v[36:37], v[198:199]
    v_pk_fma_f32 v[198:199], v[130:131], v[38:39], v[198:199]
    ds_add_u32 v224, v243 offset:3328
    buffer_load_dwordx4 v[36:39], v1, s[24:27], s71 offen offset:512 nt
    v_add_f32 v228, v198, v199
    v_pk_mul_f32 v[150:151], v[234:235], v[114:115]
    v_lshlrev_b32 v234, 16, v165
    v_and_b32 v235, 0xffff0000, v165
    v_pk_fma_f32 v[202:203], v[150:151], v[234:235], v[202:203]
    v_lshlrev_b32 v234, 16, v160
    s_waitcnt vmcnt(35)
    v_pk_fma_f32 v[198:199], v[120:121], v[40:41], v[200:201]
    v_pk_fma_f32 v[198:199], v[122:123], v[42:43], v[198:199]
    s_add_u32 s71, s71, 3072
    s_cbranch_vccnz L_th33_1
L_tb33_1:
    buffer_load_dwordx4 v[40:43], v1, s[24:27], s71 offen offset:0 nt
    v_add_f32_dpp v229, v228, v228 row_ror:8 row_mask:0xf bank_mask:0x3
    v_and_b32 v235, 0xffff0000, v160
    v_pk_mul_f32 v[152:153], v[234:235], v[116:117]
    v_lshlrev_b32 v234, 16, v166
    v_and_b32 v235, 0xffff0000, v166
    v_pk_fma_f32 v[202:203], v[152:153], v[234:235], v[202:203]
    s_waitcnt vmcnt(35)
    v_pk_fma_f32 v[198:199], v[124:125], v[44:45], v[198:199]
    v_pk_fma_f32 v[198:199], v[126:127], v[46:47], v[198:199]
    buffer_load_dwordx4 v[44:47], v1, s[24:27], s71 offen offset:256 nt
    v_lshlrev_b32 v234, 16, v161
    v_and_b32 v235, 0xffff0000, v161
    v_pk_mul_f32 v[154:155], v[234:235], v[118:119]
    v_lshlrev_b32 v234, 16, v167
    v_and_b32 v235, 0xffff0000, v167
    s_waitcnt vmcnt(35)
    v_pk_fma_f32 v[198:199], v[128:129], v[48:49], v[198:199]
    v_pk_fma_f32 v[198:199], v[130:131], v[50:51], v[198:199]
    ds_add_u32 v224, v243 offset:3328
    buffer_load_dwordx4 v[48:51], v1, s[24:27], s71 offen offset:512 nt
    v_add_f32 v228, v198, v199
    v_pk_fma_f32 v[202:203], v[154:155], v[234:235], v[202:203]
    v_pk_mul_f32 v[202:203], v[202:203], s[62:63]
    s_waitcnt vmcnt(35)
    v_pk_fma_f32 v[198:199], v[144:145], v[52:53], v[202:203]
    v_pk_fma_f32 v[198:199], v[146:147], v[54:55], v[198:199]
    ds_read_b32 v244, v243 offset:147
    s_mov_b32 s91, 0
    v_readlane_b32 s70, v245, s91
    s_add_u32 s91, s91, 1
    s_and_b32 s80, s70, 31
    s_mul_i32 s80, s80, 96
    s_lshl_b32 s73, s70, 7
    s_sub_u32 s73, s73, s80
    buffer_load_ushort v220, v3, s[40:43], s73 offen
    buffer_load_ushort v221, v3, s[44:47], s73 offen
    s_add_u32 s71, s71, 384000
    s_cbranch_vccnz L_th36_1
L_tb36_1:
    buffer_load_dwordx4 v[52:55], v1, s[24:27], s71 offen offset:0 nt
    v_add_f32_dpp v229, v228, v228 row_ror:8 row_mask:0xf bank_mask:0xc
    s_waitcnt vmcnt(37)
    v_pk_fma_f32 v[198:199], v[148:149], v[56:57], v[198:199]
    v_pk_fma_f32 v[198:199], v[150:151], v[58:59], v[198:199]
    buffer_load_dwordx4 v[56:59], v1, s[24:27], s71 offen offset:256 nt
    v_add_f32_dpp v230, v229, v229 row_shr:4 row_mask:0xf bank_mask:0xa
    s_waitcnt vmcnt(37)
    v_pk_fma_f32 v[198:199], v[152:153], v[60:61], v[198:199]
    v_pk_fma_f32 v[198:199], v[154:155], v[62:63], v[198:199]
    s_waitcnt lgkmcnt(0)
    v_cmp_lt_u32 vcc, v0, v244
    ds_add_u32 v224, v243 offset:3328
    buffer_load_dwordx4 v[60:63], v1, s[24:27], s71 offen offset:512 nt
    v_add_f32_dpp v231, v230, v230 quad_perm:[2,3,0,1] row_mask:0xf bank_mask:0xf
    v_add_f32 v228, v198, v199
    s_waitcnt vmcnt(37)
    v_pk_fma_f32 v[198:199], v[144:145], v[64:65], v[202:203]
    v_pk_fma_f32 v[198:199], v[146:147], v[66:67], v[198:199]
    s_add_u32 s71, s71, 3072
    s_cbranch_vccnz L_th39_1
L_tb39_1:
    buffer_load_dwordx4 v[64:67], v1, s[24:27], s71 offen offset:0 nt
    v_add_f32_dpp v229, v228, v228 row_ror:8 row_mask:0xf bank_mask:0x3
    s_waitcnt vmcnt(31)
    v_pk_fma_f32 v[198:199], v[148:149], v[68:69], v[198:199]
    v_pk_fma_f32 v[198:199], v[150:151], v[70:71], v[198:199]
    buffer_load_dwordx4 v[68:71], v1, s[24:27], s71 offen offset:256 nt
    v_lshlrev_b32 v234, 16, v168
    v_and_b32 v235, 0xffff0000, v168
    v_pk_mul_f32 v[120:121], v[234:235], v[108:109]
    v_lshlrev_b32 v234, 16, v174
    v_and_b32 v235, 0xffff0000, v174
    s_waitcnt vmcnt(31)
    v_pk_fma_f32 v[198:199], v[152:153], v[72:73], v[198:199]
    v_pk_fma_f32 v[198:199], v[154:155], v[74:75], v[198:199]
    ds_add_u32 v224, v243 offset:3328
    buffer_load_dwordx4 v[72:75], v1, s[24:27], s71 offen offset:512 nt
    v_add_f32 v228, v198, v199
    v_pk_mul_f32 v[200:201], v[120:121], v[234:235]
    v_lshlrev_b32 v234, 16, v169
    v_and_b32 v235, 0xffff0000, v169
    v_pk_mul_f32 v[122:123], v[234:235], v[110:111]
    v_lshlrev_b32 v234, 16, v175
    s_waitcnt vmcnt(31)
    v_pk_fma_f32 v[198:199], v[144:145], v[76:77], v[202:203]
    v_pk_fma_f32 v[198:199], v[146:147], v[78:79], v[198:199]
    s_add_u32 s71, s71, 3072
    s_cbranch_vccnz L_th42_1
L_tb42_1:
    buffer_load_dwordx4 v[76:79], v1, s[24:27], s71 offen offset:0 nt
    v_add_f32_dpp v229, v228, v228 row_ror:8 row_mask:0xf bank_mask:0xc
    v_and_b32 v235, 0xffff0000, v175
    v_pk_fma_f32 v[200:201], v[122:123], v[234:235], v[200:201]
    v_lshlrev_b32 v234, 16, v170
    v_and_b32 v235, 0xffff0000, v170
    v_pk_mul_f32 v[124:125], v[234:235], v[112:113]
    s_waitcnt vmcnt(31)
    v_pk_fma_f32 v[198:199], v[148:149], v[80:81], v[198:199]
    v_pk_fma_f32 v[198:199], v[150:151], v[82:83], v[198:199]
    buffer_load_dwordx4 v[80:83], v1, s[24:27], s71 offen offset:256 nt
    v_add_f32_dpp v230, v229, v229 row_shl:4 row_mask:0xf bank_mask:0x5
    v_lshlrev_b32 v234, 16, v176
    v_and_b32 v235, 0xffff0000, v176
    v_pk_fma_f32 v[200:201], v[124:125], v[234:235], v[200:201]
    v_lshlrev_b32 v234, 16, v171
    v_and_b32 v235, 0xffff0000, v171
    s_waitcnt vmcnt(31)
    v_pk_fma_f32 v[198:199], v[152:153], v[84:85], v[198:199]
    v_pk_fma_f32 v[198:199], v[154:155], v[86:87], v[198:199]
    ds_add_u32 v224, v243 offset:3328
    buffer_load_dwordx4 v[84:87], v1, s[24:27], s71 offen offset:512 nt
    v_add_f32 v228, v198, v199
    v_pk_mul_f32 v[126:127], v[234:235], v[114:115]
    v_lshlrev_b32 v234, 16, v177
    v_and_b32 v235, 0xffff0000, v177
    v_pk_fma_f32 v[200:201], v[126:127], v[234:235], v[200:201]
    v_lshlrev_b32 v234, 16, v172
    s_waitcnt vmcnt(31)
    v_pk_fma_f32 v[198:199], v[144:145], v[88:89], v[202:203]
    v_pk_fma_f32 v[198:199], v[146:147], v[90:91], v[198:199]
    s_add_u32 s71, s71, 3072
    s_cbranch_vccnz L_th45_1
L_tb45_1:
    buffer_load_dwordx4 v[88:91], v1, s[24:27], s71 offen offset:0 nt
    v_add_f32_dpp v229, v228, v228 row_ror:8 row_mask:0xf bank_mask:0x3
    v_and_b32 v235, 0xffff0000, v172
    v_pk_mul_f32 v[128:129], v[234:235], v[116:117]
    v_lshlrev_b32 v234, 16, v178
    v_and_b32 v235, 0xffff0000, v178
    v_pk_fma_f32 v[200:201], v[128:129], v[234:235], v[200:201]
    s_waitcnt vmcnt(31)
    v_pk_fma_f32 v[198:199], v[148:149], v[92:93], v[198:199]
    v_pk_fma_f32 v[198:199], v[150:151], v[94:95], v[198:199]
    buffer_load_dwordx4 v[92:95], v1, s[24:27], s71 offen offset:256 nt
    v_lshlrev_b32 v234, 16, v173
    v_and_b32 v235, 0xffff0000, v173
    v_pk_mul_f32 v[130:131], v[234:235], v[118:119]
    v_lshlrev_b32 v234, 16, v179
    v_and_b32 v235, 0xffff0000, v179
    s_waitcnt vmcnt(31)
    v_pk_fma_f32 v[198:199], v[152:153], v[96:97], v[198:199]
    v_pk_fma_f32 v[198:199], v[154:155], v[98:99], v[198:199]
    ds_add_u32 v224, v243 offset:3328
    buffer_load_dwordx4 v[96:99], v1, s[24:27], s71 offen offset:512 nt
    v_add_f32 v228, v198, v199
    v_pk_fma_f32 v[200:201], v[130:131], v[234:235], v[200:201]
    v_pk_mul_f32 v[200:201], v[200:201], s[62:63]
    s_waitcnt vmcnt(31)
    v_pk_fma_f32 v[198:199], v[120:121], v[4:5], v[200:201]
    v_pk_fma_f32 v[198:199], v[122:123], v[6:7], v[198:199]
    ds_read_b32 v244, v243 offset:147
    s_mul_i32 s71, s70, 49152
    s_and_b32 s80, s70, 31
    s_mul_i32 s80, s80, 36864
    s_sub_u32 s71, s71, s80
    s_cbranch_vccnz L_th0_1
L_tb0_1:
    buffer_load_dwordx4 v[4:7], v1, s[28:31], s71 offen offset:0 nt
    v_add_f32_dpp v229, v228, v228 row_ror:8 row_mask:0xf bank_mask:0xc
    s_waitcnt vmcnt(31)
    v_pk_fma_f32 v[198:199], v[124:125], v[8:9], v[198:199]
    v_pk_fma_f32 v[198:199], v[126:127], v[10:11], v[198:199]
    buffer_load_dwordx4 v[8:11], v1, s[28:31], s71 offen offset:256 nt
    v_add_f32_dpp v230, v229, v229 row_shr:4 row_mask:0xf bank_mask:0xa
    s_waitcnt vmcnt(31)
    v_pk_fma_f32 v[198:199], v[128:129], v[12:13], v[198:199]
    v_pk_fma_f32 v[198:199], v[130:131], v[14:15], v[198:199]
    s_waitcnt lgkmcnt(0)
    v_cmp_lt_u32 vcc, v0, v244
    ds_add_u32 v224, v243 offset:3328
    buffer_load_dwordx4 v[12:15], v1, s[28:31], s71 offen offset:512 nt
    v_add_f32_dpp v232, v230, v230 quad_perm:[2,3,0,1] row_mask:0xf bank_mask:0xf
    v_add_f32 v228, v198, v199
    s_waitcnt vmcnt(31)
    v_pk_fma_f32 v[198:199], v[120:121], v[16:17], v[200:201]
    v_pk_fma_f32 v[198:199], v[122:123], v[18:19], v[198:199]
    s_add_u32 s71, s71, 3072
    s_cbranch_vccnz L_th3_1
L_tb3_1:
    buffer_load_dwordx4 v[16:19], v1, s[28:31], s71 offen offset:0 nt
    v_cndmask_b32 v232, v231, v232, s[64:65]
    v_add_f32_dpp v229, v228, v228 row_ror:8 row_mask:0xf bank_mask:0x3
    s_waitcnt vmcnt(25)
    v_pk_fma_f32 v[198:199], v[124:125], v[20:21], v[198:199]
    v_pk_fma_f32 v[198:199], v[126:127], v[22:23], v[198:199]
    buffer_load_dwordx4 v[20:23], v1, s[28:31], s71 offen offset:256 nt
    v_add_f32_dpp v233, v232, v232 quad_perm:[1,0,3,2] row_mask:0xf bank_mask:0xf
    v_lshlrev_b32 v234, 16, v180
    v_and_b32 v235, 0xffff0000, v180
    v_pk_mul_f32 v[144:145], v[234:235], v[108:109]
    v_lshlrev_b32 v234, 16, v186
    v_and_b32 v235, 0xffff0000, v186
    s_waitcnt vmcnt(25)
    v_pk_fma_f32 v[198:199], v[128:129], v[24:25], v[198:199]
    v_pk_fma_f32 v[198:199], v[130:131], v[26:27], v[198:199]
    ds_add_u32 v224, v243 offset:3328
    buffer_load_dwordx4 v[24:27], v1, s[28:31], s71 offen offset:512 nt
    v_add_f32 v228, v198, v199
    v_pk_mul_f32 v[202:203], v[144:145], v[234:235]
    v_lshlrev_b32 v234, 16, v181
    v_and_b32 v235, 0xffff0000, v181
    v_pk_mul_f32 v[146:147], v[234:235], v[110:111]
    v_lshlrev_b32 v234, 16, v187
    s_waitcnt vmcnt(25)
    v_pk_fma_f32 v[198:199], v[120:121], v[28:29], v[200:201]
    v_pk_fma_f32 v[198:199], v[122:123], v[30:31], v[198:199]
    s_add_u32 s71, s71, 3072
    s_cbranch_vccnz L_th6_1
L_tb6_1:
    buffer_load_dwordx4 v[28:31], v1, s[28:31], s71 offen offset:0 nt
    v_add_f32_dpp v229, v228, v228 row_ror:8 row_mask:0xf bank_mask:0xc
    v_and_b32 v235, 0xffff0000, v187
    v_pk_fma_f32 v[202:203], v[146:147], v[234:235], v[202:203]
    v_lshlrev_b32 v234, 16, v182
    v_and_b32 v235, 0xffff0000, v182
    v_pk_mul_f32 v[148:149], v[234:235], v[112:113]
    s_waitcnt vmcnt(25)
    v_pk_fma_f32 v[198:199], v[124:125], v[32:33], v[198:199]
    v_pk_fma_f32 v[198:199], v[126:127], v[34:35], v[198:199]
    buffer_load_dwordx4 v[32:35], v1, s[28:31], s71 offen offset:256 nt
    v_add_f32_dpp v230, v229, v229 row_shl:4 row_mask:0xf bank_mask:0x5
    v_lshlrev_b32 v234, 16, v188
    v_and_b32 v235, 0xffff0000, v188
    v_pk_fma_f32 v[202:203], v[148:149], v[234:235], v[202:203]
    v_lshlrev_b32 v234, 16, v183
    v_and_b32 v235, 0xffff0000, v183
    s_waitcnt vmcnt(25)
    v_pk_fma_f32 v[198:199], v[128:129], v[36:37], v[198:199]
    v_pk_fma_f32 v[198:199], v[130:131], v[38:39], v[198:199]
    ds_add_u32 v224, v243 offset:3328
    buffer_load_dwordx4 v[36:39], v1, s[28:31], s71 offen offset:512 nt
    v_add_f32 v228, v198, v199
    v_pk_mul_f32 v[150:151], v[234:235], v[114:115]
    v_lshlrev_b32 v234, 16, v189
    v_and_b32 v235, 0xffff0000, v189
    v_pk_fma_f32 v[202:203], v[150:151], v[234:235], v[202:203]
    v_lshlrev_b32 v234, 16, v184
    s_waitcnt vmcnt(25)
    v_pk_fma_f32 v[198:199], v[120:121], v[40:41], v[200:201]
    v_pk_fma_f32 v[198:199], v[122:123], v[42:43], v[198:199]
    s_add_u32 s71, s71, 3072
    s_cbranch_vccnz L_th9_1
L_tb9_1:
    buffer_load_dwordx4 v[40:43], v1, s[28:31], s71 offen offset:0 nt
    v_add_f32_dpp v229, v228, v228 row_ror:8 row_mask:0xf bank_mask:0x3
    v_and_b32 v235, 0xffff0000, v184
    v_pk_mul_f32 v[152:153], v[234:235], v[116:117]
    v_lshlrev_b32 v234, 16, v190
    v_and_b32 v235, 0xffff0000, v190
    v_pk_fma_f32 v[202:203], v[152:153], v[234:235], v[202:203]
    s_waitcnt vmcnt(25)
    v_pk_fma_f32 v[198:199], v[124:125], v[44:45], v[198:199]
    v_pk_fma_f32 v[198:199], v[126:127], v[46:47], v[198:199]
    buffer_load_dwordx4 v[44:47], v1, s[28:31], s71 offen offset:256 nt
    v_lshlrev_b32 v234, 16, v185
    v_and_b32 v235, 0xffff0000, v185
    v_pk_mul_f32 v[154:155], v[234:235], v[118:119]
    v_lshlrev_b32 v234, 16, v191
    v_and_b32 v235, 0xffff0000, v191
    s_waitcnt vmcnt(25)
    v_pk_fma_f32 v[198:199], v[128:129], v[48:49], v[198:199]
    v_pk_fma_f32 v[198:199], v[130:131], v[50:51], v[198:199]
    ds_add_u32 v224, v243 offset:3328
    buffer_load_dwordx4 v[48:51], v1, s[28:31], s71 offen offset:512 nt
    v_add_f32 v228, v198, v199
    v_pk_fma_f32 v[202:203], v[154:155], v[234:235], v[202:203]
    v_pk_mul_f32 v[202:203], v[202:203], s[62:63]
    s_waitcnt vmcnt(23)
    v_pk_fma_f32 v[198:199], v[144:145], v[52:53], v[202:203]
    v_pk_fma_f32 v[198:199], v[146:147], v[54:55], v[198:199]
    ds_read_b32 v244, v243 offset:147
    s_add_u32 s71, s71, 384000
    s_cbranch_vccnz L_th12_1
L_tb12_1:
    buffer_load_dwordx4 v[52:55], v1, s[28:31], s71 offen offset:0 nt
    v_add_f32_dpp v229, v228, v228 row_ror:8 row_mask:0xf bank_mask:0xc
    s_waitcnt vmcnt(23)
    v_pk_fma_f32 v[198:199], v[148:149], v[56:57], v[198:199]
    v_pk_fma_f32 v[198:199], v[150:151], v[58:59], v[198:199]
    buffer_load_dwordx4 v[56:59], v1, s[28:31], s71 offen offset:256 nt
    v_add_f32_dpp v230, v229, v229 row_shr:4 row_mask:0xf bank_mask:0xa
    s_waitcnt vmcnt(23)
    v_pk_fma_f32 v[198:199], v[152:153], v[60:61], v[198:199]
    v_pk_fma_f32 v[198:199], v[154:155], v[62:63], v[198:199]
    s_waitcnt lgkmcnt(0)
    v_cmp_lt_u32 vcc, v0, v244
    ds_add_u32 v224, v243 offset:3328
    buffer_load_dwordx4 v[60:63], v1, s[28:31], s71 offen offset:512 nt
    v_add_f32_dpp v231, v230, v230 quad_perm:[2,3,0,1] row_mask:0xf bank_mask:0xf
    v_add_f32 v228, v198, v199
    s_waitcnt vmcnt(23)
    v_pk_fma_f32 v[198:199], v[144:145], v[64:65], v[202:203]
    v_pk_fma_f32 v[198:199], v[146:147], v[66:67], v[198:199]
    s_add_u32 s71, s71, 3072
    s_cbranch_vccnz L_th15_1
L_tb15_1:
    buffer_load_dwordx4 v[64:67], v1, s[28:31], s71 offen offset:0 nt
    v_add_f32_dpp v229, v228, v228 row_ror:8 row_mask:0xf bank_mask:0x3
    s_waitcnt vmcnt(23)
    v_pk_fma_f32 v[198:199], v[148:149], v[68:69], v[198:199]
    v_pk_fma_f32 v[198:199], v[150:151], v[70:71], v[198:199]
    buffer_load_dwordx4 v[68:71], v1, s[28:31], s71 offen offset:256 nt
    s_waitcnt vmcnt(23)
    v_pk_fma_f32 v[198:199], v[152:153], v[72:73], v[198:199]
    v_pk_fma_f32 v[198:199], v[154:155], v[74:75], v[198:199]
    ds_add_u32 v224, v243 offset:3328
    buffer_load_dwordx4 v[72:75], v1, s[28:31], s71 offen offset:512 nt
    s_branch L_x1
L_w1:
    s_branch L_w2
L_x1:
    v_add_f32 v228, v198, v199
    s_waitcnt vmcnt(23)
    v_pk_fma_f32 v[198:199], v[144:145], v[76:77], v[202:203]
    v_pk_fma_f32 v[198:199], v[146:147], v[78:79], v[198:199]
    s_add_u32 s71, s71, 3072
    s_cbranch_vccnz L_th18_1
L_tb18_1:
    buffer_load_dwordx4 v[76:79], v1, s[28:31], s71 offen offset:0 nt
    v_add_f32_dpp v229, v228, v228 row_ror:8 row_mask:0xf bank_mask:0xc
    s_waitcnt vmcnt(23)
    v_pk_fma_f32 v[198:199], v[148:149], v[80:81], v[198:199]
    v_pk_fma_f32 v[198:199], v[150:151], v[82:83], v[198:199]
    buffer_load_dwordx4 v[80:83], v1, s[28:31], s71 offen offset:256 nt
    v_add_f32_dpp v230, v229, v229 row_shl:4 row_mask:0xf bank_mask:0x5
    s_waitcnt vmcnt(23)
    v_pk_fma_f32 v[198:199], v[152:153], v[84:85], v[198:199]
    v_pk_fma_f32 v[198:199], v[154:155], v[86:87], v[198:199]
    ds_add_u32 v224, v243 offset:3328
    buffer_load_dwordx4 v[84:87], v1, s[28:31], s71 offen offset:512 nt
    v_add_f32 v228, v198, v199
    s_waitcnt vmcnt(23)
    v_pk_fma_f32 v[198:199], v[144:145], v[88:89], v[202:203]
    v_pk_fma_f32 v[198:199], v[146:147], v[90:91], v[198:199]
    s_add_u32 s71, s71, 3072
    s_cbranch_vccnz L_th21_1
L_tb21_1:
    buffer_load_dwordx4 v[88:91], v1, s[28:31], s71 offen offset:0 nt
    v_add_f32_dpp v229, v228, v228 row_ror:8 row_mask:0xf bank_mask:0x3
    s_waitcnt vmcnt(23)
    v_pk_fma_f32 v[198:199], v[148:149], v[92:93], v[198:199]
    v_pk_fma_f32 v[198:199], v[150:151], v[94:95], v[198:199]
    buffer_load_dwordx4 v[92:95], v1, s[28:31], s71 offen offset:256 nt
    s_waitcnt vmcnt(23)
    v_pk_fma_f32 v[198:199], v[152:153], v[96:97], v[198:199]
    v_pk_fma_f32 v[198:199], v[154:155], v[98:99], v[198:199]
    ds_add_u32 v224, v243 offset:3328
    buffer_load_dwordx4 v[96:99], v1, s[28:31], s71 offen offset:512 nt
    v_add_f32 v228, v198, v199
    s_nop 1
    v_add_f32_dpp v229, v228, v228 row_ror:8 row_mask:0xf bank_mask:0xc
    s_nop 1
    v_add_f32_dpp v230, v229, v229 row_shr:4 row_mask:0xf bank_mask:0xa
    s_nop 1
    v_add_f32_dpp v232, v230, v230 quad_perm:[2,3,0,1] row_mask:0xf bank_mask:0xf
    s_nop 1
    v_cndmask_b32 v232, v231, v232, s[64:65]
    s_nop 1
    v_add_f32_dpp v231, v232, v232 quad_perm:[1,0,3,2] row_mask:0xf bank_mask:0xf
    s_nop 1
    v_cndmask_b32 v233, v233, v231, s[66:67]
    v_mul_f32 v233, 0x58000000, v233
    ds_write_b32 v239, v233
    v_add_u32 v239, 256, v239
    s_mov_b64 exec, 1
    ds_add_u32 v243, v243 offset:127
    s_mov_b64 exec, -1
    ds_read_b32 v223, v240
    v_add_u32 v240, 256, v240
    v_lshlrev_b32 v220, 16, v220
    v_lshlrev_b32 v221, 16, v221
    s_waitcnt lgkmcnt(0)
    v_max_f32_dpp v234, v223, v223 row_ror:8 row_mask:0xf bank_mask:0xf
    s_nop 1
    v_max_f32_dpp v234, v234, v234 row_ror:4 row_mask:0xf bank_mask:0xf
    s_nop 1
    v_max_f32_dpp v234, v234, v234 row_ror:2 row_mask:0xf bank_mask:0xf
    s_nop 1
    v_max_f32_dpp v234, v234, v234 row_ror:1 row_mask:0xf bank_mask:0xf
    v_mov_b32 v228, v216
    v_max3_f32 v234, v234, v228, s77
    v_sub_f32 v235, v228, v234
    v_sub_f32 v229, v223, v234
    v_exp_f32 v235, v235
    v_exp_f32 v229, v229
    s_nop 0
    v_mul_f32 v222, v229, v220
    v_mul_f32 v230, v222, v221
    v_mul_f32 v238, 0x71800000, v222
    s_nop 0
    s_mov_b32 s76, 63
L_loop1:
    v_mov_b32_dpp v236, v238 row_newbcast:0 row_mask:0xf bank_mask:0xf
    s_waitcnt vmcnt(23)
    v_pk_fma_f32 v[204:205], v[236:237], v[4:5], v[204:205] op_sel_hi:[0,1,1]
    v_pk_fma_f32 v[206:207], v[236:237], v[6:7], v[206:207] op_sel_hi:[0,1,1]
    s_nop 1
    ds_read_b32 v244, v243 offset:147
    s_add_u32 s71, s71, 384000
    s_cbranch_vccnz L_th24_2
L_tb24_2:
    buffer_load_dwordx4 v[4:7], v1, s[28:31], s71 offen offset:0 nt
    s_bitcmp0_b32 s4, 0
    s_cbranch_scc1 L_nofl2
    s_mov_b64 exec, 1
    ds_add_u32 v242, v243
    s_mov_b64 exec, -1
    v_add_u32 v241, 4096, v241
    v_add_u32 v242, 4, v242
L_nofl2:
    s_waitcnt vmcnt(23)
    v_pk_fma_f32 v[208:209], v[236:237], v[8:9], v[208:209] op_sel_hi:[0,1,1]
    v_pk_fma_f32 v[210:211], v[236:237], v[10:11], v[210:211] op_sel_hi:[0,1,1]
    s_nop 1
    buffer_load_dwordx4 v[8:11], v1, s[28:31], s71 offen offset:256 nt
    v_pk_mul_f32 v[212:213], v[212:213], v[234:235] op_sel:[0,1] op_sel_hi:[1,1]
    v_pk_mul_f32 v[214:215], v[214:215], v[234:235] op_sel:[0,1] op_sel_hi:[1,1]
    v_mov_b32 v216, v234
    s_waitcnt vmcnt(23)
    v_pk_fma_f32 v[212:213], v[236:237], v[12:13], v[212:213] op_sel_hi:[0,1,1]
    v_pk_fma_f32 v[214:215], v[236:237], v[14:15], v[214:215] op_sel_hi:[0,1,1]
    s_nop 1
    s_waitcnt lgkmcnt(0)
    v_cmp_lt_u32 vcc, v0, v244
    ds_add_u32 v224, v243 offset:3328
    buffer_load_dwordx4 v[12:15], v1, s[28:31], s71 offen offset:512 nt
    v_fma_f32 v217, v217, v235, v229
    v_mov_b32_dpp v236, v238 row_newbcast:8 row_mask:0xf bank_mask:0xf
    s_waitcnt vmcnt(23)
    v_pk_fma_f32 v[204:205], v[236:237], v[16:17], v[204:205] op_sel_hi:[0,1,1]
    v_pk_fma_f32 v[206:207], v[236:237], v[18:19], v[206:207] op_sel_hi:[0,1,1]
    s_nop 1
    s_add_u32 s71, s71, 3072
    s_cbranch_vccnz L_th27_2
L_tb27_2:
    buffer_load_dwordx4 v[16:19], v1, s[28:31], s71 offen offset:0 nt
    v_fma_f32 v218, v218, v235, v230
    s_waitcnt vmcnt(23)
    v_pk_fma_f32 v[208:209], v[236:237], v[20:21], v[208:209] op_sel_hi:[0,1,1]
    v_pk_fma_f32 v[210:211], v[236:237], v[22:23], v[210:211] op_sel_hi:[0,1,1]
    s_nop 1
    buffer_load_dwordx4 v[20:23], v1, s[28:31], s71 offen offset:256 nt
    ds_read_b32 v223, v240
    v_add_u32 v240, 256, v240
    s_waitcnt vmcnt(23)
    v_pk_fma_f32 v[212:213], v[236:237], v[24:25], v[212:213] op_sel_hi:[0,1,1]
    v_pk_fma_f32 v[214:215], v[236:237], v[26:27], v[214:215] op_sel_hi:[0,1,1]
    s_nop 1
    ds_add_u32 v224, v243 offset:3328
    buffer_load_dwordx4 v[24:27], v1, s[28:31], s71 offen offset:512 nt
    v_mov_b32_dpp v236, v238 row_newbcast:4 row_mask:0xf bank_mask:0xf
    s_waitcnt vmcnt(23)
    v_pk_fma_f32 v[204:205], v[236:237], v[28:29], v[204:205] op_sel_hi:[0,1,1]
    v_pk_fma_f32 v[206:207], v[236:237], v[30:31], v[206:207] op_sel_hi:[0,1,1]
    s_nop 1
    s_add_u32 s71, s71, 3072
    s_cbranch_vccnz L_th30_2
L_tb30_2:
    buffer_load_dwordx4 v[28:31], v1, s[28:31], s71 offen offset:0 nt
    ds_write_b128 v241, v[216:219] offset:23552
    s_waitcnt vmcnt(23)
    v_pk_fma_f32 v[208:209], v[236:237], v[32:33], v[208:209] op_sel_hi:[0,1,1]
    v_pk_fma_f32 v[210:211], v[236:237], v[34:35], v[210:211] op_sel_hi:[0,1,1]
    s_nop 1
    buffer_load_dwordx4 v[32:35], v1, s[28:31], s71 offen offset:256 nt
    s_waitcnt vmcnt(23)
    v_pk_fma_f32 v[212:213], v[236:237], v[36:37], v[212:213] op_sel_hi:[0,1,1]
    v_pk_fma_f32 v[214:215], v[236:237], v[38:39], v[214:215] op_sel_hi:[0,1,1]
    s_nop 1
    ds_add_u32 v224, v243 offset:3328
    buffer_load_dwordx4 v[36:39], v1, s[28:31], s71 offen offset:512 nt
    v_mov_b32_dpp v236, v238 row_newbcast:12 row_mask:0xf bank_mask:0xf
    s_waitcnt vmcnt(23)
    v_pk_fma_f32 v[204:205], v[236:237], v[40:41], v[204:205] op_sel_hi:[0,1,1]
    v_pk_fma_f32 v[206:207], v[236:237], v[42:43], v[206:207] op_sel_hi:[0,1,1]
    s_nop 1
    s_add_u32 s71, s71, 3072
    s_cbranch_vccnz L_th33_2
L_tb33_2:
    buffer_load_dwordx4 v[40:43], v1, s[28:31], s71 offen offset:0 nt
    s_waitcnt vmcnt(23)
    v_pk_fma_f32 v[208:209], v[236:237], v[44:45], v[208:209] op_sel_hi:[0,1,1]
    v_pk_fma_f32 v[210:211], v[236:237], v[46:47], v[210:211] op_sel_hi:[0,1,1]
    s_nop 1
    buffer_load_dwordx4 v[44:47], v1, s[28:31], s71 offen offset:256 nt
    s_waitcnt vmcnt(23)
    v_pk_fma_f32 v[212:213], v[236:237], v[48:49], v[212:213] op_sel_hi:[0,1,1]
    v_pk_fma_f32 v[214:215], v[236:237], v[50:51], v[214:215] op_sel_hi:[0,1,1]
    s_nop 1
    ds_add_u32 v224, v243 offset:3328
    buffer_load_dwordx4 v[48:51], v1, s[28:31], s71 offen offset:512 nt
    v_mov_b32_dpp v236, v238 row_newbcast:2 row_mask:0xf bank_mask:0xf
    s_waitcnt vmcnt(23)
    v_pk_fma_f32 v[204:205], v[236:237], v[52:53], v[204:205] op_sel_hi:[0,1,1]
    v_pk_fma_f32 v[206:207], v[236:237], v[54:55], v[206:207] op_sel_hi:[0,1,1]
    s_nop 1
    ds_read_b32 v244, v243 offset:147
    v_readlane_b32 s70, v245, s91
    s_add_u32 s91, s91, 1
    s_and_b32 s80, s70, 31
    s_mul_i32 s80, s80, 96
    s_lshl_b32 s73, s70, 7
    s_sub_u32 s73, s73, s80
    buffer_load_ushort v220, v3, s[40:43], s73 offen
    buffer_load_ushort v221, v3, s[44:47], s73 offen
    s_add_u32 s71, s71, 384000
    s_cbranch_vccnz L_th36_2
L_tb36_2:
    buffer_load_dwordx4 v[52:55], v1, s[28:31], s71 offen offset:0 nt
    s_waitcnt vmcnt(25)
    v_pk_fma_f32 v[208:209], v[236:237], v[56:57], v[208:209] op_sel_hi:[0,1,1]
    v_pk_fma_f32 v[210:211], v[236:237], v[58:59], v[210:211] op_sel_hi:[0,1,1]
    s_nop 1
    buffer_load_dwordx4 v[56:59], v1, s[28:31], s71 offen offset:256 nt
    s_waitcnt vmcnt(25)
    v_pk_fma_f32 v[212:213], v[236:237], v[60:61], v[212:213] op_sel_hi:[0,1,1]
    v_pk_fma_f32 v[214:215], v[236:237], v[62:63], v[214:215] op_sel_hi:[0,1,1]
    s_nop 1
    s_waitcnt lgkmcnt(0)
    v_cmp_lt_u32 vcc, v0, v244
    ds_add_u32 v224, v243 offset:3328
    buffer_load_dwordx4 v[60:63], v1, s[28:31], s71 offen offset:512 nt
    v_mov_b32_dpp v236, v238 row_newbcast:10 row_mask:0xf bank_mask:0xf
    s_waitcnt vmcnt(25)
    v_pk_fma_f32 v[204:205], v[236:237], v[64:65], v[204:205] op_sel_hi:[0,1,1]
    v_pk_fma_f32 v[206:207], v[236:237], v[66:67], v[206:207] op_sel_hi:[0,1,1]
    s_nop 1
    s_add_u32 s71, s71, 3072
    s_cbranch_vccnz L_th39_2
L_tb39_2:
    buffer_load_dwordx4 v[64:67], v1, s[28:31], s71 offen offset:0 nt
    s_waitcnt vmcnt(25)
    v_pk_fma_f32 v[208:209], v[236:237], v[68:69], v[208:209] op_sel_hi:[0,1,1]
    v_pk_fma_f32 v[210:211], v[236:237], v[70:71], v[210:211] op_sel_hi:[0,1,1]
    s_nop 1
    buffer_load_dwordx4 v[68:71], v1, s[28:31], s71 offen offset:256 nt
    s_waitcnt vmcnt(25)
    v_pk_fma_f32 v[212:213], v[236:237], v[72:73], v[212:213] op_sel_hi:[0,1,1]
    v_pk_fma_f32 v[214:215], v[236:237], v[74:75], v[214:215] op_sel_hi:[0,1,1]
    s_nop 1
    ds_add_u32 v224, v243 offset:3328
    buffer_load_dwordx4 v[72:75], v1, s[28:31], s71 offen offset:512 nt
    v_mov_b32_dpp v236, v238 row_newbcast:6 row_mask:0xf bank_mask:0xf
    s_waitcnt vmcnt(25)
    v_pk_fma_f32 v[204:205], v[236:237], v[76:77], v[204:205] op_sel_hi:[0,1,1]
    v_pk_fma_f32 v[206:207], v[236:237], v[78:79], v[206:207] op_sel_hi:[0,1,1]
    s_nop 1
    s_add_u32 s71, s71, 3072
    s_cbranch_vccnz L_th42_2
L_tb42_2:
    buffer_load_dwordx4 v[76:79], v1, s[28:31], s71 offen offset:0 nt
    s_waitcnt vmcnt(25)
    v_pk_fma_f32 v[208:209], v[236:237], v[80:81], v[208:209] op_sel_hi:[0,1,1]
    v_pk_fma_f32 v[210:211], v[236:237], v[82:83], v[210:211] op_sel_hi:[0,1,1]
    s_nop 1
    buffer_load_dwordx4 v[80:83], v1, s[28:31], s71 offen offset:256 nt
    s_waitcnt vmcnt(25)
    v_pk_fma_f32 v[212:213], v[236:237], v[84:85], v[212:213] op_sel_hi:[0,1,1]
    v_pk_fma_f32 v[214:215], v[236:237], v[86:87], v[214:215] op_sel_hi:[0,1,1]
    s_nop 1
    ds_add_u32 v224, v243 offset:3328
    buffer_load_dwordx4 v[84:87], v1, s[28:31], s71 offen offset:512 nt
    v_mov_b32_dpp v236, v238 row_newbcast:14 row_mask:0xf bank_mask:0xf
    s_waitcnt vmcnt(25)
    v_pk_fma_f32 v[204:205], v[236:237], v[88:89], v[204:205] op_sel_hi:[0,1,1]
    v_pk_fma_f32 v[206:207], v[236:237], v[90:91], v[206:207] op_sel_hi:[0,1,1]
    s_nop 1
    s_add_u32 s71, s71, 3072
    s_cbranch_vccnz L_th45_2
L_tb45_2:
    buffer_load_dwordx4 v[88:91], v1, s[28:31], s71 offen offset:0 nt
    s_waitcnt vmcnt(25)
    v_pk_fma_f32 v[208:209], v[236:237], v[92:93], v[208:209] op_sel_hi:[0,1,1]
    v_pk_fma_f32 v[210:211], v[236:237], v[94:95], v[210:211] op_sel_hi:[0,1,1]
    s_nop 1
    buffer_load_dwordx4 v[92:95], v1, s[28:31], s71 offen offset:256 nt
    s_cmp_eq_u32 s76, 16
    s_cbranch_scc1 L_getm2
L_gotm2:
    s_waitcnt vmcnt(25)
    v_pk_fma_f32 v[212:213], v[236:237], v[96:97], v[212:213] op_sel_hi:[0,1,1]
    v_pk_fma_f32 v[214:215], v[236:237], v[98:99], v[214:215] op_sel_hi:[0,1,1]
    s_nop 1
    ds_add_u32 v224, v243 offset:3328
    buffer_load_dwordx4 v[96:99], v1, s[28:31], s71 offen offset:512 nt
    v_mov_b32_dpp v236, v238 row_newbcast:1 row_mask:0xf bank_mask:0xf
    s_waitcnt vmcnt(25)
    v_pk_fma_f32 v[204:205], v[236:237], v[4:5], v[204:205] op_sel_hi:[0,1,1]
    v_pk_fma_f32 v[206:207], v[236:237], v[6:7], v[206:207] op_sel_hi:[0,1,1]
    s_nop 1
    ds_read_b32 v244, v243 offset:147
    s_mul_i32 s71, s70, 49152
    s_and_b32 s80, s70, 31
    s_mul_i32 s80, s80, 36864
    s_sub_u32 s71, s71, s80
    s_cbranch_vccnz L_th0_2
L_tb0_2:
    buffer_load_dwordx4 v[4:7], v1, s[28:31], s71 offen offset:0 nt
    s_waitcnt vmcnt(25)
    v_pk_fma_f32 v[208:209], v[236:237], v[8:9], v[208:209] op_sel_hi:[0,1,1]
    v_pk_fma_f32 v[210:211], v[236:237], v[10:11], v[210:211] op_sel_hi:[0,1,1]
    s_nop 1
    buffer_load_dwordx4 v[8:11], v1, s[28:31], s71 offen offset:256 nt
    s_waitcnt vmcnt(25)
    v_pk_fma_f32 v[212:213], v[236:237], v[12:13], v[212:213] op_sel_hi:[0,1,1]
    v_pk_fma_f32 v[214:215], v[236:237], v[14:15], v[214:215] op_sel_hi:[0,1,1]
    s_nop 1
    s_waitcnt lgkmcnt(0)
    v_cmp_lt_u32 vcc, v0, v244
    ds_add_u32 v224, v243 offset:3328
    buffer_load_dwordx4 v[12:15], v1, s[28:31], s71 offen offset:512 nt
    v_max_f32_dpp v234, v223, v223 row_ror:8 row_mask:0xf bank_mask:0xf
    v_mov_b32_dpp v236, v238 row_newbcast:9 row_mask:0xf bank_mask:0xf
    s_waitcnt vmcnt(25)
    v_pk_fma_f32 v[204:205], v[236:237], v[16:17], v[204:205] op_sel_hi:[0,1,1]
    v_pk_fma_f32 v[206:207], v[236:237], v[18:19], v[206:207] op_sel_hi:[0,1,1]
    s_nop 1
    s_add_u32 s71, s71, 3072
    s_cbranch_vccnz L_th3_2
L_tb3_2:
    buffer_load_dwordx4 v[16:19], v1, s[28:31], s71 offen offset:0 nt
    v_max_f32_dpp v234, v234, v234 row_ror:4 row_mask:0xf bank_mask:0xf
    s_waitcnt vmcnt(25)
    v_pk_fma_f32 v[208:209], v[236:237], v[20:21], v[208:209] op_sel_hi:[0,1,1]
    v_pk_fma_f32 v[210:211], v[236:237], v[22:23], v[210:211] op_sel_hi:[0,1,1]
    s_nop 1
    buffer_load_dwordx4 v[20:23], v1, s[28:31], s71 offen offset:256 nt
    v_max_f32_dpp v234, v234, v234 row_ror:2 row_mask:0xf bank_mask:0xf
    s_waitcnt vmcnt(25)
    v_pk_fma_f32 v[212:213], v[236:237], v[24:25], v[212:213] op_sel_hi:[0,1,1]
    v_pk_fma_f32 v[214:215], v[236:237], v[26:27], v[214:215] op_sel_hi:[0,1,1]
    s_nop 1
    ds_add_u32 v224, v243 offset:3328
    buffer_load_dwordx4 v[24:27], v1, s[28:31], s71 offen offset:512 nt
    v_max_f32_dpp v234, v234, v234 row_ror:1 row_mask:0xf bank_mask:0xf
    v_mov_b32_dpp v236, v238 row_newbcast:5 row_mask:0xf bank_mask:0xf
    s_waitcnt vmcnt(25)
    v_pk_fma_f32 v[204:205], v[236:237], v[28:29], v[204:205] op_sel_hi:[0,1,1]
    v_pk_fma_f32 v[206:207], v[236:237], v[30:31], v[206:207] op_sel_hi:[0,1,1]
    s_nop 1
    s_add_u32 s71, s71, 3072
    s_cbranch_vccnz L_th6_2
L_tb6_2:
    buffer_load_dwordx4 v[28:31], v1, s[28:31], s71 offen offset:0 nt
    s_lshr_b64 s[4:5], s[4:5], 1
    s_bitcmp1_b32 s4, 0
    s_cselect_b32 s6, s7, 0x7f7fffff
    v_min_f32 v228, s6, v216
    s_waitcnt vmcnt(25)
    v_pk_fma_f32 v[208:209], v[236:237], v[32:33], v[208:209] op_sel_hi:[0,1,1]
    v_pk_fma_f32 v[210:211], v[236:237], v[34:35], v[210:211] op_sel_hi:[0,1,1]
    s_nop 1
    buffer_load_dwordx4 v[32:35], v1, s[28:31], s71 offen offset:256 nt
    v_max3_f32 v234, v234, v228, s77
    s_waitcnt vmcnt(25)
    v_pk_fma_f32 v[212:213], v[236:237], v[36:37], v[212:213] op_sel_hi:[0,1,1]
    v_pk_fma_f32 v[214:215], v[236:237], v[38:39], v[214:215] op_sel_hi:[0,1,1]
    s_nop 1
    ds_add_u32 v224, v243 offset:3328
    buffer_load_dwordx4 v[36:39], v1, s[28:31], s71 offen offset:512 nt
    v_sub_f32 v235, v228, v234
    v_sub_f32 v229, v223, v234
    v_mov_b32_dpp v236, v238 row_newbcast:13 row_mask:0xf bank_mask:0xf
    s_waitcnt vmcnt(25)
    v_pk_fma_f32 v[204:205], v[236:237], v[40:41], v[204:205] op_sel_hi:[0,1,1]
    v_pk_fma_f32 v[206:207], v[236:237], v[42:43], v[206:207] op_sel_hi:[0,1,1]
    s_nop 1
    s_add_u32 s71, s71, 3072
    s_cbranch_vccnz L_th9_2
L_tb9_2:
    buffer_load_dwordx4 v[40:43], v1, s[28:31], s71 offen offset:0 nt
    v_exp_f32 v235, v235
    s_waitcnt vmcnt(25)
    v_pk_fma_f32 v[208:209], v[236:237], v[44:45], v[208:209] op_sel_hi:[0,1,1]
    v_pk_fma_f32 v[210:211], v[236:237], v[46:47], v[210:211] op_sel_hi:[0,1,1]
    s_nop 1
    buffer_load_dwordx4 v[44:47], v1, s[28:31], s71 offen offset:256 nt
    v_exp_f32 v229, v229
    s_waitcnt vmcnt(25)
    v_pk_fma_f32 v[212:213], v[236:237], v[48:49], v[212:213] op_sel_hi:[0,1,1]
    v_pk_fma_f32 v[214:215], v[236:237], v[50:51], v[214:215] op_sel_hi:[0,1,1]
    s_nop 1
    ds_add_u32 v224, v243 offset:3328
    buffer_load_dwordx4 v[48:51], v1, s[28:31], s71 offen offset:512 nt
    v_mov_b32_dpp v236, v238 row_newbcast:3 row_mask:0xf bank_mask:0xf
    s_waitcnt vmcnt(23)
    v_pk_fma_f32 v[204:205], v[236:237], v[52:53], v[204:205] op_sel_hi:[0,1,1]
    v_pk_fma_f32 v[206:207], v[236:237], v[54:55], v[206:207] op_sel_hi:[0,1,1]
    s_nop 1
    ds_read_b32 v244, v243 offset:147
    s_add_u32 s71, s71, 384000
    s_cbranch_vccnz L_th12_2
L_tb12_2:
    buffer_load_dwordx4 v[52:55], v1, s[28:31], s71 offen offset:0 nt
    v_lshlrev_b32 v220, 16, v220
    s_waitcnt vmcnt(23)
    v_pk_fma_f32 v[208:209], v[236:237], v[56:57], v[208:209] op_sel_hi:[0,1,1]
    v_pk_fma_f32 v[210:211], v[236:237], v[58:59], v[210:211] op_sel_hi:[0,1,1]
    s_nop 1
    buffer_load_dwordx4 v[56:59], v1, s[28:31], s71 offen offset:256 nt
    v_lshlrev_b32 v221, 16, v221
    s_waitcnt vmcnt(23)
    v_pk_fma_f32 v[212:213], v[236:237], v[60:61], v[212:213] op_sel_hi:[0,1,1]
    v_pk_fma_f32 v[214:215], v[236:237], v[62:63], v[214:215] op_sel_hi:[0,1,1]
    s_nop 1
    s_waitcnt lgkmcnt(0)
    v_cmp_lt_u32 vcc, v0, v244
    ds_add_u32 v224, v243 offset:3328
    buffer_load_dwordx4 v[60:63], v1, s[28:31], s71 offen offset:512 nt
    v_mov_b32_dpp v236, v238 row_newbcast:11 row_mask:0xf bank_mask:0xf
    s_waitcnt vmcnt(23)
    v_pk_fma_f32 v[204:205], v[236:237], v[64:65], v[204:205] op_sel_hi:[0,1,1]
    v_pk_fma_f32 v[206:207], v[236:237], v[66:67], v[206:207] op_sel_hi:[0,1,1]
    s_nop 1
    s_add_u32 s71, s71, 3072
    s_cbranch_vccnz L_th15_2
L_tb15_2:
    buffer_load_dwordx4 v[64:67], v1, s[28:31], s71 offen offset:0 nt
    v_mul_f32 v222, v229, v220
    s_waitcnt vmcnt(23)
    v_pk_fma_f32 v[208:209], v[236:237], v[68:69], v[208:209] op_sel_hi:[0,1,1]
    v_pk_fma_f32 v[210:211], v[236:237], v[70:71], v[210:211] op_sel_hi:[0,1,1]
    s_nop 1
    buffer_load_dwordx4 v[68:71], v1, s[28:31], s71 offen offset:256 nt
    v_mul_f32 v230, v222, v221
    s_waitcnt vmcnt(23)
    v_pk_fma_f32 v[212:213], v[236:237], v[72:73], v[212:213] op_sel_hi:[0,1,1]
    v_pk_fma_f32 v[214:215], v[236:237], v[74:75], v[214:215] op_sel_hi:[0,1,1]
    s_nop 1
    ds_add_u32 v224, v243 offset:3328
    buffer_load_dwordx4 v[72:75], v1, s[28:31], s71 offen offset:512 nt
    v_mov_b32_dpp v236, v238 row_newbcast:7 row_mask:0xf bank_mask:0xf
    s_waitcnt vmcnt(23)
    v_pk_fma_f32 v[204:205], v[236:237], v[76:77], v[204:205] op_sel_hi:[0,1,1]
    v_pk_fma_f32 v[206:207], v[236:237], v[78:79], v[206:207] op_sel_hi:[0,1,1]
    s_nop 1
    s_add_u32 s71, s71, 3072
    s_cbranch_vccnz L_th18_2
L_tb18_2:
    buffer_load_dwordx4 v[76:79], v1, s[28:31], s71 offen offset:0 nt
    s_waitcnt vmcnt(23)
    v_pk_fma_f32 v[208:209], v[236:237], v[80:81], v[208:209] op_sel_hi:[0,1,1]
    v_pk_fma_f32 v[210:211], v[236:237], v[82:83], v[210:211] op_sel_hi:[0,1,1]
    s_nop 1
    buffer_load_dwordx4 v[80:83], v1, s[28:31], s71 offen offset:256 nt
    s_waitcnt vmcnt(23)
    v_pk_fma_f32 v[212:213], v[236:237], v[84:85], v[212:213] op_sel_hi:[0,1,1]
    v_pk_fma_f32 v[214:215], v[236:237], v[86:87], v[214:215] op_sel_hi:[0,1,1]
    s_nop 1
    ds_add_u32 v224, v243 offset:3328
    buffer_load_dwordx4 v[84:87], v1, s[28:31], s71 offen offset:512 nt
    v_mov_b32_dpp v236, v238 row_newbcast:15 row_mask:0xf bank_mask:0xf
    s_waitcnt vmcnt(23)
    v_pk_fma_f32 v[204:205], v[236:237], v[88:89], v[204:205] op_sel_hi:[0,1,1]
    v_pk_fma_f32 v[206:207], v[236:237], v[90:91], v[206:207] op_sel_hi:[0,1,1]
    s_nop 1
    s_add_u32 s71, s71, 3072
    s_cbranch_vccnz L_th21_2
L_tb21_2:
    buffer_load_dwordx4 v[88:91], v1, s[28:31], s71 offen offset:0 nt
    ds_write_b128 v241, v[204:207] offset:20480
    v_mul_f32 v238, 0x71800000, v222
    s_waitcnt vmcnt(23)
    v_pk_fma_f32 v[208:209], v[236:237], v[92:93], v[208:209] op_sel_hi:[0,1,1]
    v_pk_fma_f32 v[210:211], v[236:237], v[94:95], v[210:211] op_sel_hi:[0,1,1]
    s_nop 1
    buffer_load_dwordx4 v[92:95], v1, s[28:31], s71 offen offset:256 nt
    ds_write_b128 v241, v[208:211] offset:21504
    v_pk_mul_f32 v[204:205], v[204:205], v[234:235] op_sel:[0,1] op_sel_hi:[1,1]
    v_pk_mul_f32 v[206:207], v[206:207], v[234:235] op_sel:[0,1] op_sel_hi:[1,1]
    s_waitcnt vmcnt(23)
    v_pk_fma_f32 v[212:213], v[236:237], v[96:97], v[212:213] op_sel_hi:[0,1,1]
    v_pk_fma_f32 v[214:215], v[236:237], v[98:99], v[214:215] op_sel_hi:[0,1,1]
    s_nop 1
    ds_add_u32 v224, v243 offset:3328
    buffer_load_dwordx4 v[96:99], v1, s[28:31], s71 offen offset:512 nt
    ds_write_b128 v241, v[212:215] offset:22528
    v_pk_mul_f32 v[208:209], v[208:209], v[234:235] op_sel:[0,1] op_sel_hi:[1,1]
    v_pk_mul_f32 v[210:211], v[210:211], v[234:235] op_sel:[0,1] op_sel_hi:[1,1]
    s_sub_u32 s76, s76, 1
    s_cmp_lg_u32 s76, 0
    s_cbranch_scc1 L_loop1
    v_mov_b32_dpp v236, v238 row_newbcast:0 row_mask:0xf bank_mask:0xf
    s_waitcnt vmcnt(23)
    v_pk_fma_f32 v[204:205], v[236:237], v[4:5], v[204:205] op_sel_hi:[0,1,1]
    v_pk_fma_f32 v[206:207], v[236:237], v[6:7], v[206:207] op_sel_hi:[0,1,1]
    s_nop 1
    ds_read_b32 v244, v243 offset:147
    s_add_u32 s71, s71, 384000
    s_cbranch_vccnz L_th24_3
L_tb24_3:
    buffer_load_dwordx4 v[4:7], v1, s[28:31], s71 offen offset:0 nt
    s_bitcmp0_b32 s4, 0
    s_cbranch_scc1 L_nofl3
    s_mov_b64 exec, 1
    ds_add_u32 v242, v243
    s_mov_b64 exec, -1
    v_add_u32 v241, 4096, v241
    v_add_u32 v242, 4, v242
L_nofl3:
    s_waitcnt vmcnt(23)
    v_pk_fma_f32 v[208:209], v[236:237], v[8:9], v[208:209] op_sel_hi:[0,1,1]
    v_pk_fma_f32 v[210:211], v[236:237], v[10:11], v[210:211] op_sel_hi:[0,1,1]
    s_nop 1
    buffer_load_dwordx4 v[8:11], v1, s[28:31], s71 offen offset:256 nt
    v_pk_mul_f32 v[212:213], v[212:213], v[234:235] op_sel:[0,1] op_sel_hi:[1,1]
    v_pk_mul_f32 v[214:215], v[214:215], v[234:235] op_sel:[0,1] op_sel_hi:[1,1]
    v_mov_b32 v216, v234
    s_waitcnt vmcnt(23)
    v_pk_fma_f32 v[212:213], v[236:237], v[12:13], v[212:213] op_sel_hi:[0,1,1]
    v_pk_fma_f32 v[214:215], v[236:237], v[14:15], v[214:215] op_sel_hi:[0,1,1]
    s_nop 1
    s_waitcnt lgkmcnt(0)
    v_cmp_lt_u32 vcc, v0, v244
    ds_add_u32 v224, v243 offset:3328
    buffer_load_dwordx4 v[12:15], v1, s[28:31], s71 offen offset:512 nt
    v_fma_f32 v217, v217, v235, v229
    v_mov_b32_dpp v236, v238 row_newbcast:8 row_mask:0xf bank_mask:0xf
    s_waitcnt vmcnt(23)
    v_pk_fma_f32 v[204:205], v[236:237], v[16:17], v[204:205] op_sel_hi:[0,1,1]
    v_pk_fma_f32 v[206:207], v[236:237], v[18:19], v[206:207] op_sel_hi:[0,1,1]
    s_nop 1
    s_add_u32 s71, s71, 3072
    s_cbranch_vccnz L_th27_3
L_tb27_3:
    buffer_load_dwordx4 v[16:19], v1, s[28:31], s71 offen offset:0 nt
    v_fma_f32 v218, v218, v235, v230
    s_waitcnt vmcnt(23)
    v_pk_fma_f32 v[208:209], v[236:237], v[20:21], v[208:209] op_sel_hi:[0,1,1]
    v_pk_fma_f32 v[210:211], v[236:237], v[22:23], v[210:211] op_sel_hi:[0,1,1]
    s_nop 1
    buffer_load_dwordx4 v[20:23], v1, s[28:31], s71 offen offset:256 nt
    s_mov_b64 exec, s[88:89]
    buffer_store_dwordx4 v[100:103], v225, s[52:55], s78 offen offset:0
    s_mov_b64 exec, -1
    s_waitcnt vmcnt(23)
    v_pk_fma_f32 v[212:213], v[236:237], v[24:25], v[212:213] op_sel_hi:[0,1,1]
    v_pk_fma_f32 v[214:215], v[236:237], v[26:27], v[214:215] op_sel_hi:[0,1,1]
    s_nop 1
    ds_add_u32 v224, v243 offset:3328
    buffer_load_dwordx4 v[24:27], v1, s[28:31], s71 offen offset:512 nt
    v_add_f32_dpp v218, v218, v218 row_ror:8 row_mask:0xf bank_mask:0xf
    v_mov_b32_dpp v236, v238 row_newbcast:4 row_mask:0xf bank_mask:0xf
    s_waitcnt vmcnt(23)
    v_pk_fma_f32 v[204:205], v[236:237], v[28:29], v[204:205] op_sel_hi:[0,1,1]
    v_pk_fma_f32 v[206:207], v[236:237], v[30:31], v[206:207] op_sel_hi:[0,1,1]
    s_nop 1
    s_add_u32 s71, s71, 3072
    s_cbranch_vccnz L_th30_3
L_tb30_3:
    buffer_load_dwordx4 v[28:31], v1, s[28:31], s71 offen offset:0 nt
    v_add_f32_dpp v218, v218, v218 row_ror:4 row_mask:0xf bank_mask:0xf
    s_waitcnt vmcnt(23)
    v_pk_fma_f32 v[208:209], v[236:237], v[32:33], v[208:209] op_sel_hi:[0,1,1]
    v_pk_fma_f32 v[210:211], v[236:237], v[34:35], v[210:211] op_sel_hi:[0,1,1]
    s_nop 1
    buffer_load_dwordx4 v[32:35], v1, s[28:31], s71 offen offset:256 nt
    v_add_f32_dpp v218, v218, v218 row_ror:2 row_mask:0xf bank_mask:0xf
    s_waitcnt vmcnt(23)
    v_pk_fma_f32 v[212:213], v[236:237], v[36:37], v[212:213] op_sel_hi:[0,1,1]
    v_pk_fma_f32 v[214:215], v[236:237], v[38:39], v[214:215] op_sel_hi:[0,1,1]
    s_nop 1
    ds_add_u32 v224, v243 offset:3328
    buffer_load_dwordx4 v[36:39], v1, s[28:31], s71 offen offset:512 nt
    v_add_f32_dpp v218, v218, v218 row_ror:1 row_mask:0xf bank_mask:0xf
    v_mov_b32_dpp v236, v238 row_newbcast:12 row_mask:0xf bank_mask:0xf
    s_waitcnt vmcnt(23)
    v_pk_fma_f32 v[204:205], v[236:237], v[40:41], v[204:205] op_sel_hi:[0,1,1]
    v_pk_fma_f32 v[206:207], v[236:237], v[42:43], v[206:207] op_sel_hi:[0,1,1]
    s_nop 1
    s_add_u32 s71, s71, 3072
    s_cbranch_vccnz L_th33_3
L_tb33_3:
    buffer_load_dwordx4 v[40:43], v1, s[28:31], s71 offen offset:0 nt
    v_mov_b32 v234, v218
    s_waitcnt vmcnt(23)
    v_pk_fma_f32 v[208:209], v[236:237], v[44:45], v[208:209] op_sel_hi:[0,1,1]
    v_pk_fma_f32 v[210:211], v[236:237], v[46:47], v[210:211] op_sel_hi:[0,1,1]
    s_nop 1
    buffer_load_dwordx4 v[44:47], v1, s[28:31], s71 offen offset:256 nt
    v_permlane32_swap_b32 v218, v234
    s_waitcnt vmcnt(23)
    v_pk_fma_f32 v[212:213], v[236:237], v[48:49], v[212:213] op_sel_hi:[0,1,1]
    v_pk_fma_f32 v[214:215], v[236:237], v[50:51], v[214:215] op_sel_hi:[0,1,1]
    s_nop 1
    ds_add_u32 v224, v243 offset:3328
    buffer_load_dwordx4 v[48:51], v1, s[28:31], s71 offen offset:512 nt
    v_add_f32 v218, v218, v234
    v_mov_b32_dpp v236, v238 row_newbcast:2 row_mask:0xf bank_mask:0xf
    s_waitcnt vmcnt(23)
    v_pk_fma_f32 v[204:205], v[236:237], v[52:53], v[204:205] op_sel_hi:[0,1,1]
    v_pk_fma_f32 v[206:207], v[236:237], v[54:55], v[206:207] op_sel_hi:[0,1,1]
    s_nop 1
    ds_read_b32 v244, v243 offset:147
    s_add_u32 s71, s71, 384000
    s_cbranch_vccnz L_th36_3
L_tb36_3:
    buffer_load_dwordx4 v[52:55], v1, s[28:31], s71 offen offset:0 nt
    v_mov_b32 v234, v218
    s_waitcnt vmcnt(23)
    v_pk_fma_f32 v[208:209], v[236:237], v[56:57], v[208:209] op_sel_hi:[0,1,1]
    v_pk_fma_f32 v[210:211], v[236:237], v[58:59], v[210:211] op_sel_hi:[0,1,1]
    s_nop 1
    buffer_load_dwordx4 v[56:59], v1, s[28:31], s71 offen offset:256 nt
    v_permlane16_swap_b32 v218, v234
    s_waitcnt vmcnt(23)
    v_pk_fma_f32 v[212:213], v[236:237], v[60:61], v[212:213] op_sel_hi:[0,1,1]
    v_pk_fma_f32 v[214:215], v[236:237], v[62:63], v[214:215] op_sel_hi:[0,1,1]
    s_nop 1
    s_waitcnt lgkmcnt(0)
    v_cmp_lt_u32 vcc, v0, v244
    ds_add_u32 v224, v243 offset:3328
    buffer_load_dwordx4 v[60:63], v1, s[28:31], s71 offen offset:512 nt
    v_add_f32 v218, v218, v234
    v_mov_b32_dpp v236, v238 row_newbcast:10 row_mask:0xf bank_mask:0xf
    s_waitcnt vmcnt(23)
    v_pk_fma_f32 v[204:205], v[236:237], v[64:65], v[204:205] op_sel_hi:[0,1,1]
    v_pk_fma_f32 v[206:207], v[236:237], v[66:67], v[206:207] op_sel_hi:[0,1,1]
    s_nop 1
    s_add_u32 s71, s71, 3072
    s_cbranch_vccnz L_th39_3
L_tb39_3:
    buffer_load_dwordx4 v[64:67], v1, s[28:31], s71 offen offset:0 nt
    v_mov_b32 v103, s93
    v_lshlrev_b32 v235, 4, v0
    s_lshl_b32 s78, s3, 11
    s_mov_b32 s6, 0x58000000
    s_waitcnt vmcnt(23)
    v_pk_fma_f32 v[208:209], v[236:237], v[68:69], v[208:209] op_sel_hi:[0,1,1]
    v_pk_fma_f32 v[210:211], v[236:237], v[70:71], v[210:211] op_sel_hi:[0,1,1]
    s_nop 1
    buffer_load_dwordx4 v[68:71], v1, s[28:31], s71 offen offset:256 nt
    s_waitcnt vmcnt(23)
    v_pk_fma_f32 v[212:213], v[236:237], v[72:73], v[212:213] op_sel_hi:[0,1,1]
    v_pk_fma_f32 v[214:215], v[236:237], v[74:75], v[214:215] op_sel_hi:[0,1,1]
    s_nop 1
    ds_add_u32 v224, v243 offset:3328
    buffer_load_dwordx4 v[72:75], v1, s[28:31], s71 offen offset:512 nt
    v_mov_b32_dpp v236, v238 row_newbcast:6 row_mask:0xf bank_mask:0xf
    s_waitcnt vmcnt(23)
    v_pk_fma_f32 v[204:205], v[236:237], v[76:77], v[204:205] op_sel_hi:[0,1,1]
    v_pk_fma_f32 v[206:207], v[236:237], v[78:79], v[206:207] op_sel_hi:[0,1,1]
    s_nop 1
    s_add_u32 s71, s71, 3072
    s_cbranch_vccnz L_th42_3
L_tb42_3:
    buffer_load_dwordx4 v[76:79], v1, s[28:31], s71 offen offset:0 nt
    s_waitcnt vmcnt(23)
    v_pk_fma_f32 v[208:209], v[236:237], v[80:81], v[208:209] op_sel_hi:[0,1,1]
    v_pk_fma_f32 v[210:211], v[236:237], v[82:83], v[210:211] op_sel_hi:[0,1,1]
    s_nop 1
    buffer_load_dwordx4 v[80:83], v1, s[28:31], s71 offen offset:256 nt
    s_waitcnt vmcnt(23)
    v_pk_fma_f32 v[212:213], v[236:237], v[84:85], v[212:213] op_sel_hi:[0,1,1]
    v_pk_fma_f32 v[214:215], v[236:237], v[86:87], v[214:215] op_sel_hi:[0,1,1]
    s_nop 1
    ds_add_u32 v224, v243 offset:3328
    buffer_load_dwordx4 v[84:87], v1, s[28:31], s71 offen offset:512 nt
    v_mov_b32_dpp v236, v238 row_newbcast:14 row_mask:0xf bank_mask:0xf
    s_waitcnt vmcnt(23)
    v_pk_fma_f32 v[204:205], v[236:237], v[88:89], v[204:205] op_sel_hi:[0,1,1]
    v_pk_fma_f32 v[206:207], v[236:237], v[90:91], v[206:207] op_sel_hi:[0,1,1]
    s_nop 1
    s_add_u32 s71, s71, 3072
    s_cbranch_vccnz L_th45_3
L_tb45_3:
    buffer_load_dwordx4 v[88:91], v1, s[28:31], s71 offen offset:0 nt
    s_waitcnt vmcnt(23)
    v_pk_fma_f32 v[208:209], v[236:237], v[92:93], v[208:209] op_sel_hi:[0,1,1]
    v_pk_fma_f32 v[210:211], v[236:237], v[94:95], v[210:211] op_sel_hi:[0,1,1]
    s_nop 1
    buffer_load_dwordx4 v[92:95], v1, s[28:31], s71 offen offset:256 nt
    s_waitcnt vmcnt(23)
    v_pk_fma_f32 v[212:213], v[236:237], v[96:97], v[212:213] op_sel_hi:[0,1,1]
    v_pk_fma_f32 v[214:215], v[236:237], v[98:99], v[214:215] op_sel_hi:[0,1,1]
    s_nop 1
    ds_add_u32 v224, v243 offset:3328
    buffer_load_dwordx4 v[96:99], v1, s[28:31], s71 offen offset:512 nt
    ds_write_b32 v243, v243 offset:143
    v_mov_b32_dpp v236, v238 row_newbcast:1 row_mask:0xf bank_mask:0xf
    s_waitcnt vmcnt(23)
    v_pk_fma_f32 v[204:205], v[236:237], v[4:5], v[204:205] op_sel_hi:[0,1,1]
    s_branch L_x2
L_w2:
    s_branch L_w3
L_x2:
    v_pk_fma_f32 v[206:207], v[236:237], v[6:7], v[206:207] op_sel_hi:[0,1,1]
    s_waitcnt vmcnt(22)
    v_pk_fma_f32 v[208:209], v[236:237], v[8:9], v[208:209] op_sel_hi:[0,1,1]
    v_pk_fma_f32 v[210:211], v[236:237], v[10:11], v[210:211] op_sel_hi:[0,1,1]
    s_waitcnt vmcnt(21)
    v_pk_fma_f32 v[212:213], v[236:237], v[12:13], v[212:213] op_sel_hi:[0,1,1]
    v_pk_fma_f32 v[214:215], v[236:237], v[14:15], v[214:215] op_sel_hi:[0,1,1]
    v_mov_b32_dpp v236, v238 row_newbcast:9 row_mask:0xf bank_mask:0xf
    s_waitcnt vmcnt(20)
    v_pk_fma_f32 v[204:205], v[236:237], v[16:17], v[204:205] op_sel_hi:[0,1,1]
    v_pk_fma_f32 v[206:207], v[236:237], v[18:19], v[206:207] op_sel_hi:[0,1,1]
    s_waitcnt vmcnt(19)
    v_pk_fma_f32 v[208:209], v[236:237], v[20:21], v[208:209] op_sel_hi:[0,1,1]
    v_pk_fma_f32 v[210:211], v[236:237], v[22:23], v[210:211] op_sel_hi:[0,1,1]
    s_waitcnt vmcnt(18)
    v_pk_fma_f32 v[212:213], v[236:237], v[24:25], v[212:213] op_sel_hi:[0,1,1]
    v_pk_fma_f32 v[214:215], v[236:237], v[26:27], v[214:215] op_sel_hi:[0,1,1]
    v_mov_b32_dpp v236, v238 row_newbcast:5 row_mask:0xf bank_mask:0xf
    s_waitcnt vmcnt(17)
    v_pk_fma_f32 v[204:205], v[236:237], v[28:29], v[204:205] op_sel_hi:[0,1,1]
    v_pk_fma_f32 v[206:207], v[236:237], v[30:31], v[206:207] op_sel_hi:[0,1,1]
    s_waitcnt vmcnt(16)
    v_pk_fma_f32 v[208:209], v[236:237], v[32:33], v[208:209] op_sel_hi:[0,1,1]
    v_pk_fma_f32 v[210:211], v[236:237], v[34:35], v[210:211] op_sel_hi:[0,1,1]
    s_waitcnt vmcnt(15)
    v_pk_fma_f32 v[212:213], v[236:237], v[36:37], v[212:213] op_sel_hi:[0,1,1]
    v_pk_fma_f32 v[214:215], v[236:237], v[38:39], v[214:215] op_sel_hi:[0,1,1]
    v_mov_b32_dpp v236, v238 row_newbcast:13 row_mask:0xf bank_mask:0xf
    s_waitcnt vmcnt(14)
    v_pk_fma_f32 v[204:205], v[236:237], v[40:41], v[204:205] op_sel_hi:[0,1,1]
    v_pk_fma_f32 v[206:207], v[236:237], v[42:43], v[206:207] op_sel_hi:[0,1,1]
    s_waitcnt vmcnt(13)
    v_pk_fma_f32 v[208:209], v[236:237], v[44:45], v[208:209] op_sel_hi:[0,1,1]
    v_pk_fma_f32 v[210:211], v[236:237], v[46:47], v[210:211] op_sel_hi:[0,1,1]
    s_waitcnt vmcnt(12)
    v_pk_fma_f32 v[212:213], v[236:237], v[48:49], v[212:213] op_sel_hi:[0,1,1]
    v_pk_fma_f32 v[214:215], v[236:237], v[50:51], v[214:215] op_sel_hi:[0,1,1]
    v_mov_b32_dpp v236, v238 row_newbcast:3 row_mask:0xf bank_mask:0xf
    s_waitcnt vmcnt(11)
    v_pk_fma_f32 v[204:205], v[236:237], v[52:53], v[204:205] op_sel_hi:[0,1,1]
    v_pk_fma_f32 v[206:207], v[236:237], v[54:55], v[206:207] op_sel_hi:[0,1,1]
    s_waitcnt vmcnt(10)
    v_pk_fma_f32 v[208:209], v[236:237], v[56:57], v[208:209] op_sel_hi:[0,1,1]
    v_pk_fma_f32 v[210:211], v[236:237], v[58:59], v[210:211] op_sel_hi:[0,1,1]
    s_waitcnt vmcnt(9)
    v_pk_fma_f32 v[212:213], v[236:237], v[60:61], v[212:213] op_sel_hi:[0,1,1]
    v_pk_fma_f32 v[214:215], v[236:237], v[62:63], v[214:215] op_sel_hi:[0,1,1]
    v_mov_b32_dpp v236, v238 row_newbcast:11 row_mask:0xf bank_mask:0xf
    s_waitcnt vmcnt(8)
    v_pk_fma_f32 v[204:205], v[236:237], v[64:65], v[204:205] op_sel_hi:[0,1,1]
    v_pk_fma_f32 v[206:207], v[236:237], v[66:67], v[206:207] op_sel_hi:[0,1,1]
    s_waitcnt vmcnt(7)
    v_pk_fma_f32 v[208:209], v[236:237], v[68:69], v[208:209] op_sel_hi:[0,1,1]
    v_pk_fma_f32 v[210:211], v[236:237], v[70:71], v[210:211] op_sel_hi:[0,1,1]
    s_waitcnt vmcnt(6)
    v_pk_fma_f32 v[212:213], v[236:237], v[72:73], v[212:213] op_sel_hi:[0,1,1]
    v_pk_fma_f32 v[214:215], v[236:237], v[74:75], v[214:215] op_sel_hi:[0,1,1]
    v_mov_b32_dpp v236, v238 row_newbcast:7 row_mask:0xf bank_mask:0xf
    s_waitcnt vmcnt(5)
    v_pk_fma_f32 v[204:205], v[236:237], v[76:77], v[204:205] op_sel_hi:[0,1,1]
    v_pk_fma_f32 v[206:207], v[236:237], v[78:79], v[206:207] op_sel_hi:[0,1,1]
    s_waitcnt vmcnt(4)
    v_pk_fma_f32 v[208:209], v[236:237], v[80:81], v[208:209] op_sel_hi:[0,1,1]
    v_pk_fma_f32 v[210:211], v[236:237], v[82:83], v[210:211] op_sel_hi:[0,1,1]
    s_waitcnt vmcnt(3)
    v_pk_fma_f32 v[212:213], v[236:237], v[84:85], v[212:213] op_sel_hi:[0,1,1]
    v_pk_fma_f32 v[214:215], v[236:237], v[86:87], v[214:215] op_sel_hi:[0,1,1]
    v_mov_b32_dpp v236, v238 row_newbcast:15 row_mask:0xf bank_mask:0xf
    s_waitcnt vmcnt(2)
    v_pk_fma_f32 v[204:205], v[236:237], v[88:89], v[204:205] op_sel_hi:[0,1,1]
    v_pk_fma_f32 v[206:207], v[236:237], v[90:91], v[206:207] op_sel_hi:[0,1,1]
    s_waitcnt vmcnt(1)
    v_pk_fma_f32 v[208:209], v[236:237], v[92:93], v[208:209] op_sel_hi:[0,1,1]
    v_pk_fma_f32 v[210:211], v[236:237], v[94:95], v[210:211] op_sel_hi:[0,1,1]
    v_permlane32_swap_b32 v204, v206
    v_permlane32_swap_b32 v205, v207
    v_add_f32 v204, v204, v206
    v_add_f32 v205, v205, v207
    v_permlane32_swap_b32 v208, v210
    v_permlane32_swap_b32 v209, v211
    v_add_f32 v208, v208, v210
    v_add_f32 v209, v209, v211
    v_permlane16_swap_b32 v204, v205
    v_add_f32 v204, v204, v205
    v_fma_f32 v100, v204, s6, -v218
    v_permlane16_swap_b32 v208, v209
    v_add_f32 v208, v208, v209
    v_fma_f32 v101, v208, s6, -v218
    s_waitcnt vmcnt(0)
    v_pk_fma_f32 v[212:213], v[236:237], v[96:97], v[212:213] op_sel_hi:[0,1,1]
    v_pk_fma_f32 v[214:215], v[236:237], v[98:99], v[214:215] op_sel_hi:[0,1,1]
    s_nop 1
    v_permlane32_swap_b32 v212, v214
    v_permlane32_swap_b32 v213, v215
    v_add_f32 v212, v212, v214
    v_add_f32 v213, v213, v215
    s_nop 1
    v_permlane16_swap_b32 v212, v213
    v_add_f32 v212, v212, v213
    v_fma_f32 v102, v212, s6, -v218
    s_mov_b64 exec, s[88:89]
    buffer_store_dwordx4 v[100:103], v225, s[52:55], s78 offen offset:0
    s_not_b64 exec, exec
    buffer_store_dwordx4 v[100:103], v225, s[52:55], s78 offen offset:0 sc0 sc1
    s_mov_b64 exec, -1
L_final:
    s_endpgm
L_th24_0:
    s_waitcnt vmcnt(32)
    s_cmp_eq_u32 vcc_lo, 1
    s_cbranch_scc1 L_tb24_0
    s_waitcnt vmcnt(23)
    s_branch L_tb24_0
L_th27_0:
    s_waitcnt vmcnt(26)
    s_cmp_eq_u32 vcc_lo, 1
    s_cbranch_scc1 L_tb27_0
    s_waitcnt vmcnt(23)
    s_branch L_tb27_0
L_th30_0:
    s_waitcnt vmcnt(32)
    s_cmp_eq_u32 vcc_lo, 1
    s_cbranch_scc1 L_tb30_0
    s_waitcnt vmcnt(29)
    s_branch L_tb30_0
L_th33_0:
    s_waitcnt vmcnt(32)
    s_cmp_eq_u32 vcc_lo, 1
    s_cbranch_scc1 L_tb33_0
    s_waitcnt vmcnt(29)
    s_branch L_tb33_0
L_th36_0:
    s_waitcnt vmcnt(35)
    s_cmp_eq_u32 vcc_lo, 1
    s_cbranch_scc1 L_tb36_0
    s_waitcnt vmcnt(26)
    s_branch L_tb36_0
L_th39_0:
    s_waitcnt vmcnt(29)
    s_cmp_eq_u32 vcc_lo, 1
    s_cbranch_scc1 L_tb39_0
    s_waitcnt vmcnt(26)
    s_branch L_tb39_0
L_th42_0:
    s_waitcnt vmcnt(35)
    s_cmp_eq_u32 vcc_lo, 1
    s_cbranch_scc1 L_tb42_0
    s_waitcnt vmcnt(32)
    s_branch L_tb42_0
L_th45_0:
    s_waitcnt vmcnt(35)
    s_cmp_eq_u32 vcc_lo, 1
    s_cbranch_scc1 L_tb45_0
    s_waitcnt vmcnt(32)
    s_branch L_tb45_0
L_th0_0:
    s_waitcnt vmcnt(35)
    s_cmp_eq_u32 vcc_lo, 1
    s_cbranch_scc1 L_tb0_0
    s_waitcnt vmcnt(26)
    s_branch L_tb0_0
L_th3_0:
    s_waitcnt vmcnt(29)
    s_cmp_eq_u32 vcc_lo, 1
    s_cbranch_scc1 L_tb3_0
    s_waitcnt vmcnt(26)
    s_branch L_tb3_0
L_th6_0:
    s_waitcnt vmcnt(35)
    s_cmp_eq_u32 vcc_lo, 1
    s_cbranch_scc1 L_tb6_0
    s_waitcnt vmcnt(29)
    s_branch L_tb6_0
L_th9_0:
    s_waitcnt vmcnt(32)
    s_cmp_eq_u32 vcc_lo, 1
    s_cbranch_scc1 L_tb9_0
    s_waitcnt vmcnt(29)
    s_branch L_tb9_0
L_th12_0:
    s_waitcnt vmcnt(32)
    s_cmp_eq_u32 vcc_lo, 1
    s_cbranch_scc1 L_tb12_0
    s_waitcnt vmcnt(23)
    s_branch L_tb12_0
L_th15_0:
    s_waitcnt vmcnt(26)
    s_cmp_eq_u32 vcc_lo, 1
    s_cbranch_scc1 L_tb15_0
    s_waitcnt vmcnt(23)
    s_branch L_tb15_0
L_th18_0:
    s_waitcnt vmcnt(32)
    s_cmp_eq_u32 vcc_lo, 1
    s_cbranch_scc1 L_tb18_0
    s_waitcnt vmcnt(29)
    s_branch L_tb18_0
L_th21_0:
    s_waitcnt vmcnt(32)
    s_cmp_eq_u32 vcc_lo, 1
    s_cbranch_scc1 L_tb21_0
    s_waitcnt vmcnt(29)
    s_branch L_tb21_0
L_th24_1:
    s_waitcnt vmcnt(32)
    s_cmp_eq_u32 vcc_lo, 1
    s_cbranch_scc1 L_tb24_1
    s_waitcnt vmcnt(23)
    s_branch L_tb24_1
L_th27_1:
    s_waitcnt vmcnt(26)
    s_cmp_eq_u32 vcc_lo, 1
    s_cbranch_scc1 L_tb27_1
    s_waitcnt vmcnt(23)
    s_branch L_tb27_1
L_th30_1:
    s_waitcnt vmcnt(32)
    s_cmp_eq_u32 vcc_lo, 1
    s_cbranch_scc1 L_tb30_1
    s_waitcnt vmcnt(29)
    s_branch L_tb30_1
L_th33_1:
    s_waitcnt vmcnt(32)
    s_cmp_eq_u32 vcc_lo, 1
    s_cbranch_scc1 L_tb33_1
    s_waitcnt vmcnt(29)
    s_branch L_tb33_1
L_th36_1:
    s_waitcnt vmcnt(34)
    s_cmp_eq_u32 vcc_lo, 1
    s_cbranch_scc1 L_tb36_1
    s_waitcnt vmcnt(25)
    s_branch L_tb36_1
L_th39_1:
    s_waitcnt vmcnt(28)
    s_cmp_eq_u32 vcc_lo, 1
    s_cbranch_scc1 L_tb39_1
    s_waitcnt vmcnt(25)
    s_branch L_tb39_1
L_th42_1:
    s_waitcnt vmcnt(28)
    s_cmp_eq_u32 vcc_lo, 1
    s_cbranch_scc1 L_tb42_1
    s_waitcnt vmcnt(25)
    s_branch L_tb42_1
L_th45_1:
    s_waitcnt vmcnt(28)
    s_cmp_eq_u32 vcc_lo, 1
    s_cbranch_scc1 L_tb45_1
    s_waitcnt vmcnt(25)
    s_branch L_tb45_1
L_th0_1:
    s_waitcnt vmcnt(28)
    s_cmp_eq_u32 vcc_lo, 1
    s_cbranch_scc1 L_tb0_1
    s_waitcnt vmcnt(19)
    s_branch L_tb0_1
L_th3_1:
    s_waitcnt vmcnt(22)
    s_cmp_eq_u32 vcc_lo, 1
    s_cbranch_scc1 L_tb3_1
    s_waitcnt vmcnt(19)
    s_branch L_tb3_1
L_th6_1:
    s_waitcnt vmcnt(22)
    s_cmp_eq_u32 vcc_lo, 1
    s_cbranch_scc1 L_tb6_1
    s_waitcnt vmcnt(17)
    s_branch L_tb6_1
L_th9_1:
    s_waitcnt vmcnt(20)
    s_cmp_eq_u32 vcc_lo, 1
    s_cbranch_scc1 L_tb9_1
    s_waitcnt vmcnt(17)
    s_branch L_tb9_1
L_th12_1:
    s_waitcnt vmcnt(20)
    s_cmp_eq_u32 vcc_lo, 1
    s_cbranch_scc1 L_tb12_1
    s_waitcnt vmcnt(17)
    s_branch L_tb12_1
L_th15_1:
    s_waitcnt vmcnt(20)
    s_cmp_eq_u32 vcc_lo, 1
    s_cbranch_scc1 L_tb15_1
    s_waitcnt vmcnt(17)
    s_branch L_tb15_1
L_th18_1:
    s_waitcnt vmcnt(20)
    s_cmp_eq_u32 vcc_lo, 1
    s_cbranch_scc1 L_tb18_1
    s_waitcnt vmcnt(17)
    s_branch L_tb18_1
L_th21_1:
    s_waitcnt vmcnt(20)
    s_cmp_eq_u32 vcc_lo, 1
    s_cbranch_scc1 L_tb21_1
    s_waitcnt vmcnt(17)
    s_branch L_tb21_1
L_th24_2:
    s_nop 11
    s_waitcnt vmcnt(20)
    s_cmp_eq_u32 vcc_lo, 1
    s_cbranch_scc1 L_tb24_2
    s_waitcnt vmcnt(17)
    s_branch L_tb24_2
L_th27_2:
    s_nop 11
    s_waitcnt vmcnt(20)
    s_cmp_eq_u32 vcc_lo, 1
    s_cbranch_scc1 L_tb27_2
    s_waitcnt vmcnt(17)
    s_branch L_tb27_2
L_th30_2:
    s_nop 11
    s_waitcnt vmcnt(20)
    s_cmp_eq_u32 vcc_lo, 1
    s_cbranch_scc1 L_tb30_2
    s_waitcnt vmcnt(17)
    s_branch L_tb30_2
L_th33_2:
    s_nop 11
    s_waitcnt vmcnt(20)
    s_cmp_eq_u32 vcc_lo, 1
    s_cbranch_scc1 L_tb33_2
    s_waitcnt vmcnt(17)
    s_branch L_tb33_2
L_th36_2:
    s_nop 11
    s_waitcnt vmcnt(22)
    s_cmp_eq_u32 vcc_lo, 1
    s_cbranch_scc1 L_tb36_2
    s_waitcnt vmcnt(19)
    s_branch L_tb36_2
L_th39_2:
    s_nop 11
    s_waitcnt vmcnt(22)
    s_cmp_eq_u32 vcc_lo, 1
    s_cbranch_scc1 L_tb39_2
    s_waitcnt vmcnt(19)
    s_branch L_tb39_2
L_th42_2:
    s_nop 11
    s_waitcnt vmcnt(22)
    s_cmp_eq_u32 vcc_lo, 1
    s_cbranch_scc1 L_tb42_2
    s_waitcnt vmcnt(19)
    s_branch L_tb42_2
L_th45_2:
    s_nop 11
    s_waitcnt vmcnt(22)
    s_cmp_eq_u32 vcc_lo, 1
    s_cbranch_scc1 L_tb45_2
    s_waitcnt vmcnt(19)
    s_branch L_tb45_2
L_getm2:
    ds_read_b32 v227, v243 offset:139
    ds_read_b32 v226, v243 offset:159
    s_waitcnt lgkmcnt(0)
    v_readfirstlane_b32 s93, v227
    v_readfirstlane_b32 s77, v226
    s_cmp_eq_u32 s93, 0
    s_cbranch_scc1 L_getm2
    ds_read_b32 v226, v243 offset:151
    s_waitcnt lgkmcnt(0)
    v_readfirstlane_b32 s88, v226
    s_cmp_eq_u32 s88, -1
    s_cselect_b64 s[88:89], -1, 0
    s_branch L_gotm2
L_th0_2:
    s_nop 11
    s_waitcnt vmcnt(22)
    s_cmp_eq_u32 vcc_lo, 1
    s_cbranch_scc1 L_tb0_2
    s_waitcnt vmcnt(19)
    s_branch L_tb0_2
L_th3_2:
    s_nop 11
    s_waitcnt vmcnt(22)
    s_cmp_eq_u32 vcc_lo, 1
    s_cbranch_scc1 L_tb3_2
    s_waitcnt vmcnt(19)
    s_branch L_tb3_2
L_th6_2:
    s_nop 11
    s_waitcnt vmcnt(22)
    s_cmp_eq_u32 vcc_lo, 1
    s_cbranch_scc1 L_tb6_2
    s_waitcnt vmcnt(17)
    s_branch L_tb6_2
L_th9_2:
    s_nop 11
    s_waitcnt vmcnt(20)
    s_cmp_eq_u32 vcc_lo, 1
    s_cbranch_scc1 L_tb9_2
    s_waitcnt vmcnt(17)
    s_branch L_tb9_2
L_th12_2:
    s_nop 11
    s_waitcnt vmcnt(20)
    s_cmp_eq_u32 vcc_lo, 1
    s_cbranch_scc1 L_tb12_2
    s_waitcnt vmcnt(17)
    s_branch L_tb12_2
L_th15_2:
    s_nop 11
    s_waitcnt vmcnt(20)
    s_cmp_eq_u32 vcc_lo, 1
    s_cbranch_scc1 L_tb15_2
    s_waitcnt vmcnt(17)
    s_branch L_tb15_2
L_th18_2:
    s_nop 11
    s_waitcnt vmcnt(20)
    s_cmp_eq_u32 vcc_lo, 1
    s_cbranch_scc1 L_tb18_2
    s_waitcnt vmcnt(17)
    s_branch L_tb18_2
L_th21_2:
    s_nop 11
    s_waitcnt vmcnt(20)
    s_cmp_eq_u32 vcc_lo, 1
    s_cbranch_scc1 L_tb21_2
    s_waitcnt vmcnt(17)
    s_branch L_tb21_2
L_th24_3:
    s_nop 11
    s_waitcnt vmcnt(20)
    s_cmp_eq_u32 vcc_lo, 1
    s_cbranch_scc1 L_tb24_3
    s_waitcnt vmcnt(17)
    s_branch L_tb24_3
L_th27_3:
    s_nop 11
    s_waitcnt vmcnt(20)
    s_cmp_eq_u32 vcc_lo, 1
    s_cbranch_scc1 L_tb27_3
    s_waitcnt vmcnt(17)
    s_branch L_tb27_3
L_th30_3:
    s_nop 11
    s_waitcnt vmcnt(20)
    s_cmp_eq_u32 vcc_lo, 1
    s_cbranch_scc1 L_tb30_3
    s_waitcnt vmcnt(17)
    s_branch L_tb30_3
L_th33_3:
    s_nop 11
    s_waitcnt vmcnt(20)
    s_cmp_eq_u32 vcc_lo, 1
    s_cbranch_scc1 L_tb33_3
    s_waitcnt vmcnt(17)
    s_branch L_tb33_3
L_th36_3:
    s_nop 11
    s_waitcnt vmcnt(20)
    s_cmp_eq_u32 vcc_lo, 1
    s_cbranch_scc1 L_tb36_3
    s_waitcnt vmcnt(17)
    s_branch L_tb36_3
L_th39_3:
    s_nop 11
    s_waitcnt vmcnt(20)
    s_cmp_eq_u32 vcc_lo, 1
    s_cbranch_scc1 L_tb39_3
    s_waitcnt vmcnt(17)
    s_branch L_tb39_3
L_th42_3:
    s_nop 11
    s_waitcnt vmcnt(20)
    s_cmp_eq_u32 vcc_lo, 1
    s_cbranch_scc1 L_tb42_3
    s_waitcnt vmcnt(17)
    s_branch L_tb42_3
L_th45_3:
    s_nop 11
    s_waitcnt vmcnt(20)
    s_cmp_eq_u32 vcc_lo, 1
    s_cbranch_scc1 L_tb45_3
    s_waitcnt vmcnt(17)
    s_branch L_tb45_3
L_service:
    v_lshlrev_b32 v5, 2, v0
    v_mov_b32 v3, 0
    ds_write_b32 v5, v3 offset:0
    v_lshlrev_b32 v1, 4, v0
    v_lshlrev_b32 v28, 11, v0
    v_mov_b32 v9, 0xf149f2ca
    v_cndmask_b32 v9, v9, v3, s[66:67]
    v_and_b32 v5, 15, v0
    v_lshrrev_b32 v6, 4, v0
    v_lshl_add_u32 v11, v5, 2, v6
    v_lshlrev_b32 v11, 1, v11
    s_getreg_b32 s72, hwreg(HW_REG_XCC_ID)
    s_and_b32 s72, s72, 15
    s_waitcnt lgkmcnt(0)
    s_barrier
    s_branch L_w0
L_walked:
    s_mov_b32 s52, s22
    s_and_b32 s53, s23, 0xffff
    s_mov_b32 s54, 25165824
    s_mov_b32 s55, 0x00020000
    s_mov_b32 s56, s18
    s_and_b32 s57, s19, 0xffff
    s_mov_b32 s58, 12288
    s_mov_b32 s59, 0x00020000
    s_mov_b32 s96, s79
    s_and_b32 s82, s79, 3
    s_lshl_b32 s82, s82, 4
    v_mov_b32 v10, 0
    s_mov_b32 s80, 0x2010200
    s_mov_b32 s81, 0x2030202
    s_cmp_ge_u32 s79, 4
    s_cmov_b32 s80, 0x2050204
    s_cmov_b32 s81, 0x2070206
    s_lshr_b64 s[80:81], s[80:81], s82
    v_writelane_b32 v10, s80, 0
    s_mov_b32 s80, 0x2090208
    s_mov_b32 s81, 0x20b020a
    s_cmp_ge_u32 s79, 4
    s_cmov_b32 s80, 0x20d020c
    s_cmov_b32 s81, 0x20f020e
    s_lshr_b64 s[80:81], s[80:81], s82
    v_writelane_b32 v10, s80, 1
    s_mov_b32 s80, 0x4d00150
    s_mov_b32 s81, 0x8310571
    s_cmp_ge_u32 s79, 4
    s_cmov_b32 s80, 0x57304d2
    s_cmov_b32 s81, 0x4b40174
    s_lshr_b64 s[80:81], s[80:81], s82
    v_writelane_b32 v10, s80, 2
    s_mov_b32 s80, 0x9100d5
    s_mov_b32 s81, 0x15204b6
    s_cmp_ge_u32 s79, 4
    s_cmov_b32 s80, 0x4b700b3
    s_cmov_b32 s81, 0x8d508b7
    s_lshr_b64 s[80:81], s[80:81], s82
    v_writelane_b32 v10, s80, 3
    s_mov_b32 s80, 0x4950000
    s_mov_b32 s81, 0x8b60000
    s_cmp_ge_u32 s79, 4
    s_cmov_b32 s80, 0xc96
    s_cmov_b32 s81, 0xcb70000
    s_lshr_b64 s[80:81], s[80:81], s82
    v_writelane_b32 v10, s80, 4
    s_mov_b32 s80, 0x560000
    s_mov_b32 s81, 0x0
    s_cmp_ge_u32 s79, 4
    s_cmov_b32 s80, 0x37
    s_cmov_b32 s81, 0x0
    s_lshr_b64 s[80:81], s[80:81], s82
    v_writelane_b32 v10, s80, 5
    v_and_b32 v10, 0xffff, v10
L_tag:
    ds_read_b32 v5, v3 offset:140
    ds_read_b64 v[16:17], v3 offset:152
    s_waitcnt lgkmcnt(0)
    v_readfirstlane_b32 s69, v5
    s_cmp_eq_u32 s69, 0
    s_cbranch_scc1 L_tag
    v_readfirstlane_b32 s86, v16
    v_readfirstlane_b32 s87, v17
    s_bfm_b64 s[84:85], s92, 0
    s_bcnt1_i32_b64 s70, s[86:87]
    s_and_b64 s[84:85], s[84:85], s[86:87]
    s_bcnt1_i32_b64 s71, s[84:85]
    s_mov_b32 s73, s71
L_round:
    s_min_u32 s80, s71, 63
    v_readlane_b32 s97, v10, s80
    s_lshl_b32 s80, s71, 2
    v_mov_b32 v4, s80
    s_cmp_eq_u32 s97, 0
    s_cbranch_scc1 L_last
L_poll:
    ds_read_b32 v5, v4 offset:0
    s_waitcnt lgkmcnt(0)
    v_readfirstlane_b32 s80, v5
    s_cmp_eq_u32 s80, 0
    s_cbranch_scc1 L_poll
    s_add_u32 s95, s69, s71
    s_add_u32 s95, s95, 1
    s_and_b32 s80, s71, 1
    s_lshl_b32 s80, s80, 19
    s_add_u32 s80, s80, 2097152
    s_lshl_b32 s77, s2, 11
    s_add_u32 s77, s77, s80
    s_lshl_b32 s75, s96, 16
    s_add_u32 s75, s75, s80
L_all:
    v_mov_b32 v16, s95
    s_mov_b64 exec, s[86:87]
    buffer_load_dword v16, v28, s[52:55], s75 offen offset:1024 sc0 sc1
    s_mov_b64 exec, -1
    s_waitcnt vmcnt(0)
    v_cmp_ne_u32 vcc, s95, v16
    s_cmp_lg_u64 vcc, 0
    s_cbranch_scc1 L_all
    s_mov_b32 s74, 0
    s_mov_b64 s[84:85], s[86:87]
L_merge:
    v_mov_b32 v7, 0xf149f2ca
    v_mov_b32 v8, 0
    v_mov_b32 v12, 0
    v_mov_b32 v13, 0
    v_mov_b32 v14, 0
L_chunk:
    v_mov_b32 v48, 0
    v_mov_b32 v49, 0
    v_mov_b32 v50, 0
    v_mov_b32 v51, v9
    v_mov_b32 v52, 0
    v_mov_b32 v53, 0
    v_mov_b32 v54, 0
    v_mov_b32 v55, v9
    v_mov_b32 v56, 0
    v_mov_b32 v57, 0
    v_mov_b32 v58, 0
    v_mov_b32 v59, v9
    v_mov_b32 v60, 0
    v_mov_b32 v61, 0
    v_mov_b32 v62, 0
    v_mov_b32 v63, v9
    v_mov_b32 v64, 0
    v_mov_b32 v65, 0
    v_mov_b32 v66, 0
    v_mov_b32 v67, v9
    v_mov_b32 v68, 0
    v_mov_b32 v69, 0
    v_mov_b32 v70, 0
    v_mov_b32 v71, v9
    v_mov_b32 v72, 0
    v_mov_b32 v73, 0
    v_mov_b32 v74, 0
    v_mov_b32 v75, v9
    v_mov_b32 v76, 0
    v_mov_b32 v77, 0
    v_mov_b32 v78, 0
    v_mov_b32 v79, v9
    v_mov_b32 v80, 0
    v_mov_b32 v81, 0
    v_mov_b32 v82, 0
    v_mov_b32 v83, v9
    v_mov_b32 v84, 0
    v_mov_b32 v85, 0
    v_mov_b32 v86, 0
    v_mov_b32 v87, v9
    v_mov_b32 v88, 0
    v_mov_b32 v89, 0
    v_mov_b32 v90, 0
    v_mov_b32 v91, v9
    v_mov_b32 v92, 0
    v_mov_b32 v93, 0
    v_mov_b32 v94, 0
    v_mov_b32 v95, v9
    v_mov_b32 v96, 0
    v_mov_b32 v97, 0
    v_mov_b32 v98, 0
    v_mov_b32 v99, v9
    v_mov_b32 v100, 0
    v_mov_b32 v101, 0
    v_mov_b32 v102, 0
    v_mov_b32 v103, v9
    v_mov_b32 v104, 0
    v_mov_b32 v105, 0
    v_mov_b32 v106, 0
    v_mov_b32 v107, v9
    v_mov_b32 v108, 0
    v_mov_b32 v109, 0
    v_mov_b32 v110, 0
    v_mov_b32 v111, v9
    v_mov_b32 v112, 0
    v_mov_b32 v113, 0
    v_mov_b32 v114, 0
    v_mov_b32 v115, v9
    v_mov_b32 v116, 0
    v_mov_b32 v117, 0
    v_mov_b32 v118, 0
    v_mov_b32 v119, v9
    v_mov_b32 v120, 0
    v_mov_b32 v121, 0
    v_mov_b32 v122, 0
    v_mov_b32 v123, v9
    v_mov_b32 v124, 0
    v_mov_b32 v125, 0
    v_mov_b32 v126, 0
    v_mov_b32 v127, v9
    v_mov_b32 v128, 0
    v_mov_b32 v129, 0
    v_mov_b32 v130, 0
    v_mov_b32 v131, v9
    v_mov_b32 v132, 0
    v_mov_b32 v133, 0
    v_mov_b32 v134, 0
    v_mov_b32 v135, v9
    v_mov_b32 v136, 0
    v_mov_b32 v137, 0
    v_mov_b32 v138, 0
    v_mov_b32 v139, v9
    v_mov_b32 v140, 0
    v_mov_b32 v141, 0
    v_mov_b32 v142, 0
    v_mov_b32 v143, v9
    v_mov_b32 v144, 0
    v_mov_b32 v145, 0
    v_mov_b32 v146, 0
    v_mov_b32 v147, v9
    v_mov_b32 v148, 0
    v_mov_b32 v149, 0
    v_mov_b32 v150, 0
    v_mov_b32 v151, v9
    v_mov_b32 v152, 0
    v_mov_b32 v153, 0
    v_mov_b32 v154, 0
    v_mov_b32 v155, v9
    v_mov_b32 v156, 0
    v_mov_b32 v157, 0
    v_mov_b32 v158, 0
    v_mov_b32 v159, v9
    v_mov_b32 v160, 0
    v_mov_b32 v161, 0
    v_mov_b32 v162, 0
    v_mov_b32 v163, v9
    v_mov_b32 v164, 0
    v_mov_b32 v165, 0
    v_mov_b32 v166, 0
    v_mov_b32 v167, v9
    v_mov_b32 v168, 0
    v_mov_b32 v169, 0
    v_mov_b32 v170, 0
    v_mov_b32 v171, v9
    v_mov_b32 v172, 0
    v_mov_b32 v173, 0
    v_mov_b32 v174, 0
    v_mov_b32 v175, v9
    s_ff1_i32_b64 s80, s[84:85]
    s_bitset0_b64 s[84:85], s80
    s_lshl_b32 s81, s80, 11
    s_add_u32 s81, s81, s75
    s_cmp_ge_i32 s80, 0
    s_cselect_b64 exec, -1, 0
    buffer_load_dwordx4 v[48:51], v1, s[52:55], s81 offen sc0 sc1
    s_ff1_i32_b64 s80, s[84:85]
    s_bitset0_b64 s[84:85], s80
    s_lshl_b32 s81, s80, 11
    s_add_u32 s81, s81, s75
    s_cmp_ge_i32 s80, 0
    s_cselect_b64 exec, -1, 0
    buffer_load_dwordx4 v[52:55], v1, s[52:55], s81 offen sc0 sc1
    s_ff1_i32_b64 s80, s[84:85]
    s_bitset0_b64 s[84:85], s80
    s_lshl_b32 s81, s80, 11
    s_add_u32 s81, s81, s75
    s_cmp_ge_i32 s80, 0
    s_cselect_b64 exec, -1, 0
    buffer_load_dwordx4 v[56:59], v1, s[52:55], s81 offen sc0 sc1
    s_ff1_i32_b64 s80, s[84:85]
    s_bitset0_b64 s[84:85], s80
    s_lshl_b32 s81, s80, 11
    s_add_u32 s81, s81, s75
    s_cmp_ge_i32 s80, 0
    s_cselect_b64 exec, -1, 0
    buffer_load_dwordx4 v[60:63], v1, s[52:55], s81 offen sc0 sc1
    s_ff1_i32_b64 s80, s[84:85]
    s_bitset0_b64 s[84:85], s80
    s_lshl_b32 s81, s80, 11
    s_add_u32 s81, s81, s75
    s_cmp_ge_i32 s80, 0
    s_cselect_b64 exec, -1, 0
    buffer_load_dwordx4 v[64:67], v1, s[52:55], s81 offen sc0 sc1
    s_ff1_i32_b64 s80, s[84:85]
    s_bitset0_b64 s[84:85], s80
    s_lshl_b32 s81, s80, 11
    s_add_u32 s81, s81, s75
    s_cmp_ge_i32 s80, 0
    s_cselect_b64 exec, -1, 0
    buffer_load_dwordx4 v[68:71], v1, s[52:55], s81 offen sc0 sc1
    s_ff1_i32_b64 s80, s[84:85]
    s_bitset0_b64 s[84:85], s80
    s_lshl_b32 s81, s80, 11
    s_add_u32 s81, s81, s75
    s_cmp_ge_i32 s80, 0
    s_cselect_b64 exec, -1, 0
    buffer_load_dwordx4 v[72:75], v1, s[52:55], s81 offen sc0 sc1
    s_ff1_i32_b64 s80, s[84:85]
    s_bitset0_b64 s[84:85], s80
    s_lshl_b32 s81, s80, 11
    s_add_u32 s81, s81, s75
    s_cmp_ge_i32 s80, 0
    s_cselect_b64 exec, -1, 0
    buffer_load_dwordx4 v[76:79], v1, s[52:55], s81 offen sc0 sc1
    s_ff1_i32_b64 s80, s[84:85]
    s_bitset0_b64 s[84:85], s80
    s_lshl_b32 s81, s80, 11
    s_add_u32 s81, s81, s75
    s_cmp_ge_i32 s80, 0
    s_cbranch_scc0 L_got
    s_cselect_b64 exec, -1, 0
    buffer_load_dwordx4 v[80:83], v1, s[52:55], s81 offen sc0 sc1
    s_ff1_i32_b64 s80, s[84:85]
    s_bitset0_b64 s[84:85], s80
    s_lshl_b32 s81, s80, 11
    s_add_u32 s81, s81, s75
    s_cmp_ge_i32 s80, 0
    s_cselect_b64 exec, -1, 0
    buffer_load_dwordx4 v[84:87], v1, s[52:55], s81 offen sc0 sc1
    s_ff1_i32_b64 s80, s[84:85]
    s_bitset0_b64 s[84:85], s80
    s_lshl_b32 s81, s80, 11
    s_add_u32 s81, s81, s75
    s_cmp_ge_i32 s80, 0
    s_cselect_b64 exec, -1, 0
    buffer_load_dwordx4 v[88:91], v1, s[52:55], s81 offen sc0 sc1
    s_ff1_i32_b64 s80, s[84:85]
    s_bitset0_b64 s[84:85], s80
    s_lshl_b32 s81, s80, 11
    s_add_u32 s81, s81, s75
    s_cmp_ge_i32 s80, 0
    s_cselect_b64 exec, -1, 0
    buffer_load_dwordx4 v[92:95], v1, s[52:55], s81 offen sc0 sc1
    s_ff1_i32_b64 s80, s[84:85]
    s_bitset0_b64 s[84:85], s80
    s_lshl_b32 s81, s80, 11
    s_add_u32 s81, s81, s75
    s_cmp_ge_i32 s80, 0
    s_cselect_b64 exec, -1, 0
    buffer_load_dwordx4 v[96:99], v1, s[52:55], s81 offen sc0 sc1
    s_ff1_i32_b64 s80, s[84:85]
    s_bitset0_b64 s[84:85], s80
    s_lshl_b32 s81, s80, 11
    s_add_u32 s81, s81, s75
    s_cmp_ge_i32 s80, 0
    s_cselect_b64 exec, -1, 0
    buffer_load_dwordx4 v[100:103], v1, s[52:55], s81 offen sc0 sc1
    s_ff1_i32_b64 s80, s[84:85]
    s_bitset0_b64 s[84:85], s80
    s_lshl_b32 s81, s80, 11
    s_add_u32 s81, s81, s75
    s_cmp_ge_i32 s80, 0
    s_cselect_b64 exec, -1, 0
    buffer_load_dwordx4 v[104:107], v1, s[52:55], s81 offen sc0 sc1
    s_ff1_i32_b64 s80, s[84:85]
    s_bitset0_b64 s[84:85], s80
    s_lshl_b32 s81, s80, 11
    s_add_u32 s81, s81, s75
    s_cmp_ge_i32 s80, 0
    s_cselect_b64 exec, -1, 0
    buffer_load_dwordx4 v[108:111], v1, s[52:55], s81 offen sc0 sc1
    s_ff1_i32_b64 s80, s[84:85]
    s_bitset0_b64 s[84:85], s80
    s_lshl_b32 s81, s80, 11
    s_add_u32 s81, s81, s75
    s_cmp_ge_i32 s80, 0
    s_cbranch_scc0 L_got
    s_cselect_b64 exec, -1, 0
    buffer_load_dwordx4 v[112:115], v1, s[52:55], s81 offen sc0 sc1
    s_ff1_i32_b64 s80, s[84:85]
    s_bitset0_b64 s[84:85], s80
    s_lshl_b32 s81, s80, 11
    s_add_u32 s81, s81, s75
    s_cmp_ge_i32 s80, 0
    s_cselect_b64 exec, -1, 0
    buffer_load_dwordx4 v[116:119], v1, s[52:55], s81 offen sc0 sc1
    s_ff1_i32_b64 s80, s[84:85]
    s_bitset0_b64 s[84:85], s80
    s_lshl_b32 s81, s80, 11
    s_add_u32 s81, s81, s75
    s_cmp_ge_i32 s80, 0
    s_cselect_b64 exec, -1, 0
    buffer_load_dwordx4 v[120:123], v1, s[52:55], s81 offen sc0 sc1
    s_ff1_i32_b64 s80, s[84:85]
    s_bitset0_b64 s[84:85], s80
    s_lshl_b32 s81, s80, 11
    s_add_u32 s81, s81, s75
    s_cmp_ge_i32 s80, 0
    s_cselect_b64 exec, -1, 0
    buffer_load_dwordx4 v[124:127], v1, s[52:55], s81 offen sc0 sc1
    s_ff1_i32_b64 s80, s[84:85]
    s_bitset0_b64 s[84:85], s80
    s_lshl_b32 s81, s80, 11
    s_add_u32 s81, s81, s75
    s_cmp_ge_i32 s80, 0
    s_cselect_b64 exec, -1, 0
    buffer_load_dwordx4 v[128:131], v1, s[52:55], s81 offen sc0 sc1
    s_ff1_i32_b64 s80, s[84:85]
    s_bitset0_b64 s[84:85], s80
    s_lshl_b32 s81, s80, 11
    s_add_u32 s81, s81, s75
    s_cmp_ge_i32 s80, 0
    s_cselect_b64 exec, -1, 0
    buffer_load_dwordx4 v[132:135], v1, s[52:55], s81 offen sc0 sc1
    s_ff1_i32_b64 s80, s[84:85]
    s_bitset0_b64 s[84:85], s80
    s_lshl_b32 s81, s80, 11
    s_add_u32 s81, s81, s75
    s_cmp_ge_i32 s80, 0
    s_cselect_b64 exec, -1, 0
    buffer_load_dwordx4 v[136:139], v1, s[52:55], s81 offen sc0 sc1
    s_ff1_i32_b64 s80, s[84:85]
    s_bitset0_b64 s[84:85], s80
    s_lshl_b32 s81, s80, 11
    s_add_u32 s81, s81, s75
    s_cmp_ge_i32 s80, 0
    s_cselect_b64 exec, -1, 0
    buffer_load_dwordx4 v[140:143], v1, s[52:55], s81 offen sc0 sc1
    s_ff1_i32_b64 s80, s[84:85]
    s_bitset0_b64 s[84:85], s80
    s_lshl_b32 s81, s80, 11
    s_add_u32 s81, s81, s75
    s_cmp_ge_i32 s80, 0
    s_cbranch_scc0 L_got
    s_cselect_b64 exec, -1, 0
    buffer_load_dwordx4 v[144:147], v1, s[52:55], s81 offen sc0 sc1
    s_ff1_i32_b64 s80, s[84:85]
    s_bitset0_b64 s[84:85], s80
    s_lshl_b32 s81, s80, 11
    s_add_u32 s81, s81, s75
    s_cmp_ge_i32 s80, 0
    s_cselect_b64 exec, -1, 0
    buffer_load_dwordx4 v[148:151], v1, s[52:55], s81 offen sc0 sc1
    s_ff1_i32_b64 s80, s[84:85]
    s_bitset0_b64 s[84:85], s80
    s_lshl_b32 s81, s80, 11
    s_add_u32 s81, s81, s75
    s_cmp_ge_i32 s80, 0
    s_cselect_b64 exec, -1, 0
    buffer_load_dwordx4 v[152:155], v1, s[52:55], s81 offen sc0 sc1
    s_ff1_i32_b64 s80, s[84:85]
    s_bitset0_b64 s[84:85], s80
    s_lshl_b32 s81, s80, 11
    s_add_u32 s81, s81, s75
    s_cmp_ge_i32 s80, 0
    s_cselect_b64 exec, -1, 0
    buffer_load_dwordx4 v[156:159], v1, s[52:55], s81 offen sc0 sc1
    s_ff1_i32_b64 s80, s[84:85]
    s_bitset0_b64 s[84:85], s80
    s_lshl_b32 s81, s80, 11
    s_add_u32 s81, s81, s75
    s_cmp_ge_i32 s80, 0
    s_cselect_b64 exec, -1, 0
    buffer_load_dwordx4 v[160:163], v1, s[52:55], s81 offen sc0 sc1
    s_ff1_i32_b64 s80, s[84:85]
    s_bitset0_b64 s[84:85], s80
    s_lshl_b32 s81, s80, 11
    s_add_u32 s81, s81, s75
    s_cmp_ge_i32 s80, 0
    s_cselect_b64 exec, -1, 0
    buffer_load_dwordx4 v[164:167], v1, s[52:55], s81 offen sc0 sc1
    s_ff1_i32_b64 s80, s[84:85]
    s_bitset0_b64 s[84:85], s80
    s_branch L_x3
L_w3:
    s_branch L_w4
L_x3:
    s_lshl_b32 s81, s80, 11
    s_add_u32 s81, s81, s75
    s_cmp_ge_i32 s80, 0
    s_cselect_b64 exec, -1, 0
    buffer_load_dwordx4 v[168:171], v1, s[52:55], s81 offen sc0 sc1
    s_ff1_i32_b64 s80, s[84:85]
    s_bitset0_b64 s[84:85], s80
    s_lshl_b32 s81, s80, 11
    s_add_u32 s81, s81, s75
    s_cmp_ge_i32 s80, 0
    s_cselect_b64 exec, -1, 0
    buffer_load_dwordx4 v[172:175], v1, s[52:55], s81 offen sc0 sc1
L_got:
    s_mov_b64 exec, -1
    s_waitcnt vmcnt(0)
    v_max_f32 v5, v51, v55
    v_max3_f32 v5, v5, v59, v63
    v_max3_f32 v5, v5, v67, v71
    v_max3_f32 v5, v5, v75, v79
    v_max3_f32 v5, v5, v83, v87
    v_max3_f32 v5, v5, v91, v95
    v_max3_f32 v5, v5, v99, v103
    v_max3_f32 v5, v5, v107, v111
    v_max3_f32 v5, v5, v115, v119
    v_max3_f32 v5, v5, v123, v127
    v_max3_f32 v5, v5, v131, v135
    v_max3_f32 v5, v5, v139, v143
    v_max3_f32 v5, v5, v147, v151
    v_max3_f32 v5, v5, v155, v159
    v_max3_f32 v5, v5, v163, v167
    v_max3_f32 v5, v5, v171, v175
    s_nop 1
    v_max_f32_dpp v6, v5, v7 quad_perm:[0,0,2,2] row_mask:0xf bank_mask:0xf
    v_sub_f32 v5, v7, v6
    v_exp_f32 v5, v5
    v_mov_b32 v7, v6
    v_mul_f32 v8, v8, v5
    v_mul_f32 v12, v12, v5
    v_mul_f32 v13, v13, v5
    v_mul_f32 v14, v14, v5
    v_sub_f32_dpp v20, v51, v6 quad_perm:[0,0,2,2] row_mask:0xf bank_mask:0xf
    v_sub_f32_dpp v21, v55, v6 quad_perm:[0,0,2,2] row_mask:0xf bank_mask:0xf
    v_sub_f32_dpp v22, v59, v6 quad_perm:[0,0,2,2] row_mask:0xf bank_mask:0xf
    v_sub_f32_dpp v23, v63, v6 quad_perm:[0,0,2,2] row_mask:0xf bank_mask:0xf
    v_sub_f32_dpp v24, v67, v6 quad_perm:[0,0,2,2] row_mask:0xf bank_mask:0xf
    v_sub_f32_dpp v25, v71, v6 quad_perm:[0,0,2,2] row_mask:0xf bank_mask:0xf
    v_sub_f32_dpp v26, v75, v6 quad_perm:[0,0,2,2] row_mask:0xf bank_mask:0xf
    v_sub_f32_dpp v27, v79, v6 quad_perm:[0,0,2,2] row_mask:0xf bank_mask:0xf
    v_exp_f32 v20, v20
    v_exp_f32 v21, v21
    v_exp_f32 v22, v22
    v_exp_f32 v23, v23
    v_exp_f32 v24, v24
    v_exp_f32 v25, v25
    v_exp_f32 v26, v26
    v_exp_f32 v27, v27
    s_nop 0
    v_fmac_f32 v12, v20, v48
    v_fmac_f32 v13, v20, v49
    v_fmac_f32 v14, v20, v50
    v_fmac_f32 v8, v20, v51
    v_fmac_f32 v12, v21, v52
    v_fmac_f32 v13, v21, v53
    v_fmac_f32 v14, v21, v54
    v_fmac_f32 v8, v21, v55
    v_fmac_f32 v12, v22, v56
    v_fmac_f32 v13, v22, v57
    v_fmac_f32 v14, v22, v58
    v_fmac_f32 v8, v22, v59
    v_fmac_f32 v12, v23, v60
    v_fmac_f32 v13, v23, v61
    v_fmac_f32 v14, v23, v62
    v_fmac_f32 v8, v23, v63
    v_fmac_f32 v12, v24, v64
    v_fmac_f32 v13, v24, v65
    v_fmac_f32 v14, v24, v66
    v_fmac_f32 v8, v24, v67
    v_fmac_f32 v12, v25, v68
    v_fmac_f32 v13, v25, v69
    v_fmac_f32 v14, v25, v70
    v_fmac_f32 v8, v25, v71
    v_fmac_f32 v12, v26, v72
    v_fmac_f32 v13, v26, v73
    v_fmac_f32 v14, v26, v74
    v_fmac_f32 v8, v26, v75
    v_fmac_f32 v12, v27, v76
    v_fmac_f32 v13, v27, v77
    v_fmac_f32 v14, v27, v78
    v_fmac_f32 v8, v27, v79
    v_sub_f32_dpp v20, v83, v6 quad_perm:[0,0,2,2] row_mask:0xf bank_mask:0xf
    v_sub_f32_dpp v21, v87, v6 quad_perm:[0,0,2,2] row_mask:0xf bank_mask:0xf
    v_sub_f32_dpp v22, v91, v6 quad_perm:[0,0,2,2] row_mask:0xf bank_mask:0xf
    v_sub_f32_dpp v23, v95, v6 quad_perm:[0,0,2,2] row_mask:0xf bank_mask:0xf
    v_sub_f32_dpp v24, v99, v6 quad_perm:[0,0,2,2] row_mask:0xf bank_mask:0xf
    v_sub_f32_dpp v25, v103, v6 quad_perm:[0,0,2,2] row_mask:0xf bank_mask:0xf
    v_sub_f32_dpp v26, v107, v6 quad_perm:[0,0,2,2] row_mask:0xf bank_mask:0xf
    v_sub_f32_dpp v27, v111, v6 quad_perm:[0,0,2,2] row_mask:0xf bank_mask:0xf
    v_exp_f32 v20, v20
    v_exp_f32 v21, v21
    v_exp_f32 v22, v22
    v_exp_f32 v23, v23
    v_exp_f32 v24, v24
    v_exp_f32 v25, v25
    v_exp_f32 v26, v26
    v_exp_f32 v27, v27
    s_nop 0
    v_fmac_f32 v12, v20, v80
    v_fmac_f32 v13, v20, v81
    v_fmac_f32 v14, v20, v82
    v_fmac_f32 v8, v20, v83
    v_fmac_f32 v12, v21, v84
    v_fmac_f32 v13, v21, v85
    v_fmac_f32 v14, v21, v86
    v_fmac_f32 v8, v21, v87
    v_fmac_f32 v12, v22, v88
    v_fmac_f32 v13, v22, v89
    v_fmac_f32 v14, v22, v90
    v_fmac_f32 v8, v22, v91
    v_fmac_f32 v12, v23, v92
    v_fmac_f32 v13, v23, v93
    v_fmac_f32 v14, v23, v94
    v_fmac_f32 v8, v23, v95
    v_fmac_f32 v12, v24, v96
    v_fmac_f32 v13, v24, v97
    v_fmac_f32 v14, v24, v98
    v_fmac_f32 v8, v24, v99
    v_fmac_f32 v12, v25, v100
    v_fmac_f32 v13, v25, v101
    v_fmac_f32 v14, v25, v102
    v_fmac_f32 v8, v25, v103
    v_fmac_f32 v12, v26, v104
    v_fmac_f32 v13, v26, v105
    v_fmac_f32 v14, v26, v106
    v_fmac_f32 v8, v26, v107
    v_fmac_f32 v12, v27, v108
    v_fmac_f32 v13, v27, v109
    v_fmac_f32 v14, v27, v110
    v_fmac_f32 v8, v27, v111
    v_sub_f32_dpp v20, v115, v6 quad_perm:[0,0,2,2] row_mask:0xf bank_mask:0xf
    v_sub_f32_dpp v21, v119, v6 quad_perm:[0,0,2,2] row_mask:0xf bank_mask:0xf
    v_sub_f32_dpp v22, v123, v6 quad_perm:[0,0,2,2] row_mask:0xf bank_mask:0xf
    v_sub_f32_dpp v23, v127, v6 quad_perm:[0,0,2,2] row_mask:0xf bank_mask:0xf
    v_sub_f32_dpp v24, v131, v6 quad_perm:[0,0,2,2] row_mask:0xf bank_mask:0xf
    v_sub_f32_dpp v25, v135, v6 quad_perm:[0,0,2,2] row_mask:0xf bank_mask:0xf
    v_sub_f32_dpp v26, v139, v6 quad_perm:[0,0,2,2] row_mask:0xf bank_mask:0xf
    v_sub_f32_dpp v27, v143, v6 quad_perm:[0,0,2,2] row_mask:0xf bank_mask:0xf
    v_exp_f32 v20, v20
    v_exp_f32 v21, v21
    v_exp_f32 v22, v22
    v_exp_f32 v23, v23
    v_exp_f32 v24, v24
    v_exp_f32 v25, v25
    v_exp_f32 v26, v26
    v_exp_f32 v27, v27
    s_nop 0
    v_fmac_f32 v12, v20, v112
    v_fmac_f32 v13, v20, v113
    v_fmac_f32 v14, v20, v114
    v_fmac_f32 v8, v20, v115
    v_fmac_f32 v12, v21, v116
    v_fmac_f32 v13, v21, v117
    v_fmac_f32 v14, v21, v118
    v_fmac_f32 v8, v21, v119
    v_fmac_f32 v12, v22, v120
    v_fmac_f32 v13, v22, v121
    v_fmac_f32 v14, v22, v122
    v_fmac_f32 v8, v22, v123
    v_fmac_f32 v12, v23, v124
    v_fmac_f32 v13, v23, v125
    v_fmac_f32 v14, v23, v126
    v_fmac_f32 v8, v23, v127
    v_fmac_f32 v12, v24, v128
    v_fmac_f32 v13, v24, v129
    v_fmac_f32 v14, v24, v130
    v_fmac_f32 v8, v24, v131
    v_fmac_f32 v12, v25, v132
    v_fmac_f32 v13, v25, v133
    v_fmac_f32 v14, v25, v134
    v_fmac_f32 v8, v25, v135
    v_fmac_f32 v12, v26, v136
    v_fmac_f32 v13, v26, v137
    v_fmac_f32 v14, v26, v138
    v_fmac_f32 v8, v26, v139
    v_fmac_f32 v12, v27, v140
    v_fmac_f32 v13, v27, v141
    v_fmac_f32 v14, v27, v142
    v_fmac_f32 v8, v27, v143
    v_sub_f32_dpp v20, v147, v6 quad_perm:[0,0,2,2] row_mask:0xf bank_mask:0xf
    v_sub_f32_dpp v21, v151, v6 quad_perm:[0,0,2,2] row_mask:0xf bank_mask:0xf
    v_sub_f32_dpp v22, v155, v6 quad_perm:[0,0,2,2] row_mask:0xf bank_mask:0xf
    v_sub_f32_dpp v23, v159, v6 quad_perm:[0,0,2,2] row_mask:0xf bank_mask:0xf
    v_sub_f32_dpp v24, v163, v6 quad_perm:[0,0,2,2] row_mask:0xf bank_mask:0xf
    v_sub_f32_dpp v25, v167, v6 quad_perm:[0,0,2,2] row_mask:0xf bank_mask:0xf
    v_sub_f32_dpp v26, v171, v6 quad_perm:[0,0,2,2] row_mask:0xf bank_mask:0xf
    v_sub_f32_dpp v27, v175, v6 quad_perm:[0,0,2,2] row_mask:0xf bank_mask:0xf
    v_exp_f32 v20, v20
    v_exp_f32 v21, v21
    v_exp_f32 v22, v22
    v_exp_f32 v23, v23
    v_exp_f32 v24, v24
    v_exp_f32 v25, v25
    v_exp_f32 v26, v26
    v_exp_f32 v27, v27
    s_nop 0
    v_fmac_f32 v12, v20, v144
    v_fmac_f32 v13, v20, v145
    v_fmac_f32 v14, v20, v146
    v_fmac_f32 v8, v20, v147
    v_fmac_f32 v12, v21, v148
    v_fmac_f32 v13, v21, v149
    v_fmac_f32 v14, v21, v150
    v_fmac_f32 v8, v21, v151
    v_fmac_f32 v12, v22, v152
    v_fmac_f32 v13, v22, v153
    v_fmac_f32 v14, v22, v154
    v_fmac_f32 v8, v22, v155
    v_fmac_f32 v12, v23, v156
    v_fmac_f32 v13, v23, v157
    v_fmac_f32 v14, v23, v158
    v_fmac_f32 v8, v23, v159
    v_fmac_f32 v12, v24, v160
    v_fmac_f32 v13, v24, v161
    v_fmac_f32 v14, v24, v162
    v_fmac_f32 v8, v24, v163
    v_fmac_f32 v12, v25, v164
    v_fmac_f32 v13, v25, v165
    v_fmac_f32 v14, v25, v166
    v_fmac_f32 v8, v25, v167
    v_fmac_f32 v12, v26, v168
    v_fmac_f32 v13, v26, v169
    v_fmac_f32 v14, v26, v170
    v_fmac_f32 v8, v26, v171
    v_fmac_f32 v12, v27, v172
    v_fmac_f32 v13, v27, v173
    v_fmac_f32 v14, v27, v174
    v_fmac_f32 v8, v27, v175
    s_cmp_lg_u64 s[84:85], 0
    s_cbranch_scc1 L_chunk
    s_cmp_lg_u32 s74, 0
    s_cbranch_scc1 L_fin
    v_cndmask_b32 v15, v7, v8, s[66:67]
    v_mov_b32 v5, s95
    s_and_b32 s79, s97, 31
    s_lshr_b32 s80, s97, 10
    s_lshl_b32 s80, s80, 3
    s_and_b32 s83, s72, 7
    s_add_u32 s80, s80, s83
    s_bfm_b64 s[88:89], 1, s80
    s_bfe_u32 s83, s97, 0x50005
    s_mul_i32 s83, s83, s70
    s_cmp_lg_u32 s83, 512
    s_cbranch_scc1 L_rec
    s_mov_b64 exec, 1
    buffer_store_dword v5, v3, s[52:55], s77 offen offset:1028
    s_mov_b64 exec, -1
    s_branch L_fin
L_rec:
    s_lshl_b32 s83, s83, 16
    s_or_b32 s89, s89, s83
    v_mov_b32 v16, s88
    v_mov_b32 v17, s89
    s_lshl_b32 s75, s79, 17
    s_add_u32 s75, s75, 4194304
    s_lshl_b32 s80, s80, 11
    s_add_u32 s80, s80, s75
    buffer_store_dwordx4 v[12:15], v1, s[52:55], s80 offen sc0 sc1
    s_mov_b64 exec, 1
    buffer_store_dword v5, v3, s[52:55], s77 offen offset:1028
    s_lshl_b32 s80, s79, 8
    s_add_u32 s80, s80, 23076864
    s_waitcnt vmcnt(0)
    buffer_atomic_add_x2 v[16:17], v3, s[52:55], s80 offen sc0 sc1
    s_waitcnt vmcnt(0)
    s_mov_b64 exec, -1
    v_readfirstlane_b32 s84, v16
    v_readfirstlane_b32 s85, v17
    s_add_u32 s84, s84, s88
    s_add_u32 s85, s85, s89
    s_lshr_b32 s80, s85, 16
    s_cmp_lg_u32 s80, 512
    s_cbranch_scc1 L_next
    s_mov_b32 s74, 1
    s_and_b32 s85, s85, 0xffff
    s_branch L_merge
L_fin:
    s_nop 1
    v_mov_b32_dpp v5, v8 quad_perm:[1,1,3,3] row_mask:0xf bank_mask:0xf
    v_rcp_f32 v5, v5
    s_mul_i32 s80, s79, 384
    v_mul_f32 v12, v12, v5
    v_mul_f32 v13, v13, v5
    v_mul_f32 v14, v14, v5
    v_cvt_pk_bf16_f32 v12, v12, v12
    v_cvt_pk_bf16_f32 v13, v13, v13
    v_cvt_pk_bf16_f32 v14, v14, v14
    buffer_store_short v12, v11, s[56:59], s80 offen offset:0
    buffer_store_short v13, v11, s[56:59], s80 offen offset:128
    buffer_store_short v14, v11, s[56:59], s80 offen offset:256
L_next:
    s_add_u32 s71, s71, s70
    s_branch L_round
L_last:
    s_lshl_b32 s75, s96, 9
    s_add_u32 s75, s75, 1572864
    v_lshrrev_b32 v6, 1, v0
    v_lshlrev_b32 v28, 4, v6
L_inf:
    buffer_load_dwordx4 v[48:51], v28, s[52:55], s75 offen sc0 sc1
    s_waitcnt vmcnt(0)
    v_cmp_ne_u32 vcc, s69, v49
    s_cmp_lg_u64 vcc, 0
    s_cbranch_scc1 L_inf
    v_mov_b32 v7, v50
    s_nop 1
    v_max_f32_dpp v7, v7, v7 row_ror:8 row_mask:0xf bank_mask:0xf
    s_nop 1
    v_max_f32_dpp v7, v7, v7 row_ror:4 row_mask:0xf bank_mask:0xf
    s_nop 1
    v_max_f32_dpp v7, v7, v7 row_ror:2 row_mask:0xf bank_mask:0xf
    s_nop 1
    v_max_f32_dpp v7, v7, v7 row_ror:1 row_mask:0xf bank_mask:0xf
    v_mov_b32 v5, v7
    s_nop 1
    v_permlane32_swap_b32 v7, v5
    s_nop 1
    v_max_f32 v7, v7, v5
    v_mov_b32 v5, v7
    s_nop 1
    v_permlane16_swap_b32 v7, v5
    s_nop 1
    v_max_f32 v7, v7, v5
    v_sub_f32 v20, v50, v7
    v_exp_f32 v20, v20
    s_nop 0
    v_mul_f32 v8, v20, v51
    s_nop 1
    v_add_f32_dpp v8, v8, v8 row_ror:8 row_mask:0xf bank_mask:0xf
    s_nop 1
    v_add_f32_dpp v8, v8, v8 row_ror:4 row_mask:0xf bank_mask:0xf
    s_nop 1
    v_add_f32_dpp v8, v8, v8 row_ror:2 row_mask:0xf bank_mask:0xf
    s_nop 1
    v_add_f32_dpp v8, v8, v8 row_ror:1 row_mask:0xf bank_mask:0xf
    v_mov_b32 v5, v8
    s_nop 1
    v_permlane32_swap_b32 v8, v5
    s_nop 1
    v_add_f32 v8, v8, v5
    v_mov_b32 v5, v8
    s_nop 1
    v_permlane16_swap_b32 v8, v5
    s_nop 1
    v_add_f32 v8, v8, v5
    v_rcp_f32 v8, v8
    v_and_b32 v5, 1, v0
    v_mul_f32 v8, 2.0, v8
    v_mul_f32 v20, v20, v8
    v_lshlrev_b32 v28, 11, v6
    v_lshl_add_u32 v28, v5, 4, v28
    s_lshl_b32 s75, s96, 16
    s_lshl_b32 s80, s92, 5
    s_add_u32 s75, s75, s80
    v_mov_b32 v51, 0
    v_mov_b32 v55, 0
    v_mov_b32 v59, 0
    v_mov_b32 v63, 0
    v_mov_b32 v12, 0
    v_mov_b32 v13, 0
    v_mov_b32 v14, 0
    v_bfe_u32 v6, v0, 4, 1
    v_lshrrev_b32 v11, 5, v0
    v_lshl_add_u32 v11, v6, 1, v11
    v_lshlrev_b32 v11, 7, v11
    v_lshl_add_u32 v11, v5, 3, v11
    s_and_b32 s80, s92, 7
    s_lshl_b32 s80, s80, 4
    s_lshr_b32 s81, s92, 3
    s_lshl_b32 s81, s81, 1
    s_add_u32 s80, s80, s81
    s_add_u32 s79, s96, 24
    s_mul_i32 s78, s79, 384
    s_add_u32 s78, s78, s80
    s_mov_b64 s[24:25], -1
    s_mov_b32 s32, 0x00030003
    s_mov_b32 s33, 0x00000003
L_dt:
    ds_read_b32 v5, v3 offset:144
    s_waitcnt lgkmcnt(0)
    v_readfirstlane_b32 s80, v5
    s_cmp_eq_u32 s80, 0
    s_cbranch_scc1 L_dt
L_pa:
    buffer_load_dwordx4 v[48:51], v28, s[52:55], s75 offen offset:0 sc0 sc1
    s_waitcnt vmcnt(0)
    v_cmpx_eq_u32 vcc, s69, v51
    v_fmac_f32 v12, v20, v48
    v_fmac_f32 v13, v20, v49
    v_fmac_f32 v14, v20, v50
    s_andn2_b64 s[24:25], s[24:25], vcc
    s_mov_b64 exec, s[24:25]
    s_bcnt1_i32_b64 s80, s[24:25]
    s_cmp_gt_u32 s80, 0
    s_cbranch_scc1 L_pa
L_pd:
    s_mov_b64 exec, -1
    v_mov_b32 v15, v14
    v_permlane32_swap_b32 v12, v13
    s_nop 0
    v_permlane32_swap_b32 v14, v15
    v_add_f32 v12, v12, v13
    v_add_f32 v14, v14, v15
    s_nop 1
    v_permlane16_swap_b32 v12, v14
    v_add_f32 v12, v12, v14
    s_nop 1
    v_add_f32_dpp v12, v12, v12 row_ror:8 row_mask:0xf bank_mask:0xf
    s_nop 1
    v_add_f32_dpp v12, v12, v12 row_ror:4 row_mask:0xf bank_mask:0xf
    s_nop 1
    v_add_f32_dpp v12, v12, v12 row_ror:2 row_mask:0xf bank_mask:0xf
    s_mov_b64 exec, s[32:33]
    v_cvt_pk_bf16_f32 v12, v12, v12
    buffer_store_short v12, v11, s[56:59], s78 offen
L_end:
    s_endpgm
L_ticket:
    v_lshlrev_b32 v1, 2, v0
    v_mov_b32 v2, 0
    v_lshlrev_b32 v4, 4, v0
    v_mov_b32 v8, -1
    v_mov_b32 v9, -1
    v_mov_b32 v10, -1
    v_mov_b32 v11, -1
    ds_write_b128 v4, v[8:11] offset:256
    ds_write_b128 v4, v[8:11] offset:1280
    ds_write_b128 v4, v[8:11] offset:2304
    s_memrealtime s[80:81]
    s_waitcnt lgkmcnt(0)
    s_barrier
    s_mov_b32 s52, s22
    s_and_b32 s53, s23, 0xffff
    s_mov_b32 s54, 25165824
    s_mov_b32 s55, 0x00020000
    s_mov_b32 s60, s20
    s_and_b32 s61, s21, 0xffff
    s_mov_b32 s62, 256
    s_mov_b32 s63, 0x00020000
    s_max_u32 s69, s80, 1
    s_cmp_lg_u32 s2, 0
    s_cbranch_scc1 L_kd
    v_lshlrev_b32 v5, 8, v0
    s_mov_b32 s80, 23068672
    v_mov_b32 v3, 0
    buffer_store_dwordx2 v[2:3], v5, s[52:55], s80 offen sc0 sc1
    v_mov_b32 v3, s69
    s_mov_b64 exec, 1
    s_waitcnt vmcnt(0)
    buffer_store_dword v3, v2, s[60:63], 0 offen sc0 sc1
    s_mov_b64 exec, -1
L_kd:
    ds_read_b32 v3, v2 offset:128
    s_waitcnt lgkmcnt(0)
    v_readfirstlane_b32 s80, v3
    s_cmp_eq_u32 s80, 0
    s_cbranch_scc1 L_kd
    ds_read_b128 v[24:27], v4 offset:16128
    ds_read_b128 v[28:31], v4 offset:17152
    ds_read_b128 v[32:35], v4 offset:18176
    ds_read_b128 v[36:39], v4 offset:19200
    s_waitcnt lgkmcnt(0)
    v_max_f32 v18, v24, v25
    v_max3_f32 v18, v18, v26, v27
    v_max3_f32 v18, v18, v28, v29
    v_max3_f32 v18, v18, v30, v31
    v_max3_f32 v18, v18, v32, v33
    v_max3_f32 v18, v18, v34, v35
    v_max3_f32 v18, v18, v36, v37
    v_max3_f32 v18, v18, v38, v39
    s_nop 1
    v_max_f32_dpp v18, v18, v18 row_ror:8 row_mask:0xf bank_mask:0xf
    s_nop 1
    v_max_f32_dpp v18, v18, v18 row_ror:4 row_mask:0xf bank_mask:0xf
    s_nop 1
    v_max_f32_dpp v18, v18, v18 row_ror:2 row_mask:0xf bank_mask:0xf
    s_nop 1
    v_max_f32_dpp v18, v18, v18 row_ror:1 row_mask:0xf bank_mask:0xf
    v_mov_b32 v3, v18
    s_nop 1
    v_permlane32_swap_b32 v18, v3
    s_nop 1
    v_max_f32 v18, v18, v3
    v_mov_b32 v3, v18
    s_nop 1
    v_permlane16_swap_b32 v18, v3
    s_nop 1
    v_max_f32 v18, v18, v3
    v_sub_f32 v24, v24, v18
    v_sub_f32 v25, v25, v18
    v_sub_f32 v26, v26, v18
    v_sub_f32 v27, v27, v18
    v_sub_f32 v28, v28, v18
    v_sub_f32 v29, v29, v18
    v_sub_f32 v30, v30, v18
    v_sub_f32 v31, v31, v18
    v_sub_f32 v32, v32, v18
    v_sub_f32 v33, v33, v18
    v_sub_f32 v34, v34, v18
    v_sub_f32 v35, v35, v18
    v_sub_f32 v36, v36, v18
    v_sub_f32 v37, v37, v18
    v_sub_f32 v38, v38, v18
    v_sub_f32 v39, v39, v18
    v_exp_f32 v24, v24
    v_exp_f32 v25, v25
    v_exp_f32 v26, v26
    v_exp_f32 v27, v27
    v_exp_f32 v28, v28
    v_exp_f32 v29, v29
    v_exp_f32 v30, v30
    v_exp_f32 v31, v31
    v_exp_f32 v32, v32
    v_exp_f32 v33, v33
    v_exp_f32 v34, v34
    v_exp_f32 v35, v35
    v_exp_f32 v36, v36
    v_exp_f32 v37, v37
    v_exp_f32 v38, v38
    v_exp_f32 v39, v39
    ds_write_b32 v2, v18 offset:160
    v_add_f32 v19, v24, v25
    v_add_f32 v19, v19, v26
    v_add_f32 v19, v19, v27
    v_add_f32 v19, v19, v28
    v_add_f32 v19, v19, v29
    v_add_f32 v19, v19, v30
    v_add_f32 v19, v19, v31
    v_add_f32 v19, v19, v32
    v_add_f32 v19, v19, v33
    v_add_f32 v19, v19, v34
    v_add_f32 v19, v19, v35
    v_add_f32 v19, v19, v36
    v_add_f32 v19, v19, v37
    v_add_f32 v19, v19, v38
    v_add_f32 v19, v19, v39
    s_nop 1
    v_add_f32_dpp v19, v19, v19 row_ror:8 row_mask:0xf bank_mask:0xf
    s_nop 1
    v_add_f32_dpp v19, v19, v19 row_ror:4 row_mask:0xf bank_mask:0xf
    s_nop 1
    v_add_f32_dpp v19, v19, v19 row_ror:2 row_mask:0xf bank_mask:0xf
    s_nop 1
    v_add_f32_dpp v19, v19, v19 row_ror:1 row_mask:0xf bank_mask:0xf
    v_mov_b32 v3, v19
    s_nop 1
    v_permlane32_swap_b32 v19, v3
    s_nop 1
    v_add_f32 v19, v19, v3
    v_mov_b32 v3, v19
    s_nop 1
    v_permlane16_swap_b32 v19, v3
    s_nop 1
    v_add_f32 v19, v19, v3
    s_lshl_b32 s80, s2, 11
    s_add_u32 s80, s80, 18874368
    s_waitcnt lgkmcnt(0)
    s_mov_b64 exec, -1
L_tg:
    buffer_load_dword v3, v2, s[60:63], 0 offen sc0 sc1
    s_waitcnt vmcnt(0)
    v_readfirstlane_b32 s69, v3
    s_cmp_eq_u32 s69, 0
    s_cbranch_scc1 L_tg
    s_getreg_b32 s81, hwreg(HW_REG_XCC_ID)
    s_and_b32 s81, s81, 15
    v_mov_b32 v16, s81
    v_mov_b32 v17, s69
    s_lshl_b32 s80, s2, 11
    s_mov_b64 exec, 1
    s_lshl_b32 s82, s2, 4
    s_add_u32 s82, s82, 1572864
    buffer_store_dwordx4 v[16:19], v2, s[52:55], s82 offen sc0 sc1
    v_mov_b32 v12, s69
    v_mov_b32 v13, s69
    s_add_u32 s82, s80, 2097152
    buffer_store_dwordx2 v[12:13], v2, s[52:55], s82 offen offset:1024
    s_add_u32 s82, s80, 2621440
    buffer_store_dwordx2 v[12:13], v2, s[52:55], s82 offen offset:1024
    s_mov_b64 exec, -1
    s_mov_b32 s73, s81
    s_lshl_b32 s80, s79, 2
    s_lshr_b32 s74, 0x54465464, s80
    s_and_b32 s74, s74, 15
    s_mov_b32 s75, 0
    s_mov_b32 s95, s69
    s_lshl_b32 s77, s2, 11
    s_lshl_b32 s94, s79, 16
    s_mov_b32 s76, 2097152
    v_mov_b32 v19, 0
    v_lshlrev_b32 v20, 11, v0
    v_mov_b32 v21, v4
L_fl:
    ds_read_b32 v3, v19
    s_waitcnt lgkmcnt(0)
    v_readfirstlane_b32 s80, v3
    s_cmp_eq_u32 s80, 0
    s_cbranch_scc1 L_fl
    ds_read_b128 v[24:27], v21 offset:20480
    ds_read_b128 v[28:31], v21 offset:21504
    ds_read_b128 v[32:35], v21 offset:22528
    ds_read_b128 v[36:39], v21 offset:23552
    s_waitcnt lgkmcnt(0)
    s_nop 0
    v_add_f32_dpp v37, v37, v37 row_ror:8 row_mask:0xf bank_mask:0xf
    v_add_f32_dpp v38, v38, v38 row_ror:8 row_mask:0xf bank_mask:0xf
    s_nop 0
    v_add_f32_dpp v37, v37, v37 row_ror:4 row_mask:0xf bank_mask:0xf
    v_add_f32_dpp v38, v38, v38 row_ror:4 row_mask:0xf bank_mask:0xf
    s_nop 0
    v_add_f32_dpp v37, v37, v37 row_ror:2 row_mask:0xf bank_mask:0xf
    v_add_f32_dpp v38, v38, v38 row_ror:2 row_mask:0xf bank_mask:0xf
    s_nop 0
    v_add_f32_dpp v37, v37, v37 row_ror:1 row_mask:0xf bank_mask:0xf
    v_add_f32_dpp v38, v38, v38 row_ror:1 row_mask:0xf bank_mask:0xf
    v_mov_b32 v40, v36
    v_mov_b32 v41, v36
    s_nop 1
    v_permlane32_swap_b32 v40, v41
    s_nop 1
    v_max_f32 v40, v40, v41
    v_mov_b32 v41, v40
    s_nop 1
    v_permlane16_swap_b32 v40, v41
    s_nop 1
    v_max_f32 v40, v40, v41
    v_sub_f32 v41, v36, v40
    v_exp_f32 v41, v41
    v_mov_b32 v48, v40
    v_mul_f32 v37, v37, v41
    v_mul_f32 v38, v38, v41
    v_mul_f32 v41, 0x58000000, v41
    v_fma_f32 v24, v24, v41, -v38
    v_fma_f32 v25, v25, v41, -v38
    v_fma_f32 v26, v26, v41, -v38
    v_fma_f32 v27, v27, v41, -v38
    v_fma_f32 v28, v28, v41, -v38
    v_fma_f32 v29, v29, v41, -v38
    v_fma_f32 v30, v30, v41, -v38
    v_fma_f32 v31, v31, v41, -v38
    v_fma_f32 v32, v32, v41, -v38
    v_fma_f32 v33, v33, v41, -v38
    v_fma_f32 v34, v34, v41, -v38
    v_fma_f32 v35, v35, v41, -v38
    v_mov_b32 v40, v37
    s_nop 1
    v_permlane32_swap_b32 v37, v40
    v_permlane32_swap_b32 v24, v26
    v_permlane32_swap_b32 v25, v27
    v_permlane32_swap_b32 v28, v30
    v_permlane32_swap_b32 v29, v31
    v_permlane32_swap_b32 v32, v34
    v_permlane32_swap_b32 v33, v35
    s_nop 1
    v_add_f32 v37, v37, v40
    v_add_f32 v24, v24, v26
    v_add_f32 v25, v25, v27
    v_add_f32 v28, v28, v30
    v_add_f32 v29, v29, v31
    v_add_f32 v32, v32, v34
    v_add_f32 v33, v33, v35
    v_mov_b32 v40, v37
    s_nop 1
    v_permlane16_swap_b32 v37, v40
    v_permlane16_swap_b32 v24, v25
    v_permlane16_swap_b32 v28, v29
    v_permlane16_swap_b32 v32, v33
    s_nop 1
    v_add_f32 v49, v37, v40
    v_add_f32 v44, v24, v25
    v_add_f32 v45, v28, v29
    v_add_f32 v46, v32, v33
    v_mov_b32 v8, v44
    v_mov_b32 v9, v45
    v_mov_b32 v10, v46
    v_cndmask_b32 v11, v48, v49, s[66:67]
    s_cmp_eq_u32 s75, 1
    s_cbranch_scc1 L_dep
    s_cmp_lg_u32 s75, 0
    s_cbranch_scc1 L_guard
    s_lshr_b32 s82, s3, 5
    s_lshl_b32 s83, s79, 9
    s_add_u32 s83, s83, 1572864
    s_bfm_b64 exec, 32, 0
L_reg:
    buffer_load_dwordx2 v[12:13], v4, s[52:55], s83 offen sc0 sc1
    s_waitcnt vmcnt(0)
    v_cmp_ne_u32 vcc, s69, v13
    s_cmp_lg_u64 vcc, 0
    s_cbranch_scc1 L_reg
    v_cmp_eq_u32 s[86:87], s73, v12
    s_nop 1
    v_mov_b32 v14, s86
    v_mov_b32 v15, s87
    ds_write_b64 v2, v[14:15] offset:152
    s_waitcnt lgkmcnt(0)
    ds_write_b32 v2, v13 offset:140
    s_mov_b64 exec, -1
    s_branch L_dep
L_guard:
    s_sub_u32 s80, s95, 1
    s_add_u32 s81, s94, s76
L_guard2:
    v_mov_b32 v12, s69
    s_mov_b64 exec, s[86:87]
    buffer_load_dword v12, v20, s[52:55], s81 offen offset:1028 sc0 sc1
    s_mov_b64 exec, -1
    s_waitcnt vmcnt(0)
    v_cmp_eq_u32 vcc, s80, v12
    s_cmp_eq_u64 vcc, 0
    s_cbranch_scc1 L_guard2
L_dep:
    s_add_u32 s75, s75, 1
    s_add_u32 s95, s95, 1
    s_add_u32 s80, s77, s76
    v_mov_b32 v3, s95
    s_waitcnt lgkmcnt(0)
    buffer_store_dwordx4 v[8:11], v4, s[52:55], s80 offen
    s_mov_b64 exec, 1
    s_waitcnt vmcnt(0)
    buffer_store_dword v3, v2, s[52:55], s80 offen offset:1024
    s_mov_b64 exec, -1
    s_xor_b32 s76, s76, 0x80000
    v_add_u32 v21, 4096, v21
    v_add_u32 v19, 4, v19
    s_cmp_lt_u32 s75, s74
    s_cbranch_scc1 L_fl
    s_endpgm
L_ctl:
    v_lshlrev_b32 v1, 2, v0
    v_mov_b32 v2, 0
    ds_write_b32 v1, v2 offset:3328
    s_and_b32 s70, s2, 31
    s_lshl_b32 s70, s70, 2
    s_mov_b32 s71, 1
    v_mov_b32 v7, s2
    v_and_b32 v10, 15, v0
    v_lshrrev_b32 v8, 5, v7
    v_lshl_add_u32 v10, v8, 4, v10
    v_lshrrev_b32 v9, 4, v0
    v_lshl_add_u32 v10, v9, 7, v10
    s_lshl_b32 s82, s79, 3
    s_mov_b32 s80, 0xeff4fa00
    s_mov_b32 s81, 0xdbe0e5ea
    s_lshr_b64 s[80:81], s[80:81], s82
    s_sext_i32_i8 s80, s80
    s_mov_b32 exec_lo, 0x0
    s_mov_b32 exec_hi, 0x3ff
    v_add_u32 v10, s80, v10
    s_mov_b32 s80, 0xeff43d4c
    s_mov_b32 s81, 0xdbe0e5ea
    s_lshr_b64 s[80:81], s[80:81], s82
    s_sext_i32_i8 s80, s80
    s_mov_b32 exec_lo, 0x0
    s_mov_b32 exec_hi, 0x400
    v_add_u32 v10, s80, v10
    s_mov_b32 s80, 0x2c37424d
    s_mov_b32 s81, 0xb1621
    s_lshr_b64 s[80:81], s[80:81], s82
    s_sext_i32_i8 s80, s80
    s_mov_b32 exec_lo, 0x0
    s_mov_b32 exec_hi, 0xf800
    v_add_u32 v10, s80, v10
    s_mov_b64 exec, -1
    v_mul_u32_u24 v30, 1572864, v10
    v_and_b32 v9, 3, v7
    v_lshl_add_u32 v8, v10, 2, v9
    v_bfe_u32 v9, v7, 2, 3
    v_lshl_add_u32 v8, v8, 3, v9
    v_mul_u32_u24 v9, 384, v8
    v_lshlrev_b32 v8, 7, v8
    s_waitcnt lgkmcnt(0)
    s_mov_b32 s32, s10
    s_and_b32 s33, s11, 0xffff
    s_mov_b32 s34, 6291456
    s_mov_b32 s35, 0x00020000
    buffer_load_dword v10, v9, s[32:35], 0 offen offset:0
    buffer_load_dword v11, v9, s[32:35], 0 offen offset:128
    buffer_load_dword v12, v9, s[32:35], 0 offen offset:256
    s_mov_b32 s36, s12
    s_and_b32 s37, s13, 0xffff
    s_mov_b32 s38, 6291456
    s_mov_b32 s39, 0x00020000
    buffer_load_dword v13, v9, s[36:39], 0 offen offset:0
    buffer_load_dword v14, v9, s[36:39], 0 offen offset:128
    buffer_load_dword v15, v9, s[36:39], 0 offen offset:256
    s_mov_b32 s40, s14
    s_and_b32 s41, s15, 0xffff
    s_mov_b32 s42, 2097152
    s_mov_b32 s43, 0x00020000
    buffer_load_dword v16, v8, s[40:43], 0 offen offset:0
    s_mov_b32 s44, s16
    s_and_b32 s45, s17, 0xffff
    s_mov_b32 s46, 2097152
    s_mov_b32 s47, 0x00020000
    buffer_load_dword v17, v8, s[44:47], 0 offen offset:0
    s_mov_b32 s52, s22
    s_and_b32 s53, s23, 0xffff
    s_mov_b32 s54, 25165824
    s_mov_b32 s55, 0x00020000
    v_lshlrev_b32 v7, 7, v0
    s_lshl_b32 s80, s2, 11
    s_add_u32 s81, s80, 2097152
    s_add_u32 s82, s80, 2621440
    s_mov_b64 exec, 0x1ff
    buffer_load_dword v18, v7, s[52:55], s81 offen
    buffer_load_dword v19, v7, s[52:55], s82 offen
    s_mov_b64 exec, -1
    s_barrier
    s_mov_b32 s60, s20
    s_and_b32 s61, s21, 0xffff
    s_mov_b32 s62, 256
    s_mov_b32 s63, 0x00020000
    s_branch L_x4
L_w4:
    s_branch L_walked
L_x4:
    s_mov_b32 s52, s22
    s_and_b32 s53, s23, 0xffff
    s_mov_b32 s54, 25165824
    s_mov_b32 s55, 0x00020000
    s_getreg_b32 s76, hwreg(HW_REG_XCC_ID)
    s_and_b32 s76, s76, 15
    s_lshr_b32 s70, s70, 1
    s_and_b32 s75, s2, 31
    s_cmp_eq_u32 s75, 0
    s_cselect_b32 s75, 32, s75
    s_mul_i32 s77, s75, 64
    v_lshlrev_b32 v1, 1, v0
    v_lshlrev_b32 v7, 7, v0
    s_mov_b32 s24, s6
    s_and_b32 s25, s7, 0xffff
    s_mov_b32 s26, 805306368
    s_mov_b32 s27, 0x00020000
    s_mov_b32 s28, s8
    s_and_b32 s29, s9, 0xffff
    s_mov_b32 s30, 805306368
    s_mov_b32 s31, 0x00020000
    s_and_b32 s88, s2, 31
    s_lshl_b32 s89, s88, 4
    s_sub_i32 s89, s89, 63
    s_mov_b32 s90, 1572800
L_c:
    ds_read_b32 v3, v2 offset:3328
    ds_read_b32 v4, v2 offset:144
    s_mov_b64 exec, 1
    s_waitcnt lgkmcnt(0)
    v_add_u32 v3, 1, v3
    buffer_store_short v3, v2, s[60:63], s70 offen offset:128
    s_bfm_b64 exec, 33, 0
    buffer_load_ushort v5, v1, s[60:63], 0 offen offset:128 sc1
    v_readfirstlane_b32 s72, v3
    v_readfirstlane_b32 s81, v4
    s_add_u32 s80, s71, s72
    s_mov_b32 s71, s72
    s_mov_b64 exec, 0xffffffff
    s_waitcnt vmcnt(0)
    v_cmp_ne_u32 vcc, 0, v5
    v_lshlrev_b32 v6, 1, v5
    v_readlane_b32 s86, v5, 32
    v_cmp_le_u32 s[82:83], s80, v6
    s_bcnt1_i32_b64 s73, vcc
    s_cmp_eq_u32 s86, 0
    s_cselect_b32 s86, 1024, s86
    s_bcnt1_i32_b64 s74, s[82:83]
    s_sub_i32 s86, s86, 1003
    s_mul_i32 s80, s73, s86
    s_lshl_b32 s74, s74, 5
    s_cmp_lt_i32 s74, s80
    s_cselect_b32 s86, 1, 0
    s_lshl_b32 s82, s73, 5
    s_add_u32 s74, s74, s82
    s_cmp_lt_i32 s74, s80
    s_cselect_b32 s86, 2, s86
    v_mov_b32 v6, s86
    ds_write_b32 v2, v6 offset:148
    s_cmp_lt_i32 s72, s89
    s_cbranch_scc1 L_ntp
    v_readlane_b32 s87, v30, s88
    s_min_u32 s87, s87, 803733504
    s_cmp_ge_u32 s88, 64
    s_cbranch_scc1 L_tpv
    s_load_dword s90, s[6:7], s87
    s_add_u32 s87, s87, 1572800
    s_load_dword s91, s[6:7], s87
    s_branch L_tpd
L_tpv:
    s_load_dword s90, s[8:9], s87
    s_add_u32 s87, s87, 1572800
    s_load_dword s91, s[8:9], s87
L_tpd:
    s_add_u32 s88, s88, 32
    s_add_i32 s89, s89, 512
    s_cmp_ge_u32 s88, 128
    s_cselect_b32 s89, 0x7fffffff, s89
    s_mov_b64 exec, 0xffffffff
L_ntp:
    s_cmp_lt_u32 s72, s77
    s_cbranch_scc1 L_cn
    s_memrealtime s[84:85]
    s_add_u32 s77, s77, 2048
    s_lshl_b32 s86, s75, 11
    s_add_u32 s75, s75, 32
    s_cmp_lg_u32 s73, 32
    s_cbranch_scc1 L_cn
    v_add_u32_dpp v5, v5, v5 row_ror:8 row_mask:0xf bank_mask:0xf
    s_nop 1
    v_add_u32_dpp v5, v5, v5 row_ror:4 row_mask:0xf bank_mask:0xf
    s_nop 1
    v_add_u32_dpp v5, v5, v5 row_ror:2 row_mask:0xf bank_mask:0xf
    s_nop 1
    v_add_u32_dpp v5, v5, v5 row_ror:1 row_mask:0xf bank_mask:0xf
    s_nop 1
    v_readlane_b32 s74, v5, 0
    v_readlane_b32 s73, v5, 16
    s_add_u32 s86, s86, 3143680
    s_lshl_b32 s80, s76, 7
    s_add_u32 s80, s80, s86
    s_add_u32 s74, s74, s73
    s_lshl_b32 s74, s74, 2
    s_waitcnt lgkmcnt(0)
    s_mul_i32 s73, s84, 13
    s_sub_u32 s74, s74, s73
    v_mov_b32 v8, s74
    v_mov_b32 v9, s84
    s_mov_b64 exec, 1
    buffer_store_dwordx2 v[8:9], v2, s[52:55], s80 offen offset:2048 sc0 sc1
    s_mov_b64 exec, 0xffff
    buffer_load_dwordx2 v[10:11], v7, s[52:55], s86 offen sc0 sc1
    s_waitcnt vmcnt(0)
    v_sub_u32 v9, s84, v11
    v_cmp_gt_u32 vcc, 0x1000, v9
    v_sub_u32 v8, s74, v10
    s_bitset0_b32 vcc_lo, s76
    v_cndmask_b32 v8, 0, v8, vcc
    s_nop 1
    v_add_u32_dpp v8, v8, v8 row_ror:8 row_mask:0xf bank_mask:0xf
    s_nop 1
    v_add_u32_dpp v8, v8, v8 row_ror:4 row_mask:0xf bank_mask:0xf
    s_nop 1
    v_add_u32_dpp v8, v8, v8 row_ror:2 row_mask:0xf bank_mask:0xf
    s_nop 1
    v_add_u32_dpp v8, v8, v8 row_ror:1 row_mask:0xf bank_mask:0xf
    s_nop 1
    v_ashrrev_i32 v8, 9, v8
    v_max_i32 v8, -5, v8
    v_min_i32 v8, 40, v8
    v_add_u32 v8, 0x400, v8
    s_mov_b64 exec, 1
    buffer_store_short v8, v2, s[60:63], 0 offen offset:192
L_cn:
    s_cmp_eq_u32 s81, 0
    s_cbranch_scc1 L_c
    s_endpgm
.section .rodata,"a"
.p2align 6
.amdhsa_kernel standalone__kv_cache_quant_int4_int2_kv_with_per_channel_or_per_token_scales__decode_kernel
  .amdhsa_next_free_vgpr 246
  .amdhsa_next_free_sgpr 102
  .amdhsa_accum_offset 248
  .amdhsa_float_denorm_mode_32 3
  .amdhsa_group_segment_fixed_size 0
  .amdhsa_kernarg_size 80
  .amdhsa_user_sgpr_count 2
  .amdhsa_user_sgpr_kernarg_segment_ptr 1
  .amdhsa_system_sgpr_workgroup_id_x 1
.end_amdhsa_kernel
```

```asm
; @launch grid=(256,1,1) block=(256,1,1) lds=98304
.amdgcn_target "amdgcn-amd-amdhsa--gfx950"
.text
.globl standalone__kv_cache_quant_int4_int2_kv_with_per_channel_or_per_token_scales__decode_kernel
.p2align 12
.type standalone__kv_cache_quant_int4_int2_kv_with_per_channel_or_per_token_scales__decode_kernel,@function
standalone__kv_cache_quant_int4_int2_kv_with_per_channel_or_per_token_scales__decode_kernel:
    s_cmp_ge_u32 s2, 256
    s_cbranch_scc1 L_end
    s_load_dwordx16 s[4:19], s[0:1], 0
    s_load_dwordx4 s[20:23], s[0:1], 64
    s_and_b32 s80, s2, 7
    s_lshr_b32 s2, s2, 3
    s_lshl_b32 s80, s80, 5
    s_or_b32 s2, s2, s80
    s_mov_b32 s3, s2
    v_lshrrev_b32 v229, 6, v0
    v_and_b32 v0, 63, v0
    v_readfirstlane_b32 s68, v229
    s_lshr_b32 s79, s2, 5
    s_and_b32 s92, s2, 31
    s_mov_b32 s66, 0xaaaaaaaa
    s_mov_b32 s67, 0xaaaaaaaa
    s_cmp_eq_u32 s68, 1
    s_cbranch_scc1 L_service
    s_cmp_eq_u32 s68, 2
    s_cbranch_scc1 L_ticket
    s_cmp_eq_u32 s68, 3
    s_cbranch_scc1 L_ctl
    s_mov_b64 vcc, 0
    s_setprio 1
    v_and_b32 v235, 15, v0
    v_lshrrev_b32 v234, 4, v0
    v_mul_u32_u24 v1, 768, v234
    v_lshl_add_u32 v1, v235, 4, v1
    v_lshlrev_b32 v2, 3, v235
    v_bfrev_b32 v231, v235
    v_lshrrev_b32 v231, 28, v231
    v_and_b32 v232, 3, v231
    v_lshl_add_u32 v3, v232, 2, v234
    v_lshlrev_b32 v3, 1, v3
    v_lshrrev_b32 v231, 2, v231
    v_lshl_add_u32 v3, v231, 10, v3
    v_lshlrev_b32 v239, 2, v0
    v_add_u32 v240, 3840, v239
    v_add_u32 v239, 3584, v239
    v_lshlrev_b32 v241, 4, v0
    v_mov_b32 v242, 0
    v_mov_b32 v243, 1
    v_lshlrev_b32 v224, 2, v0
    v_mov_b32 v225, 1
    v_mov_b32 v226, 260
    s_mul_i32 s58, s79, 0
    s_and_b32 s94, s92, 448
    s_add_u32 s94, s94, s58
    s_add_u32 s94, s94, 512
    s_add_u32 s58, s58, s92
    s_and_b32 s58, s58, 511
    s_lshr_b32 s59, s3, 5
    s_lshl_b32 s69, s79, 9
    s_add_u32 s59, s59, 24
    s_lshl_b32 s59, s59, 9
    s_mov_b32 s64, 0xcccccccc
    s_mov_b32 s65, 0xcccccccc
    s_mov_b32 s60, 0x6fd53b95
    s_mov_b32 s62, 0x80000001
    s_mov_b32 s61, 0x6fd53b95
    s_mov_b32 s63, 0x80000001
    s_and_b32 s80, s92, 3
    s_cmp_eq_u32 s80, 1
    s_mov_b32 s81, 0x11119143
    s_cselect_b32 s81, 0x11659143, s81
    s_cmp_eq_u32 s80, 0
    s_cselect_b32 s81, 0x80659143, s81
    s_andn2_b32 s82, s92, 3
    s_lshr_b32 s81, s81, s82
    s_and_b32 s81, s81, 15
    s_lshl_b32 m0, s81, 1
    s_lshl_b32 s80, s80, 21
    s_max_u32 s80, s80, 64
    s_sub_u32 s80, s80, 64
    s_mul_i32 s82, s79, 25165824
    s_cmp_eq_u32 s81, 1
    s_cselect_b32 s82, s82, 0
    s_add_u32 s80, s80, s82
    v_mov_b32 v236, s80
    s_waitcnt lgkmcnt(0)
    s_movrels_b64 s[84:85], s[4:5]
    global_load_dword v236, v236, s[84:85]
    s_mov_b32 s24, s6
    s_and_b32 s25, s7, 0xffff
    s_mov_b32 s26, 805306368
    s_mov_b32 s27, 0x00020000
    s_mov_b32 s48, s4
    s_and_b32 s49, s5, 0xffff
    s_mov_b32 s50, 12288
    s_mov_b32 s51, 0x00020000
    s_mov_b32 s32, s10
    s_and_b32 s33, s11, 0xffff
    s_mov_b32 s34, 6291456
    s_mov_b32 s35, 0x00020000
    s_mov_b32 s36, s12
    s_and_b32 s37, s13, 0xffff
    s_mov_b32 s38, 6291456
    s_mov_b32 s39, 0x00020000
    s_add_u32 s70, s69, s92
    s_mov_b32 s91, 1
    s_lshr_b32 s74, s70, 9
    s_mul_i32 s74, s74, 384
    buffer_load_dwordx2 v[192:193], v2, s[48:51], s74 offen offset:0
    buffer_load_dwordx2 v[194:195], v2, s[48:51], s74 offen offset:128
    buffer_load_dwordx2 v[196:197], v2, s[48:51], s74 offen offset:256
    s_and_b32 s80, s70, 31
    s_sub_u32 s72, s70, s80
    s_lshr_b32 s80, s80, 2
    s_add_u32 s72, s72, s80
    s_mul_i32 s72, s72, 384
    buffer_load_dwordx2 v[132:133], v2, s[32:35], s72 offen offset:0
    buffer_load_dwordx2 v[134:135], v2, s[32:35], s72 offen offset:128
    buffer_load_dwordx2 v[136:137], v2, s[32:35], s72 offen offset:256
    buffer_load_dwordx2 v[138:139], v2, s[36:39], s72 offen offset:0
    buffer_load_dwordx2 v[140:141], v2, s[36:39], s72 offen offset:128
    buffer_load_dwordx2 v[142:143], v2, s[36:39], s72 offen offset:256
    s_mul_i32 s71, s70, 49152
    s_and_b32 s80, s70, 31
    s_mul_i32 s80, s80, 36864
    s_sub_u32 s71, s71, s80
    buffer_load_dwordx4 v[4:7], v1, s[24:27], s71 offen offset:0 nt
    buffer_load_dwordx4 v[8:11], v1, s[24:27], s71 offen offset:256 nt
    buffer_load_dwordx4 v[12:15], v1, s[24:27], s71 offen offset:512 nt
    s_add_u32 s71, s71, 3072
    buffer_load_dwordx4 v[16:19], v1, s[24:27], s71 offen offset:0 nt
    s_add_u32 s72, s72, 3072
    buffer_load_dwordx2 v[156:157], v2, s[32:35], s72 offen offset:0
    buffer_load_dwordx2 v[158:159], v2, s[32:35], s72 offen offset:128
    buffer_load_dwordx2 v[160:161], v2, s[32:35], s72 offen offset:256
    buffer_load_dwordx2 v[162:163], v2, s[36:39], s72 offen offset:0
    buffer_load_dwordx2 v[164:165], v2, s[36:39], s72 offen offset:128
    buffer_load_dwordx2 v[166:167], v2, s[36:39], s72 offen offset:256
    buffer_load_dwordx4 v[20:23], v1, s[24:27], s71 offen offset:256 nt
    buffer_load_dwordx4 v[24:27], v1, s[24:27], s71 offen offset:512 nt
    s_add_u32 s71, s71, 3072
    buffer_load_dwordx4 v[28:31], v1, s[24:27], s71 offen offset:0 nt
    buffer_load_dwordx4 v[32:35], v1, s[24:27], s71 offen offset:256 nt
    buffer_load_dwordx4 v[36:39], v1, s[24:27], s71 offen offset:512 nt
    s_add_u32 s71, s71, 3072
    buffer_load_dwordx4 v[40:43], v1, s[24:27], s71 offen offset:0 nt
    buffer_load_dwordx4 v[44:47], v1, s[24:27], s71 offen offset:256 nt
    buffer_load_dwordx4 v[48:51], v1, s[24:27], s71 offen offset:512 nt
    s_add_u32 s71, s71, 384000
    buffer_load_dwordx4 v[52:55], v1, s[24:27], s71 offen offset:0 nt
    buffer_load_dwordx4 v[56:59], v1, s[24:27], s71 offen offset:256 nt
    buffer_load_dwordx4 v[60:63], v1, s[24:27], s71 offen offset:512 nt
    s_add_u32 s71, s71, 3072
    buffer_load_dwordx4 v[64:67], v1, s[24:27], s71 offen offset:0 nt
    s_add_u32 s72, s72, 3072
    buffer_load_dwordx2 v[168:169], v2, s[32:35], s72 offen offset:0
    buffer_load_dwordx2 v[170:171], v2, s[32:35], s72 offen offset:128
    buffer_load_dwordx2 v[172:173], v2, s[32:35], s72 offen offset:256
    buffer_load_dwordx2 v[174:175], v2, s[36:39], s72 offen offset:0
    buffer_load_dwordx2 v[176:177], v2, s[36:39], s72 offen offset:128
    buffer_load_dwordx2 v[178:179], v2, s[36:39], s72 offen offset:256
    buffer_load_dwordx4 v[68:71], v1, s[24:27], s71 offen offset:256 nt
    buffer_load_dwordx4 v[72:75], v1, s[24:27], s71 offen offset:512 nt
    s_add_u32 s71, s71, 3072
    buffer_load_dwordx4 v[76:79], v1, s[24:27], s71 offen offset:0 nt
    buffer_load_dwordx4 v[80:83], v1, s[24:27], s71 offen offset:256 nt
    buffer_load_dwordx4 v[84:87], v1, s[24:27], s71 offen offset:512 nt
    s_add_u32 s71, s71, 3072
    buffer_load_dwordx4 v[88:91], v1, s[24:27], s71 offen offset:0 nt
    buffer_load_dwordx4 v[92:95], v1, s[24:27], s71 offen offset:256 nt
    buffer_load_dwordx4 v[96:99], v1, s[24:27], s71 offen offset:512 nt
    s_mov_b32 s28, s8
    s_and_b32 s29, s9, 0xffff
    s_mov_b32 s30, 805306368
    s_mov_b32 s31, 0x00020000
    s_mov_b32 s40, s14
    s_and_b32 s41, s15, 0xffff
    s_mov_b32 s42, 2097152
    s_mov_b32 s43, 0x00020000
    s_mov_b32 s44, s16
    s_and_b32 s45, s17, 0xffff
    s_mov_b32 s46, 2097152
    s_mov_b32 s47, 0x00020000
    s_mov_b32 s52, s22
    s_and_b32 s53, s23, 0xffff
    s_mov_b32 s54, 25165824
    s_mov_b32 s55, 0x00020000
    v_mov_b32 v229, s2
    v_and_b32 v231, 15, v0
    v_lshrrev_b32 v230, 5, v229
    v_lshl_add_u32 v231, v230, 4, v231
    v_lshrrev_b32 v232, 4, v0
    v_lshl_add_u32 v231, v232, 7, v231
    s_lshl_b32 s82, s79, 3
    s_mov_b32 s80, 0xeff4fa00
    s_mov_b32 s81, 0xdbe0e5ea
    s_lshr_b64 s[80:81], s[80:81], s82
    s_sext_i32_i8 s80, s80
    s_mov_b32 exec_lo, 0x0
    s_mov_b32 exec_hi, 0x3ff
    v_add_u32 v231, s80, v231
    s_mov_b32 s80, 0xeff43d4c
    s_mov_b32 s81, 0xdbe0e5ea
    s_lshr_b64 s[80:81], s[80:81], s82
    s_sext_i32_i8 s80, s80
    s_mov_b32 exec_lo, 0x0
    s_mov_b32 exec_hi, 0x400
    v_add_u32 v231, s80, v231
    s_mov_b32 s80, 0x2c37424d
    s_mov_b32 s81, 0xb1621
    s_lshr_b64 s[80:81], s[80:81], s82
    s_sext_i32_i8 s80, s80
    s_mov_b32 exec_lo, 0x0
    s_mov_b32 exec_hi, 0xf800
    v_add_u32 v231, s80, v231
    s_mov_b64 exec, -1
    v_and_b32 v229, 31, v229
    v_lshl_add_u32 v245, v231, 5, v229
    s_mov_b32 s4, 0x10000
    s_mov_b32 s5, 0x10401
    s_cmp_eq_u32 s79, 1
    s_cselect_b32 s4, 0x10000, s4
    s_cselect_b32 s5, 0x14441, s5
    s_cmp_eq_u32 s79, 2
    s_cselect_b32 s4, 0x10000, s4
    s_cselect_b32 s5, 0x10801, s5
    s_cmp_eq_u32 s79, 3
    s_cselect_b32 s4, 0x10000, s4
    s_cselect_b32 s5, 0x10803, s5
    s_cmp_eq_u32 s79, 4
    s_cselect_b32 s4, 0x10000, s4
    s_cselect_b32 s5, 0x18841, s5
    s_cmp_eq_u32 s79, 5
    s_cselect_b32 s4, 0x10000, s4
    s_cselect_b32 s5, 0x10801, s5
    s_cmp_eq_u32 s79, 6
    s_cselect_b32 s4, 0x10000, s4
    s_cselect_b32 s5, 0x10801, s5
    s_cmp_eq_u32 s79, 7
    s_cselect_b32 s4, 0x10000, s4
    s_cselect_b32 s5, 0x10821, s5
    s_mov_b32 s7, 0xf149f2ca
    s_mov_b32 s77, 0xf149f2ca
    v_lshlrev_b32 v225, 4, v0
    v_mov_b32 v100, 0
    v_mov_b32 v101, 0
    v_mov_b32 v102, 0
    v_mov_b32 v103, 0
    s_lshl_b32 s78, s3, 11
    s_mov_b64 s[88:89], 0
    v_mov_b32 v216, 0xf149f2ca
    v_mov_b32 v217, 0
    v_mov_b32 v218, 0
    v_mov_b32 v204, 0
    v_mov_b32 v205, 0
    v_mov_b32 v206, 0
    v_mov_b32 v207, 0
    v_mov_b32 v208, 0
    v_mov_b32 v209, 0
    v_mov_b32 v210, 0
    v_mov_b32 v211, 0
    v_mov_b32 v212, 0
    v_mov_b32 v213, 0
    v_mov_b32 v214, 0
    v_mov_b32 v215, 0
    s_barrier
    s_waitcnt vmcnt(36)
    v_lshlrev_b32 v108, 16, v192
    v_and_b32 v109, 0xffff0000, v192
    v_pk_mul_f32 v[108:109], v[108:109], s[60:61]
    v_lshlrev_b32 v110, 16, v193
    v_and_b32 v111, 0xffff0000, v193
    v_pk_mul_f32 v[110:111], v[110:111], s[60:61]
    v_lshlrev_b32 v112, 16, v194
    v_and_b32 v113, 0xffff0000, v194
    v_pk_mul_f32 v[112:113], v[112:113], s[60:61]
    v_lshlrev_b32 v114, 16, v195
    v_and_b32 v115, 0xffff0000, v195
    v_pk_mul_f32 v[114:115], v[114:115], s[60:61]
    v_lshlrev_b32 v116, 16, v196
    v_and_b32 v117, 0xffff0000, v196
    v_pk_mul_f32 v[116:117], v[116:117], s[60:61]
    v_lshlrev_b32 v118, 16, v197
    v_and_b32 v119, 0xffff0000, v197
    v_pk_mul_f32 v[118:119], v[118:119], s[60:61]
    v_lshlrev_b32 v234, 16, v132
    v_and_b32 v235, 0xffff0000, v132
    v_pk_mul_f32 v[120:121], v[234:235], v[108:109]
    v_lshlrev_b32 v234, 16, v138
    v_and_b32 v235, 0xffff0000, v138
    v_pk_mul_f32 v[200:201], v[120:121], v[234:235]
    v_lshlrev_b32 v234, 16, v133
    v_and_b32 v235, 0xffff0000, v133
    v_pk_mul_f32 v[122:123], v[234:235], v[110:111]
    v_lshlrev_b32 v234, 16, v139
    v_and_b32 v235, 0xffff0000, v139
    v_pk_fma_f32 v[200:201], v[122:123], v[234:235], v[200:201]
    v_lshlrev_b32 v234, 16, v134
    v_and_b32 v235, 0xffff0000, v134
    v_pk_mul_f32 v[124:125], v[234:235], v[112:113]
    v_lshlrev_b32 v234, 16, v140
    v_and_b32 v235, 0xffff0000, v140
    v_pk_fma_f32 v[200:201], v[124:125], v[234:235], v[200:201]
    v_lshlrev_b32 v234, 16, v135
    v_and_b32 v235, 0xffff0000, v135
    v_pk_mul_f32 v[126:127], v[234:235], v[114:115]
    v_lshlrev_b32 v234, 16, v141
    v_and_b32 v235, 0xffff0000, v141
    v_pk_fma_f32 v[200:201], v[126:127], v[234:235], v[200:201]
    v_lshlrev_b32 v234, 16, v136
    v_and_b32 v235, 0xffff0000, v136
    v_pk_mul_f32 v[128:129], v[234:235], v[116:117]
    v_lshlrev_b32 v234, 16, v142
    v_and_b32 v235, 0xffff0000, v142
    v_pk_fma_f32 v[200:201], v[128:129], v[234:235], v[200:201]
    v_lshlrev_b32 v234, 16, v137
    v_and_b32 v235, 0xffff0000, v137
    v_pk_mul_f32 v[130:131], v[234:235], v[118:119]
    v_lshlrev_b32 v234, 16, v143
    v_and_b32 v235, 0xffff0000, v143
    v_pk_fma_f32 v[200:201], v[130:131], v[234:235], v[200:201]
    v_pk_mul_f32 v[200:201], v[200:201], s[62:63]
    s_mov_b32 s76, 63
L_loop0:
    s_waitcnt vmcnt(35)
    v_pk_fma_f32 v[198:199], v[120:121], v[4:5], v[200:201]
    v_pk_fma_f32 v[198:199], v[122:123], v[6:7], v[198:199]
    ds_read_b32 v244, v243 offset:147
    s_add_u32 s71, s71, 384000
    s_cbranch_vccnz L_th24_0
L_tb24_0:
    buffer_load_dwordx4 v[4:7], v1, s[24:27], s71 offen offset:0 nt
    v_add_f32_dpp v229, v228, v228 row_ror:8 row_mask:0xf bank_mask:0xc
    s_waitcnt vmcnt(35)
    v_pk_fma_f32 v[198:199], v[124:125], v[8:9], v[198:199]
    v_pk_fma_f32 v[198:199], v[126:127], v[10:11], v[198:199]
    buffer_load_dwordx4 v[8:11], v1, s[24:27], s71 offen offset:256 nt
    v_add_f32_dpp v230, v229, v229 row_shr:4 row_mask:0xf bank_mask:0xa
    s_waitcnt vmcnt(35)
    v_pk_fma_f32 v[198:199], v[128:129], v[12:13], v[198:199]
    v_pk_fma_f32 v[198:199], v[130:131], v[14:15], v[198:199]
    s_waitcnt lgkmcnt(0)
    v_cmp_lt_u32 vcc, v0, v244
    ds_add_u32 v224, v243 offset:3328
    buffer_load_dwordx4 v[12:15], v1, s[24:27], s71 offen offset:512 nt
    v_add_f32_dpp v232, v230, v230 quad_perm:[2,3,0,1] row_mask:0xf bank_mask:0xf
    v_add_f32 v228, v198, v199
    s_waitcnt vmcnt(35)
    v_pk_fma_f32 v[198:199], v[120:121], v[16:17], v[200:201]
    v_pk_fma_f32 v[198:199], v[122:123], v[18:19], v[198:199]
    s_add_u32 s71, s71, 3072
    s_cbranch_vccnz L_th27_0
L_tb27_0:
    buffer_load_dwordx4 v[16:19], v1, s[24:27], s71 offen offset:0 nt
    v_cndmask_b32 v232, v231, v232, s[64:65]
    v_add_f32_dpp v229, v228, v228 row_ror:8 row_mask:0xf bank_mask:0x3
    s_waitcnt vmcnt(29)
    v_pk_fma_f32 v[198:199], v[124:125], v[20:21], v[198:199]
    v_pk_fma_f32 v[198:199], v[126:127], v[22:23], v[198:199]
    s_add_u32 s72, s72, 3072
    buffer_load_dwordx2 v[180:181], v2, s[32:35], s72 offen offset:0
    buffer_load_dwordx2 v[182:183], v2, s[32:35], s72 offen offset:128
    buffer_load_dwordx2 v[184:185], v2, s[32:35], s72 offen offset:256
    buffer_load_dwordx2 v[186:187], v2, s[36:39], s72 offen offset:0
    buffer_load_dwordx2 v[188:189], v2, s[36:39], s72 offen offset:128
    buffer_load_dwordx2 v[190:191], v2, s[36:39], s72 offen offset:256
    buffer_load_dwordx4 v[20:23], v1, s[24:27], s71 offen offset:256 nt
    v_add_f32_dpp v231, v232, v232 quad_perm:[1,0,3,2] row_mask:0xf bank_mask:0xf
    v_lshlrev_b32 v234, 16, v156
    v_and_b32 v235, 0xffff0000, v156
    v_pk_mul_f32 v[144:145], v[234:235], v[108:109]
    v_lshlrev_b32 v234, 16, v162
    v_and_b32 v235, 0xffff0000, v162
    s_waitcnt vmcnt(35)
    v_pk_fma_f32 v[198:199], v[128:129], v[24:25], v[198:199]
    v_pk_fma_f32 v[198:199], v[130:131], v[26:27], v[198:199]
    ds_add_u32 v224, v243 offset:3328
    buffer_load_dwordx4 v[24:27], v1, s[24:27], s71 offen offset:512 nt
    v_cndmask_b32 v233, v233, v231, s[66:67]
    v_mul_f32 v233, 0x58000000, v233
    ds_write_b32 v239, v233
    v_add_u32 v239, 256, v239
    v_add_f32 v228, v198, v199
    v_pk_mul_f32 v[202:203], v[144:145], v[234:235]
    v_lshlrev_b32 v234, 16, v157
    v_and_b32 v235, 0xffff0000, v157
    v_pk_mul_f32 v[146:147], v[234:235], v[110:111]
    v_lshlrev_b32 v234, 16, v163
    s_waitcnt vmcnt(35)
    v_pk_fma_f32 v[198:199], v[120:121], v[28:29], v[200:201]
    v_pk_fma_f32 v[198:199], v[122:123], v[30:31], v[198:199]
    s_add_u32 s71, s71, 3072
    s_cbranch_vccnz L_th30_0
L_tb30_0:
    buffer_load_dwordx4 v[28:31], v1, s[24:27], s71 offen offset:0 nt
    v_add_f32_dpp v229, v228, v228 row_ror:8 row_mask:0xf bank_mask:0xc
    v_and_b32 v235, 0xffff0000, v163
    v_pk_fma_f32 v[202:203], v[146:147], v[234:235], v[202:203]
    v_lshlrev_b32 v234, 16, v158
    v_and_b32 v235, 0xffff0000, v158
    v_pk_mul_f32 v[148:149], v[234:235], v[112:113]
    s_waitcnt vmcnt(35)
    v_pk_fma_f32 v[198:199], v[124:125], v[32:33], v[198:199]
    v_pk_fma_f32 v[198:199], v[126:127], v[34:35], v[198:199]
    buffer_load_dwordx4 v[32:35], v1, s[24:27], s71 offen offset:256 nt
    v_add_f32_dpp v230, v229, v229 row_shl:4 row_mask:0xf bank_mask:0x5
    v_lshlrev_b32 v234, 16, v164
    v_and_b32 v235, 0xffff0000, v164
    v_pk_fma_f32 v[202:203], v[148:149], v[234:235], v[202:203]
    v_lshlrev_b32 v234, 16, v159
    v_and_b32 v235, 0xffff0000, v159
    s_waitcnt vmcnt(35)
    v_pk_fma_f32 v[198:199], v[128:129], v[36:37], v[198:199]
    v_pk_fma_f32 v[198:199], v[130:131], v[38:39], v[198:199]
    ds_add_u32 v224, v243 offset:3328
    buffer_load_dwordx4 v[36:39], v1, s[24:27], s71 offen offset:512 nt
    v_add_f32 v228, v198, v199
    v_pk_mul_f32 v[150:151], v[234:235], v[114:115]
    v_lshlrev_b32 v234, 16, v165
    v_and_b32 v235, 0xffff0000, v165
    v_pk_fma_f32 v[202:203], v[150:151], v[234:235], v[202:203]
    v_lshlrev_b32 v234, 16, v160
    s_waitcnt vmcnt(35)
    v_pk_fma_f32 v[198:199], v[120:121], v[40:41], v[200:201]
    v_pk_fma_f32 v[198:199], v[122:123], v[42:43], v[198:199]
    s_add_u32 s71, s71, 3072
    s_cbranch_vccnz L_th33_0
L_tb33_0:
    buffer_load_dwordx4 v[40:43], v1, s[24:27], s71 offen offset:0 nt
    v_add_f32_dpp v229, v228, v228 row_ror:8 row_mask:0xf bank_mask:0x3
    v_and_b32 v235, 0xffff0000, v160
    v_pk_mul_f32 v[152:153], v[234:235], v[116:117]
    v_lshlrev_b32 v234, 16, v166
    v_and_b32 v235, 0xffff0000, v166
    v_pk_fma_f32 v[202:203], v[152:153], v[234:235], v[202:203]
    s_waitcnt vmcnt(35)
    v_pk_fma_f32 v[198:199], v[124:125], v[44:45], v[198:199]
    v_pk_fma_f32 v[198:199], v[126:127], v[46:47], v[198:199]
    buffer_load_dwordx4 v[44:47], v1, s[24:27], s71 offen offset:256 nt
    v_lshlrev_b32 v234, 16, v161
    v_and_b32 v235, 0xffff0000, v161
    v_pk_mul_f32 v[154:155], v[234:235], v[118:119]
    v_lshlrev_b32 v234, 16, v167
    v_and_b32 v235, 0xffff0000, v167
    s_waitcnt vmcnt(35)
    v_pk_fma_f32 v[198:199], v[128:129], v[48:49], v[198:199]
    v_pk_fma_f32 v[198:199], v[130:131], v[50:51], v[198:199]
    ds_add_u32 v224, v243 offset:3328
    buffer_load_dwordx4 v[48:51], v1, s[24:27], s71 offen offset:512 nt
    v_add_f32 v228, v198, v199
    v_pk_fma_f32 v[202:203], v[154:155], v[234:235], v[202:203]
    v_pk_mul_f32 v[202:203], v[202:203], s[62:63]
    s_waitcnt vmcnt(35)
    v_pk_fma_f32 v[198:199], v[144:145], v[52:53], v[202:203]
    v_pk_fma_f32 v[198:199], v[146:147], v[54:55], v[198:199]
    ds_read_b32 v244, v243 offset:147
    v_readlane_b32 s70, v245, s91
    s_add_u32 s91, s91, 1
    s_lshr_b32 s74, s70, 9
    s_mul_i32 s74, s74, 384
    buffer_load_dwordx2 v[192:193], v2, s[48:51], s74 offen offset:0
    buffer_load_dwordx2 v[194:195], v2, s[48:51], s74 offen offset:128
    buffer_load_dwordx2 v[196:197], v2, s[48:51], s74 offen offset:256
    s_add_u32 s71, s71, 384000
    s_cbranch_vccnz L_th36_0
L_tb36_0:
    buffer_load_dwordx4 v[52:55], v1, s[24:27], s71 offen offset:0 nt
    v_add_f32_dpp v229, v228, v228 row_ror:8 row_mask:0xf bank_mask:0xc
    s_waitcnt vmcnt(38)
    v_pk_fma_f32 v[198:199], v[148:149], v[56:57], v[198:199]
    v_pk_fma_f32 v[198:199], v[150:151], v[58:59], v[198:199]
    buffer_load_dwordx4 v[56:59], v1, s[24:27], s71 offen offset:256 nt
    v_add_f32_dpp v230, v229, v229 row_shr:4 row_mask:0xf bank_mask:0xa
    s_waitcnt vmcnt(38)
    v_pk_fma_f32 v[198:199], v[152:153], v[60:61], v[198:199]
    v_pk_fma_f32 v[198:199], v[154:155], v[62:63], v[198:199]
    s_waitcnt lgkmcnt(0)
    v_cmp_lt_u32 vcc, v0, v244
    ds_add_u32 v224, v243 offset:3328
    buffer_load_dwordx4 v[60:63], v1, s[24:27], s71 offen offset:512 nt
    v_add_f32_dpp v231, v230, v230 quad_perm:[2,3,0,1] row_mask:0xf bank_mask:0xf
    v_add_f32 v228, v198, v199
    s_waitcnt vmcnt(38)
    v_pk_fma_f32 v[198:199], v[144:145], v[64:65], v[202:203]
    v_pk_fma_f32 v[198:199], v[146:147], v[66:67], v[198:199]
    s_add_u32 s71, s71, 3072
    s_cbranch_vccnz L_th39_0
L_tb39_0:
    buffer_load_dwordx4 v[64:67], v1, s[24:27], s71 offen offset:0 nt
    v_add_f32_dpp v229, v228, v228 row_ror:8 row_mask:0xf bank_mask:0x3
    s_waitcnt vmcnt(32)
    v_pk_fma_f32 v[198:199], v[148:149], v[68:69], v[198:199]
    v_pk_fma_f32 v[198:199], v[150:151], v[70:71], v[198:199]
    s_and_b32 s80, s70, 31
    s_sub_u32 s72, s70, s80
    s_lshr_b32 s80, s80, 2
    s_add_u32 s72, s72, s80
    s_mul_i32 s72, s72, 384
    buffer_load_dwordx2 v[132:133], v2, s[32:35], s72 offen offset:0
    buffer_load_dwordx2 v[134:135], v2, s[32:35], s72 offen offset:128
    buffer_load_dwordx2 v[136:137], v2, s[32:35], s72 offen offset:256
    buffer_load_dwordx2 v[138:139], v2, s[36:39], s72 offen offset:0
    buffer_load_dwordx2 v[140:141], v2, s[36:39], s72 offen offset:128
    buffer_load_dwordx2 v[142:143], v2, s[36:39], s72 offen offset:256
    buffer_load_dwordx4 v[68:71], v1, s[24:27], s71 offen offset:256 nt
    v_lshlrev_b32 v234, 16, v168
    v_and_b32 v235, 0xffff0000, v168
    v_pk_mul_f32 v[120:121], v[234:235], v[108:109]
    v_lshlrev_b32 v234, 16, v174
    v_and_b32 v235, 0xffff0000, v174
    s_waitcnt vmcnt(38)
    v_pk_fma_f32 v[198:199], v[152:153], v[72:73], v[198:199]
    v_pk_fma_f32 v[198:199], v[154:155], v[74:75], v[198:199]
    ds_add_u32 v224, v243 offset:3328
    buffer_load_dwordx4 v[72:75], v1, s[24:27], s71 offen offset:512 nt
    v_add_f32 v228, v198, v199
    v_pk_mul_f32 v[200:201], v[120:121], v[234:235]
    v_lshlrev_b32 v234, 16, v169
    v_and_b32 v235, 0xffff0000, v169
    v_pk_mul_f32 v[122:123], v[234:235], v[110:111]
    v_lshlrev_b32 v234, 16, v175
    s_waitcnt vmcnt(38)
    v_pk_fma_f32 v[198:199], v[144:145], v[76:77], v[202:203]
    v_pk_fma_f32 v[198:199], v[146:147], v[78:79], v[198:199]
    s_add_u32 s71, s71, 3072
    s_cbranch_vccnz L_th42_0
L_tb42_0:
    buffer_load_dwordx4 v[76:79], v1, s[24:27], s71 offen offset:0 nt
    v_add_f32_dpp v229, v228, v228 row_ror:8 row_mask:0xf bank_mask:0xc
    v_and_b32 v235, 0xffff0000, v175
    v_pk_fma_f32 v[200:201], v[122:123], v[234:235], v[200:201]
    v_lshlrev_b32 v234, 16, v170
    v_and_b32 v235, 0xffff0000, v170
    v_pk_mul_f32 v[124:125], v[234:235], v[112:113]
    s_waitcnt vmcnt(38)
    v_pk_fma_f32 v[198:199], v[148:149], v[80:81], v[198:199]
    v_pk_fma_f32 v[198:199], v[150:151], v[82:83], v[198:199]
    buffer_load_dwordx4 v[80:83], v1, s[24:27], s71 offen offset:256 nt
    v_add_f32_dpp v230, v229, v229 row_shl:4 row_mask:0xf bank_mask:0x5
    v_lshlrev_b32 v234, 16, v176
    v_and_b32 v235, 0xffff0000, v176
    v_pk_fma_f32 v[200:201], v[124:125], v[234:235], v[200:201]
    v_lshlrev_b32 v234, 16, v171
    v_and_b32 v235, 0xffff0000, v171
    s_waitcnt vmcnt(38)
    v_pk_fma_f32 v[198:199], v[152:153], v[84:85], v[198:199]
    v_pk_fma_f32 v[198:199], v[154:155], v[86:87], v[198:199]
    ds_add_u32 v224, v243 offset:3328
    buffer_load_dwordx4 v[84:87], v1, s[24:27], s71 offen offset:512 nt
    v_add_f32 v228, v198, v199
    v_pk_mul_f32 v[126:127], v[234:235], v[114:115]
    v_lshlrev_b32 v234, 16, v177
    v_and_b32 v235, 0xffff0000, v177
    v_pk_fma_f32 v[200:201], v[126:127], v[234:235], v[200:201]
    v_lshlrev_b32 v234, 16, v172
    s_waitcnt vmcnt(38)
    v_pk_fma_f32 v[198:199], v[144:145], v[88:89], v[202:203]
    v_pk_fma_f32 v[198:199], v[146:147], v[90:91], v[198:199]
    s_add_u32 s71, s71, 3072
    s_cbranch_vccnz L_th45_0
L_tb45_0:
    buffer_load_dwordx4 v[88:91], v1, s[24:27], s71 offen offset:0 nt
    v_add_f32_dpp v229, v228, v228 row_ror:8 row_mask:0xf bank_mask:0x3
    v_and_b32 v235, 0xffff0000, v172
    v_pk_mul_f32 v[128:129], v[234:235], v[116:117]
    v_lshlrev_b32 v234, 16, v178
    v_and_b32 v235, 0xffff0000, v178
    v_pk_fma_f32 v[200:201], v[128:129], v[234:235], v[200:201]
    s_waitcnt vmcnt(38)
    v_pk_fma_f32 v[198:199], v[148:149], v[92:93], v[198:199]
    v_pk_fma_f32 v[198:199], v[150:151], v[94:95], v[198:199]
    buffer_load_dwordx4 v[92:95], v1, s[24:27], s71 offen offset:256 nt
    v_lshlrev_b32 v234, 16, v173
    v_and_b32 v235, 0xffff0000, v173
    v_pk_mul_f32 v[130:131], v[234:235], v[118:119]
    v_lshlrev_b32 v234, 16, v179
    v_and_b32 v235, 0xffff0000, v179
    s_waitcnt vmcnt(38)
    v_pk_fma_f32 v[198:199], v[152:153], v[96:97], v[198:199]
    v_pk_fma_f32 v[198:199], v[154:155], v[98:99], v[198:199]
    ds_add_u32 v224, v243 offset:3328
    buffer_load_dwordx4 v[96:99], v1, s[24:27], s71 offen offset:512 nt
    v_add_f32 v228, v198, v199
    v_pk_fma_f32 v[200:201], v[130:131], v[234:235], v[200:201]
    v_pk_mul_f32 v[200:201], v[200:201], s[62:63]
    s_waitcnt vmcnt(38)
    v_pk_fma_f32 v[198:199], v[120:121], v[4:5], v[200:201]
    v_pk_fma_f32 v[198:199], v[122:123], v[6:7], v[198:199]
    ds_read_b32 v244, v243 offset:147
    s_mul_i32 s71, s70, 49152
    s_and_b32 s80, s70, 31
    s_mul_i32 s80, s80, 36864
    s_sub_u32 s71, s71, s80
    s_cbranch_vccnz L_th0_0
L_tb0_0:
    buffer_load_dwordx4 v[4:7], v1, s[24:27], s71 offen offset:0 nt
    v_add_f32_dpp v229, v228, v228 row_ror:8 row_mask:0xf bank_mask:0xc
    s_waitcnt vmcnt(38)
    v_pk_fma_f32 v[198:199], v[124:125], v[8:9], v[198:199]
    v_pk_fma_f32 v[198:199], v[126:127], v[10:11], v[198:199]
    buffer_load_dwordx4 v[8:11], v1, s[24:27], s71 offen offset:256 nt
    v_add_f32_dpp v230, v229, v229 row_shr:4 row_mask:0xf bank_mask:0xa
    s_waitcnt vmcnt(38)
    v_pk_fma_f32 v[198:199], v[128:129], v[12:13], v[198:199]
    v_pk_fma_f32 v[198:199], v[130:131], v[14:15], v[198:199]
    s_waitcnt lgkmcnt(0)
    v_cmp_lt_u32 vcc, v0, v244
    ds_add_u32 v224, v243 offset:3328
    buffer_load_dwordx4 v[12:15], v1, s[24:27], s71 offen offset:512 nt
    v_add_f32_dpp v232, v230, v230 quad_perm:[2,3,0,1] row_mask:0xf bank_mask:0xf
    v_add_f32 v228, v198, v199
    s_waitcnt vmcnt(38)
    v_pk_fma_f32 v[198:199], v[120:121], v[16:17], v[200:201]
    v_pk_fma_f32 v[198:199], v[122:123], v[18:19], v[198:199]
    s_add_u32 s71, s71, 3072
    s_cbranch_vccnz L_th3_0
L_tb3_0:
    buffer_load_dwordx4 v[16:19], v1, s[24:27], s71 offen offset:0 nt
    v_cndmask_b32 v232, v231, v232, s[64:65]
    v_add_f32_dpp v229, v228, v228 row_ror:8 row_mask:0xf bank_mask:0x3
    s_waitcnt vmcnt(32)
    v_pk_fma_f32 v[198:199], v[124:125], v[20:21], v[198:199]
    v_pk_fma_f32 v[198:199], v[126:127], v[22:23], v[198:199]
    s_add_u32 s72, s72, 3072
    buffer_load_dwordx2 v[156:157], v2, s[32:35], s72 offen offset:0
    buffer_load_dwordx2 v[158:159], v2, s[32:35], s72 offen offset:128
    buffer_load_dwordx2 v[160:161], v2, s[32:35], s72 offen offset:256
    buffer_load_dwordx2 v[162:163], v2, s[36:39], s72 offen offset:0
    buffer_load_dwordx2 v[164:165], v2, s[36:39], s72 offen offset:128
    buffer_load_dwordx2 v[166:167], v2, s[36:39], s72 offen offset:256
    buffer_load_dwordx4 v[20:23], v1, s[24:27], s71 offen offset:256 nt
    v_add_f32_dpp v233, v232, v232 quad_perm:[1,0,3,2] row_mask:0xf bank_mask:0xf
    v_lshlrev_b32 v234, 16, v180
    v_and_b32 v235, 0xffff0000, v180
    v_pk_mul_f32 v[144:145], v[234:235], v[108:109]
    v_lshlrev_b32 v234, 16, v186
    v_and_b32 v235, 0xffff0000, v186
    s_waitcnt vmcnt(38)
    v_pk_fma_f32 v[198:199], v[128:129], v[24:25], v[198:199]
    v_pk_fma_f32 v[198:199], v[130:131], v[26:27], v[198:199]
    ds_add_u32 v224, v243 offset:3328
    buffer_load_dwordx4 v[24:27], v1, s[24:27], s71 offen offset:512 nt
    v_add_f32 v228, v198, v199
    v_pk_mul_f32 v[202:203], v[144:145], v[234:235]
    s_branch L_x0
L_w0:
    s_branch L_w1
L_x0:
    v_lshlrev_b32 v234, 16, v181
    v_and_b32 v235, 0xffff0000, v181
    v_pk_mul_f32 v[146:147], v[234:235], v[110:111]
    v_lshlrev_b32 v234, 16, v187
    s_waitcnt vmcnt(38)
    v_pk_fma_f32 v[198:199], v[120:121], v[28:29], v[200:201]
    v_pk_fma_f32 v[198:199], v[122:123], v[30:31], v[198:199]
    s_add_u32 s71, s71, 3072
    s_cbranch_vccnz L_th6_0
L_tb6_0:
    buffer_load_dwordx4 v[28:31], v1, s[24:27], s71 offen offset:0 nt
    v_add_f32_dpp v229, v228, v228 row_ror:8 row_mask:0xf bank_mask:0xc
    v_and_b32 v235, 0xffff0000, v187
    v_pk_fma_f32 v[202:203], v[146:147], v[234:235], v[202:203]
    v_lshlrev_b32 v234, 16, v182
    v_and_b32 v235, 0xffff0000, v182
    v_pk_mul_f32 v[148:149], v[234:235], v[112:113]
    s_waitcnt vmcnt(38)
    v_pk_fma_f32 v[198:199], v[124:125], v[32:33], v[198:199]
    v_pk_fma_f32 v[198:199], v[126:127], v[34:35], v[198:199]
    buffer_load_dwordx4 v[32:35], v1, s[24:27], s71 offen offset:256 nt
    v_add_f32_dpp v230, v229, v229 row_shl:4 row_mask:0xf bank_mask:0x5
    v_lshlrev_b32 v234, 16, v188
    v_and_b32 v235, 0xffff0000, v188
    v_pk_fma_f32 v[202:203], v[148:149], v[234:235], v[202:203]
    v_lshlrev_b32 v234, 16, v183
    v_and_b32 v235, 0xffff0000, v183
    s_waitcnt vmcnt(38)
    v_pk_fma_f32 v[198:199], v[128:129], v[36:37], v[198:199]
    v_pk_fma_f32 v[198:199], v[130:131], v[38:39], v[198:199]
    ds_add_u32 v224, v243 offset:3328
    buffer_load_dwordx4 v[36:39], v1, s[24:27], s71 offen offset:512 nt
    v_add_f32 v228, v198, v199
    v_pk_mul_f32 v[150:151], v[234:235], v[114:115]
    v_lshlrev_b32 v234, 16, v189
    v_and_b32 v235, 0xffff0000, v189
    v_pk_fma_f32 v[202:203], v[150:151], v[234:235], v[202:203]
    v_lshlrev_b32 v234, 16, v184
    s_waitcnt vmcnt(38)
    v_pk_fma_f32 v[198:199], v[120:121], v[40:41], v[200:201]
    v_pk_fma_f32 v[198:199], v[122:123], v[42:43], v[198:199]
    s_add_u32 s71, s71, 3072
    s_cbranch_vccnz L_th9_0
L_tb9_0:
    buffer_load_dwordx4 v[40:43], v1, s[24:27], s71 offen offset:0 nt
    v_add_f32_dpp v229, v228, v228 row_ror:8 row_mask:0xf bank_mask:0x3
    v_and_b32 v235, 0xffff0000, v184
    v_pk_mul_f32 v[152:153], v[234:235], v[116:117]
    v_lshlrev_b32 v234, 16, v190
    v_and_b32 v235, 0xffff0000, v190
    v_pk_fma_f32 v[202:203], v[152:153], v[234:235], v[202:203]
    s_waitcnt vmcnt(38)
    v_pk_fma_f32 v[198:199], v[124:125], v[44:45], v[198:199]
    v_pk_fma_f32 v[198:199], v[126:127], v[46:47], v[198:199]
    buffer_load_dwordx4 v[44:47], v1, s[24:27], s71 offen offset:256 nt
    v_lshlrev_b32 v234, 16, v185
    v_and_b32 v235, 0xffff0000, v185
    v_pk_mul_f32 v[154:155], v[234:235], v[118:119]
    v_lshlrev_b32 v234, 16, v191
    v_and_b32 v235, 0xffff0000, v191
    s_waitcnt vmcnt(38)
    v_pk_fma_f32 v[198:199], v[128:129], v[48:49], v[198:199]
    v_pk_fma_f32 v[198:199], v[130:131], v[50:51], v[198:199]
    ds_add_u32 v224, v243 offset:3328
    buffer_load_dwordx4 v[48:51], v1, s[24:27], s71 offen offset:512 nt
    v_add_f32 v228, v198, v199
    v_pk_fma_f32 v[202:203], v[154:155], v[234:235], v[202:203]
    v_pk_mul_f32 v[202:203], v[202:203], s[62:63]
    s_waitcnt vmcnt(35)
    v_pk_fma_f32 v[198:199], v[144:145], v[52:53], v[202:203]
    v_pk_fma_f32 v[198:199], v[146:147], v[54:55], v[198:199]
    ds_read_b32 v244, v243 offset:147
    s_add_u32 s71, s71, 384000
    s_cbranch_vccnz L_th12_0
L_tb12_0:
    buffer_load_dwordx4 v[52:55], v1, s[24:27], s71 offen offset:0 nt
    v_add_f32_dpp v229, v228, v228 row_ror:8 row_mask:0xf bank_mask:0xc
    v_lshlrev_b32 v108, 16, v192
    v_and_b32 v109, 0xffff0000, v192
    v_pk_mul_f32 v[108:109], v[108:109], s[60:61]
    v_lshlrev_b32 v110, 16, v193
    v_and_b32 v111, 0xffff0000, v193
    s_waitcnt vmcnt(35)
    v_pk_fma_f32 v[198:199], v[148:149], v[56:57], v[198:199]
    v_pk_fma_f32 v[198:199], v[150:151], v[58:59], v[198:199]
    buffer_load_dwordx4 v[56:59], v1, s[24:27], s71 offen offset:256 nt
    v_add_f32_dpp v230, v229, v229 row_shr:4 row_mask:0xf bank_mask:0xa
    v_pk_mul_f32 v[110:111], v[110:111], s[60:61]
    v_lshlrev_b32 v112, 16, v194
    v_and_b32 v113, 0xffff0000, v194
    v_pk_mul_f32 v[112:113], v[112:113], s[60:61]
    v_lshlrev_b32 v114, 16, v195
    s_waitcnt vmcnt(35)
    v_pk_fma_f32 v[198:199], v[152:153], v[60:61], v[198:199]
    v_pk_fma_f32 v[198:199], v[154:155], v[62:63], v[198:199]
    s_waitcnt lgkmcnt(0)
    v_cmp_lt_u32 vcc, v0, v244
    ds_add_u32 v224, v243 offset:3328
    buffer_load_dwordx4 v[60:63], v1, s[24:27], s71 offen offset:512 nt
    v_add_f32_dpp v231, v230, v230 quad_perm:[2,3,0,1] row_mask:0xf bank_mask:0xf
    v_add_f32 v228, v198, v199
    v_and_b32 v115, 0xffff0000, v195
    v_pk_mul_f32 v[114:115], v[114:115], s[60:61]
    v_lshlrev_b32 v116, 16, v196
    v_and_b32 v117, 0xffff0000, v196
    v_pk_mul_f32 v[116:117], v[116:117], s[60:61]
    s_waitcnt vmcnt(35)
    v_pk_fma_f32 v[198:199], v[144:145], v[64:65], v[202:203]
    v_pk_fma_f32 v[198:199], v[146:147], v[66:67], v[198:199]
    s_add_u32 s71, s71, 3072
    s_cbranch_vccnz L_th15_0
L_tb15_0:
    buffer_load_dwordx4 v[64:67], v1, s[24:27], s71 offen offset:0 nt
    v_add_f32_dpp v229, v228, v228 row_ror:8 row_mask:0xf bank_mask:0x3
    v_lshlrev_b32 v118, 16, v197
    v_and_b32 v119, 0xffff0000, v197
    v_pk_mul_f32 v[118:119], v[118:119], s[60:61]
    s_waitcnt vmcnt(29)
    v_pk_fma_f32 v[198:199], v[148:149], v[68:69], v[198:199]
    v_pk_fma_f32 v[198:199], v[150:151], v[70:71], v[198:199]
    s_add_u32 s72, s72, 3072
    buffer_load_dwordx2 v[168:169], v2, s[32:35], s72 offen offset:0
    buffer_load_dwordx2 v[170:171], v2, s[32:35], s72 offen offset:128
    buffer_load_dwordx2 v[172:173], v2, s[32:35], s72 offen offset:256
    buffer_load_dwordx2 v[174:175], v2, s[36:39], s72 offen offset:0
    buffer_load_dwordx2 v[176:177], v2, s[36:39], s72 offen offset:128
    buffer_load_dwordx2 v[178:179], v2, s[36:39], s72 offen offset:256
    buffer_load_dwordx4 v[68:71], v1, s[24:27], s71 offen offset:256 nt
    v_lshlrev_b32 v234, 16, v132
    v_and_b32 v235, 0xffff0000, v132
    v_pk_mul_f32 v[120:121], v[234:235], v[108:109]
    v_lshlrev_b32 v234, 16, v138
    v_and_b32 v235, 0xffff0000, v138
    s_waitcnt vmcnt(35)
    v_pk_fma_f32 v[198:199], v[152:153], v[72:73], v[198:199]
    v_pk_fma_f32 v[198:199], v[154:155], v[74:75], v[198:199]
    ds_add_u32 v224, v243 offset:3328
    buffer_load_dwordx4 v[72:75], v1, s[24:27], s71 offen offset:512 nt
    v_add_f32 v228, v198, v199
    v_pk_mul_f32 v[200:201], v[120:121], v[234:235]
    v_lshlrev_b32 v234, 16, v133
    v_and_b32 v235, 0xffff0000, v133
    v_pk_mul_f32 v[122:123], v[234:235], v[110:111]
    v_lshlrev_b32 v234, 16, v139
    s_waitcnt vmcnt(35)
    v_pk_fma_f32 v[198:199], v[144:145], v[76:77], v[202:203]
    v_pk_fma_f32 v[198:199], v[146:147], v[78:79], v[198:199]
    s_add_u32 s71, s71, 3072
    s_cbranch_vccnz L_th18_0
L_tb18_0:
    buffer_load_dwordx4 v[76:79], v1, s[24:27], s71 offen offset:0 nt
    v_add_f32_dpp v229, v228, v228 row_ror:8 row_mask:0xf bank_mask:0xc
    v_and_b32 v235, 0xffff0000, v139
    v_pk_fma_f32 v[200:201], v[122:123], v[234:235], v[200:201]
    v_lshlrev_b32 v234, 16, v134
    v_and_b32 v235, 0xffff0000, v134
    v_pk_mul_f32 v[124:125], v[234:235], v[112:113]
    s_waitcnt vmcnt(35)
    v_pk_fma_f32 v[198:199], v[148:149], v[80:81], v[198:199]
    v_pk_fma_f32 v[198:199], v[150:151], v[82:83], v[198:199]
    buffer_load_dwordx4 v[80:83], v1, s[24:27], s71 offen offset:256 nt
    v_add_f32_dpp v230, v229, v229 row_shl:4 row_mask:0xf bank_mask:0x5
    v_lshlrev_b32 v234, 16, v140
    v_and_b32 v235, 0xffff0000, v140
    v_pk_fma_f32 v[200:201], v[124:125], v[234:235], v[200:201]
    v_lshlrev_b32 v234, 16, v135
    v_and_b32 v235, 0xffff0000, v135
    s_waitcnt vmcnt(35)
    v_pk_fma_f32 v[198:199], v[152:153], v[84:85], v[198:199]
    v_pk_fma_f32 v[198:199], v[154:155], v[86:87], v[198:199]
    ds_add_u32 v224, v243 offset:3328
    buffer_load_dwordx4 v[84:87], v1, s[24:27], s71 offen offset:512 nt
    v_add_f32 v228, v198, v199
    v_pk_mul_f32 v[126:127], v[234:235], v[114:115]
    v_lshlrev_b32 v234, 16, v141
    v_and_b32 v235, 0xffff0000, v141
    v_pk_fma_f32 v[200:201], v[126:127], v[234:235], v[200:201]
    v_lshlrev_b32 v234, 16, v136
    s_waitcnt vmcnt(35)
    v_pk_fma_f32 v[198:199], v[144:145], v[88:89], v[202:203]
    v_pk_fma_f32 v[198:199], v[146:147], v[90:91], v[198:199]
    s_add_u32 s71, s71, 3072
    s_cbranch_vccnz L_th21_0
L_tb21_0:
    buffer_load_dwordx4 v[88:91], v1, s[24:27], s71 offen offset:0 nt
    v_add_f32_dpp v229, v228, v228 row_ror:8 row_mask:0xf bank_mask:0x3
    v_and_b32 v235, 0xffff0000, v136
    v_pk_mul_f32 v[128:129], v[234:235], v[116:117]
    v_lshlrev_b32 v234, 16, v142
    v_and_b32 v235, 0xffff0000, v142
    v_pk_fma_f32 v[200:201], v[128:129], v[234:235], v[200:201]
    s_waitcnt vmcnt(35)
    v_pk_fma_f32 v[198:199], v[148:149], v[92:93], v[198:199]
    v_pk_fma_f32 v[198:199], v[150:151], v[94:95], v[198:199]
    buffer_load_dwordx4 v[92:95], v1, s[24:27], s71 offen offset:256 nt
    v_lshlrev_b32 v234, 16, v137
    v_and_b32 v235, 0xffff0000, v137
    v_pk_mul_f32 v[130:131], v[234:235], v[118:119]
    v_lshlrev_b32 v234, 16, v143
    v_and_b32 v235, 0xffff0000, v143
    s_waitcnt vmcnt(35)
    v_pk_fma_f32 v[198:199], v[152:153], v[96:97], v[198:199]
    v_pk_fma_f32 v[198:199], v[154:155], v[98:99], v[198:199]
    ds_add_u32 v224, v243 offset:3328
    buffer_load_dwordx4 v[96:99], v1, s[24:27], s71 offen offset:512 nt
    v_add_f32 v228, v198, v199
    v_pk_fma_f32 v[200:201], v[130:131], v[234:235], v[200:201]
    v_pk_mul_f32 v[200:201], v[200:201], s[62:63]
    s_sub_u32 s76, s76, 1
    s_cmp_lg_u32 s76, 0
    s_cbranch_scc1 L_loop0
L_h0:
    s_cbranch_execz L_h1
    s_waitcnt vmcnt(35)
    v_pk_fma_f32 v[198:199], v[120:121], v[4:5], v[200:201]
L_h1:
    s_cbranch_execz L_h2
    v_pk_fma_f32 v[198:199], v[122:123], v[6:7], v[198:199]
    ds_read_b32 v244, v243 offset:147
    s_add_u32 s71, s71, 384000
    s_cbranch_vccnz L_th24_1
L_tb24_1:
    buffer_load_dwordx4 v[4:7], v1, s[24:27], s71 offen offset:0 nt
    v_add_f32_dpp v229, v228, v228 row_ror:8 row_mask:0xf bank_mask:0xc
    s_waitcnt vmcnt(35)
    v_pk_fma_f32 v[198:199], v[124:125], v[8:9], v[198:199]
    v_pk_fma_f32 v[198:199], v[126:127], v[10:11], v[198:199]
    buffer_load_dwordx4 v[8:11], v1, s[24:27], s71 offen offset:256 nt
    v_add_f32_dpp v230, v229, v229 row_shr:4 row_mask:0xf bank_mask:0xa
    s_waitcnt vmcnt(35)
    v_pk_fma_f32 v[198:199], v[128:129], v[12:13], v[198:199]
    v_pk_fma_f32 v[198:199], v[130:131], v[14:15], v[198:199]
    s_waitcnt lgkmcnt(0)
    v_cmp_lt_u32 vcc, v0, v244
    ds_add_u32 v224, v243 offset:3328
    buffer_load_dwordx4 v[12:15], v1, s[24:27], s71 offen offset:512 nt
L_h2:
    s_cbranch_execz L_h3
    v_add_f32_dpp v232, v230, v230 quad_perm:[2,3,0,1] row_mask:0xf bank_mask:0xf
    v_add_f32 v228, v198, v199
    s_waitcnt vmcnt(35)
    v_pk_fma_f32 v[198:199], v[120:121], v[16:17], v[200:201]
    v_pk_fma_f32 v[198:199], v[122:123], v[18:19], v[198:199]
    s_add_u32 s71, s71, 3072
    s_cbranch_vccnz L_th27_1
L_tb27_1:
    buffer_load_dwordx4 v[16:19], v1, s[24:27], s71 offen offset:0 nt
    v_cndmask_b32 v232, v231, v232, s[64:65]
    v_add_f32_dpp v229, v228, v228 row_ror:8 row_mask:0xf bank_mask:0x3
    s_waitcnt vmcnt(29)
    v_pk_fma_f32 v[198:199], v[124:125], v[20:21], v[198:199]
    v_pk_fma_f32 v[198:199], v[126:127], v[22:23], v[198:199]
    s_add_u32 s72, s72, 3072
    buffer_load_dwordx2 v[180:181], v2, s[32:35], s72 offen offset:0
    buffer_load_dwordx2 v[182:183], v2, s[32:35], s72 offen offset:128
    buffer_load_dwordx2 v[184:185], v2, s[32:35], s72 offen offset:256
    buffer_load_dwordx2 v[186:187], v2, s[36:39], s72 offen offset:0
L_h3:
    s_cbranch_execz L_h4
    buffer_load_dwordx2 v[188:189], v2, s[36:39], s72 offen offset:128
    buffer_load_dwordx2 v[190:191], v2, s[36:39], s72 offen offset:256
    buffer_load_dwordx4 v[20:23], v1, s[24:27], s71 offen offset:256 nt
    v_add_f32_dpp v231, v232, v232 quad_perm:[1,0,3,2] row_mask:0xf bank_mask:0xf
    v_lshlrev_b32 v234, 16, v156
    v_and_b32 v235, 0xffff0000, v156
    v_pk_mul_f32 v[144:145], v[234:235], v[108:109]
    v_lshlrev_b32 v234, 16, v162
    v_and_b32 v235, 0xffff0000, v162
    s_waitcnt vmcnt(35)
    v_pk_fma_f32 v[198:199], v[128:129], v[24:25], v[198:199]
    v_pk_fma_f32 v[198:199], v[130:131], v[26:27], v[198:199]
    ds_add_u32 v224, v243 offset:3328
    buffer_load_dwordx4 v[24:27], v1, s[24:27], s71 offen offset:512 nt
    v_cndmask_b32 v233, v233, v231, s[66:67]
    v_mul_f32 v233, 0x58000000, v233
    ds_write_b32 v239, v233
L_h4:
    s_cbranch_execz L_h5
    v_add_u32 v239, 256, v239
    v_add_f32 v228, v198, v199
    v_pk_mul_f32 v[202:203], v[144:145], v[234:235]
    v_lshlrev_b32 v234, 16, v157
    v_and_b32 v235, 0xffff0000, v157
    v_pk_mul_f32 v[146:147], v[234:235], v[110:111]
    v_lshlrev_b32 v234, 16, v163
    s_waitcnt vmcnt(35)
    v_pk_fma_f32 v[198:199], v[120:121], v[28:29], v[200:201]
    v_pk_fma_f32 v[198:199], v[122:123], v[30:31], v[198:199]
    s_add_u32 s71, s71, 3072
    s_cbranch_vccnz L_th30_1
L_tb30_1:
    buffer_load_dwordx4 v[28:31], v1, s[24:27], s71 offen offset:0 nt
    v_add_f32_dpp v229, v228, v228 row_ror:8 row_mask:0xf bank_mask:0xc
    v_and_b32 v235, 0xffff0000, v163
    v_pk_fma_f32 v[202:203], v[146:147], v[234:235], v[202:203]
    v_lshlrev_b32 v234, 16, v158
    v_and_b32 v235, 0xffff0000, v158
L_h5:
    s_cbranch_execz L_h6
    v_pk_mul_f32 v[148:149], v[234:235], v[112:113]
    s_waitcnt vmcnt(35)
    v_pk_fma_f32 v[198:199], v[124:125], v[32:33], v[198:199]
    v_pk_fma_f32 v[198:199], v[126:127], v[34:35], v[198:199]
    buffer_load_dwordx4 v[32:35], v1, s[24:27], s71 offen offset:256 nt
    v_add_f32_dpp v230, v229, v229 row_shl:4 row_mask:0xf bank_mask:0x5
    v_lshlrev_b32 v234, 16, v164
    v_and_b32 v235, 0xffff0000, v164
    v_pk_fma_f32 v[202:203], v[148:149], v[234:235], v[202:203]
    v_lshlrev_b32 v234, 16, v159
    v_and_b32 v235, 0xffff0000, v159
    s_waitcnt vmcnt(35)
    v_pk_fma_f32 v[198:199], v[128:129], v[36:37], v[198:199]
    v_pk_fma_f32 v[198:199], v[130:131], v[38:39], v[198:199]
    ds_add_u32 v224, v243 offset:3328
    buffer_load_dwordx4 v[36:39], v1, s[24:27], s71 offen offset:512 nt
    v_add_f32 v228, v198, v199
    v_pk_mul_f32 v[150:151], v[234:235], v[114:115]
L_h6:
    s_cbranch_execz L_h7
    v_lshlrev_b32 v234, 16, v165
    v_and_b32 v235, 0xffff0000, v165
    v_pk_fma_f32 v[202:203], v[150:151], v[234:235], v[202:203]
    v_lshlrev_b32 v234, 16, v160
    s_waitcnt vmcnt(35)
    v_pk_fma_f32 v[198:199], v[120:121], v[40:41], v[200:201]
    v_pk_fma_f32 v[198:199], v[122:123], v[42:43], v[198:199]
    s_add_u32 s71, s71, 3072
    s_cbranch_vccnz L_th33_1
L_tb33_1:
    buffer_load_dwordx4 v[40:43], v1, s[24:27], s71 offen offset:0 nt
    v_add_f32_dpp v229, v228, v228 row_ror:8 row_mask:0xf bank_mask:0x3
    v_and_b32 v235, 0xffff0000, v160
    v_pk_mul_f32 v[152:153], v[234:235], v[116:117]
    v_lshlrev_b32 v234, 16, v166
    v_and_b32 v235, 0xffff0000, v166
    v_pk_fma_f32 v[202:203], v[152:153], v[234:235], v[202:203]
    s_waitcnt vmcnt(35)
    v_pk_fma_f32 v[198:199], v[124:125], v[44:45], v[198:199]
    v_pk_fma_f32 v[198:199], v[126:127], v[46:47], v[198:199]
L_h7:
    s_cbranch_execz L_h8
    buffer_load_dwordx4 v[44:47], v1, s[24:27], s71 offen offset:256 nt
    v_lshlrev_b32 v234, 16, v161
    v_and_b32 v235, 0xffff0000, v161
    v_pk_mul_f32 v[154:155], v[234:235], v[118:119]
    v_lshlrev_b32 v234, 16, v167
    v_and_b32 v235, 0xffff0000, v167
    s_waitcnt vmcnt(35)
    v_pk_fma_f32 v[198:199], v[128:129], v[48:49], v[198:199]
    v_pk_fma_f32 v[198:199], v[130:131], v[50:51], v[198:199]
    ds_add_u32 v224, v243 offset:3328
    buffer_load_dwordx4 v[48:51], v1, s[24:27], s71 offen offset:512 nt
    v_add_f32 v228, v198, v199
    v_pk_fma_f32 v[202:203], v[154:155], v[234:235], v[202:203]
    v_pk_mul_f32 v[202:203], v[202:203], s[62:63]
    s_waitcnt vmcnt(35)
    v_pk_fma_f32 v[198:199], v[144:145], v[52:53], v[202:203]
    v_pk_fma_f32 v[198:199], v[146:147], v[54:55], v[198:199]
    ds_read_b32 v244, v243 offset:147
L_h8:
    s_cbranch_execz L_h9
    s_mov_b32 s91, 0
    v_readlane_b32 s70, v245, s91
    s_add_u32 s91, s91, 1
    s_and_b32 s80, s70, 31
    s_mul_i32 s80, s80, 96
    s_lshl_b32 s73, s70, 7
    s_sub_u32 s73, s73, s80
    buffer_load_ushort v220, v3, s[40:43], s73 offen
    buffer_load_ushort v221, v3, s[44:47], s73 offen
    s_add_u32 s71, s71, 384000
    s_cbranch_vccnz L_th36_1
L_tb36_1:
    buffer_load_dwordx4 v[52:55], v1, s[24:27], s71 offen offset:0 nt
    v_add_f32_dpp v229, v228, v228 row_ror:8 row_mask:0xf bank_mask:0xc
    s_waitcnt vmcnt(37)
    v_pk_fma_f32 v[198:199], v[148:149], v[56:57], v[198:199]
    v_pk_fma_f32 v[198:199], v[150:151], v[58:59], v[198:199]
    buffer_load_dwordx4 v[56:59], v1, s[24:27], s71 offen offset:256 nt
    v_add_f32_dpp v230, v229, v229 row_shr:4 row_mask:0xf bank_mask:0xa
    s_waitcnt vmcnt(37)
L_h9:
    s_cbranch_execz L_h10
    v_pk_fma_f32 v[198:199], v[152:153], v[60:61], v[198:199]
    v_pk_fma_f32 v[198:199], v[154:155], v[62:63], v[198:199]
    s_waitcnt lgkmcnt(0)
    v_cmp_lt_u32 vcc, v0, v244
    ds_add_u32 v224, v243 offset:3328
    buffer_load_dwordx4 v[60:63], v1, s[24:27], s71 offen offset:512 nt
    v_add_f32_dpp v231, v230, v230 quad_perm:[2,3,0,1] row_mask:0xf bank_mask:0xf
    v_add_f32 v228, v198, v199
    s_waitcnt vmcnt(37)
    v_pk_fma_f32 v[198:199], v[144:145], v[64:65], v[202:203]
    v_pk_fma_f32 v[198:199], v[146:147], v[66:67], v[198:199]
    s_add_u32 s71, s71, 3072
    s_cbranch_vccnz L_th39_1
L_tb39_1:
    buffer_load_dwordx4 v[64:67], v1, s[24:27], s71 offen offset:0 nt
    v_add_f32_dpp v229, v228, v228 row_ror:8 row_mask:0xf bank_mask:0x3
    s_waitcnt vmcnt(31)
    v_pk_fma_f32 v[198:199], v[148:149], v[68:69], v[198:199]
    v_pk_fma_f32 v[198:199], v[150:151], v[70:71], v[198:199]
    buffer_load_dwordx4 v[68:71], v1, s[24:27], s71 offen offset:256 nt
L_h10:
    s_cbranch_execz L_h11
    v_lshlrev_b32 v234, 16, v168
    v_and_b32 v235, 0xffff0000, v168
    v_pk_mul_f32 v[120:121], v[234:235], v[108:109]
    v_lshlrev_b32 v234, 16, v174
    v_and_b32 v235, 0xffff0000, v174
    s_waitcnt vmcnt(31)
    v_pk_fma_f32 v[198:199], v[152:153], v[72:73], v[198:199]
    v_pk_fma_f32 v[198:199], v[154:155], v[74:75], v[198:199]
    ds_add_u32 v224, v243 offset:3328
    buffer_load_dwordx4 v[72:75], v1, s[24:27], s71 offen offset:512 nt
    v_add_f32 v228, v198, v199
    v_pk_mul_f32 v[200:201], v[120:121], v[234:235]
    v_lshlrev_b32 v234, 16, v169
    v_and_b32 v235, 0xffff0000, v169
    v_pk_mul_f32 v[122:123], v[234:235], v[110:111]
    v_lshlrev_b32 v234, 16, v175
    s_waitcnt vmcnt(31)
    v_pk_fma_f32 v[198:199], v[144:145], v[76:77], v[202:203]
    v_pk_fma_f32 v[198:199], v[146:147], v[78:79], v[198:199]
L_h11:
    s_cbranch_execz L_h12
    s_add_u32 s71, s71, 3072
    s_cbranch_vccnz L_th42_1
L_tb42_1:
    buffer_load_dwordx4 v[76:79], v1, s[24:27], s71 offen offset:0 nt
    v_add_f32_dpp v229, v228, v228 row_ror:8 row_mask:0xf bank_mask:0xc
    v_and_b32 v235, 0xffff0000, v175
    v_pk_fma_f32 v[200:201], v[122:123], v[234:235], v[200:201]
    v_lshlrev_b32 v234, 16, v170
    v_and_b32 v235, 0xffff0000, v170
    v_pk_mul_f32 v[124:125], v[234:235], v[112:113]
    s_waitcnt vmcnt(31)
    v_pk_fma_f32 v[198:199], v[148:149], v[80:81], v[198:199]
    v_pk_fma_f32 v[198:199], v[150:151], v[82:83], v[198:199]
    buffer_load_dwordx4 v[80:83], v1, s[24:27], s71 offen offset:256 nt
    v_add_f32_dpp v230, v229, v229 row_shl:4 row_mask:0xf bank_mask:0x5
    v_lshlrev_b32 v234, 16, v176
    v_and_b32 v235, 0xffff0000, v176
    v_pk_fma_f32 v[200:201], v[124:125], v[234:235], v[200:201]
L_h12:
    s_cbranch_execz L_h13
    v_lshlrev_b32 v234, 16, v171
    v_and_b32 v235, 0xffff0000, v171
    s_waitcnt vmcnt(31)
    v_pk_fma_f32 v[198:199], v[152:153], v[84:85], v[198:199]
    v_pk_fma_f32 v[198:199], v[154:155], v[86:87], v[198:199]
    ds_add_u32 v224, v243 offset:3328
    buffer_load_dwordx4 v[84:87], v1, s[24:27], s71 offen offset:512 nt
    v_add_f32 v228, v198, v199
    v_pk_mul_f32 v[126:127], v[234:235], v[114:115]
    v_lshlrev_b32 v234, 16, v177
    v_and_b32 v235, 0xffff0000, v177
    v_pk_fma_f32 v[200:201], v[126:127], v[234:235], v[200:201]
    v_lshlrev_b32 v234, 16, v172
    s_waitcnt vmcnt(31)
    v_pk_fma_f32 v[198:199], v[144:145], v[88:89], v[202:203]
    v_pk_fma_f32 v[198:199], v[146:147], v[90:91], v[198:199]
    s_add_u32 s71, s71, 3072
    s_cbranch_vccnz L_th45_1
L_tb45_1:
    buffer_load_dwordx4 v[88:91], v1, s[24:27], s71 offen offset:0 nt
L_h13:
    s_cbranch_execz L_h14
    v_add_f32_dpp v229, v228, v228 row_ror:8 row_mask:0xf bank_mask:0x3
    v_and_b32 v235, 0xffff0000, v172
    v_pk_mul_f32 v[128:129], v[234:235], v[116:117]
    v_lshlrev_b32 v234, 16, v178
    v_and_b32 v235, 0xffff0000, v178
    v_pk_fma_f32 v[200:201], v[128:129], v[234:235], v[200:201]
    s_waitcnt vmcnt(31)
    v_pk_fma_f32 v[198:199], v[148:149], v[92:93], v[198:199]
    v_pk_fma_f32 v[198:199], v[150:151], v[94:95], v[198:199]
    buffer_load_dwordx4 v[92:95], v1, s[24:27], s71 offen offset:256 nt
    v_lshlrev_b32 v234, 16, v173
    v_and_b32 v235, 0xffff0000, v173
    v_pk_mul_f32 v[130:131], v[234:235], v[118:119]
    v_lshlrev_b32 v234, 16, v179
    v_and_b32 v235, 0xffff0000, v179
    s_waitcnt vmcnt(31)
    v_pk_fma_f32 v[198:199], v[152:153], v[96:97], v[198:199]
    v_pk_fma_f32 v[198:199], v[154:155], v[98:99], v[198:199]
L_h14:
    s_cbranch_execz L_h15
    ds_add_u32 v224, v243 offset:3328
    buffer_load_dwordx4 v[96:99], v1, s[24:27], s71 offen offset:512 nt
    v_add_f32 v228, v198, v199
    v_pk_fma_f32 v[200:201], v[130:131], v[234:235], v[200:201]
    v_pk_mul_f32 v[200:201], v[200:201], s[62:63]
    s_waitcnt vmcnt(31)
    v_pk_fma_f32 v[198:199], v[120:121], v[4:5], v[200:201]
    v_pk_fma_f32 v[198:199], v[122:123], v[6:7], v[198:199]
    ds_read_b32 v244, v243 offset:147
    s_mul_i32 s71, s70, 49152
    s_and_b32 s80, s70, 31
    s_mul_i32 s80, s80, 36864
    s_sub_u32 s71, s71, s80
    s_cbranch_vccnz L_th0_1
L_tb0_1:
    buffer_load_dwordx4 v[4:7], v1, s[28:31], s71 offen offset:0 nt
    v_add_f32_dpp v229, v228, v228 row_ror:8 row_mask:0xf bank_mask:0xc
    s_waitcnt vmcnt(31)
    v_pk_fma_f32 v[198:199], v[124:125], v[8:9], v[198:199]
    v_pk_fma_f32 v[198:199], v[126:127], v[10:11], v[198:199]
L_h15:
    s_cbranch_execz L_h16
    buffer_load_dwordx4 v[8:11], v1, s[28:31], s71 offen offset:256 nt
    v_add_f32_dpp v230, v229, v229 row_shr:4 row_mask:0xf bank_mask:0xa
    s_waitcnt vmcnt(31)
    v_pk_fma_f32 v[198:199], v[128:129], v[12:13], v[198:199]
    v_pk_fma_f32 v[198:199], v[130:131], v[14:15], v[198:199]
    s_waitcnt lgkmcnt(0)
    v_cmp_lt_u32 vcc, v0, v244
    ds_add_u32 v224, v243 offset:3328
    buffer_load_dwordx4 v[12:15], v1, s[28:31], s71 offen offset:512 nt
    v_add_f32_dpp v232, v230, v230 quad_perm:[2,3,0,1] row_mask:0xf bank_mask:0xf
    v_add_f32 v228, v198, v199
    s_waitcnt vmcnt(31)
    v_pk_fma_f32 v[198:199], v[120:121], v[16:17], v[200:201]
    v_pk_fma_f32 v[198:199], v[122:123], v[18:19], v[198:199]
    s_add_u32 s71, s71, 3072
    s_cbranch_vccnz L_th3_1
L_tb3_1:
    buffer_load_dwordx4 v[16:19], v1, s[28:31], s71 offen offset:0 nt
    v_cndmask_b32 v232, v231, v232, s[64:65]
L_h16:
    s_cbranch_execz L_h17
    v_add_f32_dpp v229, v228, v228 row_ror:8 row_mask:0xf bank_mask:0x3
    s_waitcnt vmcnt(25)
    v_pk_fma_f32 v[198:199], v[124:125], v[20:21], v[198:199]
    v_pk_fma_f32 v[198:199], v[126:127], v[22:23], v[198:199]
    buffer_load_dwordx4 v[20:23], v1, s[28:31], s71 offen offset:256 nt
    v_add_f32_dpp v233, v232, v232 quad_perm:[1,0,3,2] row_mask:0xf bank_mask:0xf
    v_lshlrev_b32 v234, 16, v180
    v_and_b32 v235, 0xffff0000, v180
    v_pk_mul_f32 v[144:145], v[234:235], v[108:109]
    v_lshlrev_b32 v234, 16, v186
    v_and_b32 v235, 0xffff0000, v186
    s_waitcnt vmcnt(25)
    v_pk_fma_f32 v[198:199], v[128:129], v[24:25], v[198:199]
    v_pk_fma_f32 v[198:199], v[130:131], v[26:27], v[198:199]
    ds_add_u32 v224, v243 offset:3328
    buffer_load_dwordx4 v[24:27], v1, s[28:31], s71 offen offset:512 nt
    v_add_f32 v228, v198, v199
    v_pk_mul_f32 v[202:203], v[144:145], v[234:235]
L_h17:
    s_cbranch_execz L_h18
    v_lshlrev_b32 v234, 16, v181
    v_and_b32 v235, 0xffff0000, v181
    v_pk_mul_f32 v[146:147], v[234:235], v[110:111]
    v_lshlrev_b32 v234, 16, v187
    s_waitcnt vmcnt(25)
    v_pk_fma_f32 v[198:199], v[120:121], v[28:29], v[200:201]
    v_pk_fma_f32 v[198:199], v[122:123], v[30:31], v[198:199]
    s_add_u32 s71, s71, 3072
    s_cbranch_vccnz L_th6_1
L_tb6_1:
    buffer_load_dwordx4 v[28:31], v1, s[28:31], s71 offen offset:0 nt
    v_add_f32_dpp v229, v228, v228 row_ror:8 row_mask:0xf bank_mask:0xc
    v_and_b32 v235, 0xffff0000, v187
    v_pk_fma_f32 v[202:203], v[146:147], v[234:235], v[202:203]
    v_lshlrev_b32 v234, 16, v182
    v_and_b32 v235, 0xffff0000, v182
    v_pk_mul_f32 v[148:149], v[234:235], v[112:113]
    s_waitcnt vmcnt(25)
    v_pk_fma_f32 v[198:199], v[124:125], v[32:33], v[198:199]
    v_pk_fma_f32 v[198:199], v[126:127], v[34:35], v[198:199]
L_h18:
    s_cbranch_execz L_h19
    buffer_load_dwordx4 v[32:35], v1, s[28:31], s71 offen offset:256 nt
    v_add_f32_dpp v230, v229, v229 row_shl:4 row_mask:0xf bank_mask:0x5
    v_lshlrev_b32 v234, 16, v188
    v_and_b32 v235, 0xffff0000, v188
    v_pk_fma_f32 v[202:203], v[148:149], v[234:235], v[202:203]
    v_lshlrev_b32 v234, 16, v183
    v_and_b32 v235, 0xffff0000, v183
    s_waitcnt vmcnt(25)
    v_pk_fma_f32 v[198:199], v[128:129], v[36:37], v[198:199]
    v_pk_fma_f32 v[198:199], v[130:131], v[38:39], v[198:199]
    ds_add_u32 v224, v243 offset:3328
    buffer_load_dwordx4 v[36:39], v1, s[28:31], s71 offen offset:512 nt
    v_add_f32 v228, v198, v199
    v_pk_mul_f32 v[150:151], v[234:235], v[114:115]
    v_lshlrev_b32 v234, 16, v189
    v_and_b32 v235, 0xffff0000, v189
    v_pk_fma_f32 v[202:203], v[150:151], v[234:235], v[202:203]
    v_lshlrev_b32 v234, 16, v184
L_h19:
    s_cbranch_execz L_h20
    s_waitcnt vmcnt(25)
    v_pk_fma_f32 v[198:199], v[120:121], v[40:41], v[200:201]
    v_pk_fma_f32 v[198:199], v[122:123], v[42:43], v[198:199]
    s_add_u32 s71, s71, 3072
    s_cbranch_vccnz L_th9_1
L_tb9_1:
    buffer_load_dwordx4 v[40:43], v1, s[28:31], s71 offen offset:0 nt
    v_add_f32_dpp v229, v228, v228 row_ror:8 row_mask:0xf bank_mask:0x3
    v_and_b32 v235, 0xffff0000, v184
    v_pk_mul_f32 v[152:153], v[234:235], v[116:117]
    v_lshlrev_b32 v234, 16, v190
    v_and_b32 v235, 0xffff0000, v190
    v_pk_fma_f32 v[202:203], v[152:153], v[234:235], v[202:203]
    s_waitcnt vmcnt(25)
    v_pk_fma_f32 v[198:199], v[124:125], v[44:45], v[198:199]
    v_pk_fma_f32 v[198:199], v[126:127], v[46:47], v[198:199]
    buffer_load_dwordx4 v[44:47], v1, s[28:31], s71 offen offset:256 nt
    v_lshlrev_b32 v234, 16, v185
    v_and_b32 v235, 0xffff0000, v185
L_h20:
    s_cbranch_execz L_h21
    v_pk_mul_f32 v[154:155], v[234:235], v[118:119]
    v_lshlrev_b32 v234, 16, v191
    v_and_b32 v235, 0xffff0000, v191
    s_waitcnt vmcnt(25)
    v_pk_fma_f32 v[198:199], v[128:129], v[48:49], v[198:199]
    v_pk_fma_f32 v[198:199], v[130:131], v[50:51], v[198:199]
    ds_add_u32 v224, v243 offset:3328
    buffer_load_dwordx4 v[48:51], v1, s[28:31], s71 offen offset:512 nt
    v_add_f32 v228, v198, v199
    v_pk_fma_f32 v[202:203], v[154:155], v[234:235], v[202:203]
    v_pk_mul_f32 v[202:203], v[202:203], s[62:63]
    s_waitcnt vmcnt(23)
    v_pk_fma_f32 v[198:199], v[144:145], v[52:53], v[202:203]
    v_pk_fma_f32 v[198:199], v[146:147], v[54:55], v[198:199]
    ds_read_b32 v244, v243 offset:147
    s_add_u32 s71, s71, 384000
    s_cbranch_vccnz L_th12_1
L_tb12_1:
    buffer_load_dwordx4 v[52:55], v1, s[28:31], s71 offen offset:0 nt
L_h21:
    s_cbranch_execz L_h22
    v_add_f32_dpp v229, v228, v228 row_ror:8 row_mask:0xf bank_mask:0xc
    s_waitcnt vmcnt(23)
    v_pk_fma_f32 v[198:199], v[148:149], v[56:57], v[198:199]
    v_pk_fma_f32 v[198:199], v[150:151], v[58:59], v[198:199]
    buffer_load_dwordx4 v[56:59], v1, s[28:31], s71 offen offset:256 nt
    v_add_f32_dpp v230, v229, v229 row_shr:4 row_mask:0xf bank_mask:0xa
    s_waitcnt vmcnt(23)
    v_pk_fma_f32 v[198:199], v[152:153], v[60:61], v[198:199]
    v_pk_fma_f32 v[198:199], v[154:155], v[62:63], v[198:199]
    s_waitcnt lgkmcnt(0)
    v_cmp_lt_u32 vcc, v0, v244
    ds_add_u32 v224, v243 offset:3328
    buffer_load_dwordx4 v[60:63], v1, s[28:31], s71 offen offset:512 nt
    v_add_f32_dpp v231, v230, v230 quad_perm:[2,3,0,1] row_mask:0xf bank_mask:0xf
    v_add_f32 v228, v198, v199
    s_waitcnt vmcnt(23)
    v_pk_fma_f32 v[198:199], v[144:145], v[64:65], v[202:203]
    v_pk_fma_f32 v[198:199], v[146:147], v[66:67], v[198:199]
    s_add_u32 s71, s71, 3072
L_h22:
    s_cbranch_execz L_h23
    s_cbranch_vccnz L_th15_1
L_tb15_1:
    buffer_load_dwordx4 v[64:67], v1, s[28:31], s71 offen offset:0 nt
    v_add_f32_dpp v229, v228, v228 row_ror:8 row_mask:0xf bank_mask:0x3
    s_waitcnt vmcnt(23)
    v_pk_fma_f32 v[198:199], v[148:149], v[68:69], v[198:199]
    v_pk_fma_f32 v[198:199], v[150:151], v[70:71], v[198:199]
    buffer_load_dwordx4 v[68:71], v1, s[28:31], s71 offen offset:256 nt
    s_waitcnt vmcnt(23)
    v_pk_fma_f32 v[198:199], v[152:153], v[72:73], v[198:199]
    v_pk_fma_f32 v[198:199], v[154:155], v[74:75], v[198:199]
    ds_add_u32 v224, v243 offset:3328
    buffer_load_dwordx4 v[72:75], v1, s[28:31], s71 offen offset:512 nt
    v_add_f32 v228, v198, v199
    s_waitcnt vmcnt(23)
    v_pk_fma_f32 v[198:199], v[144:145], v[76:77], v[202:203]
    v_pk_fma_f32 v[198:199], v[146:147], v[78:79], v[198:199]
    s_add_u32 s71, s71, 3072
    s_cbranch_vccnz L_th18_1
L_tb18_1:
L_h23:
    s_cbranch_execz L_h24
    buffer_load_dwordx4 v[76:79], v1, s[28:31], s71 offen offset:0 nt
    v_add_f32_dpp v229, v228, v228 row_ror:8 row_mask:0xf bank_mask:0xc
    s_waitcnt vmcnt(23)
    v_pk_fma_f32 v[198:199], v[148:149], v[80:81], v[198:199]
    v_pk_fma_f32 v[198:199], v[150:151], v[82:83], v[198:199]
    buffer_load_dwordx4 v[80:83], v1, s[28:31], s71 offen offset:256 nt
    v_add_f32_dpp v230, v229, v229 row_shl:4 row_mask:0xf bank_mask:0x5
    s_waitcnt vmcnt(23)
    v_pk_fma_f32 v[198:199], v[152:153], v[84:85], v[198:199]
    v_pk_fma_f32 v[198:199], v[154:155], v[86:87], v[198:199]
    ds_add_u32 v224, v243 offset:3328
    buffer_load_dwordx4 v[84:87], v1, s[28:31], s71 offen offset:512 nt
    v_add_f32 v228, v198, v199
    s_waitcnt vmcnt(23)
    v_pk_fma_f32 v[198:199], v[144:145], v[88:89], v[202:203]
    v_pk_fma_f32 v[198:199], v[146:147], v[90:91], v[198:199]
    s_add_u32 s71, s71, 3072
    s_cbranch_vccnz L_th21_1
L_tb21_1:
L_h24:
    s_cbranch_execz L_h25
    buffer_load_dwordx4 v[88:91], v1, s[28:31], s71 offen offset:0 nt
    v_add_f32_dpp v229, v228, v228 row_ror:8 row_mask:0xf bank_mask:0x3
    s_waitcnt vmcnt(23)
    v_pk_fma_f32 v[198:199], v[148:149], v[92:93], v[198:199]
    v_pk_fma_f32 v[198:199], v[150:151], v[94:95], v[198:199]
    buffer_load_dwordx4 v[92:95], v1, s[28:31], s71 offen offset:256 nt
    s_waitcnt vmcnt(23)
    v_pk_fma_f32 v[198:199], v[152:153], v[96:97], v[198:199]
    v_pk_fma_f32 v[198:199], v[154:155], v[98:99], v[198:199]
    ds_add_u32 v224, v243 offset:3328
    buffer_load_dwordx4 v[96:99], v1, s[28:31], s71 offen offset:512 nt
    v_add_f32 v228, v198, v199
    s_nop 1
    v_add_f32_dpp v229, v228, v228 row_ror:8 row_mask:0xf bank_mask:0xc
    s_nop 1
    v_add_f32_dpp v230, v229, v229 row_shr:4 row_mask:0xf bank_mask:0xa
    s_nop 1
    v_add_f32_dpp v232, v230, v230 quad_perm:[2,3,0,1] row_mask:0xf bank_mask:0xf
    s_nop 1
L_h25:
    s_cbranch_execz L_h26
    v_cndmask_b32 v232, v231, v232, s[64:65]
    s_nop 1
    v_add_f32_dpp v231, v232, v232 quad_perm:[1,0,3,2] row_mask:0xf bank_mask:0xf
    s_nop 1
    v_cndmask_b32 v233, v233, v231, s[66:67]
    v_mul_f32 v233, 0x58000000, v233
    ds_write_b32 v239, v233
    v_add_u32 v239, 256, v239
    s_mov_b64 exec, 1
    ds_add_u32 v243, v243 offset:127
    s_mov_b64 exec, -1
    ds_read_b32 v223, v240
    v_add_u32 v240, 256, v240
    v_lshlrev_b32 v220, 16, v220
    v_lshlrev_b32 v221, 16, v221
    s_waitcnt lgkmcnt(0)
    v_max_f32_dpp v234, v223, v223 row_ror:8 row_mask:0xf bank_mask:0xf
    s_nop 1
    v_max_f32_dpp v234, v234, v234 row_ror:4 row_mask:0xf bank_mask:0xf
    s_nop 1
L_h26:
    s_cbranch_execz L_h27
    v_max_f32_dpp v234, v234, v234 row_ror:2 row_mask:0xf bank_mask:0xf
    s_nop 1
    v_max_f32_dpp v234, v234, v234 row_ror:1 row_mask:0xf bank_mask:0xf
    v_mov_b32 v228, v216
    v_max3_f32 v234, v234, v228, s77
    v_sub_f32 v235, v228, v234
    v_sub_f32 v229, v223, v234
    v_exp_f32 v235, v235
    v_exp_f32 v229, v229
    s_nop 0
    v_mul_f32 v222, v229, v220
    v_mul_f32 v230, v222, v221
    v_mul_f32 v238, 0x71800000, v222
    s_nop 0
    s_mov_b32 s76, 63
L_loop1:
    v_mov_b32_dpp v236, v238 row_newbcast:0 row_mask:0xf bank_mask:0xf
    s_waitcnt vmcnt(23)
    v_pk_fma_f32 v[204:205], v[236:237], v[4:5], v[204:205] op_sel_hi:[0,1,1]
    v_pk_fma_f32 v[206:207], v[236:237], v[6:7], v[206:207] op_sel_hi:[0,1,1]
    ds_read_b32 v244, v243 offset:147
    s_add_u32 s71, s71, 384000
    s_cbranch_vccnz L_th24_2
L_tb24_2:
L_h27:
    s_cbranch_execz L_h28
    buffer_load_dwordx4 v[4:7], v1, s[28:31], s71 offen offset:0 nt
    s_bitcmp0_b32 s4, 0
    s_cbranch_scc1 L_nofl2
    s_mov_b64 exec, 1
    ds_add_u32 v242, v243
    s_mov_b64 exec, -1
    v_add_u32 v241, 4096, v241
    v_add_u32 v242, 4, v242
L_nofl2:
    s_waitcnt vmcnt(23)
    v_pk_fma_f32 v[208:209], v[236:237], v[8:9], v[208:209] op_sel_hi:[0,1,1]
    v_pk_fma_f32 v[210:211], v[236:237], v[10:11], v[210:211] op_sel_hi:[0,1,1]
    buffer_load_dwordx4 v[8:11], v1, s[28:31], s71 offen offset:256 nt
    v_pk_mul_f32 v[212:213], v[212:213], v[234:235] op_sel:[0,1] op_sel_hi:[1,1]
    v_pk_mul_f32 v[214:215], v[214:215], v[234:235] op_sel:[0,1] op_sel_hi:[1,1]
    v_mov_b32 v216, v234
    s_waitcnt vmcnt(23)
    v_pk_fma_f32 v[212:213], v[236:237], v[12:13], v[212:213] op_sel_hi:[0,1,1]
    v_pk_fma_f32 v[214:215], v[236:237], v[14:15], v[214:215] op_sel_hi:[0,1,1]
    s_nop 1
    s_waitcnt lgkmcnt(0)
    v_cmp_lt_u32 vcc, v0, v244
L_h28:
    s_cbranch_execz L_h29
    ds_add_u32 v224, v243 offset:3328
    buffer_load_dwordx4 v[12:15], v1, s[28:31], s71 offen offset:512 nt
    v_fma_f32 v217, v217, v235, v229
    v_mov_b32_dpp v236, v238 row_newbcast:8 row_mask:0xf bank_mask:0xf
    s_waitcnt vmcnt(23)
    v_pk_fma_f32 v[204:205], v[236:237], v[16:17], v[204:205] op_sel_hi:[0,1,1]
    v_pk_fma_f32 v[206:207], v[236:237], v[18:19], v[206:207] op_sel_hi:[0,1,1]
    s_add_u32 s71, s71, 3072
    s_cbranch_vccnz L_th27_2
L_tb27_2:
    buffer_load_dwordx4 v[16:19], v1, s[28:31], s71 offen offset:0 nt
    v_fma_f32 v218, v218, v235, v230
    s_waitcnt vmcnt(23)
    v_pk_fma_f32 v[208:209], v[236:237], v[20:21], v[208:209] op_sel_hi:[0,1,1]
    v_pk_fma_f32 v[210:211], v[236:237], v[22:23], v[210:211] op_sel_hi:[0,1,1]
    s_nop 1
    buffer_load_dwordx4 v[20:23], v1, s[28:31], s71 offen offset:256 nt
    ds_read_b32 v223, v240
    v_add_u32 v240, 256, v240
L_h29:
    s_cbranch_execz L_h30
    s_waitcnt vmcnt(23)
    v_pk_fma_f32 v[212:213], v[236:237], v[24:25], v[212:213] op_sel_hi:[0,1,1]
    v_pk_fma_f32 v[214:215], v[236:237], v[26:27], v[214:215] op_sel_hi:[0,1,1]
    ds_add_u32 v224, v243 offset:3328
    buffer_load_dwordx4 v[24:27], v1, s[28:31], s71 offen offset:512 nt
    v_mov_b32_dpp v236, v238 row_newbcast:4 row_mask:0xf bank_mask:0xf
    s_waitcnt vmcnt(23)
    v_pk_fma_f32 v[204:205], v[236:237], v[28:29], v[204:205] op_sel_hi:[0,1,1]
    v_pk_fma_f32 v[206:207], v[236:237], v[30:31], v[206:207] op_sel_hi:[0,1,1]
    s_nop 1
    s_add_u32 s71, s71, 3072
    s_cbranch_vccnz L_th30_2
L_tb30_2:
    buffer_load_dwordx4 v[28:31], v1, s[28:31], s71 offen offset:0 nt
    ds_write_b128 v241, v[216:219] offset:23552
    s_waitcnt vmcnt(23)
    v_pk_fma_f32 v[208:209], v[236:237], v[32:33], v[208:209] op_sel_hi:[0,1,1]
    v_pk_fma_f32 v[210:211], v[236:237], v[34:35], v[210:211] op_sel_hi:[0,1,1]
    s_nop 1
L_h30:
    s_cbranch_execz L_h31
    buffer_load_dwordx4 v[32:35], v1, s[28:31], s71 offen offset:256 nt
    s_waitcnt vmcnt(23)
    v_pk_fma_f32 v[212:213], v[236:237], v[36:37], v[212:213] op_sel_hi:[0,1,1]
    v_pk_fma_f32 v[214:215], v[236:237], v[38:39], v[214:215] op_sel_hi:[0,1,1]
    ds_add_u32 v224, v243 offset:3328
    buffer_load_dwordx4 v[36:39], v1, s[28:31], s71 offen offset:512 nt
    v_mov_b32_dpp v236, v238 row_newbcast:12 row_mask:0xf bank_mask:0xf
    s_waitcnt vmcnt(23)
    v_pk_fma_f32 v[204:205], v[236:237], v[40:41], v[204:205] op_sel_hi:[0,1,1]
    v_pk_fma_f32 v[206:207], v[236:237], v[42:43], v[206:207] op_sel_hi:[0,1,1]
    s_nop 1
    s_add_u32 s71, s71, 3072
    s_cbranch_vccnz L_th33_2
L_tb33_2:
    buffer_load_dwordx4 v[40:43], v1, s[28:31], s71 offen offset:0 nt
    s_waitcnt vmcnt(23)
    v_pk_fma_f32 v[208:209], v[236:237], v[44:45], v[208:209] op_sel_hi:[0,1,1]
    v_pk_fma_f32 v[210:211], v[236:237], v[46:47], v[210:211] op_sel_hi:[0,1,1]
    s_nop 1
    buffer_load_dwordx4 v[44:47], v1, s[28:31], s71 offen offset:256 nt
L_h31:
    s_cbranch_execz L_h32
    s_waitcnt vmcnt(23)
    v_pk_fma_f32 v[212:213], v[236:237], v[48:49], v[212:213] op_sel_hi:[0,1,1]
    v_pk_fma_f32 v[214:215], v[236:237], v[50:51], v[214:215] op_sel_hi:[0,1,1]
    ds_add_u32 v224, v243 offset:3328
    buffer_load_dwordx4 v[48:51], v1, s[28:31], s71 offen offset:512 nt
    v_mov_b32_dpp v236, v238 row_newbcast:2 row_mask:0xf bank_mask:0xf
    s_waitcnt vmcnt(23)
    v_pk_fma_f32 v[204:205], v[236:237], v[52:53], v[204:205] op_sel_hi:[0,1,1]
    v_pk_fma_f32 v[206:207], v[236:237], v[54:55], v[206:207] op_sel_hi:[0,1,1]
    s_nop 1
    ds_read_b32 v244, v243 offset:147
    v_readlane_b32 s70, v245, s91
    s_add_u32 s91, s91, 1
    s_and_b32 s80, s70, 31
    s_mul_i32 s80, s80, 96
    s_lshl_b32 s73, s70, 7
    s_sub_u32 s73, s73, s80
    buffer_load_ushort v220, v3, s[40:43], s73 offen
    buffer_load_ushort v221, v3, s[44:47], s73 offen
L_h32:
    s_cbranch_execz L_h33
    s_add_u32 s71, s71, 384000
    s_cbranch_vccnz L_th36_2
L_tb36_2:
    buffer_load_dwordx4 v[52:55], v1, s[28:31], s71 offen offset:0 nt
    s_waitcnt vmcnt(25)
    v_pk_fma_f32 v[208:209], v[236:237], v[56:57], v[208:209] op_sel_hi:[0,1,1]
    v_pk_fma_f32 v[210:211], v[236:237], v[58:59], v[210:211] op_sel_hi:[0,1,1]
    buffer_load_dwordx4 v[56:59], v1, s[28:31], s71 offen offset:256 nt
    s_waitcnt vmcnt(25)
    v_pk_fma_f32 v[212:213], v[236:237], v[60:61], v[212:213] op_sel_hi:[0,1,1]
    v_pk_fma_f32 v[214:215], v[236:237], v[62:63], v[214:215] op_sel_hi:[0,1,1]
    s_nop 1
    s_waitcnt lgkmcnt(0)
    v_cmp_lt_u32 vcc, v0, v244
    ds_add_u32 v224, v243 offset:3328
    buffer_load_dwordx4 v[60:63], v1, s[28:31], s71 offen offset:512 nt
    v_mov_b32_dpp v236, v238 row_newbcast:10 row_mask:0xf bank_mask:0xf
    s_waitcnt vmcnt(25)
    v_pk_fma_f32 v[204:205], v[236:237], v[64:65], v[204:205] op_sel_hi:[0,1,1]
    v_pk_fma_f32 v[206:207], v[236:237], v[66:67], v[206:207] op_sel_hi:[0,1,1]
L_h33:
    s_cbranch_execz L_h34
    s_add_u32 s71, s71, 3072
    s_cbranch_vccnz L_th39_2
L_tb39_2:
    buffer_load_dwordx4 v[64:67], v1, s[28:31], s71 offen offset:0 nt
    s_waitcnt vmcnt(25)
    v_pk_fma_f32 v[208:209], v[236:237], v[68:69], v[208:209] op_sel_hi:[0,1,1]
    v_pk_fma_f32 v[210:211], v[236:237], v[70:71], v[210:211] op_sel_hi:[0,1,1]
    s_nop 1
    buffer_load_dwordx4 v[68:71], v1, s[28:31], s71 offen offset:256 nt
    s_waitcnt vmcnt(25)
    v_pk_fma_f32 v[212:213], v[236:237], v[72:73], v[212:213] op_sel_hi:[0,1,1]
    v_pk_fma_f32 v[214:215], v[236:237], v[74:75], v[214:215] op_sel_hi:[0,1,1]
    s_nop 1
    ds_add_u32 v224, v243 offset:3328
    buffer_load_dwordx4 v[72:75], v1, s[28:31], s71 offen offset:512 nt
    v_mov_b32_dpp v236, v238 row_newbcast:6 row_mask:0xf bank_mask:0xf
    s_waitcnt vmcnt(25)
    v_pk_fma_f32 v[204:205], v[236:237], v[76:77], v[204:205] op_sel_hi:[0,1,1]
    v_pk_fma_f32 v[206:207], v[236:237], v[78:79], v[206:207] op_sel_hi:[0,1,1]
L_h34:
    s_cbranch_execz L_h35
    s_add_u32 s71, s71, 3072
    s_cbranch_vccnz L_th42_2
L_tb42_2:
    buffer_load_dwordx4 v[76:79], v1, s[28:31], s71 offen offset:0 nt
    s_waitcnt vmcnt(25)
    v_pk_fma_f32 v[208:209], v[236:237], v[80:81], v[208:209] op_sel_hi:[0,1,1]
    v_pk_fma_f32 v[210:211], v[236:237], v[82:83], v[210:211] op_sel_hi:[0,1,1]
    s_nop 1
    buffer_load_dwordx4 v[80:83], v1, s[28:31], s71 offen offset:256 nt
    s_waitcnt vmcnt(25)
    v_pk_fma_f32 v[212:213], v[236:237], v[84:85], v[212:213] op_sel_hi:[0,1,1]
    v_pk_fma_f32 v[214:215], v[236:237], v[86:87], v[214:215] op_sel_hi:[0,1,1]
    s_nop 1
    ds_add_u32 v224, v243 offset:3328
    buffer_load_dwordx4 v[84:87], v1, s[28:31], s71 offen offset:512 nt
    v_mov_b32_dpp v236, v238 row_newbcast:14 row_mask:0xf bank_mask:0xf
    s_waitcnt vmcnt(25)
    v_pk_fma_f32 v[204:205], v[236:237], v[88:89], v[204:205] op_sel_hi:[0,1,1]
    v_pk_fma_f32 v[206:207], v[236:237], v[90:91], v[206:207] op_sel_hi:[0,1,1]
    s_nop 1
L_h35:
    s_cbranch_execz L_h36
    s_add_u32 s71, s71, 3072
    s_cbranch_vccnz L_th45_2
L_tb45_2:
    buffer_load_dwordx4 v[88:91], v1, s[28:31], s71 offen offset:0 nt
    s_waitcnt vmcnt(25)
    v_pk_fma_f32 v[208:209], v[236:237], v[92:93], v[208:209] op_sel_hi:[0,1,1]
    v_pk_fma_f32 v[210:211], v[236:237], v[94:95], v[210:211] op_sel_hi:[0,1,1]
    buffer_load_dwordx4 v[92:95], v1, s[28:31], s71 offen offset:256 nt
    s_cmp_eq_u32 s76, 16
    s_cbranch_scc1 L_getm2
L_gotm2:
    s_waitcnt vmcnt(25)
    v_pk_fma_f32 v[212:213], v[236:237], v[96:97], v[212:213] op_sel_hi:[0,1,1]
    v_pk_fma_f32 v[214:215], v[236:237], v[98:99], v[214:215] op_sel_hi:[0,1,1]
    s_nop 1
    ds_add_u32 v224, v243 offset:3328
    buffer_load_dwordx4 v[96:99], v1, s[28:31], s71 offen offset:512 nt
    v_mov_b32_dpp v236, v238 row_newbcast:1 row_mask:0xf bank_mask:0xf
    s_waitcnt vmcnt(25)
    v_pk_fma_f32 v[204:205], v[236:237], v[4:5], v[204:205] op_sel_hi:[0,1,1]
    v_pk_fma_f32 v[206:207], v[236:237], v[6:7], v[206:207] op_sel_hi:[0,1,1]
L_h36:
    s_cbranch_execz L_h37
    ds_read_b32 v244, v243 offset:147
    s_mul_i32 s71, s70, 49152
    s_and_b32 s80, s70, 31
    s_mul_i32 s80, s80, 36864
    s_sub_u32 s71, s71, s80
    s_cbranch_vccnz L_th0_2
L_tb0_2:
    buffer_load_dwordx4 v[4:7], v1, s[28:31], s71 offen offset:0 nt
    s_waitcnt vmcnt(25)
    v_pk_fma_f32 v[208:209], v[236:237], v[8:9], v[208:209] op_sel_hi:[0,1,1]
    v_pk_fma_f32 v[210:211], v[236:237], v[10:11], v[210:211] op_sel_hi:[0,1,1]
    s_nop 1
    buffer_load_dwordx4 v[8:11], v1, s[28:31], s71 offen offset:256 nt
    s_waitcnt vmcnt(25)
    v_pk_fma_f32 v[212:213], v[236:237], v[12:13], v[212:213] op_sel_hi:[0,1,1]
    v_pk_fma_f32 v[214:215], v[236:237], v[14:15], v[214:215] op_sel_hi:[0,1,1]
    s_nop 1
    s_waitcnt lgkmcnt(0)
    v_cmp_lt_u32 vcc, v0, v244
    ds_add_u32 v224, v243 offset:3328
    buffer_load_dwordx4 v[12:15], v1, s[28:31], s71 offen offset:512 nt
L_h37:
    s_cbranch_execz L_h38
    v_max_f32_dpp v234, v223, v223 row_ror:8 row_mask:0xf bank_mask:0xf
    v_mov_b32_dpp v236, v238 row_newbcast:9 row_mask:0xf bank_mask:0xf
    s_waitcnt vmcnt(25)
    v_pk_fma_f32 v[204:205], v[236:237], v[16:17], v[204:205] op_sel_hi:[0,1,1]
    v_pk_fma_f32 v[206:207], v[236:237], v[18:19], v[206:207] op_sel_hi:[0,1,1]
    s_add_u32 s71, s71, 3072
    s_cbranch_vccnz L_th3_2
L_tb3_2:
    buffer_load_dwordx4 v[16:19], v1, s[28:31], s71 offen offset:0 nt
    v_max_f32_dpp v234, v234, v234 row_ror:4 row_mask:0xf bank_mask:0xf
    s_waitcnt vmcnt(25)
    v_pk_fma_f32 v[208:209], v[236:237], v[20:21], v[208:209] op_sel_hi:[0,1,1]
    v_pk_fma_f32 v[210:211], v[236:237], v[22:23], v[210:211] op_sel_hi:[0,1,1]
    s_nop 1
    buffer_load_dwordx4 v[20:23], v1, s[28:31], s71 offen offset:256 nt
    v_max_f32_dpp v234, v234, v234 row_ror:2 row_mask:0xf bank_mask:0xf
    s_waitcnt vmcnt(25)
    v_pk_fma_f32 v[212:213], v[236:237], v[24:25], v[212:213] op_sel_hi:[0,1,1]
    v_pk_fma_f32 v[214:215], v[236:237], v[26:27], v[214:215] op_sel_hi:[0,1,1]
L_h38:
    s_cbranch_execz L_h39
    ds_add_u32 v224, v243 offset:3328
    buffer_load_dwordx4 v[24:27], v1, s[28:31], s71 offen offset:512 nt
    v_max_f32_dpp v234, v234, v234 row_ror:1 row_mask:0xf bank_mask:0xf
    v_mov_b32_dpp v236, v238 row_newbcast:5 row_mask:0xf bank_mask:0xf
    s_waitcnt vmcnt(25)
    v_pk_fma_f32 v[204:205], v[236:237], v[28:29], v[204:205] op_sel_hi:[0,1,1]
    v_pk_fma_f32 v[206:207], v[236:237], v[30:31], v[206:207] op_sel_hi:[0,1,1]
    s_nop 1
    s_add_u32 s71, s71, 3072
    s_cbranch_vccnz L_th6_2
L_tb6_2:
    buffer_load_dwordx4 v[28:31], v1, s[28:31], s71 offen offset:0 nt
    s_lshr_b64 s[4:5], s[4:5], 1
    s_bitcmp1_b32 s4, 0
    s_cselect_b32 s6, s7, 0x7f7fffff
    v_min_f32 v228, s6, v216
    s_waitcnt vmcnt(25)
    v_pk_fma_f32 v[208:209], v[236:237], v[32:33], v[208:209] op_sel_hi:[0,1,1]
    v_pk_fma_f32 v[210:211], v[236:237], v[34:35], v[210:211] op_sel_hi:[0,1,1]
    s_nop 1
    buffer_load_dwordx4 v[32:35], v1, s[28:31], s71 offen offset:256 nt
L_h39:
    s_cbranch_execz L_h40
    v_max3_f32 v234, v234, v228, s77
    s_waitcnt vmcnt(25)
    v_pk_fma_f32 v[212:213], v[236:237], v[36:37], v[212:213] op_sel_hi:[0,1,1]
    v_pk_fma_f32 v[214:215], v[236:237], v[38:39], v[214:215] op_sel_hi:[0,1,1]
    ds_add_u32 v224, v243 offset:3328
    buffer_load_dwordx4 v[36:39], v1, s[28:31], s71 offen offset:512 nt
    v_sub_f32 v235, v228, v234
    v_sub_f32 v229, v223, v234
    v_mov_b32_dpp v236, v238 row_newbcast:13 row_mask:0xf bank_mask:0xf
    s_waitcnt vmcnt(25)
    v_pk_fma_f32 v[204:205], v[236:237], v[40:41], v[204:205] op_sel_hi:[0,1,1]
    v_pk_fma_f32 v[206:207], v[236:237], v[42:43], v[206:207] op_sel_hi:[0,1,1]
    s_nop 1
    s_add_u32 s71, s71, 3072
    s_cbranch_vccnz L_th9_2
L_tb9_2:
    buffer_load_dwordx4 v[40:43], v1, s[28:31], s71 offen offset:0 nt
    v_exp_f32 v235, v235
    s_waitcnt vmcnt(25)
    v_pk_fma_f32 v[208:209], v[236:237], v[44:45], v[208:209] op_sel_hi:[0,1,1]
L_h40:
    s_cbranch_execz L_h41
    v_pk_fma_f32 v[210:211], v[236:237], v[46:47], v[210:211] op_sel_hi:[0,1,1]
    buffer_load_dwordx4 v[44:47], v1, s[28:31], s71 offen offset:256 nt
    v_exp_f32 v229, v229
    s_waitcnt vmcnt(25)
    v_pk_fma_f32 v[212:213], v[236:237], v[48:49], v[212:213] op_sel_hi:[0,1,1]
    v_pk_fma_f32 v[214:215], v[236:237], v[50:51], v[214:215] op_sel_hi:[0,1,1]
    s_nop 1
    ds_add_u32 v224, v243 offset:3328
    buffer_load_dwordx4 v[48:51], v1, s[28:31], s71 offen offset:512 nt
    v_mov_b32_dpp v236, v238 row_newbcast:3 row_mask:0xf bank_mask:0xf
    s_waitcnt vmcnt(23)
    v_pk_fma_f32 v[204:205], v[236:237], v[52:53], v[204:205] op_sel_hi:[0,1,1]
    v_pk_fma_f32 v[206:207], v[236:237], v[54:55], v[206:207] op_sel_hi:[0,1,1]
    s_nop 1
    ds_read_b32 v244, v243 offset:147
    s_add_u32 s71, s71, 384000
    s_cbranch_vccnz L_th12_2
L_tb12_2:
    buffer_load_dwordx4 v[52:55], v1, s[28:31], s71 offen offset:0 nt
    v_lshlrev_b32 v220, 16, v220
L_h41:
    s_cbranch_execz L_h42
    s_waitcnt vmcnt(23)
    v_pk_fma_f32 v[208:209], v[236:237], v[56:57], v[208:209] op_sel_hi:[0,1,1]
    v_pk_fma_f32 v[210:211], v[236:237], v[58:59], v[210:211] op_sel_hi:[0,1,1]
    buffer_load_dwordx4 v[56:59], v1, s[28:31], s71 offen offset:256 nt
    v_lshlrev_b32 v221, 16, v221
    s_waitcnt vmcnt(23)
    v_pk_fma_f32 v[212:213], v[236:237], v[60:61], v[212:213] op_sel_hi:[0,1,1]
    v_pk_fma_f32 v[214:215], v[236:237], v[62:63], v[214:215] op_sel_hi:[0,1,1]
    s_nop 1
    s_waitcnt lgkmcnt(0)
    v_cmp_lt_u32 vcc, v0, v244
    ds_add_u32 v224, v243 offset:3328
    buffer_load_dwordx4 v[60:63], v1, s[28:31], s71 offen offset:512 nt
    v_mov_b32_dpp v236, v238 row_newbcast:11 row_mask:0xf bank_mask:0xf
    s_waitcnt vmcnt(23)
    v_pk_fma_f32 v[204:205], v[236:237], v[64:65], v[204:205] op_sel_hi:[0,1,1]
    v_pk_fma_f32 v[206:207], v[236:237], v[66:67], v[206:207] op_sel_hi:[0,1,1]
    s_nop 1
    s_add_u32 s71, s71, 3072
    s_cbranch_vccnz L_th15_2
L_tb15_2:
L_h42:
    s_cbranch_execz L_h43
    buffer_load_dwordx4 v[64:67], v1, s[28:31], s71 offen offset:0 nt
    v_mul_f32 v222, v229, v220
    s_waitcnt vmcnt(23)
    v_pk_fma_f32 v[208:209], v[236:237], v[68:69], v[208:209] op_sel_hi:[0,1,1]
    v_pk_fma_f32 v[210:211], v[236:237], v[70:71], v[210:211] op_sel_hi:[0,1,1]
    buffer_load_dwordx4 v[68:71], v1, s[28:31], s71 offen offset:256 nt
    v_mul_f32 v230, v222, v221
    s_waitcnt vmcnt(23)
    v_pk_fma_f32 v[212:213], v[236:237], v[72:73], v[212:213] op_sel_hi:[0,1,1]
    v_pk_fma_f32 v[214:215], v[236:237], v[74:75], v[214:215] op_sel_hi:[0,1,1]
    s_nop 1
    ds_add_u32 v224, v243 offset:3328
    buffer_load_dwordx4 v[72:75], v1, s[28:31], s71 offen offset:512 nt
    v_mov_b32_dpp v236, v238 row_newbcast:7 row_mask:0xf bank_mask:0xf
    s_waitcnt vmcnt(23)
    v_pk_fma_f32 v[204:205], v[236:237], v[76:77], v[204:205] op_sel_hi:[0,1,1]
    v_pk_fma_f32 v[206:207], v[236:237], v[78:79], v[206:207] op_sel_hi:[0,1,1]
    s_nop 1
    s_add_u32 s71, s71, 3072
L_h43:
    s_cbranch_execz L_h44
    s_cbranch_vccnz L_th18_2
L_tb18_2:
    buffer_load_dwordx4 v[76:79], v1, s[28:31], s71 offen offset:0 nt
    s_waitcnt vmcnt(23)
    v_pk_fma_f32 v[208:209], v[236:237], v[80:81], v[208:209] op_sel_hi:[0,1,1]
    v_pk_fma_f32 v[210:211], v[236:237], v[82:83], v[210:211] op_sel_hi:[0,1,1]
    buffer_load_dwordx4 v[80:83], v1, s[28:31], s71 offen offset:256 nt
    s_waitcnt vmcnt(23)
    v_pk_fma_f32 v[212:213], v[236:237], v[84:85], v[212:213] op_sel_hi:[0,1,1]
    v_pk_fma_f32 v[214:215], v[236:237], v[86:87], v[214:215] op_sel_hi:[0,1,1]
    s_nop 1
    ds_add_u32 v224, v243 offset:3328
    buffer_load_dwordx4 v[84:87], v1, s[28:31], s71 offen offset:512 nt
    v_mov_b32_dpp v236, v238 row_newbcast:15 row_mask:0xf bank_mask:0xf
    s_waitcnt vmcnt(23)
    v_pk_fma_f32 v[204:205], v[236:237], v[88:89], v[204:205] op_sel_hi:[0,1,1]
    v_pk_fma_f32 v[206:207], v[236:237], v[90:91], v[206:207] op_sel_hi:[0,1,1]
    s_nop 1
    s_add_u32 s71, s71, 3072
    s_cbranch_vccnz L_th21_2
L_tb21_2:
L_h44:
    s_cbranch_execz L_h45
    buffer_load_dwordx4 v[88:91], v1, s[28:31], s71 offen offset:0 nt
    ds_write_b128 v241, v[204:207] offset:20480
    v_mul_f32 v238, 0x71800000, v222
    s_waitcnt vmcnt(23)
    v_pk_fma_f32 v[208:209], v[236:237], v[92:93], v[208:209] op_sel_hi:[0,1,1]
    v_pk_fma_f32 v[210:211], v[236:237], v[94:95], v[210:211] op_sel_hi:[0,1,1]
    buffer_load_dwordx4 v[92:95], v1, s[28:31], s71 offen offset:256 nt
    ds_write_b128 v241, v[208:211] offset:21504
    v_pk_mul_f32 v[204:205], v[204:205], v[234:235] op_sel:[0,1] op_sel_hi:[1,1]
    v_pk_mul_f32 v[206:207], v[206:207], v[234:235] op_sel:[0,1] op_sel_hi:[1,1]
    s_waitcnt vmcnt(23)
    v_pk_fma_f32 v[212:213], v[236:237], v[96:97], v[212:213] op_sel_hi:[0,1,1]
    v_pk_fma_f32 v[214:215], v[236:237], v[98:99], v[214:215] op_sel_hi:[0,1,1]
    s_nop 1
    ds_add_u32 v224, v243 offset:3328
    buffer_load_dwordx4 v[96:99], v1, s[28:31], s71 offen offset:512 nt
    ds_write_b128 v241, v[212:215] offset:22528
L_h45:
    s_cbranch_execz L_h46
    v_pk_mul_f32 v[208:209], v[208:209], v[234:235] op_sel:[0,1] op_sel_hi:[1,1]
    v_pk_mul_f32 v[210:211], v[210:211], v[234:235] op_sel:[0,1] op_sel_hi:[1,1]
    s_sub_u32 s76, s76, 1
    s_cmp_lg_u32 s76, 0
    s_cbranch_scc1 L_loop1
    v_mov_b32_dpp v236, v238 row_newbcast:0 row_mask:0xf bank_mask:0xf
    s_waitcnt vmcnt(23)
    v_pk_fma_f32 v[204:205], v[236:237], v[4:5], v[204:205] op_sel_hi:[0,1,1]
    v_pk_fma_f32 v[206:207], v[236:237], v[6:7], v[206:207] op_sel_hi:[0,1,1]
    ds_read_b32 v244, v243 offset:147
    s_add_u32 s71, s71, 384000
    s_cbranch_vccnz L_th24_3
L_tb24_3:
    buffer_load_dwordx4 v[4:7], v1, s[28:31], s71 offen offset:0 nt
    s_bitcmp0_b32 s4, 0
    s_cbranch_scc1 L_nofl3
    s_mov_b64 exec, 1
    ds_add_u32 v242, v243
    s_mov_b64 exec, -1
    v_add_u32 v241, 4096, v241
    v_add_u32 v242, 4, v242
L_nofl3:
    s_waitcnt vmcnt(23)
L_h46:
    s_cbranch_execz L_h47
    v_pk_fma_f32 v[208:209], v[236:237], v[8:9], v[208:209] op_sel_hi:[0,1,1]
    v_pk_fma_f32 v[210:211], v[236:237], v[10:11], v[210:211] op_sel_hi:[0,1,1]
    buffer_load_dwordx4 v[8:11], v1, s[28:31], s71 offen offset:256 nt
    v_pk_mul_f32 v[212:213], v[212:213], v[234:235] op_sel:[0,1] op_sel_hi:[1,1]
    v_pk_mul_f32 v[214:215], v[214:215], v[234:235] op_sel:[0,1] op_sel_hi:[1,1]
    v_mov_b32 v216, v234
    s_waitcnt vmcnt(23)
    v_pk_fma_f32 v[212:213], v[236:237], v[12:13], v[212:213] op_sel_hi:[0,1,1]
    v_pk_fma_f32 v[214:215], v[236:237], v[14:15], v[214:215] op_sel_hi:[0,1,1]
    s_nop 1
    s_waitcnt lgkmcnt(0)
    v_cmp_lt_u32 vcc, v0, v244
    ds_add_u32 v224, v243 offset:3328
    buffer_load_dwordx4 v[12:15], v1, s[28:31], s71 offen offset:512 nt
    v_fma_f32 v217, v217, v235, v229
    v_mov_b32_dpp v236, v238 row_newbcast:8 row_mask:0xf bank_mask:0xf
    s_waitcnt vmcnt(23)
    v_pk_fma_f32 v[204:205], v[236:237], v[16:17], v[204:205] op_sel_hi:[0,1,1]
    v_pk_fma_f32 v[206:207], v[236:237], v[18:19], v[206:207] op_sel_hi:[0,1,1]
L_h47:
    s_cbranch_execz L_h48
    s_add_u32 s71, s71, 3072
    s_cbranch_vccnz L_th27_3
L_tb27_3:
    buffer_load_dwordx4 v[16:19], v1, s[28:31], s71 offen offset:0 nt
    v_fma_f32 v218, v218, v235, v230
    s_waitcnt vmcnt(23)
    v_pk_fma_f32 v[208:209], v[236:237], v[20:21], v[208:209] op_sel_hi:[0,1,1]
    v_pk_fma_f32 v[210:211], v[236:237], v[22:23], v[210:211] op_sel_hi:[0,1,1]
    s_nop 1
    buffer_load_dwordx4 v[20:23], v1, s[28:31], s71 offen offset:256 nt
    s_mov_b64 exec, s[88:89]
    buffer_store_dwordx4 v[100:103], v225, s[52:55], s78 offen offset:0
    s_mov_b64 exec, -1
    s_waitcnt vmcnt(23)
    v_pk_fma_f32 v[212:213], v[236:237], v[24:25], v[212:213] op_sel_hi:[0,1,1]
    v_pk_fma_f32 v[214:215], v[236:237], v[26:27], v[214:215] op_sel_hi:[0,1,1]
    s_nop 1
    ds_add_u32 v224, v243 offset:3328
    buffer_load_dwordx4 v[24:27], v1, s[28:31], s71 offen offset:512 nt
    v_add_f32_dpp v218, v218, v218 row_ror:8 row_mask:0xf bank_mask:0xf
L_h48:
    s_cbranch_execz L_h49
    v_mov_b32_dpp v236, v238 row_newbcast:4 row_mask:0xf bank_mask:0xf
    s_waitcnt vmcnt(23)
    v_pk_fma_f32 v[204:205], v[236:237], v[28:29], v[204:205] op_sel_hi:[0,1,1]
    v_pk_fma_f32 v[206:207], v[236:237], v[30:31], v[206:207] op_sel_hi:[0,1,1]
    s_add_u32 s71, s71, 3072
    s_cbranch_vccnz L_th30_3
L_tb30_3:
    buffer_load_dwordx4 v[28:31], v1, s[28:31], s71 offen offset:0 nt
    v_add_f32_dpp v218, v218, v218 row_ror:4 row_mask:0xf bank_mask:0xf
    s_waitcnt vmcnt(23)
    v_pk_fma_f32 v[208:209], v[236:237], v[32:33], v[208:209] op_sel_hi:[0,1,1]
    v_pk_fma_f32 v[210:211], v[236:237], v[34:35], v[210:211] op_sel_hi:[0,1,1]
    s_nop 1
    buffer_load_dwordx4 v[32:35], v1, s[28:31], s71 offen offset:256 nt
    v_add_f32_dpp v218, v218, v218 row_ror:2 row_mask:0xf bank_mask:0xf
    s_waitcnt vmcnt(23)
    v_pk_fma_f32 v[212:213], v[236:237], v[36:37], v[212:213] op_sel_hi:[0,1,1]
    v_pk_fma_f32 v[214:215], v[236:237], v[38:39], v[214:215] op_sel_hi:[0,1,1]
    s_nop 1
L_h49:
    s_cbranch_execz L_h50
    ds_add_u32 v224, v243 offset:3328
    buffer_load_dwordx4 v[36:39], v1, s[28:31], s71 offen offset:512 nt
    v_add_f32_dpp v218, v218, v218 row_ror:1 row_mask:0xf bank_mask:0xf
    v_mov_b32_dpp v236, v238 row_newbcast:12 row_mask:0xf bank_mask:0xf
    s_waitcnt vmcnt(23)
    v_pk_fma_f32 v[204:205], v[236:237], v[40:41], v[204:205] op_sel_hi:[0,1,1]
    v_pk_fma_f32 v[206:207], v[236:237], v[42:43], v[206:207] op_sel_hi:[0,1,1]
    s_add_u32 s71, s71, 3072
    s_cbranch_vccnz L_th33_3
L_tb33_3:
    buffer_load_dwordx4 v[40:43], v1, s[28:31], s71 offen offset:0 nt
    v_mov_b32 v234, v218
    s_waitcnt vmcnt(23)
    v_pk_fma_f32 v[208:209], v[236:237], v[44:45], v[208:209] op_sel_hi:[0,1,1]
    v_pk_fma_f32 v[210:211], v[236:237], v[46:47], v[210:211] op_sel_hi:[0,1,1]
    s_nop 1
    buffer_load_dwordx4 v[44:47], v1, s[28:31], s71 offen offset:256 nt
    v_permlane32_swap_b32 v218, v234
    s_waitcnt vmcnt(23)
    v_pk_fma_f32 v[212:213], v[236:237], v[48:49], v[212:213] op_sel_hi:[0,1,1]
L_h50:
    s_cbranch_execz L_h51
    v_pk_fma_f32 v[214:215], v[236:237], v[50:51], v[214:215] op_sel_hi:[0,1,1]
    ds_add_u32 v224, v243 offset:3328
    buffer_load_dwordx4 v[48:51], v1, s[28:31], s71 offen offset:512 nt
    v_add_f32 v218, v218, v234
    v_mov_b32_dpp v236, v238 row_newbcast:2 row_mask:0xf bank_mask:0xf
    s_waitcnt vmcnt(23)
    v_pk_fma_f32 v[204:205], v[236:237], v[52:53], v[204:205] op_sel_hi:[0,1,1]
    v_pk_fma_f32 v[206:207], v[236:237], v[54:55], v[206:207] op_sel_hi:[0,1,1]
    s_nop 1
    ds_read_b32 v244, v243 offset:147
    s_add_u32 s71, s71, 384000
    s_cbranch_vccnz L_th36_3
L_tb36_3:
    buffer_load_dwordx4 v[52:55], v1, s[28:31], s71 offen offset:0 nt
    v_mov_b32 v234, v218
    s_waitcnt vmcnt(23)
    v_pk_fma_f32 v[208:209], v[236:237], v[56:57], v[208:209] op_sel_hi:[0,1,1]
    v_pk_fma_f32 v[210:211], v[236:237], v[58:59], v[210:211] op_sel_hi:[0,1,1]
    s_nop 1
    buffer_load_dwordx4 v[56:59], v1, s[28:31], s71 offen offset:256 nt
L_h51:
    s_cbranch_execz L_h52
    v_permlane16_swap_b32 v218, v234
    s_waitcnt vmcnt(23)
    v_pk_fma_f32 v[212:213], v[236:237], v[60:61], v[212:213] op_sel_hi:[0,1,1]
    v_pk_fma_f32 v[214:215], v[236:237], v[62:63], v[214:215] op_sel_hi:[0,1,1]
    s_waitcnt lgkmcnt(0)
    v_cmp_lt_u32 vcc, v0, v244
    ds_add_u32 v224, v243 offset:3328
    buffer_load_dwordx4 v[60:63], v1, s[28:31], s71 offen offset:512 nt
    v_add_f32 v218, v218, v234
    v_mov_b32_dpp v236, v238 row_newbcast:10 row_mask:0xf bank_mask:0xf
    s_waitcnt vmcnt(23)
    v_pk_fma_f32 v[204:205], v[236:237], v[64:65], v[204:205] op_sel_hi:[0,1,1]
    v_pk_fma_f32 v[206:207], v[236:237], v[66:67], v[206:207] op_sel_hi:[0,1,1]
    s_nop 1
    s_add_u32 s71, s71, 3072
    s_cbranch_vccnz L_th39_3
L_tb39_3:
    buffer_load_dwordx4 v[64:67], v1, s[28:31], s71 offen offset:0 nt
    v_mov_b32 v103, s93
    v_lshlrev_b32 v235, 4, v0
    s_lshl_b32 s78, s3, 11
    s_mov_b32 s6, 0x58000000
L_h52:
    s_cbranch_execz L_h53
    s_waitcnt vmcnt(23)
    v_pk_fma_f32 v[208:209], v[236:237], v[68:69], v[208:209] op_sel_hi:[0,1,1]
    v_pk_fma_f32 v[210:211], v[236:237], v[70:71], v[210:211] op_sel_hi:[0,1,1]
    buffer_load_dwordx4 v[68:71], v1, s[28:31], s71 offen offset:256 nt
    s_waitcnt vmcnt(23)
    v_pk_fma_f32 v[212:213], v[236:237], v[72:73], v[212:213] op_sel_hi:[0,1,1]
    v_pk_fma_f32 v[214:215], v[236:237], v[74:75], v[214:215] op_sel_hi:[0,1,1]
    s_nop 1
    ds_add_u32 v224, v243 offset:3328
    buffer_load_dwordx4 v[72:75], v1, s[28:31], s71 offen offset:512 nt
    v_mov_b32_dpp v236, v238 row_newbcast:6 row_mask:0xf bank_mask:0xf
    s_waitcnt vmcnt(23)
    v_pk_fma_f32 v[204:205], v[236:237], v[76:77], v[204:205] op_sel_hi:[0,1,1]
    v_pk_fma_f32 v[206:207], v[236:237], v[78:79], v[206:207] op_sel_hi:[0,1,1]
    s_nop 1
    s_add_u32 s71, s71, 3072
    s_cbranch_vccnz L_th42_3
L_tb42_3:
    buffer_load_dwordx4 v[76:79], v1, s[28:31], s71 offen offset:0 nt
    s_waitcnt vmcnt(23)
L_h53:
    s_cbranch_execz L_h54
    v_pk_fma_f32 v[208:209], v[236:237], v[80:81], v[208:209] op_sel_hi:[0,1,1]
    v_pk_fma_f32 v[210:211], v[236:237], v[82:83], v[210:211] op_sel_hi:[0,1,1]
    buffer_load_dwordx4 v[80:83], v1, s[28:31], s71 offen offset:256 nt
    s_waitcnt vmcnt(23)
    v_pk_fma_f32 v[212:213], v[236:237], v[84:85], v[212:213] op_sel_hi:[0,1,1]
    v_pk_fma_f32 v[214:215], v[236:237], v[86:87], v[214:215] op_sel_hi:[0,1,1]
    s_nop 1
    ds_add_u32 v224, v243 offset:3328
    buffer_load_dwordx4 v[84:87], v1, s[28:31], s71 offen offset:512 nt
    v_mov_b32_dpp v236, v238 row_newbcast:14 row_mask:0xf bank_mask:0xf
    s_waitcnt vmcnt(23)
    v_pk_fma_f32 v[204:205], v[236:237], v[88:89], v[204:205] op_sel_hi:[0,1,1]
    v_pk_fma_f32 v[206:207], v[236:237], v[90:91], v[206:207] op_sel_hi:[0,1,1]
    s_nop 1
    s_add_u32 s71, s71, 3072
    s_cbranch_vccnz L_th45_3
L_tb45_3:
    buffer_load_dwordx4 v[88:91], v1, s[28:31], s71 offen offset:0 nt
    s_waitcnt vmcnt(23)
    v_pk_fma_f32 v[208:209], v[236:237], v[92:93], v[208:209] op_sel_hi:[0,1,1]
L_h54:
    s_cbranch_execz L_h55
    v_pk_fma_f32 v[210:211], v[236:237], v[94:95], v[210:211] op_sel_hi:[0,1,1]
    buffer_load_dwordx4 v[92:95], v1, s[28:31], s71 offen offset:256 nt
    s_waitcnt vmcnt(23)
    v_pk_fma_f32 v[212:213], v[236:237], v[96:97], v[212:213] op_sel_hi:[0,1,1]
    v_pk_fma_f32 v[214:215], v[236:237], v[98:99], v[214:215] op_sel_hi:[0,1,1]
    s_nop 1
    ds_add_u32 v224, v243 offset:3328
    buffer_load_dwordx4 v[96:99], v1, s[28:31], s71 offen offset:512 nt
    ds_write_b32 v243, v243 offset:143
    v_mov_b32_dpp v236, v238 row_newbcast:1 row_mask:0xf bank_mask:0xf
    s_waitcnt vmcnt(23)
    v_pk_fma_f32 v[204:205], v[236:237], v[4:5], v[204:205] op_sel_hi:[0,1,1]
    v_pk_fma_f32 v[206:207], v[236:237], v[6:7], v[206:207] op_sel_hi:[0,1,1]
    s_waitcnt vmcnt(22)
    v_pk_fma_f32 v[208:209], v[236:237], v[8:9], v[208:209] op_sel_hi:[0,1,1]
    v_pk_fma_f32 v[210:211], v[236:237], v[10:11], v[210:211] op_sel_hi:[0,1,1]
    s_waitcnt vmcnt(21)
    v_pk_fma_f32 v[212:213], v[236:237], v[12:13], v[212:213] op_sel_hi:[0,1,1]
L_h55:
    s_cbranch_execz L_h56
    v_pk_fma_f32 v[214:215], v[236:237], v[14:15], v[214:215] op_sel_hi:[0,1,1]
    v_mov_b32_dpp v236, v238 row_newbcast:9 row_mask:0xf bank_mask:0xf
    s_waitcnt vmcnt(20)
    v_pk_fma_f32 v[204:205], v[236:237], v[16:17], v[204:205] op_sel_hi:[0,1,1]
    v_pk_fma_f32 v[206:207], v[236:237], v[18:19], v[206:207] op_sel_hi:[0,1,1]
    s_waitcnt vmcnt(19)
    v_pk_fma_f32 v[208:209], v[236:237], v[20:21], v[208:209] op_sel_hi:[0,1,1]
    v_pk_fma_f32 v[210:211], v[236:237], v[22:23], v[210:211] op_sel_hi:[0,1,1]
    s_waitcnt vmcnt(18)
    v_pk_fma_f32 v[212:213], v[236:237], v[24:25], v[212:213] op_sel_hi:[0,1,1]
    v_pk_fma_f32 v[214:215], v[236:237], v[26:27], v[214:215] op_sel_hi:[0,1,1]
    v_mov_b32_dpp v236, v238 row_newbcast:5 row_mask:0xf bank_mask:0xf
    s_waitcnt vmcnt(17)
    v_pk_fma_f32 v[204:205], v[236:237], v[28:29], v[204:205] op_sel_hi:[0,1,1]
    v_pk_fma_f32 v[206:207], v[236:237], v[30:31], v[206:207] op_sel_hi:[0,1,1]
    s_waitcnt vmcnt(16)
    v_pk_fma_f32 v[208:209], v[236:237], v[32:33], v[208:209] op_sel_hi:[0,1,1]
    v_pk_fma_f32 v[210:211], v[236:237], v[34:35], v[210:211] op_sel_hi:[0,1,1]
L_h56:
    s_cbranch_execz L_h57
    s_waitcnt vmcnt(15)
    v_pk_fma_f32 v[212:213], v[236:237], v[36:37], v[212:213] op_sel_hi:[0,1,1]
    v_pk_fma_f32 v[214:215], v[236:237], v[38:39], v[214:215] op_sel_hi:[0,1,1]
    v_mov_b32_dpp v236, v238 row_newbcast:13 row_mask:0xf bank_mask:0xf
    s_waitcnt vmcnt(14)
    v_pk_fma_f32 v[204:205], v[236:237], v[40:41], v[204:205] op_sel_hi:[0,1,1]
    v_pk_fma_f32 v[206:207], v[236:237], v[42:43], v[206:207] op_sel_hi:[0,1,1]
    s_waitcnt vmcnt(13)
    v_pk_fma_f32 v[208:209], v[236:237], v[44:45], v[208:209] op_sel_hi:[0,1,1]
    v_pk_fma_f32 v[210:211], v[236:237], v[46:47], v[210:211] op_sel_hi:[0,1,1]
    s_waitcnt vmcnt(12)
    v_pk_fma_f32 v[212:213], v[236:237], v[48:49], v[212:213] op_sel_hi:[0,1,1]
    v_pk_fma_f32 v[214:215], v[236:237], v[50:51], v[214:215] op_sel_hi:[0,1,1]
    v_mov_b32_dpp v236, v238 row_newbcast:3 row_mask:0xf bank_mask:0xf
    s_waitcnt vmcnt(11)
    v_pk_fma_f32 v[204:205], v[236:237], v[52:53], v[204:205] op_sel_hi:[0,1,1]
    v_pk_fma_f32 v[206:207], v[236:237], v[54:55], v[206:207] op_sel_hi:[0,1,1]
    s_waitcnt vmcnt(10)
L_h57:
    s_cbranch_execz L_h58
    v_pk_fma_f32 v[208:209], v[236:237], v[56:57], v[208:209] op_sel_hi:[0,1,1]
    v_pk_fma_f32 v[210:211], v[236:237], v[58:59], v[210:211] op_sel_hi:[0,1,1]
    s_waitcnt vmcnt(9)
    v_pk_fma_f32 v[212:213], v[236:237], v[60:61], v[212:213] op_sel_hi:[0,1,1]
    v_pk_fma_f32 v[214:215], v[236:237], v[62:63], v[214:215] op_sel_hi:[0,1,1]
    v_mov_b32_dpp v236, v238 row_newbcast:11 row_mask:0xf bank_mask:0xf
    s_waitcnt vmcnt(8)
    v_pk_fma_f32 v[204:205], v[236:237], v[64:65], v[204:205] op_sel_hi:[0,1,1]
    v_pk_fma_f32 v[206:207], v[236:237], v[66:67], v[206:207] op_sel_hi:[0,1,1]
    s_waitcnt vmcnt(7)
    v_pk_fma_f32 v[208:209], v[236:237], v[68:69], v[208:209] op_sel_hi:[0,1,1]
    v_pk_fma_f32 v[210:211], v[236:237], v[70:71], v[210:211] op_sel_hi:[0,1,1]
    s_waitcnt vmcnt(6)
    v_pk_fma_f32 v[212:213], v[236:237], v[72:73], v[212:213] op_sel_hi:[0,1,1]
    v_pk_fma_f32 v[214:215], v[236:237], v[74:75], v[214:215] op_sel_hi:[0,1,1]
    v_mov_b32_dpp v236, v238 row_newbcast:7 row_mask:0xf bank_mask:0xf
    s_waitcnt vmcnt(5)
    v_pk_fma_f32 v[204:205], v[236:237], v[76:77], v[204:205] op_sel_hi:[0,1,1]
L_h58:
    s_cbranch_execz L_h59
    v_pk_fma_f32 v[206:207], v[236:237], v[78:79], v[206:207] op_sel_hi:[0,1,1]
    s_waitcnt vmcnt(4)
    v_pk_fma_f32 v[208:209], v[236:237], v[80:81], v[208:209] op_sel_hi:[0,1,1]
    v_pk_fma_f32 v[210:211], v[236:237], v[82:83], v[210:211] op_sel_hi:[0,1,1]
    s_waitcnt vmcnt(3)
    v_pk_fma_f32 v[212:213], v[236:237], v[84:85], v[212:213] op_sel_hi:[0,1,1]
    v_pk_fma_f32 v[214:215], v[236:237], v[86:87], v[214:215] op_sel_hi:[0,1,1]
    v_mov_b32_dpp v236, v238 row_newbcast:15 row_mask:0xf bank_mask:0xf
    s_waitcnt vmcnt(2)
    v_pk_fma_f32 v[204:205], v[236:237], v[88:89], v[204:205] op_sel_hi:[0,1,1]
    v_pk_fma_f32 v[206:207], v[236:237], v[90:91], v[206:207] op_sel_hi:[0,1,1]
    s_waitcnt vmcnt(1)
    v_pk_fma_f32 v[208:209], v[236:237], v[92:93], v[208:209] op_sel_hi:[0,1,1]
    v_pk_fma_f32 v[210:211], v[236:237], v[94:95], v[210:211] op_sel_hi:[0,1,1]
    v_permlane32_swap_b32 v204, v206
    v_permlane32_swap_b32 v205, v207
    v_add_f32 v204, v204, v206
    v_add_f32 v205, v205, v207
    v_permlane32_swap_b32 v208, v210
    v_permlane32_swap_b32 v209, v211
    v_add_f32 v208, v208, v210
L_h59:
    s_cbranch_execz L_h60
    v_add_f32 v209, v209, v211
    v_permlane16_swap_b32 v204, v205
    v_add_f32 v204, v204, v205
    v_fma_f32 v100, v204, s6, -v218
    v_permlane16_swap_b32 v208, v209
    v_add_f32 v208, v208, v209
    v_fma_f32 v101, v208, s6, -v218
    s_waitcnt vmcnt(0)
    v_pk_fma_f32 v[212:213], v[236:237], v[96:97], v[212:213] op_sel_hi:[0,1,1]
    v_pk_fma_f32 v[214:215], v[236:237], v[98:99], v[214:215] op_sel_hi:[0,1,1]
    s_nop 1
    v_permlane32_swap_b32 v212, v214
    v_permlane32_swap_b32 v213, v215
    v_add_f32 v212, v212, v214
    v_add_f32 v213, v213, v215
    s_nop 1
    v_permlane16_swap_b32 v212, v213
    v_add_f32 v212, v212, v213
    v_fma_f32 v102, v212, s6, -v218
    s_mov_b64 exec, s[88:89]
    buffer_store_dwordx4 v[100:103], v225, s[52:55], s78 offen offset:0
    s_not_b64 exec, exec
    buffer_store_dwordx4 v[100:103], v225, s[52:55], s78 offen offset:0 sc0 sc1
    s_mov_b64 exec, -1
L_final:
L_h60:
    s_cbranch_execz L_h61
    s_endpgm
L_th24_0:
    s_waitcnt vmcnt(32)
    s_cmp_eq_u32 vcc_lo, 1
    s_cbranch_scc1 L_tb24_0
    s_waitcnt vmcnt(23)
    s_branch L_tb24_0
L_th27_0:
    s_waitcnt vmcnt(26)
    s_cmp_eq_u32 vcc_lo, 1
    s_cbranch_scc1 L_tb27_0
    s_waitcnt vmcnt(23)
    s_branch L_tb27_0
L_th30_0:
    s_waitcnt vmcnt(32)
    s_cmp_eq_u32 vcc_lo, 1
    s_cbranch_scc1 L_tb30_0
    s_waitcnt vmcnt(29)
    s_branch L_tb30_0
L_th33_0:
    s_waitcnt vmcnt(32)
    s_cmp_eq_u32 vcc_lo, 1
    s_cbranch_scc1 L_tb33_0
    s_waitcnt vmcnt(29)
    s_branch L_tb33_0
L_th36_0:
    s_waitcnt vmcnt(35)
    s_cmp_eq_u32 vcc_lo, 1
    s_cbranch_scc1 L_tb36_0
    s_waitcnt vmcnt(26)
    s_branch L_tb36_0
L_th39_0:
    s_waitcnt vmcnt(29)
    s_cmp_eq_u32 vcc_lo, 1
    s_cbranch_scc1 L_tb39_0
    s_waitcnt vmcnt(26)
    s_branch L_tb39_0
L_h61:
    s_branch L_h62
L_th42_0:
    s_waitcnt vmcnt(35)
    s_cmp_eq_u32 vcc_lo, 1
    s_cbranch_scc1 L_tb42_0
    s_waitcnt vmcnt(32)
    s_branch L_tb42_0
L_th45_0:
    s_waitcnt vmcnt(35)
    s_cmp_eq_u32 vcc_lo, 1
    s_cbranch_scc1 L_tb45_0
    s_waitcnt vmcnt(32)
    s_branch L_tb45_0
L_th0_0:
    s_waitcnt vmcnt(35)
    s_cmp_eq_u32 vcc_lo, 1
    s_cbranch_scc1 L_tb0_0
    s_waitcnt vmcnt(26)
    s_branch L_tb0_0
L_th3_0:
    s_waitcnt vmcnt(29)
    s_cmp_eq_u32 vcc_lo, 1
    s_cbranch_scc1 L_tb3_0
    s_waitcnt vmcnt(26)
    s_branch L_tb3_0
L_th6_0:
    s_waitcnt vmcnt(35)
    s_cmp_eq_u32 vcc_lo, 1
    s_cbranch_scc1 L_tb6_0
    s_waitcnt vmcnt(29)
    s_branch L_tb6_0
L_th9_0:
    s_waitcnt vmcnt(32)
    s_cmp_eq_u32 vcc_lo, 1
    s_cbranch_scc1 L_tb9_0
    s_waitcnt vmcnt(29)
    s_branch L_tb9_0
L_th12_0:
    s_waitcnt vmcnt(32)
L_h62:
    s_cbranch_execz L_h63
    s_cmp_eq_u32 vcc_lo, 1
    s_cbranch_scc1 L_tb12_0
    s_waitcnt vmcnt(23)
    s_branch L_tb12_0
L_th15_0:
    s_waitcnt vmcnt(26)
    s_cmp_eq_u32 vcc_lo, 1
    s_cbranch_scc1 L_tb15_0
    s_waitcnt vmcnt(23)
    s_branch L_tb15_0
L_th18_0:
    s_waitcnt vmcnt(32)
    s_cmp_eq_u32 vcc_lo, 1
    s_cbranch_scc1 L_tb18_0
    s_waitcnt vmcnt(29)
    s_branch L_tb18_0
L_th21_0:
    s_waitcnt vmcnt(32)
    s_cmp_eq_u32 vcc_lo, 1
    s_cbranch_scc1 L_tb21_0
    s_waitcnt vmcnt(29)
    s_branch L_tb21_0
L_th24_1:
    s_waitcnt vmcnt(32)
    s_cmp_eq_u32 vcc_lo, 1
    s_cbranch_scc1 L_tb24_1
    s_waitcnt vmcnt(23)
    s_branch L_tb24_1
L_th27_1:
    s_waitcnt vmcnt(26)
    s_cmp_eq_u32 vcc_lo, 1
    s_cbranch_scc1 L_tb27_1
    s_waitcnt vmcnt(23)
    s_branch L_tb27_1
L_th30_1:
    s_waitcnt vmcnt(32)
    s_cmp_eq_u32 vcc_lo, 1
L_h63:
    s_cbranch_execz L_h64
    s_cbranch_scc1 L_tb30_1
    s_waitcnt vmcnt(29)
    s_branch L_tb30_1
L_th33_1:
    s_waitcnt vmcnt(32)
    s_cmp_eq_u32 vcc_lo, 1
    s_cbranch_scc1 L_tb33_1
    s_waitcnt vmcnt(29)
    s_branch L_tb33_1
L_th36_1:
    s_waitcnt vmcnt(34)
    s_cmp_eq_u32 vcc_lo, 1
    s_cbranch_scc1 L_tb36_1
    s_waitcnt vmcnt(25)
    s_branch L_tb36_1
L_th39_1:
    s_waitcnt vmcnt(28)
    s_cmp_eq_u32 vcc_lo, 1
    s_cbranch_scc1 L_tb39_1
    s_waitcnt vmcnt(25)
    s_branch L_tb39_1
L_th42_1:
    s_waitcnt vmcnt(28)
    s_cmp_eq_u32 vcc_lo, 1
    s_cbranch_scc1 L_tb42_1
    s_waitcnt vmcnt(25)
    s_branch L_tb42_1
L_th45_1:
    s_waitcnt vmcnt(28)
    s_cmp_eq_u32 vcc_lo, 1
    s_cbranch_scc1 L_tb45_1
    s_waitcnt vmcnt(25)
    s_branch L_tb45_1
L_th0_1:
    s_waitcnt vmcnt(28)
    s_cmp_eq_u32 vcc_lo, 1
    s_cbranch_scc1 L_tb0_1
L_h64:
    s_cbranch_execz L_h65
    s_waitcnt vmcnt(19)
    s_branch L_tb0_1
L_th3_1:
    s_waitcnt vmcnt(22)
    s_cmp_eq_u32 vcc_lo, 1
    s_cbranch_scc1 L_tb3_1
    s_waitcnt vmcnt(19)
    s_branch L_tb3_1
L_th6_1:
    s_waitcnt vmcnt(22)
    s_cmp_eq_u32 vcc_lo, 1
    s_cbranch_scc1 L_tb6_1
    s_waitcnt vmcnt(17)
    s_branch L_tb6_1
L_th9_1:
    s_waitcnt vmcnt(20)
    s_cmp_eq_u32 vcc_lo, 1
    s_cbranch_scc1 L_tb9_1
    s_waitcnt vmcnt(17)
    s_branch L_tb9_1
L_th12_1:
    s_waitcnt vmcnt(20)
    s_cmp_eq_u32 vcc_lo, 1
    s_cbranch_scc1 L_tb12_1
    s_waitcnt vmcnt(17)
    s_branch L_tb12_1
L_th15_1:
    s_waitcnt vmcnt(20)
    s_cmp_eq_u32 vcc_lo, 1
    s_cbranch_scc1 L_tb15_1
    s_waitcnt vmcnt(17)
    s_branch L_tb15_1
L_th18_1:
    s_waitcnt vmcnt(20)
    s_cmp_eq_u32 vcc_lo, 1
    s_cbranch_scc1 L_tb18_1
    s_waitcnt vmcnt(17)
L_h65:
    s_cbranch_execz L_h66
    s_branch L_tb18_1
L_th21_1:
    s_waitcnt vmcnt(20)
    s_cmp_eq_u32 vcc_lo, 1
    s_cbranch_scc1 L_tb21_1
    s_waitcnt vmcnt(17)
    s_branch L_tb21_1
L_th24_2:
    s_nop 11
    s_waitcnt vmcnt(20)
    s_cmp_eq_u32 vcc_lo, 1
    s_cbranch_scc1 L_tb24_2
    s_waitcnt vmcnt(17)
    s_branch L_tb24_2
L_th27_2:
    s_nop 11
    s_waitcnt vmcnt(20)
    s_cmp_eq_u32 vcc_lo, 1
    s_cbranch_scc1 L_tb27_2
    s_waitcnt vmcnt(17)
    s_branch L_tb27_2
L_th30_2:
    s_nop 11
    s_waitcnt vmcnt(20)
    s_cmp_eq_u32 vcc_lo, 1
    s_cbranch_scc1 L_tb30_2
    s_waitcnt vmcnt(17)
    s_branch L_tb30_2
L_th33_2:
    s_nop 11
    s_waitcnt vmcnt(20)
    s_cmp_eq_u32 vcc_lo, 1
    s_cbranch_scc1 L_tb33_2
    s_waitcnt vmcnt(17)
    s_branch L_tb33_2
L_th36_2:
    s_nop 11
L_h66:
    s_cbranch_execz L_h67
    s_waitcnt vmcnt(22)
    s_cmp_eq_u32 vcc_lo, 1
    s_cbranch_scc1 L_tb36_2
    s_waitcnt vmcnt(19)
    s_branch L_tb36_2
L_th39_2:
    s_nop 11
    s_waitcnt vmcnt(22)
    s_cmp_eq_u32 vcc_lo, 1
    s_cbranch_scc1 L_tb39_2
    s_waitcnt vmcnt(19)
    s_branch L_tb39_2
L_th42_2:
    s_nop 11
    s_waitcnt vmcnt(22)
    s_cmp_eq_u32 vcc_lo, 1
    s_cbranch_scc1 L_tb42_2
    s_waitcnt vmcnt(19)
    s_branch L_tb42_2
L_th45_2:
    s_nop 11
    s_waitcnt vmcnt(22)
    s_cmp_eq_u32 vcc_lo, 1
    s_cbranch_scc1 L_tb45_2
    s_waitcnt vmcnt(19)
    s_branch L_tb45_2
L_getm2:
    ds_read_b32 v227, v243 offset:139
    ds_read_b32 v226, v243 offset:159
    s_waitcnt lgkmcnt(0)
    v_readfirstlane_b32 s93, v227
    v_readfirstlane_b32 s77, v226
    s_cmp_eq_u32 s93, 0
L_h67:
    s_cbranch_execz L_h68
    s_cbranch_scc1 L_getm2
    ds_read_b32 v226, v243 offset:151
    s_waitcnt lgkmcnt(0)
    v_readfirstlane_b32 s88, v226
    s_cmp_eq_u32 s88, -1
    s_cselect_b64 s[88:89], -1, 0
    s_branch L_gotm2
L_th0_2:
    s_nop 11
    s_waitcnt vmcnt(22)
    s_cmp_eq_u32 vcc_lo, 1
    s_cbranch_scc1 L_tb0_2
    s_waitcnt vmcnt(19)
    s_branch L_tb0_2
L_th3_2:
    s_nop 11
    s_waitcnt vmcnt(22)
    s_cmp_eq_u32 vcc_lo, 1
    s_cbranch_scc1 L_tb3_2
    s_waitcnt vmcnt(19)
    s_branch L_tb3_2
L_th6_2:
    s_nop 11
    s_waitcnt vmcnt(22)
    s_cmp_eq_u32 vcc_lo, 1
    s_cbranch_scc1 L_tb6_2
    s_waitcnt vmcnt(17)
    s_branch L_tb6_2
L_th9_2:
    s_nop 11
    s_waitcnt vmcnt(20)
    s_cmp_eq_u32 vcc_lo, 1
    s_cbranch_scc1 L_tb9_2
    s_waitcnt vmcnt(17)
L_h68:
    s_cbranch_execz L_h69
    s_branch L_tb9_2
L_th12_2:
    s_nop 11
    s_waitcnt vmcnt(20)
    s_cmp_eq_u32 vcc_lo, 1
    s_cbranch_scc1 L_tb12_2
    s_waitcnt vmcnt(17)
    s_branch L_tb12_2
L_th15_2:
    s_nop 11
    s_waitcnt vmcnt(20)
    s_cmp_eq_u32 vcc_lo, 1
    s_cbranch_scc1 L_tb15_2
    s_waitcnt vmcnt(17)
    s_branch L_tb15_2
L_th18_2:
    s_nop 11
    s_waitcnt vmcnt(20)
    s_cmp_eq_u32 vcc_lo, 1
    s_cbranch_scc1 L_tb18_2
    s_waitcnt vmcnt(17)
    s_branch L_tb18_2
L_th21_2:
    s_nop 11
    s_waitcnt vmcnt(20)
    s_cmp_eq_u32 vcc_lo, 1
    s_cbranch_scc1 L_tb21_2
    s_waitcnt vmcnt(17)
    s_branch L_tb21_2
L_th24_3:
    s_nop 11
    s_waitcnt vmcnt(20)
    s_cmp_eq_u32 vcc_lo, 1
    s_cbranch_scc1 L_tb24_3
    s_waitcnt vmcnt(17)
    s_branch L_tb24_3
L_h69:
    s_branch L_h70
L_th27_3:
    s_nop 11
    s_waitcnt vmcnt(20)
    s_cmp_eq_u32 vcc_lo, 1
    s_cbranch_scc1 L_tb27_3
    s_waitcnt vmcnt(17)
    s_branch L_tb27_3
L_th30_3:
    s_nop 11
    s_waitcnt vmcnt(20)
    s_cmp_eq_u32 vcc_lo, 1
    s_cbranch_scc1 L_tb30_3
    s_waitcnt vmcnt(17)
    s_branch L_tb30_3
L_th33_3:
    s_nop 11
    s_waitcnt vmcnt(20)
    s_cmp_eq_u32 vcc_lo, 1
    s_cbranch_scc1 L_tb33_3
    s_waitcnt vmcnt(17)
    s_branch L_tb33_3
L_th36_3:
    s_nop 11
    s_waitcnt vmcnt(20)
    s_cmp_eq_u32 vcc_lo, 1
    s_cbranch_scc1 L_tb36_3
    s_waitcnt vmcnt(17)
    s_branch L_tb36_3
L_th39_3:
    s_nop 11
    s_waitcnt vmcnt(20)
    s_cmp_eq_u32 vcc_lo, 1
    s_cbranch_scc1 L_tb39_3
    s_waitcnt vmcnt(17)
    s_branch L_tb39_3
L_th42_3:
    s_nop 11
L_h70:
    s_cbranch_execz L_hopped
    s_waitcnt vmcnt(20)
    s_cmp_eq_u32 vcc_lo, 1
    s_cbranch_scc1 L_tb42_3
    s_waitcnt vmcnt(17)
    s_branch L_tb42_3
L_th45_3:
    s_nop 11
    s_waitcnt vmcnt(20)
    s_cmp_eq_u32 vcc_lo, 1
    s_cbranch_scc1 L_tb45_3
    s_waitcnt vmcnt(17)
    s_branch L_tb45_3
L_service:
    v_lshlrev_b32 v5, 2, v0
    v_mov_b32 v3, 0
    ds_write_b32 v5, v3 offset:0
    v_lshlrev_b32 v1, 4, v0
    v_lshlrev_b32 v28, 11, v0
    v_mov_b32 v9, 0xf149f2ca
    v_cndmask_b32 v9, v9, v3, s[66:67]
    v_and_b32 v5, 15, v0
    v_lshrrev_b32 v6, 4, v0
    v_lshl_add_u32 v11, v5, 2, v6
    v_lshlrev_b32 v11, 1, v11
    s_getreg_b32 s72, hwreg(HW_REG_XCC_ID)
    s_and_b32 s72, s72, 15
    s_waitcnt lgkmcnt(0)
    s_barrier
    s_branch L_w0
L_walked:
    s_mov_b32 s24, s6
    s_and_b32 s25, s7, 0xffff
    s_mov_b32 s26, 805306368
    s_mov_b32 s27, 0x00020000
    s_mov_b32 s28, s8
    s_and_b32 s29, s9, 0xffff
    s_mov_b32 s30, 805306368
    s_mov_b32 s31, 0x00020000
    s_mov_b32 s32, s10
    s_and_b32 s33, s11, 0xffff
    s_mov_b32 s34, 6291456
    s_mov_b32 s35, 0x00020000
    s_mov_b32 s36, s12
    s_and_b32 s37, s13, 0xffff
    s_mov_b32 s38, 6291456
    s_mov_b32 s39, 0x00020000
    s_mov_b32 s40, s14
    s_and_b32 s41, s15, 0xffff
    s_mov_b32 s42, 2097152
    s_mov_b32 s43, 0x00020000
    s_mov_b32 s44, s16
    s_and_b32 s45, s17, 0xffff
    s_mov_b32 s46, 2097152
    s_mov_b32 s47, 0x00020000
    s_mov_b32 s48, s4
    s_and_b32 s49, s5, 0xffff
    s_mov_b32 s50, 12288
    s_mov_b32 s51, 0x00020000
    s_mov_b32 s52, s22
    s_and_b32 s53, s23, 0xffff
    s_mov_b32 s54, 25165824
    s_mov_b32 s55, 0x00020000
    s_mov_b64 exec, 0
    s_branch L_h0
L_hopped:
    s_mov_b64 exec, -1
    s_mov_b32 s52, s22
    s_and_b32 s53, s23, 0xffff
    s_mov_b32 s54, 25165824
    s_mov_b32 s55, 0x00020000
    s_mov_b32 s56, s18
    s_and_b32 s57, s19, 0xffff
    s_mov_b32 s58, 12288
    s_mov_b32 s59, 0x00020000
    s_mov_b32 s96, s79
    s_and_b32 s82, s79, 3
    s_lshl_b32 s82, s82, 4
    v_mov_b32 v10, 0
    s_mov_b32 s80, 0x2010200
    s_mov_b32 s81, 0x2030202
    s_cmp_ge_u32 s79, 4
    s_cmov_b32 s80, 0x2050204
    s_cmov_b32 s81, 0x2070206
    s_lshr_b64 s[80:81], s[80:81], s82
    v_writelane_b32 v10, s80, 0
    s_mov_b32 s80, 0x2090208
    s_mov_b32 s81, 0x20b020a
    s_cmp_ge_u32 s79, 4
    s_cmov_b32 s80, 0x20d020c
    s_cmov_b32 s81, 0x20f020e
    s_lshr_b64 s[80:81], s[80:81], s82
    v_writelane_b32 v10, s80, 1
    s_mov_b32 s80, 0x4d00150
    s_mov_b32 s81, 0x8310571
    s_cmp_ge_u32 s79, 4
    s_cmov_b32 s80, 0x57304d2
    s_cmov_b32 s81, 0x4b40174
    s_lshr_b64 s[80:81], s[80:81], s82
    v_writelane_b32 v10, s80, 2
    s_mov_b32 s80, 0x9100d5
    s_mov_b32 s81, 0x15204b6
    s_cmp_ge_u32 s79, 4
    s_cmov_b32 s80, 0x4b700b3
    s_cmov_b32 s81, 0x8d508b7
    s_lshr_b64 s[80:81], s[80:81], s82
    v_writelane_b32 v10, s80, 3
    s_mov_b32 s80, 0x4950000
    s_mov_b32 s81, 0x8b60000
    s_cmp_ge_u32 s79, 4
    s_cmov_b32 s80, 0xc96
    s_cmov_b32 s81, 0xcb70000
    s_lshr_b64 s[80:81], s[80:81], s82
    v_writelane_b32 v10, s80, 4
    s_mov_b32 s80, 0x560000
    s_mov_b32 s81, 0x0
    s_cmp_ge_u32 s79, 4
    s_cmov_b32 s80, 0x37
    s_cmov_b32 s81, 0x0
    s_lshr_b64 s[80:81], s[80:81], s82
    v_writelane_b32 v10, s80, 5
    v_and_b32 v10, 0xffff, v10
L_tag:
    ds_read_b32 v5, v3 offset:140
    ds_read_b64 v[16:17], v3 offset:152
    s_waitcnt lgkmcnt(0)
    v_readfirstlane_b32 s69, v5
    s_cmp_eq_u32 s69, 0
    s_cbranch_scc1 L_tag
    v_readfirstlane_b32 s86, v16
    v_readfirstlane_b32 s87, v17
    s_bfm_b64 s[84:85], s92, 0
    s_bcnt1_i32_b64 s70, s[86:87]
    s_and_b64 s[84:85], s[84:85], s[86:87]
    s_bcnt1_i32_b64 s71, s[84:85]
    s_mov_b32 s73, s71
L_round:
    s_min_u32 s80, s71, 63
    v_readlane_b32 s97, v10, s80
    s_lshl_b32 s80, s71, 2
    v_mov_b32 v4, s80
    s_cmp_eq_u32 s97, 0
    s_cbranch_scc1 L_last
L_poll:
    ds_read_b32 v5, v4 offset:0
    s_waitcnt lgkmcnt(0)
    v_readfirstlane_b32 s80, v5
    s_cmp_eq_u32 s80, 0
    s_cbranch_scc1 L_poll
    s_add_u32 s95, s69, s71
    s_add_u32 s95, s95, 1
    s_and_b32 s80, s71, 1
    s_lshl_b32 s80, s80, 19
    s_add_u32 s80, s80, 2097152
    s_lshl_b32 s77, s2, 11
    s_add_u32 s77, s77, s80
    s_lshl_b32 s75, s96, 16
    s_add_u32 s75, s75, s80
L_all:
    v_mov_b32 v16, s95
    s_mov_b64 exec, s[86:87]
    buffer_load_dword v16, v28, s[52:55], s75 offen offset:1024 sc0 sc1
    s_mov_b64 exec, -1
    s_waitcnt vmcnt(0)
    v_cmp_ne_u32 vcc, s95, v16
    s_cmp_lg_u64 vcc, 0
    s_cbranch_scc1 L_all
    s_mov_b32 s74, 0
    s_mov_b64 s[84:85], s[86:87]
L_merge:
    v_mov_b32 v7, 0xf149f2ca
    v_mov_b32 v8, 0
    v_mov_b32 v12, 0
    v_mov_b32 v13, 0
    v_mov_b32 v14, 0
L_chunk:
    v_mov_b32 v48, 0
    v_mov_b32 v49, 0
    v_mov_b32 v50, 0
    v_mov_b32 v51, v9
    v_mov_b32 v52, 0
    v_mov_b32 v53, 0
    v_mov_b32 v54, 0
    v_mov_b32 v55, v9
    v_mov_b32 v56, 0
    v_mov_b32 v57, 0
    v_mov_b32 v58, 0
    v_mov_b32 v59, v9
    v_mov_b32 v60, 0
    v_mov_b32 v61, 0
    v_mov_b32 v62, 0
    v_mov_b32 v63, v9
    v_mov_b32 v64, 0
    v_mov_b32 v65, 0
    v_mov_b32 v66, 0
    v_mov_b32 v67, v9
    v_mov_b32 v68, 0
    v_mov_b32 v69, 0
    v_mov_b32 v70, 0
    v_mov_b32 v71, v9
    v_mov_b32 v72, 0
    v_mov_b32 v73, 0
    v_mov_b32 v74, 0
    v_mov_b32 v75, v9
    v_mov_b32 v76, 0
    v_mov_b32 v77, 0
    v_mov_b32 v78, 0
    v_mov_b32 v79, v9
    v_mov_b32 v80, 0
    v_mov_b32 v81, 0
    v_mov_b32 v82, 0
    v_mov_b32 v83, v9
    v_mov_b32 v84, 0
    v_mov_b32 v85, 0
    v_mov_b32 v86, 0
    v_mov_b32 v87, v9
    v_mov_b32 v88, 0
    v_mov_b32 v89, 0
    v_mov_b32 v90, 0
    v_mov_b32 v91, v9
    v_mov_b32 v92, 0
    v_mov_b32 v93, 0
    v_mov_b32 v94, 0
    v_mov_b32 v95, v9
    v_mov_b32 v96, 0
    v_mov_b32 v97, 0
    v_mov_b32 v98, 0
    v_mov_b32 v99, v9
    v_mov_b32 v100, 0
    v_mov_b32 v101, 0
    v_mov_b32 v102, 0
    v_mov_b32 v103, v9
    v_mov_b32 v104, 0
    v_mov_b32 v105, 0
    v_mov_b32 v106, 0
    v_mov_b32 v107, v9
    v_mov_b32 v108, 0
    v_mov_b32 v109, 0
    v_mov_b32 v110, 0
    v_mov_b32 v111, v9
    v_mov_b32 v112, 0
    v_mov_b32 v113, 0
    v_mov_b32 v114, 0
    v_mov_b32 v115, v9
    v_mov_b32 v116, 0
    v_mov_b32 v117, 0
    v_mov_b32 v118, 0
    v_mov_b32 v119, v9
    v_mov_b32 v120, 0
    v_mov_b32 v121, 0
    v_mov_b32 v122, 0
    v_mov_b32 v123, v9
    v_mov_b32 v124, 0
    v_mov_b32 v125, 0
    v_mov_b32 v126, 0
    v_mov_b32 v127, v9
    v_mov_b32 v128, 0
    v_mov_b32 v129, 0
    v_mov_b32 v130, 0
    v_mov_b32 v131, v9
    v_mov_b32 v132, 0
    v_mov_b32 v133, 0
    v_mov_b32 v134, 0
    v_mov_b32 v135, v9
    v_mov_b32 v136, 0
    v_mov_b32 v137, 0
    v_mov_b32 v138, 0
    v_mov_b32 v139, v9
    v_mov_b32 v140, 0
    v_mov_b32 v141, 0
    v_mov_b32 v142, 0
    v_mov_b32 v143, v9
    v_mov_b32 v144, 0
    v_mov_b32 v145, 0
    v_mov_b32 v146, 0
    v_mov_b32 v147, v9
    v_mov_b32 v148, 0
    v_mov_b32 v149, 0
    v_mov_b32 v150, 0
    v_mov_b32 v151, v9
    v_mov_b32 v152, 0
    v_mov_b32 v153, 0
    v_mov_b32 v154, 0
    v_mov_b32 v155, v9
    v_mov_b32 v156, 0
    v_mov_b32 v157, 0
    v_mov_b32 v158, 0
    v_mov_b32 v159, v9
    v_mov_b32 v160, 0
    v_mov_b32 v161, 0
    v_mov_b32 v162, 0
    v_mov_b32 v163, v9
    v_mov_b32 v164, 0
    v_mov_b32 v165, 0
    v_mov_b32 v166, 0
    v_mov_b32 v167, v9
    v_mov_b32 v168, 0
    v_mov_b32 v169, 0
    v_mov_b32 v170, 0
    v_mov_b32 v171, v9
    v_mov_b32 v172, 0
    v_mov_b32 v173, 0
    v_mov_b32 v174, 0
    v_mov_b32 v175, v9
    s_ff1_i32_b64 s80, s[84:85]
    s_bitset0_b64 s[84:85], s80
    s_lshl_b32 s81, s80, 11
    s_add_u32 s81, s81, s75
    s_cmp_ge_i32 s80, 0
    s_cselect_b64 exec, -1, 0
    buffer_load_dwordx4 v[48:51], v1, s[52:55], s81 offen sc0 sc1
    s_ff1_i32_b64 s80, s[84:85]
    s_bitset0_b64 s[84:85], s80
    s_lshl_b32 s81, s80, 11
    s_add_u32 s81, s81, s75
    s_cmp_ge_i32 s80, 0
    s_cselect_b64 exec, -1, 0
    buffer_load_dwordx4 v[52:55], v1, s[52:55], s81 offen sc0 sc1
    s_ff1_i32_b64 s80, s[84:85]
    s_bitset0_b64 s[84:85], s80
    s_lshl_b32 s81, s80, 11
    s_add_u32 s81, s81, s75
    s_cmp_ge_i32 s80, 0
    s_cselect_b64 exec, -1, 0
    buffer_load_dwordx4 v[56:59], v1, s[52:55], s81 offen sc0 sc1
    s_ff1_i32_b64 s80, s[84:85]
    s_bitset0_b64 s[84:85], s80
    s_lshl_b32 s81, s80, 11
    s_add_u32 s81, s81, s75
    s_cmp_ge_i32 s80, 0
    s_cselect_b64 exec, -1, 0
    buffer_load_dwordx4 v[60:63], v1, s[52:55], s81 offen sc0 sc1
    s_ff1_i32_b64 s80, s[84:85]
    s_bitset0_b64 s[84:85], s80
    s_lshl_b32 s81, s80, 11
    s_add_u32 s81, s81, s75
    s_cmp_ge_i32 s80, 0
    s_cselect_b64 exec, -1, 0
    buffer_load_dwordx4 v[64:67], v1, s[52:55], s81 offen sc0 sc1
    s_ff1_i32_b64 s80, s[84:85]
    s_bitset0_b64 s[84:85], s80
    s_lshl_b32 s81, s80, 11
    s_add_u32 s81, s81, s75
    s_cmp_ge_i32 s80, 0
    s_cselect_b64 exec, -1, 0
    buffer_load_dwordx4 v[68:71], v1, s[52:55], s81 offen sc0 sc1
    s_ff1_i32_b64 s80, s[84:85]
    s_bitset0_b64 s[84:85], s80
    s_lshl_b32 s81, s80, 11
    s_add_u32 s81, s81, s75
    s_cmp_ge_i32 s80, 0
    s_cselect_b64 exec, -1, 0
    buffer_load_dwordx4 v[72:75], v1, s[52:55], s81 offen sc0 sc1
    s_ff1_i32_b64 s80, s[84:85]
    s_bitset0_b64 s[84:85], s80
    s_lshl_b32 s81, s80, 11
    s_add_u32 s81, s81, s75
    s_cmp_ge_i32 s80, 0
    s_cselect_b64 exec, -1, 0
    buffer_load_dwordx4 v[76:79], v1, s[52:55], s81 offen sc0 sc1
    s_ff1_i32_b64 s80, s[84:85]
    s_bitset0_b64 s[84:85], s80
    s_lshl_b32 s81, s80, 11
    s_add_u32 s81, s81, s75
    s_cmp_ge_i32 s80, 0
    s_cbranch_scc0 L_got
    s_cselect_b64 exec, -1, 0
    buffer_load_dwordx4 v[80:83], v1, s[52:55], s81 offen sc0 sc1
    s_ff1_i32_b64 s80, s[84:85]
    s_bitset0_b64 s[84:85], s80
    s_lshl_b32 s81, s80, 11
    s_add_u32 s81, s81, s75
    s_cmp_ge_i32 s80, 0
    s_cselect_b64 exec, -1, 0
    buffer_load_dwordx4 v[84:87], v1, s[52:55], s81 offen sc0 sc1
    s_ff1_i32_b64 s80, s[84:85]
    s_bitset0_b64 s[84:85], s80
    s_lshl_b32 s81, s80, 11
    s_add_u32 s81, s81, s75
    s_cmp_ge_i32 s80, 0
    s_cselect_b64 exec, -1, 0
    buffer_load_dwordx4 v[88:91], v1, s[52:55], s81 offen sc0 sc1
    s_ff1_i32_b64 s80, s[84:85]
    s_bitset0_b64 s[84:85], s80
    s_lshl_b32 s81, s80, 11
    s_add_u32 s81, s81, s75
    s_cmp_ge_i32 s80, 0
    s_cselect_b64 exec, -1, 0
    buffer_load_dwordx4 v[92:95], v1, s[52:55], s81 offen sc0 sc1
    s_ff1_i32_b64 s80, s[84:85]
    s_bitset0_b64 s[84:85], s80
    s_lshl_b32 s81, s80, 11
    s_add_u32 s81, s81, s75
    s_cmp_ge_i32 s80, 0
    s_cselect_b64 exec, -1, 0
    buffer_load_dwordx4 v[96:99], v1, s[52:55], s81 offen sc0 sc1
    s_ff1_i32_b64 s80, s[84:85]
    s_bitset0_b64 s[84:85], s80
    s_lshl_b32 s81, s80, 11
    s_add_u32 s81, s81, s75
    s_cmp_ge_i32 s80, 0
    s_cselect_b64 exec, -1, 0
    buffer_load_dwordx4 v[100:103], v1, s[52:55], s81 offen sc0 sc1
    s_ff1_i32_b64 s80, s[84:85]
    s_bitset0_b64 s[84:85], s80
    s_lshl_b32 s81, s80, 11
    s_add_u32 s81, s81, s75
    s_cmp_ge_i32 s80, 0
    s_cselect_b64 exec, -1, 0
    buffer_load_dwordx4 v[104:107], v1, s[52:55], s81 offen sc0 sc1
    s_ff1_i32_b64 s80, s[84:85]
    s_bitset0_b64 s[84:85], s80
    s_lshl_b32 s81, s80, 11
    s_add_u32 s81, s81, s75
    s_cmp_ge_i32 s80, 0
    s_cselect_b64 exec, -1, 0
    buffer_load_dwordx4 v[108:111], v1, s[52:55], s81 offen sc0 sc1
    s_ff1_i32_b64 s80, s[84:85]
    s_bitset0_b64 s[84:85], s80
    s_lshl_b32 s81, s80, 11
    s_add_u32 s81, s81, s75
    s_cmp_ge_i32 s80, 0
    s_cbranch_scc0 L_got
    s_cselect_b64 exec, -1, 0
    buffer_load_dwordx4 v[112:115], v1, s[52:55], s81 offen sc0 sc1
    s_ff1_i32_b64 s80, s[84:85]
    s_bitset0_b64 s[84:85], s80
    s_lshl_b32 s81, s80, 11
    s_add_u32 s81, s81, s75
    s_cmp_ge_i32 s80, 0
    s_cselect_b64 exec, -1, 0
    buffer_load_dwordx4 v[116:119], v1, s[52:55], s81 offen sc0 sc1
    s_ff1_i32_b64 s80, s[84:85]
    s_bitset0_b64 s[84:85], s80
    s_branch L_x1
L_w1:
    s_branch L_w2
L_x1:
    s_lshl_b32 s81, s80, 11
    s_add_u32 s81, s81, s75
    s_cmp_ge_i32 s80, 0
    s_cselect_b64 exec, -1, 0
    buffer_load_dwordx4 v[120:123], v1, s[52:55], s81 offen sc0 sc1
    s_ff1_i32_b64 s80, s[84:85]
    s_bitset0_b64 s[84:85], s80
    s_lshl_b32 s81, s80, 11
    s_add_u32 s81, s81, s75
    s_cmp_ge_i32 s80, 0
    s_cselect_b64 exec, -1, 0
    buffer_load_dwordx4 v[124:127], v1, s[52:55], s81 offen sc0 sc1
    s_ff1_i32_b64 s80, s[84:85]
    s_bitset0_b64 s[84:85], s80
    s_lshl_b32 s81, s80, 11
    s_add_u32 s81, s81, s75
    s_cmp_ge_i32 s80, 0
    s_cselect_b64 exec, -1, 0
    buffer_load_dwordx4 v[128:131], v1, s[52:55], s81 offen sc0 sc1
    s_ff1_i32_b64 s80, s[84:85]
    s_bitset0_b64 s[84:85], s80
    s_lshl_b32 s81, s80, 11
    s_add_u32 s81, s81, s75
    s_cmp_ge_i32 s80, 0
    s_cselect_b64 exec, -1, 0
    buffer_load_dwordx4 v[132:135], v1, s[52:55], s81 offen sc0 sc1
    s_ff1_i32_b64 s80, s[84:85]
    s_bitset0_b64 s[84:85], s80
    s_lshl_b32 s81, s80, 11
    s_add_u32 s81, s81, s75
    s_cmp_ge_i32 s80, 0
    s_cselect_b64 exec, -1, 0
    buffer_load_dwordx4 v[136:139], v1, s[52:55], s81 offen sc0 sc1
    s_ff1_i32_b64 s80, s[84:85]
    s_bitset0_b64 s[84:85], s80
    s_lshl_b32 s81, s80, 11
    s_add_u32 s81, s81, s75
    s_cmp_ge_i32 s80, 0
    s_cselect_b64 exec, -1, 0
    buffer_load_dwordx4 v[140:143], v1, s[52:55], s81 offen sc0 sc1
    s_ff1_i32_b64 s80, s[84:85]
    s_bitset0_b64 s[84:85], s80
    s_lshl_b32 s81, s80, 11
    s_add_u32 s81, s81, s75
    s_cmp_ge_i32 s80, 0
    s_cbranch_scc0 L_got
    s_cselect_b64 exec, -1, 0
    buffer_load_dwordx4 v[144:147], v1, s[52:55], s81 offen sc0 sc1
    s_ff1_i32_b64 s80, s[84:85]
    s_bitset0_b64 s[84:85], s80
    s_lshl_b32 s81, s80, 11
    s_add_u32 s81, s81, s75
    s_cmp_ge_i32 s80, 0
    s_cselect_b64 exec, -1, 0
    buffer_load_dwordx4 v[148:151], v1, s[52:55], s81 offen sc0 sc1
    s_ff1_i32_b64 s80, s[84:85]
    s_bitset0_b64 s[84:85], s80
    s_lshl_b32 s81, s80, 11
    s_add_u32 s81, s81, s75
    s_cmp_ge_i32 s80, 0
    s_cselect_b64 exec, -1, 0
    buffer_load_dwordx4 v[152:155], v1, s[52:55], s81 offen sc0 sc1
    s_ff1_i32_b64 s80, s[84:85]
    s_bitset0_b64 s[84:85], s80
    s_lshl_b32 s81, s80, 11
    s_add_u32 s81, s81, s75
    s_cmp_ge_i32 s80, 0
    s_cselect_b64 exec, -1, 0
    buffer_load_dwordx4 v[156:159], v1, s[52:55], s81 offen sc0 sc1
    s_ff1_i32_b64 s80, s[84:85]
    s_bitset0_b64 s[84:85], s80
    s_lshl_b32 s81, s80, 11
    s_add_u32 s81, s81, s75
    s_cmp_ge_i32 s80, 0
    s_cselect_b64 exec, -1, 0
    buffer_load_dwordx4 v[160:163], v1, s[52:55], s81 offen sc0 sc1
    s_ff1_i32_b64 s80, s[84:85]
    s_bitset0_b64 s[84:85], s80
    s_lshl_b32 s81, s80, 11
    s_add_u32 s81, s81, s75
    s_cmp_ge_i32 s80, 0
    s_cselect_b64 exec, -1, 0
    buffer_load_dwordx4 v[164:167], v1, s[52:55], s81 offen sc0 sc1
    s_ff1_i32_b64 s80, s[84:85]
    s_bitset0_b64 s[84:85], s80
    s_lshl_b32 s81, s80, 11
    s_add_u32 s81, s81, s75
    s_cmp_ge_i32 s80, 0
    s_cselect_b64 exec, -1, 0
    buffer_load_dwordx4 v[168:171], v1, s[52:55], s81 offen sc0 sc1
    s_ff1_i32_b64 s80, s[84:85]
    s_bitset0_b64 s[84:85], s80
    s_lshl_b32 s81, s80, 11
    s_add_u32 s81, s81, s75
    s_cmp_ge_i32 s80, 0
    s_cselect_b64 exec, -1, 0
    buffer_load_dwordx4 v[172:175], v1, s[52:55], s81 offen sc0 sc1
L_got:
    s_mov_b64 exec, -1
    s_waitcnt vmcnt(0)
    v_max_f32 v5, v51, v55
    v_max3_f32 v5, v5, v59, v63
    v_max3_f32 v5, v5, v67, v71
    v_max3_f32 v5, v5, v75, v79
    v_max3_f32 v5, v5, v83, v87
    v_max3_f32 v5, v5, v91, v95
    v_max3_f32 v5, v5, v99, v103
    v_max3_f32 v5, v5, v107, v111
    v_max3_f32 v5, v5, v115, v119
    v_max3_f32 v5, v5, v123, v127
    v_max3_f32 v5, v5, v131, v135
    v_max3_f32 v5, v5, v139, v143
    v_max3_f32 v5, v5, v147, v151
    v_max3_f32 v5, v5, v155, v159
    v_max3_f32 v5, v5, v163, v167
    v_max3_f32 v5, v5, v171, v175
    s_nop 1
    v_max_f32_dpp v6, v5, v7 quad_perm:[0,0,2,2] row_mask:0xf bank_mask:0xf
    v_sub_f32 v5, v7, v6
    v_exp_f32 v5, v5
    v_mov_b32 v7, v6
    v_mul_f32 v8, v8, v5
    v_mul_f32 v12, v12, v5
    v_mul_f32 v13, v13, v5
    v_mul_f32 v14, v14, v5
    v_sub_f32_dpp v20, v51, v6 quad_perm:[0,0,2,2] row_mask:0xf bank_mask:0xf
    v_sub_f32_dpp v21, v55, v6 quad_perm:[0,0,2,2] row_mask:0xf bank_mask:0xf
    v_sub_f32_dpp v22, v59, v6 quad_perm:[0,0,2,2] row_mask:0xf bank_mask:0xf
    v_sub_f32_dpp v23, v63, v6 quad_perm:[0,0,2,2] row_mask:0xf bank_mask:0xf
    v_sub_f32_dpp v24, v67, v6 quad_perm:[0,0,2,2] row_mask:0xf bank_mask:0xf
    v_sub_f32_dpp v25, v71, v6 quad_perm:[0,0,2,2] row_mask:0xf bank_mask:0xf
    v_sub_f32_dpp v26, v75, v6 quad_perm:[0,0,2,2] row_mask:0xf bank_mask:0xf
    v_sub_f32_dpp v27, v79, v6 quad_perm:[0,0,2,2] row_mask:0xf bank_mask:0xf
    v_exp_f32 v20, v20
    v_exp_f32 v21, v21
    v_exp_f32 v22, v22
    v_exp_f32 v23, v23
    v_exp_f32 v24, v24
    v_exp_f32 v25, v25
    v_exp_f32 v26, v26
    v_exp_f32 v27, v27
    s_nop 0
    v_fmac_f32 v12, v20, v48
    v_fmac_f32 v13, v20, v49
    v_fmac_f32 v14, v20, v50
    v_fmac_f32 v8, v20, v51
    v_fmac_f32 v12, v21, v52
    v_fmac_f32 v13, v21, v53
    v_fmac_f32 v14, v21, v54
    v_fmac_f32 v8, v21, v55
    v_fmac_f32 v12, v22, v56
    v_fmac_f32 v13, v22, v57
    v_fmac_f32 v14, v22, v58
    v_fmac_f32 v8, v22, v59
    v_fmac_f32 v12, v23, v60
    v_fmac_f32 v13, v23, v61
    v_fmac_f32 v14, v23, v62
    v_fmac_f32 v8, v23, v63
    v_fmac_f32 v12, v24, v64
    v_fmac_f32 v13, v24, v65
    v_fmac_f32 v14, v24, v66
    v_fmac_f32 v8, v24, v67
    v_fmac_f32 v12, v25, v68
    v_fmac_f32 v13, v25, v69
    v_fmac_f32 v14, v25, v70
    v_fmac_f32 v8, v25, v71
    v_fmac_f32 v12, v26, v72
    v_fmac_f32 v13, v26, v73
    v_fmac_f32 v14, v26, v74
    v_fmac_f32 v8, v26, v75
    v_fmac_f32 v12, v27, v76
    v_fmac_f32 v13, v27, v77
    v_fmac_f32 v14, v27, v78
    v_fmac_f32 v8, v27, v79
    v_sub_f32_dpp v20, v83, v6 quad_perm:[0,0,2,2] row_mask:0xf bank_mask:0xf
    v_sub_f32_dpp v21, v87, v6 quad_perm:[0,0,2,2] row_mask:0xf bank_mask:0xf
    v_sub_f32_dpp v22, v91, v6 quad_perm:[0,0,2,2] row_mask:0xf bank_mask:0xf
    v_sub_f32_dpp v23, v95, v6 quad_perm:[0,0,2,2] row_mask:0xf bank_mask:0xf
    v_sub_f32_dpp v24, v99, v6 quad_perm:[0,0,2,2] row_mask:0xf bank_mask:0xf
    v_sub_f32_dpp v25, v103, v6 quad_perm:[0,0,2,2] row_mask:0xf bank_mask:0xf
    v_sub_f32_dpp v26, v107, v6 quad_perm:[0,0,2,2] row_mask:0xf bank_mask:0xf
    v_sub_f32_dpp v27, v111, v6 quad_perm:[0,0,2,2] row_mask:0xf bank_mask:0xf
    v_exp_f32 v20, v20
    v_exp_f32 v21, v21
    v_exp_f32 v22, v22
    v_exp_f32 v23, v23
    v_exp_f32 v24, v24
    v_exp_f32 v25, v25
    v_exp_f32 v26, v26
    v_exp_f32 v27, v27
    s_nop 0
    v_fmac_f32 v12, v20, v80
    v_fmac_f32 v13, v20, v81
    v_fmac_f32 v14, v20, v82
    v_fmac_f32 v8, v20, v83
    v_fmac_f32 v12, v21, v84
    v_fmac_f32 v13, v21, v85
    v_fmac_f32 v14, v21, v86
    v_fmac_f32 v8, v21, v87
    v_fmac_f32 v12, v22, v88
    v_fmac_f32 v13, v22, v89
    v_fmac_f32 v14, v22, v90
    v_fmac_f32 v8, v22, v91
    v_fmac_f32 v12, v23, v92
    v_fmac_f32 v13, v23, v93
    v_fmac_f32 v14, v23, v94
    v_fmac_f32 v8, v23, v95
    v_fmac_f32 v12, v24, v96
    v_fmac_f32 v13, v24, v97
    v_fmac_f32 v14, v24, v98
    v_fmac_f32 v8, v24, v99
    v_fmac_f32 v12, v25, v100
    v_fmac_f32 v13, v25, v101
    v_fmac_f32 v14, v25, v102
    v_fmac_f32 v8, v25, v103
    v_fmac_f32 v12, v26, v104
    v_fmac_f32 v13, v26, v105
    v_fmac_f32 v14, v26, v106
    v_fmac_f32 v8, v26, v107
    v_fmac_f32 v12, v27, v108
    v_fmac_f32 v13, v27, v109
    v_fmac_f32 v14, v27, v110
    v_fmac_f32 v8, v27, v111
    v_sub_f32_dpp v20, v115, v6 quad_perm:[0,0,2,2] row_mask:0xf bank_mask:0xf
    v_sub_f32_dpp v21, v119, v6 quad_perm:[0,0,2,2] row_mask:0xf bank_mask:0xf
    v_sub_f32_dpp v22, v123, v6 quad_perm:[0,0,2,2] row_mask:0xf bank_mask:0xf
    v_sub_f32_dpp v23, v127, v6 quad_perm:[0,0,2,2] row_mask:0xf bank_mask:0xf
    v_sub_f32_dpp v24, v131, v6 quad_perm:[0,0,2,2] row_mask:0xf bank_mask:0xf
    v_sub_f32_dpp v25, v135, v6 quad_perm:[0,0,2,2] row_mask:0xf bank_mask:0xf
    v_sub_f32_dpp v26, v139, v6 quad_perm:[0,0,2,2] row_mask:0xf bank_mask:0xf
    v_sub_f32_dpp v27, v143, v6 quad_perm:[0,0,2,2] row_mask:0xf bank_mask:0xf
    v_exp_f32 v20, v20
    v_exp_f32 v21, v21
    v_exp_f32 v22, v22
    v_exp_f32 v23, v23
    v_exp_f32 v24, v24
    v_exp_f32 v25, v25
    v_exp_f32 v26, v26
    v_exp_f32 v27, v27
    s_nop 0
    v_fmac_f32 v12, v20, v112
    v_fmac_f32 v13, v20, v113
    v_fmac_f32 v14, v20, v114
    v_fmac_f32 v8, v20, v115
    v_fmac_f32 v12, v21, v116
    v_fmac_f32 v13, v21, v117
    v_fmac_f32 v14, v21, v118
    v_fmac_f32 v8, v21, v119
    v_fmac_f32 v12, v22, v120
    v_fmac_f32 v13, v22, v121
    v_fmac_f32 v14, v22, v122
    v_fmac_f32 v8, v22, v123
    v_fmac_f32 v12, v23, v124
    v_fmac_f32 v13, v23, v125
    v_fmac_f32 v14, v23, v126
    v_fmac_f32 v8, v23, v127
    v_fmac_f32 v12, v24, v128
    v_fmac_f32 v13, v24, v129
    v_fmac_f32 v14, v24, v130
    v_fmac_f32 v8, v24, v131
    v_fmac_f32 v12, v25, v132
    v_fmac_f32 v13, v25, v133
    v_fmac_f32 v14, v25, v134
    v_fmac_f32 v8, v25, v135
    v_fmac_f32 v12, v26, v136
    v_fmac_f32 v13, v26, v137
    v_fmac_f32 v14, v26, v138
    v_fmac_f32 v8, v26, v139
    v_fmac_f32 v12, v27, v140
    v_fmac_f32 v13, v27, v141
    v_fmac_f32 v14, v27, v142
    v_fmac_f32 v8, v27, v143
    v_sub_f32_dpp v20, v147, v6 quad_perm:[0,0,2,2] row_mask:0xf bank_mask:0xf
    v_sub_f32_dpp v21, v151, v6 quad_perm:[0,0,2,2] row_mask:0xf bank_mask:0xf
    v_sub_f32_dpp v22, v155, v6 quad_perm:[0,0,2,2] row_mask:0xf bank_mask:0xf
    v_sub_f32_dpp v23, v159, v6 quad_perm:[0,0,2,2] row_mask:0xf bank_mask:0xf
    v_sub_f32_dpp v24, v163, v6 quad_perm:[0,0,2,2] row_mask:0xf bank_mask:0xf
    v_sub_f32_dpp v25, v167, v6 quad_perm:[0,0,2,2] row_mask:0xf bank_mask:0xf
    v_sub_f32_dpp v26, v171, v6 quad_perm:[0,0,2,2] row_mask:0xf bank_mask:0xf
    v_sub_f32_dpp v27, v175, v6 quad_perm:[0,0,2,2] row_mask:0xf bank_mask:0xf
    v_exp_f32 v20, v20
    v_exp_f32 v21, v21
    v_exp_f32 v22, v22
    v_exp_f32 v23, v23
    v_exp_f32 v24, v24
    v_exp_f32 v25, v25
    v_exp_f32 v26, v26
    v_exp_f32 v27, v27
    s_nop 0
    v_fmac_f32 v12, v20, v144
    v_fmac_f32 v13, v20, v145
    v_fmac_f32 v14, v20, v146
    v_fmac_f32 v8, v20, v147
    v_fmac_f32 v12, v21, v148
    v_fmac_f32 v13, v21, v149
    v_fmac_f32 v14, v21, v150
    v_fmac_f32 v8, v21, v151
    v_fmac_f32 v12, v22, v152
    v_fmac_f32 v13, v22, v153
    v_fmac_f32 v14, v22, v154
    v_fmac_f32 v8, v22, v155
    v_fmac_f32 v12, v23, v156
    v_fmac_f32 v13, v23, v157
    v_fmac_f32 v14, v23, v158
    v_fmac_f32 v8, v23, v159
    v_fmac_f32 v12, v24, v160
    v_fmac_f32 v13, v24, v161
    v_fmac_f32 v14, v24, v162
    v_fmac_f32 v8, v24, v163
    v_fmac_f32 v12, v25, v164
    v_fmac_f32 v13, v25, v165
    v_fmac_f32 v14, v25, v166
    v_fmac_f32 v8, v25, v167
    v_fmac_f32 v12, v26, v168
    v_fmac_f32 v13, v26, v169
    v_fmac_f32 v14, v26, v170
    v_fmac_f32 v8, v26, v171
    v_fmac_f32 v12, v27, v172
    v_fmac_f32 v13, v27, v173
    v_fmac_f32 v14, v27, v174
    v_fmac_f32 v8, v27, v175
    s_cmp_lg_u64 s[84:85], 0
    s_cbranch_scc1 L_chunk
    s_cmp_lg_u32 s74, 0
    s_cbranch_scc1 L_fin
    v_cndmask_b32 v15, v7, v8, s[66:67]
    v_mov_b32 v5, s95
    s_and_b32 s79, s97, 31
    s_lshr_b32 s80, s97, 10
    s_lshl_b32 s80, s80, 3
    s_and_b32 s83, s72, 7
    s_add_u32 s80, s80, s83
    s_bfm_b64 s[88:89], 1, s80
    s_bfe_u32 s83, s97, 0x50005
    s_mul_i32 s83, s83, s70
    s_cmp_lg_u32 s83, 512
    s_cbranch_scc1 L_rec
    s_mov_b64 exec, 1
    buffer_store_dword v5, v3, s[52:55], s77 offen offset:1028
    s_mov_b64 exec, -1
    s_branch L_fin
L_rec:
    s_lshl_b32 s83, s83, 16
    s_or_b32 s89, s89, s83
    v_mov_b32 v16, s88
    v_mov_b32 v17, s89
    s_lshl_b32 s75, s79, 17
    s_add_u32 s75, s75, 4194304
    s_lshl_b32 s80, s80, 11
    s_add_u32 s80, s80, s75
    buffer_store_dwordx4 v[12:15], v1, s[52:55], s80 offen sc0 sc1
    s_mov_b64 exec, 1
    buffer_store_dword v5, v3, s[52:55], s77 offen offset:1028
    s_lshl_b32 s80, s79, 8
    s_add_u32 s80, s80, 23076864
    s_waitcnt vmcnt(0)
    buffer_atomic_add_x2 v[16:17], v3, s[52:55], s80 offen sc0 sc1
    s_waitcnt vmcnt(0)
    s_mov_b64 exec, -1
    v_readfirstlane_b32 s84, v16
    v_readfirstlane_b32 s85, v17
    s_add_u32 s84, s84, s88
    s_add_u32 s85, s85, s89
    s_lshr_b32 s80, s85, 16
    s_cmp_lg_u32 s80, 512
    s_cbranch_scc1 L_next
    s_mov_b32 s74, 1
    s_and_b32 s85, s85, 0xffff
    s_branch L_merge
L_fin:
    s_nop 1
    v_mov_b32_dpp v5, v8 quad_perm:[1,1,3,3] row_mask:0xf bank_mask:0xf
    v_rcp_f32 v5, v5
    s_mul_i32 s80, s79, 384
    v_mul_f32 v12, v12, v5
    v_mul_f32 v13, v13, v5
    v_mul_f32 v14, v14, v5
    v_cvt_pk_bf16_f32 v12, v12, v12
    v_cvt_pk_bf16_f32 v13, v13, v13
    v_cvt_pk_bf16_f32 v14, v14, v14
    buffer_store_short v12, v11, s[56:59], s80 offen offset:0
    buffer_store_short v13, v11, s[56:59], s80 offen offset:128
    buffer_store_short v14, v11, s[56:59], s80 offen offset:256
L_next:
    s_add_u32 s71, s71, s70
    s_branch L_round
L_last:
    s_lshl_b32 s75, s96, 9
    s_add_u32 s75, s75, 1572864
    v_lshrrev_b32 v6, 1, v0
    v_lshlrev_b32 v28, 4, v6
L_inf:
    buffer_load_dwordx4 v[48:51], v28, s[52:55], s75 offen sc0 sc1
    s_waitcnt vmcnt(0)
    v_cmp_ne_u32 vcc, s69, v49
    s_cmp_lg_u64 vcc, 0
    s_cbranch_scc1 L_inf
    v_mov_b32 v7, v50
    s_nop 1
    v_max_f32_dpp v7, v7, v7 row_ror:8 row_mask:0xf bank_mask:0xf
    s_nop 1
    v_max_f32_dpp v7, v7, v7 row_ror:4 row_mask:0xf bank_mask:0xf
    s_nop 1
    v_max_f32_dpp v7, v7, v7 row_ror:2 row_mask:0xf bank_mask:0xf
    s_nop 1
    v_max_f32_dpp v7, v7, v7 row_ror:1 row_mask:0xf bank_mask:0xf
    v_mov_b32 v5, v7
    s_nop 1
    v_permlane32_swap_b32 v7, v5
    s_nop 1
    v_max_f32 v7, v7, v5
    v_mov_b32 v5, v7
    s_nop 1
    v_permlane16_swap_b32 v7, v5
    s_nop 1
    v_max_f32 v7, v7, v5
    v_sub_f32 v20, v50, v7
    v_exp_f32 v20, v20
    s_nop 0
    v_mul_f32 v8, v20, v51
    s_nop 1
    v_add_f32_dpp v8, v8, v8 row_ror:8 row_mask:0xf bank_mask:0xf
    s_nop 1
    v_add_f32_dpp v8, v8, v8 row_ror:4 row_mask:0xf bank_mask:0xf
    s_nop 1
    v_add_f32_dpp v8, v8, v8 row_ror:2 row_mask:0xf bank_mask:0xf
    s_nop 1
    v_add_f32_dpp v8, v8, v8 row_ror:1 row_mask:0xf bank_mask:0xf
    v_mov_b32 v5, v8
    s_nop 1
    v_permlane32_swap_b32 v8, v5
    s_nop 1
    v_add_f32 v8, v8, v5
    v_mov_b32 v5, v8
    s_nop 1
    v_permlane16_swap_b32 v8, v5
    s_nop 1
    v_add_f32 v8, v8, v5
    v_rcp_f32 v8, v8
    v_and_b32 v5, 1, v0
    v_mul_f32 v8, 2.0, v8
    v_mul_f32 v20, v20, v8
    v_lshlrev_b32 v28, 11, v6
    v_lshl_add_u32 v28, v5, 4, v28
    s_lshl_b32 s75, s96, 16
    s_lshl_b32 s80, s92, 5
    s_add_u32 s75, s75, s80
    v_mov_b32 v51, 0
    v_mov_b32 v55, 0
    v_mov_b32 v59, 0
    v_mov_b32 v63, 0
    v_mov_b32 v12, 0
    v_mov_b32 v13, 0
    v_mov_b32 v14, 0
    v_bfe_u32 v6, v0, 4, 1
    v_lshrrev_b32 v11, 5, v0
    v_lshl_add_u32 v11, v6, 1, v11
    v_lshlrev_b32 v11, 7, v11
    v_lshl_add_u32 v11, v5, 3, v11
    s_and_b32 s80, s92, 7
    s_lshl_b32 s80, s80, 4
    s_lshr_b32 s81, s92, 3
    s_lshl_b32 s81, s81, 1
    s_add_u32 s80, s80, s81
    s_add_u32 s79, s96, 24
    s_mul_i32 s78, s79, 384
    s_add_u32 s78, s78, s80
    s_mov_b64 s[24:25], -1
    s_mov_b32 s32, 0x00030003
    s_mov_b32 s33, 0x00000003
L_dt:
    ds_read_b32 v5, v3 offset:144
    s_waitcnt lgkmcnt(0)
    v_readfirstlane_b32 s80, v5
    s_cmp_eq_u32 s80, 0
    s_cbranch_scc1 L_dt
L_pa:
    buffer_load_dwordx4 v[48:51], v28, s[52:55], s75 offen offset:0 sc0 sc1
    s_waitcnt vmcnt(0)
    v_cmpx_eq_u32 vcc, s69, v51
    v_fmac_f32 v12, v20, v48
    v_fmac_f32 v13, v20, v49
    v_fmac_f32 v14, v20, v50
    s_andn2_b64 s[24:25], s[24:25], vcc
    s_mov_b64 exec, s[24:25]
    s_bcnt1_i32_b64 s80, s[24:25]
    s_cmp_gt_u32 s80, 0
    s_cbranch_scc1 L_pa
L_pd:
    s_mov_b64 exec, -1
    v_mov_b32 v15, v14
    v_permlane32_swap_b32 v12, v13
    s_nop 0
    v_permlane32_swap_b32 v14, v15
    v_add_f32 v12, v12, v13
    v_add_f32 v14, v14, v15
    s_nop 1
    v_permlane16_swap_b32 v12, v14
    v_add_f32 v12, v12, v14
    s_nop 1
    v_add_f32_dpp v12, v12, v12 row_ror:8 row_mask:0xf bank_mask:0xf
    s_nop 1
    v_add_f32_dpp v12, v12, v12 row_ror:4 row_mask:0xf bank_mask:0xf
    s_nop 1
    v_add_f32_dpp v12, v12, v12 row_ror:2 row_mask:0xf bank_mask:0xf
    s_mov_b64 exec, s[32:33]
    v_cvt_pk_bf16_f32 v12, v12, v12
    buffer_store_short v12, v11, s[56:59], s78 offen
L_end:
    s_endpgm
L_ticket:
    v_lshlrev_b32 v1, 2, v0
    v_mov_b32 v2, 0
    v_lshlrev_b32 v4, 4, v0
    v_mov_b32 v8, -1
    v_mov_b32 v9, -1
    v_mov_b32 v10, -1
    v_mov_b32 v11, -1
    ds_write_b128 v4, v[8:11] offset:256
    ds_write_b128 v4, v[8:11] offset:1280
    ds_write_b128 v4, v[8:11] offset:2304
    s_memrealtime s[80:81]
    s_waitcnt lgkmcnt(0)
    s_barrier
    s_mov_b32 s52, s22
    s_and_b32 s53, s23, 0xffff
    s_mov_b32 s54, 25165824
    s_mov_b32 s55, 0x00020000
    s_mov_b32 s60, s20
    s_and_b32 s61, s21, 0xffff
    s_mov_b32 s62, 256
    s_mov_b32 s63, 0x00020000
    s_max_u32 s69, s80, 1
    s_cmp_lg_u32 s2, 0
    s_cbranch_scc1 L_kd
    v_lshlrev_b32 v5, 8, v0
    s_mov_b32 s80, 23068672
    v_mov_b32 v3, 0
    buffer_store_dwordx2 v[2:3], v5, s[52:55], s80 offen sc0 sc1
    v_mov_b32 v3, s69
    s_mov_b64 exec, 1
    s_waitcnt vmcnt(0)
    buffer_store_dword v3, v2, s[60:63], 0 offen sc0 sc1
    s_mov_b64 exec, -1
L_kd:
    ds_read_b32 v3, v2 offset:128
    s_waitcnt lgkmcnt(0)
    v_readfirstlane_b32 s80, v3
    s_cmp_eq_u32 s80, 0
    s_cbranch_scc1 L_kd
    ds_read_b128 v[24:27], v4 offset:16128
    ds_read_b128 v[28:31], v4 offset:17152
    ds_read_b128 v[32:35], v4 offset:18176
    ds_read_b128 v[36:39], v4 offset:19200
    s_waitcnt lgkmcnt(0)
    v_max_f32 v18, v24, v25
    v_max3_f32 v18, v18, v26, v27
    v_max3_f32 v18, v18, v28, v29
    v_max3_f32 v18, v18, v30, v31
    v_max3_f32 v18, v18, v32, v33
    v_max3_f32 v18, v18, v34, v35
    v_max3_f32 v18, v18, v36, v37
    v_max3_f32 v18, v18, v38, v39
    s_nop 1
    v_max_f32_dpp v18, v18, v18 row_ror:8 row_mask:0xf bank_mask:0xf
    s_nop 1
    v_max_f32_dpp v18, v18, v18 row_ror:4 row_mask:0xf bank_mask:0xf
    s_nop 1
    v_max_f32_dpp v18, v18, v18 row_ror:2 row_mask:0xf bank_mask:0xf
    s_nop 1
    v_max_f32_dpp v18, v18, v18 row_ror:1 row_mask:0xf bank_mask:0xf
    v_mov_b32 v3, v18
    s_nop 1
    v_permlane32_swap_b32 v18, v3
    s_nop 1
    v_max_f32 v18, v18, v3
    v_mov_b32 v3, v18
    s_nop 1
    v_permlane16_swap_b32 v18, v3
    s_nop 1
    v_max_f32 v18, v18, v3
    v_sub_f32 v24, v24, v18
    v_sub_f32 v25, v25, v18
    v_sub_f32 v26, v26, v18
    v_sub_f32 v27, v27, v18
    v_sub_f32 v28, v28, v18
    v_sub_f32 v29, v29, v18
    v_sub_f32 v30, v30, v18
    v_sub_f32 v31, v31, v18
    v_sub_f32 v32, v32, v18
    v_sub_f32 v33, v33, v18
    v_sub_f32 v34, v34, v18
    v_sub_f32 v35, v35, v18
    v_sub_f32 v36, v36, v18
    v_sub_f32 v37, v37, v18
    v_sub_f32 v38, v38, v18
    v_sub_f32 v39, v39, v18
    v_exp_f32 v24, v24
    v_exp_f32 v25, v25
    v_exp_f32 v26, v26
    v_exp_f32 v27, v27
    v_exp_f32 v28, v28
    v_exp_f32 v29, v29
    v_exp_f32 v30, v30
    v_exp_f32 v31, v31
    v_exp_f32 v32, v32
    v_exp_f32 v33, v33
    v_exp_f32 v34, v34
    v_exp_f32 v35, v35
    v_exp_f32 v36, v36
    v_exp_f32 v37, v37
    v_exp_f32 v38, v38
    v_exp_f32 v39, v39
    ds_write_b32 v2, v18 offset:160
    v_add_f32 v19, v24, v25
    v_add_f32 v19, v19, v26
    v_add_f32 v19, v19, v27
    v_add_f32 v19, v19, v28
    v_add_f32 v19, v19, v29
    v_add_f32 v19, v19, v30
    v_add_f32 v19, v19, v31
    v_add_f32 v19, v19, v32
    v_add_f32 v19, v19, v33
    v_add_f32 v19, v19, v34
    v_add_f32 v19, v19, v35
    v_add_f32 v19, v19, v36
    v_add_f32 v19, v19, v37
    v_add_f32 v19, v19, v38
    v_add_f32 v19, v19, v39
    s_nop 1
    v_add_f32_dpp v19, v19, v19 row_ror:8 row_mask:0xf bank_mask:0xf
    s_nop 1
    v_add_f32_dpp v19, v19, v19 row_ror:4 row_mask:0xf bank_mask:0xf
    s_nop 1
    v_add_f32_dpp v19, v19, v19 row_ror:2 row_mask:0xf bank_mask:0xf
    s_nop 1
    v_add_f32_dpp v19, v19, v19 row_ror:1 row_mask:0xf bank_mask:0xf
    v_mov_b32 v3, v19
    s_nop 1
    v_permlane32_swap_b32 v19, v3
    s_nop 1
    v_add_f32 v19, v19, v3
    v_mov_b32 v3, v19
    s_nop 1
    v_permlane16_swap_b32 v19, v3
    s_nop 1
    v_add_f32 v19, v19, v3
    s_lshl_b32 s80, s2, 11
    s_add_u32 s80, s80, 18874368
    s_waitcnt lgkmcnt(0)
    s_mov_b64 exec, -1
L_tg:
    buffer_load_dword v3, v2, s[60:63], 0 offen sc0 sc1
    s_waitcnt vmcnt(0)
    v_readfirstlane_b32 s69, v3
    s_cmp_eq_u32 s69, 0
    s_cbranch_scc1 L_tg
    s_getreg_b32 s81, hwreg(HW_REG_XCC_ID)
    s_and_b32 s81, s81, 15
    v_mov_b32 v16, s81
    v_mov_b32 v17, s69
    s_lshl_b32 s80, s2, 11
    s_mov_b64 exec, 1
    s_lshl_b32 s82, s2, 4
    s_add_u32 s82, s82, 1572864
    buffer_store_dwordx4 v[16:19], v2, s[52:55], s82 offen sc0 sc1
    v_mov_b32 v12, s69
    v_mov_b32 v13, s69
    s_add_u32 s82, s80, 2097152
    buffer_store_dwordx2 v[12:13], v2, s[52:55], s82 offen offset:1024
    s_add_u32 s82, s80, 2621440
    buffer_store_dwordx2 v[12:13], v2, s[52:55], s82 offen offset:1024
    s_mov_b64 exec, -1
    s_mov_b32 s73, s81
    s_lshl_b32 s80, s79, 2
    s_lshr_b32 s74, 0x54465464, s80
    s_and_b32 s74, s74, 15
    s_mov_b32 s75, 0
    s_mov_b32 s95, s69
    s_lshl_b32 s77, s2, 11
    s_lshl_b32 s94, s79, 16
    s_mov_b32 s76, 2097152
    v_mov_b32 v19, 0
    v_lshlrev_b32 v20, 11, v0
    v_mov_b32 v21, v4
L_fl:
    ds_read_b32 v3, v19
    s_waitcnt lgkmcnt(0)
    v_readfirstlane_b32 s80, v3
    s_cmp_eq_u32 s80, 0
    s_cbranch_scc1 L_fl
    ds_read_b128 v[24:27], v21 offset:20480
    ds_read_b128 v[28:31], v21 offset:21504
    ds_read_b128 v[32:35], v21 offset:22528
    ds_read_b128 v[36:39], v21 offset:23552
    s_waitcnt lgkmcnt(0)
    s_nop 0
    v_add_f32_dpp v37, v37, v37 row_ror:8 row_mask:0xf bank_mask:0xf
    v_add_f32_dpp v38, v38, v38 row_ror:8 row_mask:0xf bank_mask:0xf
    s_nop 0
    v_add_f32_dpp v37, v37, v37 row_ror:4 row_mask:0xf bank_mask:0xf
    v_add_f32_dpp v38, v38, v38 row_ror:4 row_mask:0xf bank_mask:0xf
    s_nop 0
    v_add_f32_dpp v37, v37, v37 row_ror:2 row_mask:0xf bank_mask:0xf
    v_add_f32_dpp v38, v38, v38 row_ror:2 row_mask:0xf bank_mask:0xf
    s_nop 0
    v_add_f32_dpp v37, v37, v37 row_ror:1 row_mask:0xf bank_mask:0xf
    v_add_f32_dpp v38, v38, v38 row_ror:1 row_mask:0xf bank_mask:0xf
    v_mov_b32 v40, v36
    v_mov_b32 v41, v36
    s_nop 1
    v_permlane32_swap_b32 v40, v41
    s_nop 1
    v_max_f32 v40, v40, v41
    v_mov_b32 v41, v40
    s_nop 1
    v_permlane16_swap_b32 v40, v41
    s_nop 1
    v_max_f32 v40, v40, v41
    v_sub_f32 v41, v36, v40
    v_exp_f32 v41, v41
    v_mov_b32 v48, v40
    v_mul_f32 v37, v37, v41
    v_mul_f32 v38, v38, v41
    v_mul_f32 v41, 0x58000000, v41
    v_fma_f32 v24, v24, v41, -v38
    v_fma_f32 v25, v25, v41, -v38
    v_fma_f32 v26, v26, v41, -v38
    v_fma_f32 v27, v27, v41, -v38
    v_fma_f32 v28, v28, v41, -v38
    v_fma_f32 v29, v29, v41, -v38
    v_fma_f32 v30, v30, v41, -v38
    v_fma_f32 v31, v31, v41, -v38
    v_fma_f32 v32, v32, v41, -v38
    v_fma_f32 v33, v33, v41, -v38
    v_fma_f32 v34, v34, v41, -v38
    v_fma_f32 v35, v35, v41, -v38
    v_mov_b32 v40, v37
    s_nop 1
    v_permlane32_swap_b32 v37, v40
    v_permlane32_swap_b32 v24, v26
    v_permlane32_swap_b32 v25, v27
    v_permlane32_swap_b32 v28, v30
    v_permlane32_swap_b32 v29, v31
    v_permlane32_swap_b32 v32, v34
    v_permlane32_swap_b32 v33, v35
    s_nop 1
    v_add_f32 v37, v37, v40
    v_add_f32 v24, v24, v26
    v_add_f32 v25, v25, v27
    v_add_f32 v28, v28, v30
    v_add_f32 v29, v29, v31
    v_add_f32 v32, v32, v34
    v_add_f32 v33, v33, v35
    v_mov_b32 v40, v37
    s_nop 1
    v_permlane16_swap_b32 v37, v40
    v_permlane16_swap_b32 v24, v25
    v_permlane16_swap_b32 v28, v29
    v_permlane16_swap_b32 v32, v33
    s_nop 1
    v_add_f32 v49, v37, v40
    v_add_f32 v44, v24, v25
    v_add_f32 v45, v28, v29
    v_add_f32 v46, v32, v33
    v_mov_b32 v8, v44
    v_mov_b32 v9, v45
    v_mov_b32 v10, v46
    v_cndmask_b32 v11, v48, v49, s[66:67]
    s_cmp_eq_u32 s75, 1
    s_cbranch_scc1 L_dep
    s_cmp_lg_u32 s75, 0
    s_cbranch_scc1 L_guard
    s_lshr_b32 s82, s3, 5
    s_lshl_b32 s83, s79, 9
    s_add_u32 s83, s83, 1572864
    s_bfm_b64 exec, 32, 0
L_reg:
    buffer_load_dwordx2 v[12:13], v4, s[52:55], s83 offen sc0 sc1
    s_waitcnt vmcnt(0)
    v_cmp_ne_u32 vcc, s69, v13
    s_cmp_lg_u64 vcc, 0
    s_cbranch_scc1 L_reg
    v_cmp_eq_u32 s[86:87], s73, v12
    s_nop 1
    v_mov_b32 v14, s86
    v_mov_b32 v15, s87
    ds_write_b64 v2, v[14:15] offset:152
    s_waitcnt lgkmcnt(0)
    ds_write_b32 v2, v13 offset:140
    s_mov_b64 exec, -1
    s_branch L_dep
L_guard:
    s_sub_u32 s80, s95, 1
    s_add_u32 s81, s94, s76
L_guard2:
    v_mov_b32 v12, s69
    s_mov_b64 exec, s[86:87]
    buffer_load_dword v12, v20, s[52:55], s81 offen offset:1028 sc0 sc1
    s_mov_b64 exec, -1
    s_waitcnt vmcnt(0)
    v_cmp_eq_u32 vcc, s80, v12
    s_cmp_eq_u64 vcc, 0
    s_cbranch_scc1 L_guard2
L_dep:
    s_add_u32 s75, s75, 1
    s_add_u32 s95, s95, 1
    s_add_u32 s80, s77, s76
    v_mov_b32 v3, s95
    s_waitcnt lgkmcnt(0)
    buffer_store_dwordx4 v[8:11], v4, s[52:55], s80 offen
    s_mov_b64 exec, 1
    s_waitcnt vmcnt(0)
    buffer_store_dword v3, v2, s[52:55], s80 offen offset:1024
    s_mov_b64 exec, -1
    s_xor_b32 s76, s76, 0x80000
    v_add_u32 v21, 4096, v21
    v_add_u32 v19, 4, v19
    s_cmp_lt_u32 s75, s74
    s_cbranch_scc1 L_fl
    s_endpgm
L_ctl:
    v_lshlrev_b32 v1, 2, v0
    v_mov_b32 v2, 0
    ds_write_b32 v1, v2 offset:3328
    s_and_b32 s70, s2, 31
    s_lshl_b32 s70, s70, 2
    s_mov_b32 s71, 1
    v_mov_b32 v7, s2
    v_and_b32 v10, 15, v0
    v_lshrrev_b32 v8, 5, v7
    v_lshl_add_u32 v10, v8, 4, v10
    v_lshrrev_b32 v9, 4, v0
    v_lshl_add_u32 v10, v9, 7, v10
    s_lshl_b32 s82, s79, 3
    s_mov_b32 s80, 0xeff4fa00
    s_mov_b32 s81, 0xdbe0e5ea
    s_lshr_b64 s[80:81], s[80:81], s82
    s_sext_i32_i8 s80, s80
    s_mov_b32 exec_lo, 0x0
    s_mov_b32 exec_hi, 0x3ff
    v_add_u32 v10, s80, v10
    s_mov_b32 s80, 0xeff43d4c
    s_mov_b32 s81, 0xdbe0e5ea
    s_lshr_b64 s[80:81], s[80:81], s82
    s_sext_i32_i8 s80, s80
    s_mov_b32 exec_lo, 0x0
    s_mov_b32 exec_hi, 0x400
    s_branch L_x2
L_w2:
    s_branch L_walked
L_x2:
    v_add_u32 v10, s80, v10
    s_mov_b32 s80, 0x2c37424d
    s_mov_b32 s81, 0xb1621
    s_lshr_b64 s[80:81], s[80:81], s82
    s_sext_i32_i8 s80, s80
    s_mov_b32 exec_lo, 0x0
    s_mov_b32 exec_hi, 0xf800
    v_add_u32 v10, s80, v10
    s_mov_b64 exec, -1
    v_mul_u32_u24 v30, 1572864, v10
    v_and_b32 v9, 3, v7
    v_lshl_add_u32 v8, v10, 2, v9
    v_bfe_u32 v9, v7, 2, 3
    v_lshl_add_u32 v8, v8, 3, v9
    v_mul_u32_u24 v9, 384, v8
    v_lshlrev_b32 v8, 7, v8
    s_waitcnt lgkmcnt(0)
    s_mov_b32 s32, s10
    s_and_b32 s33, s11, 0xffff
    s_mov_b32 s34, 6291456
    s_mov_b32 s35, 0x00020000
    buffer_load_dword v10, v9, s[32:35], 0 offen offset:0
    buffer_load_dword v11, v9, s[32:35], 0 offen offset:128
    buffer_load_dword v12, v9, s[32:35], 0 offen offset:256
    s_mov_b32 s36, s12
    s_and_b32 s37, s13, 0xffff
    s_mov_b32 s38, 6291456
    s_mov_b32 s39, 0x00020000
    buffer_load_dword v13, v9, s[36:39], 0 offen offset:0
    buffer_load_dword v14, v9, s[36:39], 0 offen offset:128
    buffer_load_dword v15, v9, s[36:39], 0 offen offset:256
    s_mov_b32 s40, s14
    s_and_b32 s41, s15, 0xffff
    s_mov_b32 s42, 2097152
    s_mov_b32 s43, 0x00020000
    buffer_load_dword v16, v8, s[40:43], 0 offen offset:0
    s_mov_b32 s44, s16
    s_and_b32 s45, s17, 0xffff
    s_mov_b32 s46, 2097152
    s_mov_b32 s47, 0x00020000
    buffer_load_dword v17, v8, s[44:47], 0 offen offset:0
    s_mov_b32 s52, s22
    s_and_b32 s53, s23, 0xffff
    s_mov_b32 s54, 25165824
    s_mov_b32 s55, 0x00020000
    v_lshlrev_b32 v7, 7, v0
    s_lshl_b32 s80, s2, 11
    s_add_u32 s81, s80, 2097152
    s_add_u32 s82, s80, 2621440
    s_mov_b64 exec, 0x1ff
    buffer_load_dword v18, v7, s[52:55], s81 offen
    buffer_load_dword v19, v7, s[52:55], s82 offen
    s_mov_b64 exec, -1
    s_barrier
    s_mov_b32 s60, s20
    s_and_b32 s61, s21, 0xffff
    s_mov_b32 s62, 256
    s_mov_b32 s63, 0x00020000
    s_mov_b32 s52, s22
    s_and_b32 s53, s23, 0xffff
    s_mov_b32 s54, 25165824
    s_mov_b32 s55, 0x00020000
    s_getreg_b32 s76, hwreg(HW_REG_XCC_ID)
    s_and_b32 s76, s76, 15
    s_lshr_b32 s70, s70, 1
    s_and_b32 s75, s2, 31
    s_cmp_eq_u32 s75, 0
    s_cselect_b32 s75, 32, s75
    s_mul_i32 s77, s75, 32
    s_mul_i32 s83, s75, 16
    s_add_u32 s83, s83, 768
    s_min_u32 s77, s77, s83
    v_lshlrev_b32 v1, 1, v0
    v_lshlrev_b32 v7, 7, v0
    s_mov_b32 s24, s6
    s_and_b32 s25, s7, 0xffff
    s_mov_b32 s26, 805306368
    s_mov_b32 s27, 0x00020000
    s_mov_b32 s28, s8
    s_and_b32 s29, s9, 0xffff
    s_mov_b32 s30, 805306368
    s_mov_b32 s31, 0x00020000
    s_and_b32 s88, s2, 31
    s_lshl_b32 s89, s88, 4
    s_sub_i32 s89, s89, 63
    s_mov_b32 s90, 1572800
L_c:
    ds_read_b32 v3, v2 offset:3328
    ds_read_b32 v4, v2 offset:144
    s_mov_b64 exec, 1
    s_waitcnt lgkmcnt(0)
    v_add_u32 v3, 1, v3
    buffer_store_short v3, v2, s[60:63], s70 offen offset:128
    s_bfm_b64 exec, 33, 0
    buffer_load_ushort v5, v1, s[60:63], 0 offen offset:128 sc1
    v_readfirstlane_b32 s72, v3
    v_readfirstlane_b32 s81, v4
    s_add_u32 s80, s71, s72
    s_mov_b32 s71, s72
    s_mov_b64 exec, 0xffffffff
    s_waitcnt vmcnt(0)
    v_cmp_ne_u32 vcc, 0, v5
    v_lshlrev_b32 v6, 1, v5
    v_readlane_b32 s86, v5, 32
    v_cmp_le_u32 s[82:83], s80, v6
    s_bcnt1_i32_b64 s73, vcc
    s_cmp_eq_u32 s86, 0
    s_cselect_b32 s86, 1024, s86
    s_bcnt1_i32_b64 s74, s[82:83]
    s_sub_i32 s86, s86, 1003
    s_mul_i32 s80, s73, s86
    s_lshl_b32 s74, s74, 5
    s_cmp_lt_i32 s74, s80
    s_cselect_b32 s86, 1, 0
    s_lshl_b32 s82, s73, 5
    s_add_u32 s74, s74, s82
    s_cmp_lt_i32 s74, s80
    s_cselect_b32 s86, 2, s86
    v_mov_b32 v6, s86
    ds_write_b32 v2, v6 offset:148
    s_cmp_lt_i32 s72, s89
    s_cbranch_scc1 L_ntp
    v_readlane_b32 s87, v30, s88
    s_min_u32 s87, s87, 803733504
    s_cmp_ge_u32 s88, 64
    s_cbranch_scc1 L_tpv
    s_load_dword s90, s[6:7], s87
    s_add_u32 s87, s87, 1572800
    s_load_dword s91, s[6:7], s87
    s_branch L_tpd
L_tpv:
    s_load_dword s90, s[8:9], s87
    s_add_u32 s87, s87, 1572800
    s_load_dword s91, s[8:9], s87
L_tpd:
    s_add_u32 s88, s88, 32
    s_add_i32 s89, s89, 512
    s_cmp_ge_u32 s88, 128
    s_cselect_b32 s89, 0x7fffffff, s89
    s_mov_b64 exec, 0xffffffff
L_ntp:
    s_cmp_lt_u32 s72, s77
    s_cbranch_scc1 L_cn
    s_memrealtime s[84:85]
    s_lshl_b32 s86, s75, 11
    s_add_u32 s75, s75, 32
    s_mul_i32 s77, s75, 32
    s_mul_i32 s83, s75, 16
    s_add_u32 s83, s83, 768
    s_min_u32 s77, s77, s83
    s_cmp_lg_u32 s73, 32
    s_cbranch_scc1 L_cn
    v_add_u32_dpp v5, v5, v5 row_ror:8 row_mask:0xf bank_mask:0xf
    s_nop 1
    v_add_u32_dpp v5, v5, v5 row_ror:4 row_mask:0xf bank_mask:0xf
    s_nop 1
    v_add_u32_dpp v5, v5, v5 row_ror:2 row_mask:0xf bank_mask:0xf
    s_nop 1
    v_add_u32_dpp v5, v5, v5 row_ror:1 row_mask:0xf bank_mask:0xf
    s_nop 1
    v_readlane_b32 s74, v5, 0
    v_readlane_b32 s73, v5, 16
    s_add_u32 s86, s86, 3143680
    s_lshl_b32 s80, s76, 7
    s_add_u32 s80, s80, s86
    s_add_u32 s74, s74, s73
    s_lshl_b32 s74, s74, 2
    s_waitcnt lgkmcnt(0)
    s_mul_i32 s73, s84, 13
    s_sub_u32 s74, s74, s73
    v_mov_b32 v8, s74
    v_mov_b32 v9, s84
    s_mov_b64 exec, 1
    buffer_store_dwordx2 v[8:9], v2, s[52:55], s80 offen offset:2048 sc0 sc1
    s_load_dwordx2 s[32:33], s[22:23], s86 offset:0 glc
    s_load_dwordx2 s[34:35], s[22:23], s86 offset:128 glc
    s_load_dwordx2 s[36:37], s[22:23], s86 offset:256 glc
    s_load_dwordx2 s[38:39], s[22:23], s86 offset:384 glc
    s_load_dwordx2 s[40:41], s[22:23], s86 offset:512 glc
    s_load_dwordx2 s[42:43], s[22:23], s86 offset:640 glc
    s_load_dwordx2 s[44:45], s[22:23], s86 offset:768 glc
    s_load_dwordx2 s[46:47], s[22:23], s86 offset:896 glc
    s_mov_b64 exec, 0xffff
    v_mov_b32 v23, 0
    s_waitcnt lgkmcnt(0)
    v_writelane_b32 v22, s32, 0
    v_writelane_b32 v23, s33, 0
    v_writelane_b32 v22, s34, 1
    v_writelane_b32 v23, s35, 1
    v_writelane_b32 v22, s36, 2
    v_writelane_b32 v23, s37, 2
    v_writelane_b32 v22, s38, 3
    v_writelane_b32 v23, s39, 3
    v_writelane_b32 v22, s40, 4
    v_writelane_b32 v23, s41, 4
    v_writelane_b32 v22, s42, 5
    v_writelane_b32 v23, s43, 5
    v_writelane_b32 v22, s44, 6
    v_writelane_b32 v23, s45, 6
    v_writelane_b32 v22, s46, 7
    v_writelane_b32 v23, s47, 7
    v_sub_u32 v9, s84, v23
    v_cmp_gt_u32 vcc, 0x1000, v9
    v_sub_u32 v8, s74, v22
    s_and_b32 vcc_lo, vcc_lo, 255
    s_bitset0_b32 vcc_lo, s76
    v_cndmask_b32 v8, 0, v8, vcc
    s_nop 1
    v_add_u32_dpp v8, v8, v8 row_ror:8 row_mask:0xf bank_mask:0xf
    s_nop 1
    v_add_u32_dpp v8, v8, v8 row_ror:4 row_mask:0xf bank_mask:0xf
    s_nop 1
    v_add_u32_dpp v8, v8, v8 row_ror:2 row_mask:0xf bank_mask:0xf
    s_nop 1
    v_add_u32_dpp v8, v8, v8 row_ror:1 row_mask:0xf bank_mask:0xf
    s_nop 1
    v_ashrrev_i32 v8, 9, v8
    v_max_i32 v8, -5, v8
    v_min_i32 v8, 40, v8
    v_add_u32 v8, 0x400, v8
    s_mov_b64 exec, 1
    buffer_store_short v8, v2, s[60:63], 0 offen offset:192
L_cn:
    s_cmp_eq_u32 s81, 0
    s_cbranch_scc1 L_c
    s_endpgm
.section .rodata,"a"
.p2align 6
.amdhsa_kernel standalone__kv_cache_quant_int4_int2_kv_with_per_channel_or_per_token_scales__decode_kernel
  .amdhsa_next_free_vgpr 246
  .amdhsa_next_free_sgpr 102
  .amdhsa_accum_offset 248
  .amdhsa_float_denorm_mode_32 3
  .amdhsa_group_segment_fixed_size 0
  .amdhsa_kernarg_size 80
  .amdhsa_user_sgpr_count 2
  .amdhsa_user_sgpr_kernarg_segment_ptr 1
  .amdhsa_system_sgpr_workgroup_id_x 1
.end_amdhsa_kernel
```

```asm
; @launch grid=(256,1,1) block=(256,1,1) lds=98304
.amdgcn_target "amdgcn-amd-amdhsa--gfx950"
.text
.globl standalone__kv_cache_quant_int4_int2_kv_with_per_channel_or_per_token_scales__decode_kernel
.p2align 12
.type standalone__kv_cache_quant_int4_int2_kv_with_per_channel_or_per_token_scales__decode_kernel,@function
standalone__kv_cache_quant_int4_int2_kv_with_per_channel_or_per_token_scales__decode_kernel:
    s_cmp_ge_u32 s2, 256
    s_cbranch_scc1 L_end
    s_load_dwordx16 s[4:19], s[0:1], 0
    s_load_dwordx4 s[20:23], s[0:1], 64
    s_and_b32 s80, s2, 7
    s_lshr_b32 s2, s2, 3
    s_lshl_b32 s80, s80, 5
    s_or_b32 s2, s2, s80
    s_mov_b32 s3, s2
    v_lshrrev_b32 v229, 6, v0
    v_and_b32 v0, 63, v0
    v_readfirstlane_b32 s68, v229
    s_lshr_b32 s79, s2, 5
    s_and_b32 s92, s2, 31
    s_mov_b32 s66, 0xaaaaaaaa
    s_mov_b32 s67, 0xaaaaaaaa
    s_cmp_eq_u32 s68, 1
    s_cbranch_scc1 L_service
    s_cmp_eq_u32 s68, 2
    s_cbranch_scc1 L_ticket
    s_cmp_eq_u32 s68, 3
    s_cbranch_scc1 L_ctl
    s_mov_b64 vcc, 0
    s_setprio 1
    v_and_b32 v235, 15, v0
    v_lshrrev_b32 v234, 4, v0
    v_mul_u32_u24 v1, 768, v234
    v_lshl_add_u32 v1, v235, 4, v1
    v_lshlrev_b32 v2, 3, v235
    v_bfrev_b32 v231, v235
    v_lshrrev_b32 v231, 28, v231
    v_and_b32 v232, 3, v231
    v_lshl_add_u32 v3, v232, 2, v234
    v_lshlrev_b32 v3, 1, v3
    v_lshrrev_b32 v231, 2, v231
    v_lshl_add_u32 v3, v231, 10, v3
    v_lshlrev_b32 v239, 2, v0
    v_add_u32 v240, 3840, v239
    v_add_u32 v239, 3584, v239
    v_lshlrev_b32 v241, 4, v0
    v_mov_b32 v242, 0
    v_mov_b32 v243, 1
    v_lshlrev_b32 v224, 2, v0
    v_mov_b32 v225, 1
    v_mov_b32 v226, 260
    s_mul_i32 s58, s79, 0
    s_and_b32 s94, s92, 448
    s_add_u32 s94, s94, s58
    s_add_u32 s94, s94, 512
    s_add_u32 s58, s58, s92
    s_and_b32 s58, s58, 511
    s_lshr_b32 s59, s3, 5
    s_lshl_b32 s69, s79, 9
    s_add_u32 s59, s59, 24
    s_lshl_b32 s59, s59, 9
    s_mov_b32 s64, 0xcccccccc
    s_mov_b32 s65, 0xcccccccc
    s_mov_b32 s60, 0x6fd53b95
    s_mov_b32 s62, 0x80000001
    s_mov_b32 s61, 0x6fd53b95
    s_mov_b32 s63, 0x80000001
    s_and_b32 s80, s92, 3
    s_cmp_eq_u32 s80, 1
    s_mov_b32 s81, 0x11119143
    s_cselect_b32 s81, 0x11659143, s81
    s_cmp_eq_u32 s80, 0
    s_cselect_b32 s81, 0x80659143, s81
    s_andn2_b32 s82, s92, 3
    s_lshr_b32 s81, s81, s82
    s_and_b32 s81, s81, 15
    s_lshl_b32 m0, s81, 1
    s_lshl_b32 s80, s80, 21
    s_max_u32 s80, s80, 64
    s_sub_u32 s80, s80, 64
    s_mul_i32 s82, s79, 25165824
    s_cmp_eq_u32 s81, 1
    s_cselect_b32 s82, s82, 0
    s_add_u32 s80, s80, s82
    v_mov_b32 v236, s80
    s_waitcnt lgkmcnt(0)
    s_movrels_b64 s[84:85], s[4:5]
    global_load_dword v236, v236, s[84:85]
    s_mov_b32 s24, s6
    s_and_b32 s25, s7, 0xffff
    s_mov_b32 s26, 805306368
    s_mov_b32 s27, 0x00020000
    s_mov_b32 s48, s4
    s_and_b32 s49, s5, 0xffff
    s_mov_b32 s50, 12288
    s_mov_b32 s51, 0x00020000
    s_mov_b32 s32, s10
    s_and_b32 s33, s11, 0xffff
    s_mov_b32 s34, 6291456
    s_mov_b32 s35, 0x00020000
    s_mov_b32 s36, s12
    s_and_b32 s37, s13, 0xffff
    s_mov_b32 s38, 6291456
    s_mov_b32 s39, 0x00020000
    s_add_u32 s70, s69, s92
    s_mov_b32 s91, 1
    s_lshr_b32 s74, s70, 9
    s_mul_i32 s74, s74, 384
    buffer_load_dwordx2 v[192:193], v2, s[48:51], s74 offen offset:0
    buffer_load_dwordx2 v[194:195], v2, s[48:51], s74 offen offset:128
    buffer_load_dwordx2 v[196:197], v2, s[48:51], s74 offen offset:256
    s_and_b32 s80, s70, 31
    s_sub_u32 s72, s70, s80
    s_lshr_b32 s80, s80, 2
    s_add_u32 s72, s72, s80
    s_mul_i32 s72, s72, 384
    buffer_load_dwordx2 v[132:133], v2, s[32:35], s72 offen offset:0
    buffer_load_dwordx2 v[134:135], v2, s[32:35], s72 offen offset:128
    buffer_load_dwordx2 v[136:137], v2, s[32:35], s72 offen offset:256
    buffer_load_dwordx2 v[138:139], v2, s[36:39], s72 offen offset:0
    buffer_load_dwordx2 v[140:141], v2, s[36:39], s72 offen offset:128
    buffer_load_dwordx2 v[142:143], v2, s[36:39], s72 offen offset:256
    s_mul_i32 s71, s70, 49152
    s_and_b32 s80, s70, 31
    s_mul_i32 s80, s80, 36864
    s_sub_u32 s71, s71, s80
    buffer_load_dwordx4 v[4:7], v1, s[24:27], s71 offen offset:0 nt
    buffer_load_dwordx4 v[8:11], v1, s[24:27], s71 offen offset:256 nt
    buffer_load_dwordx4 v[12:15], v1, s[24:27], s71 offen offset:512 nt
    s_add_u32 s71, s71, 3072
    buffer_load_dwordx4 v[16:19], v1, s[24:27], s71 offen offset:0 nt
    s_add_u32 s72, s72, 3072
    buffer_load_dwordx2 v[156:157], v2, s[32:35], s72 offen offset:0
    buffer_load_dwordx2 v[158:159], v2, s[32:35], s72 offen offset:128
    buffer_load_dwordx2 v[160:161], v2, s[32:35], s72 offen offset:256
    buffer_load_dwordx2 v[162:163], v2, s[36:39], s72 offen offset:0
    buffer_load_dwordx2 v[164:165], v2, s[36:39], s72 offen offset:128
    buffer_load_dwordx2 v[166:167], v2, s[36:39], s72 offen offset:256
    buffer_load_dwordx4 v[20:23], v1, s[24:27], s71 offen offset:256 nt
    buffer_load_dwordx4 v[24:27], v1, s[24:27], s71 offen offset:512 nt
    s_add_u32 s71, s71, 3072
    buffer_load_dwordx4 v[28:31], v1, s[24:27], s71 offen offset:0 nt
    buffer_load_dwordx4 v[32:35], v1, s[24:27], s71 offen offset:256 nt
    buffer_load_dwordx4 v[36:39], v1, s[24:27], s71 offen offset:512 nt
    s_add_u32 s71, s71, 3072
    buffer_load_dwordx4 v[40:43], v1, s[24:27], s71 offen offset:0 nt
    buffer_load_dwordx4 v[44:47], v1, s[24:27], s71 offen offset:256 nt
    buffer_load_dwordx4 v[48:51], v1, s[24:27], s71 offen offset:512 nt
    s_add_u32 s71, s71, 384000
    buffer_load_dwordx4 v[52:55], v1, s[24:27], s71 offen offset:0 nt
    buffer_load_dwordx4 v[56:59], v1, s[24:27], s71 offen offset:256 nt
    buffer_load_dwordx4 v[60:63], v1, s[24:27], s71 offen offset:512 nt
    s_add_u32 s71, s71, 3072
    buffer_load_dwordx4 v[64:67], v1, s[24:27], s71 offen offset:0 nt
    s_add_u32 s72, s72, 3072
    buffer_load_dwordx2 v[168:169], v2, s[32:35], s72 offen offset:0
    buffer_load_dwordx2 v[170:171], v2, s[32:35], s72 offen offset:128
    buffer_load_dwordx2 v[172:173], v2, s[32:35], s72 offen offset:256
    buffer_load_dwordx2 v[174:175], v2, s[36:39], s72 offen offset:0
    buffer_load_dwordx2 v[176:177], v2, s[36:39], s72 offen offset:128
    buffer_load_dwordx2 v[178:179], v2, s[36:39], s72 offen offset:256
    buffer_load_dwordx4 v[68:71], v1, s[24:27], s71 offen offset:256 nt
    buffer_load_dwordx4 v[72:75], v1, s[24:27], s71 offen offset:512 nt
    s_add_u32 s71, s71, 3072
    buffer_load_dwordx4 v[76:79], v1, s[24:27], s71 offen offset:0 nt
    buffer_load_dwordx4 v[80:83], v1, s[24:27], s71 offen offset:256 nt
    buffer_load_dwordx4 v[84:87], v1, s[24:27], s71 offen offset:512 nt
    s_add_u32 s71, s71, 3072
    buffer_load_dwordx4 v[88:91], v1, s[24:27], s71 offen offset:0 nt
    buffer_load_dwordx4 v[92:95], v1, s[24:27], s71 offen offset:256 nt
    buffer_load_dwordx4 v[96:99], v1, s[24:27], s71 offen offset:512 nt
    s_mov_b32 s28, s8
    s_and_b32 s29, s9, 0xffff
    s_mov_b32 s30, 805306368
    s_mov_b32 s31, 0x00020000
    s_mov_b32 s40, s14
    s_and_b32 s41, s15, 0xffff
    s_mov_b32 s42, 2097152
    s_mov_b32 s43, 0x00020000
    s_mov_b32 s44, s16
    s_and_b32 s45, s17, 0xffff
    s_mov_b32 s46, 2097152
    s_mov_b32 s47, 0x00020000
    s_mov_b32 s52, s22
    s_and_b32 s53, s23, 0xffff
    s_mov_b32 s54, 25165824
    s_mov_b32 s55, 0x00020000
    v_mov_b32 v229, s2
    v_and_b32 v231, 15, v0
    v_lshrrev_b32 v230, 5, v229
    v_lshl_add_u32 v231, v230, 4, v231
    v_lshrrev_b32 v232, 4, v0
    v_lshl_add_u32 v231, v232, 7, v231
    s_lshl_b32 s82, s79, 3
    s_mov_b32 s80, 0xeff4fa00
    s_mov_b32 s81, 0xdbe0e5ea
    s_lshr_b64 s[80:81], s[80:81], s82
    s_sext_i32_i8 s80, s80
    s_mov_b32 exec_lo, 0x0
    s_mov_b32 exec_hi, 0x3ff
    v_add_u32 v231, s80, v231
    s_mov_b32 s80, 0xeff43d4c
    s_mov_b32 s81, 0xdbe0e5ea
    s_lshr_b64 s[80:81], s[80:81], s82
    s_sext_i32_i8 s80, s80
    s_mov_b32 exec_lo, 0x0
    s_mov_b32 exec_hi, 0x400
    v_add_u32 v231, s80, v231
    s_mov_b32 s80, 0x2c37424d
    s_mov_b32 s81, 0xb1621
    s_lshr_b64 s[80:81], s[80:81], s82
    s_sext_i32_i8 s80, s80
    s_mov_b32 exec_lo, 0x0
    s_mov_b32 exec_hi, 0xf800
    v_add_u32 v231, s80, v231
    s_mov_b64 exec, -1
    v_and_b32 v229, 31, v229
    v_lshl_add_u32 v245, v231, 5, v229
    s_mov_b32 s4, 0x10000
    s_mov_b32 s5, 0x10401
    s_cmp_eq_u32 s79, 1
    s_cselect_b32 s4, 0x10000, s4
    s_cselect_b32 s5, 0x14441, s5
    s_cmp_eq_u32 s79, 2
    s_cselect_b32 s4, 0x10000, s4
    s_cselect_b32 s5, 0x10801, s5
    s_cmp_eq_u32 s79, 3
    s_cselect_b32 s4, 0x10000, s4
    s_cselect_b32 s5, 0x10803, s5
    s_cmp_eq_u32 s79, 4
    s_cselect_b32 s4, 0x10000, s4
    s_cselect_b32 s5, 0x18841, s5
    s_cmp_eq_u32 s79, 5
    s_cselect_b32 s4, 0x10000, s4
    s_cselect_b32 s5, 0x10801, s5
    s_cmp_eq_u32 s79, 6
    s_cselect_b32 s4, 0x10000, s4
    s_cselect_b32 s5, 0x10801, s5
    s_cmp_eq_u32 s79, 7
    s_cselect_b32 s4, 0x10000, s4
    s_cselect_b32 s5, 0x10821, s5
    s_mov_b32 s7, 0xf149f2ca
    s_mov_b32 s77, 0xf149f2ca
    v_lshlrev_b32 v225, 4, v0
    v_mov_b32 v100, 0
    v_mov_b32 v101, 0
    v_mov_b32 v102, 0
    v_mov_b32 v103, 0
    s_lshl_b32 s78, s3, 11
    s_mov_b64 s[88:89], 0
    v_mov_b32 v216, 0xf149f2ca
    v_mov_b32 v217, 0
    v_mov_b32 v218, 0
    v_mov_b32 v204, 0
    v_mov_b32 v205, 0
    v_mov_b32 v206, 0
    v_mov_b32 v207, 0
    v_mov_b32 v208, 0
    v_mov_b32 v209, 0
    v_mov_b32 v210, 0
    v_mov_b32 v211, 0
    v_mov_b32 v212, 0
    v_mov_b32 v213, 0
    v_mov_b32 v214, 0
    v_mov_b32 v215, 0
    s_barrier
    s_waitcnt vmcnt(36)
    v_lshlrev_b32 v108, 16, v192
    v_and_b32 v109, 0xffff0000, v192
    v_pk_mul_f32 v[108:109], v[108:109], s[60:61]
    v_lshlrev_b32 v110, 16, v193
    v_and_b32 v111, 0xffff0000, v193
    v_pk_mul_f32 v[110:111], v[110:111], s[60:61]
    v_lshlrev_b32 v112, 16, v194
    v_and_b32 v113, 0xffff0000, v194
    v_pk_mul_f32 v[112:113], v[112:113], s[60:61]
    v_lshlrev_b32 v114, 16, v195
    v_and_b32 v115, 0xffff0000, v195
    v_pk_mul_f32 v[114:115], v[114:115], s[60:61]
    v_lshlrev_b32 v116, 16, v196
    v_and_b32 v117, 0xffff0000, v196
    v_pk_mul_f32 v[116:117], v[116:117], s[60:61]
    v_lshlrev_b32 v118, 16, v197
    v_and_b32 v119, 0xffff0000, v197
    v_pk_mul_f32 v[118:119], v[118:119], s[60:61]
    v_lshlrev_b32 v234, 16, v132
    v_and_b32 v235, 0xffff0000, v132
    v_pk_mul_f32 v[120:121], v[234:235], v[108:109]
    v_lshlrev_b32 v234, 16, v138
    v_and_b32 v235, 0xffff0000, v138
    v_pk_mul_f32 v[200:201], v[120:121], v[234:235]
    v_lshlrev_b32 v234, 16, v133
    v_and_b32 v235, 0xffff0000, v133
    v_pk_mul_f32 v[122:123], v[234:235], v[110:111]
    v_lshlrev_b32 v234, 16, v139
    v_and_b32 v235, 0xffff0000, v139
    v_pk_fma_f32 v[200:201], v[122:123], v[234:235], v[200:201]
    v_lshlrev_b32 v234, 16, v134
    v_and_b32 v235, 0xffff0000, v134
    v_pk_mul_f32 v[124:125], v[234:235], v[112:113]
    v_lshlrev_b32 v234, 16, v140
    v_and_b32 v235, 0xffff0000, v140
    v_pk_fma_f32 v[200:201], v[124:125], v[234:235], v[200:201]
    v_lshlrev_b32 v234, 16, v135
    v_and_b32 v235, 0xffff0000, v135
    v_pk_mul_f32 v[126:127], v[234:235], v[114:115]
    v_lshlrev_b32 v234, 16, v141
    v_and_b32 v235, 0xffff0000, v141
    v_pk_fma_f32 v[200:201], v[126:127], v[234:235], v[200:201]
    v_lshlrev_b32 v234, 16, v136
    v_and_b32 v235, 0xffff0000, v136
    v_pk_mul_f32 v[128:129], v[234:235], v[116:117]
    v_lshlrev_b32 v234, 16, v142
    v_and_b32 v235, 0xffff0000, v142
    v_pk_fma_f32 v[200:201], v[128:129], v[234:235], v[200:201]
    v_lshlrev_b32 v234, 16, v137
    v_and_b32 v235, 0xffff0000, v137
    v_pk_mul_f32 v[130:131], v[234:235], v[118:119]
    v_lshlrev_b32 v234, 16, v143
    v_and_b32 v235, 0xffff0000, v143
    v_pk_fma_f32 v[200:201], v[130:131], v[234:235], v[200:201]
    v_pk_mul_f32 v[200:201], v[200:201], s[62:63]
    s_mov_b32 s76, 63
L_loop0:
    s_waitcnt vmcnt(35)
    v_pk_fma_f32 v[198:199], v[120:121], v[4:5], v[200:201]
    v_pk_fma_f32 v[198:199], v[122:123], v[6:7], v[198:199]
    ds_read_b32 v244, v243 offset:147
    s_add_u32 s71, s71, 384000
    s_cbranch_vccnz L_th24_0
L_tb24_0:
    buffer_load_dwordx4 v[4:7], v1, s[24:27], s71 offen offset:0 nt
    v_add_f32_dpp v229, v228, v228 row_ror:8 row_mask:0xf bank_mask:0xc
    s_waitcnt vmcnt(35)
    v_pk_fma_f32 v[198:199], v[124:125], v[8:9], v[198:199]
    v_pk_fma_f32 v[198:199], v[126:127], v[10:11], v[198:199]
    buffer_load_dwordx4 v[8:11], v1, s[24:27], s71 offen offset:256 nt
    v_add_f32_dpp v230, v229, v229 row_shr:4 row_mask:0xf bank_mask:0xa
    s_waitcnt vmcnt(35)
    v_pk_fma_f32 v[198:199], v[128:129], v[12:13], v[198:199]
    v_pk_fma_f32 v[198:199], v[130:131], v[14:15], v[198:199]
    s_waitcnt lgkmcnt(0)
    v_cmp_lt_u32 vcc, v0, v244
    ds_add_u32 v224, v243 offset:3328
    buffer_load_dwordx4 v[12:15], v1, s[24:27], s71 offen offset:512 nt
    v_add_f32_dpp v232, v230, v230 quad_perm:[2,3,0,1] row_mask:0xf bank_mask:0xf
    v_add_f32 v228, v198, v199
    s_waitcnt vmcnt(35)
    v_pk_fma_f32 v[198:199], v[120:121], v[16:17], v[200:201]
    v_pk_fma_f32 v[198:199], v[122:123], v[18:19], v[198:199]
    s_add_u32 s71, s71, 3072
    s_cbranch_vccnz L_th27_0
L_tb27_0:
    buffer_load_dwordx4 v[16:19], v1, s[24:27], s71 offen offset:0 nt
    v_cndmask_b32 v232, v231, v232, s[64:65]
    v_add_f32_dpp v229, v228, v228 row_ror:8 row_mask:0xf bank_mask:0x3
    s_waitcnt vmcnt(29)
    v_pk_fma_f32 v[198:199], v[124:125], v[20:21], v[198:199]
    v_pk_fma_f32 v[198:199], v[126:127], v[22:23], v[198:199]
    s_add_u32 s72, s72, 3072
    buffer_load_dwordx2 v[180:181], v2, s[32:35], s72 offen offset:0
    buffer_load_dwordx2 v[182:183], v2, s[32:35], s72 offen offset:128
    buffer_load_dwordx2 v[184:185], v2, s[32:35], s72 offen offset:256
    buffer_load_dwordx2 v[186:187], v2, s[36:39], s72 offen offset:0
    buffer_load_dwordx2 v[188:189], v2, s[36:39], s72 offen offset:128
    buffer_load_dwordx2 v[190:191], v2, s[36:39], s72 offen offset:256
    buffer_load_dwordx4 v[20:23], v1, s[24:27], s71 offen offset:256 nt
    v_add_f32_dpp v231, v232, v232 quad_perm:[1,0,3,2] row_mask:0xf bank_mask:0xf
    v_lshlrev_b32 v234, 16, v156
    v_and_b32 v235, 0xffff0000, v156
    v_pk_mul_f32 v[144:145], v[234:235], v[108:109]
    v_lshlrev_b32 v234, 16, v162
    v_and_b32 v235, 0xffff0000, v162
    s_waitcnt vmcnt(35)
    v_pk_fma_f32 v[198:199], v[128:129], v[24:25], v[198:199]
    v_pk_fma_f32 v[198:199], v[130:131], v[26:27], v[198:199]
    ds_add_u32 v224, v243 offset:3328
    buffer_load_dwordx4 v[24:27], v1, s[24:27], s71 offen offset:512 nt
    v_cndmask_b32 v233, v233, v231, s[66:67]
    v_mul_f32 v233, 0x58000000, v233
    ds_write_b32 v239, v233
    v_add_u32 v239, 256, v239
    v_add_f32 v228, v198, v199
    v_pk_mul_f32 v[202:203], v[144:145], v[234:235]
    v_lshlrev_b32 v234, 16, v157
    v_and_b32 v235, 0xffff0000, v157
    v_pk_mul_f32 v[146:147], v[234:235], v[110:111]
    v_lshlrev_b32 v234, 16, v163
    s_waitcnt vmcnt(35)
    v_pk_fma_f32 v[198:199], v[120:121], v[28:29], v[200:201]
    v_pk_fma_f32 v[198:199], v[122:123], v[30:31], v[198:199]
    s_add_u32 s71, s71, 3072
    s_cbranch_vccnz L_th30_0
L_tb30_0:
    buffer_load_dwordx4 v[28:31], v1, s[24:27], s71 offen offset:0 nt
    v_add_f32_dpp v229, v228, v228 row_ror:8 row_mask:0xf bank_mask:0xc
    v_and_b32 v235, 0xffff0000, v163
    v_pk_fma_f32 v[202:203], v[146:147], v[234:235], v[202:203]
    v_lshlrev_b32 v234, 16, v158
    v_and_b32 v235, 0xffff0000, v158
    v_pk_mul_f32 v[148:149], v[234:235], v[112:113]
    s_waitcnt vmcnt(35)
    v_pk_fma_f32 v[198:199], v[124:125], v[32:33], v[198:199]
    v_pk_fma_f32 v[198:199], v[126:127], v[34:35], v[198:199]
    buffer_load_dwordx4 v[32:35], v1, s[24:27], s71 offen offset:256 nt
    v_add_f32_dpp v230, v229, v229 row_shl:4 row_mask:0xf bank_mask:0x5
    v_lshlrev_b32 v234, 16, v164
    v_and_b32 v235, 0xffff0000, v164
    v_pk_fma_f32 v[202:203], v[148:149], v[234:235], v[202:203]
    v_lshlrev_b32 v234, 16, v159
    v_and_b32 v235, 0xffff0000, v159
    s_waitcnt vmcnt(35)
    v_pk_fma_f32 v[198:199], v[128:129], v[36:37], v[198:199]
    v_pk_fma_f32 v[198:199], v[130:131], v[38:39], v[198:199]
    ds_add_u32 v224, v243 offset:3328
    buffer_load_dwordx4 v[36:39], v1, s[24:27], s71 offen offset:512 nt
    v_add_f32 v228, v198, v199
    v_pk_mul_f32 v[150:151], v[234:235], v[114:115]
    v_lshlrev_b32 v234, 16, v165
    v_and_b32 v235, 0xffff0000, v165
    v_pk_fma_f32 v[202:203], v[150:151], v[234:235], v[202:203]
    v_lshlrev_b32 v234, 16, v160
    s_waitcnt vmcnt(35)
    v_pk_fma_f32 v[198:199], v[120:121], v[40:41], v[200:201]
    v_pk_fma_f32 v[198:199], v[122:123], v[42:43], v[198:199]
    s_add_u32 s71, s71, 3072
    s_cbranch_vccnz L_th33_0
L_tb33_0:
    buffer_load_dwordx4 v[40:43], v1, s[24:27], s71 offen offset:0 nt
    v_add_f32_dpp v229, v228, v228 row_ror:8 row_mask:0xf bank_mask:0x3
    v_and_b32 v235, 0xffff0000, v160
    v_pk_mul_f32 v[152:153], v[234:235], v[116:117]
    v_lshlrev_b32 v234, 16, v166
    v_and_b32 v235, 0xffff0000, v166
    v_pk_fma_f32 v[202:203], v[152:153], v[234:235], v[202:203]
    s_waitcnt vmcnt(35)
    v_pk_fma_f32 v[198:199], v[124:125], v[44:45], v[198:199]
    v_pk_fma_f32 v[198:199], v[126:127], v[46:47], v[198:199]
    buffer_load_dwordx4 v[44:47], v1, s[24:27], s71 offen offset:256 nt
    v_lshlrev_b32 v234, 16, v161
    v_and_b32 v235, 0xffff0000, v161
    v_pk_mul_f32 v[154:155], v[234:235], v[118:119]
    v_lshlrev_b32 v234, 16, v167
    v_and_b32 v235, 0xffff0000, v167
    s_waitcnt vmcnt(35)
    v_pk_fma_f32 v[198:199], v[128:129], v[48:49], v[198:199]
    v_pk_fma_f32 v[198:199], v[130:131], v[50:51], v[198:199]
    ds_add_u32 v224, v243 offset:3328
    buffer_load_dwordx4 v[48:51], v1, s[24:27], s71 offen offset:512 nt
    v_add_f32 v228, v198, v199
    v_pk_fma_f32 v[202:203], v[154:155], v[234:235], v[202:203]
    v_pk_mul_f32 v[202:203], v[202:203], s[62:63]
    s_waitcnt vmcnt(35)
    v_pk_fma_f32 v[198:199], v[144:145], v[52:53], v[202:203]
    v_pk_fma_f32 v[198:199], v[146:147], v[54:55], v[198:199]
    ds_read_b32 v244, v243 offset:147
    v_readlane_b32 s70, v245, s91
    s_add_u32 s91, s91, 1
    s_lshr_b32 s74, s70, 9
    s_mul_i32 s74, s74, 384
    buffer_load_dwordx2 v[192:193], v2, s[48:51], s74 offen offset:0
    buffer_load_dwordx2 v[194:195], v2, s[48:51], s74 offen offset:128
    buffer_load_dwordx2 v[196:197], v2, s[48:51], s74 offen offset:256
    s_add_u32 s71, s71, 384000
    s_cbranch_vccnz L_th36_0
L_tb36_0:
    buffer_load_dwordx4 v[52:55], v1, s[24:27], s71 offen offset:0 nt
    v_add_f32_dpp v229, v228, v228 row_ror:8 row_mask:0xf bank_mask:0xc
    s_waitcnt vmcnt(38)
    v_pk_fma_f32 v[198:199], v[148:149], v[56:57], v[198:199]
    v_pk_fma_f32 v[198:199], v[150:151], v[58:59], v[198:199]
    buffer_load_dwordx4 v[56:59], v1, s[24:27], s71 offen offset:256 nt
    v_add_f32_dpp v230, v229, v229 row_shr:4 row_mask:0xf bank_mask:0xa
    s_waitcnt vmcnt(38)
    v_pk_fma_f32 v[198:199], v[152:153], v[60:61], v[198:199]
    v_pk_fma_f32 v[198:199], v[154:155], v[62:63], v[198:199]
    s_waitcnt lgkmcnt(0)
    v_cmp_lt_u32 vcc, v0, v244
    ds_add_u32 v224, v243 offset:3328
    buffer_load_dwordx4 v[60:63], v1, s[24:27], s71 offen offset:512 nt
    v_add_f32_dpp v231, v230, v230 quad_perm:[2,3,0,1] row_mask:0xf bank_mask:0xf
    v_add_f32 v228, v198, v199
    s_waitcnt vmcnt(38)
    v_pk_fma_f32 v[198:199], v[144:145], v[64:65], v[202:203]
    v_pk_fma_f32 v[198:199], v[146:147], v[66:67], v[198:199]
    s_add_u32 s71, s71, 3072
    s_cbranch_vccnz L_th39_0
L_tb39_0:
    buffer_load_dwordx4 v[64:67], v1, s[24:27], s71 offen offset:0 nt
    v_add_f32_dpp v229, v228, v228 row_ror:8 row_mask:0xf bank_mask:0x3
    s_waitcnt vmcnt(32)
    v_pk_fma_f32 v[198:199], v[148:149], v[68:69], v[198:199]
    v_pk_fma_f32 v[198:199], v[150:151], v[70:71], v[198:199]
    s_and_b32 s80, s70, 31
    s_sub_u32 s72, s70, s80
    s_lshr_b32 s80, s80, 2
    s_add_u32 s72, s72, s80
    s_mul_i32 s72, s72, 384
    buffer_load_dwordx2 v[132:133], v2, s[32:35], s72 offen offset:0
    buffer_load_dwordx2 v[134:135], v2, s[32:35], s72 offen offset:128
    buffer_load_dwordx2 v[136:137], v2, s[32:35], s72 offen offset:256
    buffer_load_dwordx2 v[138:139], v2, s[36:39], s72 offen offset:0
    buffer_load_dwordx2 v[140:141], v2, s[36:39], s72 offen offset:128
    buffer_load_dwordx2 v[142:143], v2, s[36:39], s72 offen offset:256
    buffer_load_dwordx4 v[68:71], v1, s[24:27], s71 offen offset:256 nt
    v_lshlrev_b32 v234, 16, v168
    v_and_b32 v235, 0xffff0000, v168
    v_pk_mul_f32 v[120:121], v[234:235], v[108:109]
    v_lshlrev_b32 v234, 16, v174
    v_and_b32 v235, 0xffff0000, v174
    s_waitcnt vmcnt(38)
    v_pk_fma_f32 v[198:199], v[152:153], v[72:73], v[198:199]
    v_pk_fma_f32 v[198:199], v[154:155], v[74:75], v[198:199]
    ds_add_u32 v224, v243 offset:3328
    buffer_load_dwordx4 v[72:75], v1, s[24:27], s71 offen offset:512 nt
    v_add_f32 v228, v198, v199
    v_pk_mul_f32 v[200:201], v[120:121], v[234:235]
    v_lshlrev_b32 v234, 16, v169
    v_and_b32 v235, 0xffff0000, v169
    v_pk_mul_f32 v[122:123], v[234:235], v[110:111]
    v_lshlrev_b32 v234, 16, v175
    s_waitcnt vmcnt(38)
    v_pk_fma_f32 v[198:199], v[144:145], v[76:77], v[202:203]
    v_pk_fma_f32 v[198:199], v[146:147], v[78:79], v[198:199]
    s_add_u32 s71, s71, 3072
    s_cbranch_vccnz L_th42_0
L_tb42_0:
    buffer_load_dwordx4 v[76:79], v1, s[24:27], s71 offen offset:0 nt
    v_add_f32_dpp v229, v228, v228 row_ror:8 row_mask:0xf bank_mask:0xc
    v_and_b32 v235, 0xffff0000, v175
    v_pk_fma_f32 v[200:201], v[122:123], v[234:235], v[200:201]
    v_lshlrev_b32 v234, 16, v170
    v_and_b32 v235, 0xffff0000, v170
    v_pk_mul_f32 v[124:125], v[234:235], v[112:113]
    s_waitcnt vmcnt(38)
    v_pk_fma_f32 v[198:199], v[148:149], v[80:81], v[198:199]
    v_pk_fma_f32 v[198:199], v[150:151], v[82:83], v[198:199]
    buffer_load_dwordx4 v[80:83], v1, s[24:27], s71 offen offset:256 nt
    v_add_f32_dpp v230, v229, v229 row_shl:4 row_mask:0xf bank_mask:0x5
    v_lshlrev_b32 v234, 16, v176
    v_and_b32 v235, 0xffff0000, v176
    v_pk_fma_f32 v[200:201], v[124:125], v[234:235], v[200:201]
    v_lshlrev_b32 v234, 16, v171
    v_and_b32 v235, 0xffff0000, v171
    s_waitcnt vmcnt(38)
    v_pk_fma_f32 v[198:199], v[152:153], v[84:85], v[198:199]
    v_pk_fma_f32 v[198:199], v[154:155], v[86:87], v[198:199]
    ds_add_u32 v224, v243 offset:3328
    buffer_load_dwordx4 v[84:87], v1, s[24:27], s71 offen offset:512 nt
    v_add_f32 v228, v198, v199
    v_pk_mul_f32 v[126:127], v[234:235], v[114:115]
    v_lshlrev_b32 v234, 16, v177
    v_and_b32 v235, 0xffff0000, v177
    v_pk_fma_f32 v[200:201], v[126:127], v[234:235], v[200:201]
    v_lshlrev_b32 v234, 16, v172
    s_waitcnt vmcnt(38)
    v_pk_fma_f32 v[198:199], v[144:145], v[88:89], v[202:203]
    v_pk_fma_f32 v[198:199], v[146:147], v[90:91], v[198:199]
    s_add_u32 s71, s71, 3072
    s_cbranch_vccnz L_th45_0
L_tb45_0:
    buffer_load_dwordx4 v[88:91], v1, s[24:27], s71 offen offset:0 nt
    v_add_f32_dpp v229, v228, v228 row_ror:8 row_mask:0xf bank_mask:0x3
    v_and_b32 v235, 0xffff0000, v172
    v_pk_mul_f32 v[128:129], v[234:235], v[116:117]
    v_lshlrev_b32 v234, 16, v178
    v_and_b32 v235, 0xffff0000, v178
    v_pk_fma_f32 v[200:201], v[128:129], v[234:235], v[200:201]
    s_waitcnt vmcnt(38)
    v_pk_fma_f32 v[198:199], v[148:149], v[92:93], v[198:199]
    v_pk_fma_f32 v[198:199], v[150:151], v[94:95], v[198:199]
    buffer_load_dwordx4 v[92:95], v1, s[24:27], s71 offen offset:256 nt
    v_lshlrev_b32 v234, 16, v173
    v_and_b32 v235, 0xffff0000, v173
    v_pk_mul_f32 v[130:131], v[234:235], v[118:119]
    v_lshlrev_b32 v234, 16, v179
    v_and_b32 v235, 0xffff0000, v179
    s_waitcnt vmcnt(38)
    v_pk_fma_f32 v[198:199], v[152:153], v[96:97], v[198:199]
    v_pk_fma_f32 v[198:199], v[154:155], v[98:99], v[198:199]
    ds_add_u32 v224, v243 offset:3328
    buffer_load_dwordx4 v[96:99], v1, s[24:27], s71 offen offset:512 nt
    v_add_f32 v228, v198, v199
    v_pk_fma_f32 v[200:201], v[130:131], v[234:235], v[200:201]
    v_pk_mul_f32 v[200:201], v[200:201], s[62:63]
    s_waitcnt vmcnt(38)
    v_pk_fma_f32 v[198:199], v[120:121], v[4:5], v[200:201]
    v_pk_fma_f32 v[198:199], v[122:123], v[6:7], v[198:199]
    ds_read_b32 v244, v243 offset:147
    s_mul_i32 s71, s70, 49152
    s_and_b32 s80, s70, 31
    s_mul_i32 s80, s80, 36864
    s_sub_u32 s71, s71, s80
    s_cbranch_vccnz L_th0_0
L_tb0_0:
    buffer_load_dwordx4 v[4:7], v1, s[24:27], s71 offen offset:0 nt
    v_add_f32_dpp v229, v228, v228 row_ror:8 row_mask:0xf bank_mask:0xc
    s_waitcnt vmcnt(38)
    v_pk_fma_f32 v[198:199], v[124:125], v[8:9], v[198:199]
    v_pk_fma_f32 v[198:199], v[126:127], v[10:11], v[198:199]
    buffer_load_dwordx4 v[8:11], v1, s[24:27], s71 offen offset:256 nt
    v_add_f32_dpp v230, v229, v229 row_shr:4 row_mask:0xf bank_mask:0xa
    s_waitcnt vmcnt(38)
    v_pk_fma_f32 v[198:199], v[128:129], v[12:13], v[198:199]
    v_pk_fma_f32 v[198:199], v[130:131], v[14:15], v[198:199]
    s_waitcnt lgkmcnt(0)
    v_cmp_lt_u32 vcc, v0, v244
    ds_add_u32 v224, v243 offset:3328
    buffer_load_dwordx4 v[12:15], v1, s[24:27], s71 offen offset:512 nt
    v_add_f32_dpp v232, v230, v230 quad_perm:[2,3,0,1] row_mask:0xf bank_mask:0xf
    v_add_f32 v228, v198, v199
    s_waitcnt vmcnt(38)
    v_pk_fma_f32 v[198:199], v[120:121], v[16:17], v[200:201]
    v_pk_fma_f32 v[198:199], v[122:123], v[18:19], v[198:199]
    s_add_u32 s71, s71, 3072
    s_cbranch_vccnz L_th3_0
L_tb3_0:
    buffer_load_dwordx4 v[16:19], v1, s[24:27], s71 offen offset:0 nt
    v_cndmask_b32 v232, v231, v232, s[64:65]
    v_add_f32_dpp v229, v228, v228 row_ror:8 row_mask:0xf bank_mask:0x3
    s_waitcnt vmcnt(32)
    v_pk_fma_f32 v[198:199], v[124:125], v[20:21], v[198:199]
    v_pk_fma_f32 v[198:199], v[126:127], v[22:23], v[198:199]
    s_add_u32 s72, s72, 3072
    buffer_load_dwordx2 v[156:157], v2, s[32:35], s72 offen offset:0
    buffer_load_dwordx2 v[158:159], v2, s[32:35], s72 offen offset:128
    buffer_load_dwordx2 v[160:161], v2, s[32:35], s72 offen offset:256
    buffer_load_dwordx2 v[162:163], v2, s[36:39], s72 offen offset:0
    buffer_load_dwordx2 v[164:165], v2, s[36:39], s72 offen offset:128
    buffer_load_dwordx2 v[166:167], v2, s[36:39], s72 offen offset:256
    buffer_load_dwordx4 v[20:23], v1, s[24:27], s71 offen offset:256 nt
    v_add_f32_dpp v233, v232, v232 quad_perm:[1,0,3,2] row_mask:0xf bank_mask:0xf
    v_lshlrev_b32 v234, 16, v180
    v_and_b32 v235, 0xffff0000, v180
    v_pk_mul_f32 v[144:145], v[234:235], v[108:109]
    v_lshlrev_b32 v234, 16, v186
    v_and_b32 v235, 0xffff0000, v186
    s_waitcnt vmcnt(38)
    v_pk_fma_f32 v[198:199], v[128:129], v[24:25], v[198:199]
    v_pk_fma_f32 v[198:199], v[130:131], v[26:27], v[198:199]
    ds_add_u32 v224, v243 offset:3328
    buffer_load_dwordx4 v[24:27], v1, s[24:27], s71 offen offset:512 nt
    v_add_f32 v228, v198, v199
    v_pk_mul_f32 v[202:203], v[144:145], v[234:235]
    s_branch L_x0
L_w0:
    s_branch L_w1
L_x0:
    v_lshlrev_b32 v234, 16, v181
    v_and_b32 v235, 0xffff0000, v181
    v_pk_mul_f32 v[146:147], v[234:235], v[110:111]
    v_lshlrev_b32 v234, 16, v187
    s_waitcnt vmcnt(38)
    v_pk_fma_f32 v[198:199], v[120:121], v[28:29], v[200:201]
    v_pk_fma_f32 v[198:199], v[122:123], v[30:31], v[198:199]
    s_add_u32 s71, s71, 3072
    s_cbranch_vccnz L_th6_0
L_tb6_0:
    buffer_load_dwordx4 v[28:31], v1, s[24:27], s71 offen offset:0 nt
    v_add_f32_dpp v229, v228, v228 row_ror:8 row_mask:0xf bank_mask:0xc
    v_and_b32 v235, 0xffff0000, v187
    v_pk_fma_f32 v[202:203], v[146:147], v[234:235], v[202:203]
    v_lshlrev_b32 v234, 16, v182
    v_and_b32 v235, 0xffff0000, v182
    v_pk_mul_f32 v[148:149], v[234:235], v[112:113]
    s_waitcnt vmcnt(38)
    v_pk_fma_f32 v[198:199], v[124:125], v[32:33], v[198:199]
    v_pk_fma_f32 v[198:199], v[126:127], v[34:35], v[198:199]
    buffer_load_dwordx4 v[32:35], v1, s[24:27], s71 offen offset:256 nt
    v_add_f32_dpp v230, v229, v229 row_shl:4 row_mask:0xf bank_mask:0x5
    v_lshlrev_b32 v234, 16, v188
    v_and_b32 v235, 0xffff0000, v188
    v_pk_fma_f32 v[202:203], v[148:149], v[234:235], v[202:203]
    v_lshlrev_b32 v234, 16, v183
    v_and_b32 v235, 0xffff0000, v183
    s_waitcnt vmcnt(38)
    v_pk_fma_f32 v[198:199], v[128:129], v[36:37], v[198:199]
    v_pk_fma_f32 v[198:199], v[130:131], v[38:39], v[198:199]
    ds_add_u32 v224, v243 offset:3328
    buffer_load_dwordx4 v[36:39], v1, s[24:27], s71 offen offset:512 nt
    v_add_f32 v228, v198, v199
    v_pk_mul_f32 v[150:151], v[234:235], v[114:115]
    v_lshlrev_b32 v234, 16, v189
    v_and_b32 v235, 0xffff0000, v189
    v_pk_fma_f32 v[202:203], v[150:151], v[234:235], v[202:203]
    v_lshlrev_b32 v234, 16, v184
    s_waitcnt vmcnt(38)
    v_pk_fma_f32 v[198:199], v[120:121], v[40:41], v[200:201]
    v_pk_fma_f32 v[198:199], v[122:123], v[42:43], v[198:199]
    s_add_u32 s71, s71, 3072
    s_cbranch_vccnz L_th9_0
L_tb9_0:
    buffer_load_dwordx4 v[40:43], v1, s[24:27], s71 offen offset:0 nt
    v_add_f32_dpp v229, v228, v228 row_ror:8 row_mask:0xf bank_mask:0x3
    v_and_b32 v235, 0xffff0000, v184
    v_pk_mul_f32 v[152:153], v[234:235], v[116:117]
    v_lshlrev_b32 v234, 16, v190
    v_and_b32 v235, 0xffff0000, v190
    v_pk_fma_f32 v[202:203], v[152:153], v[234:235], v[202:203]
    s_waitcnt vmcnt(38)
    v_pk_fma_f32 v[198:199], v[124:125], v[44:45], v[198:199]
    v_pk_fma_f32 v[198:199], v[126:127], v[46:47], v[198:199]
    buffer_load_dwordx4 v[44:47], v1, s[24:27], s71 offen offset:256 nt
    v_lshlrev_b32 v234, 16, v185
    v_and_b32 v235, 0xffff0000, v185
    v_pk_mul_f32 v[154:155], v[234:235], v[118:119]
    v_lshlrev_b32 v234, 16, v191
    v_and_b32 v235, 0xffff0000, v191
    s_waitcnt vmcnt(38)
    v_pk_fma_f32 v[198:199], v[128:129], v[48:49], v[198:199]
    v_pk_fma_f32 v[198:199], v[130:131], v[50:51], v[198:199]
    ds_add_u32 v224, v243 offset:3328
    buffer_load_dwordx4 v[48:51], v1, s[24:27], s71 offen offset:512 nt
    v_add_f32 v228, v198, v199
    v_pk_fma_f32 v[202:203], v[154:155], v[234:235], v[202:203]
    v_pk_mul_f32 v[202:203], v[202:203], s[62:63]
    s_waitcnt vmcnt(35)
    v_pk_fma_f32 v[198:199], v[144:145], v[52:53], v[202:203]
    v_pk_fma_f32 v[198:199], v[146:147], v[54:55], v[198:199]
    ds_read_b32 v244, v243 offset:147
    s_add_u32 s71, s71, 384000
    s_cbranch_vccnz L_th12_0
L_tb12_0:
    buffer_load_dwordx4 v[52:55], v1, s[24:27], s71 offen offset:0 nt
    v_add_f32_dpp v229, v228, v228 row_ror:8 row_mask:0xf bank_mask:0xc
    v_lshlrev_b32 v108, 16, v192
    v_and_b32 v109, 0xffff0000, v192
    v_pk_mul_f32 v[108:109], v[108:109], s[60:61]
    v_lshlrev_b32 v110, 16, v193
    v_and_b32 v111, 0xffff0000, v193
    s_waitcnt vmcnt(35)
    v_pk_fma_f32 v[198:199], v[148:149], v[56:57], v[198:199]
    v_pk_fma_f32 v[198:199], v[150:151], v[58:59], v[198:199]
    buffer_load_dwordx4 v[56:59], v1, s[24:27], s71 offen offset:256 nt
    v_add_f32_dpp v230, v229, v229 row_shr:4 row_mask:0xf bank_mask:0xa
    v_pk_mul_f32 v[110:111], v[110:111], s[60:61]
    v_lshlrev_b32 v112, 16, v194
    v_and_b32 v113, 0xffff0000, v194
    v_pk_mul_f32 v[112:113], v[112:113], s[60:61]
    v_lshlrev_b32 v114, 16, v195
    s_waitcnt vmcnt(35)
    v_pk_fma_f32 v[198:199], v[152:153], v[60:61], v[198:199]
    v_pk_fma_f32 v[198:199], v[154:155], v[62:63], v[198:199]
    s_waitcnt lgkmcnt(0)
    v_cmp_lt_u32 vcc, v0, v244
    ds_add_u32 v224, v243 offset:3328
    buffer_load_dwordx4 v[60:63], v1, s[24:27], s71 offen offset:512 nt
    v_add_f32_dpp v231, v230, v230 quad_perm:[2,3,0,1] row_mask:0xf bank_mask:0xf
    v_add_f32 v228, v198, v199
    v_and_b32 v115, 0xffff0000, v195
    v_pk_mul_f32 v[114:115], v[114:115], s[60:61]
    v_lshlrev_b32 v116, 16, v196
    v_and_b32 v117, 0xffff0000, v196
    v_pk_mul_f32 v[116:117], v[116:117], s[60:61]
    s_waitcnt vmcnt(35)
    v_pk_fma_f32 v[198:199], v[144:145], v[64:65], v[202:203]
    v_pk_fma_f32 v[198:199], v[146:147], v[66:67], v[198:199]
    s_add_u32 s71, s71, 3072
    s_cbranch_vccnz L_th15_0
L_tb15_0:
    buffer_load_dwordx4 v[64:67], v1, s[24:27], s71 offen offset:0 nt
    v_add_f32_dpp v229, v228, v228 row_ror:8 row_mask:0xf bank_mask:0x3
    v_lshlrev_b32 v118, 16, v197
    v_and_b32 v119, 0xffff0000, v197
    v_pk_mul_f32 v[118:119], v[118:119], s[60:61]
    s_waitcnt vmcnt(29)
    v_pk_fma_f32 v[198:199], v[148:149], v[68:69], v[198:199]
    v_pk_fma_f32 v[198:199], v[150:151], v[70:71], v[198:199]
    s_add_u32 s72, s72, 3072
    buffer_load_dwordx2 v[168:169], v2, s[32:35], s72 offen offset:0
    buffer_load_dwordx2 v[170:171], v2, s[32:35], s72 offen offset:128
    buffer_load_dwordx2 v[172:173], v2, s[32:35], s72 offen offset:256
    buffer_load_dwordx2 v[174:175], v2, s[36:39], s72 offen offset:0
    buffer_load_dwordx2 v[176:177], v2, s[36:39], s72 offen offset:128
    buffer_load_dwordx2 v[178:179], v2, s[36:39], s72 offen offset:256
    buffer_load_dwordx4 v[68:71], v1, s[24:27], s71 offen offset:256 nt
    v_lshlrev_b32 v234, 16, v132
    v_and_b32 v235, 0xffff0000, v132
    v_pk_mul_f32 v[120:121], v[234:235], v[108:109]
    v_lshlrev_b32 v234, 16, v138
    v_and_b32 v235, 0xffff0000, v138
    s_waitcnt vmcnt(35)
    v_pk_fma_f32 v[198:199], v[152:153], v[72:73], v[198:199]
    v_pk_fma_f32 v[198:199], v[154:155], v[74:75], v[198:199]
    ds_add_u32 v224, v243 offset:3328
    buffer_load_dwordx4 v[72:75], v1, s[24:27], s71 offen offset:512 nt
    v_add_f32 v228, v198, v199
    v_pk_mul_f32 v[200:201], v[120:121], v[234:235]
    v_lshlrev_b32 v234, 16, v133
    v_and_b32 v235, 0xffff0000, v133
    v_pk_mul_f32 v[122:123], v[234:235], v[110:111]
    v_lshlrev_b32 v234, 16, v139
    s_waitcnt vmcnt(35)
    v_pk_fma_f32 v[198:199], v[144:145], v[76:77], v[202:203]
    v_pk_fma_f32 v[198:199], v[146:147], v[78:79], v[198:199]
    s_add_u32 s71, s71, 3072
    s_cbranch_vccnz L_th18_0
L_tb18_0:
    buffer_load_dwordx4 v[76:79], v1, s[24:27], s71 offen offset:0 nt
    v_add_f32_dpp v229, v228, v228 row_ror:8 row_mask:0xf bank_mask:0xc
    v_and_b32 v235, 0xffff0000, v139
    v_pk_fma_f32 v[200:201], v[122:123], v[234:235], v[200:201]
    v_lshlrev_b32 v234, 16, v134
    v_and_b32 v235, 0xffff0000, v134
    v_pk_mul_f32 v[124:125], v[234:235], v[112:113]
    s_waitcnt vmcnt(35)
    v_pk_fma_f32 v[198:199], v[148:149], v[80:81], v[198:199]
    v_pk_fma_f32 v[198:199], v[150:151], v[82:83], v[198:199]
    buffer_load_dwordx4 v[80:83], v1, s[24:27], s71 offen offset:256 nt
    v_add_f32_dpp v230, v229, v229 row_shl:4 row_mask:0xf bank_mask:0x5
    v_lshlrev_b32 v234, 16, v140
    v_and_b32 v235, 0xffff0000, v140
    v_pk_fma_f32 v[200:201], v[124:125], v[234:235], v[200:201]
    v_lshlrev_b32 v234, 16, v135
    v_and_b32 v235, 0xffff0000, v135
    s_waitcnt vmcnt(35)
    v_pk_fma_f32 v[198:199], v[152:153], v[84:85], v[198:199]
    v_pk_fma_f32 v[198:199], v[154:155], v[86:87], v[198:199]
    ds_add_u32 v224, v243 offset:3328
    buffer_load_dwordx4 v[84:87], v1, s[24:27], s71 offen offset:512 nt
    v_add_f32 v228, v198, v199
    v_pk_mul_f32 v[126:127], v[234:235], v[114:115]
    v_lshlrev_b32 v234, 16, v141
    v_and_b32 v235, 0xffff0000, v141
    v_pk_fma_f32 v[200:201], v[126:127], v[234:235], v[200:201]
    v_lshlrev_b32 v234, 16, v136
    s_waitcnt vmcnt(35)
    v_pk_fma_f32 v[198:199], v[144:145], v[88:89], v[202:203]
    v_pk_fma_f32 v[198:199], v[146:147], v[90:91], v[198:199]
    s_add_u32 s71, s71, 3072
    s_cbranch_vccnz L_th21_0
L_tb21_0:
    buffer_load_dwordx4 v[88:91], v1, s[24:27], s71 offen offset:0 nt
    v_add_f32_dpp v229, v228, v228 row_ror:8 row_mask:0xf bank_mask:0x3
    v_and_b32 v235, 0xffff0000, v136
    v_pk_mul_f32 v[128:129], v[234:235], v[116:117]
    v_lshlrev_b32 v234, 16, v142
    v_and_b32 v235, 0xffff0000, v142
    v_pk_fma_f32 v[200:201], v[128:129], v[234:235], v[200:201]
    s_waitcnt vmcnt(35)
    v_pk_fma_f32 v[198:199], v[148:149], v[92:93], v[198:199]
    v_pk_fma_f32 v[198:199], v[150:151], v[94:95], v[198:199]
    buffer_load_dwordx4 v[92:95], v1, s[24:27], s71 offen offset:256 nt
    v_lshlrev_b32 v234, 16, v137
    v_and_b32 v235, 0xffff0000, v137
    v_pk_mul_f32 v[130:131], v[234:235], v[118:119]
    v_lshlrev_b32 v234, 16, v143
    v_and_b32 v235, 0xffff0000, v143
    s_waitcnt vmcnt(35)
    v_pk_fma_f32 v[198:199], v[152:153], v[96:97], v[198:199]
    v_pk_fma_f32 v[198:199], v[154:155], v[98:99], v[198:199]
    ds_add_u32 v224, v243 offset:3328
    buffer_load_dwordx4 v[96:99], v1, s[24:27], s71 offen offset:512 nt
    v_add_f32 v228, v198, v199
    v_pk_fma_f32 v[200:201], v[130:131], v[234:235], v[200:201]
    v_pk_mul_f32 v[200:201], v[200:201], s[62:63]
    s_sub_u32 s76, s76, 1
    s_cmp_lg_u32 s76, 0
    s_cbranch_scc1 L_loop0
L_h0:
    s_cbranch_execz L_h1
    s_waitcnt vmcnt(35)
    v_pk_fma_f32 v[198:199], v[120:121], v[4:5], v[200:201]
L_h1:
    s_cbranch_execz L_h2
    v_pk_fma_f32 v[198:199], v[122:123], v[6:7], v[198:199]
    ds_read_b32 v244, v243 offset:147
    s_add_u32 s71, s71, 384000
    s_cbranch_vccnz L_th24_1
L_tb24_1:
    buffer_load_dwordx4 v[4:7], v1, s[24:27], s71 offen offset:0 nt
    v_add_f32_dpp v229, v228, v228 row_ror:8 row_mask:0xf bank_mask:0xc
    s_waitcnt vmcnt(35)
    v_pk_fma_f32 v[198:199], v[124:125], v[8:9], v[198:199]
    v_pk_fma_f32 v[198:199], v[126:127], v[10:11], v[198:199]
    buffer_load_dwordx4 v[8:11], v1, s[24:27], s71 offen offset:256 nt
    v_add_f32_dpp v230, v229, v229 row_shr:4 row_mask:0xf bank_mask:0xa
    s_waitcnt vmcnt(35)
    v_pk_fma_f32 v[198:199], v[128:129], v[12:13], v[198:199]
    v_pk_fma_f32 v[198:199], v[130:131], v[14:15], v[198:199]
    s_waitcnt lgkmcnt(0)
    v_cmp_lt_u32 vcc, v0, v244
    ds_add_u32 v224, v243 offset:3328
    buffer_load_dwordx4 v[12:15], v1, s[24:27], s71 offen offset:512 nt
L_h2:
    s_cbranch_execz L_h3
    v_add_f32_dpp v232, v230, v230 quad_perm:[2,3,0,1] row_mask:0xf bank_mask:0xf
    v_add_f32 v228, v198, v199
    s_waitcnt vmcnt(35)
    v_pk_fma_f32 v[198:199], v[120:121], v[16:17], v[200:201]
    v_pk_fma_f32 v[198:199], v[122:123], v[18:19], v[198:199]
    s_add_u32 s71, s71, 3072
    s_cbranch_vccnz L_th27_1
L_tb27_1:
    buffer_load_dwordx4 v[16:19], v1, s[24:27], s71 offen offset:0 nt
    v_cndmask_b32 v232, v231, v232, s[64:65]
    v_add_f32_dpp v229, v228, v228 row_ror:8 row_mask:0xf bank_mask:0x3
    s_waitcnt vmcnt(29)
    v_pk_fma_f32 v[198:199], v[124:125], v[20:21], v[198:199]
    v_pk_fma_f32 v[198:199], v[126:127], v[22:23], v[198:199]
    s_add_u32 s72, s72, 3072
    buffer_load_dwordx2 v[180:181], v2, s[32:35], s72 offen offset:0
    buffer_load_dwordx2 v[182:183], v2, s[32:35], s72 offen offset:128
    buffer_load_dwordx2 v[184:185], v2, s[32:35], s72 offen offset:256
    buffer_load_dwordx2 v[186:187], v2, s[36:39], s72 offen offset:0
L_h3:
    s_cbranch_execz L_h4
    buffer_load_dwordx2 v[188:189], v2, s[36:39], s72 offen offset:128
    buffer_load_dwordx2 v[190:191], v2, s[36:39], s72 offen offset:256
    buffer_load_dwordx4 v[20:23], v1, s[24:27], s71 offen offset:256 nt
    v_add_f32_dpp v231, v232, v232 quad_perm:[1,0,3,2] row_mask:0xf bank_mask:0xf
    v_lshlrev_b32 v234, 16, v156
    v_and_b32 v235, 0xffff0000, v156
    v_pk_mul_f32 v[144:145], v[234:235], v[108:109]
    v_lshlrev_b32 v234, 16, v162
    v_and_b32 v235, 0xffff0000, v162
    s_waitcnt vmcnt(35)
    v_pk_fma_f32 v[198:199], v[128:129], v[24:25], v[198:199]
    v_pk_fma_f32 v[198:199], v[130:131], v[26:27], v[198:199]
    ds_add_u32 v224, v243 offset:3328
    buffer_load_dwordx4 v[24:27], v1, s[24:27], s71 offen offset:512 nt
    v_cndmask_b32 v233, v233, v231, s[66:67]
    v_mul_f32 v233, 0x58000000, v233
    ds_write_b32 v239, v233
L_h4:
    s_cbranch_execz L_h5
    v_add_u32 v239, 256, v239
    v_add_f32 v228, v198, v199
    v_pk_mul_f32 v[202:203], v[144:145], v[234:235]
    v_lshlrev_b32 v234, 16, v157
    v_and_b32 v235, 0xffff0000, v157
    v_pk_mul_f32 v[146:147], v[234:235], v[110:111]
    v_lshlrev_b32 v234, 16, v163
    s_waitcnt vmcnt(35)
    v_pk_fma_f32 v[198:199], v[120:121], v[28:29], v[200:201]
    v_pk_fma_f32 v[198:199], v[122:123], v[30:31], v[198:199]
    s_add_u32 s71, s71, 3072
    s_cbranch_vccnz L_th30_1
L_tb30_1:
    buffer_load_dwordx4 v[28:31], v1, s[24:27], s71 offen offset:0 nt
    v_add_f32_dpp v229, v228, v228 row_ror:8 row_mask:0xf bank_mask:0xc
    v_and_b32 v235, 0xffff0000, v163
    v_pk_fma_f32 v[202:203], v[146:147], v[234:235], v[202:203]
    v_lshlrev_b32 v234, 16, v158
    v_and_b32 v235, 0xffff0000, v158
L_h5:
    s_cbranch_execz L_h6
    v_pk_mul_f32 v[148:149], v[234:235], v[112:113]
    s_waitcnt vmcnt(35)
    v_pk_fma_f32 v[198:199], v[124:125], v[32:33], v[198:199]
    v_pk_fma_f32 v[198:199], v[126:127], v[34:35], v[198:199]
    buffer_load_dwordx4 v[32:35], v1, s[24:27], s71 offen offset:256 nt
    v_add_f32_dpp v230, v229, v229 row_shl:4 row_mask:0xf bank_mask:0x5
    v_lshlrev_b32 v234, 16, v164
    v_and_b32 v235, 0xffff0000, v164
    v_pk_fma_f32 v[202:203], v[148:149], v[234:235], v[202:203]
    v_lshlrev_b32 v234, 16, v159
    v_and_b32 v235, 0xffff0000, v159
    s_waitcnt vmcnt(35)
    v_pk_fma_f32 v[198:199], v[128:129], v[36:37], v[198:199]
    v_pk_fma_f32 v[198:199], v[130:131], v[38:39], v[198:199]
    ds_add_u32 v224, v243 offset:3328
    buffer_load_dwordx4 v[36:39], v1, s[24:27], s71 offen offset:512 nt
    v_add_f32 v228, v198, v199
    v_pk_mul_f32 v[150:151], v[234:235], v[114:115]
L_h6:
    s_cbranch_execz L_h7
    v_lshlrev_b32 v234, 16, v165
    v_and_b32 v235, 0xffff0000, v165
    v_pk_fma_f32 v[202:203], v[150:151], v[234:235], v[202:203]
    v_lshlrev_b32 v234, 16, v160
    s_waitcnt vmcnt(35)
    v_pk_fma_f32 v[198:199], v[120:121], v[40:41], v[200:201]
    v_pk_fma_f32 v[198:199], v[122:123], v[42:43], v[198:199]
    s_add_u32 s71, s71, 3072
    s_cbranch_vccnz L_th33_1
L_tb33_1:
    buffer_load_dwordx4 v[40:43], v1, s[24:27], s71 offen offset:0 nt
    v_add_f32_dpp v229, v228, v228 row_ror:8 row_mask:0xf bank_mask:0x3
    v_and_b32 v235, 0xffff0000, v160
    v_pk_mul_f32 v[152:153], v[234:235], v[116:117]
    v_lshlrev_b32 v234, 16, v166
    v_and_b32 v235, 0xffff0000, v166
    v_pk_fma_f32 v[202:203], v[152:153], v[234:235], v[202:203]
    s_waitcnt vmcnt(35)
    v_pk_fma_f32 v[198:199], v[124:125], v[44:45], v[198:199]
    v_pk_fma_f32 v[198:199], v[126:127], v[46:47], v[198:199]
L_h7:
    s_cbranch_execz L_h8
    buffer_load_dwordx4 v[44:47], v1, s[24:27], s71 offen offset:256 nt
    v_lshlrev_b32 v234, 16, v161
    v_and_b32 v235, 0xffff0000, v161
    v_pk_mul_f32 v[154:155], v[234:235], v[118:119]
    v_lshlrev_b32 v234, 16, v167
    v_and_b32 v235, 0xffff0000, v167
    s_waitcnt vmcnt(35)
    v_pk_fma_f32 v[198:199], v[128:129], v[48:49], v[198:199]
    v_pk_fma_f32 v[198:199], v[130:131], v[50:51], v[198:199]
    ds_add_u32 v224, v243 offset:3328
    buffer_load_dwordx4 v[48:51], v1, s[24:27], s71 offen offset:512 nt
    v_add_f32 v228, v198, v199
    v_pk_fma_f32 v[202:203], v[154:155], v[234:235], v[202:203]
    v_pk_mul_f32 v[202:203], v[202:203], s[62:63]
    s_waitcnt vmcnt(35)
    v_pk_fma_f32 v[198:199], v[144:145], v[52:53], v[202:203]
    v_pk_fma_f32 v[198:199], v[146:147], v[54:55], v[198:199]
    ds_read_b32 v244, v243 offset:147
L_h8:
    s_cbranch_execz L_h9
    s_mov_b32 s91, 0
    v_readlane_b32 s70, v245, s91
    s_add_u32 s91, s91, 1
    s_and_b32 s80, s70, 31
    s_mul_i32 s80, s80, 96
    s_lshl_b32 s73, s70, 7
    s_sub_u32 s73, s73, s80
    buffer_load_ushort v220, v3, s[40:43], s73 offen
    buffer_load_ushort v221, v3, s[44:47], s73 offen
    s_add_u32 s71, s71, 384000
    s_cbranch_vccnz L_th36_1
L_tb36_1:
    buffer_load_dwordx4 v[52:55], v1, s[24:27], s71 offen offset:0 nt
    v_add_f32_dpp v229, v228, v228 row_ror:8 row_mask:0xf bank_mask:0xc
    s_waitcnt vmcnt(37)
    v_pk_fma_f32 v[198:199], v[148:149], v[56:57], v[198:199]
    v_pk_fma_f32 v[198:199], v[150:151], v[58:59], v[198:199]
    buffer_load_dwordx4 v[56:59], v1, s[24:27], s71 offen offset:256 nt
    v_add_f32_dpp v230, v229, v229 row_shr:4 row_mask:0xf bank_mask:0xa
    s_waitcnt vmcnt(37)
L_h9:
    s_cbranch_execz L_h10
    v_pk_fma_f32 v[198:199], v[152:153], v[60:61], v[198:199]
    v_pk_fma_f32 v[198:199], v[154:155], v[62:63], v[198:199]
    s_waitcnt lgkmcnt(0)
    v_cmp_lt_u32 vcc, v0, v244
    ds_add_u32 v224, v243 offset:3328
    buffer_load_dwordx4 v[60:63], v1, s[24:27], s71 offen offset:512 nt
    v_add_f32_dpp v231, v230, v230 quad_perm:[2,3,0,1] row_mask:0xf bank_mask:0xf
    v_add_f32 v228, v198, v199
    s_waitcnt vmcnt(37)
    v_pk_fma_f32 v[198:199], v[144:145], v[64:65], v[202:203]
    v_pk_fma_f32 v[198:199], v[146:147], v[66:67], v[198:199]
    s_add_u32 s71, s71, 3072
    s_cbranch_vccnz L_th39_1
L_tb39_1:
    buffer_load_dwordx4 v[64:67], v1, s[24:27], s71 offen offset:0 nt
    v_add_f32_dpp v229, v228, v228 row_ror:8 row_mask:0xf bank_mask:0x3
    s_waitcnt vmcnt(31)
    v_pk_fma_f32 v[198:199], v[148:149], v[68:69], v[198:199]
    v_pk_fma_f32 v[198:199], v[150:151], v[70:71], v[198:199]
    buffer_load_dwordx4 v[68:71], v1, s[24:27], s71 offen offset:256 nt
L_h10:
    s_cbranch_execz L_h11
    v_lshlrev_b32 v234, 16, v168
    v_and_b32 v235, 0xffff0000, v168
    v_pk_mul_f32 v[120:121], v[234:235], v[108:109]
    v_lshlrev_b32 v234, 16, v174
    v_and_b32 v235, 0xffff0000, v174
    s_waitcnt vmcnt(31)
    v_pk_fma_f32 v[198:199], v[152:153], v[72:73], v[198:199]
    v_pk_fma_f32 v[198:199], v[154:155], v[74:75], v[198:199]
    ds_add_u32 v224, v243 offset:3328
    buffer_load_dwordx4 v[72:75], v1, s[24:27], s71 offen offset:512 nt
    v_add_f32 v228, v198, v199
    v_pk_mul_f32 v[200:201], v[120:121], v[234:235]
    v_lshlrev_b32 v234, 16, v169
    v_and_b32 v235, 0xffff0000, v169
    v_pk_mul_f32 v[122:123], v[234:235], v[110:111]
    v_lshlrev_b32 v234, 16, v175
    s_waitcnt vmcnt(31)
    v_pk_fma_f32 v[198:199], v[144:145], v[76:77], v[202:203]
    v_pk_fma_f32 v[198:199], v[146:147], v[78:79], v[198:199]
L_h11:
    s_cbranch_execz L_h12
    s_add_u32 s71, s71, 3072
    s_cbranch_vccnz L_th42_1
L_tb42_1:
    buffer_load_dwordx4 v[76:79], v1, s[24:27], s71 offen offset:0 nt
    v_add_f32_dpp v229, v228, v228 row_ror:8 row_mask:0xf bank_mask:0xc
    v_and_b32 v235, 0xffff0000, v175
    v_pk_fma_f32 v[200:201], v[122:123], v[234:235], v[200:201]
    v_lshlrev_b32 v234, 16, v170
    v_and_b32 v235, 0xffff0000, v170
    v_pk_mul_f32 v[124:125], v[234:235], v[112:113]
    s_waitcnt vmcnt(31)
    v_pk_fma_f32 v[198:199], v[148:149], v[80:81], v[198:199]
    v_pk_fma_f32 v[198:199], v[150:151], v[82:83], v[198:199]
    buffer_load_dwordx4 v[80:83], v1, s[24:27], s71 offen offset:256 nt
    v_add_f32_dpp v230, v229, v229 row_shl:4 row_mask:0xf bank_mask:0x5
    v_lshlrev_b32 v234, 16, v176
    v_and_b32 v235, 0xffff0000, v176
    v_pk_fma_f32 v[200:201], v[124:125], v[234:235], v[200:201]
L_h12:
    s_cbranch_execz L_h13
    v_lshlrev_b32 v234, 16, v171
    v_and_b32 v235, 0xffff0000, v171
    s_waitcnt vmcnt(31)
    v_pk_fma_f32 v[198:199], v[152:153], v[84:85], v[198:199]
    v_pk_fma_f32 v[198:199], v[154:155], v[86:87], v[198:199]
    ds_add_u32 v224, v243 offset:3328
    buffer_load_dwordx4 v[84:87], v1, s[24:27], s71 offen offset:512 nt
    v_add_f32 v228, v198, v199
    v_pk_mul_f32 v[126:127], v[234:235], v[114:115]
    v_lshlrev_b32 v234, 16, v177
    v_and_b32 v235, 0xffff0000, v177
    v_pk_fma_f32 v[200:201], v[126:127], v[234:235], v[200:201]
    v_lshlrev_b32 v234, 16, v172
    s_waitcnt vmcnt(31)
    v_pk_fma_f32 v[198:199], v[144:145], v[88:89], v[202:203]
    v_pk_fma_f32 v[198:199], v[146:147], v[90:91], v[198:199]
    s_add_u32 s71, s71, 3072
    s_cbranch_vccnz L_th45_1
L_tb45_1:
    buffer_load_dwordx4 v[88:91], v1, s[24:27], s71 offen offset:0 nt
L_h13:
    s_cbranch_execz L_h14
    v_add_f32_dpp v229, v228, v228 row_ror:8 row_mask:0xf bank_mask:0x3
    v_and_b32 v235, 0xffff0000, v172
    v_pk_mul_f32 v[128:129], v[234:235], v[116:117]
    v_lshlrev_b32 v234, 16, v178
    v_and_b32 v235, 0xffff0000, v178
    v_pk_fma_f32 v[200:201], v[128:129], v[234:235], v[200:201]
    s_waitcnt vmcnt(31)
    v_pk_fma_f32 v[198:199], v[148:149], v[92:93], v[198:199]
    v_pk_fma_f32 v[198:199], v[150:151], v[94:95], v[198:199]
    buffer_load_dwordx4 v[92:95], v1, s[24:27], s71 offen offset:256 nt
    v_lshlrev_b32 v234, 16, v173
    v_and_b32 v235, 0xffff0000, v173
    v_pk_mul_f32 v[130:131], v[234:235], v[118:119]
    v_lshlrev_b32 v234, 16, v179
    v_and_b32 v235, 0xffff0000, v179
    s_waitcnt vmcnt(31)
    v_pk_fma_f32 v[198:199], v[152:153], v[96:97], v[198:199]
    v_pk_fma_f32 v[198:199], v[154:155], v[98:99], v[198:199]
L_h14:
    s_cbranch_execz L_h15
    ds_add_u32 v224, v243 offset:3328
    buffer_load_dwordx4 v[96:99], v1, s[24:27], s71 offen offset:512 nt
    v_add_f32 v228, v198, v199
    v_pk_fma_f32 v[200:201], v[130:131], v[234:235], v[200:201]
    v_pk_mul_f32 v[200:201], v[200:201], s[62:63]
    s_waitcnt vmcnt(31)
    v_pk_fma_f32 v[198:199], v[120:121], v[4:5], v[200:201]
    v_pk_fma_f32 v[198:199], v[122:123], v[6:7], v[198:199]
    ds_read_b32 v244, v243 offset:147
    s_mul_i32 s71, s70, 49152
    s_and_b32 s80, s70, 31
    s_mul_i32 s80, s80, 36864
    s_sub_u32 s71, s71, s80
    s_cbranch_vccnz L_th0_1
L_tb0_1:
    buffer_load_dwordx4 v[4:7], v1, s[28:31], s71 offen offset:0 nt
    v_add_f32_dpp v229, v228, v228 row_ror:8 row_mask:0xf bank_mask:0xc
    s_waitcnt vmcnt(31)
    v_pk_fma_f32 v[198:199], v[124:125], v[8:9], v[198:199]
    v_pk_fma_f32 v[198:199], v[126:127], v[10:11], v[198:199]
L_h15:
    s_cbranch_execz L_h16
    buffer_load_dwordx4 v[8:11], v1, s[28:31], s71 offen offset:256 nt
    v_add_f32_dpp v230, v229, v229 row_shr:4 row_mask:0xf bank_mask:0xa
    s_waitcnt vmcnt(31)
    v_pk_fma_f32 v[198:199], v[128:129], v[12:13], v[198:199]
    v_pk_fma_f32 v[198:199], v[130:131], v[14:15], v[198:199]
    s_waitcnt lgkmcnt(0)
    v_cmp_lt_u32 vcc, v0, v244
    ds_add_u32 v224, v243 offset:3328
    buffer_load_dwordx4 v[12:15], v1, s[28:31], s71 offen offset:512 nt
    v_add_f32_dpp v232, v230, v230 quad_perm:[2,3,0,1] row_mask:0xf bank_mask:0xf
    v_add_f32 v228, v198, v199
    s_waitcnt vmcnt(31)
    v_pk_fma_f32 v[198:199], v[120:121], v[16:17], v[200:201]
    v_pk_fma_f32 v[198:199], v[122:123], v[18:19], v[198:199]
    s_add_u32 s71, s71, 3072
    s_cbranch_vccnz L_th3_1
L_tb3_1:
    buffer_load_dwordx4 v[16:19], v1, s[28:31], s71 offen offset:0 nt
    v_cndmask_b32 v232, v231, v232, s[64:65]
L_h16:
    s_cbranch_execz L_h17
    v_add_f32_dpp v229, v228, v228 row_ror:8 row_mask:0xf bank_mask:0x3
    s_waitcnt vmcnt(25)
    v_pk_fma_f32 v[198:199], v[124:125], v[20:21], v[198:199]
    v_pk_fma_f32 v[198:199], v[126:127], v[22:23], v[198:199]
    buffer_load_dwordx4 v[20:23], v1, s[28:31], s71 offen offset:256 nt
    v_add_f32_dpp v233, v232, v232 quad_perm:[1,0,3,2] row_mask:0xf bank_mask:0xf
    v_lshlrev_b32 v234, 16, v180
    v_and_b32 v235, 0xffff0000, v180
    v_pk_mul_f32 v[144:145], v[234:235], v[108:109]
    v_lshlrev_b32 v234, 16, v186
    v_and_b32 v235, 0xffff0000, v186
    s_waitcnt vmcnt(25)
    v_pk_fma_f32 v[198:199], v[128:129], v[24:25], v[198:199]
    v_pk_fma_f32 v[198:199], v[130:131], v[26:27], v[198:199]
    ds_add_u32 v224, v243 offset:3328
    buffer_load_dwordx4 v[24:27], v1, s[28:31], s71 offen offset:512 nt
    v_add_f32 v228, v198, v199
    v_pk_mul_f32 v[202:203], v[144:145], v[234:235]
L_h17:
    s_cbranch_execz L_h18
    v_lshlrev_b32 v234, 16, v181
    v_and_b32 v235, 0xffff0000, v181
    v_pk_mul_f32 v[146:147], v[234:235], v[110:111]
    v_lshlrev_b32 v234, 16, v187
    s_waitcnt vmcnt(25)
    v_pk_fma_f32 v[198:199], v[120:121], v[28:29], v[200:201]
    v_pk_fma_f32 v[198:199], v[122:123], v[30:31], v[198:199]
    s_add_u32 s71, s71, 3072
    s_cbranch_vccnz L_th6_1
L_tb6_1:
    buffer_load_dwordx4 v[28:31], v1, s[28:31], s71 offen offset:0 nt
    v_add_f32_dpp v229, v228, v228 row_ror:8 row_mask:0xf bank_mask:0xc
    v_and_b32 v235, 0xffff0000, v187
    v_pk_fma_f32 v[202:203], v[146:147], v[234:235], v[202:203]
    v_lshlrev_b32 v234, 16, v182
    v_and_b32 v235, 0xffff0000, v182
    v_pk_mul_f32 v[148:149], v[234:235], v[112:113]
    s_waitcnt vmcnt(25)
    v_pk_fma_f32 v[198:199], v[124:125], v[32:33], v[198:199]
    v_pk_fma_f32 v[198:199], v[126:127], v[34:35], v[198:199]
L_h18:
    s_cbranch_execz L_h19
    buffer_load_dwordx4 v[32:35], v1, s[28:31], s71 offen offset:256 nt
    v_add_f32_dpp v230, v229, v229 row_shl:4 row_mask:0xf bank_mask:0x5
    v_lshlrev_b32 v234, 16, v188
    v_and_b32 v235, 0xffff0000, v188
    v_pk_fma_f32 v[202:203], v[148:149], v[234:235], v[202:203]
    v_lshlrev_b32 v234, 16, v183
    v_and_b32 v235, 0xffff0000, v183
    s_waitcnt vmcnt(25)
    v_pk_fma_f32 v[198:199], v[128:129], v[36:37], v[198:199]
    v_pk_fma_f32 v[198:199], v[130:131], v[38:39], v[198:199]
    ds_add_u32 v224, v243 offset:3328
    buffer_load_dwordx4 v[36:39], v1, s[28:31], s71 offen offset:512 nt
    v_add_f32 v228, v198, v199
    v_pk_mul_f32 v[150:151], v[234:235], v[114:115]
    v_lshlrev_b32 v234, 16, v189
    v_and_b32 v235, 0xffff0000, v189
    v_pk_fma_f32 v[202:203], v[150:151], v[234:235], v[202:203]
    v_lshlrev_b32 v234, 16, v184
L_h19:
    s_cbranch_execz L_h20
    s_waitcnt vmcnt(25)
    v_pk_fma_f32 v[198:199], v[120:121], v[40:41], v[200:201]
    v_pk_fma_f32 v[198:199], v[122:123], v[42:43], v[198:199]
    s_add_u32 s71, s71, 3072
    s_cbranch_vccnz L_th9_1
L_tb9_1:
    buffer_load_dwordx4 v[40:43], v1, s[28:31], s71 offen offset:0 nt
    v_add_f32_dpp v229, v228, v228 row_ror:8 row_mask:0xf bank_mask:0x3
    v_and_b32 v235, 0xffff0000, v184
    v_pk_mul_f32 v[152:153], v[234:235], v[116:117]
    v_lshlrev_b32 v234, 16, v190
    v_and_b32 v235, 0xffff0000, v190
    v_pk_fma_f32 v[202:203], v[152:153], v[234:235], v[202:203]
    s_waitcnt vmcnt(25)
    v_pk_fma_f32 v[198:199], v[124:125], v[44:45], v[198:199]
    v_pk_fma_f32 v[198:199], v[126:127], v[46:47], v[198:199]
    buffer_load_dwordx4 v[44:47], v1, s[28:31], s71 offen offset:256 nt
    v_lshlrev_b32 v234, 16, v185
    v_and_b32 v235, 0xffff0000, v185
L_h20:
    s_cbranch_execz L_h21
    v_pk_mul_f32 v[154:155], v[234:235], v[118:119]
    v_lshlrev_b32 v234, 16, v191
    v_and_b32 v235, 0xffff0000, v191
    s_waitcnt vmcnt(25)
    v_pk_fma_f32 v[198:199], v[128:129], v[48:49], v[198:199]
    v_pk_fma_f32 v[198:199], v[130:131], v[50:51], v[198:199]
    ds_add_u32 v224, v243 offset:3328
    buffer_load_dwordx4 v[48:51], v1, s[28:31], s71 offen offset:512 nt
    v_add_f32 v228, v198, v199
    v_pk_fma_f32 v[202:203], v[154:155], v[234:235], v[202:203]
    v_pk_mul_f32 v[202:203], v[202:203], s[62:63]
    s_waitcnt vmcnt(23)
    v_pk_fma_f32 v[198:199], v[144:145], v[52:53], v[202:203]
    v_pk_fma_f32 v[198:199], v[146:147], v[54:55], v[198:199]
    ds_read_b32 v244, v243 offset:147
    s_add_u32 s71, s71, 384000
    s_cbranch_vccnz L_th12_1
L_tb12_1:
    buffer_load_dwordx4 v[52:55], v1, s[28:31], s71 offen offset:0 nt
L_h21:
    s_cbranch_execz L_h22
    v_add_f32_dpp v229, v228, v228 row_ror:8 row_mask:0xf bank_mask:0xc
    s_waitcnt vmcnt(23)
    v_pk_fma_f32 v[198:199], v[148:149], v[56:57], v[198:199]
    v_pk_fma_f32 v[198:199], v[150:151], v[58:59], v[198:199]
    buffer_load_dwordx4 v[56:59], v1, s[28:31], s71 offen offset:256 nt
    v_add_f32_dpp v230, v229, v229 row_shr:4 row_mask:0xf bank_mask:0xa
    s_waitcnt vmcnt(23)
    v_pk_fma_f32 v[198:199], v[152:153], v[60:61], v[198:199]
    v_pk_fma_f32 v[198:199], v[154:155], v[62:63], v[198:199]
    s_waitcnt lgkmcnt(0)
    v_cmp_lt_u32 vcc, v0, v244
    ds_add_u32 v224, v243 offset:3328
    buffer_load_dwordx4 v[60:63], v1, s[28:31], s71 offen offset:512 nt
    v_add_f32_dpp v231, v230, v230 quad_perm:[2,3,0,1] row_mask:0xf bank_mask:0xf
    v_add_f32 v228, v198, v199
    s_waitcnt vmcnt(23)
    v_pk_fma_f32 v[198:199], v[144:145], v[64:65], v[202:203]
    v_pk_fma_f32 v[198:199], v[146:147], v[66:67], v[198:199]
    s_add_u32 s71, s71, 3072
L_h22:
    s_cbranch_execz L_h23
    s_cbranch_vccnz L_th15_1
L_tb15_1:
    buffer_load_dwordx4 v[64:67], v1, s[28:31], s71 offen offset:0 nt
    v_add_f32_dpp v229, v228, v228 row_ror:8 row_mask:0xf bank_mask:0x3
    s_waitcnt vmcnt(23)
    v_pk_fma_f32 v[198:199], v[148:149], v[68:69], v[198:199]
    v_pk_fma_f32 v[198:199], v[150:151], v[70:71], v[198:199]
    buffer_load_dwordx4 v[68:71], v1, s[28:31], s71 offen offset:256 nt
    s_waitcnt vmcnt(23)
    v_pk_fma_f32 v[198:199], v[152:153], v[72:73], v[198:199]
    v_pk_fma_f32 v[198:199], v[154:155], v[74:75], v[198:199]
    ds_add_u32 v224, v243 offset:3328
    buffer_load_dwordx4 v[72:75], v1, s[28:31], s71 offen offset:512 nt
    v_add_f32 v228, v198, v199
    s_waitcnt vmcnt(23)
    v_pk_fma_f32 v[198:199], v[144:145], v[76:77], v[202:203]
    v_pk_fma_f32 v[198:199], v[146:147], v[78:79], v[198:199]
    s_add_u32 s71, s71, 3072
    s_cbranch_vccnz L_th18_1
L_tb18_1:
L_h23:
    s_cbranch_execz L_h24
    buffer_load_dwordx4 v[76:79], v1, s[28:31], s71 offen offset:0 nt
    v_add_f32_dpp v229, v228, v228 row_ror:8 row_mask:0xf bank_mask:0xc
    s_waitcnt vmcnt(23)
    v_pk_fma_f32 v[198:199], v[148:149], v[80:81], v[198:199]
    v_pk_fma_f32 v[198:199], v[150:151], v[82:83], v[198:199]
    buffer_load_dwordx4 v[80:83], v1, s[28:31], s71 offen offset:256 nt
    v_add_f32_dpp v230, v229, v229 row_shl:4 row_mask:0xf bank_mask:0x5
    s_waitcnt vmcnt(23)
    v_pk_fma_f32 v[198:199], v[152:153], v[84:85], v[198:199]
    v_pk_fma_f32 v[198:199], v[154:155], v[86:87], v[198:199]
    ds_add_u32 v224, v243 offset:3328
    buffer_load_dwordx4 v[84:87], v1, s[28:31], s71 offen offset:512 nt
    v_add_f32 v228, v198, v199
    s_waitcnt vmcnt(23)
    v_pk_fma_f32 v[198:199], v[144:145], v[88:89], v[202:203]
    v_pk_fma_f32 v[198:199], v[146:147], v[90:91], v[198:199]
    s_add_u32 s71, s71, 3072
    s_cbranch_vccnz L_th21_1
L_tb21_1:
L_h24:
    s_cbranch_execz L_h25
    buffer_load_dwordx4 v[88:91], v1, s[28:31], s71 offen offset:0 nt
    v_add_f32_dpp v229, v228, v228 row_ror:8 row_mask:0xf bank_mask:0x3
    s_waitcnt vmcnt(23)
    v_pk_fma_f32 v[198:199], v[148:149], v[92:93], v[198:199]
    v_pk_fma_f32 v[198:199], v[150:151], v[94:95], v[198:199]
    buffer_load_dwordx4 v[92:95], v1, s[28:31], s71 offen offset:256 nt
    s_waitcnt vmcnt(23)
    v_pk_fma_f32 v[198:199], v[152:153], v[96:97], v[198:199]
    v_pk_fma_f32 v[198:199], v[154:155], v[98:99], v[198:199]
    ds_add_u32 v224, v243 offset:3328
    buffer_load_dwordx4 v[96:99], v1, s[28:31], s71 offen offset:512 nt
    v_add_f32 v228, v198, v199
    s_nop 1
    v_add_f32_dpp v229, v228, v228 row_ror:8 row_mask:0xf bank_mask:0xc
    s_nop 1
    v_add_f32_dpp v230, v229, v229 row_shr:4 row_mask:0xf bank_mask:0xa
    s_nop 1
    v_add_f32_dpp v232, v230, v230 quad_perm:[2,3,0,1] row_mask:0xf bank_mask:0xf
    s_nop 1
L_h25:
    s_cbranch_execz L_h26
    v_cndmask_b32 v232, v231, v232, s[64:65]
    s_nop 1
    v_add_f32_dpp v231, v232, v232 quad_perm:[1,0,3,2] row_mask:0xf bank_mask:0xf
    s_nop 1
    v_cndmask_b32 v233, v233, v231, s[66:67]
    v_mul_f32 v233, 0x58000000, v233
    ds_write_b32 v239, v233
    v_add_u32 v239, 256, v239
    s_mov_b64 exec, 1
    ds_add_u32 v243, v243 offset:127
    s_mov_b64 exec, -1
    ds_read_b32 v223, v240
    v_add_u32 v240, 256, v240
    v_lshlrev_b32 v220, 16, v220
    v_lshlrev_b32 v221, 16, v221
    s_waitcnt lgkmcnt(0)
    v_max_f32_dpp v234, v223, v223 row_ror:8 row_mask:0xf bank_mask:0xf
    s_nop 1
    v_max_f32_dpp v234, v234, v234 row_ror:4 row_mask:0xf bank_mask:0xf
    s_nop 1
L_h26:
    s_cbranch_execz L_h27
    v_max_f32_dpp v234, v234, v234 row_ror:2 row_mask:0xf bank_mask:0xf
    s_nop 1
    v_max_f32_dpp v234, v234, v234 row_ror:1 row_mask:0xf bank_mask:0xf
    v_mov_b32 v228, v216
    v_max3_f32 v234, v234, v228, s77
    v_sub_f32 v235, v228, v234
    v_sub_f32 v229, v223, v234
    v_exp_f32 v235, v235
    v_exp_f32 v229, v229
    s_nop 0
    v_mul_f32 v222, v229, v220
    v_mul_f32 v230, v222, v221
    v_mul_f32 v238, 0x71800000, v222
    s_nop 0
    s_mov_b32 s76, 63
L_loop1:
    v_mov_b32_dpp v236, v238 row_newbcast:0 row_mask:0xf bank_mask:0xf
    s_waitcnt vmcnt(23)
    v_pk_fma_f32 v[204:205], v[236:237], v[4:5], v[204:205] op_sel_hi:[0,1,1]
    v_pk_fma_f32 v[206:207], v[236:237], v[6:7], v[206:207] op_sel_hi:[0,1,1]
    ds_read_b32 v244, v243 offset:147
    s_add_u32 s71, s71, 384000
    s_cbranch_vccnz L_th24_2
L_tb24_2:
L_h27:
    s_cbranch_execz L_h28
    buffer_load_dwordx4 v[4:7], v1, s[28:31], s71 offen offset:0 nt
    s_bitcmp0_b32 s4, 0
    s_cbranch_scc1 L_nofl2
    s_mov_b64 exec, 1
    ds_add_u32 v242, v243
    s_mov_b64 exec, -1
    v_add_u32 v241, 4096, v241
    v_add_u32 v242, 4, v242
L_nofl2:
    s_waitcnt vmcnt(23)
    v_pk_fma_f32 v[208:209], v[236:237], v[8:9], v[208:209] op_sel_hi:[0,1,1]
    v_pk_fma_f32 v[210:211], v[236:237], v[10:11], v[210:211] op_sel_hi:[0,1,1]
    buffer_load_dwordx4 v[8:11], v1, s[28:31], s71 offen offset:256 nt
    v_pk_mul_f32 v[212:213], v[212:213], v[234:235] op_sel:[0,1] op_sel_hi:[1,1]
    v_pk_mul_f32 v[214:215], v[214:215], v[234:235] op_sel:[0,1] op_sel_hi:[1,1]
    v_mov_b32 v216, v234
    s_waitcnt vmcnt(23)
    v_pk_fma_f32 v[212:213], v[236:237], v[12:13], v[212:213] op_sel_hi:[0,1,1]
    v_pk_fma_f32 v[214:215], v[236:237], v[14:15], v[214:215] op_sel_hi:[0,1,1]
    s_waitcnt lgkmcnt(0)
    v_cmp_lt_u32 vcc, v0, v244
    ds_add_u32 v224, v243 offset:3328
L_h28:
    s_cbranch_execz L_h29
    buffer_load_dwordx4 v[12:15], v1, s[28:31], s71 offen offset:512 nt
    v_fma_f32 v217, v217, v235, v229
    v_mov_b32_dpp v236, v238 row_newbcast:8 row_mask:0xf bank_mask:0xf
    s_waitcnt vmcnt(23)
    v_pk_fma_f32 v[204:205], v[236:237], v[16:17], v[204:205] op_sel_hi:[0,1,1]
    v_pk_fma_f32 v[206:207], v[236:237], v[18:19], v[206:207] op_sel_hi:[0,1,1]
    s_add_u32 s71, s71, 3072
    s_cbranch_vccnz L_th27_2
L_tb27_2:
    buffer_load_dwordx4 v[16:19], v1, s[28:31], s71 offen offset:0 nt
    v_fma_f32 v218, v218, v235, v230
    s_waitcnt vmcnt(23)
    v_pk_fma_f32 v[208:209], v[236:237], v[20:21], v[208:209] op_sel_hi:[0,1,1]
    v_pk_fma_f32 v[210:211], v[236:237], v[22:23], v[210:211] op_sel_hi:[0,1,1]
    buffer_load_dwordx4 v[20:23], v1, s[28:31], s71 offen offset:256 nt
    ds_read_b32 v223, v240
    v_add_u32 v240, 256, v240
    s_waitcnt vmcnt(23)
L_h29:
    s_cbranch_execz L_h30
    v_pk_fma_f32 v[212:213], v[236:237], v[24:25], v[212:213] op_sel_hi:[0,1,1]
    v_pk_fma_f32 v[214:215], v[236:237], v[26:27], v[214:215] op_sel_hi:[0,1,1]
    ds_add_u32 v224, v243 offset:3328
    buffer_load_dwordx4 v[24:27], v1, s[28:31], s71 offen offset:512 nt
    v_mov_b32_dpp v236, v238 row_newbcast:4 row_mask:0xf bank_mask:0xf
    s_waitcnt vmcnt(23)
    v_pk_fma_f32 v[204:205], v[236:237], v[28:29], v[204:205] op_sel_hi:[0,1,1]
    v_pk_fma_f32 v[206:207], v[236:237], v[30:31], v[206:207] op_sel_hi:[0,1,1]
    s_add_u32 s71, s71, 3072
    s_cbranch_vccnz L_th30_2
L_tb30_2:
    buffer_load_dwordx4 v[28:31], v1, s[28:31], s71 offen offset:0 nt
    ds_write_b128 v241, v[216:219] offset:23552
    s_waitcnt vmcnt(23)
    v_pk_fma_f32 v[208:209], v[236:237], v[32:33], v[208:209] op_sel_hi:[0,1,1]
    v_pk_fma_f32 v[210:211], v[236:237], v[34:35], v[210:211] op_sel_hi:[0,1,1]
    buffer_load_dwordx4 v[32:35], v1, s[28:31], s71 offen offset:256 nt
    s_waitcnt vmcnt(23)
    v_pk_fma_f32 v[212:213], v[236:237], v[36:37], v[212:213] op_sel_hi:[0,1,1]
L_h30:
    s_cbranch_execz L_h31
    v_pk_fma_f32 v[214:215], v[236:237], v[38:39], v[214:215] op_sel_hi:[0,1,1]
    ds_add_u32 v224, v243 offset:3328
    buffer_load_dwordx4 v[36:39], v1, s[28:31], s71 offen offset:512 nt
    v_mov_b32_dpp v236, v238 row_newbcast:12 row_mask:0xf bank_mask:0xf
    s_waitcnt vmcnt(23)
    v_pk_fma_f32 v[204:205], v[236:237], v[40:41], v[204:205] op_sel_hi:[0,1,1]
    v_pk_fma_f32 v[206:207], v[236:237], v[42:43], v[206:207] op_sel_hi:[0,1,1]
    s_add_u32 s71, s71, 3072
    s_cbranch_vccnz L_th33_2
L_tb33_2:
    buffer_load_dwordx4 v[40:43], v1, s[28:31], s71 offen offset:0 nt
    s_waitcnt vmcnt(23)
    v_pk_fma_f32 v[208:209], v[236:237], v[44:45], v[208:209] op_sel_hi:[0,1,1]
    v_pk_fma_f32 v[210:211], v[236:237], v[46:47], v[210:211] op_sel_hi:[0,1,1]
    buffer_load_dwordx4 v[44:47], v1, s[28:31], s71 offen offset:256 nt
    s_waitcnt vmcnt(23)
    v_pk_fma_f32 v[212:213], v[236:237], v[48:49], v[212:213] op_sel_hi:[0,1,1]
    v_pk_fma_f32 v[214:215], v[236:237], v[50:51], v[214:215] op_sel_hi:[0,1,1]
L_h31:
    s_cbranch_execz L_h32
    ds_add_u32 v224, v243 offset:3328
    buffer_load_dwordx4 v[48:51], v1, s[28:31], s71 offen offset:512 nt
    v_mov_b32_dpp v236, v238 row_newbcast:2 row_mask:0xf bank_mask:0xf
    s_waitcnt vmcnt(23)
    v_pk_fma_f32 v[204:205], v[236:237], v[52:53], v[204:205] op_sel_hi:[0,1,1]
    v_pk_fma_f32 v[206:207], v[236:237], v[54:55], v[206:207] op_sel_hi:[0,1,1]
    ds_read_b32 v244, v243 offset:147
    v_readlane_b32 s70, v245, s91
    s_add_u32 s91, s91, 1
    s_and_b32 s80, s70, 31
    s_mul_i32 s80, s80, 96
    s_lshl_b32 s73, s70, 7
    s_sub_u32 s73, s73, s80
    buffer_load_ushort v220, v3, s[40:43], s73 offen
    buffer_load_ushort v221, v3, s[44:47], s73 offen
    s_add_u32 s71, s71, 384000
    s_cbranch_vccnz L_th36_2
L_tb36_2:
    buffer_load_dwordx4 v[52:55], v1, s[28:31], s71 offen offset:0 nt
    s_waitcnt vmcnt(25)
L_h32:
    s_cbranch_execz L_h33
    v_pk_fma_f32 v[208:209], v[236:237], v[56:57], v[208:209] op_sel_hi:[0,1,1]
    v_pk_fma_f32 v[210:211], v[236:237], v[58:59], v[210:211] op_sel_hi:[0,1,1]
    buffer_load_dwordx4 v[56:59], v1, s[28:31], s71 offen offset:256 nt
    s_waitcnt vmcnt(25)
    v_pk_fma_f32 v[212:213], v[236:237], v[60:61], v[212:213] op_sel_hi:[0,1,1]
    v_pk_fma_f32 v[214:215], v[236:237], v[62:63], v[214:215] op_sel_hi:[0,1,1]
    s_waitcnt lgkmcnt(0)
    v_cmp_lt_u32 vcc, v0, v244
    ds_add_u32 v224, v243 offset:3328
    buffer_load_dwordx4 v[60:63], v1, s[28:31], s71 offen offset:512 nt
    v_mov_b32_dpp v236, v238 row_newbcast:10 row_mask:0xf bank_mask:0xf
    s_waitcnt vmcnt(25)
    v_pk_fma_f32 v[204:205], v[236:237], v[64:65], v[204:205] op_sel_hi:[0,1,1]
    v_pk_fma_f32 v[206:207], v[236:237], v[66:67], v[206:207] op_sel_hi:[0,1,1]
    s_add_u32 s71, s71, 3072
    s_cbranch_vccnz L_th39_2
L_tb39_2:
    buffer_load_dwordx4 v[64:67], v1, s[28:31], s71 offen offset:0 nt
    s_waitcnt vmcnt(25)
    v_pk_fma_f32 v[208:209], v[236:237], v[68:69], v[208:209] op_sel_hi:[0,1,1]
L_h33:
    s_cbranch_execz L_h34
    v_pk_fma_f32 v[210:211], v[236:237], v[70:71], v[210:211] op_sel_hi:[0,1,1]
    buffer_load_dwordx4 v[68:71], v1, s[28:31], s71 offen offset:256 nt
    s_waitcnt vmcnt(25)
    v_pk_fma_f32 v[212:213], v[236:237], v[72:73], v[212:213] op_sel_hi:[0,1,1]
    v_pk_fma_f32 v[214:215], v[236:237], v[74:75], v[214:215] op_sel_hi:[0,1,1]
    ds_add_u32 v224, v243 offset:3328
    buffer_load_dwordx4 v[72:75], v1, s[28:31], s71 offen offset:512 nt
    v_mov_b32_dpp v236, v238 row_newbcast:6 row_mask:0xf bank_mask:0xf
    s_waitcnt vmcnt(25)
    v_pk_fma_f32 v[204:205], v[236:237], v[76:77], v[204:205] op_sel_hi:[0,1,1]
    v_pk_fma_f32 v[206:207], v[236:237], v[78:79], v[206:207] op_sel_hi:[0,1,1]
    s_add_u32 s71, s71, 3072
    s_cbranch_vccnz L_th42_2
L_tb42_2:
    buffer_load_dwordx4 v[76:79], v1, s[28:31], s71 offen offset:0 nt
    s_waitcnt vmcnt(25)
    v_pk_fma_f32 v[208:209], v[236:237], v[80:81], v[208:209] op_sel_hi:[0,1,1]
    v_pk_fma_f32 v[210:211], v[236:237], v[82:83], v[210:211] op_sel_hi:[0,1,1]
L_h34:
    s_cbranch_execz L_h35
    buffer_load_dwordx4 v[80:83], v1, s[28:31], s71 offen offset:256 nt
    s_waitcnt vmcnt(25)
    v_pk_fma_f32 v[212:213], v[236:237], v[84:85], v[212:213] op_sel_hi:[0,1,1]
    v_pk_fma_f32 v[214:215], v[236:237], v[86:87], v[214:215] op_sel_hi:[0,1,1]
    ds_add_u32 v224, v243 offset:3328
    buffer_load_dwordx4 v[84:87], v1, s[28:31], s71 offen offset:512 nt
    v_mov_b32_dpp v236, v238 row_newbcast:14 row_mask:0xf bank_mask:0xf
    s_waitcnt vmcnt(25)
    v_pk_fma_f32 v[204:205], v[236:237], v[88:89], v[204:205] op_sel_hi:[0,1,1]
    v_pk_fma_f32 v[206:207], v[236:237], v[90:91], v[206:207] op_sel_hi:[0,1,1]
    s_add_u32 s71, s71, 3072
    s_cbranch_vccnz L_th45_2
L_tb45_2:
    buffer_load_dwordx4 v[88:91], v1, s[28:31], s71 offen offset:0 nt
    s_waitcnt vmcnt(25)
    v_pk_fma_f32 v[208:209], v[236:237], v[92:93], v[208:209] op_sel_hi:[0,1,1]
    v_pk_fma_f32 v[210:211], v[236:237], v[94:95], v[210:211] op_sel_hi:[0,1,1]
    buffer_load_dwordx4 v[92:95], v1, s[28:31], s71 offen offset:256 nt
    s_cmp_eq_u32 s76, 16
L_h35:
    s_cbranch_execz L_h36
    s_cbranch_scc1 L_getm2
L_gotm2:
    s_waitcnt vmcnt(25)
    v_pk_fma_f32 v[212:213], v[236:237], v[96:97], v[212:213] op_sel_hi:[0,1,1]
    v_pk_fma_f32 v[214:215], v[236:237], v[98:99], v[214:215] op_sel_hi:[0,1,1]
    ds_add_u32 v224, v243 offset:3328
    buffer_load_dwordx4 v[96:99], v1, s[28:31], s71 offen offset:512 nt
    v_mov_b32_dpp v236, v238 row_newbcast:1 row_mask:0xf bank_mask:0xf
    s_waitcnt vmcnt(25)
    v_pk_fma_f32 v[204:205], v[236:237], v[4:5], v[204:205] op_sel_hi:[0,1,1]
    v_pk_fma_f32 v[206:207], v[236:237], v[6:7], v[206:207] op_sel_hi:[0,1,1]
    ds_read_b32 v244, v243 offset:147
    s_mul_i32 s71, s70, 49152
    s_and_b32 s80, s70, 31
    s_mul_i32 s80, s80, 36864
    s_sub_u32 s71, s71, s80
    s_cbranch_vccnz L_th0_2
L_tb0_2:
    buffer_load_dwordx4 v[4:7], v1, s[28:31], s71 offen offset:0 nt
    s_waitcnt vmcnt(25)
    v_pk_fma_f32 v[208:209], v[236:237], v[8:9], v[208:209] op_sel_hi:[0,1,1]
L_h36:
    s_cbranch_execz L_h37
    v_pk_fma_f32 v[210:211], v[236:237], v[10:11], v[210:211] op_sel_hi:[0,1,1]
    buffer_load_dwordx4 v[8:11], v1, s[28:31], s71 offen offset:256 nt
    s_waitcnt vmcnt(25)
    v_pk_fma_f32 v[212:213], v[236:237], v[12:13], v[212:213] op_sel_hi:[0,1,1]
    v_pk_fma_f32 v[214:215], v[236:237], v[14:15], v[214:215] op_sel_hi:[0,1,1]
    s_waitcnt lgkmcnt(0)
    v_cmp_lt_u32 vcc, v0, v244
    ds_add_u32 v224, v243 offset:3328
    buffer_load_dwordx4 v[12:15], v1, s[28:31], s71 offen offset:512 nt
    v_max_f32_dpp v234, v223, v223 row_ror:8 row_mask:0xf bank_mask:0xf
    v_mov_b32_dpp v236, v238 row_newbcast:9 row_mask:0xf bank_mask:0xf
    s_waitcnt vmcnt(25)
    v_pk_fma_f32 v[204:205], v[236:237], v[16:17], v[204:205] op_sel_hi:[0,1,1]
    v_pk_fma_f32 v[206:207], v[236:237], v[18:19], v[206:207] op_sel_hi:[0,1,1]
    s_add_u32 s71, s71, 3072
    s_cbranch_vccnz L_th3_2
L_tb3_2:
    buffer_load_dwordx4 v[16:19], v1, s[28:31], s71 offen offset:0 nt
    v_max_f32_dpp v234, v234, v234 row_ror:4 row_mask:0xf bank_mask:0xf
L_h37:
    s_cbranch_execz L_h38
    s_waitcnt vmcnt(25)
    v_pk_fma_f32 v[208:209], v[236:237], v[20:21], v[208:209] op_sel_hi:[0,1,1]
    v_pk_fma_f32 v[210:211], v[236:237], v[22:23], v[210:211] op_sel_hi:[0,1,1]
    buffer_load_dwordx4 v[20:23], v1, s[28:31], s71 offen offset:256 nt
    v_max_f32_dpp v234, v234, v234 row_ror:2 row_mask:0xf bank_mask:0xf
    s_waitcnt vmcnt(25)
    v_pk_fma_f32 v[212:213], v[236:237], v[24:25], v[212:213] op_sel_hi:[0,1,1]
    v_pk_fma_f32 v[214:215], v[236:237], v[26:27], v[214:215] op_sel_hi:[0,1,1]
    ds_add_u32 v224, v243 offset:3328
    buffer_load_dwordx4 v[24:27], v1, s[28:31], s71 offen offset:512 nt
    v_max_f32_dpp v234, v234, v234 row_ror:1 row_mask:0xf bank_mask:0xf
    v_mov_b32_dpp v236, v238 row_newbcast:5 row_mask:0xf bank_mask:0xf
    s_waitcnt vmcnt(25)
    v_pk_fma_f32 v[204:205], v[236:237], v[28:29], v[204:205] op_sel_hi:[0,1,1]
    v_pk_fma_f32 v[206:207], v[236:237], v[30:31], v[206:207] op_sel_hi:[0,1,1]
    s_add_u32 s71, s71, 3072
    s_cbranch_vccnz L_th6_2
L_tb6_2:
    buffer_load_dwordx4 v[28:31], v1, s[28:31], s71 offen offset:0 nt
L_h38:
    s_cbranch_execz L_h39
    s_lshr_b64 s[4:5], s[4:5], 1
    s_bitcmp1_b32 s4, 0
    s_cselect_b32 s6, s7, 0x7f7fffff
    v_min_f32 v228, s6, v216
    s_waitcnt vmcnt(25)
    v_pk_fma_f32 v[208:209], v[236:237], v[32:33], v[208:209] op_sel_hi:[0,1,1]
    v_pk_fma_f32 v[210:211], v[236:237], v[34:35], v[210:211] op_sel_hi:[0,1,1]
    buffer_load_dwordx4 v[32:35], v1, s[28:31], s71 offen offset:256 nt
    v_max3_f32 v234, v234, v228, s77
    s_waitcnt vmcnt(25)
    v_pk_fma_f32 v[212:213], v[236:237], v[36:37], v[212:213] op_sel_hi:[0,1,1]
    v_pk_fma_f32 v[214:215], v[236:237], v[38:39], v[214:215] op_sel_hi:[0,1,1]
    ds_add_u32 v224, v243 offset:3328
    buffer_load_dwordx4 v[36:39], v1, s[28:31], s71 offen offset:512 nt
    v_sub_f32 v235, v228, v234
    v_sub_f32 v229, v223, v234
    v_mov_b32_dpp v236, v238 row_newbcast:13 row_mask:0xf bank_mask:0xf
    s_waitcnt vmcnt(25)
    v_pk_fma_f32 v[204:205], v[236:237], v[40:41], v[204:205] op_sel_hi:[0,1,1]
L_h39:
    s_cbranch_execz L_h40
    v_pk_fma_f32 v[206:207], v[236:237], v[42:43], v[206:207] op_sel_hi:[0,1,1]
    s_add_u32 s71, s71, 3072
    s_cbranch_vccnz L_th9_2
L_tb9_2:
    buffer_load_dwordx4 v[40:43], v1, s[28:31], s71 offen offset:0 nt
    v_exp_f32 v235, v235
    s_waitcnt vmcnt(25)
    v_pk_fma_f32 v[208:209], v[236:237], v[44:45], v[208:209] op_sel_hi:[0,1,1]
    v_pk_fma_f32 v[210:211], v[236:237], v[46:47], v[210:211] op_sel_hi:[0,1,1]
    buffer_load_dwordx4 v[44:47], v1, s[28:31], s71 offen offset:256 nt
    v_exp_f32 v229, v229
    s_waitcnt vmcnt(25)
    v_pk_fma_f32 v[212:213], v[236:237], v[48:49], v[212:213] op_sel_hi:[0,1,1]
    v_pk_fma_f32 v[214:215], v[236:237], v[50:51], v[214:215] op_sel_hi:[0,1,1]
    ds_add_u32 v224, v243 offset:3328
    buffer_load_dwordx4 v[48:51], v1, s[28:31], s71 offen offset:512 nt
    v_mov_b32_dpp v236, v238 row_newbcast:3 row_mask:0xf bank_mask:0xf
    s_waitcnt vmcnt(23)
    v_pk_fma_f32 v[204:205], v[236:237], v[52:53], v[204:205] op_sel_hi:[0,1,1]
    v_pk_fma_f32 v[206:207], v[236:237], v[54:55], v[206:207] op_sel_hi:[0,1,1]
L_h40:
    s_cbranch_execz L_h41
    ds_read_b32 v244, v243 offset:147
    s_add_u32 s71, s71, 384000
    s_cbranch_vccnz L_th12_2
L_tb12_2:
    buffer_load_dwordx4 v[52:55], v1, s[28:31], s71 offen offset:0 nt
    v_lshlrev_b32 v220, 16, v220
    s_waitcnt vmcnt(23)
    v_pk_fma_f32 v[208:209], v[236:237], v[56:57], v[208:209] op_sel_hi:[0,1,1]
    v_pk_fma_f32 v[210:211], v[236:237], v[58:59], v[210:211] op_sel_hi:[0,1,1]
    buffer_load_dwordx4 v[56:59], v1, s[28:31], s71 offen offset:256 nt
    v_lshlrev_b32 v221, 16, v221
    s_waitcnt vmcnt(23)
    v_pk_fma_f32 v[212:213], v[236:237], v[60:61], v[212:213] op_sel_hi:[0,1,1]
    v_pk_fma_f32 v[214:215], v[236:237], v[62:63], v[214:215] op_sel_hi:[0,1,1]
    s_waitcnt lgkmcnt(0)
    v_cmp_lt_u32 vcc, v0, v244
    ds_add_u32 v224, v243 offset:3328
    buffer_load_dwordx4 v[60:63], v1, s[28:31], s71 offen offset:512 nt
    v_mov_b32_dpp v236, v238 row_newbcast:11 row_mask:0xf bank_mask:0xf
    s_waitcnt vmcnt(23)
L_h41:
    s_cbranch_execz L_h42
    v_pk_fma_f32 v[204:205], v[236:237], v[64:65], v[204:205] op_sel_hi:[0,1,1]
    v_pk_fma_f32 v[206:207], v[236:237], v[66:67], v[206:207] op_sel_hi:[0,1,1]
    s_add_u32 s71, s71, 3072
    s_cbranch_vccnz L_th15_2
L_tb15_2:
    buffer_load_dwordx4 v[64:67], v1, s[28:31], s71 offen offset:0 nt
    v_mul_f32 v222, v229, v220
    s_waitcnt vmcnt(23)
    v_pk_fma_f32 v[208:209], v[236:237], v[68:69], v[208:209] op_sel_hi:[0,1,1]
    v_pk_fma_f32 v[210:211], v[236:237], v[70:71], v[210:211] op_sel_hi:[0,1,1]
    buffer_load_dwordx4 v[68:71], v1, s[28:31], s71 offen offset:256 nt
    v_mul_f32 v230, v222, v221
    s_waitcnt vmcnt(23)
    v_pk_fma_f32 v[212:213], v[236:237], v[72:73], v[212:213] op_sel_hi:[0,1,1]
    v_pk_fma_f32 v[214:215], v[236:237], v[74:75], v[214:215] op_sel_hi:[0,1,1]
    ds_add_u32 v224, v243 offset:3328
    buffer_load_dwordx4 v[72:75], v1, s[28:31], s71 offen offset:512 nt
    v_mov_b32_dpp v236, v238 row_newbcast:7 row_mask:0xf bank_mask:0xf
    s_waitcnt vmcnt(23)
    v_pk_fma_f32 v[204:205], v[236:237], v[76:77], v[204:205] op_sel_hi:[0,1,1]
L_h42:
    s_cbranch_execz L_h43
    v_pk_fma_f32 v[206:207], v[236:237], v[78:79], v[206:207] op_sel_hi:[0,1,1]
    s_add_u32 s71, s71, 3072
    s_cbranch_vccnz L_th18_2
L_tb18_2:
    buffer_load_dwordx4 v[76:79], v1, s[28:31], s71 offen offset:0 nt
    s_waitcnt vmcnt(23)
    v_pk_fma_f32 v[208:209], v[236:237], v[80:81], v[208:209] op_sel_hi:[0,1,1]
    v_pk_fma_f32 v[210:211], v[236:237], v[82:83], v[210:211] op_sel_hi:[0,1,1]
    buffer_load_dwordx4 v[80:83], v1, s[28:31], s71 offen offset:256 nt
    s_waitcnt vmcnt(23)
    v_pk_fma_f32 v[212:213], v[236:237], v[84:85], v[212:213] op_sel_hi:[0,1,1]
    v_pk_fma_f32 v[214:215], v[236:237], v[86:87], v[214:215] op_sel_hi:[0,1,1]
    ds_add_u32 v224, v243 offset:3328
    buffer_load_dwordx4 v[84:87], v1, s[28:31], s71 offen offset:512 nt
    v_mov_b32_dpp v236, v238 row_newbcast:15 row_mask:0xf bank_mask:0xf
    s_waitcnt vmcnt(23)
    v_pk_fma_f32 v[204:205], v[236:237], v[88:89], v[204:205] op_sel_hi:[0,1,1]
    v_pk_fma_f32 v[206:207], v[236:237], v[90:91], v[206:207] op_sel_hi:[0,1,1]
L_h43:
    s_cbranch_execz L_h44
    s_add_u32 s71, s71, 3072
    s_cbranch_vccnz L_th21_2
L_tb21_2:
    buffer_load_dwordx4 v[88:91], v1, s[28:31], s71 offen offset:0 nt
    ds_write_b128 v241, v[204:207] offset:20480
    v_mul_f32 v238, 0x71800000, v222
    s_waitcnt vmcnt(23)
    v_pk_fma_f32 v[208:209], v[236:237], v[92:93], v[208:209] op_sel_hi:[0,1,1]
    v_pk_fma_f32 v[210:211], v[236:237], v[94:95], v[210:211] op_sel_hi:[0,1,1]
    buffer_load_dwordx4 v[92:95], v1, s[28:31], s71 offen offset:256 nt
    ds_write_b128 v241, v[208:211] offset:21504
    v_pk_mul_f32 v[204:205], v[204:205], v[234:235] op_sel:[0,1] op_sel_hi:[1,1]
    v_pk_mul_f32 v[206:207], v[206:207], v[234:235] op_sel:[0,1] op_sel_hi:[1,1]
    s_waitcnt vmcnt(23)
    v_pk_fma_f32 v[212:213], v[236:237], v[96:97], v[212:213] op_sel_hi:[0,1,1]
    v_pk_fma_f32 v[214:215], v[236:237], v[98:99], v[214:215] op_sel_hi:[0,1,1]
    ds_add_u32 v224, v243 offset:3328
    buffer_load_dwordx4 v[96:99], v1, s[28:31], s71 offen offset:512 nt
L_h44:
    s_cbranch_execz L_h45
    ds_write_b128 v241, v[212:215] offset:22528
    v_pk_mul_f32 v[208:209], v[208:209], v[234:235] op_sel:[0,1] op_sel_hi:[1,1]
    v_pk_mul_f32 v[210:211], v[210:211], v[234:235] op_sel:[0,1] op_sel_hi:[1,1]
    s_sub_u32 s76, s76, 1
    s_cmp_lg_u32 s76, 0
    s_cbranch_scc1 L_loop1
    v_mov_b32_dpp v236, v238 row_newbcast:0 row_mask:0xf bank_mask:0xf
    s_waitcnt vmcnt(23)
    v_pk_fma_f32 v[204:205], v[236:237], v[4:5], v[204:205] op_sel_hi:[0,1,1]
    v_pk_fma_f32 v[206:207], v[236:237], v[6:7], v[206:207] op_sel_hi:[0,1,1]
    ds_read_b32 v244, v243 offset:147
    s_add_u32 s71, s71, 384000
    s_cbranch_vccnz L_th24_3
L_tb24_3:
    buffer_load_dwordx4 v[4:7], v1, s[28:31], s71 offen offset:0 nt
    s_bitcmp0_b32 s4, 0
    s_cbranch_scc1 L_nofl3
    s_mov_b64 exec, 1
    ds_add_u32 v242, v243
    s_mov_b64 exec, -1
    v_add_u32 v241, 4096, v241
L_h45:
    s_cbranch_execz L_h46
    v_add_u32 v242, 4, v242
L_nofl3:
    s_waitcnt vmcnt(23)
    v_pk_fma_f32 v[208:209], v[236:237], v[8:9], v[208:209] op_sel_hi:[0,1,1]
    v_pk_fma_f32 v[210:211], v[236:237], v[10:11], v[210:211] op_sel_hi:[0,1,1]
    buffer_load_dwordx4 v[8:11], v1, s[28:31], s71 offen offset:256 nt
    v_pk_mul_f32 v[212:213], v[212:213], v[234:235] op_sel:[0,1] op_sel_hi:[1,1]
    v_pk_mul_f32 v[214:215], v[214:215], v[234:235] op_sel:[0,1] op_sel_hi:[1,1]
    v_mov_b32 v216, v234
    s_waitcnt vmcnt(23)
    v_pk_fma_f32 v[212:213], v[236:237], v[12:13], v[212:213] op_sel_hi:[0,1,1]
    v_pk_fma_f32 v[214:215], v[236:237], v[14:15], v[214:215] op_sel_hi:[0,1,1]
    s_waitcnt lgkmcnt(0)
    v_cmp_lt_u32 vcc, v0, v244
    ds_add_u32 v224, v243 offset:3328
    buffer_load_dwordx4 v[12:15], v1, s[28:31], s71 offen offset:512 nt
    v_fma_f32 v217, v217, v235, v229
    v_mov_b32_dpp v236, v238 row_newbcast:8 row_mask:0xf bank_mask:0xf
    s_waitcnt vmcnt(23)
    v_pk_fma_f32 v[204:205], v[236:237], v[16:17], v[204:205] op_sel_hi:[0,1,1]
L_h46:
    s_cbranch_execz L_h47
    v_pk_fma_f32 v[206:207], v[236:237], v[18:19], v[206:207] op_sel_hi:[0,1,1]
    s_add_u32 s71, s71, 3072
    s_cbranch_vccnz L_th27_3
L_tb27_3:
    buffer_load_dwordx4 v[16:19], v1, s[28:31], s71 offen offset:0 nt
    v_fma_f32 v218, v218, v235, v230
    s_waitcnt vmcnt(23)
    v_pk_fma_f32 v[208:209], v[236:237], v[20:21], v[208:209] op_sel_hi:[0,1,1]
    v_pk_fma_f32 v[210:211], v[236:237], v[22:23], v[210:211] op_sel_hi:[0,1,1]
    buffer_load_dwordx4 v[20:23], v1, s[28:31], s71 offen offset:256 nt
    s_mov_b64 exec, s[88:89]
    buffer_store_dwordx4 v[100:103], v225, s[52:55], s78 offen offset:0
    s_mov_b64 exec, -1
    s_waitcnt vmcnt(23)
    v_pk_fma_f32 v[212:213], v[236:237], v[24:25], v[212:213] op_sel_hi:[0,1,1]
    v_pk_fma_f32 v[214:215], v[236:237], v[26:27], v[214:215] op_sel_hi:[0,1,1]
    ds_add_u32 v224, v243 offset:3328
    buffer_load_dwordx4 v[24:27], v1, s[28:31], s71 offen offset:512 nt
    v_add_f32_dpp v218, v218, v218 row_ror:8 row_mask:0xf bank_mask:0xf
L_h47:
    s_cbranch_execz L_h48
    v_mov_b32_dpp v236, v238 row_newbcast:4 row_mask:0xf bank_mask:0xf
    s_waitcnt vmcnt(23)
    v_pk_fma_f32 v[204:205], v[236:237], v[28:29], v[204:205] op_sel_hi:[0,1,1]
    v_pk_fma_f32 v[206:207], v[236:237], v[30:31], v[206:207] op_sel_hi:[0,1,1]
    s_add_u32 s71, s71, 3072
    s_cbranch_vccnz L_th30_3
L_tb30_3:
    buffer_load_dwordx4 v[28:31], v1, s[28:31], s71 offen offset:0 nt
    v_add_f32_dpp v218, v218, v218 row_ror:4 row_mask:0xf bank_mask:0xf
    s_waitcnt vmcnt(23)
    v_pk_fma_f32 v[208:209], v[236:237], v[32:33], v[208:209] op_sel_hi:[0,1,1]
    v_pk_fma_f32 v[210:211], v[236:237], v[34:35], v[210:211] op_sel_hi:[0,1,1]
    buffer_load_dwordx4 v[32:35], v1, s[28:31], s71 offen offset:256 nt
    v_add_f32_dpp v218, v218, v218 row_ror:2 row_mask:0xf bank_mask:0xf
    s_waitcnt vmcnt(23)
    v_pk_fma_f32 v[212:213], v[236:237], v[36:37], v[212:213] op_sel_hi:[0,1,1]
    v_pk_fma_f32 v[214:215], v[236:237], v[38:39], v[214:215] op_sel_hi:[0,1,1]
    ds_add_u32 v224, v243 offset:3328
    buffer_load_dwordx4 v[36:39], v1, s[28:31], s71 offen offset:512 nt
L_h48:
    s_cbranch_execz L_h49
    v_add_f32_dpp v218, v218, v218 row_ror:1 row_mask:0xf bank_mask:0xf
    v_mov_b32_dpp v236, v238 row_newbcast:12 row_mask:0xf bank_mask:0xf
    s_waitcnt vmcnt(23)
    v_pk_fma_f32 v[204:205], v[236:237], v[40:41], v[204:205] op_sel_hi:[0,1,1]
    v_pk_fma_f32 v[206:207], v[236:237], v[42:43], v[206:207] op_sel_hi:[0,1,1]
    s_add_u32 s71, s71, 3072
    s_cbranch_vccnz L_th33_3
L_tb33_3:
    buffer_load_dwordx4 v[40:43], v1, s[28:31], s71 offen offset:0 nt
    v_mov_b32 v234, v218
    s_waitcnt vmcnt(23)
    v_pk_fma_f32 v[208:209], v[236:237], v[44:45], v[208:209] op_sel_hi:[0,1,1]
    v_pk_fma_f32 v[210:211], v[236:237], v[46:47], v[210:211] op_sel_hi:[0,1,1]
    buffer_load_dwordx4 v[44:47], v1, s[28:31], s71 offen offset:256 nt
    v_permlane32_swap_b32 v218, v234
    s_waitcnt vmcnt(23)
    v_pk_fma_f32 v[212:213], v[236:237], v[48:49], v[212:213] op_sel_hi:[0,1,1]
    v_pk_fma_f32 v[214:215], v[236:237], v[50:51], v[214:215] op_sel_hi:[0,1,1]
    ds_add_u32 v224, v243 offset:3328
L_h49:
    s_cbranch_execz L_h50
    buffer_load_dwordx4 v[48:51], v1, s[28:31], s71 offen offset:512 nt
    v_add_f32 v218, v218, v234
    v_mov_b32_dpp v236, v238 row_newbcast:2 row_mask:0xf bank_mask:0xf
    s_waitcnt vmcnt(23)
    v_pk_fma_f32 v[204:205], v[236:237], v[52:53], v[204:205] op_sel_hi:[0,1,1]
    v_pk_fma_f32 v[206:207], v[236:237], v[54:55], v[206:207] op_sel_hi:[0,1,1]
    ds_read_b32 v244, v243 offset:147
    s_add_u32 s71, s71, 384000
    s_cbranch_vccnz L_th36_3
L_tb36_3:
    buffer_load_dwordx4 v[52:55], v1, s[28:31], s71 offen offset:0 nt
    v_mov_b32 v234, v218
    s_waitcnt vmcnt(23)
    v_pk_fma_f32 v[208:209], v[236:237], v[56:57], v[208:209] op_sel_hi:[0,1,1]
    v_pk_fma_f32 v[210:211], v[236:237], v[58:59], v[210:211] op_sel_hi:[0,1,1]
    buffer_load_dwordx4 v[56:59], v1, s[28:31], s71 offen offset:256 nt
    v_permlane16_swap_b32 v218, v234
    s_waitcnt vmcnt(23)
    v_pk_fma_f32 v[212:213], v[236:237], v[60:61], v[212:213] op_sel_hi:[0,1,1]
    v_pk_fma_f32 v[214:215], v[236:237], v[62:63], v[214:215] op_sel_hi:[0,1,1]
L_h50:
    s_cbranch_execz L_h51
    s_waitcnt lgkmcnt(0)
    v_cmp_lt_u32 vcc, v0, v244
    ds_add_u32 v224, v243 offset:3328
    buffer_load_dwordx4 v[60:63], v1, s[28:31], s71 offen offset:512 nt
    v_add_f32 v218, v218, v234
    v_mov_b32_dpp v236, v238 row_newbcast:10 row_mask:0xf bank_mask:0xf
    s_waitcnt vmcnt(23)
    v_pk_fma_f32 v[204:205], v[236:237], v[64:65], v[204:205] op_sel_hi:[0,1,1]
    v_pk_fma_f32 v[206:207], v[236:237], v[66:67], v[206:207] op_sel_hi:[0,1,1]
    s_add_u32 s71, s71, 3072
    s_cbranch_vccnz L_th39_3
L_tb39_3:
    buffer_load_dwordx4 v[64:67], v1, s[28:31], s71 offen offset:0 nt
    v_mov_b32 v103, s93
    v_lshlrev_b32 v235, 4, v0
    s_lshl_b32 s78, s3, 11
    s_mov_b32 s6, 0x58000000
    s_waitcnt vmcnt(23)
    v_pk_fma_f32 v[208:209], v[236:237], v[68:69], v[208:209] op_sel_hi:[0,1,1]
    v_pk_fma_f32 v[210:211], v[236:237], v[70:71], v[210:211] op_sel_hi:[0,1,1]
    buffer_load_dwordx4 v[68:71], v1, s[28:31], s71 offen offset:256 nt
L_h51:
    s_cbranch_execz L_h52
    s_waitcnt vmcnt(23)
    v_pk_fma_f32 v[212:213], v[236:237], v[72:73], v[212:213] op_sel_hi:[0,1,1]
    v_pk_fma_f32 v[214:215], v[236:237], v[74:75], v[214:215] op_sel_hi:[0,1,1]
    ds_add_u32 v224, v243 offset:3328
    buffer_load_dwordx4 v[72:75], v1, s[28:31], s71 offen offset:512 nt
    v_mov_b32_dpp v236, v238 row_newbcast:6 row_mask:0xf bank_mask:0xf
    s_waitcnt vmcnt(23)
    v_pk_fma_f32 v[204:205], v[236:237], v[76:77], v[204:205] op_sel_hi:[0,1,1]
    v_pk_fma_f32 v[206:207], v[236:237], v[78:79], v[206:207] op_sel_hi:[0,1,1]
    s_add_u32 s71, s71, 3072
    s_cbranch_vccnz L_th42_3
L_tb42_3:
    buffer_load_dwordx4 v[76:79], v1, s[28:31], s71 offen offset:0 nt
    s_waitcnt vmcnt(23)
    v_pk_fma_f32 v[208:209], v[236:237], v[80:81], v[208:209] op_sel_hi:[0,1,1]
    v_pk_fma_f32 v[210:211], v[236:237], v[82:83], v[210:211] op_sel_hi:[0,1,1]
    buffer_load_dwordx4 v[80:83], v1, s[28:31], s71 offen offset:256 nt
    s_waitcnt vmcnt(23)
    v_pk_fma_f32 v[212:213], v[236:237], v[84:85], v[212:213] op_sel_hi:[0,1,1]
L_h52:
    s_cbranch_execz L_h53
    v_pk_fma_f32 v[214:215], v[236:237], v[86:87], v[214:215] op_sel_hi:[0,1,1]
    ds_add_u32 v224, v243 offset:3328
    buffer_load_dwordx4 v[84:87], v1, s[28:31], s71 offen offset:512 nt
    v_mov_b32_dpp v236, v238 row_newbcast:14 row_mask:0xf bank_mask:0xf
    s_waitcnt vmcnt(23)
    v_pk_fma_f32 v[204:205], v[236:237], v[88:89], v[204:205] op_sel_hi:[0,1,1]
    v_pk_fma_f32 v[206:207], v[236:237], v[90:91], v[206:207] op_sel_hi:[0,1,1]
    s_add_u32 s71, s71, 3072
    s_cbranch_vccnz L_th45_3
L_tb45_3:
    buffer_load_dwordx4 v[88:91], v1, s[28:31], s71 offen offset:0 nt
    s_waitcnt vmcnt(23)
    v_pk_fma_f32 v[208:209], v[236:237], v[92:93], v[208:209] op_sel_hi:[0,1,1]
    v_pk_fma_f32 v[210:211], v[236:237], v[94:95], v[210:211] op_sel_hi:[0,1,1]
    buffer_load_dwordx4 v[92:95], v1, s[28:31], s71 offen offset:256 nt
    s_waitcnt vmcnt(23)
    v_pk_fma_f32 v[212:213], v[236:237], v[96:97], v[212:213] op_sel_hi:[0,1,1]
    v_pk_fma_f32 v[214:215], v[236:237], v[98:99], v[214:215] op_sel_hi:[0,1,1]
    ds_add_u32 v224, v243 offset:3328
L_h53:
    s_cbranch_execz L_h54
    buffer_load_dwordx4 v[96:99], v1, s[28:31], s71 offen offset:512 nt
    ds_write_b32 v243, v243 offset:143
    v_mov_b32_dpp v236, v238 row_newbcast:1 row_mask:0xf bank_mask:0xf
    s_waitcnt vmcnt(23)
    v_pk_fma_f32 v[204:205], v[236:237], v[4:5], v[204:205] op_sel_hi:[0,1,1]
    v_pk_fma_f32 v[206:207], v[236:237], v[6:7], v[206:207] op_sel_hi:[0,1,1]
    s_waitcnt vmcnt(22)
    v_pk_fma_f32 v[208:209], v[236:237], v[8:9], v[208:209] op_sel_hi:[0,1,1]
    v_pk_fma_f32 v[210:211], v[236:237], v[10:11], v[210:211] op_sel_hi:[0,1,1]
    s_waitcnt vmcnt(21)
    v_pk_fma_f32 v[212:213], v[236:237], v[12:13], v[212:213] op_sel_hi:[0,1,1]
    v_pk_fma_f32 v[214:215], v[236:237], v[14:15], v[214:215] op_sel_hi:[0,1,1]
    v_mov_b32_dpp v236, v238 row_newbcast:9 row_mask:0xf bank_mask:0xf
    s_waitcnt vmcnt(20)
    v_pk_fma_f32 v[204:205], v[236:237], v[16:17], v[204:205] op_sel_hi:[0,1,1]
    v_pk_fma_f32 v[206:207], v[236:237], v[18:19], v[206:207] op_sel_hi:[0,1,1]
    s_waitcnt vmcnt(19)
    v_pk_fma_f32 v[208:209], v[236:237], v[20:21], v[208:209] op_sel_hi:[0,1,1]
L_h54:
    s_cbranch_execz L_h55
    v_pk_fma_f32 v[210:211], v[236:237], v[22:23], v[210:211] op_sel_hi:[0,1,1]
    s_waitcnt vmcnt(18)
    v_pk_fma_f32 v[212:213], v[236:237], v[24:25], v[212:213] op_sel_hi:[0,1,1]
    v_pk_fma_f32 v[214:215], v[236:237], v[26:27], v[214:215] op_sel_hi:[0,1,1]
    v_mov_b32_dpp v236, v238 row_newbcast:5 row_mask:0xf bank_mask:0xf
    s_waitcnt vmcnt(17)
    v_pk_fma_f32 v[204:205], v[236:237], v[28:29], v[204:205] op_sel_hi:[0,1,1]
    v_pk_fma_f32 v[206:207], v[236:237], v[30:31], v[206:207] op_sel_hi:[0,1,1]
    s_waitcnt vmcnt(16)
    v_pk_fma_f32 v[208:209], v[236:237], v[32:33], v[208:209] op_sel_hi:[0,1,1]
    v_pk_fma_f32 v[210:211], v[236:237], v[34:35], v[210:211] op_sel_hi:[0,1,1]
    s_waitcnt vmcnt(15)
    v_pk_fma_f32 v[212:213], v[236:237], v[36:37], v[212:213] op_sel_hi:[0,1,1]
    v_pk_fma_f32 v[214:215], v[236:237], v[38:39], v[214:215] op_sel_hi:[0,1,1]
    v_mov_b32_dpp v236, v238 row_newbcast:13 row_mask:0xf bank_mask:0xf
    s_waitcnt vmcnt(14)
    v_pk_fma_f32 v[204:205], v[236:237], v[40:41], v[204:205] op_sel_hi:[0,1,1]
    v_pk_fma_f32 v[206:207], v[236:237], v[42:43], v[206:207] op_sel_hi:[0,1,1]
L_h55:
    s_cbranch_execz L_h56
    s_waitcnt vmcnt(13)
    v_pk_fma_f32 v[208:209], v[236:237], v[44:45], v[208:209] op_sel_hi:[0,1,1]
    v_pk_fma_f32 v[210:211], v[236:237], v[46:47], v[210:211] op_sel_hi:[0,1,1]
    s_waitcnt vmcnt(12)
    v_pk_fma_f32 v[212:213], v[236:237], v[48:49], v[212:213] op_sel_hi:[0,1,1]
    v_pk_fma_f32 v[214:215], v[236:237], v[50:51], v[214:215] op_sel_hi:[0,1,1]
    v_mov_b32_dpp v236, v238 row_newbcast:3 row_mask:0xf bank_mask:0xf
    s_waitcnt vmcnt(11)
    v_pk_fma_f32 v[204:205], v[236:237], v[52:53], v[204:205] op_sel_hi:[0,1,1]
    v_pk_fma_f32 v[206:207], v[236:237], v[54:55], v[206:207] op_sel_hi:[0,1,1]
    s_waitcnt vmcnt(10)
    v_pk_fma_f32 v[208:209], v[236:237], v[56:57], v[208:209] op_sel_hi:[0,1,1]
    v_pk_fma_f32 v[210:211], v[236:237], v[58:59], v[210:211] op_sel_hi:[0,1,1]
    s_waitcnt vmcnt(9)
    v_pk_fma_f32 v[212:213], v[236:237], v[60:61], v[212:213] op_sel_hi:[0,1,1]
    v_pk_fma_f32 v[214:215], v[236:237], v[62:63], v[214:215] op_sel_hi:[0,1,1]
    v_mov_b32_dpp v236, v238 row_newbcast:11 row_mask:0xf bank_mask:0xf
    s_waitcnt vmcnt(8)
L_h56:
    s_cbranch_execz L_h57
    v_pk_fma_f32 v[204:205], v[236:237], v[64:65], v[204:205] op_sel_hi:[0,1,1]
    v_pk_fma_f32 v[206:207], v[236:237], v[66:67], v[206:207] op_sel_hi:[0,1,1]
    s_waitcnt vmcnt(7)
    v_pk_fma_f32 v[208:209], v[236:237], v[68:69], v[208:209] op_sel_hi:[0,1,1]
    v_pk_fma_f32 v[210:211], v[236:237], v[70:71], v[210:211] op_sel_hi:[0,1,1]
    s_waitcnt vmcnt(6)
    v_pk_fma_f32 v[212:213], v[236:237], v[72:73], v[212:213] op_sel_hi:[0,1,1]
    v_pk_fma_f32 v[214:215], v[236:237], v[74:75], v[214:215] op_sel_hi:[0,1,1]
    v_mov_b32_dpp v236, v238 row_newbcast:7 row_mask:0xf bank_mask:0xf
    s_waitcnt vmcnt(5)
    v_pk_fma_f32 v[204:205], v[236:237], v[76:77], v[204:205] op_sel_hi:[0,1,1]
    v_pk_fma_f32 v[206:207], v[236:237], v[78:79], v[206:207] op_sel_hi:[0,1,1]
    s_waitcnt vmcnt(4)
    v_pk_fma_f32 v[208:209], v[236:237], v[80:81], v[208:209] op_sel_hi:[0,1,1]
    v_pk_fma_f32 v[210:211], v[236:237], v[82:83], v[210:211] op_sel_hi:[0,1,1]
    s_waitcnt vmcnt(3)
    v_pk_fma_f32 v[212:213], v[236:237], v[84:85], v[212:213] op_sel_hi:[0,1,1]
    v_pk_fma_f32 v[214:215], v[236:237], v[86:87], v[214:215] op_sel_hi:[0,1,1]
L_h57:
    s_cbranch_execz L_h58
    v_mov_b32_dpp v236, v238 row_newbcast:15 row_mask:0xf bank_mask:0xf
    s_waitcnt vmcnt(2)
    v_pk_fma_f32 v[204:205], v[236:237], v[88:89], v[204:205] op_sel_hi:[0,1,1]
    v_pk_fma_f32 v[206:207], v[236:237], v[90:91], v[206:207] op_sel_hi:[0,1,1]
    s_waitcnt vmcnt(1)
    v_pk_fma_f32 v[208:209], v[236:237], v[92:93], v[208:209] op_sel_hi:[0,1,1]
    v_pk_fma_f32 v[210:211], v[236:237], v[94:95], v[210:211] op_sel_hi:[0,1,1]
    v_permlane32_swap_b32 v204, v206
    v_permlane32_swap_b32 v205, v207
    v_add_f32 v204, v204, v206
    v_add_f32 v205, v205, v207
    v_permlane32_swap_b32 v208, v210
    v_permlane32_swap_b32 v209, v211
    v_add_f32 v208, v208, v210
    v_add_f32 v209, v209, v211
    v_permlane16_swap_b32 v204, v205
    v_add_f32 v204, v204, v205
    v_fma_f32 v100, v204, s6, -v218
    v_permlane16_swap_b32 v208, v209
    v_add_f32 v208, v208, v209
    v_fma_f32 v101, v208, s6, -v218
    s_waitcnt vmcnt(0)
    v_pk_fma_f32 v[212:213], v[236:237], v[96:97], v[212:213] op_sel_hi:[0,1,1]
L_h58:
    s_cbranch_execz L_h59
    v_pk_fma_f32 v[214:215], v[236:237], v[98:99], v[214:215] op_sel_hi:[0,1,1]
    s_nop 1
    v_permlane32_swap_b32 v212, v214
    v_permlane32_swap_b32 v213, v215
    v_add_f32 v212, v212, v214
    v_add_f32 v213, v213, v215
    s_nop 1
    v_permlane16_swap_b32 v212, v213
    v_add_f32 v212, v212, v213
    v_fma_f32 v102, v212, s6, -v218
    s_mov_b64 exec, s[88:89]
    buffer_store_dwordx4 v[100:103], v225, s[52:55], s78 offen offset:0
    s_not_b64 exec, exec
    buffer_store_dwordx4 v[100:103], v225, s[52:55], s78 offen offset:0 sc0 sc1
    s_mov_b64 exec, -1
L_final:
    s_endpgm
L_th24_0:
    s_waitcnt vmcnt(32)
    s_cmp_eq_u32 vcc_lo, 1
    s_cbranch_scc1 L_tb24_0
    s_waitcnt vmcnt(23)
    s_branch L_tb24_0
L_th27_0:
    s_waitcnt vmcnt(26)
    s_cmp_eq_u32 vcc_lo, 1
    s_cbranch_scc1 L_tb27_0
    s_waitcnt vmcnt(23)
    s_branch L_tb27_0
L_th30_0:
    s_waitcnt vmcnt(32)
L_h59:
    s_cbranch_execz L_h60
    s_cmp_eq_u32 vcc_lo, 1
    s_cbranch_scc1 L_tb30_0
    s_waitcnt vmcnt(29)
    s_branch L_tb30_0
L_th33_0:
    s_waitcnt vmcnt(32)
    s_cmp_eq_u32 vcc_lo, 1
    s_cbranch_scc1 L_tb33_0
    s_waitcnt vmcnt(29)
    s_branch L_tb33_0
L_th36_0:
    s_waitcnt vmcnt(35)
    s_cmp_eq_u32 vcc_lo, 1
    s_cbranch_scc1 L_tb36_0
    s_waitcnt vmcnt(26)
    s_branch L_tb36_0
L_th39_0:
    s_waitcnt vmcnt(29)
    s_cmp_eq_u32 vcc_lo, 1
    s_cbranch_scc1 L_tb39_0
    s_waitcnt vmcnt(26)
    s_branch L_tb39_0
L_th42_0:
    s_waitcnt vmcnt(35)
    s_cmp_eq_u32 vcc_lo, 1
    s_cbranch_scc1 L_tb42_0
    s_waitcnt vmcnt(32)
    s_branch L_tb42_0
L_th45_0:
    s_waitcnt vmcnt(35)
    s_cmp_eq_u32 vcc_lo, 1
    s_cbranch_scc1 L_tb45_0
    s_waitcnt vmcnt(32)
    s_branch L_tb45_0
L_th0_0:
    s_waitcnt vmcnt(35)
    s_cmp_eq_u32 vcc_lo, 1
L_h60:
    s_cbranch_execz L_h61
    s_cbranch_scc1 L_tb0_0
    s_waitcnt vmcnt(26)
    s_branch L_tb0_0
L_th3_0:
    s_waitcnt vmcnt(29)
    s_cmp_eq_u32 vcc_lo, 1
    s_cbranch_scc1 L_tb3_0
    s_waitcnt vmcnt(26)
    s_branch L_tb3_0
L_th6_0:
    s_waitcnt vmcnt(35)
    s_cmp_eq_u32 vcc_lo, 1
    s_cbranch_scc1 L_tb6_0
    s_waitcnt vmcnt(29)
    s_branch L_tb6_0
L_th9_0:
    s_waitcnt vmcnt(32)
    s_cmp_eq_u32 vcc_lo, 1
    s_cbranch_scc1 L_tb9_0
    s_waitcnt vmcnt(29)
    s_branch L_tb9_0
L_th12_0:
    s_waitcnt vmcnt(32)
    s_cmp_eq_u32 vcc_lo, 1
    s_cbranch_scc1 L_tb12_0
    s_waitcnt vmcnt(23)
    s_branch L_tb12_0
L_th15_0:
    s_waitcnt vmcnt(26)
    s_cmp_eq_u32 vcc_lo, 1
    s_cbranch_scc1 L_tb15_0
    s_waitcnt vmcnt(23)
    s_branch L_tb15_0
L_th18_0:
    s_waitcnt vmcnt(32)
    s_cmp_eq_u32 vcc_lo, 1
    s_cbranch_scc1 L_tb18_0
L_h61:
    s_cbranch_execz L_h62
    s_waitcnt vmcnt(29)
    s_branch L_tb18_0
L_th21_0:
    s_waitcnt vmcnt(32)
    s_cmp_eq_u32 vcc_lo, 1
    s_cbranch_scc1 L_tb21_0
    s_waitcnt vmcnt(29)
    s_branch L_tb21_0
L_th24_1:
    s_waitcnt vmcnt(32)
    s_cmp_eq_u32 vcc_lo, 1
    s_cbranch_scc1 L_tb24_1
    s_waitcnt vmcnt(23)
    s_branch L_tb24_1
L_th27_1:
    s_waitcnt vmcnt(26)
    s_cmp_eq_u32 vcc_lo, 1
    s_cbranch_scc1 L_tb27_1
    s_waitcnt vmcnt(23)
    s_branch L_tb27_1
L_th30_1:
    s_waitcnt vmcnt(32)
    s_cmp_eq_u32 vcc_lo, 1
    s_cbranch_scc1 L_tb30_1
    s_waitcnt vmcnt(29)
    s_branch L_tb30_1
L_th33_1:
    s_waitcnt vmcnt(32)
    s_cmp_eq_u32 vcc_lo, 1
    s_cbranch_scc1 L_tb33_1
    s_waitcnt vmcnt(29)
    s_branch L_tb33_1
L_th36_1:
    s_waitcnt vmcnt(34)
    s_cmp_eq_u32 vcc_lo, 1
    s_cbranch_scc1 L_tb36_1
    s_waitcnt vmcnt(25)
L_h62:
    s_cbranch_execz L_h63
    s_branch L_tb36_1
L_th39_1:
    s_waitcnt vmcnt(28)
    s_cmp_eq_u32 vcc_lo, 1
    s_cbranch_scc1 L_tb39_1
    s_waitcnt vmcnt(25)
    s_branch L_tb39_1
L_th42_1:
    s_waitcnt vmcnt(28)
    s_cmp_eq_u32 vcc_lo, 1
    s_cbranch_scc1 L_tb42_1
    s_waitcnt vmcnt(25)
    s_branch L_tb42_1
L_th45_1:
    s_waitcnt vmcnt(28)
    s_cmp_eq_u32 vcc_lo, 1
    s_cbranch_scc1 L_tb45_1
    s_waitcnt vmcnt(25)
    s_branch L_tb45_1
L_th0_1:
    s_waitcnt vmcnt(28)
    s_cmp_eq_u32 vcc_lo, 1
    s_cbranch_scc1 L_tb0_1
    s_waitcnt vmcnt(19)
    s_branch L_tb0_1
L_th3_1:
    s_waitcnt vmcnt(22)
    s_cmp_eq_u32 vcc_lo, 1
    s_cbranch_scc1 L_tb3_1
    s_waitcnt vmcnt(19)
    s_branch L_tb3_1
L_th6_1:
    s_waitcnt vmcnt(22)
    s_cmp_eq_u32 vcc_lo, 1
    s_cbranch_scc1 L_tb6_1
    s_waitcnt vmcnt(17)
    s_branch L_tb6_1
L_h63:
    s_branch L_h64
L_th9_1:
    s_waitcnt vmcnt(20)
    s_cmp_eq_u32 vcc_lo, 1
    s_cbranch_scc1 L_tb9_1
    s_waitcnt vmcnt(17)
    s_branch L_tb9_1
L_th12_1:
    s_waitcnt vmcnt(20)
    s_cmp_eq_u32 vcc_lo, 1
    s_cbranch_scc1 L_tb12_1
    s_waitcnt vmcnt(17)
    s_branch L_tb12_1
L_th15_1:
    s_waitcnt vmcnt(20)
    s_cmp_eq_u32 vcc_lo, 1
    s_cbranch_scc1 L_tb15_1
    s_waitcnt vmcnt(17)
    s_branch L_tb15_1
L_th18_1:
    s_waitcnt vmcnt(20)
    s_cmp_eq_u32 vcc_lo, 1
    s_cbranch_scc1 L_tb18_1
    s_waitcnt vmcnt(17)
    s_branch L_tb18_1
L_th21_1:
    s_waitcnt vmcnt(20)
    s_cmp_eq_u32 vcc_lo, 1
    s_cbranch_scc1 L_tb21_1
    s_waitcnt vmcnt(17)
    s_branch L_tb21_1
L_th24_2:
    s_cmp_eq_u32 vcc_lo, 1
    s_cbranch_scc0 L_tx24_2
    s_nop 5
    s_waitcnt vmcnt(20)
    s_branch L_tb24_2
L_tx24_2:
    s_nop 5
L_h64:
    s_cbranch_execz L_h65
    s_waitcnt vmcnt(20)
    s_cmp_lt_u32 vcc_lo, 7
    s_cbranch_scc1 L_tb24_2
    s_waitcnt vmcnt(17)
    s_branch L_tb24_2
L_th27_2:
    s_cmp_eq_u32 vcc_lo, 1
    s_cbranch_scc0 L_tx27_2
    s_nop 5
    s_waitcnt vmcnt(20)
    s_branch L_tb27_2
L_tx27_2:
    s_nop 5
    s_waitcnt vmcnt(20)
    s_cmp_lt_u32 vcc_lo, 7
    s_cbranch_scc1 L_tb27_2
    s_waitcnt vmcnt(17)
    s_branch L_tb27_2
L_th30_2:
    s_cmp_eq_u32 vcc_lo, 1
    s_cbranch_scc0 L_tx30_2
    s_nop 5
    s_waitcnt vmcnt(20)
    s_branch L_tb30_2
L_tx30_2:
    s_nop 5
    s_waitcnt vmcnt(20)
    s_cmp_lt_u32 vcc_lo, 7
    s_cbranch_scc1 L_tb30_2
    s_waitcnt vmcnt(17)
    s_branch L_tb30_2
L_th33_2:
    s_cmp_eq_u32 vcc_lo, 1
    s_cbranch_scc0 L_tx33_2
    s_nop 5
    s_waitcnt vmcnt(20)
L_h65:
    s_cbranch_execz L_h66
    s_branch L_tb33_2
L_tx33_2:
    s_nop 5
    s_waitcnt vmcnt(20)
    s_cmp_lt_u32 vcc_lo, 7
    s_cbranch_scc1 L_tb33_2
    s_waitcnt vmcnt(17)
    s_branch L_tb33_2
L_th36_2:
    s_cmp_eq_u32 vcc_lo, 1
    s_cbranch_scc0 L_tx36_2
    s_nop 5
    s_waitcnt vmcnt(22)
    s_branch L_tb36_2
L_tx36_2:
    s_nop 5
    s_waitcnt vmcnt(22)
    s_cmp_lt_u32 vcc_lo, 7
    s_cbranch_scc1 L_tb36_2
    s_waitcnt vmcnt(19)
    s_branch L_tb36_2
L_th39_2:
    s_cmp_eq_u32 vcc_lo, 1
    s_cbranch_scc0 L_tx39_2
    s_nop 5
    s_waitcnt vmcnt(22)
    s_branch L_tb39_2
L_tx39_2:
    s_nop 5
    s_waitcnt vmcnt(22)
    s_cmp_lt_u32 vcc_lo, 7
    s_cbranch_scc1 L_tb39_2
    s_waitcnt vmcnt(19)
    s_branch L_tb39_2
L_th42_2:
    s_cmp_eq_u32 vcc_lo, 1
    s_cbranch_scc0 L_tx42_2
L_h66:
    s_cbranch_execz L_h67
    s_nop 5
    s_waitcnt vmcnt(22)
    s_branch L_tb42_2
L_tx42_2:
    s_nop 5
    s_waitcnt vmcnt(22)
    s_cmp_lt_u32 vcc_lo, 7
    s_cbranch_scc1 L_tb42_2
    s_waitcnt vmcnt(19)
    s_branch L_tb42_2
L_th45_2:
    s_cmp_eq_u32 vcc_lo, 1
    s_cbranch_scc0 L_tx45_2
    s_nop 5
    s_waitcnt vmcnt(22)
    s_branch L_tb45_2
L_tx45_2:
    s_nop 5
    s_waitcnt vmcnt(22)
    s_cmp_lt_u32 vcc_lo, 7
    s_cbranch_scc1 L_tb45_2
    s_waitcnt vmcnt(19)
    s_branch L_tb45_2
L_getm2:
    ds_read_b32 v227, v243 offset:139
    ds_read_b32 v226, v243 offset:159
    s_waitcnt lgkmcnt(0)
    v_readfirstlane_b32 s93, v227
    v_readfirstlane_b32 s77, v226
    s_cmp_eq_u32 s93, 0
    s_cbranch_scc1 L_getm2
    ds_read_b32 v226, v243 offset:151
L_h67:
    s_cbranch_execz L_h68
    s_waitcnt lgkmcnt(0)
    v_readfirstlane_b32 s88, v226
    s_cmp_eq_u32 s88, -1
    s_cselect_b64 s[88:89], -1, 0
    s_branch L_gotm2
L_th0_2:
    s_cmp_eq_u32 vcc_lo, 1
    s_cbranch_scc0 L_tx0_2
    s_nop 5
    s_waitcnt vmcnt(22)
    s_branch L_tb0_2
L_tx0_2:
    s_nop 5
    s_waitcnt vmcnt(22)
    s_cmp_lt_u32 vcc_lo, 7
    s_cbranch_scc1 L_tb0_2
    s_waitcnt vmcnt(19)
    s_branch L_tb0_2
L_th3_2:
    s_cmp_eq_u32 vcc_lo, 1
    s_cbranch_scc0 L_tx3_2
    s_nop 5
    s_waitcnt vmcnt(22)
    s_branch L_tb3_2
L_tx3_2:
    s_nop 5
    s_waitcnt vmcnt(22)
    s_cmp_lt_u32 vcc_lo, 7
    s_cbranch_scc1 L_tb3_2
    s_waitcnt vmcnt(19)
    s_branch L_tb3_2
L_th6_2:
    s_cmp_eq_u32 vcc_lo, 1
    s_cbranch_scc0 L_tx6_2
    s_nop 5
    s_waitcnt vmcnt(22)
L_h68:
    s_cbranch_execz L_h69
    s_branch L_tb6_2
L_tx6_2:
    s_nop 5
    s_waitcnt vmcnt(22)
    s_cmp_lt_u32 vcc_lo, 7
    s_cbranch_scc1 L_tb6_2
    s_waitcnt vmcnt(17)
    s_branch L_tb6_2
L_th9_2:
    s_cmp_eq_u32 vcc_lo, 1
    s_cbranch_scc0 L_tx9_2
    s_nop 5
    s_waitcnt vmcnt(20)
    s_branch L_tb9_2
L_tx9_2:
    s_nop 5
    s_waitcnt vmcnt(20)
    s_cmp_lt_u32 vcc_lo, 7
    s_cbranch_scc1 L_tb9_2
    s_waitcnt vmcnt(17)
    s_branch L_tb9_2
L_th12_2:
    s_cmp_eq_u32 vcc_lo, 1
    s_cbranch_scc0 L_tx12_2
    s_nop 5
    s_waitcnt vmcnt(20)
    s_branch L_tb12_2
L_tx12_2:
    s_nop 5
    s_waitcnt vmcnt(20)
    s_cmp_lt_u32 vcc_lo, 7
    s_cbranch_scc1 L_tb12_2
    s_waitcnt vmcnt(17)
    s_branch L_tb12_2
L_th15_2:
    s_cmp_eq_u32 vcc_lo, 1
    s_cbranch_scc0 L_tx15_2
L_h69:
    s_cbranch_execz L_h70
    s_nop 5
    s_waitcnt vmcnt(20)
    s_branch L_tb15_2
L_tx15_2:
    s_nop 5
    s_waitcnt vmcnt(20)
    s_cmp_lt_u32 vcc_lo, 7
    s_cbranch_scc1 L_tb15_2
    s_waitcnt vmcnt(17)
    s_branch L_tb15_2
L_th18_2:
    s_cmp_eq_u32 vcc_lo, 1
    s_cbranch_scc0 L_tx18_2
    s_nop 5
    s_waitcnt vmcnt(20)
    s_branch L_tb18_2
L_tx18_2:
    s_nop 5
    s_waitcnt vmcnt(20)
    s_cmp_lt_u32 vcc_lo, 7
    s_cbranch_scc1 L_tb18_2
    s_waitcnt vmcnt(17)
    s_branch L_tb18_2
L_th21_2:
    s_cmp_eq_u32 vcc_lo, 1
    s_cbranch_scc0 L_tx21_2
    s_nop 5
    s_waitcnt vmcnt(20)
    s_branch L_tb21_2
L_tx21_2:
    s_nop 5
    s_waitcnt vmcnt(20)
    s_cmp_lt_u32 vcc_lo, 7
    s_cbranch_scc1 L_tb21_2
    s_waitcnt vmcnt(17)
    s_branch L_tb21_2
L_h70:
    s_branch L_h71
L_th24_3:
    s_cmp_eq_u32 vcc_lo, 1
    s_cbranch_scc0 L_tx24_3
    s_nop 5
    s_waitcnt vmcnt(20)
    s_branch L_tb24_3
L_tx24_3:
    s_nop 5
    s_waitcnt vmcnt(20)
    s_cmp_lt_u32 vcc_lo, 7
    s_cbranch_scc1 L_tb24_3
    s_waitcnt vmcnt(17)
    s_branch L_tb24_3
L_th27_3:
    s_cmp_eq_u32 vcc_lo, 1
    s_cbranch_scc0 L_tx27_3
    s_nop 5
    s_waitcnt vmcnt(20)
    s_branch L_tb27_3
L_tx27_3:
    s_nop 5
    s_waitcnt vmcnt(20)
    s_cmp_lt_u32 vcc_lo, 7
    s_cbranch_scc1 L_tb27_3
    s_waitcnt vmcnt(17)
    s_branch L_tb27_3
L_th30_3:
    s_cmp_eq_u32 vcc_lo, 1
    s_cbranch_scc0 L_tx30_3
    s_nop 5
    s_waitcnt vmcnt(20)
    s_branch L_tb30_3
L_tx30_3:
    s_nop 5
    s_waitcnt vmcnt(20)
    s_cmp_lt_u32 vcc_lo, 7
    s_cbranch_scc1 L_tb30_3
L_h71:
    s_cbranch_execz L_h72
    s_waitcnt vmcnt(17)
    s_branch L_tb30_3
L_th33_3:
    s_cmp_eq_u32 vcc_lo, 1
    s_cbranch_scc0 L_tx33_3
    s_nop 5
    s_waitcnt vmcnt(20)
    s_branch L_tb33_3
L_tx33_3:
    s_nop 5
    s_waitcnt vmcnt(20)
    s_cmp_lt_u32 vcc_lo, 7
    s_cbranch_scc1 L_tb33_3
    s_waitcnt vmcnt(17)
    s_branch L_tb33_3
L_th36_3:
    s_cmp_eq_u32 vcc_lo, 1
    s_cbranch_scc0 L_tx36_3
    s_nop 5
    s_waitcnt vmcnt(20)
    s_branch L_tb36_3
L_tx36_3:
    s_nop 5
    s_waitcnt vmcnt(20)
    s_cmp_lt_u32 vcc_lo, 7
    s_cbranch_scc1 L_tb36_3
    s_waitcnt vmcnt(17)
    s_branch L_tb36_3
L_th39_3:
    s_cmp_eq_u32 vcc_lo, 1
    s_cbranch_scc0 L_tx39_3
    s_nop 5
    s_waitcnt vmcnt(20)
    s_branch L_tb39_3
L_tx39_3:
    s_nop 5
    s_waitcnt vmcnt(20)
L_h72:
    s_cbranch_execz L_hopped
    s_cmp_lt_u32 vcc_lo, 7
    s_cbranch_scc1 L_tb39_3
    s_waitcnt vmcnt(17)
    s_branch L_tb39_3
L_th42_3:
    s_cmp_eq_u32 vcc_lo, 1
    s_cbranch_scc0 L_tx42_3
    s_nop 5
    s_waitcnt vmcnt(20)
    s_branch L_tb42_3
L_tx42_3:
    s_nop 5
    s_waitcnt vmcnt(20)
    s_cmp_lt_u32 vcc_lo, 7
    s_cbranch_scc1 L_tb42_3
    s_waitcnt vmcnt(17)
    s_branch L_tb42_3
L_th45_3:
    s_cmp_eq_u32 vcc_lo, 1
    s_cbranch_scc0 L_tx45_3
    s_nop 5
    s_waitcnt vmcnt(20)
    s_branch L_tb45_3
L_tx45_3:
    s_nop 5
    s_waitcnt vmcnt(20)
    s_cmp_lt_u32 vcc_lo, 7
    s_cbranch_scc1 L_tb45_3
    s_waitcnt vmcnt(17)
    s_branch L_tb45_3
L_service:
    v_lshlrev_b32 v5, 2, v0
    v_mov_b32 v3, 0
    ds_write_b32 v5, v3 offset:0
    v_lshlrev_b32 v1, 4, v0
    v_lshlrev_b32 v28, 11, v0
    v_mov_b32 v9, 0xf149f2ca
    v_cndmask_b32 v9, v9, v3, s[66:67]
    v_and_b32 v5, 15, v0
    v_lshrrev_b32 v6, 4, v0
    v_lshl_add_u32 v11, v5, 2, v6
    v_lshlrev_b32 v11, 1, v11
    s_getreg_b32 s72, hwreg(HW_REG_XCC_ID)
    s_and_b32 s72, s72, 15
    s_waitcnt lgkmcnt(0)
    s_barrier
    s_branch L_w0
L_walked:
    s_mov_b32 s24, s6
    s_and_b32 s25, s7, 0xffff
    s_mov_b32 s26, 805306368
    s_mov_b32 s27, 0x00020000
    s_mov_b32 s28, s8
    s_and_b32 s29, s9, 0xffff
    s_mov_b32 s30, 805306368
    s_mov_b32 s31, 0x00020000
    s_mov_b32 s32, s10
    s_and_b32 s33, s11, 0xffff
    s_mov_b32 s34, 6291456
    s_mov_b32 s35, 0x00020000
    s_mov_b32 s36, s12
    s_and_b32 s37, s13, 0xffff
    s_mov_b32 s38, 6291456
    s_mov_b32 s39, 0x00020000
    s_mov_b32 s40, s14
    s_and_b32 s41, s15, 0xffff
    s_mov_b32 s42, 2097152
    s_mov_b32 s43, 0x00020000
    s_mov_b32 s44, s16
    s_and_b32 s45, s17, 0xffff
    s_mov_b32 s46, 2097152
    s_mov_b32 s47, 0x00020000
    s_mov_b32 s48, s4
    s_and_b32 s49, s5, 0xffff
    s_mov_b32 s50, 12288
    s_mov_b32 s51, 0x00020000
    s_mov_b32 s52, s22
    s_and_b32 s53, s23, 0xffff
    s_mov_b32 s54, 25165824
    s_mov_b32 s55, 0x00020000
    s_mov_b64 exec, 0
    s_branch L_h0
L_hopped:
    s_mov_b64 exec, -1
    s_mov_b32 s52, s22
    s_and_b32 s53, s23, 0xffff
    s_mov_b32 s54, 25165824
    s_mov_b32 s55, 0x00020000
    s_mov_b32 s56, s18
    s_and_b32 s57, s19, 0xffff
    s_mov_b32 s58, 12288
    s_mov_b32 s59, 0x00020000
    s_mov_b32 s96, s79
    s_and_b32 s82, s79, 3
    s_lshl_b32 s82, s82, 4
    v_mov_b32 v10, 0
    s_mov_b32 s80, 0x2010200
    s_mov_b32 s81, 0x2030202
    s_cmp_ge_u32 s79, 4
    s_cmov_b32 s80, 0x2050204
    s_cmov_b32 s81, 0x2070206
    s_lshr_b64 s[80:81], s[80:81], s82
    v_writelane_b32 v10, s80, 0
    s_mov_b32 s80, 0x2090208
    s_mov_b32 s81, 0x20b020a
    s_cmp_ge_u32 s79, 4
    s_cmov_b32 s80, 0x20d020c
    s_cmov_b32 s81, 0x20f020e
    s_lshr_b64 s[80:81], s[80:81], s82
    v_writelane_b32 v10, s80, 1
    s_mov_b32 s80, 0x4d00150
    s_mov_b32 s81, 0x8310571
    s_cmp_ge_u32 s79, 4
    s_cmov_b32 s80, 0x57304d2
    s_cmov_b32 s81, 0x4b40174
    s_lshr_b64 s[80:81], s[80:81], s82
    v_writelane_b32 v10, s80, 2
    s_mov_b32 s80, 0x9100d5
    s_mov_b32 s81, 0x15204b6
    s_cmp_ge_u32 s79, 4
    s_cmov_b32 s80, 0x4b700b3
    s_cmov_b32 s81, 0x8d508b7
    s_lshr_b64 s[80:81], s[80:81], s82
    v_writelane_b32 v10, s80, 3
    s_mov_b32 s80, 0x4950000
    s_mov_b32 s81, 0x8b60000
    s_cmp_ge_u32 s79, 4
    s_cmov_b32 s80, 0xc96
    s_cmov_b32 s81, 0xcb70000
    s_lshr_b64 s[80:81], s[80:81], s82
    v_writelane_b32 v10, s80, 4
    s_mov_b32 s80, 0x560000
    s_mov_b32 s81, 0x0
    s_cmp_ge_u32 s79, 4
    s_cmov_b32 s80, 0x37
    s_cmov_b32 s81, 0x0
    s_lshr_b64 s[80:81], s[80:81], s82
    v_writelane_b32 v10, s80, 5
    v_and_b32 v10, 0xffff, v10
L_tag:
    ds_read_b32 v5, v3 offset:140
    ds_read_b64 v[16:17], v3 offset:152
    s_waitcnt lgkmcnt(0)
    v_readfirstlane_b32 s69, v5
    s_cmp_eq_u32 s69, 0
    s_cbranch_scc1 L_tag
    v_readfirstlane_b32 s86, v16
    v_readfirstlane_b32 s87, v17
    s_bfm_b64 s[84:85], s92, 0
    s_bcnt1_i32_b64 s70, s[86:87]
    s_and_b64 s[84:85], s[84:85], s[86:87]
    s_bcnt1_i32_b64 s71, s[84:85]
    s_mov_b32 s73, s71
L_round:
    s_min_u32 s80, s71, 63
    v_readlane_b32 s97, v10, s80
    s_lshl_b32 s80, s71, 2
    v_mov_b32 v4, s80
    s_cmp_eq_u32 s97, 0
    s_cbranch_scc1 L_last
L_poll:
    ds_read_b32 v5, v4 offset:0
    s_waitcnt lgkmcnt(0)
    v_readfirstlane_b32 s80, v5
    s_cmp_eq_u32 s80, 0
    s_cbranch_scc1 L_poll
    s_add_u32 s95, s69, s71
    s_add_u32 s95, s95, 1
    s_and_b32 s80, s71, 1
    s_lshl_b32 s80, s80, 19
    s_add_u32 s80, s80, 2097152
    s_lshl_b32 s77, s2, 11
    s_add_u32 s77, s77, s80
    s_lshl_b32 s75, s96, 16
    s_add_u32 s75, s75, s80
L_all:
    v_mov_b32 v16, s95
    s_mov_b64 exec, s[86:87]
    buffer_load_dword v16, v28, s[52:55], s75 offen offset:1024 sc0 sc1
    s_mov_b64 exec, -1
    s_waitcnt vmcnt(0)
    v_cmp_ne_u32 vcc, s95, v16
    s_cmp_lg_u64 vcc, 0
    s_cbranch_scc1 L_all
    s_mov_b32 s74, 0
    s_mov_b64 s[84:85], s[86:87]
L_merge:
    v_mov_b32 v7, 0xf149f2ca
    v_mov_b32 v8, 0
    v_mov_b32 v12, 0
    v_mov_b32 v13, 0
    v_mov_b32 v14, 0
L_chunk:
    v_mov_b32 v48, 0
    v_mov_b32 v49, 0
    v_mov_b32 v50, 0
    v_mov_b32 v51, v9
    v_mov_b32 v52, 0
    v_mov_b32 v53, 0
    v_mov_b32 v54, 0
    v_mov_b32 v55, v9
    v_mov_b32 v56, 0
    v_mov_b32 v57, 0
    v_mov_b32 v58, 0
    v_mov_b32 v59, v9
    v_mov_b32 v60, 0
    v_mov_b32 v61, 0
    v_mov_b32 v62, 0
    v_mov_b32 v63, v9
    v_mov_b32 v64, 0
    v_mov_b32 v65, 0
    v_mov_b32 v66, 0
    v_mov_b32 v67, v9
    v_mov_b32 v68, 0
    v_mov_b32 v69, 0
    v_mov_b32 v70, 0
    v_mov_b32 v71, v9
    v_mov_b32 v72, 0
    v_mov_b32 v73, 0
    v_mov_b32 v74, 0
    v_mov_b32 v75, v9
    v_mov_b32 v76, 0
    v_mov_b32 v77, 0
    v_mov_b32 v78, 0
    v_mov_b32 v79, v9
    v_mov_b32 v80, 0
    v_mov_b32 v81, 0
    v_mov_b32 v82, 0
    v_mov_b32 v83, v9
    v_mov_b32 v84, 0
    v_mov_b32 v85, 0
    v_mov_b32 v86, 0
    v_mov_b32 v87, v9
    v_mov_b32 v88, 0
    v_mov_b32 v89, 0
    v_mov_b32 v90, 0
    v_mov_b32 v91, v9
    v_mov_b32 v92, 0
    v_mov_b32 v93, 0
    v_mov_b32 v94, 0
    v_mov_b32 v95, v9
    v_mov_b32 v96, 0
    v_mov_b32 v97, 0
    v_mov_b32 v98, 0
    v_mov_b32 v99, v9
    v_mov_b32 v100, 0
    v_mov_b32 v101, 0
    v_mov_b32 v102, 0
    v_mov_b32 v103, v9
    v_mov_b32 v104, 0
    v_mov_b32 v105, 0
    v_mov_b32 v106, 0
    v_mov_b32 v107, v9
    v_mov_b32 v108, 0
    v_mov_b32 v109, 0
    v_mov_b32 v110, 0
    v_mov_b32 v111, v9
    v_mov_b32 v112, 0
    v_mov_b32 v113, 0
    v_mov_b32 v114, 0
    v_mov_b32 v115, v9
    v_mov_b32 v116, 0
    v_mov_b32 v117, 0
    v_mov_b32 v118, 0
    v_mov_b32 v119, v9
    v_mov_b32 v120, 0
    v_mov_b32 v121, 0
    v_mov_b32 v122, 0
    v_mov_b32 v123, v9
    v_mov_b32 v124, 0
    v_mov_b32 v125, 0
    v_mov_b32 v126, 0
    v_mov_b32 v127, v9
    v_mov_b32 v128, 0
    v_mov_b32 v129, 0
    v_mov_b32 v130, 0
    v_mov_b32 v131, v9
    v_mov_b32 v132, 0
    v_mov_b32 v133, 0
    v_mov_b32 v134, 0
    v_mov_b32 v135, v9
    v_mov_b32 v136, 0
    v_mov_b32 v137, 0
    v_mov_b32 v138, 0
    v_mov_b32 v139, v9
    v_mov_b32 v140, 0
    v_mov_b32 v141, 0
    v_mov_b32 v142, 0
    v_mov_b32 v143, v9
    v_mov_b32 v144, 0
    v_mov_b32 v145, 0
    v_mov_b32 v146, 0
    v_mov_b32 v147, v9
    v_mov_b32 v148, 0
    v_mov_b32 v149, 0
    v_mov_b32 v150, 0
    v_mov_b32 v151, v9
    v_mov_b32 v152, 0
    v_mov_b32 v153, 0
    v_mov_b32 v154, 0
    v_mov_b32 v155, v9
    v_mov_b32 v156, 0
    v_mov_b32 v157, 0
    v_mov_b32 v158, 0
    v_mov_b32 v159, v9
    v_mov_b32 v160, 0
    v_mov_b32 v161, 0
    v_mov_b32 v162, 0
    v_mov_b32 v163, v9
    v_mov_b32 v164, 0
    v_mov_b32 v165, 0
    v_mov_b32 v166, 0
    v_mov_b32 v167, v9
    v_mov_b32 v168, 0
    v_mov_b32 v169, 0
    v_mov_b32 v170, 0
    v_mov_b32 v171, v9
    v_mov_b32 v172, 0
    v_mov_b32 v173, 0
    v_mov_b32 v174, 0
    v_mov_b32 v175, v9
    s_ff1_i32_b64 s80, s[84:85]
    s_bitset0_b64 s[84:85], s80
    s_lshl_b32 s81, s80, 11
    s_add_u32 s81, s81, s75
    s_cmp_ge_i32 s80, 0
    s_cselect_b64 exec, -1, 0
    buffer_load_dwordx4 v[48:51], v1, s[52:55], s81 offen sc0 sc1
    s_ff1_i32_b64 s80, s[84:85]
    s_bitset0_b64 s[84:85], s80
    s_lshl_b32 s81, s80, 11
    s_add_u32 s81, s81, s75
    s_cmp_ge_i32 s80, 0
    s_cselect_b64 exec, -1, 0
    buffer_load_dwordx4 v[52:55], v1, s[52:55], s81 offen sc0 sc1
    s_ff1_i32_b64 s80, s[84:85]
    s_bitset0_b64 s[84:85], s80
    s_lshl_b32 s81, s80, 11
    s_add_u32 s81, s81, s75
    s_cmp_ge_i32 s80, 0
    s_cselect_b64 exec, -1, 0
    buffer_load_dwordx4 v[56:59], v1, s[52:55], s81 offen sc0 sc1
    s_ff1_i32_b64 s80, s[84:85]
    s_bitset0_b64 s[84:85], s80
    s_lshl_b32 s81, s80, 11
    s_add_u32 s81, s81, s75
    s_cmp_ge_i32 s80, 0
    s_cselect_b64 exec, -1, 0
    buffer_load_dwordx4 v[60:63], v1, s[52:55], s81 offen sc0 sc1
    s_ff1_i32_b64 s80, s[84:85]
    s_bitset0_b64 s[84:85], s80
    s_lshl_b32 s81, s80, 11
    s_add_u32 s81, s81, s75
    s_cmp_ge_i32 s80, 0
    s_cselect_b64 exec, -1, 0
    buffer_load_dwordx4 v[64:67], v1, s[52:55], s81 offen sc0 sc1
    s_ff1_i32_b64 s80, s[84:85]
    s_bitset0_b64 s[84:85], s80
    s_lshl_b32 s81, s80, 11
    s_add_u32 s81, s81, s75
    s_cmp_ge_i32 s80, 0
    s_cselect_b64 exec, -1, 0
    buffer_load_dwordx4 v[68:71], v1, s[52:55], s81 offen sc0 sc1
    s_ff1_i32_b64 s80, s[84:85]
    s_bitset0_b64 s[84:85], s80
    s_lshl_b32 s81, s80, 11
    s_add_u32 s81, s81, s75
    s_cmp_ge_i32 s80, 0
    s_cselect_b64 exec, -1, 0
    buffer_load_dwordx4 v[72:75], v1, s[52:55], s81 offen sc0 sc1
    s_ff1_i32_b64 s80, s[84:85]
    s_bitset0_b64 s[84:85], s80
    s_lshl_b32 s81, s80, 11
    s_add_u32 s81, s81, s75
    s_cmp_ge_i32 s80, 0
    s_cselect_b64 exec, -1, 0
    buffer_load_dwordx4 v[76:79], v1, s[52:55], s81 offen sc0 sc1
    s_ff1_i32_b64 s80, s[84:85]
    s_bitset0_b64 s[84:85], s80
    s_lshl_b32 s81, s80, 11
    s_add_u32 s81, s81, s75
    s_cmp_ge_i32 s80, 0
    s_branch L_x1
L_w1:
    s_branch L_w2
L_x1:
    s_cbranch_scc0 L_got
    s_cselect_b64 exec, -1, 0
    buffer_load_dwordx4 v[80:83], v1, s[52:55], s81 offen sc0 sc1
    s_ff1_i32_b64 s80, s[84:85]
    s_bitset0_b64 s[84:85], s80
    s_lshl_b32 s81, s80, 11
    s_add_u32 s81, s81, s75
    s_cmp_ge_i32 s80, 0
    s_cselect_b64 exec, -1, 0
    buffer_load_dwordx4 v[84:87], v1, s[52:55], s81 offen sc0 sc1
    s_ff1_i32_b64 s80, s[84:85]
    s_bitset0_b64 s[84:85], s80
    s_lshl_b32 s81, s80, 11
    s_add_u32 s81, s81, s75
    s_cmp_ge_i32 s80, 0
    s_cselect_b64 exec, -1, 0
    buffer_load_dwordx4 v[88:91], v1, s[52:55], s81 offen sc0 sc1
    s_ff1_i32_b64 s80, s[84:85]
    s_bitset0_b64 s[84:85], s80
    s_lshl_b32 s81, s80, 11
    s_add_u32 s81, s81, s75
    s_cmp_ge_i32 s80, 0
    s_cselect_b64 exec, -1, 0
    buffer_load_dwordx4 v[92:95], v1, s[52:55], s81 offen sc0 sc1
    s_ff1_i32_b64 s80, s[84:85]
    s_bitset0_b64 s[84:85], s80
    s_lshl_b32 s81, s80, 11
    s_add_u32 s81, s81, s75
    s_cmp_ge_i32 s80, 0
    s_cselect_b64 exec, -1, 0
    buffer_load_dwordx4 v[96:99], v1, s[52:55], s81 offen sc0 sc1
    s_ff1_i32_b64 s80, s[84:85]
    s_bitset0_b64 s[84:85], s80
    s_lshl_b32 s81, s80, 11
    s_add_u32 s81, s81, s75
    s_cmp_ge_i32 s80, 0
    s_cselect_b64 exec, -1, 0
    buffer_load_dwordx4 v[100:103], v1, s[52:55], s81 offen sc0 sc1
    s_ff1_i32_b64 s80, s[84:85]
    s_bitset0_b64 s[84:85], s80
    s_lshl_b32 s81, s80, 11
    s_add_u32 s81, s81, s75
    s_cmp_ge_i32 s80, 0
    s_cselect_b64 exec, -1, 0
    buffer_load_dwordx4 v[104:107], v1, s[52:55], s81 offen sc0 sc1
    s_ff1_i32_b64 s80, s[84:85]
    s_bitset0_b64 s[84:85], s80
    s_lshl_b32 s81, s80, 11
    s_add_u32 s81, s81, s75
    s_cmp_ge_i32 s80, 0
    s_cselect_b64 exec, -1, 0
    buffer_load_dwordx4 v[108:111], v1, s[52:55], s81 offen sc0 sc1
    s_ff1_i32_b64 s80, s[84:85]
    s_bitset0_b64 s[84:85], s80
    s_lshl_b32 s81, s80, 11
    s_add_u32 s81, s81, s75
    s_cmp_ge_i32 s80, 0
    s_cbranch_scc0 L_got
    s_cselect_b64 exec, -1, 0
    buffer_load_dwordx4 v[112:115], v1, s[52:55], s81 offen sc0 sc1
    s_ff1_i32_b64 s80, s[84:85]
    s_bitset0_b64 s[84:85], s80
    s_lshl_b32 s81, s80, 11
    s_add_u32 s81, s81, s75
    s_cmp_ge_i32 s80, 0
    s_cselect_b64 exec, -1, 0
    buffer_load_dwordx4 v[116:119], v1, s[52:55], s81 offen sc0 sc1
    s_ff1_i32_b64 s80, s[84:85]
    s_bitset0_b64 s[84:85], s80
    s_lshl_b32 s81, s80, 11
    s_add_u32 s81, s81, s75
    s_cmp_ge_i32 s80, 0
    s_cselect_b64 exec, -1, 0
    buffer_load_dwordx4 v[120:123], v1, s[52:55], s81 offen sc0 sc1
    s_ff1_i32_b64 s80, s[84:85]
    s_bitset0_b64 s[84:85], s80
    s_lshl_b32 s81, s80, 11
    s_add_u32 s81, s81, s75
    s_cmp_ge_i32 s80, 0
    s_cselect_b64 exec, -1, 0
    buffer_load_dwordx4 v[124:127], v1, s[52:55], s81 offen sc0 sc1
    s_ff1_i32_b64 s80, s[84:85]
    s_bitset0_b64 s[84:85], s80
    s_lshl_b32 s81, s80, 11
    s_add_u32 s81, s81, s75
    s_cmp_ge_i32 s80, 0
    s_cselect_b64 exec, -1, 0
    buffer_load_dwordx4 v[128:131], v1, s[52:55], s81 offen sc0 sc1
    s_ff1_i32_b64 s80, s[84:85]
    s_bitset0_b64 s[84:85], s80
    s_lshl_b32 s81, s80, 11
    s_add_u32 s81, s81, s75
    s_cmp_ge_i32 s80, 0
    s_cselect_b64 exec, -1, 0
    buffer_load_dwordx4 v[132:135], v1, s[52:55], s81 offen sc0 sc1
    s_ff1_i32_b64 s80, s[84:85]
    s_bitset0_b64 s[84:85], s80
    s_lshl_b32 s81, s80, 11
    s_add_u32 s81, s81, s75
    s_cmp_ge_i32 s80, 0
    s_cselect_b64 exec, -1, 0
    buffer_load_dwordx4 v[136:139], v1, s[52:55], s81 offen sc0 sc1
    s_ff1_i32_b64 s80, s[84:85]
    s_bitset0_b64 s[84:85], s80
    s_lshl_b32 s81, s80, 11
    s_add_u32 s81, s81, s75
    s_cmp_ge_i32 s80, 0
    s_cselect_b64 exec, -1, 0
    buffer_load_dwordx4 v[140:143], v1, s[52:55], s81 offen sc0 sc1
    s_ff1_i32_b64 s80, s[84:85]
    s_bitset0_b64 s[84:85], s80
    s_lshl_b32 s81, s80, 11
    s_add_u32 s81, s81, s75
    s_cmp_ge_i32 s80, 0
    s_cbranch_scc0 L_got
    s_cselect_b64 exec, -1, 0
    buffer_load_dwordx4 v[144:147], v1, s[52:55], s81 offen sc0 sc1
    s_ff1_i32_b64 s80, s[84:85]
    s_bitset0_b64 s[84:85], s80
    s_lshl_b32 s81, s80, 11
    s_add_u32 s81, s81, s75
    s_cmp_ge_i32 s80, 0
    s_cselect_b64 exec, -1, 0
    buffer_load_dwordx4 v[148:151], v1, s[52:55], s81 offen sc0 sc1
    s_ff1_i32_b64 s80, s[84:85]
    s_bitset0_b64 s[84:85], s80
    s_lshl_b32 s81, s80, 11
    s_add_u32 s81, s81, s75
    s_cmp_ge_i32 s80, 0
    s_cselect_b64 exec, -1, 0
    buffer_load_dwordx4 v[152:155], v1, s[52:55], s81 offen sc0 sc1
    s_ff1_i32_b64 s80, s[84:85]
    s_bitset0_b64 s[84:85], s80
    s_lshl_b32 s81, s80, 11
    s_add_u32 s81, s81, s75
    s_cmp_ge_i32 s80, 0
    s_cselect_b64 exec, -1, 0
    buffer_load_dwordx4 v[156:159], v1, s[52:55], s81 offen sc0 sc1
    s_ff1_i32_b64 s80, s[84:85]
    s_bitset0_b64 s[84:85], s80
    s_lshl_b32 s81, s80, 11
    s_add_u32 s81, s81, s75
    s_cmp_ge_i32 s80, 0
    s_cselect_b64 exec, -1, 0
    buffer_load_dwordx4 v[160:163], v1, s[52:55], s81 offen sc0 sc1
    s_ff1_i32_b64 s80, s[84:85]
    s_bitset0_b64 s[84:85], s80
    s_lshl_b32 s81, s80, 11
    s_add_u32 s81, s81, s75
    s_cmp_ge_i32 s80, 0
    s_cselect_b64 exec, -1, 0
    buffer_load_dwordx4 v[164:167], v1, s[52:55], s81 offen sc0 sc1
    s_ff1_i32_b64 s80, s[84:85]
    s_bitset0_b64 s[84:85], s80
    s_lshl_b32 s81, s80, 11
    s_add_u32 s81, s81, s75
    s_cmp_ge_i32 s80, 0
    s_cselect_b64 exec, -1, 0
    buffer_load_dwordx4 v[168:171], v1, s[52:55], s81 offen sc0 sc1
    s_ff1_i32_b64 s80, s[84:85]
    s_bitset0_b64 s[84:85], s80
    s_lshl_b32 s81, s80, 11
    s_add_u32 s81, s81, s75
    s_cmp_ge_i32 s80, 0
    s_cselect_b64 exec, -1, 0
    buffer_load_dwordx4 v[172:175], v1, s[52:55], s81 offen sc0 sc1
L_got:
    s_mov_b64 exec, -1
    s_waitcnt vmcnt(0)
    v_max_f32 v5, v51, v55
    v_max3_f32 v5, v5, v59, v63
    v_max3_f32 v5, v5, v67, v71
    v_max3_f32 v5, v5, v75, v79
    v_max3_f32 v5, v5, v83, v87
    v_max3_f32 v5, v5, v91, v95
    v_max3_f32 v5, v5, v99, v103
    v_max3_f32 v5, v5, v107, v111
    v_max3_f32 v5, v5, v115, v119
    v_max3_f32 v5, v5, v123, v127
    v_max3_f32 v5, v5, v131, v135
    v_max3_f32 v5, v5, v139, v143
    v_max3_f32 v5, v5, v147, v151
    v_max3_f32 v5, v5, v155, v159
    v_max3_f32 v5, v5, v163, v167
    v_max3_f32 v5, v5, v171, v175
    s_nop 1
    v_max_f32_dpp v6, v5, v7 quad_perm:[0,0,2,2] row_mask:0xf bank_mask:0xf
    v_sub_f32 v5, v7, v6
    v_exp_f32 v5, v5
    v_mov_b32 v7, v6
    v_mul_f32 v8, v8, v5
    v_mul_f32 v12, v12, v5
    v_mul_f32 v13, v13, v5
    v_mul_f32 v14, v14, v5
    v_sub_f32_dpp v20, v51, v6 quad_perm:[0,0,2,2] row_mask:0xf bank_mask:0xf
    v_sub_f32_dpp v21, v55, v6 quad_perm:[0,0,2,2] row_mask:0xf bank_mask:0xf
    v_sub_f32_dpp v22, v59, v6 quad_perm:[0,0,2,2] row_mask:0xf bank_mask:0xf
    v_sub_f32_dpp v23, v63, v6 quad_perm:[0,0,2,2] row_mask:0xf bank_mask:0xf
    v_sub_f32_dpp v24, v67, v6 quad_perm:[0,0,2,2] row_mask:0xf bank_mask:0xf
    v_sub_f32_dpp v25, v71, v6 quad_perm:[0,0,2,2] row_mask:0xf bank_mask:0xf
    v_sub_f32_dpp v26, v75, v6 quad_perm:[0,0,2,2] row_mask:0xf bank_mask:0xf
    v_sub_f32_dpp v27, v79, v6 quad_perm:[0,0,2,2] row_mask:0xf bank_mask:0xf
    v_exp_f32 v20, v20
    v_exp_f32 v21, v21
    v_exp_f32 v22, v22
    v_exp_f32 v23, v23
    v_exp_f32 v24, v24
    v_exp_f32 v25, v25
    v_exp_f32 v26, v26
    v_exp_f32 v27, v27
    s_nop 0
    v_fmac_f32 v12, v20, v48
    v_fmac_f32 v13, v20, v49
    v_fmac_f32 v14, v20, v50
    v_fmac_f32 v8, v20, v51
    v_fmac_f32 v12, v21, v52
    v_fmac_f32 v13, v21, v53
    v_fmac_f32 v14, v21, v54
    v_fmac_f32 v8, v21, v55
    v_fmac_f32 v12, v22, v56
    v_fmac_f32 v13, v22, v57
    v_fmac_f32 v14, v22, v58
    v_fmac_f32 v8, v22, v59
    v_fmac_f32 v12, v23, v60
    v_fmac_f32 v13, v23, v61
    v_fmac_f32 v14, v23, v62
    v_fmac_f32 v8, v23, v63
    v_fmac_f32 v12, v24, v64
    v_fmac_f32 v13, v24, v65
    v_fmac_f32 v14, v24, v66
    v_fmac_f32 v8, v24, v67
    v_fmac_f32 v12, v25, v68
    v_fmac_f32 v13, v25, v69
    v_fmac_f32 v14, v25, v70
    v_fmac_f32 v8, v25, v71
    v_fmac_f32 v12, v26, v72
    v_fmac_f32 v13, v26, v73
    v_fmac_f32 v14, v26, v74
    v_fmac_f32 v8, v26, v75
    v_fmac_f32 v12, v27, v76
    v_fmac_f32 v13, v27, v77
    v_fmac_f32 v14, v27, v78
    v_fmac_f32 v8, v27, v79
    v_sub_f32_dpp v20, v83, v6 quad_perm:[0,0,2,2] row_mask:0xf bank_mask:0xf
    v_sub_f32_dpp v21, v87, v6 quad_perm:[0,0,2,2] row_mask:0xf bank_mask:0xf
    v_sub_f32_dpp v22, v91, v6 quad_perm:[0,0,2,2] row_mask:0xf bank_mask:0xf
    v_sub_f32_dpp v23, v95, v6 quad_perm:[0,0,2,2] row_mask:0xf bank_mask:0xf
    v_sub_f32_dpp v24, v99, v6 quad_perm:[0,0,2,2] row_mask:0xf bank_mask:0xf
    v_sub_f32_dpp v25, v103, v6 quad_perm:[0,0,2,2] row_mask:0xf bank_mask:0xf
    v_sub_f32_dpp v26, v107, v6 quad_perm:[0,0,2,2] row_mask:0xf bank_mask:0xf
    v_sub_f32_dpp v27, v111, v6 quad_perm:[0,0,2,2] row_mask:0xf bank_mask:0xf
    v_exp_f32 v20, v20
    v_exp_f32 v21, v21
    v_exp_f32 v22, v22
    v_exp_f32 v23, v23
    v_exp_f32 v24, v24
    v_exp_f32 v25, v25
    v_exp_f32 v26, v26
    v_exp_f32 v27, v27
    s_nop 0
    v_fmac_f32 v12, v20, v80
    v_fmac_f32 v13, v20, v81
    v_fmac_f32 v14, v20, v82
    v_fmac_f32 v8, v20, v83
    v_fmac_f32 v12, v21, v84
    v_fmac_f32 v13, v21, v85
    v_fmac_f32 v14, v21, v86
    v_fmac_f32 v8, v21, v87
    v_fmac_f32 v12, v22, v88
    v_fmac_f32 v13, v22, v89
    v_fmac_f32 v14, v22, v90
    v_fmac_f32 v8, v22, v91
    v_fmac_f32 v12, v23, v92
    v_fmac_f32 v13, v23, v93
    v_fmac_f32 v14, v23, v94
    v_fmac_f32 v8, v23, v95
    v_fmac_f32 v12, v24, v96
    v_fmac_f32 v13, v24, v97
    v_fmac_f32 v14, v24, v98
    v_fmac_f32 v8, v24, v99
    v_fmac_f32 v12, v25, v100
    v_fmac_f32 v13, v25, v101
    v_fmac_f32 v14, v25, v102
    v_fmac_f32 v8, v25, v103
    v_fmac_f32 v12, v26, v104
    v_fmac_f32 v13, v26, v105
    v_fmac_f32 v14, v26, v106
    v_fmac_f32 v8, v26, v107
    v_fmac_f32 v12, v27, v108
    v_fmac_f32 v13, v27, v109
    v_fmac_f32 v14, v27, v110
    v_fmac_f32 v8, v27, v111
    v_sub_f32_dpp v20, v115, v6 quad_perm:[0,0,2,2] row_mask:0xf bank_mask:0xf
    v_sub_f32_dpp v21, v119, v6 quad_perm:[0,0,2,2] row_mask:0xf bank_mask:0xf
    v_sub_f32_dpp v22, v123, v6 quad_perm:[0,0,2,2] row_mask:0xf bank_mask:0xf
    v_sub_f32_dpp v23, v127, v6 quad_perm:[0,0,2,2] row_mask:0xf bank_mask:0xf
    v_sub_f32_dpp v24, v131, v6 quad_perm:[0,0,2,2] row_mask:0xf bank_mask:0xf
    v_sub_f32_dpp v25, v135, v6 quad_perm:[0,0,2,2] row_mask:0xf bank_mask:0xf
    v_sub_f32_dpp v26, v139, v6 quad_perm:[0,0,2,2] row_mask:0xf bank_mask:0xf
    v_sub_f32_dpp v27, v143, v6 quad_perm:[0,0,2,2] row_mask:0xf bank_mask:0xf
    v_exp_f32 v20, v20
    v_exp_f32 v21, v21
    v_exp_f32 v22, v22
    v_exp_f32 v23, v23
    v_exp_f32 v24, v24
    v_exp_f32 v25, v25
    v_exp_f32 v26, v26
    v_exp_f32 v27, v27
    s_nop 0
    v_fmac_f32 v12, v20, v112
    v_fmac_f32 v13, v20, v113
    v_fmac_f32 v14, v20, v114
    v_fmac_f32 v8, v20, v115
    v_fmac_f32 v12, v21, v116
    v_fmac_f32 v13, v21, v117
    v_fmac_f32 v14, v21, v118
    v_fmac_f32 v8, v21, v119
    v_fmac_f32 v12, v22, v120
    v_fmac_f32 v13, v22, v121
    v_fmac_f32 v14, v22, v122
    v_fmac_f32 v8, v22, v123
    v_fmac_f32 v12, v23, v124
    v_fmac_f32 v13, v23, v125
    v_fmac_f32 v14, v23, v126
    v_fmac_f32 v8, v23, v127
    v_fmac_f32 v12, v24, v128
    v_fmac_f32 v13, v24, v129
    v_fmac_f32 v14, v24, v130
    v_fmac_f32 v8, v24, v131
    v_fmac_f32 v12, v25, v132
    v_fmac_f32 v13, v25, v133
    v_fmac_f32 v14, v25, v134
    v_fmac_f32 v8, v25, v135
    v_fmac_f32 v12, v26, v136
    v_fmac_f32 v13, v26, v137
    v_fmac_f32 v14, v26, v138
    v_fmac_f32 v8, v26, v139
    v_fmac_f32 v12, v27, v140
    v_fmac_f32 v13, v27, v141
    v_fmac_f32 v14, v27, v142
    v_fmac_f32 v8, v27, v143
    v_sub_f32_dpp v20, v147, v6 quad_perm:[0,0,2,2] row_mask:0xf bank_mask:0xf
    v_sub_f32_dpp v21, v151, v6 quad_perm:[0,0,2,2] row_mask:0xf bank_mask:0xf
    v_sub_f32_dpp v22, v155, v6 quad_perm:[0,0,2,2] row_mask:0xf bank_mask:0xf
    v_sub_f32_dpp v23, v159, v6 quad_perm:[0,0,2,2] row_mask:0xf bank_mask:0xf
    v_sub_f32_dpp v24, v163, v6 quad_perm:[0,0,2,2] row_mask:0xf bank_mask:0xf
    v_sub_f32_dpp v25, v167, v6 quad_perm:[0,0,2,2] row_mask:0xf bank_mask:0xf
    v_sub_f32_dpp v26, v171, v6 quad_perm:[0,0,2,2] row_mask:0xf bank_mask:0xf
    v_sub_f32_dpp v27, v175, v6 quad_perm:[0,0,2,2] row_mask:0xf bank_mask:0xf
    v_exp_f32 v20, v20
    v_exp_f32 v21, v21
    v_exp_f32 v22, v22
    v_exp_f32 v23, v23
    v_exp_f32 v24, v24
    v_exp_f32 v25, v25
    v_exp_f32 v26, v26
    v_exp_f32 v27, v27
    s_nop 0
    v_fmac_f32 v12, v20, v144
    v_fmac_f32 v13, v20, v145
    v_fmac_f32 v14, v20, v146
    v_fmac_f32 v8, v20, v147
    v_fmac_f32 v12, v21, v148
    v_fmac_f32 v13, v21, v149
    v_fmac_f32 v14, v21, v150
    v_fmac_f32 v8, v21, v151
    v_fmac_f32 v12, v22, v152
    v_fmac_f32 v13, v22, v153
    v_fmac_f32 v14, v22, v154
    v_fmac_f32 v8, v22, v155
    v_fmac_f32 v12, v23, v156
    v_fmac_f32 v13, v23, v157
    v_fmac_f32 v14, v23, v158
    v_fmac_f32 v8, v23, v159
    v_fmac_f32 v12, v24, v160
    v_fmac_f32 v13, v24, v161
    v_fmac_f32 v14, v24, v162
    v_fmac_f32 v8, v24, v163
    v_fmac_f32 v12, v25, v164
    v_fmac_f32 v13, v25, v165
    v_fmac_f32 v14, v25, v166
    v_fmac_f32 v8, v25, v167
    v_fmac_f32 v12, v26, v168
    v_fmac_f32 v13, v26, v169
    v_fmac_f32 v14, v26, v170
    v_fmac_f32 v8, v26, v171
    v_fmac_f32 v12, v27, v172
    v_fmac_f32 v13, v27, v173
    v_fmac_f32 v14, v27, v174
    v_fmac_f32 v8, v27, v175
    s_cmp_lg_u64 s[84:85], 0
    s_cbranch_scc1 L_chunk
    s_cmp_lg_u32 s74, 0
    s_cbranch_scc1 L_fin
    v_cndmask_b32 v15, v7, v8, s[66:67]
    v_mov_b32 v5, s95
    s_and_b32 s79, s97, 31
    s_lshr_b32 s80, s97, 10
    s_lshl_b32 s80, s80, 3
    s_and_b32 s83, s72, 7
    s_add_u32 s80, s80, s83
    s_bfm_b64 s[88:89], 1, s80
    s_bfe_u32 s83, s97, 0x50005
    s_mul_i32 s83, s83, s70
    s_cmp_lg_u32 s83, 512
    s_cbranch_scc1 L_rec
    s_mov_b64 exec, 1
    buffer_store_dword v5, v3, s[52:55], s77 offen offset:1028
    s_mov_b64 exec, -1
    s_branch L_fin
L_rec:
    s_lshl_b32 s83, s83, 16
    s_or_b32 s89, s89, s83
    v_mov_b32 v16, s88
    v_mov_b32 v17, s89
    s_lshl_b32 s75, s79, 17
    s_add_u32 s75, s75, 4194304
    s_lshl_b32 s80, s80, 11
    s_add_u32 s80, s80, s75
    buffer_store_dwordx4 v[12:15], v1, s[52:55], s80 offen sc0 sc1
    s_mov_b64 exec, 1
    buffer_store_dword v5, v3, s[52:55], s77 offen offset:1028
    s_lshl_b32 s80, s79, 8
    s_add_u32 s80, s80, 23076864
    s_waitcnt vmcnt(0)
    buffer_atomic_add_x2 v[16:17], v3, s[52:55], s80 offen sc0 sc1
    s_waitcnt vmcnt(0)
    s_mov_b64 exec, -1
    v_readfirstlane_b32 s84, v16
    v_readfirstlane_b32 s85, v17
    s_add_u32 s84, s84, s88
    s_add_u32 s85, s85, s89
    s_lshr_b32 s80, s85, 16
    s_cmp_lg_u32 s80, 512
    s_cbranch_scc1 L_next
    s_mov_b32 s74, 1
    s_and_b32 s85, s85, 0xffff
    s_branch L_merge
L_fin:
    s_nop 1
    v_mov_b32_dpp v5, v8 quad_perm:[1,1,3,3] row_mask:0xf bank_mask:0xf
    v_rcp_f32 v5, v5
    s_mul_i32 s80, s79, 384
    v_mul_f32 v12, v12, v5
    v_mul_f32 v13, v13, v5
    v_mul_f32 v14, v14, v5
    v_cvt_pk_bf16_f32 v12, v12, v12
    v_cvt_pk_bf16_f32 v13, v13, v13
    v_cvt_pk_bf16_f32 v14, v14, v14
    buffer_store_short v12, v11, s[56:59], s80 offen offset:0
    buffer_store_short v13, v11, s[56:59], s80 offen offset:128
    buffer_store_short v14, v11, s[56:59], s80 offen offset:256
L_next:
    s_add_u32 s71, s71, s70
    s_branch L_round
L_last:
    s_lshl_b32 s75, s96, 9
    s_add_u32 s75, s75, 1572864
    v_lshrrev_b32 v6, 1, v0
    v_lshlrev_b32 v28, 4, v6
L_inf:
    buffer_load_dwordx4 v[48:51], v28, s[52:55], s75 offen sc0 sc1
    s_waitcnt vmcnt(0)
    v_cmp_ne_u32 vcc, s69, v49
    s_cmp_lg_u64 vcc, 0
    s_cbranch_scc1 L_inf
    v_mov_b32 v7, v50
    s_nop 1
    v_max_f32_dpp v7, v7, v7 row_ror:8 row_mask:0xf bank_mask:0xf
    s_nop 1
    v_max_f32_dpp v7, v7, v7 row_ror:4 row_mask:0xf bank_mask:0xf
    s_nop 1
    v_max_f32_dpp v7, v7, v7 row_ror:2 row_mask:0xf bank_mask:0xf
    s_nop 1
    v_max_f32_dpp v7, v7, v7 row_ror:1 row_mask:0xf bank_mask:0xf
    v_mov_b32 v5, v7
    s_nop 1
    v_permlane32_swap_b32 v7, v5
    s_nop 1
    v_max_f32 v7, v7, v5
    v_mov_b32 v5, v7
    s_nop 1
    v_permlane16_swap_b32 v7, v5
    s_nop 1
    v_max_f32 v7, v7, v5
    v_sub_f32 v20, v50, v7
    v_exp_f32 v20, v20
    s_nop 0
    v_mul_f32 v8, v20, v51
    s_nop 1
    v_add_f32_dpp v8, v8, v8 row_ror:8 row_mask:0xf bank_mask:0xf
    s_nop 1
    v_add_f32_dpp v8, v8, v8 row_ror:4 row_mask:0xf bank_mask:0xf
    s_nop 1
    v_add_f32_dpp v8, v8, v8 row_ror:2 row_mask:0xf bank_mask:0xf
    s_nop 1
    v_add_f32_dpp v8, v8, v8 row_ror:1 row_mask:0xf bank_mask:0xf
    v_mov_b32 v5, v8
    s_nop 1
    v_permlane32_swap_b32 v8, v5
    s_nop 1
    v_add_f32 v8, v8, v5
    v_mov_b32 v5, v8
    s_nop 1
    v_permlane16_swap_b32 v8, v5
    s_nop 1
    v_add_f32 v8, v8, v5
    v_rcp_f32 v8, v8
    v_and_b32 v5, 1, v0
    v_mul_f32 v8, 2.0, v8
    v_mul_f32 v20, v20, v8
    v_lshlrev_b32 v28, 11, v6
    v_lshl_add_u32 v28, v5, 4, v28
    s_lshl_b32 s75, s96, 16
    s_lshl_b32 s80, s92, 5
    s_add_u32 s75, s75, s80
    v_mov_b32 v51, 0
    v_mov_b32 v55, 0
    v_mov_b32 v59, 0
    v_mov_b32 v63, 0
    v_mov_b32 v12, 0
    v_mov_b32 v13, 0
    v_mov_b32 v14, 0
    v_bfe_u32 v6, v0, 4, 1
    v_lshrrev_b32 v11, 5, v0
    v_lshl_add_u32 v11, v6, 1, v11
    v_lshlrev_b32 v11, 7, v11
    v_lshl_add_u32 v11, v5, 3, v11
    s_and_b32 s80, s92, 7
    s_lshl_b32 s80, s80, 4
    s_lshr_b32 s81, s92, 3
    s_lshl_b32 s81, s81, 1
    s_add_u32 s80, s80, s81
    s_add_u32 s79, s96, 24
    s_mul_i32 s78, s79, 384
    s_add_u32 s78, s78, s80
    s_mov_b64 s[24:25], -1
    s_mov_b32 s32, 0x00030003
    s_mov_b32 s33, 0x00000003
L_dt:
    ds_read_b32 v5, v3 offset:144
    s_waitcnt lgkmcnt(0)
    v_readfirstlane_b32 s80, v5
    s_cmp_eq_u32 s80, 0
    s_cbranch_scc1 L_dt
L_pa:
    buffer_load_dwordx4 v[48:51], v28, s[52:55], s75 offen offset:0 sc0 sc1
    s_waitcnt vmcnt(0)
    v_cmpx_eq_u32 vcc, s69, v51
    v_fmac_f32 v12, v20, v48
    v_fmac_f32 v13, v20, v49
    v_fmac_f32 v14, v20, v50
    s_andn2_b64 s[24:25], s[24:25], vcc
    s_mov_b64 exec, s[24:25]
    s_bcnt1_i32_b64 s80, s[24:25]
    s_cmp_gt_u32 s80, 0
    s_cbranch_scc1 L_pa
L_pd:
    s_mov_b64 exec, -1
    v_mov_b32 v15, v14
    v_permlane32_swap_b32 v12, v13
    s_nop 0
    v_permlane32_swap_b32 v14, v15
    v_add_f32 v12, v12, v13
    v_add_f32 v14, v14, v15
    s_nop 1
    v_permlane16_swap_b32 v12, v14
    v_add_f32 v12, v12, v14
    s_nop 1
    v_add_f32_dpp v12, v12, v12 row_ror:8 row_mask:0xf bank_mask:0xf
    s_nop 1
    v_add_f32_dpp v12, v12, v12 row_ror:4 row_mask:0xf bank_mask:0xf
    s_nop 1
    v_add_f32_dpp v12, v12, v12 row_ror:2 row_mask:0xf bank_mask:0xf
    s_mov_b64 exec, s[32:33]
    v_cvt_pk_bf16_f32 v12, v12, v12
    buffer_store_short v12, v11, s[56:59], s78 offen
L_end:
    s_endpgm
L_ticket:
    v_lshlrev_b32 v1, 2, v0
    v_mov_b32 v2, 0
    v_lshlrev_b32 v4, 4, v0
    v_mov_b32 v8, -1
    v_mov_b32 v9, -1
    v_mov_b32 v10, -1
    v_mov_b32 v11, -1
    ds_write_b128 v4, v[8:11] offset:256
    ds_write_b128 v4, v[8:11] offset:1280
    ds_write_b128 v4, v[8:11] offset:2304
    s_memrealtime s[80:81]
    s_waitcnt lgkmcnt(0)
    s_barrier
    s_mov_b32 s52, s22
    s_and_b32 s53, s23, 0xffff
    s_mov_b32 s54, 25165824
    s_mov_b32 s55, 0x00020000
    s_mov_b32 s60, s20
    s_and_b32 s61, s21, 0xffff
    s_mov_b32 s62, 256
    s_mov_b32 s63, 0x00020000
    s_max_u32 s69, s80, 1
    s_cmp_lg_u32 s2, 0
    s_cbranch_scc1 L_kd
    v_lshlrev_b32 v5, 8, v0
    s_mov_b32 s80, 23068672
    v_mov_b32 v3, 0
    buffer_store_dwordx2 v[2:3], v5, s[52:55], s80 offen sc0 sc1
    v_mov_b32 v3, s69
    s_mov_b64 exec, 1
    s_waitcnt vmcnt(0)
    buffer_store_dword v3, v2, s[60:63], 0 offen sc0 sc1
    s_mov_b64 exec, -1
L_kd:
    ds_read_b32 v3, v2 offset:128
    s_waitcnt lgkmcnt(0)
    v_readfirstlane_b32 s80, v3
    s_cmp_eq_u32 s80, 0
    s_cbranch_scc1 L_kd
    ds_read_b128 v[24:27], v4 offset:16128
    ds_read_b128 v[28:31], v4 offset:17152
    ds_read_b128 v[32:35], v4 offset:18176
    ds_read_b128 v[36:39], v4 offset:19200
    s_waitcnt lgkmcnt(0)
    v_max_f32 v18, v24, v25
    v_max3_f32 v18, v18, v26, v27
    v_max3_f32 v18, v18, v28, v29
    v_max3_f32 v18, v18, v30, v31
    v_max3_f32 v18, v18, v32, v33
    v_max3_f32 v18, v18, v34, v35
    v_max3_f32 v18, v18, v36, v37
    v_max3_f32 v18, v18, v38, v39
    s_nop 1
    v_max_f32_dpp v18, v18, v18 row_ror:8 row_mask:0xf bank_mask:0xf
    s_nop 1
    v_max_f32_dpp v18, v18, v18 row_ror:4 row_mask:0xf bank_mask:0xf
    s_nop 1
    v_max_f32_dpp v18, v18, v18 row_ror:2 row_mask:0xf bank_mask:0xf
    s_nop 1
    v_max_f32_dpp v18, v18, v18 row_ror:1 row_mask:0xf bank_mask:0xf
    v_mov_b32 v3, v18
    s_nop 1
    v_permlane32_swap_b32 v18, v3
    s_nop 1
    v_max_f32 v18, v18, v3
    v_mov_b32 v3, v18
    s_nop 1
    v_permlane16_swap_b32 v18, v3
    s_nop 1
    v_max_f32 v18, v18, v3
    v_sub_f32 v24, v24, v18
    v_sub_f32 v25, v25, v18
    v_sub_f32 v26, v26, v18
    v_sub_f32 v27, v27, v18
    v_sub_f32 v28, v28, v18
    v_sub_f32 v29, v29, v18
    v_sub_f32 v30, v30, v18
    v_sub_f32 v31, v31, v18
    v_sub_f32 v32, v32, v18
    v_sub_f32 v33, v33, v18
    v_sub_f32 v34, v34, v18
    v_sub_f32 v35, v35, v18
    v_sub_f32 v36, v36, v18
    v_sub_f32 v37, v37, v18
    v_sub_f32 v38, v38, v18
    v_sub_f32 v39, v39, v18
    v_exp_f32 v24, v24
    v_exp_f32 v25, v25
    v_exp_f32 v26, v26
    v_exp_f32 v27, v27
    v_exp_f32 v28, v28
    v_exp_f32 v29, v29
    v_exp_f32 v30, v30
    v_exp_f32 v31, v31
    v_exp_f32 v32, v32
    v_exp_f32 v33, v33
    v_exp_f32 v34, v34
    v_exp_f32 v35, v35
    v_exp_f32 v36, v36
    v_exp_f32 v37, v37
    v_exp_f32 v38, v38
    v_exp_f32 v39, v39
    ds_write_b32 v2, v18 offset:160
    v_add_f32 v19, v24, v25
    v_add_f32 v19, v19, v26
    v_add_f32 v19, v19, v27
    v_add_f32 v19, v19, v28
    v_add_f32 v19, v19, v29
    v_add_f32 v19, v19, v30
    v_add_f32 v19, v19, v31
    v_add_f32 v19, v19, v32
    v_add_f32 v19, v19, v33
    v_add_f32 v19, v19, v34
    v_add_f32 v19, v19, v35
    v_add_f32 v19, v19, v36
    v_add_f32 v19, v19, v37
    v_add_f32 v19, v19, v38
    v_add_f32 v19, v19, v39
    s_nop 1
    v_add_f32_dpp v19, v19, v19 row_ror:8 row_mask:0xf bank_mask:0xf
    s_nop 1
    v_add_f32_dpp v19, v19, v19 row_ror:4 row_mask:0xf bank_mask:0xf
    s_nop 1
    v_add_f32_dpp v19, v19, v19 row_ror:2 row_mask:0xf bank_mask:0xf
    s_nop 1
    v_add_f32_dpp v19, v19, v19 row_ror:1 row_mask:0xf bank_mask:0xf
    v_mov_b32 v3, v19
    s_nop 1
    v_permlane32_swap_b32 v19, v3
    s_nop 1
    v_add_f32 v19, v19, v3
    v_mov_b32 v3, v19
    s_nop 1
    v_permlane16_swap_b32 v19, v3
    s_nop 1
    v_add_f32 v19, v19, v3
    s_lshl_b32 s80, s2, 11
    s_add_u32 s80, s80, 18874368
    s_waitcnt lgkmcnt(0)
    s_mov_b64 exec, -1
L_tg:
    buffer_load_dword v3, v2, s[60:63], 0 offen sc0 sc1
    s_waitcnt vmcnt(0)
    v_readfirstlane_b32 s69, v3
    s_cmp_eq_u32 s69, 0
    s_cbranch_scc1 L_tg
    s_getreg_b32 s81, hwreg(HW_REG_XCC_ID)
    s_and_b32 s81, s81, 15
    v_mov_b32 v16, s81
    v_mov_b32 v17, s69
    s_lshl_b32 s80, s2, 11
    s_mov_b64 exec, 1
    s_lshl_b32 s82, s2, 4
    s_add_u32 s82, s82, 1572864
    buffer_store_dwordx4 v[16:19], v2, s[52:55], s82 offen sc0 sc1
    v_mov_b32 v12, s69
    v_mov_b32 v13, s69
    s_add_u32 s82, s80, 2097152
    buffer_store_dwordx2 v[12:13], v2, s[52:55], s82 offen offset:1024
    s_add_u32 s82, s80, 2621440
    buffer_store_dwordx2 v[12:13], v2, s[52:55], s82 offen offset:1024
    s_mov_b64 exec, -1
    s_mov_b32 s73, s81
    s_lshl_b32 s80, s79, 2
    s_lshr_b32 s74, 0x54465464, s80
    s_and_b32 s74, s74, 15
    s_mov_b32 s75, 0
    s_mov_b32 s95, s69
    s_lshl_b32 s77, s2, 11
    s_lshl_b32 s94, s79, 16
    s_mov_b32 s76, 2097152
    v_mov_b32 v19, 0
    v_lshlrev_b32 v20, 11, v0
    v_mov_b32 v21, v4
L_fl:
    ds_read_b32 v3, v19
    s_waitcnt lgkmcnt(0)
    v_readfirstlane_b32 s80, v3
    s_cmp_eq_u32 s80, 0
    s_cbranch_scc1 L_fl
    ds_read_b128 v[24:27], v21 offset:20480
    ds_read_b128 v[28:31], v21 offset:21504
    ds_read_b128 v[32:35], v21 offset:22528
    ds_read_b128 v[36:39], v21 offset:23552
    s_waitcnt lgkmcnt(0)
    s_nop 0
    v_add_f32_dpp v37, v37, v37 row_ror:8 row_mask:0xf bank_mask:0xf
    v_add_f32_dpp v38, v38, v38 row_ror:8 row_mask:0xf bank_mask:0xf
    s_nop 0
    v_add_f32_dpp v37, v37, v37 row_ror:4 row_mask:0xf bank_mask:0xf
    v_add_f32_dpp v38, v38, v38 row_ror:4 row_mask:0xf bank_mask:0xf
    s_nop 0
    v_add_f32_dpp v37, v37, v37 row_ror:2 row_mask:0xf bank_mask:0xf
    v_add_f32_dpp v38, v38, v38 row_ror:2 row_mask:0xf bank_mask:0xf
    s_nop 0
    v_add_f32_dpp v37, v37, v37 row_ror:1 row_mask:0xf bank_mask:0xf
    v_add_f32_dpp v38, v38, v38 row_ror:1 row_mask:0xf bank_mask:0xf
    v_mov_b32 v40, v36
    v_mov_b32 v41, v36
    s_nop 1
    v_permlane32_swap_b32 v40, v41
    s_nop 1
    v_max_f32 v40, v40, v41
    v_mov_b32 v41, v40
    s_nop 1
    v_permlane16_swap_b32 v40, v41
    s_nop 1
    v_max_f32 v40, v40, v41
    v_sub_f32 v41, v36, v40
    v_exp_f32 v41, v41
    v_mov_b32 v48, v40
    v_mul_f32 v37, v37, v41
    v_mul_f32 v38, v38, v41
    v_mul_f32 v41, 0x58000000, v41
    v_fma_f32 v24, v24, v41, -v38
    v_fma_f32 v25, v25, v41, -v38
    v_fma_f32 v26, v26, v41, -v38
    v_fma_f32 v27, v27, v41, -v38
    v_fma_f32 v28, v28, v41, -v38
    v_fma_f32 v29, v29, v41, -v38
    v_fma_f32 v30, v30, v41, -v38
    v_fma_f32 v31, v31, v41, -v38
    v_fma_f32 v32, v32, v41, -v38
    v_fma_f32 v33, v33, v41, -v38
    v_fma_f32 v34, v34, v41, -v38
    v_fma_f32 v35, v35, v41, -v38
    v_mov_b32 v40, v37
    s_nop 1
    v_permlane32_swap_b32 v37, v40
    v_permlane32_swap_b32 v24, v26
    v_permlane32_swap_b32 v25, v27
    v_permlane32_swap_b32 v28, v30
    v_permlane32_swap_b32 v29, v31
    v_permlane32_swap_b32 v32, v34
    v_permlane32_swap_b32 v33, v35
    s_nop 1
    v_add_f32 v37, v37, v40
    v_add_f32 v24, v24, v26
    v_add_f32 v25, v25, v27
    v_add_f32 v28, v28, v30
    v_add_f32 v29, v29, v31
    v_add_f32 v32, v32, v34
    v_add_f32 v33, v33, v35
    v_mov_b32 v40, v37
    s_nop 1
    v_permlane16_swap_b32 v37, v40
    v_permlane16_swap_b32 v24, v25
    v_permlane16_swap_b32 v28, v29
    v_permlane16_swap_b32 v32, v33
    s_nop 1
    v_add_f32 v49, v37, v40
    v_add_f32 v44, v24, v25
    v_add_f32 v45, v28, v29
    v_add_f32 v46, v32, v33
    v_mov_b32 v8, v44
    v_mov_b32 v9, v45
    v_mov_b32 v10, v46
    v_cndmask_b32 v11, v48, v49, s[66:67]
    s_cmp_eq_u32 s75, 1
    s_cbranch_scc1 L_dep
    s_cmp_lg_u32 s75, 0
    s_cbranch_scc1 L_guard
    s_lshr_b32 s82, s3, 5
    s_lshl_b32 s83, s79, 9
    s_add_u32 s83, s83, 1572864
    s_bfm_b64 exec, 32, 0
L_reg:
    buffer_load_dwordx2 v[12:13], v4, s[52:55], s83 offen sc0 sc1
    s_waitcnt vmcnt(0)
    v_cmp_ne_u32 vcc, s69, v13
    s_branch L_x2
L_w2:
    s_branch L_walked
L_x2:
    s_cmp_lg_u64 vcc, 0
    s_cbranch_scc1 L_reg
    v_cmp_eq_u32 s[86:87], s73, v12
    s_nop 1
    v_mov_b32 v14, s86
    v_mov_b32 v15, s87
    ds_write_b64 v2, v[14:15] offset:152
    s_waitcnt lgkmcnt(0)
    ds_write_b32 v2, v13 offset:140
    s_mov_b64 exec, -1
    s_branch L_dep
L_guard:
    s_sub_u32 s80, s95, 1
    s_add_u32 s81, s94, s76
L_guard2:
    v_mov_b32 v12, s69
    s_mov_b64 exec, s[86:87]
    buffer_load_dword v12, v20, s[52:55], s81 offen offset:1028 sc0 sc1
    s_mov_b64 exec, -1
    s_waitcnt vmcnt(0)
    v_cmp_eq_u32 vcc, s80, v12
    s_cmp_eq_u64 vcc, 0
    s_cbranch_scc1 L_guard2
L_dep:
    s_add_u32 s75, s75, 1
    s_add_u32 s95, s95, 1
    s_add_u32 s80, s77, s76
    v_mov_b32 v3, s95
    s_waitcnt lgkmcnt(0)
    buffer_store_dwordx4 v[8:11], v4, s[52:55], s80 offen
    s_mov_b64 exec, 1
    s_waitcnt vmcnt(0)
    buffer_store_dword v3, v2, s[52:55], s80 offen offset:1024
    s_mov_b64 exec, -1
    s_xor_b32 s76, s76, 0x80000
    v_add_u32 v21, 4096, v21
    v_add_u32 v19, 4, v19
    s_cmp_lt_u32 s75, s74
    s_cbranch_scc1 L_fl
    s_endpgm
L_ctl:
    s_memtime s[48:49]
    s_memrealtime s[50:51]
    s_mov_b32 s56, 8
    s_mov_b32 s57, -1
    s_mov_b32 s58, 0
    s_mov_b32 s59, 0x210
    v_lshlrev_b32 v1, 2, v0
    v_mov_b32 v2, 0
    ds_write_b32 v1, v2 offset:3328
    s_and_b32 s70, s2, 31
    s_lshl_b32 s70, s70, 2
    s_mov_b32 s71, 1
    v_mov_b32 v7, s2
    v_and_b32 v10, 15, v0
    v_lshrrev_b32 v8, 5, v7
    v_lshl_add_u32 v10, v8, 4, v10
    v_lshrrev_b32 v9, 4, v0
    v_lshl_add_u32 v10, v9, 7, v10
    s_lshl_b32 s82, s79, 3
    s_mov_b32 s80, 0xeff4fa00
    s_mov_b32 s81, 0xdbe0e5ea
    s_lshr_b64 s[80:81], s[80:81], s82
    s_sext_i32_i8 s80, s80
    s_mov_b32 exec_lo, 0x0
    s_mov_b32 exec_hi, 0x3ff
    v_add_u32 v10, s80, v10
    s_mov_b32 s80, 0xeff43d4c
    s_mov_b32 s81, 0xdbe0e5ea
    s_lshr_b64 s[80:81], s[80:81], s82
    s_sext_i32_i8 s80, s80
    s_mov_b32 exec_lo, 0x0
    s_mov_b32 exec_hi, 0x400
    v_add_u32 v10, s80, v10
    s_mov_b32 s80, 0x2c37424d
    s_mov_b32 s81, 0xb1621
    s_lshr_b64 s[80:81], s[80:81], s82
    s_sext_i32_i8 s80, s80
    s_mov_b32 exec_lo, 0x0
    s_mov_b32 exec_hi, 0xf800
    v_add_u32 v10, s80, v10
    s_mov_b64 exec, -1
    v_mul_u32_u24 v30, 1572864, v10
    v_and_b32 v9, 3, v7
    v_lshl_add_u32 v8, v10, 2, v9
    v_bfe_u32 v9, v7, 2, 3
    v_lshl_add_u32 v8, v8, 3, v9
    v_mul_u32_u24 v9, 384, v8
    v_lshlrev_b32 v8, 7, v8
    s_waitcnt lgkmcnt(0)
    s_mov_b32 s32, s10
    s_and_b32 s33, s11, 0xffff
    s_mov_b32 s34, 6291456
    s_mov_b32 s35, 0x00020000
    buffer_load_dword v10, v9, s[32:35], 0 offen offset:0
    buffer_load_dword v11, v9, s[32:35], 0 offen offset:128
    buffer_load_dword v12, v9, s[32:35], 0 offen offset:256
    s_mov_b32 s36, s12
    s_and_b32 s37, s13, 0xffff
    s_mov_b32 s38, 6291456
    s_mov_b32 s39, 0x00020000
    buffer_load_dword v13, v9, s[36:39], 0 offen offset:0
    buffer_load_dword v14, v9, s[36:39], 0 offen offset:128
    buffer_load_dword v15, v9, s[36:39], 0 offen offset:256
    s_mov_b32 s40, s14
    s_and_b32 s41, s15, 0xffff
    s_mov_b32 s42, 2097152
    s_mov_b32 s43, 0x00020000
    buffer_load_dword v16, v8, s[40:43], 0 offen offset:0
    s_mov_b32 s44, s16
    s_and_b32 s45, s17, 0xffff
    s_mov_b32 s46, 2097152
    s_mov_b32 s47, 0x00020000
    buffer_load_dword v17, v8, s[44:47], 0 offen offset:0
    s_mov_b32 s52, s22
    s_and_b32 s53, s23, 0xffff
    s_mov_b32 s54, 25165824
    s_mov_b32 s55, 0x00020000
    v_lshlrev_b32 v7, 7, v0
    s_lshl_b32 s80, s2, 11
    s_add_u32 s81, s80, 2097152
    s_add_u32 s82, s80, 2621440
    s_mov_b64 exec, 0x1ff
    buffer_load_dword v18, v7, s[52:55], s81 offen
    buffer_load_dword v19, v7, s[52:55], s82 offen
    s_mov_b64 exec, -1
    s_barrier
    s_mov_b32 s60, s20
    s_and_b32 s61, s21, 0xffff
    s_mov_b32 s62, 256
    s_mov_b32 s63, 0x00020000
    s_mov_b32 s52, s22
    s_and_b32 s53, s23, 0xffff
    s_mov_b32 s54, 25165824
    s_mov_b32 s55, 0x00020000
    s_getreg_b32 s76, hwreg(HW_REG_XCC_ID)
    s_and_b32 s76, s76, 15
    s_lshr_b32 s70, s70, 1
    s_and_b32 s75, s2, 31
    s_cmp_eq_u32 s75, 0
    s_cselect_b32 s75, 32, s75
    s_mul_i32 s77, s75, 32
    s_mul_i32 s83, s75, 16
    s_add_u32 s83, s83, 768
    s_min_u32 s77, s77, s83
    v_lshlrev_b32 v1, 1, v0
    v_lshlrev_b32 v7, 7, v0
    s_mov_b32 s24, s6
    s_and_b32 s25, s7, 0xffff
    s_mov_b32 s26, 805306368
    s_mov_b32 s27, 0x00020000
    s_mov_b32 s28, s8
    s_and_b32 s29, s9, 0xffff
    s_mov_b32 s30, 805306368
    s_mov_b32 s31, 0x00020000
    s_and_b32 s88, s2, 31
    s_lshl_b32 s89, s88, 4
    s_sub_i32 s89, s89, 63
    s_mov_b32 s90, 1572800
L_c:
    ds_read_b32 v3, v2 offset:3328
    ds_read_b32 v4, v2 offset:144
    s_mov_b64 exec, 1
    s_waitcnt lgkmcnt(0)
    v_add_u32 v3, 1, v3
    buffer_store_short v3, v2, s[60:63], s70 offen offset:128
    s_bfm_b64 exec, 33, 0
    buffer_load_ushort v5, v1, s[60:63], 0 offen offset:128 sc1
    v_readfirstlane_b32 s72, v3
    v_readfirstlane_b32 s81, v4
    s_add_u32 s80, s71, s72
    s_mov_b32 s71, s72
    s_mov_b64 exec, 0xffffffff
    s_waitcnt vmcnt(0)
    v_cmp_ne_u32 vcc, 0, v5
    v_lshlrev_b32 v6, 1, v5
    v_readlane_b32 s86, v5, 32
    v_cmp_le_u32 s[82:83], s80, v6
    s_bcnt1_i32_b64 s73, vcc
    s_cmp_eq_u32 s86, 0
    s_cselect_b32 s86, 1024, s86
    s_bcnt1_i32_b64 s74, s[82:83]
    s_sub_i32 s86, s86, 1004
    s_cmp_ge_u32 s72, 1024
    s_cselect_b32 s80, 1, 0
    s_add_i32 s86, s86, s80
    s_cmp_ge_u32 s72, 1024
    s_cselect_b32 s80, s58, s57
    s_add_i32 s86, s86, s80
    s_mul_i32 s80, s73, s86
    s_lshl_b32 s74, s74, 5
    s_cmp_lt_i32 s74, s80
    s_cselect_b32 s86, 1, 0
    s_lshl_b32 s82, s73, 5
    s_add_u32 s74, s74, s82
    s_cmp_lt_i32 s74, s80
    s_cselect_b32 s86, 2, s86
    s_cmp_ge_u32 s72, 1024
    s_cselect_b32 s80, s59, 0x210
    s_lshl_b32 s86, s86, 2
    s_lshr_b32 s86, s80, s86
    s_and_b32 s86, s86, 15
    v_mov_b32 v6, s86
    ds_write_b32 v2, v6 offset:148
    s_cmp_lt_u32 s72, s56
    s_cbranch_scc1 L_nad
    s_memtime s[64:65]
    s_memrealtime s[66:67]
    s_add_u32 s56, s56, 128
    s_waitcnt lgkmcnt(0)
    s_sub_u32 s68, s64, s48
    s_sub_u32 s69, s66, s50
    s_mov_b32 s48, s64
    s_mov_b32 s50, s66
    v_cvt_f32_u32 v25, s69
    v_cvt_f32_u32 v24, s68
    v_rcp_f32 v25, v25
    s_nop 1
    v_mul_f32 v24, v24, v25
    v_add_f32 v25, 0xc1b66666, v24
    v_readfirstlane_b32 s68, v24
    v_mul_f32 v25, 0x40400000, v25
    v_rndne_f32 v25, v25
    v_cvt_i32_f32 v25, v25
    s_cmp_ge_u32 s68, 0x41b4cccd
    s_mov_b32 s69, 0x41ac0000
    s_cselect_b32 s69, 0x41ba6666, s69
    s_mov_b32 s59, 0x310
    s_cselect_b32 s59, 0x320, s59
    v_readfirstlane_b32 s57, v25
    v_subrev_f32 v24, s69, v24
    v_mul_f32 v24, 0x00000000, v24
    v_rndne_f32 v24, v24
    v_cvt_i32_f32 v24, v24
    s_max_i32 s57, s57, -9
    s_min_i32 s57, s57, 2
    v_readfirstlane_b32 s58, v24
    s_max_i32 s58, s58, 0
    s_min_i32 s58, s58, 0
L_nad:
    s_cmp_lt_i32 s72, s89
    s_cbranch_scc1 L_ntp
    v_readlane_b32 s87, v30, s88
    s_min_u32 s87, s87, 803733504
    s_cmp_ge_u32 s88, 64
    s_cbranch_scc1 L_tpv
    s_load_dword s90, s[6:7], s87
    s_add_u32 s87, s87, 1572800
    s_load_dword s91, s[6:7], s87
    s_branch L_tpd
L_tpv:
    s_load_dword s90, s[8:9], s87
    s_add_u32 s87, s87, 1572800
    s_load_dword s91, s[8:9], s87
L_tpd:
    s_add_u32 s88, s88, 32
    s_add_i32 s89, s89, 512
    s_cmp_ge_u32 s88, 128
    s_cselect_b32 s89, 0x7fffffff, s89
    s_mov_b64 exec, 0xffffffff
L_ntp:
    s_cmp_lt_u32 s72, s77
    s_cbranch_scc1 L_cn
    s_memrealtime s[84:85]
    s_lshl_b32 s86, s75, 11
    s_add_u32 s75, s75, 32
    s_mul_i32 s77, s75, 32
    s_mul_i32 s83, s75, 16
    s_add_u32 s83, s83, 768
    s_min_u32 s77, s77, s83
    s_cmp_lg_u32 s73, 32
    s_cbranch_scc1 L_cn
    v_add_u32_dpp v5, v5, v5 row_ror:8 row_mask:0xf bank_mask:0xf
    s_nop 1
    v_add_u32_dpp v5, v5, v5 row_ror:4 row_mask:0xf bank_mask:0xf
    s_nop 1
    v_add_u32_dpp v5, v5, v5 row_ror:2 row_mask:0xf bank_mask:0xf
    s_nop 1
    v_add_u32_dpp v5, v5, v5 row_ror:1 row_mask:0xf bank_mask:0xf
    s_nop 1
    v_readlane_b32 s74, v5, 0
    v_readlane_b32 s73, v5, 16
    s_add_u32 s86, s86, 3143680
    s_lshl_b32 s80, s76, 7
    s_add_u32 s80, s80, s86
    s_add_u32 s74, s74, s73
    s_lshl_b32 s74, s74, 2
    s_waitcnt lgkmcnt(0)
    s_mul_i32 s73, s84, 13
    s_sub_u32 s74, s74, s73
    v_mov_b32 v8, s74
    v_mov_b32 v9, s84
    s_mov_b64 exec, 1
    buffer_store_dwordx2 v[8:9], v2, s[52:55], s80 offen offset:2048 sc0 sc1
    s_load_dwordx2 s[32:33], s[22:23], s86 offset:0 glc
    s_load_dwordx2 s[34:35], s[22:23], s86 offset:128 glc
    s_load_dwordx2 s[36:37], s[22:23], s86 offset:256 glc
    s_load_dwordx2 s[38:39], s[22:23], s86 offset:384 glc
    s_load_dwordx2 s[40:41], s[22:23], s86 offset:512 glc
    s_load_dwordx2 s[42:43], s[22:23], s86 offset:640 glc
    s_load_dwordx2 s[44:45], s[22:23], s86 offset:768 glc
    s_load_dwordx2 s[46:47], s[22:23], s86 offset:896 glc
    s_mov_b64 exec, 0xffff
    v_mov_b32 v23, 0
    s_waitcnt lgkmcnt(0)
    v_writelane_b32 v22, s32, 0
    v_writelane_b32 v23, s33, 0
    v_writelane_b32 v22, s34, 1
    v_writelane_b32 v23, s35, 1
    v_writelane_b32 v22, s36, 2
    v_writelane_b32 v23, s37, 2
    v_writelane_b32 v22, s38, 3
    v_writelane_b32 v23, s39, 3
    v_writelane_b32 v22, s40, 4
    v_writelane_b32 v23, s41, 4
    v_writelane_b32 v22, s42, 5
    v_writelane_b32 v23, s43, 5
    v_writelane_b32 v22, s44, 6
    v_writelane_b32 v23, s45, 6
    v_writelane_b32 v22, s46, 7
    v_writelane_b32 v23, s47, 7
    v_sub_u32 v9, s84, v23
    v_cmp_gt_u32 vcc, 0x1000, v9
    v_sub_u32 v8, s74, v22
    s_and_b32 vcc_lo, vcc_lo, 255
    s_bitset0_b32 vcc_lo, s76
    v_cndmask_b32 v8, 0, v8, vcc
    s_nop 1
    v_add_u32_dpp v8, v8, v8 row_ror:8 row_mask:0xf bank_mask:0xf
    s_nop 1
    v_add_u32_dpp v8, v8, v8 row_ror:4 row_mask:0xf bank_mask:0xf
    s_nop 1
    v_add_u32_dpp v8, v8, v8 row_ror:2 row_mask:0xf bank_mask:0xf
    s_nop 1
    v_add_u32_dpp v8, v8, v8 row_ror:1 row_mask:0xf bank_mask:0xf
    s_nop 1
    v_ashrrev_i32 v8, 9, v8
    v_max_i32 v8, -5, v8
    v_min_i32 v8, 40, v8
    v_add_u32 v8, 0x400, v8
    s_mov_b64 exec, 1
    buffer_store_short v8, v2, s[60:63], 0 offen offset:192
L_cn:
    s_cmp_eq_u32 s81, 0
    s_cbranch_scc1 L_c
    s_endpgm
.section .rodata,"a"
.p2align 6
.amdhsa_kernel standalone__kv_cache_quant_int4_int2_kv_with_per_channel_or_per_token_scales__decode_kernel
  .amdhsa_next_free_vgpr 246
  .amdhsa_next_free_sgpr 102
  .amdhsa_accum_offset 248
  .amdhsa_float_denorm_mode_32 3
  .amdhsa_group_segment_fixed_size 0
  .amdhsa_kernarg_size 80
  .amdhsa_user_sgpr_count 2
  .amdhsa_user_sgpr_kernarg_segment_ptr 1
  .amdhsa_system_sgpr_workgroup_id_x 1
.end_amdhsa_kernel
```

```asm
; @launch grid=(256,1,1) block=(256,1,1) lds=98304
.amdgcn_target "amdgcn-amd-amdhsa--gfx950"
.text
.globl standalone__kv_cache_quant_int4_int2_kv_with_per_channel_or_per_token_scales__decode_kernel
.p2align 12
.type standalone__kv_cache_quant_int4_int2_kv_with_per_channel_or_per_token_scales__decode_kernel,@function
standalone__kv_cache_quant_int4_int2_kv_with_per_channel_or_per_token_scales__decode_kernel:
    s_cmp_ge_u32 s2, 256
    s_cbranch_scc1 L_end
    s_load_dwordx16 s[4:19], s[0:1], 0
    s_load_dwordx4 s[20:23], s[0:1], 64
    s_and_b32 s80, s2, 7
    s_lshr_b32 s2, s2, 3
    s_lshl_b32 s80, s80, 5
    s_or_b32 s2, s2, s80
    s_mov_b32 s3, s2
    v_lshrrev_b32 v229, 6, v0
    v_and_b32 v0, 63, v0
    v_readfirstlane_b32 s68, v229
    s_lshr_b32 s79, s2, 5
    s_and_b32 s92, s2, 31
    s_mov_b32 s66, 0xaaaaaaaa
    s_mov_b32 s67, 0xaaaaaaaa
    s_cmp_eq_u32 s68, 1
    s_cbranch_scc1 L_service
    s_cmp_eq_u32 s68, 2
    s_cbranch_scc1 L_ticket
    s_cmp_eq_u32 s68, 3
    s_cbranch_scc1 L_ctl
    s_mov_b64 vcc, 0
    s_setprio 1
    v_and_b32 v235, 15, v0
    v_lshrrev_b32 v234, 4, v0
    v_mul_u32_u24 v1, 768, v234
    v_lshl_add_u32 v1, v235, 4, v1
    v_lshlrev_b32 v2, 3, v235
    v_bfrev_b32 v231, v235
    v_lshrrev_b32 v231, 28, v231
    v_and_b32 v232, 3, v231
    v_lshl_add_u32 v3, v232, 2, v234
    v_lshlrev_b32 v3, 1, v3
    v_lshrrev_b32 v231, 2, v231
    v_lshl_add_u32 v3, v231, 10, v3
    v_lshlrev_b32 v239, 2, v0
    v_add_u32 v240, 3840, v239
    v_add_u32 v239, 3584, v239
    v_lshlrev_b32 v241, 4, v0
    v_mov_b32 v242, 0
    v_mov_b32 v243, 1
    v_lshlrev_b32 v224, 2, v0
    v_mov_b32 v225, 1
    v_mov_b32 v226, 260
    s_mul_i32 s58, s79, 0
    s_and_b32 s94, s92, 448
    s_add_u32 s94, s94, s58
    s_add_u32 s94, s94, 512
    s_add_u32 s58, s58, s92
    s_and_b32 s58, s58, 511
    s_lshr_b32 s59, s3, 5
    s_lshl_b32 s69, s79, 9
    s_add_u32 s59, s59, 24
    s_lshl_b32 s59, s59, 9
    s_mov_b32 s64, 0xcccccccc
    s_mov_b32 s65, 0xcccccccc
    s_mov_b32 s60, 0x6fd53b95
    s_mov_b32 s62, 0x80000001
    s_mov_b32 s61, 0x6fd53b95
    s_mov_b32 s63, 0x80000001
    s_and_b32 s80, s92, 3
    s_cmp_eq_u32 s80, 1
    s_mov_b32 s81, 0x11119143
    s_cselect_b32 s81, 0x11659143, s81
    s_cmp_eq_u32 s80, 0
    s_cselect_b32 s81, 0x80659143, s81
    s_andn2_b32 s82, s92, 3
    s_lshr_b32 s81, s81, s82
    s_and_b32 s81, s81, 15
    s_lshl_b32 m0, s81, 1
    s_lshl_b32 s80, s80, 21
    s_max_u32 s80, s80, 64
    s_sub_u32 s80, s80, 64
    s_mul_i32 s82, s79, 25165824
    s_cmp_eq_u32 s81, 1
    s_cselect_b32 s82, s82, 0
    s_add_u32 s80, s80, s82
    v_mov_b32 v236, s80
    s_waitcnt lgkmcnt(0)
    s_movrels_b64 s[84:85], s[4:5]
    global_load_dword v236, v236, s[84:85]
    s_mov_b32 s24, s6
    s_and_b32 s25, s7, 0xffff
    s_mov_b32 s26, 805306368
    s_mov_b32 s27, 0x00020000
    s_mov_b32 s48, s4
    s_and_b32 s49, s5, 0xffff
    s_mov_b32 s50, 12288
    s_mov_b32 s51, 0x00020000
    s_mov_b32 s32, s10
    s_and_b32 s33, s11, 0xffff
    s_mov_b32 s34, 6291456
    s_mov_b32 s35, 0x00020000
    s_mov_b32 s36, s12
    s_and_b32 s37, s13, 0xffff
    s_mov_b32 s38, 6291456
    s_mov_b32 s39, 0x00020000
    s_add_u32 s70, s69, s92
    s_mov_b32 s91, 1
    s_lshr_b32 s74, s70, 9
    s_mul_i32 s74, s74, 384
    buffer_load_dwordx2 v[192:193], v2, s[48:51], s74 offen offset:0
    buffer_load_dwordx2 v[194:195], v2, s[48:51], s74 offen offset:128
    buffer_load_dwordx2 v[196:197], v2, s[48:51], s74 offen offset:256
    s_and_b32 s80, s70, 31
    s_sub_u32 s72, s70, s80
    s_lshr_b32 s80, s80, 2
    s_add_u32 s72, s72, s80
    s_mul_i32 s72, s72, 384
    buffer_load_dwordx2 v[132:133], v2, s[32:35], s72 offen offset:0
    buffer_load_dwordx2 v[134:135], v2, s[32:35], s72 offen offset:128
    buffer_load_dwordx2 v[136:137], v2, s[32:35], s72 offen offset:256
    buffer_load_dwordx2 v[138:139], v2, s[36:39], s72 offen offset:0
    buffer_load_dwordx2 v[140:141], v2, s[36:39], s72 offen offset:128
    buffer_load_dwordx2 v[142:143], v2, s[36:39], s72 offen offset:256
    s_mul_i32 s71, s70, 49152
    s_and_b32 s80, s70, 31
    s_mul_i32 s80, s80, 36864
    s_sub_u32 s71, s71, s80
    buffer_load_dwordx4 v[4:7], v1, s[24:27], s71 offen offset:0 nt
    buffer_load_dwordx4 v[8:11], v1, s[24:27], s71 offen offset:256 nt
    buffer_load_dwordx4 v[12:15], v1, s[24:27], s71 offen offset:512 nt
    s_add_u32 s71, s71, 3072
    buffer_load_dwordx4 v[16:19], v1, s[24:27], s71 offen offset:0 nt
    s_add_u32 s72, s72, 3072
    buffer_load_dwordx2 v[156:157], v2, s[32:35], s72 offen offset:0
    buffer_load_dwordx2 v[158:159], v2, s[32:35], s72 offen offset:128
    buffer_load_dwordx2 v[160:161], v2, s[32:35], s72 offen offset:256
    buffer_load_dwordx2 v[162:163], v2, s[36:39], s72 offen offset:0
    buffer_load_dwordx2 v[164:165], v2, s[36:39], s72 offen offset:128
    buffer_load_dwordx2 v[166:167], v2, s[36:39], s72 offen offset:256
    buffer_load_dwordx4 v[20:23], v1, s[24:27], s71 offen offset:256 nt
    buffer_load_dwordx4 v[24:27], v1, s[24:27], s71 offen offset:512 nt
    s_add_u32 s71, s71, 3072
    buffer_load_dwordx4 v[28:31], v1, s[24:27], s71 offen offset:0 nt
    buffer_load_dwordx4 v[32:35], v1, s[24:27], s71 offen offset:256 nt
    buffer_load_dwordx4 v[36:39], v1, s[24:27], s71 offen offset:512 nt
    s_add_u32 s71, s71, 3072
    buffer_load_dwordx4 v[40:43], v1, s[24:27], s71 offen offset:0 nt
    buffer_load_dwordx4 v[44:47], v1, s[24:27], s71 offen offset:256 nt
    buffer_load_dwordx4 v[48:51], v1, s[24:27], s71 offen offset:512 nt
    s_add_u32 s71, s71, 384000
    buffer_load_dwordx4 v[52:55], v1, s[24:27], s71 offen offset:0 nt
    buffer_load_dwordx4 v[56:59], v1, s[24:27], s71 offen offset:256 nt
    buffer_load_dwordx4 v[60:63], v1, s[24:27], s71 offen offset:512 nt
    s_add_u32 s71, s71, 3072
    buffer_load_dwordx4 v[64:67], v1, s[24:27], s71 offen offset:0 nt
    s_add_u32 s72, s72, 3072
    buffer_load_dwordx2 v[168:169], v2, s[32:35], s72 offen offset:0
    buffer_load_dwordx2 v[170:171], v2, s[32:35], s72 offen offset:128
    buffer_load_dwordx2 v[172:173], v2, s[32:35], s72 offen offset:256
    buffer_load_dwordx2 v[174:175], v2, s[36:39], s72 offen offset:0
    buffer_load_dwordx2 v[176:177], v2, s[36:39], s72 offen offset:128
    buffer_load_dwordx2 v[178:179], v2, s[36:39], s72 offen offset:256
    buffer_load_dwordx4 v[68:71], v1, s[24:27], s71 offen offset:256 nt
    buffer_load_dwordx4 v[72:75], v1, s[24:27], s71 offen offset:512 nt
    s_add_u32 s71, s71, 3072
    buffer_load_dwordx4 v[76:79], v1, s[24:27], s71 offen offset:0 nt
    buffer_load_dwordx4 v[80:83], v1, s[24:27], s71 offen offset:256 nt
    buffer_load_dwordx4 v[84:87], v1, s[24:27], s71 offen offset:512 nt
    s_add_u32 s71, s71, 3072
    buffer_load_dwordx4 v[88:91], v1, s[24:27], s71 offen offset:0 nt
    buffer_load_dwordx4 v[92:95], v1, s[24:27], s71 offen offset:256 nt
    buffer_load_dwordx4 v[96:99], v1, s[24:27], s71 offen offset:512 nt
    s_mov_b32 s28, s8
    s_and_b32 s29, s9, 0xffff
    s_mov_b32 s30, 805306368
    s_mov_b32 s31, 0x00020000
    s_mov_b32 s40, s14
    s_and_b32 s41, s15, 0xffff
    s_mov_b32 s42, 2097152
    s_mov_b32 s43, 0x00020000
    s_mov_b32 s44, s16
    s_and_b32 s45, s17, 0xffff
    s_mov_b32 s46, 2097152
    s_mov_b32 s47, 0x00020000
    s_mov_b32 s52, s22
    s_and_b32 s53, s23, 0xffff
    s_mov_b32 s54, 25165824
    s_mov_b32 s55, 0x00020000
    v_mov_b32 v229, s2
    v_and_b32 v231, 15, v0
    v_lshrrev_b32 v230, 5, v229
    v_lshl_add_u32 v231, v230, 4, v231
    v_lshrrev_b32 v232, 4, v0
    v_lshl_add_u32 v231, v232, 7, v231
    s_lshl_b32 s82, s79, 3
    s_mov_b32 s80, 0xeff4fa00
    s_mov_b32 s81, 0xdbe0e5ea
    s_lshr_b64 s[80:81], s[80:81], s82
    s_sext_i32_i8 s80, s80
    s_mov_b32 exec_lo, 0x0
    s_mov_b32 exec_hi, 0x3ff
    v_add_u32 v231, s80, v231
    s_mov_b32 s80, 0xeff43d4c
    s_mov_b32 s81, 0xdbe0e5ea
    s_lshr_b64 s[80:81], s[80:81], s82
    s_sext_i32_i8 s80, s80
    s_mov_b32 exec_lo, 0x0
    s_mov_b32 exec_hi, 0x400
    v_add_u32 v231, s80, v231
    s_mov_b32 s80, 0x2c37424d
    s_mov_b32 s81, 0xb1621
    s_lshr_b64 s[80:81], s[80:81], s82
    s_sext_i32_i8 s80, s80
    s_mov_b32 exec_lo, 0x0
    s_mov_b32 exec_hi, 0xf800
    v_add_u32 v231, s80, v231
    s_mov_b64 exec, -1
    v_and_b32 v229, 31, v229
    v_lshl_add_u32 v245, v231, 5, v229
    s_mov_b32 s4, 0x10000
    s_mov_b32 s5, 0x10401
    s_cmp_eq_u32 s79, 1
    s_cselect_b32 s4, 0x10000, s4
    s_cselect_b32 s5, 0x14441, s5
    s_cmp_eq_u32 s79, 2
    s_cselect_b32 s4, 0x10000, s4
    s_cselect_b32 s5, 0x10801, s5
    s_cmp_eq_u32 s79, 3
    s_cselect_b32 s4, 0x10000, s4
    s_cselect_b32 s5, 0x10803, s5
    s_cmp_eq_u32 s79, 4
    s_cselect_b32 s4, 0x10000, s4
    s_cselect_b32 s5, 0x18841, s5
    s_cmp_eq_u32 s79, 5
    s_cselect_b32 s4, 0x10000, s4
    s_cselect_b32 s5, 0x10801, s5
    s_cmp_eq_u32 s79, 6
    s_cselect_b32 s4, 0x10000, s4
    s_cselect_b32 s5, 0x10801, s5
    s_cmp_eq_u32 s79, 7
    s_cselect_b32 s4, 0x10000, s4
    s_cselect_b32 s5, 0x10821, s5
    s_mov_b32 s7, 0xf149f2ca
    s_mov_b32 s77, 0xf149f2ca
    v_lshlrev_b32 v225, 4, v0
    v_mov_b32 v100, 0
    v_mov_b32 v101, 0
    v_mov_b32 v102, 0
    v_mov_b32 v103, 0
    s_lshl_b32 s78, s3, 11
    s_mov_b64 s[88:89], 0
    v_mov_b32 v216, 0xf149f2ca
    v_mov_b32 v217, 0
    v_mov_b32 v218, 0
    v_mov_b32 v204, 0
    v_mov_b32 v205, 0
    v_mov_b32 v206, 0
    v_mov_b32 v207, 0
    v_mov_b32 v208, 0
    v_mov_b32 v209, 0
    v_mov_b32 v210, 0
    v_mov_b32 v211, 0
    v_mov_b32 v212, 0
    v_mov_b32 v213, 0
    v_mov_b32 v214, 0
    v_mov_b32 v215, 0
    s_barrier
    s_waitcnt vmcnt(36)
    v_lshlrev_b32 v108, 16, v192
    v_and_b32 v109, 0xffff0000, v192
    v_pk_mul_f32 v[108:109], v[108:109], s[60:61]
    v_lshlrev_b32 v110, 16, v193
    v_and_b32 v111, 0xffff0000, v193
    v_pk_mul_f32 v[110:111], v[110:111], s[60:61]
    v_lshlrev_b32 v112, 16, v194
    v_and_b32 v113, 0xffff0000, v194
    v_pk_mul_f32 v[112:113], v[112:113], s[60:61]
    v_lshlrev_b32 v114, 16, v195
    v_and_b32 v115, 0xffff0000, v195
    v_pk_mul_f32 v[114:115], v[114:115], s[60:61]
    v_lshlrev_b32 v116, 16, v196
    v_and_b32 v117, 0xffff0000, v196
    v_pk_mul_f32 v[116:117], v[116:117], s[60:61]
    v_lshlrev_b32 v118, 16, v197
    v_and_b32 v119, 0xffff0000, v197
    v_pk_mul_f32 v[118:119], v[118:119], s[60:61]
    v_lshlrev_b32 v234, 16, v132
    v_and_b32 v235, 0xffff0000, v132
    v_pk_mul_f32 v[120:121], v[234:235], v[108:109]
    v_lshlrev_b32 v234, 16, v138
    v_and_b32 v235, 0xffff0000, v138
    v_pk_mul_f32 v[200:201], v[120:121], v[234:235]
    v_lshlrev_b32 v234, 16, v133
    v_and_b32 v235, 0xffff0000, v133
    v_pk_mul_f32 v[122:123], v[234:235], v[110:111]
    v_lshlrev_b32 v234, 16, v139
    v_and_b32 v235, 0xffff0000, v139
    v_pk_fma_f32 v[200:201], v[122:123], v[234:235], v[200:201]
    v_lshlrev_b32 v234, 16, v134
    v_and_b32 v235, 0xffff0000, v134
    v_pk_mul_f32 v[124:125], v[234:235], v[112:113]
    v_lshlrev_b32 v234, 16, v140
    v_and_b32 v235, 0xffff0000, v140
    v_pk_fma_f32 v[200:201], v[124:125], v[234:235], v[200:201]
    v_lshlrev_b32 v234, 16, v135
    v_and_b32 v235, 0xffff0000, v135
    v_pk_mul_f32 v[126:127], v[234:235], v[114:115]
    v_lshlrev_b32 v234, 16, v141
    v_and_b32 v235, 0xffff0000, v141
    v_pk_fma_f32 v[200:201], v[126:127], v[234:235], v[200:201]
    v_lshlrev_b32 v234, 16, v136
    v_and_b32 v235, 0xffff0000, v136
    v_pk_mul_f32 v[128:129], v[234:235], v[116:117]
    v_lshlrev_b32 v234, 16, v142
    v_and_b32 v235, 0xffff0000, v142
    v_pk_fma_f32 v[200:201], v[128:129], v[234:235], v[200:201]
    v_lshlrev_b32 v234, 16, v137
    v_and_b32 v235, 0xffff0000, v137
    v_pk_mul_f32 v[130:131], v[234:235], v[118:119]
    v_lshlrev_b32 v234, 16, v143
    v_and_b32 v235, 0xffff0000, v143
    v_pk_fma_f32 v[200:201], v[130:131], v[234:235], v[200:201]
    v_pk_mul_f32 v[200:201], v[200:201], s[62:63]
    s_mov_b32 s76, 63
L_loop0:
    s_waitcnt vmcnt(35)
    v_pk_fma_f32 v[198:199], v[120:121], v[4:5], v[200:201]
    v_pk_fma_f32 v[198:199], v[122:123], v[6:7], v[198:199]
    ds_read_b32 v244, v243 offset:147
    s_add_u32 s71, s71, 384000
    s_cbranch_vccnz L_th24_0
L_tb24_0:
    buffer_load_dwordx4 v[4:7], v1, s[24:27], s71 offen offset:0 nt
    v_add_f32_dpp v229, v228, v228 row_ror:8 row_mask:0xf bank_mask:0xc
    s_waitcnt vmcnt(35)
    v_pk_fma_f32 v[198:199], v[124:125], v[8:9], v[198:199]
    v_pk_fma_f32 v[198:199], v[126:127], v[10:11], v[198:199]
    buffer_load_dwordx4 v[8:11], v1, s[24:27], s71 offen offset:256 nt
    v_add_f32_dpp v230, v229, v229 row_shr:4 row_mask:0xf bank_mask:0xa
    s_waitcnt vmcnt(35)
    v_pk_fma_f32 v[198:199], v[128:129], v[12:13], v[198:199]
    v_pk_fma_f32 v[198:199], v[130:131], v[14:15], v[198:199]
    s_waitcnt lgkmcnt(0)
    v_cmp_lt_u32 vcc, v0, v244
    ds_add_u32 v224, v243 offset:3328
    buffer_load_dwordx4 v[12:15], v1, s[24:27], s71 offen offset:512 nt
    v_add_f32_dpp v232, v230, v230 quad_perm:[2,3,0,1] row_mask:0xf bank_mask:0xf
    v_add_f32 v228, v198, v199
    s_waitcnt vmcnt(35)
    v_pk_fma_f32 v[198:199], v[120:121], v[16:17], v[200:201]
    v_pk_fma_f32 v[198:199], v[122:123], v[18:19], v[198:199]
    s_add_u32 s71, s71, 3072
    s_cbranch_vccnz L_th27_0
L_tb27_0:
    buffer_load_dwordx4 v[16:19], v1, s[24:27], s71 offen offset:0 nt
    v_cndmask_b32 v232, v231, v232, s[64:65]
    v_add_f32_dpp v229, v228, v228 row_ror:8 row_mask:0xf bank_mask:0x3
    s_waitcnt vmcnt(29)
    v_pk_fma_f32 v[198:199], v[124:125], v[20:21], v[198:199]
    v_pk_fma_f32 v[198:199], v[126:127], v[22:23], v[198:199]
    s_add_u32 s72, s72, 3072
    buffer_load_dwordx2 v[180:181], v2, s[32:35], s72 offen offset:0
    buffer_load_dwordx2 v[182:183], v2, s[32:35], s72 offen offset:128
    buffer_load_dwordx2 v[184:185], v2, s[32:35], s72 offen offset:256
    buffer_load_dwordx2 v[186:187], v2, s[36:39], s72 offen offset:0
    buffer_load_dwordx2 v[188:189], v2, s[36:39], s72 offen offset:128
    buffer_load_dwordx2 v[190:191], v2, s[36:39], s72 offen offset:256
    buffer_load_dwordx4 v[20:23], v1, s[24:27], s71 offen offset:256 nt
    v_add_f32_dpp v231, v232, v232 quad_perm:[1,0,3,2] row_mask:0xf bank_mask:0xf
    v_lshlrev_b32 v234, 16, v156
    v_and_b32 v235, 0xffff0000, v156
    v_pk_mul_f32 v[144:145], v[234:235], v[108:109]
    v_lshlrev_b32 v234, 16, v162
    v_and_b32 v235, 0xffff0000, v162
    s_waitcnt vmcnt(35)
    v_pk_fma_f32 v[198:199], v[128:129], v[24:25], v[198:199]
    v_pk_fma_f32 v[198:199], v[130:131], v[26:27], v[198:199]
    ds_add_u32 v224, v243 offset:3328
    buffer_load_dwordx4 v[24:27], v1, s[24:27], s71 offen offset:512 nt
    v_cndmask_b32 v233, v233, v231, s[66:67]
    v_mul_f32 v233, 0x58000000, v233
    ds_write_b32 v239, v233
    v_add_u32 v239, 256, v239
    v_add_f32 v228, v198, v199
    v_pk_mul_f32 v[202:203], v[144:145], v[234:235]
    v_lshlrev_b32 v234, 16, v157
    v_and_b32 v235, 0xffff0000, v157
    v_pk_mul_f32 v[146:147], v[234:235], v[110:111]
    v_lshlrev_b32 v234, 16, v163
    s_waitcnt vmcnt(35)
    v_pk_fma_f32 v[198:199], v[120:121], v[28:29], v[200:201]
    v_pk_fma_f32 v[198:199], v[122:123], v[30:31], v[198:199]
    s_add_u32 s71, s71, 3072
    s_cbranch_vccnz L_th30_0
L_tb30_0:
    buffer_load_dwordx4 v[28:31], v1, s[24:27], s71 offen offset:0 nt
    v_add_f32_dpp v229, v228, v228 row_ror:8 row_mask:0xf bank_mask:0xc
    v_and_b32 v235, 0xffff0000, v163
    v_pk_fma_f32 v[202:203], v[146:147], v[234:235], v[202:203]
    v_lshlrev_b32 v234, 16, v158
    v_and_b32 v235, 0xffff0000, v158
    v_pk_mul_f32 v[148:149], v[234:235], v[112:113]
    s_waitcnt vmcnt(35)
    v_pk_fma_f32 v[198:199], v[124:125], v[32:33], v[198:199]
    v_pk_fma_f32 v[198:199], v[126:127], v[34:35], v[198:199]
    buffer_load_dwordx4 v[32:35], v1, s[24:27], s71 offen offset:256 nt
    v_add_f32_dpp v230, v229, v229 row_shl:4 row_mask:0xf bank_mask:0x5
    v_lshlrev_b32 v234, 16, v164
    v_and_b32 v235, 0xffff0000, v164
    v_pk_fma_f32 v[202:203], v[148:149], v[234:235], v[202:203]
    v_lshlrev_b32 v234, 16, v159
    v_and_b32 v235, 0xffff0000, v159
    s_waitcnt vmcnt(35)
    v_pk_fma_f32 v[198:199], v[128:129], v[36:37], v[198:199]
    v_pk_fma_f32 v[198:199], v[130:131], v[38:39], v[198:199]
    ds_add_u32 v224, v243 offset:3328
    buffer_load_dwordx4 v[36:39], v1, s[24:27], s71 offen offset:512 nt
    v_add_f32 v228, v198, v199
    v_pk_mul_f32 v[150:151], v[234:235], v[114:115]
    v_lshlrev_b32 v234, 16, v165
    v_and_b32 v235, 0xffff0000, v165
    v_pk_fma_f32 v[202:203], v[150:151], v[234:235], v[202:203]
    v_lshlrev_b32 v234, 16, v160
    s_waitcnt vmcnt(35)
    v_pk_fma_f32 v[198:199], v[120:121], v[40:41], v[200:201]
    v_pk_fma_f32 v[198:199], v[122:123], v[42:43], v[198:199]
    s_add_u32 s71, s71, 3072
    s_cbranch_vccnz L_th33_0
L_tb33_0:
    buffer_load_dwordx4 v[40:43], v1, s[24:27], s71 offen offset:0 nt
    v_add_f32_dpp v229, v228, v228 row_ror:8 row_mask:0xf bank_mask:0x3
    v_and_b32 v235, 0xffff0000, v160
    v_pk_mul_f32 v[152:153], v[234:235], v[116:117]
    v_lshlrev_b32 v234, 16, v166
    v_and_b32 v235, 0xffff0000, v166
    v_pk_fma_f32 v[202:203], v[152:153], v[234:235], v[202:203]
    s_waitcnt vmcnt(35)
    v_pk_fma_f32 v[198:199], v[124:125], v[44:45], v[198:199]
    v_pk_fma_f32 v[198:199], v[126:127], v[46:47], v[198:199]
    buffer_load_dwordx4 v[44:47], v1, s[24:27], s71 offen offset:256 nt
    v_lshlrev_b32 v234, 16, v161
    v_and_b32 v235, 0xffff0000, v161
    v_pk_mul_f32 v[154:155], v[234:235], v[118:119]
    v_lshlrev_b32 v234, 16, v167
    v_and_b32 v235, 0xffff0000, v167
    s_waitcnt vmcnt(35)
    v_pk_fma_f32 v[198:199], v[128:129], v[48:49], v[198:199]
    v_pk_fma_f32 v[198:199], v[130:131], v[50:51], v[198:199]
    ds_add_u32 v224, v243 offset:3328
    buffer_load_dwordx4 v[48:51], v1, s[24:27], s71 offen offset:512 nt
    v_add_f32 v228, v198, v199
    v_pk_fma_f32 v[202:203], v[154:155], v[234:235], v[202:203]
    v_pk_mul_f32 v[202:203], v[202:203], s[62:63]
    s_waitcnt vmcnt(35)
    v_pk_fma_f32 v[198:199], v[144:145], v[52:53], v[202:203]
    v_pk_fma_f32 v[198:199], v[146:147], v[54:55], v[198:199]
    ds_read_b32 v244, v243 offset:147
    v_readlane_b32 s70, v245, s91
    s_add_u32 s91, s91, 1
    s_lshr_b32 s74, s70, 9
    s_mul_i32 s74, s74, 384
    buffer_load_dwordx2 v[192:193], v2, s[48:51], s74 offen offset:0
    buffer_load_dwordx2 v[194:195], v2, s[48:51], s74 offen offset:128
    buffer_load_dwordx2 v[196:197], v2, s[48:51], s74 offen offset:256
    s_add_u32 s71, s71, 384000
    s_cbranch_vccnz L_th36_0
L_tb36_0:
    buffer_load_dwordx4 v[52:55], v1, s[24:27], s71 offen offset:0 nt
    v_add_f32_dpp v229, v228, v228 row_ror:8 row_mask:0xf bank_mask:0xc
    s_waitcnt vmcnt(38)
    v_pk_fma_f32 v[198:199], v[148:149], v[56:57], v[198:199]
    v_pk_fma_f32 v[198:199], v[150:151], v[58:59], v[198:199]
    buffer_load_dwordx4 v[56:59], v1, s[24:27], s71 offen offset:256 nt
    v_add_f32_dpp v230, v229, v229 row_shr:4 row_mask:0xf bank_mask:0xa
    s_waitcnt vmcnt(38)
    v_pk_fma_f32 v[198:199], v[152:153], v[60:61], v[198:199]
    v_pk_fma_f32 v[198:199], v[154:155], v[62:63], v[198:199]
    s_waitcnt lgkmcnt(0)
    v_cmp_lt_u32 vcc, v0, v244
    ds_add_u32 v224, v243 offset:3328
    buffer_load_dwordx4 v[60:63], v1, s[24:27], s71 offen offset:512 nt
    v_add_f32_dpp v231, v230, v230 quad_perm:[2,3,0,1] row_mask:0xf bank_mask:0xf
    v_add_f32 v228, v198, v199
    s_waitcnt vmcnt(38)
    v_pk_fma_f32 v[198:199], v[144:145], v[64:65], v[202:203]
    v_pk_fma_f32 v[198:199], v[146:147], v[66:67], v[198:199]
    s_add_u32 s71, s71, 3072
    s_cbranch_vccnz L_th39_0
L_tb39_0:
    buffer_load_dwordx4 v[64:67], v1, s[24:27], s71 offen offset:0 nt
    v_add_f32_dpp v229, v228, v228 row_ror:8 row_mask:0xf bank_mask:0x3
    s_waitcnt vmcnt(32)
    v_pk_fma_f32 v[198:199], v[148:149], v[68:69], v[198:199]
    v_pk_fma_f32 v[198:199], v[150:151], v[70:71], v[198:199]
    s_and_b32 s80, s70, 31
    s_sub_u32 s72, s70, s80
    s_lshr_b32 s80, s80, 2
    s_add_u32 s72, s72, s80
    s_mul_i32 s72, s72, 384
    buffer_load_dwordx2 v[132:133], v2, s[32:35], s72 offen offset:0
    buffer_load_dwordx2 v[134:135], v2, s[32:35], s72 offen offset:128
    buffer_load_dwordx2 v[136:137], v2, s[32:35], s72 offen offset:256
    buffer_load_dwordx2 v[138:139], v2, s[36:39], s72 offen offset:0
    buffer_load_dwordx2 v[140:141], v2, s[36:39], s72 offen offset:128
    buffer_load_dwordx2 v[142:143], v2, s[36:39], s72 offen offset:256
    buffer_load_dwordx4 v[68:71], v1, s[24:27], s71 offen offset:256 nt
    v_lshlrev_b32 v234, 16, v168
    v_and_b32 v235, 0xffff0000, v168
    v_pk_mul_f32 v[120:121], v[234:235], v[108:109]
    v_lshlrev_b32 v234, 16, v174
    v_and_b32 v235, 0xffff0000, v174
    s_waitcnt vmcnt(38)
    v_pk_fma_f32 v[198:199], v[152:153], v[72:73], v[198:199]
    v_pk_fma_f32 v[198:199], v[154:155], v[74:75], v[198:199]
    ds_add_u32 v224, v243 offset:3328
    buffer_load_dwordx4 v[72:75], v1, s[24:27], s71 offen offset:512 nt
    v_add_f32 v228, v198, v199
    v_pk_mul_f32 v[200:201], v[120:121], v[234:235]
    v_lshlrev_b32 v234, 16, v169
    v_and_b32 v235, 0xffff0000, v169
    v_pk_mul_f32 v[122:123], v[234:235], v[110:111]
    v_lshlrev_b32 v234, 16, v175
    s_waitcnt vmcnt(38)
    v_pk_fma_f32 v[198:199], v[144:145], v[76:77], v[202:203]
    v_pk_fma_f32 v[198:199], v[146:147], v[78:79], v[198:199]
    s_add_u32 s71, s71, 3072
    s_cbranch_vccnz L_th42_0
L_tb42_0:
    buffer_load_dwordx4 v[76:79], v1, s[24:27], s71 offen offset:0 nt
    v_add_f32_dpp v229, v228, v228 row_ror:8 row_mask:0xf bank_mask:0xc
    v_and_b32 v235, 0xffff0000, v175
    v_pk_fma_f32 v[200:201], v[122:123], v[234:235], v[200:201]
    v_lshlrev_b32 v234, 16, v170
    v_and_b32 v235, 0xffff0000, v170
    v_pk_mul_f32 v[124:125], v[234:235], v[112:113]
    s_waitcnt vmcnt(38)
    v_pk_fma_f32 v[198:199], v[148:149], v[80:81], v[198:199]
    v_pk_fma_f32 v[198:199], v[150:151], v[82:83], v[198:199]
    buffer_load_dwordx4 v[80:83], v1, s[24:27], s71 offen offset:256 nt
    v_add_f32_dpp v230, v229, v229 row_shl:4 row_mask:0xf bank_mask:0x5
    v_lshlrev_b32 v234, 16, v176
    v_and_b32 v235, 0xffff0000, v176
    v_pk_fma_f32 v[200:201], v[124:125], v[234:235], v[200:201]
    v_lshlrev_b32 v234, 16, v171
    v_and_b32 v235, 0xffff0000, v171
    s_waitcnt vmcnt(38)
    v_pk_fma_f32 v[198:199], v[152:153], v[84:85], v[198:199]
    v_pk_fma_f32 v[198:199], v[154:155], v[86:87], v[198:199]
    ds_add_u32 v224, v243 offset:3328
    buffer_load_dwordx4 v[84:87], v1, s[24:27], s71 offen offset:512 nt
    v_add_f32 v228, v198, v199
    v_pk_mul_f32 v[126:127], v[234:235], v[114:115]
    v_lshlrev_b32 v234, 16, v177
    v_and_b32 v235, 0xffff0000, v177
    v_pk_fma_f32 v[200:201], v[126:127], v[234:235], v[200:201]
    v_lshlrev_b32 v234, 16, v172
    s_waitcnt vmcnt(38)
    v_pk_fma_f32 v[198:199], v[144:145], v[88:89], v[202:203]
    v_pk_fma_f32 v[198:199], v[146:147], v[90:91], v[198:199]
    s_add_u32 s71, s71, 3072
    s_cbranch_vccnz L_th45_0
L_tb45_0:
    buffer_load_dwordx4 v[88:91], v1, s[24:27], s71 offen offset:0 nt
    v_add_f32_dpp v229, v228, v228 row_ror:8 row_mask:0xf bank_mask:0x3
    v_and_b32 v235, 0xffff0000, v172
    v_pk_mul_f32 v[128:129], v[234:235], v[116:117]
    v_lshlrev_b32 v234, 16, v178
    v_and_b32 v235, 0xffff0000, v178
    v_pk_fma_f32 v[200:201], v[128:129], v[234:235], v[200:201]
    s_waitcnt vmcnt(38)
    v_pk_fma_f32 v[198:199], v[148:149], v[92:93], v[198:199]
    v_pk_fma_f32 v[198:199], v[150:151], v[94:95], v[198:199]
    buffer_load_dwordx4 v[92:95], v1, s[24:27], s71 offen offset:256 nt
    v_lshlrev_b32 v234, 16, v173
    v_and_b32 v235, 0xffff0000, v173
    v_pk_mul_f32 v[130:131], v[234:235], v[118:119]
    v_lshlrev_b32 v234, 16, v179
    v_and_b32 v235, 0xffff0000, v179
    s_waitcnt vmcnt(38)
    v_pk_fma_f32 v[198:199], v[152:153], v[96:97], v[198:199]
    v_pk_fma_f32 v[198:199], v[154:155], v[98:99], v[198:199]
    ds_add_u32 v224, v243 offset:3328
    buffer_load_dwordx4 v[96:99], v1, s[24:27], s71 offen offset:512 nt
    v_add_f32 v228, v198, v199
    v_pk_fma_f32 v[200:201], v[130:131], v[234:235], v[200:201]
    v_pk_mul_f32 v[200:201], v[200:201], s[62:63]
    s_waitcnt vmcnt(38)
    v_pk_fma_f32 v[198:199], v[120:121], v[4:5], v[200:201]
    v_pk_fma_f32 v[198:199], v[122:123], v[6:7], v[198:199]
    ds_read_b32 v244, v243 offset:147
    s_mul_i32 s71, s70, 49152
    s_and_b32 s80, s70, 31
    s_mul_i32 s80, s80, 36864
    s_sub_u32 s71, s71, s80
    s_cbranch_vccnz L_th0_0
L_tb0_0:
    buffer_load_dwordx4 v[4:7], v1, s[24:27], s71 offen offset:0 nt
    v_add_f32_dpp v229, v228, v228 row_ror:8 row_mask:0xf bank_mask:0xc
    s_waitcnt vmcnt(38)
    v_pk_fma_f32 v[198:199], v[124:125], v[8:9], v[198:199]
    v_pk_fma_f32 v[198:199], v[126:127], v[10:11], v[198:199]
    buffer_load_dwordx4 v[8:11], v1, s[24:27], s71 offen offset:256 nt
    v_add_f32_dpp v230, v229, v229 row_shr:4 row_mask:0xf bank_mask:0xa
    s_waitcnt vmcnt(38)
    v_pk_fma_f32 v[198:199], v[128:129], v[12:13], v[198:199]
    v_pk_fma_f32 v[198:199], v[130:131], v[14:15], v[198:199]
    s_waitcnt lgkmcnt(0)
    v_cmp_lt_u32 vcc, v0, v244
    ds_add_u32 v224, v243 offset:3328
    buffer_load_dwordx4 v[12:15], v1, s[24:27], s71 offen offset:512 nt
    v_add_f32_dpp v232, v230, v230 quad_perm:[2,3,0,1] row_mask:0xf bank_mask:0xf
    v_add_f32 v228, v198, v199
    s_waitcnt vmcnt(38)
    v_pk_fma_f32 v[198:199], v[120:121], v[16:17], v[200:201]
    v_pk_fma_f32 v[198:199], v[122:123], v[18:19], v[198:199]
    s_add_u32 s71, s71, 3072
    s_cbranch_vccnz L_th3_0
L_tb3_0:
    buffer_load_dwordx4 v[16:19], v1, s[24:27], s71 offen offset:0 nt
    v_cndmask_b32 v232, v231, v232, s[64:65]
    v_add_f32_dpp v229, v228, v228 row_ror:8 row_mask:0xf bank_mask:0x3
    s_waitcnt vmcnt(32)
    v_pk_fma_f32 v[198:199], v[124:125], v[20:21], v[198:199]
    v_pk_fma_f32 v[198:199], v[126:127], v[22:23], v[198:199]
    s_add_u32 s72, s72, 3072
    buffer_load_dwordx2 v[156:157], v2, s[32:35], s72 offen offset:0
    buffer_load_dwordx2 v[158:159], v2, s[32:35], s72 offen offset:128
    buffer_load_dwordx2 v[160:161], v2, s[32:35], s72 offen offset:256
    buffer_load_dwordx2 v[162:163], v2, s[36:39], s72 offen offset:0
    buffer_load_dwordx2 v[164:165], v2, s[36:39], s72 offen offset:128
    buffer_load_dwordx2 v[166:167], v2, s[36:39], s72 offen offset:256
    buffer_load_dwordx4 v[20:23], v1, s[24:27], s71 offen offset:256 nt
    v_add_f32_dpp v233, v232, v232 quad_perm:[1,0,3,2] row_mask:0xf bank_mask:0xf
    v_lshlrev_b32 v234, 16, v180
    v_and_b32 v235, 0xffff0000, v180
    v_pk_mul_f32 v[144:145], v[234:235], v[108:109]
    v_lshlrev_b32 v234, 16, v186
    v_and_b32 v235, 0xffff0000, v186
    s_waitcnt vmcnt(38)
    v_pk_fma_f32 v[198:199], v[128:129], v[24:25], v[198:199]
    v_pk_fma_f32 v[198:199], v[130:131], v[26:27], v[198:199]
    ds_add_u32 v224, v243 offset:3328
    buffer_load_dwordx4 v[24:27], v1, s[24:27], s71 offen offset:512 nt
    v_add_f32 v228, v198, v199
    v_pk_mul_f32 v[202:203], v[144:145], v[234:235]
    s_branch L_x0
L_w0:
    s_branch L_w1
L_x0:
    v_lshlrev_b32 v234, 16, v181
    v_and_b32 v235, 0xffff0000, v181
    v_pk_mul_f32 v[146:147], v[234:235], v[110:111]
    v_lshlrev_b32 v234, 16, v187
    s_waitcnt vmcnt(38)
    v_pk_fma_f32 v[198:199], v[120:121], v[28:29], v[200:201]
    v_pk_fma_f32 v[198:199], v[122:123], v[30:31], v[198:199]
    s_add_u32 s71, s71, 3072
    s_cbranch_vccnz L_th6_0
L_tb6_0:
    buffer_load_dwordx4 v[28:31], v1, s[24:27], s71 offen offset:0 nt
    v_add_f32_dpp v229, v228, v228 row_ror:8 row_mask:0xf bank_mask:0xc
    v_and_b32 v235, 0xffff0000, v187
    v_pk_fma_f32 v[202:203], v[146:147], v[234:235], v[202:203]
    v_lshlrev_b32 v234, 16, v182
    v_and_b32 v235, 0xffff0000, v182
    v_pk_mul_f32 v[148:149], v[234:235], v[112:113]
    s_waitcnt vmcnt(38)
    v_pk_fma_f32 v[198:199], v[124:125], v[32:33], v[198:199]
    v_pk_fma_f32 v[198:199], v[126:127], v[34:35], v[198:199]
    buffer_load_dwordx4 v[32:35], v1, s[24:27], s71 offen offset:256 nt
    v_add_f32_dpp v230, v229, v229 row_shl:4 row_mask:0xf bank_mask:0x5
    v_lshlrev_b32 v234, 16, v188
    v_and_b32 v235, 0xffff0000, v188
    v_pk_fma_f32 v[202:203], v[148:149], v[234:235], v[202:203]
    v_lshlrev_b32 v234, 16, v183
    v_and_b32 v235, 0xffff0000, v183
    s_waitcnt vmcnt(38)
    v_pk_fma_f32 v[198:199], v[128:129], v[36:37], v[198:199]
    v_pk_fma_f32 v[198:199], v[130:131], v[38:39], v[198:199]
    ds_add_u32 v224, v243 offset:3328
    buffer_load_dwordx4 v[36:39], v1, s[24:27], s71 offen offset:512 nt
    v_add_f32 v228, v198, v199
    v_pk_mul_f32 v[150:151], v[234:235], v[114:115]
    v_lshlrev_b32 v234, 16, v189
    v_and_b32 v235, 0xffff0000, v189
    v_pk_fma_f32 v[202:203], v[150:151], v[234:235], v[202:203]
    v_lshlrev_b32 v234, 16, v184
    s_waitcnt vmcnt(38)
    v_pk_fma_f32 v[198:199], v[120:121], v[40:41], v[200:201]
    v_pk_fma_f32 v[198:199], v[122:123], v[42:43], v[198:199]
    s_add_u32 s71, s71, 3072
    s_cbranch_vccnz L_th9_0
L_tb9_0:
    buffer_load_dwordx4 v[40:43], v1, s[24:27], s71 offen offset:0 nt
    v_add_f32_dpp v229, v228, v228 row_ror:8 row_mask:0xf bank_mask:0x3
    v_and_b32 v235, 0xffff0000, v184
    v_pk_mul_f32 v[152:153], v[234:235], v[116:117]
    v_lshlrev_b32 v234, 16, v190
    v_and_b32 v235, 0xffff0000, v190
    v_pk_fma_f32 v[202:203], v[152:153], v[234:235], v[202:203]
    s_waitcnt vmcnt(38)
    v_pk_fma_f32 v[198:199], v[124:125], v[44:45], v[198:199]
    v_pk_fma_f32 v[198:199], v[126:127], v[46:47], v[198:199]
    buffer_load_dwordx4 v[44:47], v1, s[24:27], s71 offen offset:256 nt
    v_lshlrev_b32 v234, 16, v185
    v_and_b32 v235, 0xffff0000, v185
    v_pk_mul_f32 v[154:155], v[234:235], v[118:119]
    v_lshlrev_b32 v234, 16, v191
    v_and_b32 v235, 0xffff0000, v191
    s_waitcnt vmcnt(38)
    v_pk_fma_f32 v[198:199], v[128:129], v[48:49], v[198:199]
    v_pk_fma_f32 v[198:199], v[130:131], v[50:51], v[198:199]
    ds_add_u32 v224, v243 offset:3328
    buffer_load_dwordx4 v[48:51], v1, s[24:27], s71 offen offset:512 nt
    v_add_f32 v228, v198, v199
    v_pk_fma_f32 v[202:203], v[154:155], v[234:235], v[202:203]
    v_pk_mul_f32 v[202:203], v[202:203], s[62:63]
    s_waitcnt vmcnt(35)
    v_pk_fma_f32 v[198:199], v[144:145], v[52:53], v[202:203]
    v_pk_fma_f32 v[198:199], v[146:147], v[54:55], v[198:199]
    ds_read_b32 v244, v243 offset:147
    s_add_u32 s71, s71, 384000
    s_cbranch_vccnz L_th12_0
L_tb12_0:
    buffer_load_dwordx4 v[52:55], v1, s[24:27], s71 offen offset:0 nt
    v_add_f32_dpp v229, v228, v228 row_ror:8 row_mask:0xf bank_mask:0xc
    v_lshlrev_b32 v108, 16, v192
    v_and_b32 v109, 0xffff0000, v192
    v_pk_mul_f32 v[108:109], v[108:109], s[60:61]
    v_lshlrev_b32 v110, 16, v193
    v_and_b32 v111, 0xffff0000, v193
    s_waitcnt vmcnt(35)
    v_pk_fma_f32 v[198:199], v[148:149], v[56:57], v[198:199]
    v_pk_fma_f32 v[198:199], v[150:151], v[58:59], v[198:199]
    buffer_load_dwordx4 v[56:59], v1, s[24:27], s71 offen offset:256 nt
    v_add_f32_dpp v230, v229, v229 row_shr:4 row_mask:0xf bank_mask:0xa
    v_pk_mul_f32 v[110:111], v[110:111], s[60:61]
    v_lshlrev_b32 v112, 16, v194
    v_and_b32 v113, 0xffff0000, v194
    v_pk_mul_f32 v[112:113], v[112:113], s[60:61]
    v_lshlrev_b32 v114, 16, v195
    s_waitcnt vmcnt(35)
    v_pk_fma_f32 v[198:199], v[152:153], v[60:61], v[198:199]
    v_pk_fma_f32 v[198:199], v[154:155], v[62:63], v[198:199]
    s_waitcnt lgkmcnt(0)
    v_cmp_lt_u32 vcc, v0, v244
    ds_add_u32 v224, v243 offset:3328
    buffer_load_dwordx4 v[60:63], v1, s[24:27], s71 offen offset:512 nt
    v_add_f32_dpp v231, v230, v230 quad_perm:[2,3,0,1] row_mask:0xf bank_mask:0xf
    v_add_f32 v228, v198, v199
    v_and_b32 v115, 0xffff0000, v195
    v_pk_mul_f32 v[114:115], v[114:115], s[60:61]
    v_lshlrev_b32 v116, 16, v196
    v_and_b32 v117, 0xffff0000, v196
    v_pk_mul_f32 v[116:117], v[116:117], s[60:61]
    s_waitcnt vmcnt(35)
    v_pk_fma_f32 v[198:199], v[144:145], v[64:65], v[202:203]
    v_pk_fma_f32 v[198:199], v[146:147], v[66:67], v[198:199]
    s_add_u32 s71, s71, 3072
    s_cbranch_vccnz L_th15_0
L_tb15_0:
    buffer_load_dwordx4 v[64:67], v1, s[24:27], s71 offen offset:0 nt
    v_add_f32_dpp v229, v228, v228 row_ror:8 row_mask:0xf bank_mask:0x3
    v_lshlrev_b32 v118, 16, v197
    v_and_b32 v119, 0xffff0000, v197
    v_pk_mul_f32 v[118:119], v[118:119], s[60:61]
    s_waitcnt vmcnt(29)
    v_pk_fma_f32 v[198:199], v[148:149], v[68:69], v[198:199]
    v_pk_fma_f32 v[198:199], v[150:151], v[70:71], v[198:199]
    s_add_u32 s72, s72, 3072
    buffer_load_dwordx2 v[168:169], v2, s[32:35], s72 offen offset:0
    buffer_load_dwordx2 v[170:171], v2, s[32:35], s72 offen offset:128
    buffer_load_dwordx2 v[172:173], v2, s[32:35], s72 offen offset:256
    buffer_load_dwordx2 v[174:175], v2, s[36:39], s72 offen offset:0
    buffer_load_dwordx2 v[176:177], v2, s[36:39], s72 offen offset:128
    buffer_load_dwordx2 v[178:179], v2, s[36:39], s72 offen offset:256
    buffer_load_dwordx4 v[68:71], v1, s[24:27], s71 offen offset:256 nt
    v_lshlrev_b32 v234, 16, v132
    v_and_b32 v235, 0xffff0000, v132
    v_pk_mul_f32 v[120:121], v[234:235], v[108:109]
    v_lshlrev_b32 v234, 16, v138
    v_and_b32 v235, 0xffff0000, v138
    s_waitcnt vmcnt(35)
    v_pk_fma_f32 v[198:199], v[152:153], v[72:73], v[198:199]
    v_pk_fma_f32 v[198:199], v[154:155], v[74:75], v[198:199]
    ds_add_u32 v224, v243 offset:3328
    buffer_load_dwordx4 v[72:75], v1, s[24:27], s71 offen offset:512 nt
    v_add_f32 v228, v198, v199
    v_pk_mul_f32 v[200:201], v[120:121], v[234:235]
    v_lshlrev_b32 v234, 16, v133
    v_and_b32 v235, 0xffff0000, v133
    v_pk_mul_f32 v[122:123], v[234:235], v[110:111]
    v_lshlrev_b32 v234, 16, v139
    s_waitcnt vmcnt(35)
    v_pk_fma_f32 v[198:199], v[144:145], v[76:77], v[202:203]
    v_pk_fma_f32 v[198:199], v[146:147], v[78:79], v[198:199]
    s_add_u32 s71, s71, 3072
    s_cbranch_vccnz L_th18_0
L_tb18_0:
    buffer_load_dwordx4 v[76:79], v1, s[24:27], s71 offen offset:0 nt
    v_add_f32_dpp v229, v228, v228 row_ror:8 row_mask:0xf bank_mask:0xc
    v_and_b32 v235, 0xffff0000, v139
    v_pk_fma_f32 v[200:201], v[122:123], v[234:235], v[200:201]
    v_lshlrev_b32 v234, 16, v134
    v_and_b32 v235, 0xffff0000, v134
    v_pk_mul_f32 v[124:125], v[234:235], v[112:113]
    s_waitcnt vmcnt(35)
    v_pk_fma_f32 v[198:199], v[148:149], v[80:81], v[198:199]
    v_pk_fma_f32 v[198:199], v[150:151], v[82:83], v[198:199]
    buffer_load_dwordx4 v[80:83], v1, s[24:27], s71 offen offset:256 nt
    v_add_f32_dpp v230, v229, v229 row_shl:4 row_mask:0xf bank_mask:0x5
    v_lshlrev_b32 v234, 16, v140
    v_and_b32 v235, 0xffff0000, v140
    v_pk_fma_f32 v[200:201], v[124:125], v[234:235], v[200:201]
    v_lshlrev_b32 v234, 16, v135
    v_and_b32 v235, 0xffff0000, v135
    s_waitcnt vmcnt(35)
    v_pk_fma_f32 v[198:199], v[152:153], v[84:85], v[198:199]
    v_pk_fma_f32 v[198:199], v[154:155], v[86:87], v[198:199]
    ds_add_u32 v224, v243 offset:3328
    buffer_load_dwordx4 v[84:87], v1, s[24:27], s71 offen offset:512 nt
    v_add_f32 v228, v198, v199
    v_pk_mul_f32 v[126:127], v[234:235], v[114:115]
    v_lshlrev_b32 v234, 16, v141
    v_and_b32 v235, 0xffff0000, v141
    v_pk_fma_f32 v[200:201], v[126:127], v[234:235], v[200:201]
    v_lshlrev_b32 v234, 16, v136
    s_waitcnt vmcnt(35)
    v_pk_fma_f32 v[198:199], v[144:145], v[88:89], v[202:203]
    v_pk_fma_f32 v[198:199], v[146:147], v[90:91], v[198:199]
    s_add_u32 s71, s71, 3072
    s_cbranch_vccnz L_th21_0
L_tb21_0:
    buffer_load_dwordx4 v[88:91], v1, s[24:27], s71 offen offset:0 nt
    v_add_f32_dpp v229, v228, v228 row_ror:8 row_mask:0xf bank_mask:0x3
    v_and_b32 v235, 0xffff0000, v136
    v_pk_mul_f32 v[128:129], v[234:235], v[116:117]
    v_lshlrev_b32 v234, 16, v142
    v_and_b32 v235, 0xffff0000, v142
    v_pk_fma_f32 v[200:201], v[128:129], v[234:235], v[200:201]
    s_waitcnt vmcnt(35)
    v_pk_fma_f32 v[198:199], v[148:149], v[92:93], v[198:199]
    v_pk_fma_f32 v[198:199], v[150:151], v[94:95], v[198:199]
    buffer_load_dwordx4 v[92:95], v1, s[24:27], s71 offen offset:256 nt
    v_lshlrev_b32 v234, 16, v137
    v_and_b32 v235, 0xffff0000, v137
    v_pk_mul_f32 v[130:131], v[234:235], v[118:119]
    v_lshlrev_b32 v234, 16, v143
    v_and_b32 v235, 0xffff0000, v143
    s_waitcnt vmcnt(35)
    v_pk_fma_f32 v[198:199], v[152:153], v[96:97], v[198:199]
    v_pk_fma_f32 v[198:199], v[154:155], v[98:99], v[198:199]
    ds_add_u32 v224, v243 offset:3328
    buffer_load_dwordx4 v[96:99], v1, s[24:27], s71 offen offset:512 nt
    v_add_f32 v228, v198, v199
    v_pk_fma_f32 v[200:201], v[130:131], v[234:235], v[200:201]
    v_pk_mul_f32 v[200:201], v[200:201], s[62:63]
    s_sub_u32 s76, s76, 1
    s_cmp_lg_u32 s76, 0
    s_cbranch_scc1 L_loop0
L_h0:
    s_cbranch_execz L_h1
    s_waitcnt vmcnt(35)
    v_pk_fma_f32 v[198:199], v[120:121], v[4:5], v[200:201]
L_h1:
    s_cbranch_execz L_h2
    v_pk_fma_f32 v[198:199], v[122:123], v[6:7], v[198:199]
    ds_read_b32 v244, v243 offset:147
    s_add_u32 s71, s71, 384000
    s_cbranch_vccnz L_th24_1
L_tb24_1:
    buffer_load_dwordx4 v[4:7], v1, s[24:27], s71 offen offset:0 nt
    v_add_f32_dpp v229, v228, v228 row_ror:8 row_mask:0xf bank_mask:0xc
    s_waitcnt vmcnt(35)
    v_pk_fma_f32 v[198:199], v[124:125], v[8:9], v[198:199]
    v_pk_fma_f32 v[198:199], v[126:127], v[10:11], v[198:199]
    buffer_load_dwordx4 v[8:11], v1, s[24:27], s71 offen offset:256 nt
    v_add_f32_dpp v230, v229, v229 row_shr:4 row_mask:0xf bank_mask:0xa
    s_waitcnt vmcnt(35)
    v_pk_fma_f32 v[198:199], v[128:129], v[12:13], v[198:199]
    v_pk_fma_f32 v[198:199], v[130:131], v[14:15], v[198:199]
    s_waitcnt lgkmcnt(0)
    v_cmp_lt_u32 vcc, v0, v244
    ds_add_u32 v224, v243 offset:3328
    buffer_load_dwordx4 v[12:15], v1, s[24:27], s71 offen offset:512 nt
L_h2:
    s_cbranch_execz L_h3
    v_add_f32_dpp v232, v230, v230 quad_perm:[2,3,0,1] row_mask:0xf bank_mask:0xf
    v_add_f32 v228, v198, v199
    s_waitcnt vmcnt(35)
    v_pk_fma_f32 v[198:199], v[120:121], v[16:17], v[200:201]
    v_pk_fma_f32 v[198:199], v[122:123], v[18:19], v[198:199]
    s_add_u32 s71, s71, 3072
    s_cbranch_vccnz L_th27_1
L_tb27_1:
    buffer_load_dwordx4 v[16:19], v1, s[24:27], s71 offen offset:0 nt
    v_cndmask_b32 v232, v231, v232, s[64:65]
    v_add_f32_dpp v229, v228, v228 row_ror:8 row_mask:0xf bank_mask:0x3
    s_waitcnt vmcnt(29)
    v_pk_fma_f32 v[198:199], v[124:125], v[20:21], v[198:199]
    v_pk_fma_f32 v[198:199], v[126:127], v[22:23], v[198:199]
    s_add_u32 s72, s72, 3072
    buffer_load_dwordx2 v[180:181], v2, s[32:35], s72 offen offset:0
    buffer_load_dwordx2 v[182:183], v2, s[32:35], s72 offen offset:128
    buffer_load_dwordx2 v[184:185], v2, s[32:35], s72 offen offset:256
    buffer_load_dwordx2 v[186:187], v2, s[36:39], s72 offen offset:0
L_h3:
    s_cbranch_execz L_h4
    buffer_load_dwordx2 v[188:189], v2, s[36:39], s72 offen offset:128
    buffer_load_dwordx2 v[190:191], v2, s[36:39], s72 offen offset:256
    buffer_load_dwordx4 v[20:23], v1, s[24:27], s71 offen offset:256 nt
    v_add_f32_dpp v231, v232, v232 quad_perm:[1,0,3,2] row_mask:0xf bank_mask:0xf
    v_lshlrev_b32 v234, 16, v156
    v_and_b32 v235, 0xffff0000, v156
    v_pk_mul_f32 v[144:145], v[234:235], v[108:109]
    v_lshlrev_b32 v234, 16, v162
    v_and_b32 v235, 0xffff0000, v162
    s_waitcnt vmcnt(35)
    v_pk_fma_f32 v[198:199], v[128:129], v[24:25], v[198:199]
    v_pk_fma_f32 v[198:199], v[130:131], v[26:27], v[198:199]
    ds_add_u32 v224, v243 offset:3328
    buffer_load_dwordx4 v[24:27], v1, s[24:27], s71 offen offset:512 nt
    v_cndmask_b32 v233, v233, v231, s[66:67]
    v_mul_f32 v233, 0x58000000, v233
    ds_write_b32 v239, v233
L_h4:
    s_cbranch_execz L_h5
    v_add_u32 v239, 256, v239
    v_add_f32 v228, v198, v199
    v_pk_mul_f32 v[202:203], v[144:145], v[234:235]
    v_lshlrev_b32 v234, 16, v157
    v_and_b32 v235, 0xffff0000, v157
    v_pk_mul_f32 v[146:147], v[234:235], v[110:111]
    v_lshlrev_b32 v234, 16, v163
    s_waitcnt vmcnt(35)
    v_pk_fma_f32 v[198:199], v[120:121], v[28:29], v[200:201]
    v_pk_fma_f32 v[198:199], v[122:123], v[30:31], v[198:199]
    s_add_u32 s71, s71, 3072
    s_cbranch_vccnz L_th30_1
L_tb30_1:
    buffer_load_dwordx4 v[28:31], v1, s[24:27], s71 offen offset:0 nt
    v_add_f32_dpp v229, v228, v228 row_ror:8 row_mask:0xf bank_mask:0xc
    v_and_b32 v235, 0xffff0000, v163
    v_pk_fma_f32 v[202:203], v[146:147], v[234:235], v[202:203]
    v_lshlrev_b32 v234, 16, v158
    v_and_b32 v235, 0xffff0000, v158
L_h5:
    s_cbranch_execz L_h6
    v_pk_mul_f32 v[148:149], v[234:235], v[112:113]
    s_waitcnt vmcnt(35)
    v_pk_fma_f32 v[198:199], v[124:125], v[32:33], v[198:199]
    v_pk_fma_f32 v[198:199], v[126:127], v[34:35], v[198:199]
    buffer_load_dwordx4 v[32:35], v1, s[24:27], s71 offen offset:256 nt
    v_add_f32_dpp v230, v229, v229 row_shl:4 row_mask:0xf bank_mask:0x5
    v_lshlrev_b32 v234, 16, v164
    v_and_b32 v235, 0xffff0000, v164
    v_pk_fma_f32 v[202:203], v[148:149], v[234:235], v[202:203]
    v_lshlrev_b32 v234, 16, v159
    v_and_b32 v235, 0xffff0000, v159
    s_waitcnt vmcnt(35)
    v_pk_fma_f32 v[198:199], v[128:129], v[36:37], v[198:199]
    v_pk_fma_f32 v[198:199], v[130:131], v[38:39], v[198:199]
    ds_add_u32 v224, v243 offset:3328
    buffer_load_dwordx4 v[36:39], v1, s[24:27], s71 offen offset:512 nt
    v_add_f32 v228, v198, v199
    v_pk_mul_f32 v[150:151], v[234:235], v[114:115]
L_h6:
    s_cbranch_execz L_h7
    v_lshlrev_b32 v234, 16, v165
    v_and_b32 v235, 0xffff0000, v165
    v_pk_fma_f32 v[202:203], v[150:151], v[234:235], v[202:203]
    v_lshlrev_b32 v234, 16, v160
    s_waitcnt vmcnt(35)
    v_pk_fma_f32 v[198:199], v[120:121], v[40:41], v[200:201]
    v_pk_fma_f32 v[198:199], v[122:123], v[42:43], v[198:199]
    s_add_u32 s71, s71, 3072
    s_cbranch_vccnz L_th33_1
L_tb33_1:
    buffer_load_dwordx4 v[40:43], v1, s[24:27], s71 offen offset:0 nt
    v_add_f32_dpp v229, v228, v228 row_ror:8 row_mask:0xf bank_mask:0x3
    v_and_b32 v235, 0xffff0000, v160
    v_pk_mul_f32 v[152:153], v[234:235], v[116:117]
    v_lshlrev_b32 v234, 16, v166
    v_and_b32 v235, 0xffff0000, v166
    v_pk_fma_f32 v[202:203], v[152:153], v[234:235], v[202:203]
    s_waitcnt vmcnt(35)
    v_pk_fma_f32 v[198:199], v[124:125], v[44:45], v[198:199]
    v_pk_fma_f32 v[198:199], v[126:127], v[46:47], v[198:199]
L_h7:
    s_cbranch_execz L_h8
    buffer_load_dwordx4 v[44:47], v1, s[24:27], s71 offen offset:256 nt
    v_lshlrev_b32 v234, 16, v161
    v_and_b32 v235, 0xffff0000, v161
    v_pk_mul_f32 v[154:155], v[234:235], v[118:119]
    v_lshlrev_b32 v234, 16, v167
    v_and_b32 v235, 0xffff0000, v167
    s_waitcnt vmcnt(35)
    v_pk_fma_f32 v[198:199], v[128:129], v[48:49], v[198:199]
    v_pk_fma_f32 v[198:199], v[130:131], v[50:51], v[198:199]
    ds_add_u32 v224, v243 offset:3328
    buffer_load_dwordx4 v[48:51], v1, s[24:27], s71 offen offset:512 nt
    v_add_f32 v228, v198, v199
    v_pk_fma_f32 v[202:203], v[154:155], v[234:235], v[202:203]
    v_pk_mul_f32 v[202:203], v[202:203], s[62:63]
    s_waitcnt vmcnt(35)
    v_pk_fma_f32 v[198:199], v[144:145], v[52:53], v[202:203]
    v_pk_fma_f32 v[198:199], v[146:147], v[54:55], v[198:199]
    ds_read_b32 v244, v243 offset:147
L_h8:
    s_cbranch_execz L_h9
    s_mov_b32 s91, 0
    v_readlane_b32 s70, v245, s91
    s_add_u32 s91, s91, 1
    s_and_b32 s80, s70, 31
    s_mul_i32 s80, s80, 96
    s_lshl_b32 s73, s70, 7
    s_sub_u32 s73, s73, s80
    buffer_load_ushort v220, v3, s[40:43], s73 offen
    buffer_load_ushort v221, v3, s[44:47], s73 offen
    s_add_u32 s71, s71, 384000
    s_cbranch_vccnz L_th36_1
L_tb36_1:
    buffer_load_dwordx4 v[52:55], v1, s[24:27], s71 offen offset:0 nt
    v_add_f32_dpp v229, v228, v228 row_ror:8 row_mask:0xf bank_mask:0xc
    s_waitcnt vmcnt(37)
    v_pk_fma_f32 v[198:199], v[148:149], v[56:57], v[198:199]
    v_pk_fma_f32 v[198:199], v[150:151], v[58:59], v[198:199]
    buffer_load_dwordx4 v[56:59], v1, s[24:27], s71 offen offset:256 nt
    v_add_f32_dpp v230, v229, v229 row_shr:4 row_mask:0xf bank_mask:0xa
    s_waitcnt vmcnt(37)
L_h9:
    s_cbranch_execz L_h10
    v_pk_fma_f32 v[198:199], v[152:153], v[60:61], v[198:199]
    v_pk_fma_f32 v[198:199], v[154:155], v[62:63], v[198:199]
    s_waitcnt lgkmcnt(0)
    v_cmp_lt_u32 vcc, v0, v244
    ds_add_u32 v224, v243 offset:3328
    buffer_load_dwordx4 v[60:63], v1, s[24:27], s71 offen offset:512 nt
    v_add_f32_dpp v231, v230, v230 quad_perm:[2,3,0,1] row_mask:0xf bank_mask:0xf
    v_add_f32 v228, v198, v199
    s_waitcnt vmcnt(37)
    v_pk_fma_f32 v[198:199], v[144:145], v[64:65], v[202:203]
    v_pk_fma_f32 v[198:199], v[146:147], v[66:67], v[198:199]
    s_add_u32 s71, s71, 3072
    s_cbranch_vccnz L_th39_1
L_tb39_1:
    buffer_load_dwordx4 v[64:67], v1, s[24:27], s71 offen offset:0 nt
    v_add_f32_dpp v229, v228, v228 row_ror:8 row_mask:0xf bank_mask:0x3
    s_waitcnt vmcnt(31)
    v_pk_fma_f32 v[198:199], v[148:149], v[68:69], v[198:199]
    v_pk_fma_f32 v[198:199], v[150:151], v[70:71], v[198:199]
    buffer_load_dwordx4 v[68:71], v1, s[24:27], s71 offen offset:256 nt
L_h10:
    s_cbranch_execz L_h11
    v_lshlrev_b32 v234, 16, v168
    v_and_b32 v235, 0xffff0000, v168
    v_pk_mul_f32 v[120:121], v[234:235], v[108:109]
    v_lshlrev_b32 v234, 16, v174
    v_and_b32 v235, 0xffff0000, v174
    s_waitcnt vmcnt(31)
    v_pk_fma_f32 v[198:199], v[152:153], v[72:73], v[198:199]
    v_pk_fma_f32 v[198:199], v[154:155], v[74:75], v[198:199]
    ds_add_u32 v224, v243 offset:3328
    buffer_load_dwordx4 v[72:75], v1, s[24:27], s71 offen offset:512 nt
    v_add_f32 v228, v198, v199
    v_pk_mul_f32 v[200:201], v[120:121], v[234:235]
    v_lshlrev_b32 v234, 16, v169
    v_and_b32 v235, 0xffff0000, v169
    v_pk_mul_f32 v[122:123], v[234:235], v[110:111]
    v_lshlrev_b32 v234, 16, v175
    s_waitcnt vmcnt(31)
    v_pk_fma_f32 v[198:199], v[144:145], v[76:77], v[202:203]
    v_pk_fma_f32 v[198:199], v[146:147], v[78:79], v[198:199]
L_h11:
    s_cbranch_execz L_h12
    s_add_u32 s71, s71, 3072
    s_cbranch_vccnz L_th42_1
L_tb42_1:
    buffer_load_dwordx4 v[76:79], v1, s[24:27], s71 offen offset:0 nt
    v_add_f32_dpp v229, v228, v228 row_ror:8 row_mask:0xf bank_mask:0xc
    v_and_b32 v235, 0xffff0000, v175
    v_pk_fma_f32 v[200:201], v[122:123], v[234:235], v[200:201]
    v_lshlrev_b32 v234, 16, v170
    v_and_b32 v235, 0xffff0000, v170
    v_pk_mul_f32 v[124:125], v[234:235], v[112:113]
    s_waitcnt vmcnt(31)
    v_pk_fma_f32 v[198:199], v[148:149], v[80:81], v[198:199]
    v_pk_fma_f32 v[198:199], v[150:151], v[82:83], v[198:199]
    buffer_load_dwordx4 v[80:83], v1, s[24:27], s71 offen offset:256 nt
    v_add_f32_dpp v230, v229, v229 row_shl:4 row_mask:0xf bank_mask:0x5
    v_lshlrev_b32 v234, 16, v176
    v_and_b32 v235, 0xffff0000, v176
    v_pk_fma_f32 v[200:201], v[124:125], v[234:235], v[200:201]
L_h12:
    s_cbranch_execz L_h13
    v_lshlrev_b32 v234, 16, v171
    v_and_b32 v235, 0xffff0000, v171
    s_waitcnt vmcnt(31)
    v_pk_fma_f32 v[198:199], v[152:153], v[84:85], v[198:199]
    v_pk_fma_f32 v[198:199], v[154:155], v[86:87], v[198:199]
    ds_add_u32 v224, v243 offset:3328
    buffer_load_dwordx4 v[84:87], v1, s[24:27], s71 offen offset:512 nt
    v_add_f32 v228, v198, v199
    v_pk_mul_f32 v[126:127], v[234:235], v[114:115]
    v_lshlrev_b32 v234, 16, v177
    v_and_b32 v235, 0xffff0000, v177
    v_pk_fma_f32 v[200:201], v[126:127], v[234:235], v[200:201]
    v_lshlrev_b32 v234, 16, v172
    s_waitcnt vmcnt(31)
    v_pk_fma_f32 v[198:199], v[144:145], v[88:89], v[202:203]
    v_pk_fma_f32 v[198:199], v[146:147], v[90:91], v[198:199]
    s_add_u32 s71, s71, 3072
    s_cbranch_vccnz L_th45_1
L_tb45_1:
    buffer_load_dwordx4 v[88:91], v1, s[24:27], s71 offen offset:0 nt
L_h13:
    s_cbranch_execz L_h14
    v_add_f32_dpp v229, v228, v228 row_ror:8 row_mask:0xf bank_mask:0x3
    v_and_b32 v235, 0xffff0000, v172
    v_pk_mul_f32 v[128:129], v[234:235], v[116:117]
    v_lshlrev_b32 v234, 16, v178
    v_and_b32 v235, 0xffff0000, v178
    v_pk_fma_f32 v[200:201], v[128:129], v[234:235], v[200:201]
    s_waitcnt vmcnt(31)
    v_pk_fma_f32 v[198:199], v[148:149], v[92:93], v[198:199]
    v_pk_fma_f32 v[198:199], v[150:151], v[94:95], v[198:199]
    buffer_load_dwordx4 v[92:95], v1, s[24:27], s71 offen offset:256 nt
    v_lshlrev_b32 v234, 16, v173
    v_and_b32 v235, 0xffff0000, v173
    v_pk_mul_f32 v[130:131], v[234:235], v[118:119]
    v_lshlrev_b32 v234, 16, v179
    v_and_b32 v235, 0xffff0000, v179
    s_waitcnt vmcnt(31)
    v_pk_fma_f32 v[198:199], v[152:153], v[96:97], v[198:199]
    v_pk_fma_f32 v[198:199], v[154:155], v[98:99], v[198:199]
L_h14:
    s_cbranch_execz L_h15
    ds_add_u32 v224, v243 offset:3328
    buffer_load_dwordx4 v[96:99], v1, s[24:27], s71 offen offset:512 nt
    v_add_f32 v228, v198, v199
    v_pk_fma_f32 v[200:201], v[130:131], v[234:235], v[200:201]
    v_pk_mul_f32 v[200:201], v[200:201], s[62:63]
    s_waitcnt vmcnt(31)
    v_pk_fma_f32 v[198:199], v[120:121], v[4:5], v[200:201]
    v_pk_fma_f32 v[198:199], v[122:123], v[6:7], v[198:199]
    ds_read_b32 v244, v243 offset:147
    s_mul_i32 s71, s70, 49152
    s_and_b32 s80, s70, 31
    s_mul_i32 s80, s80, 36864
    s_sub_u32 s71, s71, s80
    s_cbranch_vccnz L_th0_1
L_tb0_1:
    buffer_load_dwordx4 v[4:7], v1, s[28:31], s71 offen offset:0 nt
    v_add_f32_dpp v229, v228, v228 row_ror:8 row_mask:0xf bank_mask:0xc
    s_waitcnt vmcnt(31)
    v_pk_fma_f32 v[198:199], v[124:125], v[8:9], v[198:199]
    v_pk_fma_f32 v[198:199], v[126:127], v[10:11], v[198:199]
L_h15:
    s_cbranch_execz L_h16
    buffer_load_dwordx4 v[8:11], v1, s[28:31], s71 offen offset:256 nt
    v_add_f32_dpp v230, v229, v229 row_shr:4 row_mask:0xf bank_mask:0xa
    s_waitcnt vmcnt(31)
    v_pk_fma_f32 v[198:199], v[128:129], v[12:13], v[198:199]
    v_pk_fma_f32 v[198:199], v[130:131], v[14:15], v[198:199]
    s_waitcnt lgkmcnt(0)
    v_cmp_lt_u32 vcc, v0, v244
    ds_add_u32 v224, v243 offset:3328
    buffer_load_dwordx4 v[12:15], v1, s[28:31], s71 offen offset:512 nt
    v_add_f32_dpp v232, v230, v230 quad_perm:[2,3,0,1] row_mask:0xf bank_mask:0xf
    v_add_f32 v228, v198, v199
    s_waitcnt vmcnt(31)
    v_pk_fma_f32 v[198:199], v[120:121], v[16:17], v[200:201]
    v_pk_fma_f32 v[198:199], v[122:123], v[18:19], v[198:199]
    s_add_u32 s71, s71, 3072
    s_cbranch_vccnz L_th3_1
L_tb3_1:
    buffer_load_dwordx4 v[16:19], v1, s[28:31], s71 offen offset:0 nt
    v_cndmask_b32 v232, v231, v232, s[64:65]
L_h16:
    s_cbranch_execz L_h17
    v_add_f32_dpp v229, v228, v228 row_ror:8 row_mask:0xf bank_mask:0x3
    s_waitcnt vmcnt(25)
    v_pk_fma_f32 v[198:199], v[124:125], v[20:21], v[198:199]
    v_pk_fma_f32 v[198:199], v[126:127], v[22:23], v[198:199]
    buffer_load_dwordx4 v[20:23], v1, s[28:31], s71 offen offset:256 nt
    v_add_f32_dpp v233, v232, v232 quad_perm:[1,0,3,2] row_mask:0xf bank_mask:0xf
    v_lshlrev_b32 v234, 16, v180
    v_and_b32 v235, 0xffff0000, v180
    v_pk_mul_f32 v[144:145], v[234:235], v[108:109]
    v_lshlrev_b32 v234, 16, v186
    v_and_b32 v235, 0xffff0000, v186
    s_waitcnt vmcnt(25)
    v_pk_fma_f32 v[198:199], v[128:129], v[24:25], v[198:199]
    v_pk_fma_f32 v[198:199], v[130:131], v[26:27], v[198:199]
    ds_add_u32 v224, v243 offset:3328
    buffer_load_dwordx4 v[24:27], v1, s[28:31], s71 offen offset:512 nt
    v_add_f32 v228, v198, v199
    v_pk_mul_f32 v[202:203], v[144:145], v[234:235]
L_h17:
    s_cbranch_execz L_h18
    v_lshlrev_b32 v234, 16, v181
    v_and_b32 v235, 0xffff0000, v181
    v_pk_mul_f32 v[146:147], v[234:235], v[110:111]
    v_lshlrev_b32 v234, 16, v187
    s_waitcnt vmcnt(25)
    v_pk_fma_f32 v[198:199], v[120:121], v[28:29], v[200:201]
    v_pk_fma_f32 v[198:199], v[122:123], v[30:31], v[198:199]
    s_add_u32 s71, s71, 3072
    s_cbranch_vccnz L_th6_1
L_tb6_1:
    buffer_load_dwordx4 v[28:31], v1, s[28:31], s71 offen offset:0 nt
    v_add_f32_dpp v229, v228, v228 row_ror:8 row_mask:0xf bank_mask:0xc
    v_and_b32 v235, 0xffff0000, v187
    v_pk_fma_f32 v[202:203], v[146:147], v[234:235], v[202:203]
    v_lshlrev_b32 v234, 16, v182
    v_and_b32 v235, 0xffff0000, v182
    v_pk_mul_f32 v[148:149], v[234:235], v[112:113]
    s_waitcnt vmcnt(25)
    v_pk_fma_f32 v[198:199], v[124:125], v[32:33], v[198:199]
    v_pk_fma_f32 v[198:199], v[126:127], v[34:35], v[198:199]
L_h18:
    s_cbranch_execz L_h19
    buffer_load_dwordx4 v[32:35], v1, s[28:31], s71 offen offset:256 nt
    v_add_f32_dpp v230, v229, v229 row_shl:4 row_mask:0xf bank_mask:0x5
    v_lshlrev_b32 v234, 16, v188
    v_and_b32 v235, 0xffff0000, v188
    v_pk_fma_f32 v[202:203], v[148:149], v[234:235], v[202:203]
    v_lshlrev_b32 v234, 16, v183
    v_and_b32 v235, 0xffff0000, v183
    s_waitcnt vmcnt(25)
    v_pk_fma_f32 v[198:199], v[128:129], v[36:37], v[198:199]
    v_pk_fma_f32 v[198:199], v[130:131], v[38:39], v[198:199]
    ds_add_u32 v224, v243 offset:3328
    buffer_load_dwordx4 v[36:39], v1, s[28:31], s71 offen offset:512 nt
    v_add_f32 v228, v198, v199
    v_pk_mul_f32 v[150:151], v[234:235], v[114:115]
    v_lshlrev_b32 v234, 16, v189
    v_and_b32 v235, 0xffff0000, v189
    v_pk_fma_f32 v[202:203], v[150:151], v[234:235], v[202:203]
    v_lshlrev_b32 v234, 16, v184
L_h19:
    s_cbranch_execz L_h20
    s_waitcnt vmcnt(25)
    v_pk_fma_f32 v[198:199], v[120:121], v[40:41], v[200:201]
    v_pk_fma_f32 v[198:199], v[122:123], v[42:43], v[198:199]
    s_add_u32 s71, s71, 3072
    s_cbranch_vccnz L_th9_1
L_tb9_1:
    buffer_load_dwordx4 v[40:43], v1, s[28:31], s71 offen offset:0 nt
    v_add_f32_dpp v229, v228, v228 row_ror:8 row_mask:0xf bank_mask:0x3
    v_and_b32 v235, 0xffff0000, v184
    v_pk_mul_f32 v[152:153], v[234:235], v[116:117]
    v_lshlrev_b32 v234, 16, v190
    v_and_b32 v235, 0xffff0000, v190
    v_pk_fma_f32 v[202:203], v[152:153], v[234:235], v[202:203]
    s_waitcnt vmcnt(25)
    v_pk_fma_f32 v[198:199], v[124:125], v[44:45], v[198:199]
    v_pk_fma_f32 v[198:199], v[126:127], v[46:47], v[198:199]
    buffer_load_dwordx4 v[44:47], v1, s[28:31], s71 offen offset:256 nt
    v_lshlrev_b32 v234, 16, v185
    v_and_b32 v235, 0xffff0000, v185
L_h20:
    s_cbranch_execz L_h21
    v_pk_mul_f32 v[154:155], v[234:235], v[118:119]
    v_lshlrev_b32 v234, 16, v191
    v_and_b32 v235, 0xffff0000, v191
    s_waitcnt vmcnt(25)
    v_pk_fma_f32 v[198:199], v[128:129], v[48:49], v[198:199]
    v_pk_fma_f32 v[198:199], v[130:131], v[50:51], v[198:199]
    ds_add_u32 v224, v243 offset:3328
    buffer_load_dwordx4 v[48:51], v1, s[28:31], s71 offen offset:512 nt
    v_add_f32 v228, v198, v199
    v_pk_fma_f32 v[202:203], v[154:155], v[234:235], v[202:203]
    v_pk_mul_f32 v[202:203], v[202:203], s[62:63]
    s_waitcnt vmcnt(23)
    v_pk_fma_f32 v[198:199], v[144:145], v[52:53], v[202:203]
    v_pk_fma_f32 v[198:199], v[146:147], v[54:55], v[198:199]
    ds_read_b32 v244, v243 offset:147
    s_add_u32 s71, s71, 384000
    s_cbranch_vccnz L_th12_1
L_tb12_1:
    buffer_load_dwordx4 v[52:55], v1, s[28:31], s71 offen offset:0 nt
L_h21:
    s_cbranch_execz L_h22
    v_add_f32_dpp v229, v228, v228 row_ror:8 row_mask:0xf bank_mask:0xc
    s_waitcnt vmcnt(23)
    v_pk_fma_f32 v[198:199], v[148:149], v[56:57], v[198:199]
    v_pk_fma_f32 v[198:199], v[150:151], v[58:59], v[198:199]
    buffer_load_dwordx4 v[56:59], v1, s[28:31], s71 offen offset:256 nt
    v_add_f32_dpp v230, v229, v229 row_shr:4 row_mask:0xf bank_mask:0xa
    s_waitcnt vmcnt(23)
    v_pk_fma_f32 v[198:199], v[152:153], v[60:61], v[198:199]
    v_pk_fma_f32 v[198:199], v[154:155], v[62:63], v[198:199]
    s_waitcnt lgkmcnt(0)
    v_cmp_lt_u32 vcc, v0, v244
    ds_add_u32 v224, v243 offset:3328
    buffer_load_dwordx4 v[60:63], v1, s[28:31], s71 offen offset:512 nt
    v_add_f32_dpp v231, v230, v230 quad_perm:[2,3,0,1] row_mask:0xf bank_mask:0xf
    v_add_f32 v228, v198, v199
    s_waitcnt vmcnt(23)
    v_pk_fma_f32 v[198:199], v[144:145], v[64:65], v[202:203]
    v_pk_fma_f32 v[198:199], v[146:147], v[66:67], v[198:199]
    s_add_u32 s71, s71, 3072
L_h22:
    s_cbranch_execz L_h23
    s_cbranch_vccnz L_th15_1
L_tb15_1:
    buffer_load_dwordx4 v[64:67], v1, s[28:31], s71 offen offset:0 nt
    v_add_f32_dpp v229, v228, v228 row_ror:8 row_mask:0xf bank_mask:0x3
    s_waitcnt vmcnt(23)
    v_pk_fma_f32 v[198:199], v[148:149], v[68:69], v[198:199]
    v_pk_fma_f32 v[198:199], v[150:151], v[70:71], v[198:199]
    buffer_load_dwordx4 v[68:71], v1, s[28:31], s71 offen offset:256 nt
    s_waitcnt vmcnt(23)
    v_pk_fma_f32 v[198:199], v[152:153], v[72:73], v[198:199]
    v_pk_fma_f32 v[198:199], v[154:155], v[74:75], v[198:199]
    ds_add_u32 v224, v243 offset:3328
    buffer_load_dwordx4 v[72:75], v1, s[28:31], s71 offen offset:512 nt
    v_add_f32 v228, v198, v199
    s_waitcnt vmcnt(23)
    v_pk_fma_f32 v[198:199], v[144:145], v[76:77], v[202:203]
    v_pk_fma_f32 v[198:199], v[146:147], v[78:79], v[198:199]
    s_add_u32 s71, s71, 3072
    s_cbranch_vccnz L_th18_1
L_tb18_1:
L_h23:
    s_cbranch_execz L_h24
    buffer_load_dwordx4 v[76:79], v1, s[28:31], s71 offen offset:0 nt
    v_add_f32_dpp v229, v228, v228 row_ror:8 row_mask:0xf bank_mask:0xc
    s_waitcnt vmcnt(23)
    v_pk_fma_f32 v[198:199], v[148:149], v[80:81], v[198:199]
    v_pk_fma_f32 v[198:199], v[150:151], v[82:83], v[198:199]
    buffer_load_dwordx4 v[80:83], v1, s[28:31], s71 offen offset:256 nt
    v_add_f32_dpp v230, v229, v229 row_shl:4 row_mask:0xf bank_mask:0x5
    s_waitcnt vmcnt(23)
    v_pk_fma_f32 v[198:199], v[152:153], v[84:85], v[198:199]
    v_pk_fma_f32 v[198:199], v[154:155], v[86:87], v[198:199]
    ds_add_u32 v224, v243 offset:3328
    buffer_load_dwordx4 v[84:87], v1, s[28:31], s71 offen offset:512 nt
    v_add_f32 v228, v198, v199
    s_waitcnt vmcnt(23)
    v_pk_fma_f32 v[198:199], v[144:145], v[88:89], v[202:203]
    v_pk_fma_f32 v[198:199], v[146:147], v[90:91], v[198:199]
    s_add_u32 s71, s71, 3072
    s_cbranch_vccnz L_th21_1
L_tb21_1:
L_h24:
    s_cbranch_execz L_h25
    buffer_load_dwordx4 v[88:91], v1, s[28:31], s71 offen offset:0 nt
    v_add_f32_dpp v229, v228, v228 row_ror:8 row_mask:0xf bank_mask:0x3
    s_waitcnt vmcnt(23)
    v_pk_fma_f32 v[198:199], v[148:149], v[92:93], v[198:199]
    v_pk_fma_f32 v[198:199], v[150:151], v[94:95], v[198:199]
    buffer_load_dwordx4 v[92:95], v1, s[28:31], s71 offen offset:256 nt
    s_waitcnt vmcnt(23)
    v_pk_fma_f32 v[198:199], v[152:153], v[96:97], v[198:199]
    v_pk_fma_f32 v[198:199], v[154:155], v[98:99], v[198:199]
    ds_add_u32 v224, v243 offset:3328
    buffer_load_dwordx4 v[96:99], v1, s[28:31], s71 offen offset:512 nt
    v_add_f32 v228, v198, v199
    s_nop 1
    v_add_f32_dpp v229, v228, v228 row_ror:8 row_mask:0xf bank_mask:0xc
    s_nop 1
    v_add_f32_dpp v230, v229, v229 row_shr:4 row_mask:0xf bank_mask:0xa
    s_nop 1
    v_add_f32_dpp v232, v230, v230 quad_perm:[2,3,0,1] row_mask:0xf bank_mask:0xf
    s_nop 1
L_h25:
    s_cbranch_execz L_h26
    v_cndmask_b32 v232, v231, v232, s[64:65]
    s_nop 1
    v_add_f32_dpp v231, v232, v232 quad_perm:[1,0,3,2] row_mask:0xf bank_mask:0xf
    s_nop 1
    v_cndmask_b32 v233, v233, v231, s[66:67]
    v_mul_f32 v233, 0x58000000, v233
    ds_write_b32 v239, v233
    v_add_u32 v239, 256, v239
    s_mov_b64 exec, 1
    ds_add_u32 v243, v243 offset:127
    s_mov_b64 exec, -1
    ds_read_b32 v223, v240
    v_add_u32 v240, 256, v240
    v_lshlrev_b32 v220, 16, v220
    v_lshlrev_b32 v221, 16, v221
    s_waitcnt lgkmcnt(0)
    v_max_f32_dpp v234, v223, v223 row_ror:8 row_mask:0xf bank_mask:0xf
    s_nop 1
    v_max_f32_dpp v234, v234, v234 row_ror:4 row_mask:0xf bank_mask:0xf
    s_nop 1
L_h26:
    s_cbranch_execz L_h27
    v_max_f32_dpp v234, v234, v234 row_ror:2 row_mask:0xf bank_mask:0xf
    s_nop 1
    v_max_f32_dpp v234, v234, v234 row_ror:1 row_mask:0xf bank_mask:0xf
    v_mov_b32 v228, v216
    v_max3_f32 v234, v234, v228, s77
    v_sub_f32 v235, v228, v234
    v_sub_f32 v229, v223, v234
    v_exp_f32 v235, v235
    v_exp_f32 v229, v229
    s_nop 0
    v_mul_f32 v222, v229, v220
    v_mul_f32 v230, v222, v221
    v_mul_f32 v238, 0x71800000, v222
    s_nop 0
    s_mov_b32 s76, 63
L_loop1:
    v_mov_b32_dpp v236, v238 row_newbcast:0 row_mask:0xf bank_mask:0xf
    s_waitcnt vmcnt(23)
    v_pk_fma_f32 v[204:205], v[236:237], v[4:5], v[204:205] op_sel_hi:[0,1,1]
    v_pk_fma_f32 v[206:207], v[236:237], v[6:7], v[206:207] op_sel_hi:[0,1,1]
    ds_read_b32 v244, v243 offset:147
    s_add_u32 s71, s71, 384000
    s_cbranch_vccnz L_th24_2
L_tb24_2:
L_h27:
    s_cbranch_execz L_h28
    buffer_load_dwordx4 v[4:7], v1, s[28:31], s71 offen offset:0 nt
    s_bitcmp0_b32 s4, 0
    s_cbranch_scc1 L_nofl2
    s_mov_b64 exec, 1
    ds_add_u32 v242, v243
    s_mov_b64 exec, -1
    v_add_u32 v241, 4096, v241
    v_add_u32 v242, 4, v242
L_nofl2:
    s_waitcnt vmcnt(23)
    v_pk_fma_f32 v[208:209], v[236:237], v[8:9], v[208:209] op_sel_hi:[0,1,1]
    v_pk_fma_f32 v[210:211], v[236:237], v[10:11], v[210:211] op_sel_hi:[0,1,1]
    buffer_load_dwordx4 v[8:11], v1, s[28:31], s71 offen offset:256 nt
    v_pk_mul_f32 v[212:213], v[212:213], v[234:235] op_sel:[0,1] op_sel_hi:[1,1]
    v_pk_mul_f32 v[214:215], v[214:215], v[234:235] op_sel:[0,1] op_sel_hi:[1,1]
    v_mov_b32 v216, v234
    s_waitcnt vmcnt(23)
    v_pk_fma_f32 v[212:213], v[236:237], v[12:13], v[212:213] op_sel_hi:[0,1,1]
    v_pk_fma_f32 v[214:215], v[236:237], v[14:15], v[214:215] op_sel_hi:[0,1,1]
    s_nop 2
    s_waitcnt lgkmcnt(0)
    v_cmp_lt_u32 vcc, v0, v244
L_h28:
    s_cbranch_execz L_h29
    ds_add_u32 v224, v243 offset:3328
    buffer_load_dwordx4 v[12:15], v1, s[28:31], s71 offen offset:512 nt
    v_fma_f32 v217, v217, v235, v229
    v_mov_b32_dpp v236, v238 row_newbcast:8 row_mask:0xf bank_mask:0xf
    s_waitcnt vmcnt(23)
    v_pk_fma_f32 v[204:205], v[236:237], v[16:17], v[204:205] op_sel_hi:[0,1,1]
    v_pk_fma_f32 v[206:207], v[236:237], v[18:19], v[206:207] op_sel_hi:[0,1,1]
    s_add_u32 s71, s71, 3072
    s_cbranch_vccnz L_th27_2
L_tb27_2:
    buffer_load_dwordx4 v[16:19], v1, s[28:31], s71 offen offset:0 nt
    v_fma_f32 v218, v218, v235, v230
    s_waitcnt vmcnt(23)
    v_pk_fma_f32 v[208:209], v[236:237], v[20:21], v[208:209] op_sel_hi:[0,1,1]
    v_pk_fma_f32 v[210:211], v[236:237], v[22:23], v[210:211] op_sel_hi:[0,1,1]
    s_nop 2
    buffer_load_dwordx4 v[20:23], v1, s[28:31], s71 offen offset:256 nt
    ds_read_b32 v223, v240
    v_add_u32 v240, 256, v240
L_h29:
    s_cbranch_execz L_h30
    s_waitcnt vmcnt(23)
    v_pk_fma_f32 v[212:213], v[236:237], v[24:25], v[212:213] op_sel_hi:[0,1,1]
    v_pk_fma_f32 v[214:215], v[236:237], v[26:27], v[214:215] op_sel_hi:[0,1,1]
    ds_add_u32 v224, v243 offset:3328
    buffer_load_dwordx4 v[24:27], v1, s[28:31], s71 offen offset:512 nt
    v_mov_b32_dpp v236, v238 row_newbcast:4 row_mask:0xf bank_mask:0xf
    s_waitcnt vmcnt(23)
    v_pk_fma_f32 v[204:205], v[236:237], v[28:29], v[204:205] op_sel_hi:[0,1,1]
    v_pk_fma_f32 v[206:207], v[236:237], v[30:31], v[206:207] op_sel_hi:[0,1,1]
    s_nop 2
    s_add_u32 s71, s71, 3072
    s_cbranch_vccnz L_th30_2
L_tb30_2:
    buffer_load_dwordx4 v[28:31], v1, s[28:31], s71 offen offset:0 nt
    ds_write_b128 v241, v[216:219] offset:23552
    s_waitcnt vmcnt(23)
    v_pk_fma_f32 v[208:209], v[236:237], v[32:33], v[208:209] op_sel_hi:[0,1,1]
    v_pk_fma_f32 v[210:211], v[236:237], v[34:35], v[210:211] op_sel_hi:[0,1,1]
    s_nop 2
L_h30:
    s_cbranch_execz L_h31
    buffer_load_dwordx4 v[32:35], v1, s[28:31], s71 offen offset:256 nt
    s_waitcnt vmcnt(23)
    v_pk_fma_f32 v[212:213], v[236:237], v[36:37], v[212:213] op_sel_hi:[0,1,1]
    v_pk_fma_f32 v[214:215], v[236:237], v[38:39], v[214:215] op_sel_hi:[0,1,1]
    ds_add_u32 v224, v243 offset:3328
    buffer_load_dwordx4 v[36:39], v1, s[28:31], s71 offen offset:512 nt
    v_mov_b32_dpp v236, v238 row_newbcast:12 row_mask:0xf bank_mask:0xf
    s_waitcnt vmcnt(23)
    v_pk_fma_f32 v[204:205], v[236:237], v[40:41], v[204:205] op_sel_hi:[0,1,1]
    v_pk_fma_f32 v[206:207], v[236:237], v[42:43], v[206:207] op_sel_hi:[0,1,1]
    s_nop 2
    s_add_u32 s71, s71, 3072
    s_cbranch_vccnz L_th33_2
L_tb33_2:
    buffer_load_dwordx4 v[40:43], v1, s[28:31], s71 offen offset:0 nt
    s_waitcnt vmcnt(23)
    v_pk_fma_f32 v[208:209], v[236:237], v[44:45], v[208:209] op_sel_hi:[0,1,1]
    v_pk_fma_f32 v[210:211], v[236:237], v[46:47], v[210:211] op_sel_hi:[0,1,1]
    s_nop 2
    buffer_load_dwordx4 v[44:47], v1, s[28:31], s71 offen offset:256 nt
L_h31:
    s_cbranch_execz L_h32
    s_waitcnt vmcnt(23)
    v_pk_fma_f32 v[212:213], v[236:237], v[48:49], v[212:213] op_sel_hi:[0,1,1]
    v_pk_fma_f32 v[214:215], v[236:237], v[50:51], v[214:215] op_sel_hi:[0,1,1]
    ds_add_u32 v224, v243 offset:3328
    buffer_load_dwordx4 v[48:51], v1, s[28:31], s71 offen offset:512 nt
    v_mov_b32_dpp v236, v238 row_newbcast:2 row_mask:0xf bank_mask:0xf
    s_waitcnt vmcnt(23)
    v_pk_fma_f32 v[204:205], v[236:237], v[52:53], v[204:205] op_sel_hi:[0,1,1]
    v_pk_fma_f32 v[206:207], v[236:237], v[54:55], v[206:207] op_sel_hi:[0,1,1]
    s_nop 2
    ds_read_b32 v244, v243 offset:147
    v_readlane_b32 s70, v245, s91
    s_add_u32 s91, s91, 1
    s_and_b32 s80, s70, 31
    s_mul_i32 s80, s80, 96
    s_lshl_b32 s73, s70, 7
    s_sub_u32 s73, s73, s80
    buffer_load_ushort v220, v3, s[40:43], s73 offen
    buffer_load_ushort v221, v3, s[44:47], s73 offen
L_h32:
    s_cbranch_execz L_h33
    s_add_u32 s71, s71, 384000
    s_cbranch_vccnz L_th36_2
L_tb36_2:
    buffer_load_dwordx4 v[52:55], v1, s[28:31], s71 offen offset:0 nt
    s_waitcnt vmcnt(25)
    v_pk_fma_f32 v[208:209], v[236:237], v[56:57], v[208:209] op_sel_hi:[0,1,1]
    v_pk_fma_f32 v[210:211], v[236:237], v[58:59], v[210:211] op_sel_hi:[0,1,1]
    buffer_load_dwordx4 v[56:59], v1, s[28:31], s71 offen offset:256 nt
    s_waitcnt vmcnt(25)
    v_pk_fma_f32 v[212:213], v[236:237], v[60:61], v[212:213] op_sel_hi:[0,1,1]
    v_pk_fma_f32 v[214:215], v[236:237], v[62:63], v[214:215] op_sel_hi:[0,1,1]
    s_nop 2
    s_waitcnt lgkmcnt(0)
    v_cmp_lt_u32 vcc, v0, v244
    ds_add_u32 v224, v243 offset:3328
    buffer_load_dwordx4 v[60:63], v1, s[28:31], s71 offen offset:512 nt
    v_mov_b32_dpp v236, v238 row_newbcast:10 row_mask:0xf bank_mask:0xf
    s_waitcnt vmcnt(25)
    v_pk_fma_f32 v[204:205], v[236:237], v[64:65], v[204:205] op_sel_hi:[0,1,1]
    v_pk_fma_f32 v[206:207], v[236:237], v[66:67], v[206:207] op_sel_hi:[0,1,1]
L_h33:
    s_cbranch_execz L_h34
    s_add_u32 s71, s71, 3072
    s_cbranch_vccnz L_th39_2
L_tb39_2:
    buffer_load_dwordx4 v[64:67], v1, s[28:31], s71 offen offset:0 nt
    s_waitcnt vmcnt(25)
    v_pk_fma_f32 v[208:209], v[236:237], v[68:69], v[208:209] op_sel_hi:[0,1,1]
    v_pk_fma_f32 v[210:211], v[236:237], v[70:71], v[210:211] op_sel_hi:[0,1,1]
    s_nop 2
    buffer_load_dwordx4 v[68:71], v1, s[28:31], s71 offen offset:256 nt
    s_waitcnt vmcnt(25)
    v_pk_fma_f32 v[212:213], v[236:237], v[72:73], v[212:213] op_sel_hi:[0,1,1]
    v_pk_fma_f32 v[214:215], v[236:237], v[74:75], v[214:215] op_sel_hi:[0,1,1]
    s_nop 2
    ds_add_u32 v224, v243 offset:3328
    buffer_load_dwordx4 v[72:75], v1, s[28:31], s71 offen offset:512 nt
    v_mov_b32_dpp v236, v238 row_newbcast:6 row_mask:0xf bank_mask:0xf
    s_waitcnt vmcnt(25)
    v_pk_fma_f32 v[204:205], v[236:237], v[76:77], v[204:205] op_sel_hi:[0,1,1]
    v_pk_fma_f32 v[206:207], v[236:237], v[78:79], v[206:207] op_sel_hi:[0,1,1]
L_h34:
    s_cbranch_execz L_h35
    s_add_u32 s71, s71, 3072
    s_cbranch_vccnz L_th42_2
L_tb42_2:
    buffer_load_dwordx4 v[76:79], v1, s[28:31], s71 offen offset:0 nt
    s_waitcnt vmcnt(25)
    v_pk_fma_f32 v[208:209], v[236:237], v[80:81], v[208:209] op_sel_hi:[0,1,1]
    v_pk_fma_f32 v[210:211], v[236:237], v[82:83], v[210:211] op_sel_hi:[0,1,1]
    s_nop 2
    buffer_load_dwordx4 v[80:83], v1, s[28:31], s71 offen offset:256 nt
    s_waitcnt vmcnt(25)
    v_pk_fma_f32 v[212:213], v[236:237], v[84:85], v[212:213] op_sel_hi:[0,1,1]
    v_pk_fma_f32 v[214:215], v[236:237], v[86:87], v[214:215] op_sel_hi:[0,1,1]
    s_nop 2
    ds_add_u32 v224, v243 offset:3328
    buffer_load_dwordx4 v[84:87], v1, s[28:31], s71 offen offset:512 nt
    v_mov_b32_dpp v236, v238 row_newbcast:14 row_mask:0xf bank_mask:0xf
    s_waitcnt vmcnt(25)
    v_pk_fma_f32 v[204:205], v[236:237], v[88:89], v[204:205] op_sel_hi:[0,1,1]
    v_pk_fma_f32 v[206:207], v[236:237], v[90:91], v[206:207] op_sel_hi:[0,1,1]
    s_nop 2
L_h35:
    s_cbranch_execz L_h36
    s_add_u32 s71, s71, 3072
    s_cbranch_vccnz L_th45_2
L_tb45_2:
    buffer_load_dwordx4 v[88:91], v1, s[28:31], s71 offen offset:0 nt
    s_waitcnt vmcnt(25)
    v_pk_fma_f32 v[208:209], v[236:237], v[92:93], v[208:209] op_sel_hi:[0,1,1]
    v_pk_fma_f32 v[210:211], v[236:237], v[94:95], v[210:211] op_sel_hi:[0,1,1]
    buffer_load_dwordx4 v[92:95], v1, s[28:31], s71 offen offset:256 nt
    s_cmp_eq_u32 s76, 16
    s_cbranch_scc1 L_getm2
L_gotm2:
    s_waitcnt vmcnt(25)
    v_pk_fma_f32 v[212:213], v[236:237], v[96:97], v[212:213] op_sel_hi:[0,1,1]
    v_pk_fma_f32 v[214:215], v[236:237], v[98:99], v[214:215] op_sel_hi:[0,1,1]
    s_nop 2
    ds_add_u32 v224, v243 offset:3328
    buffer_load_dwordx4 v[96:99], v1, s[28:31], s71 offen offset:512 nt
    v_mov_b32_dpp v236, v238 row_newbcast:1 row_mask:0xf bank_mask:0xf
    s_waitcnt vmcnt(25)
    v_pk_fma_f32 v[204:205], v[236:237], v[4:5], v[204:205] op_sel_hi:[0,1,1]
    v_pk_fma_f32 v[206:207], v[236:237], v[6:7], v[206:207] op_sel_hi:[0,1,1]
L_h36:
    s_cbranch_execz L_h37
    ds_read_b32 v244, v243 offset:147
    s_mul_i32 s71, s70, 49152
    s_and_b32 s80, s70, 31
    s_mul_i32 s80, s80, 36864
    s_sub_u32 s71, s71, s80
    s_cbranch_vccnz L_th0_2
L_tb0_2:
    buffer_load_dwordx4 v[4:7], v1, s[28:31], s71 offen offset:0 nt
    s_waitcnt vmcnt(25)
    v_pk_fma_f32 v[208:209], v[236:237], v[8:9], v[208:209] op_sel_hi:[0,1,1]
    v_pk_fma_f32 v[210:211], v[236:237], v[10:11], v[210:211] op_sel_hi:[0,1,1]
    s_nop 2
    buffer_load_dwordx4 v[8:11], v1, s[28:31], s71 offen offset:256 nt
    s_waitcnt vmcnt(25)
    v_pk_fma_f32 v[212:213], v[236:237], v[12:13], v[212:213] op_sel_hi:[0,1,1]
    v_pk_fma_f32 v[214:215], v[236:237], v[14:15], v[214:215] op_sel_hi:[0,1,1]
    s_nop 2
    s_waitcnt lgkmcnt(0)
    v_cmp_lt_u32 vcc, v0, v244
    ds_add_u32 v224, v243 offset:3328
    buffer_load_dwordx4 v[12:15], v1, s[28:31], s71 offen offset:512 nt
L_h37:
    s_cbranch_execz L_h38
    v_max_f32_dpp v234, v223, v223 row_ror:8 row_mask:0xf bank_mask:0xf
    v_mov_b32_dpp v236, v238 row_newbcast:9 row_mask:0xf bank_mask:0xf
    s_waitcnt vmcnt(25)
    v_pk_fma_f32 v[204:205], v[236:237], v[16:17], v[204:205] op_sel_hi:[0,1,1]
    v_pk_fma_f32 v[206:207], v[236:237], v[18:19], v[206:207] op_sel_hi:[0,1,1]
    s_add_u32 s71, s71, 3072
    s_cbranch_vccnz L_th3_2
L_tb3_2:
    buffer_load_dwordx4 v[16:19], v1, s[28:31], s71 offen offset:0 nt
    v_max_f32_dpp v234, v234, v234 row_ror:4 row_mask:0xf bank_mask:0xf
    s_waitcnt vmcnt(25)
    v_pk_fma_f32 v[208:209], v[236:237], v[20:21], v[208:209] op_sel_hi:[0,1,1]
    v_pk_fma_f32 v[210:211], v[236:237], v[22:23], v[210:211] op_sel_hi:[0,1,1]
    s_nop 2
    buffer_load_dwordx4 v[20:23], v1, s[28:31], s71 offen offset:256 nt
    v_max_f32_dpp v234, v234, v234 row_ror:2 row_mask:0xf bank_mask:0xf
    s_waitcnt vmcnt(25)
    v_pk_fma_f32 v[212:213], v[236:237], v[24:25], v[212:213] op_sel_hi:[0,1,1]
    v_pk_fma_f32 v[214:215], v[236:237], v[26:27], v[214:215] op_sel_hi:[0,1,1]
L_h38:
    s_cbranch_execz L_h39
    ds_add_u32 v224, v243 offset:3328
    buffer_load_dwordx4 v[24:27], v1, s[28:31], s71 offen offset:512 nt
    v_max_f32_dpp v234, v234, v234 row_ror:1 row_mask:0xf bank_mask:0xf
    v_mov_b32_dpp v236, v238 row_newbcast:5 row_mask:0xf bank_mask:0xf
    s_waitcnt vmcnt(25)
    v_pk_fma_f32 v[204:205], v[236:237], v[28:29], v[204:205] op_sel_hi:[0,1,1]
    v_pk_fma_f32 v[206:207], v[236:237], v[30:31], v[206:207] op_sel_hi:[0,1,1]
    s_nop 2
    s_add_u32 s71, s71, 3072
    s_cbranch_vccnz L_th6_2
L_tb6_2:
    buffer_load_dwordx4 v[28:31], v1, s[28:31], s71 offen offset:0 nt
    s_lshr_b64 s[4:5], s[4:5], 1
    s_bitcmp1_b32 s4, 0
    s_cselect_b32 s6, s7, 0x7f7fffff
    v_min_f32 v228, s6, v216
    s_waitcnt vmcnt(25)
    v_pk_fma_f32 v[208:209], v[236:237], v[32:33], v[208:209] op_sel_hi:[0,1,1]
    v_pk_fma_f32 v[210:211], v[236:237], v[34:35], v[210:211] op_sel_hi:[0,1,1]
    s_nop 2
    buffer_load_dwordx4 v[32:35], v1, s[28:31], s71 offen offset:256 nt
L_h39:
    s_cbranch_execz L_h40
    v_max3_f32 v234, v234, v228, s77
    s_waitcnt vmcnt(25)
    v_pk_fma_f32 v[212:213], v[236:237], v[36:37], v[212:213] op_sel_hi:[0,1,1]
    v_pk_fma_f32 v[214:215], v[236:237], v[38:39], v[214:215] op_sel_hi:[0,1,1]
    ds_add_u32 v224, v243 offset:3328
    buffer_load_dwordx4 v[36:39], v1, s[28:31], s71 offen offset:512 nt
    v_sub_f32 v235, v228, v234
    v_sub_f32 v229, v223, v234
    v_mov_b32_dpp v236, v238 row_newbcast:13 row_mask:0xf bank_mask:0xf
    s_waitcnt vmcnt(25)
    v_pk_fma_f32 v[204:205], v[236:237], v[40:41], v[204:205] op_sel_hi:[0,1,1]
    v_pk_fma_f32 v[206:207], v[236:237], v[42:43], v[206:207] op_sel_hi:[0,1,1]
    s_nop 2
    s_add_u32 s71, s71, 3072
    s_cbranch_vccnz L_th9_2
L_tb9_2:
    buffer_load_dwordx4 v[40:43], v1, s[28:31], s71 offen offset:0 nt
    v_exp_f32 v235, v235
    s_waitcnt vmcnt(25)
    v_pk_fma_f32 v[208:209], v[236:237], v[44:45], v[208:209] op_sel_hi:[0,1,1]
L_h40:
    s_cbranch_execz L_h41
    v_pk_fma_f32 v[210:211], v[236:237], v[46:47], v[210:211] op_sel_hi:[0,1,1]
    buffer_load_dwordx4 v[44:47], v1, s[28:31], s71 offen offset:256 nt
    v_exp_f32 v229, v229
    s_waitcnt vmcnt(25)
    v_pk_fma_f32 v[212:213], v[236:237], v[48:49], v[212:213] op_sel_hi:[0,1,1]
    v_pk_fma_f32 v[214:215], v[236:237], v[50:51], v[214:215] op_sel_hi:[0,1,1]
    s_nop 2
    ds_add_u32 v224, v243 offset:3328
    buffer_load_dwordx4 v[48:51], v1, s[28:31], s71 offen offset:512 nt
    v_mov_b32_dpp v236, v238 row_newbcast:3 row_mask:0xf bank_mask:0xf
    s_waitcnt vmcnt(23)
    v_pk_fma_f32 v[204:205], v[236:237], v[52:53], v[204:205] op_sel_hi:[0,1,1]
    v_pk_fma_f32 v[206:207], v[236:237], v[54:55], v[206:207] op_sel_hi:[0,1,1]
    s_nop 2
    ds_read_b32 v244, v243 offset:147
    s_add_u32 s71, s71, 384000
    s_cbranch_vccnz L_th12_2
L_tb12_2:
    buffer_load_dwordx4 v[52:55], v1, s[28:31], s71 offen offset:0 nt
    v_lshlrev_b32 v220, 16, v220
L_h41:
    s_cbranch_execz L_h42
    s_waitcnt vmcnt(23)
    v_pk_fma_f32 v[208:209], v[236:237], v[56:57], v[208:209] op_sel_hi:[0,1,1]
    v_pk_fma_f32 v[210:211], v[236:237], v[58:59], v[210:211] op_sel_hi:[0,1,1]
    buffer_load_dwordx4 v[56:59], v1, s[28:31], s71 offen offset:256 nt
    v_lshlrev_b32 v221, 16, v221
    s_waitcnt vmcnt(23)
    v_pk_fma_f32 v[212:213], v[236:237], v[60:61], v[212:213] op_sel_hi:[0,1,1]
    v_pk_fma_f32 v[214:215], v[236:237], v[62:63], v[214:215] op_sel_hi:[0,1,1]
    s_nop 2
    s_waitcnt lgkmcnt(0)
    v_cmp_lt_u32 vcc, v0, v244
    ds_add_u32 v224, v243 offset:3328
    buffer_load_dwordx4 v[60:63], v1, s[28:31], s71 offen offset:512 nt
    v_mov_b32_dpp v236, v238 row_newbcast:11 row_mask:0xf bank_mask:0xf
    s_waitcnt vmcnt(23)
    v_pk_fma_f32 v[204:205], v[236:237], v[64:65], v[204:205] op_sel_hi:[0,1,1]
    v_pk_fma_f32 v[206:207], v[236:237], v[66:67], v[206:207] op_sel_hi:[0,1,1]
    s_nop 2
    s_add_u32 s71, s71, 3072
    s_cbranch_vccnz L_th15_2
L_tb15_2:
L_h42:
    s_cbranch_execz L_h43
    buffer_load_dwordx4 v[64:67], v1, s[28:31], s71 offen offset:0 nt
    v_mul_f32 v222, v229, v220
    s_waitcnt vmcnt(23)
    v_pk_fma_f32 v[208:209], v[236:237], v[68:69], v[208:209] op_sel_hi:[0,1,1]
    v_pk_fma_f32 v[210:211], v[236:237], v[70:71], v[210:211] op_sel_hi:[0,1,1]
    buffer_load_dwordx4 v[68:71], v1, s[28:31], s71 offen offset:256 nt
    v_mul_f32 v230, v222, v221
    s_waitcnt vmcnt(23)
    v_pk_fma_f32 v[212:213], v[236:237], v[72:73], v[212:213] op_sel_hi:[0,1,1]
    v_pk_fma_f32 v[214:215], v[236:237], v[74:75], v[214:215] op_sel_hi:[0,1,1]
    s_nop 2
    ds_add_u32 v224, v243 offset:3328
    buffer_load_dwordx4 v[72:75], v1, s[28:31], s71 offen offset:512 nt
    v_mov_b32_dpp v236, v238 row_newbcast:7 row_mask:0xf bank_mask:0xf
    s_waitcnt vmcnt(23)
    v_pk_fma_f32 v[204:205], v[236:237], v[76:77], v[204:205] op_sel_hi:[0,1,1]
    v_pk_fma_f32 v[206:207], v[236:237], v[78:79], v[206:207] op_sel_hi:[0,1,1]
    s_nop 2
    s_add_u32 s71, s71, 3072
L_h43:
    s_cbranch_execz L_h44
    s_cbranch_vccnz L_th18_2
L_tb18_2:
    buffer_load_dwordx4 v[76:79], v1, s[28:31], s71 offen offset:0 nt
    s_waitcnt vmcnt(23)
    v_pk_fma_f32 v[208:209], v[236:237], v[80:81], v[208:209] op_sel_hi:[0,1,1]
    v_pk_fma_f32 v[210:211], v[236:237], v[82:83], v[210:211] op_sel_hi:[0,1,1]
    buffer_load_dwordx4 v[80:83], v1, s[28:31], s71 offen offset:256 nt
    s_waitcnt vmcnt(23)
    v_pk_fma_f32 v[212:213], v[236:237], v[84:85], v[212:213] op_sel_hi:[0,1,1]
    v_pk_fma_f32 v[214:215], v[236:237], v[86:87], v[214:215] op_sel_hi:[0,1,1]
    s_nop 2
    ds_add_u32 v224, v243 offset:3328
    buffer_load_dwordx4 v[84:87], v1, s[28:31], s71 offen offset:512 nt
    v_mov_b32_dpp v236, v238 row_newbcast:15 row_mask:0xf bank_mask:0xf
    s_waitcnt vmcnt(23)
    v_pk_fma_f32 v[204:205], v[236:237], v[88:89], v[204:205] op_sel_hi:[0,1,1]
    v_pk_fma_f32 v[206:207], v[236:237], v[90:91], v[206:207] op_sel_hi:[0,1,1]
    s_nop 2
    s_add_u32 s71, s71, 3072
    s_cbranch_vccnz L_th21_2
L_tb21_2:
L_h44:
    s_cbranch_execz L_h45
    buffer_load_dwordx4 v[88:91], v1, s[28:31], s71 offen offset:0 nt
    ds_write_b128 v241, v[204:207] offset:20480
    v_mul_f32 v238, 0x71800000, v222
    s_waitcnt vmcnt(23)
    v_pk_fma_f32 v[208:209], v[236:237], v[92:93], v[208:209] op_sel_hi:[0,1,1]
    v_pk_fma_f32 v[210:211], v[236:237], v[94:95], v[210:211] op_sel_hi:[0,1,1]
    buffer_load_dwordx4 v[92:95], v1, s[28:31], s71 offen offset:256 nt
    ds_write_b128 v241, v[208:211] offset:21504
    v_pk_mul_f32 v[204:205], v[204:205], v[234:235] op_sel:[0,1] op_sel_hi:[1,1]
    v_pk_mul_f32 v[206:207], v[206:207], v[234:235] op_sel:[0,1] op_sel_hi:[1,1]
    s_waitcnt vmcnt(23)
    v_pk_fma_f32 v[212:213], v[236:237], v[96:97], v[212:213] op_sel_hi:[0,1,1]
    v_pk_fma_f32 v[214:215], v[236:237], v[98:99], v[214:215] op_sel_hi:[0,1,1]
    s_nop 2
    ds_add_u32 v224, v243 offset:3328
    buffer_load_dwordx4 v[96:99], v1, s[28:31], s71 offen offset:512 nt
    ds_write_b128 v241, v[212:215] offset:22528
L_h45:
    s_cbranch_execz L_h46
    v_pk_mul_f32 v[208:209], v[208:209], v[234:235] op_sel:[0,1] op_sel_hi:[1,1]
    v_pk_mul_f32 v[210:211], v[210:211], v[234:235] op_sel:[0,1] op_sel_hi:[1,1]
    s_sub_u32 s76, s76, 1
    s_cmp_lg_u32 s76, 0
    s_cbranch_scc1 L_loop1
    v_mov_b32_dpp v236, v238 row_newbcast:0 row_mask:0xf bank_mask:0xf
    s_waitcnt vmcnt(23)
    v_pk_fma_f32 v[204:205], v[236:237], v[4:5], v[204:205] op_sel_hi:[0,1,1]
    v_pk_fma_f32 v[206:207], v[236:237], v[6:7], v[206:207] op_sel_hi:[0,1,1]
    ds_read_b32 v244, v243 offset:147
    s_add_u32 s71, s71, 384000
    s_cbranch_vccnz L_th24_3
L_tb24_3:
    buffer_load_dwordx4 v[4:7], v1, s[28:31], s71 offen offset:0 nt
    s_bitcmp0_b32 s4, 0
    s_cbranch_scc1 L_nofl3
    s_mov_b64 exec, 1
    ds_add_u32 v242, v243
    s_mov_b64 exec, -1
    v_add_u32 v241, 4096, v241
    v_add_u32 v242, 4, v242
L_nofl3:
    s_waitcnt vmcnt(23)
L_h46:
    s_cbranch_execz L_h47
    v_pk_fma_f32 v[208:209], v[236:237], v[8:9], v[208:209] op_sel_hi:[0,1,1]
    v_pk_fma_f32 v[210:211], v[236:237], v[10:11], v[210:211] op_sel_hi:[0,1,1]
    buffer_load_dwordx4 v[8:11], v1, s[28:31], s71 offen offset:256 nt
    v_pk_mul_f32 v[212:213], v[212:213], v[234:235] op_sel:[0,1] op_sel_hi:[1,1]
    v_pk_mul_f32 v[214:215], v[214:215], v[234:235] op_sel:[0,1] op_sel_hi:[1,1]
    v_mov_b32 v216, v234
    s_waitcnt vmcnt(23)
    v_pk_fma_f32 v[212:213], v[236:237], v[12:13], v[212:213] op_sel_hi:[0,1,1]
    v_pk_fma_f32 v[214:215], v[236:237], v[14:15], v[214:215] op_sel_hi:[0,1,1]
    s_nop 2
    s_waitcnt lgkmcnt(0)
    v_cmp_lt_u32 vcc, v0, v244
    ds_add_u32 v224, v243 offset:3328
    buffer_load_dwordx4 v[12:15], v1, s[28:31], s71 offen offset:512 nt
    v_fma_f32 v217, v217, v235, v229
    v_mov_b32_dpp v236, v238 row_newbcast:8 row_mask:0xf bank_mask:0xf
    s_waitcnt vmcnt(23)
    v_pk_fma_f32 v[204:205], v[236:237], v[16:17], v[204:205] op_sel_hi:[0,1,1]
    v_pk_fma_f32 v[206:207], v[236:237], v[18:19], v[206:207] op_sel_hi:[0,1,1]
L_h47:
    s_cbranch_execz L_h48
    s_add_u32 s71, s71, 3072
    s_cbranch_vccnz L_th27_3
L_tb27_3:
    buffer_load_dwordx4 v[16:19], v1, s[28:31], s71 offen offset:0 nt
    v_fma_f32 v218, v218, v235, v230
    s_waitcnt vmcnt(23)
    v_pk_fma_f32 v[208:209], v[236:237], v[20:21], v[208:209] op_sel_hi:[0,1,1]
    v_pk_fma_f32 v[210:211], v[236:237], v[22:23], v[210:211] op_sel_hi:[0,1,1]
    s_nop 2
    buffer_load_dwordx4 v[20:23], v1, s[28:31], s71 offen offset:256 nt
    s_mov_b64 exec, s[88:89]
    buffer_store_dwordx4 v[100:103], v225, s[52:55], s78 offen offset:0
    s_mov_b64 exec, -1
    s_waitcnt vmcnt(23)
    v_pk_fma_f32 v[212:213], v[236:237], v[24:25], v[212:213] op_sel_hi:[0,1,1]
    v_pk_fma_f32 v[214:215], v[236:237], v[26:27], v[214:215] op_sel_hi:[0,1,1]
    s_nop 2
    ds_add_u32 v224, v243 offset:3328
    buffer_load_dwordx4 v[24:27], v1, s[28:31], s71 offen offset:512 nt
    v_add_f32_dpp v218, v218, v218 row_ror:8 row_mask:0xf bank_mask:0xf
L_h48:
    s_cbranch_execz L_h49
    v_mov_b32_dpp v236, v238 row_newbcast:4 row_mask:0xf bank_mask:0xf
    s_waitcnt vmcnt(23)
    v_pk_fma_f32 v[204:205], v[236:237], v[28:29], v[204:205] op_sel_hi:[0,1,1]
    v_pk_fma_f32 v[206:207], v[236:237], v[30:31], v[206:207] op_sel_hi:[0,1,1]
    s_add_u32 s71, s71, 3072
    s_cbranch_vccnz L_th30_3
L_tb30_3:
    buffer_load_dwordx4 v[28:31], v1, s[28:31], s71 offen offset:0 nt
    v_add_f32_dpp v218, v218, v218 row_ror:4 row_mask:0xf bank_mask:0xf
    s_waitcnt vmcnt(23)
    v_pk_fma_f32 v[208:209], v[236:237], v[32:33], v[208:209] op_sel_hi:[0,1,1]
    v_pk_fma_f32 v[210:211], v[236:237], v[34:35], v[210:211] op_sel_hi:[0,1,1]
    s_nop 2
    buffer_load_dwordx4 v[32:35], v1, s[28:31], s71 offen offset:256 nt
    v_add_f32_dpp v218, v218, v218 row_ror:2 row_mask:0xf bank_mask:0xf
    s_waitcnt vmcnt(23)
    v_pk_fma_f32 v[212:213], v[236:237], v[36:37], v[212:213] op_sel_hi:[0,1,1]
    v_pk_fma_f32 v[214:215], v[236:237], v[38:39], v[214:215] op_sel_hi:[0,1,1]
    s_nop 2
L_h49:
    s_cbranch_execz L_h50
    ds_add_u32 v224, v243 offset:3328
    buffer_load_dwordx4 v[36:39], v1, s[28:31], s71 offen offset:512 nt
    v_add_f32_dpp v218, v218, v218 row_ror:1 row_mask:0xf bank_mask:0xf
    v_mov_b32_dpp v236, v238 row_newbcast:12 row_mask:0xf bank_mask:0xf
    s_waitcnt vmcnt(23)
    v_pk_fma_f32 v[204:205], v[236:237], v[40:41], v[204:205] op_sel_hi:[0,1,1]
    v_pk_fma_f32 v[206:207], v[236:237], v[42:43], v[206:207] op_sel_hi:[0,1,1]
    s_add_u32 s71, s71, 3072
    s_cbranch_vccnz L_th33_3
L_tb33_3:
    buffer_load_dwordx4 v[40:43], v1, s[28:31], s71 offen offset:0 nt
    v_mov_b32 v234, v218
    s_waitcnt vmcnt(23)
    v_pk_fma_f32 v[208:209], v[236:237], v[44:45], v[208:209] op_sel_hi:[0,1,1]
    v_pk_fma_f32 v[210:211], v[236:237], v[46:47], v[210:211] op_sel_hi:[0,1,1]
    s_nop 2
    buffer_load_dwordx4 v[44:47], v1, s[28:31], s71 offen offset:256 nt
    v_permlane32_swap_b32 v218, v234
    s_waitcnt vmcnt(23)
    v_pk_fma_f32 v[212:213], v[236:237], v[48:49], v[212:213] op_sel_hi:[0,1,1]
L_h50:
    s_cbranch_execz L_h51
    v_pk_fma_f32 v[214:215], v[236:237], v[50:51], v[214:215] op_sel_hi:[0,1,1]
    ds_add_u32 v224, v243 offset:3328
    buffer_load_dwordx4 v[48:51], v1, s[28:31], s71 offen offset:512 nt
    v_add_f32 v218, v218, v234
    v_mov_b32_dpp v236, v238 row_newbcast:2 row_mask:0xf bank_mask:0xf
    s_waitcnt vmcnt(23)
    v_pk_fma_f32 v[204:205], v[236:237], v[52:53], v[204:205] op_sel_hi:[0,1,1]
    v_pk_fma_f32 v[206:207], v[236:237], v[54:55], v[206:207] op_sel_hi:[0,1,1]
    s_nop 2
    ds_read_b32 v244, v243 offset:147
    s_add_u32 s71, s71, 384000
    s_cbranch_vccnz L_th36_3
L_tb36_3:
    buffer_load_dwordx4 v[52:55], v1, s[28:31], s71 offen offset:0 nt
    v_mov_b32 v234, v218
    s_waitcnt vmcnt(23)
    v_pk_fma_f32 v[208:209], v[236:237], v[56:57], v[208:209] op_sel_hi:[0,1,1]
    v_pk_fma_f32 v[210:211], v[236:237], v[58:59], v[210:211] op_sel_hi:[0,1,1]
    s_nop 2
    buffer_load_dwordx4 v[56:59], v1, s[28:31], s71 offen offset:256 nt
L_h51:
    s_cbranch_execz L_h52
    v_permlane16_swap_b32 v218, v234
    s_waitcnt vmcnt(23)
    v_pk_fma_f32 v[212:213], v[236:237], v[60:61], v[212:213] op_sel_hi:[0,1,1]
    v_pk_fma_f32 v[214:215], v[236:237], v[62:63], v[214:215] op_sel_hi:[0,1,1]
    s_waitcnt lgkmcnt(0)
    v_cmp_lt_u32 vcc, v0, v244
    ds_add_u32 v224, v243 offset:3328
    buffer_load_dwordx4 v[60:63], v1, s[28:31], s71 offen offset:512 nt
    v_add_f32 v218, v218, v234
    v_mov_b32_dpp v236, v238 row_newbcast:10 row_mask:0xf bank_mask:0xf
    s_waitcnt vmcnt(23)
    v_pk_fma_f32 v[204:205], v[236:237], v[64:65], v[204:205] op_sel_hi:[0,1,1]
    v_pk_fma_f32 v[206:207], v[236:237], v[66:67], v[206:207] op_sel_hi:[0,1,1]
    s_nop 2
    s_add_u32 s71, s71, 3072
    s_cbranch_vccnz L_th39_3
L_tb39_3:
    buffer_load_dwordx4 v[64:67], v1, s[28:31], s71 offen offset:0 nt
    v_mov_b32 v103, s93
    v_lshlrev_b32 v235, 4, v0
    s_lshl_b32 s78, s3, 11
    s_mov_b32 s6, 0x58000000
L_h52:
    s_cbranch_execz L_h53
    s_waitcnt vmcnt(23)
    v_pk_fma_f32 v[208:209], v[236:237], v[68:69], v[208:209] op_sel_hi:[0,1,1]
    v_pk_fma_f32 v[210:211], v[236:237], v[70:71], v[210:211] op_sel_hi:[0,1,1]
    buffer_load_dwordx4 v[68:71], v1, s[28:31], s71 offen offset:256 nt
    s_waitcnt vmcnt(23)
    v_pk_fma_f32 v[212:213], v[236:237], v[72:73], v[212:213] op_sel_hi:[0,1,1]
    v_pk_fma_f32 v[214:215], v[236:237], v[74:75], v[214:215] op_sel_hi:[0,1,1]
    s_nop 2
    ds_add_u32 v224, v243 offset:3328
    buffer_load_dwordx4 v[72:75], v1, s[28:31], s71 offen offset:512 nt
    v_mov_b32_dpp v236, v238 row_newbcast:6 row_mask:0xf bank_mask:0xf
    s_waitcnt vmcnt(23)
    v_pk_fma_f32 v[204:205], v[236:237], v[76:77], v[204:205] op_sel_hi:[0,1,1]
    v_pk_fma_f32 v[206:207], v[236:237], v[78:79], v[206:207] op_sel_hi:[0,1,1]
    s_nop 2
    s_add_u32 s71, s71, 3072
    s_cbranch_vccnz L_th42_3
L_tb42_3:
    buffer_load_dwordx4 v[76:79], v1, s[28:31], s71 offen offset:0 nt
    s_waitcnt vmcnt(23)
L_h53:
    s_cbranch_execz L_h54
    v_pk_fma_f32 v[208:209], v[236:237], v[80:81], v[208:209] op_sel_hi:[0,1,1]
    v_pk_fma_f32 v[210:211], v[236:237], v[82:83], v[210:211] op_sel_hi:[0,1,1]
    buffer_load_dwordx4 v[80:83], v1, s[28:31], s71 offen offset:256 nt
    s_waitcnt vmcnt(23)
    v_pk_fma_f32 v[212:213], v[236:237], v[84:85], v[212:213] op_sel_hi:[0,1,1]
    v_pk_fma_f32 v[214:215], v[236:237], v[86:87], v[214:215] op_sel_hi:[0,1,1]
    s_nop 2
    ds_add_u32 v224, v243 offset:3328
    buffer_load_dwordx4 v[84:87], v1, s[28:31], s71 offen offset:512 nt
    v_mov_b32_dpp v236, v238 row_newbcast:14 row_mask:0xf bank_mask:0xf
    s_waitcnt vmcnt(23)
    v_pk_fma_f32 v[204:205], v[236:237], v[88:89], v[204:205] op_sel_hi:[0,1,1]
    v_pk_fma_f32 v[206:207], v[236:237], v[90:91], v[206:207] op_sel_hi:[0,1,1]
    s_nop 2
    s_add_u32 s71, s71, 3072
    s_cbranch_vccnz L_th45_3
L_tb45_3:
    buffer_load_dwordx4 v[88:91], v1, s[28:31], s71 offen offset:0 nt
    s_waitcnt vmcnt(23)
    v_pk_fma_f32 v[208:209], v[236:237], v[92:93], v[208:209] op_sel_hi:[0,1,1]
L_h54:
    s_cbranch_execz L_h55
    v_pk_fma_f32 v[210:211], v[236:237], v[94:95], v[210:211] op_sel_hi:[0,1,1]
    buffer_load_dwordx4 v[92:95], v1, s[28:31], s71 offen offset:256 nt
    s_waitcnt vmcnt(23)
    v_pk_fma_f32 v[212:213], v[236:237], v[96:97], v[212:213] op_sel_hi:[0,1,1]
    v_pk_fma_f32 v[214:215], v[236:237], v[98:99], v[214:215] op_sel_hi:[0,1,1]
    s_nop 2
    ds_add_u32 v224, v243 offset:3328
    buffer_load_dwordx4 v[96:99], v1, s[28:31], s71 offen offset:512 nt
    ds_write_b32 v243, v243 offset:143
    v_mov_b32_dpp v236, v238 row_newbcast:1 row_mask:0xf bank_mask:0xf
    s_waitcnt vmcnt(23)
    v_pk_fma_f32 v[204:205], v[236:237], v[4:5], v[204:205] op_sel_hi:[0,1,1]
    v_pk_fma_f32 v[206:207], v[236:237], v[6:7], v[206:207] op_sel_hi:[0,1,1]
    s_waitcnt vmcnt(22)
    v_pk_fma_f32 v[208:209], v[236:237], v[8:9], v[208:209] op_sel_hi:[0,1,1]
    v_pk_fma_f32 v[210:211], v[236:237], v[10:11], v[210:211] op_sel_hi:[0,1,1]
    s_waitcnt vmcnt(21)
    v_pk_fma_f32 v[212:213], v[236:237], v[12:13], v[212:213] op_sel_hi:[0,1,1]
L_h55:
    s_cbranch_execz L_h56
    v_pk_fma_f32 v[214:215], v[236:237], v[14:15], v[214:215] op_sel_hi:[0,1,1]
    v_mov_b32_dpp v236, v238 row_newbcast:9 row_mask:0xf bank_mask:0xf
    s_waitcnt vmcnt(20)
    v_pk_fma_f32 v[204:205], v[236:237], v[16:17], v[204:205] op_sel_hi:[0,1,1]
    v_pk_fma_f32 v[206:207], v[236:237], v[18:19], v[206:207] op_sel_hi:[0,1,1]
    s_waitcnt vmcnt(19)
    v_pk_fma_f32 v[208:209], v[236:237], v[20:21], v[208:209] op_sel_hi:[0,1,1]
    v_pk_fma_f32 v[210:211], v[236:237], v[22:23], v[210:211] op_sel_hi:[0,1,1]
    s_waitcnt vmcnt(18)
    v_pk_fma_f32 v[212:213], v[236:237], v[24:25], v[212:213] op_sel_hi:[0,1,1]
    v_pk_fma_f32 v[214:215], v[236:237], v[26:27], v[214:215] op_sel_hi:[0,1,1]
    v_mov_b32_dpp v236, v238 row_newbcast:5 row_mask:0xf bank_mask:0xf
    s_waitcnt vmcnt(17)
    v_pk_fma_f32 v[204:205], v[236:237], v[28:29], v[204:205] op_sel_hi:[0,1,1]
    v_pk_fma_f32 v[206:207], v[236:237], v[30:31], v[206:207] op_sel_hi:[0,1,1]
    s_waitcnt vmcnt(16)
    v_pk_fma_f32 v[208:209], v[236:237], v[32:33], v[208:209] op_sel_hi:[0,1,1]
    v_pk_fma_f32 v[210:211], v[236:237], v[34:35], v[210:211] op_sel_hi:[0,1,1]
L_h56:
    s_cbranch_execz L_h57
    s_waitcnt vmcnt(15)
    v_pk_fma_f32 v[212:213], v[236:237], v[36:37], v[212:213] op_sel_hi:[0,1,1]
    v_pk_fma_f32 v[214:215], v[236:237], v[38:39], v[214:215] op_sel_hi:[0,1,1]
    v_mov_b32_dpp v236, v238 row_newbcast:13 row_mask:0xf bank_mask:0xf
    s_waitcnt vmcnt(14)
    v_pk_fma_f32 v[204:205], v[236:237], v[40:41], v[204:205] op_sel_hi:[0,1,1]
    v_pk_fma_f32 v[206:207], v[236:237], v[42:43], v[206:207] op_sel_hi:[0,1,1]
    s_waitcnt vmcnt(13)
    v_pk_fma_f32 v[208:209], v[236:237], v[44:45], v[208:209] op_sel_hi:[0,1,1]
    v_pk_fma_f32 v[210:211], v[236:237], v[46:47], v[210:211] op_sel_hi:[0,1,1]
    s_waitcnt vmcnt(12)
    v_pk_fma_f32 v[212:213], v[236:237], v[48:49], v[212:213] op_sel_hi:[0,1,1]
    v_pk_fma_f32 v[214:215], v[236:237], v[50:51], v[214:215] op_sel_hi:[0,1,1]
    v_mov_b32_dpp v236, v238 row_newbcast:3 row_mask:0xf bank_mask:0xf
    s_waitcnt vmcnt(11)
    v_pk_fma_f32 v[204:205], v[236:237], v[52:53], v[204:205] op_sel_hi:[0,1,1]
    v_pk_fma_f32 v[206:207], v[236:237], v[54:55], v[206:207] op_sel_hi:[0,1,1]
    s_waitcnt vmcnt(10)
L_h57:
    s_cbranch_execz L_h58
    v_pk_fma_f32 v[208:209], v[236:237], v[56:57], v[208:209] op_sel_hi:[0,1,1]
    v_pk_fma_f32 v[210:211], v[236:237], v[58:59], v[210:211] op_sel_hi:[0,1,1]
    s_waitcnt vmcnt(9)
    v_pk_fma_f32 v[212:213], v[236:237], v[60:61], v[212:213] op_sel_hi:[0,1,1]
    v_pk_fma_f32 v[214:215], v[236:237], v[62:63], v[214:215] op_sel_hi:[0,1,1]
    v_mov_b32_dpp v236, v238 row_newbcast:11 row_mask:0xf bank_mask:0xf
    s_waitcnt vmcnt(8)
    v_pk_fma_f32 v[204:205], v[236:237], v[64:65], v[204:205] op_sel_hi:[0,1,1]
    v_pk_fma_f32 v[206:207], v[236:237], v[66:67], v[206:207] op_sel_hi:[0,1,1]
    s_waitcnt vmcnt(7)
    v_pk_fma_f32 v[208:209], v[236:237], v[68:69], v[208:209] op_sel_hi:[0,1,1]
    v_pk_fma_f32 v[210:211], v[236:237], v[70:71], v[210:211] op_sel_hi:[0,1,1]
    s_waitcnt vmcnt(6)
    v_pk_fma_f32 v[212:213], v[236:237], v[72:73], v[212:213] op_sel_hi:[0,1,1]
    v_pk_fma_f32 v[214:215], v[236:237], v[74:75], v[214:215] op_sel_hi:[0,1,1]
    v_mov_b32_dpp v236, v238 row_newbcast:7 row_mask:0xf bank_mask:0xf
    s_waitcnt vmcnt(5)
    v_pk_fma_f32 v[204:205], v[236:237], v[76:77], v[204:205] op_sel_hi:[0,1,1]
L_h58:
    s_cbranch_execz L_h59
    v_pk_fma_f32 v[206:207], v[236:237], v[78:79], v[206:207] op_sel_hi:[0,1,1]
    s_waitcnt vmcnt(4)
    v_pk_fma_f32 v[208:209], v[236:237], v[80:81], v[208:209] op_sel_hi:[0,1,1]
    v_pk_fma_f32 v[210:211], v[236:237], v[82:83], v[210:211] op_sel_hi:[0,1,1]
    s_waitcnt vmcnt(3)
    v_pk_fma_f32 v[212:213], v[236:237], v[84:85], v[212:213] op_sel_hi:[0,1,1]
    v_pk_fma_f32 v[214:215], v[236:237], v[86:87], v[214:215] op_sel_hi:[0,1,1]
    v_mov_b32_dpp v236, v238 row_newbcast:15 row_mask:0xf bank_mask:0xf
    s_waitcnt vmcnt(2)
    v_pk_fma_f32 v[204:205], v[236:237], v[88:89], v[204:205] op_sel_hi:[0,1,1]
    v_pk_fma_f32 v[206:207], v[236:237], v[90:91], v[206:207] op_sel_hi:[0,1,1]
    s_waitcnt vmcnt(1)
    v_pk_fma_f32 v[208:209], v[236:237], v[92:93], v[208:209] op_sel_hi:[0,1,1]
    v_pk_fma_f32 v[210:211], v[236:237], v[94:95], v[210:211] op_sel_hi:[0,1,1]
    v_permlane32_swap_b32 v204, v206
    v_permlane32_swap_b32 v205, v207
    v_add_f32 v204, v204, v206
    v_add_f32 v205, v205, v207
    v_permlane32_swap_b32 v208, v210
    v_permlane32_swap_b32 v209, v211
    v_add_f32 v208, v208, v210
L_h59:
    s_cbranch_execz L_h60
    v_add_f32 v209, v209, v211
    v_permlane16_swap_b32 v204, v205
    v_add_f32 v204, v204, v205
    v_fma_f32 v100, v204, s6, -v218
    v_permlane16_swap_b32 v208, v209
    v_add_f32 v208, v208, v209
    v_fma_f32 v101, v208, s6, -v218
    s_waitcnt vmcnt(0)
    v_pk_fma_f32 v[212:213], v[236:237], v[96:97], v[212:213] op_sel_hi:[0,1,1]
    v_pk_fma_f32 v[214:215], v[236:237], v[98:99], v[214:215] op_sel_hi:[0,1,1]
    s_nop 1
    v_permlane32_swap_b32 v212, v214
    v_permlane32_swap_b32 v213, v215
    v_add_f32 v212, v212, v214
    v_add_f32 v213, v213, v215
    s_nop 1
    v_permlane16_swap_b32 v212, v213
    v_add_f32 v212, v212, v213
    v_fma_f32 v102, v212, s6, -v218
    s_mov_b64 exec, s[88:89]
    buffer_store_dwordx4 v[100:103], v225, s[52:55], s78 offen offset:0
    s_not_b64 exec, exec
    buffer_store_dwordx4 v[100:103], v225, s[52:55], s78 offen offset:0 sc0 sc1
    s_mov_b64 exec, -1
L_final:
L_h60:
    s_cbranch_execz L_h61
    s_endpgm
L_th24_0:
    s_waitcnt vmcnt(33)
    s_bitcmp0_b32 vcc_lo, 2
    s_cbranch_scc1 L_tb24_0
    s_bitcmp0_b32 vcc_lo, 19
    s_cbranch_scc1 L_tb24_0
    s_waitcnt vmcnt(23)
    s_branch L_tb24_0
L_th27_0:
    s_waitcnt vmcnt(27)
    s_bitcmp0_b32 vcc_lo, 10
    s_cbranch_scc1 L_tb27_0
    s_bitcmp0_b32 vcc_lo, 19
    s_cbranch_scc1 L_tb27_0
    s_waitcnt vmcnt(23)
    s_branch L_tb27_0
L_th30_0:
    s_waitcnt vmcnt(33)
    s_bitcmp0_b32 vcc_lo, 6
    s_cbranch_scc1 L_tb30_0
    s_bitcmp0_b32 vcc_lo, 19
    s_cbranch_scc1 L_tb30_0
    s_waitcnt vmcnt(29)
    s_branch L_tb30_0
L_th33_0:
    s_waitcnt vmcnt(33)
    s_bitcmp0_b32 vcc_lo, 14
    s_cbranch_scc1 L_tb33_0
    s_bitcmp0_b32 vcc_lo, 19
    s_cbranch_scc1 L_tb33_0
    s_waitcnt vmcnt(29)
    s_branch L_tb33_0
L_th36_0:
    s_waitcnt vmcnt(36)
    s_bitcmp0_b32 vcc_lo, 4
L_h61:
    s_cbranch_execz L_h62
    s_cbranch_scc1 L_tb36_0
    s_bitcmp0_b32 vcc_lo, 19
    s_cbranch_scc1 L_tb36_0
    s_waitcnt vmcnt(26)
    s_branch L_tb36_0
L_th39_0:
    s_waitcnt vmcnt(30)
    s_bitcmp0_b32 vcc_lo, 12
    s_cbranch_scc1 L_tb39_0
    s_bitcmp0_b32 vcc_lo, 19
    s_cbranch_scc1 L_tb39_0
    s_waitcnt vmcnt(26)
    s_branch L_tb39_0
L_th42_0:
    s_waitcnt vmcnt(36)
    s_bitcmp0_b32 vcc_lo, 8
    s_cbranch_scc1 L_tb42_0
    s_bitcmp0_b32 vcc_lo, 19
    s_cbranch_scc1 L_tb42_0
    s_waitcnt vmcnt(32)
    s_branch L_tb42_0
L_th45_0:
    s_waitcnt vmcnt(36)
    s_bitcmp0_b32 vcc_lo, 16
    s_cbranch_scc1 L_tb45_0
    s_bitcmp0_b32 vcc_lo, 19
    s_cbranch_scc1 L_tb45_0
    s_waitcnt vmcnt(32)
    s_branch L_tb45_0
L_th0_0:
    s_waitcnt vmcnt(36)
    s_bitcmp0_b32 vcc_lo, 1
    s_cbranch_scc1 L_tb0_0
    s_bitcmp0_b32 vcc_lo, 19
    s_cbranch_scc1 L_tb0_0
L_h62:
    s_cbranch_execz L_h63
    s_waitcnt vmcnt(26)
    s_branch L_tb0_0
L_th3_0:
    s_waitcnt vmcnt(30)
    s_bitcmp0_b32 vcc_lo, 9
    s_cbranch_scc1 L_tb3_0
    s_bitcmp0_b32 vcc_lo, 19
    s_cbranch_scc1 L_tb3_0
    s_waitcnt vmcnt(26)
    s_branch L_tb3_0
L_th6_0:
    s_waitcnt vmcnt(36)
    s_bitcmp0_b32 vcc_lo, 5
    s_cbranch_scc1 L_tb6_0
    s_bitcmp0_b32 vcc_lo, 19
    s_cbranch_scc1 L_tb6_0
    s_waitcnt vmcnt(29)
    s_branch L_tb6_0
L_th9_0:
    s_waitcnt vmcnt(36)
    s_bitcmp0_b32 vcc_lo, 13
    s_cbranch_scc1 L_tb9_0
    s_bitcmp0_b32 vcc_lo, 19
    s_cbranch_scc1 L_tb9_0
    s_waitcnt vmcnt(29)
    s_branch L_tb9_0
L_th12_0:
    s_waitcnt vmcnt(33)
    s_bitcmp0_b32 vcc_lo, 3
    s_cbranch_scc1 L_tb12_0
    s_bitcmp0_b32 vcc_lo, 19
    s_cbranch_scc1 L_tb12_0
    s_waitcnt vmcnt(23)
    s_branch L_tb12_0
L_th15_0:
    s_waitcnt vmcnt(27)
L_h63:
    s_cbranch_execz L_h64
    s_bitcmp0_b32 vcc_lo, 11
    s_cbranch_scc1 L_tb15_0
    s_bitcmp0_b32 vcc_lo, 19
    s_cbranch_scc1 L_tb15_0
    s_waitcnt vmcnt(23)
    s_branch L_tb15_0
L_th18_0:
    s_waitcnt vmcnt(33)
    s_bitcmp0_b32 vcc_lo, 7
    s_cbranch_scc1 L_tb18_0
    s_bitcmp0_b32 vcc_lo, 19
    s_cbranch_scc1 L_tb18_0
    s_waitcnt vmcnt(29)
    s_branch L_tb18_0
L_th21_0:
    s_waitcnt vmcnt(33)
    s_bitcmp0_b32 vcc_lo, 15
    s_cbranch_scc1 L_tb21_0
    s_bitcmp0_b32 vcc_lo, 19
    s_cbranch_scc1 L_tb21_0
    s_waitcnt vmcnt(29)
    s_branch L_tb21_0
L_th24_1:
    s_waitcnt vmcnt(33)
    s_bitcmp0_b32 vcc_lo, 2
    s_cbranch_scc1 L_tb24_1
    s_bitcmp0_b32 vcc_lo, 19
    s_cbranch_scc1 L_tb24_1
    s_waitcnt vmcnt(23)
    s_branch L_tb24_1
L_th27_1:
    s_waitcnt vmcnt(27)
    s_bitcmp0_b32 vcc_lo, 10
    s_cbranch_scc1 L_tb27_1
    s_bitcmp0_b32 vcc_lo, 19
L_h64:
    s_cbranch_execz L_h65
    s_cbranch_scc1 L_tb27_1
    s_waitcnt vmcnt(23)
    s_branch L_tb27_1
L_th30_1:
    s_waitcnt vmcnt(33)
    s_bitcmp0_b32 vcc_lo, 6
    s_cbranch_scc1 L_tb30_1
    s_bitcmp0_b32 vcc_lo, 19
    s_cbranch_scc1 L_tb30_1
    s_waitcnt vmcnt(29)
    s_branch L_tb30_1
L_th33_1:
    s_waitcnt vmcnt(33)
    s_bitcmp0_b32 vcc_lo, 14
    s_cbranch_scc1 L_tb33_1
    s_bitcmp0_b32 vcc_lo, 19
    s_cbranch_scc1 L_tb33_1
    s_waitcnt vmcnt(29)
    s_branch L_tb33_1
L_th36_1:
    s_waitcnt vmcnt(35)
    s_bitcmp0_b32 vcc_lo, 4
    s_cbranch_scc1 L_tb36_1
    s_bitcmp0_b32 vcc_lo, 19
    s_cbranch_scc1 L_tb36_1
    s_waitcnt vmcnt(25)
    s_branch L_tb36_1
L_th39_1:
    s_waitcnt vmcnt(29)
    s_bitcmp0_b32 vcc_lo, 12
    s_cbranch_scc1 L_tb39_1
    s_bitcmp0_b32 vcc_lo, 19
    s_cbranch_scc1 L_tb39_1
    s_waitcnt vmcnt(25)
    s_branch L_tb39_1
L_h65:
    s_branch L_h66
L_th42_1:
    s_waitcnt vmcnt(29)
    s_bitcmp0_b32 vcc_lo, 8
    s_cbranch_scc1 L_tb42_1
    s_bitcmp0_b32 vcc_lo, 19
    s_cbranch_scc1 L_tb42_1
    s_waitcnt vmcnt(25)
    s_branch L_tb42_1
L_th45_1:
    s_waitcnt vmcnt(29)
    s_bitcmp0_b32 vcc_lo, 16
    s_cbranch_scc1 L_tb45_1
    s_bitcmp0_b32 vcc_lo, 19
    s_cbranch_scc1 L_tb45_1
    s_waitcnt vmcnt(25)
    s_branch L_tb45_1
L_th0_1:
    s_waitcnt vmcnt(29)
    s_bitcmp0_b32 vcc_lo, 1
    s_cbranch_scc1 L_tb0_1
    s_bitcmp0_b32 vcc_lo, 19
    s_cbranch_scc1 L_tb0_1
    s_waitcnt vmcnt(19)
    s_branch L_tb0_1
L_th3_1:
    s_waitcnt vmcnt(23)
    s_bitcmp0_b32 vcc_lo, 9
    s_cbranch_scc1 L_tb3_1
    s_bitcmp0_b32 vcc_lo, 19
    s_cbranch_scc1 L_tb3_1
    s_waitcnt vmcnt(19)
    s_branch L_tb3_1
L_th6_1:
    s_waitcnt vmcnt(23)
    s_bitcmp0_b32 vcc_lo, 5
    s_cbranch_scc1 L_tb6_1
L_h66:
    s_cbranch_execz L_h67
    s_bitcmp0_b32 vcc_lo, 19
    s_cbranch_scc1 L_tb6_1
    s_waitcnt vmcnt(17)
    s_branch L_tb6_1
L_th9_1:
    s_waitcnt vmcnt(23)
    s_bitcmp0_b32 vcc_lo, 13
    s_cbranch_scc1 L_tb9_1
    s_bitcmp0_b32 vcc_lo, 19
    s_cbranch_scc1 L_tb9_1
    s_waitcnt vmcnt(17)
    s_branch L_tb9_1
L_th12_1:
    s_waitcnt vmcnt(21)
    s_bitcmp0_b32 vcc_lo, 3
    s_cbranch_scc1 L_tb12_1
    s_bitcmp0_b32 vcc_lo, 19
    s_cbranch_scc1 L_tb12_1
    s_waitcnt vmcnt(17)
    s_branch L_tb12_1
L_th15_1:
    s_waitcnt vmcnt(21)
    s_bitcmp0_b32 vcc_lo, 11
    s_cbranch_scc1 L_tb15_1
    s_bitcmp0_b32 vcc_lo, 19
    s_cbranch_scc1 L_tb15_1
    s_waitcnt vmcnt(17)
    s_branch L_tb15_1
L_th18_1:
    s_waitcnt vmcnt(21)
    s_bitcmp0_b32 vcc_lo, 7
    s_cbranch_scc1 L_tb18_1
    s_bitcmp0_b32 vcc_lo, 19
    s_cbranch_scc1 L_tb18_1
    s_waitcnt vmcnt(17)
L_h67:
    s_cbranch_execz L_h68
    s_branch L_tb18_1
L_th21_1:
    s_waitcnt vmcnt(21)
    s_bitcmp0_b32 vcc_lo, 15
    s_cbranch_scc1 L_tb21_1
    s_bitcmp0_b32 vcc_lo, 19
    s_cbranch_scc1 L_tb21_1
    s_waitcnt vmcnt(17)
    s_branch L_tb21_1
L_th24_2:
    s_bitcmp1_b32 vcc_lo, 2
    s_cbranch_scc1 L_tx24_2
    s_waitcnt vmcnt(22)
    s_branch L_tb24_2
L_tx24_2:
    s_nop 7
    s_waitcnt vmcnt(22)
    s_bitcmp0_b32 vcc_lo, 19
    s_cbranch_scc1 L_tb24_2
    s_waitcnt vmcnt(17)
    s_branch L_tb24_2
L_th27_2:
    s_bitcmp1_b32 vcc_lo, 10
    s_cbranch_scc1 L_tx27_2
    s_waitcnt vmcnt(22)
    s_branch L_tb27_2
L_tx27_2:
    s_nop 7
    s_waitcnt vmcnt(22)
    s_bitcmp0_b32 vcc_lo, 19
    s_cbranch_scc1 L_tb27_2
    s_waitcnt vmcnt(17)
    s_branch L_tb27_2
L_th30_2:
    s_bitcmp1_b32 vcc_lo, 6
    s_cbranch_scc1 L_tx30_2
    s_waitcnt vmcnt(22)
L_h68:
    s_cbranch_execz L_h69
    s_branch L_tb30_2
L_tx30_2:
    s_nop 7
    s_waitcnt vmcnt(22)
    s_bitcmp0_b32 vcc_lo, 19
    s_cbranch_scc1 L_tb30_2
    s_waitcnt vmcnt(17)
    s_branch L_tb30_2
L_th33_2:
    s_bitcmp1_b32 vcc_lo, 14
    s_cbranch_scc1 L_tx33_2
    s_waitcnt vmcnt(22)
    s_branch L_tb33_2
L_tx33_2:
    s_nop 7
    s_waitcnt vmcnt(22)
    s_bitcmp0_b32 vcc_lo, 19
    s_cbranch_scc1 L_tb33_2
    s_waitcnt vmcnt(17)
    s_branch L_tb33_2
L_th36_2:
    s_bitcmp1_b32 vcc_lo, 4
    s_cbranch_scc1 L_tx36_2
    s_waitcnt vmcnt(24)
    s_branch L_tb36_2
L_tx36_2:
    s_nop 7
    s_waitcnt vmcnt(24)
    s_bitcmp0_b32 vcc_lo, 19
    s_cbranch_scc1 L_tb36_2
    s_waitcnt vmcnt(19)
    s_branch L_tb36_2
L_th39_2:
    s_bitcmp1_b32 vcc_lo, 12
    s_cbranch_scc1 L_tx39_2
    s_waitcnt vmcnt(24)
    s_branch L_tb39_2
L_h69:
    s_branch L_h70
L_tx39_2:
    s_nop 7
    s_waitcnt vmcnt(24)
    s_bitcmp0_b32 vcc_lo, 19
    s_cbranch_scc1 L_tb39_2
    s_waitcnt vmcnt(19)
    s_branch L_tb39_2
L_th42_2:
    s_bitcmp1_b32 vcc_lo, 8
    s_cbranch_scc1 L_tx42_2
    s_waitcnt vmcnt(24)
    s_branch L_tb42_2
L_tx42_2:
    s_nop 7
    s_waitcnt vmcnt(24)
    s_bitcmp0_b32 vcc_lo, 19
    s_cbranch_scc1 L_tb42_2
    s_waitcnt vmcnt(19)
    s_branch L_tb42_2
L_th45_2:
    s_bitcmp1_b32 vcc_lo, 16
    s_cbranch_scc1 L_tx45_2
    s_waitcnt vmcnt(24)
    s_branch L_tb45_2
L_tx45_2:
    s_nop 7
    s_waitcnt vmcnt(24)
    s_bitcmp0_b32 vcc_lo, 19
    s_cbranch_scc1 L_tb45_2
    s_waitcnt vmcnt(19)
    s_branch L_tb45_2
L_getm2:
    ds_read_b32 v227, v243 offset:139
    ds_read_b32 v226, v243 offset:159
    s_waitcnt lgkmcnt(0)
L_h70:
    s_cbranch_execz L_h71
    v_readfirstlane_b32 s93, v227
    v_readfirstlane_b32 s77, v226
    s_cmp_eq_u32 s93, 0
    s_cbranch_scc1 L_getm2
    ds_read_b32 v226, v243 offset:151
    s_waitcnt lgkmcnt(0)
    v_readfirstlane_b32 s88, v226
    s_cmp_eq_u32 s88, -1
    s_cselect_b64 s[88:89], -1, 0
    s_branch L_gotm2
L_th0_2:
    s_bitcmp1_b32 vcc_lo, 1
    s_cbranch_scc1 L_tx0_2
    s_waitcnt vmcnt(24)
    s_branch L_tb0_2
L_tx0_2:
    s_nop 7
    s_waitcnt vmcnt(24)
    s_bitcmp0_b32 vcc_lo, 19
    s_cbranch_scc1 L_tb0_2
    s_waitcnt vmcnt(19)
    s_branch L_tb0_2
L_th3_2:
    s_bitcmp1_b32 vcc_lo, 9
    s_cbranch_scc1 L_tx3_2
    s_waitcnt vmcnt(24)
    s_branch L_tb3_2
L_tx3_2:
    s_nop 7
    s_waitcnt vmcnt(24)
    s_bitcmp0_b32 vcc_lo, 19
    s_cbranch_scc1 L_tb3_2
    s_waitcnt vmcnt(19)
    s_branch L_tb3_2
L_h71:
    s_branch L_h72
L_th6_2:
    s_bitcmp1_b32 vcc_lo, 5
    s_cbranch_scc1 L_tx6_2
    s_waitcnt vmcnt(24)
    s_branch L_tb6_2
L_tx6_2:
    s_nop 7
    s_waitcnt vmcnt(24)
    s_bitcmp0_b32 vcc_lo, 19
    s_cbranch_scc1 L_tb6_2
    s_waitcnt vmcnt(17)
    s_branch L_tb6_2
L_th9_2:
    s_bitcmp1_b32 vcc_lo, 13
    s_cbranch_scc1 L_tx9_2
    s_waitcnt vmcnt(24)
    s_branch L_tb9_2
L_tx9_2:
    s_nop 7
    s_waitcnt vmcnt(24)
    s_bitcmp0_b32 vcc_lo, 19
    s_cbranch_scc1 L_tb9_2
    s_waitcnt vmcnt(17)
    s_branch L_tb9_2
L_th12_2:
    s_bitcmp1_b32 vcc_lo, 3
    s_cbranch_scc1 L_tx12_2
    s_waitcnt vmcnt(22)
    s_branch L_tb12_2
L_tx12_2:
    s_nop 7
    s_waitcnt vmcnt(22)
    s_bitcmp0_b32 vcc_lo, 19
    s_cbranch_scc1 L_tb12_2
    s_waitcnt vmcnt(17)
    s_branch L_tb12_2
L_th15_2:
    s_bitcmp1_b32 vcc_lo, 11
L_h72:
    s_cbranch_execz L_h73
    s_cbranch_scc1 L_tx15_2
    s_waitcnt vmcnt(22)
    s_branch L_tb15_2
L_tx15_2:
    s_nop 7
    s_waitcnt vmcnt(22)
    s_bitcmp0_b32 vcc_lo, 19
    s_cbranch_scc1 L_tb15_2
    s_waitcnt vmcnt(17)
    s_branch L_tb15_2
L_th18_2:
    s_bitcmp1_b32 vcc_lo, 7
    s_cbranch_scc1 L_tx18_2
    s_waitcnt vmcnt(22)
    s_branch L_tb18_2
L_tx18_2:
    s_nop 7
    s_waitcnt vmcnt(22)
    s_bitcmp0_b32 vcc_lo, 19
    s_cbranch_scc1 L_tb18_2
    s_waitcnt vmcnt(17)
    s_branch L_tb18_2
L_th21_2:
    s_bitcmp1_b32 vcc_lo, 15
    s_cbranch_scc1 L_tx21_2
    s_waitcnt vmcnt(22)
    s_branch L_tb21_2
L_tx21_2:
    s_nop 7
    s_waitcnt vmcnt(22)
    s_bitcmp0_b32 vcc_lo, 19
    s_cbranch_scc1 L_tb21_2
    s_waitcnt vmcnt(17)
    s_branch L_tb21_2
L_th24_3:
    s_bitcmp1_b32 vcc_lo, 2
    s_cbranch_scc1 L_tx24_3
L_h73:
    s_cbranch_execz L_h74
    s_waitcnt vmcnt(22)
    s_branch L_tb24_3
L_tx24_3:
    s_nop 7
    s_waitcnt vmcnt(22)
    s_bitcmp0_b32 vcc_lo, 19
    s_cbranch_scc1 L_tb24_3
    s_waitcnt vmcnt(17)
    s_branch L_tb24_3
L_th27_3:
    s_bitcmp1_b32 vcc_lo, 10
    s_cbranch_scc1 L_tx27_3
    s_waitcnt vmcnt(22)
    s_branch L_tb27_3
L_tx27_3:
    s_nop 7
    s_waitcnt vmcnt(22)
    s_bitcmp0_b32 vcc_lo, 19
    s_cbranch_scc1 L_tb27_3
    s_waitcnt vmcnt(17)
    s_branch L_tb27_3
L_th30_3:
    s_bitcmp1_b32 vcc_lo, 6
    s_cbranch_scc1 L_tx30_3
    s_waitcnt vmcnt(22)
    s_branch L_tb30_3
L_tx30_3:
    s_nop 7
    s_waitcnt vmcnt(22)
    s_bitcmp0_b32 vcc_lo, 19
    s_cbranch_scc1 L_tb30_3
    s_waitcnt vmcnt(17)
    s_branch L_tb30_3
L_th33_3:
    s_bitcmp1_b32 vcc_lo, 14
    s_cbranch_scc1 L_tx33_3
    s_waitcnt vmcnt(22)
L_h74:
    s_cbranch_execz L_h75
    s_branch L_tb33_3
L_tx33_3:
    s_nop 7
    s_waitcnt vmcnt(22)
    s_bitcmp0_b32 vcc_lo, 19
    s_cbranch_scc1 L_tb33_3
    s_waitcnt vmcnt(17)
    s_branch L_tb33_3
L_th36_3:
    s_bitcmp1_b32 vcc_lo, 4
    s_cbranch_scc1 L_tx36_3
    s_waitcnt vmcnt(22)
    s_branch L_tb36_3
L_tx36_3:
    s_nop 7
    s_waitcnt vmcnt(22)
    s_bitcmp0_b32 vcc_lo, 19
    s_cbranch_scc1 L_tb36_3
    s_waitcnt vmcnt(17)
    s_branch L_tb36_3
L_th39_3:
    s_bitcmp1_b32 vcc_lo, 12
    s_cbranch_scc1 L_tx39_3
    s_waitcnt vmcnt(22)
    s_branch L_tb39_3
L_tx39_3:
    s_nop 7
    s_waitcnt vmcnt(22)
    s_bitcmp0_b32 vcc_lo, 19
    s_cbranch_scc1 L_tb39_3
    s_waitcnt vmcnt(17)
    s_branch L_tb39_3
L_th42_3:
    s_bitcmp1_b32 vcc_lo, 8
    s_cbranch_scc1 L_tx42_3
    s_waitcnt vmcnt(22)
    s_branch L_tb42_3
L_h75:
    s_branch L_hopped
L_tx42_3:
    s_nop 7
    s_waitcnt vmcnt(22)
    s_bitcmp0_b32 vcc_lo, 19
    s_cbranch_scc1 L_tb42_3
    s_waitcnt vmcnt(17)
    s_branch L_tb42_3
L_th45_3:
    s_bitcmp1_b32 vcc_lo, 16
    s_cbranch_scc1 L_tx45_3
    s_waitcnt vmcnt(22)
    s_branch L_tb45_3
L_tx45_3:
    s_nop 7
    s_waitcnt vmcnt(22)
    s_bitcmp0_b32 vcc_lo, 19
    s_cbranch_scc1 L_tb45_3
    s_waitcnt vmcnt(17)
    s_branch L_tb45_3
L_service:
    v_lshlrev_b32 v5, 2, v0
    v_mov_b32 v3, 0
    ds_write_b32 v5, v3 offset:0
    v_lshlrev_b32 v1, 4, v0
    v_lshlrev_b32 v28, 11, v0
    v_mov_b32 v9, 0xf149f2ca
    v_cndmask_b32 v9, v9, v3, s[66:67]
    v_and_b32 v5, 15, v0
    v_lshrrev_b32 v6, 4, v0
    v_lshl_add_u32 v11, v5, 2, v6
    v_lshlrev_b32 v11, 1, v11
    s_getreg_b32 s72, hwreg(HW_REG_XCC_ID)
    s_and_b32 s72, s72, 15
    s_waitcnt lgkmcnt(0)
    s_barrier
    s_branch L_w0
L_walked:
    s_mov_b32 s24, s6
    s_and_b32 s25, s7, 0xffff
    s_mov_b32 s26, 805306368
    s_mov_b32 s27, 0x00020000
    s_mov_b32 s28, s8
    s_and_b32 s29, s9, 0xffff
    s_mov_b32 s30, 805306368
    s_mov_b32 s31, 0x00020000
    s_mov_b32 s32, s10
    s_and_b32 s33, s11, 0xffff
    s_mov_b32 s34, 6291456
    s_mov_b32 s35, 0x00020000
    s_mov_b32 s36, s12
    s_and_b32 s37, s13, 0xffff
    s_mov_b32 s38, 6291456
    s_mov_b32 s39, 0x00020000
    s_mov_b32 s40, s14
    s_and_b32 s41, s15, 0xffff
    s_mov_b32 s42, 2097152
    s_mov_b32 s43, 0x00020000
    s_mov_b32 s44, s16
    s_and_b32 s45, s17, 0xffff
    s_mov_b32 s46, 2097152
    s_mov_b32 s47, 0x00020000
    s_mov_b32 s48, s4
    s_and_b32 s49, s5, 0xffff
    s_mov_b32 s50, 12288
    s_mov_b32 s51, 0x00020000
    s_mov_b32 s52, s22
    s_and_b32 s53, s23, 0xffff
    s_mov_b32 s54, 25165824
    s_mov_b32 s55, 0x00020000
    s_mov_b64 exec, 0
    s_branch L_h0
L_hopped:
    s_mov_b64 exec, -1
    s_mov_b32 s52, s22
    s_and_b32 s53, s23, 0xffff
    s_mov_b32 s54, 25165824
    s_mov_b32 s55, 0x00020000
    s_mov_b32 s56, s18
    s_and_b32 s57, s19, 0xffff
    s_mov_b32 s58, 12288
    s_mov_b32 s59, 0x00020000
    s_mov_b32 s96, s79
    s_and_b32 s82, s79, 3
    s_lshl_b32 s82, s82, 4
    v_mov_b32 v10, 0
    s_mov_b32 s80, 0x2010200
    s_mov_b32 s81, 0x2030202
    s_cmp_ge_u32 s79, 4
    s_cmov_b32 s80, 0x2050204
    s_cmov_b32 s81, 0x2070206
    s_lshr_b64 s[80:81], s[80:81], s82
    v_writelane_b32 v10, s80, 0
    s_mov_b32 s80, 0x2090208
    s_mov_b32 s81, 0x20b020a
    s_cmp_ge_u32 s79, 4
    s_cmov_b32 s80, 0x20d020c
    s_cmov_b32 s81, 0x20f020e
    s_lshr_b64 s[80:81], s[80:81], s82
    v_writelane_b32 v10, s80, 1
    s_mov_b32 s80, 0x4d00150
    s_mov_b32 s81, 0x8310571
    s_cmp_ge_u32 s79, 4
    s_cmov_b32 s80, 0x57304d2
    s_cmov_b32 s81, 0x4b40174
    s_lshr_b64 s[80:81], s[80:81], s82
    v_writelane_b32 v10, s80, 2
    s_mov_b32 s80, 0x9100d5
    s_mov_b32 s81, 0x15204b6
    s_cmp_ge_u32 s79, 4
    s_cmov_b32 s80, 0x4b700b3
    s_cmov_b32 s81, 0x8d508b7
    s_lshr_b64 s[80:81], s[80:81], s82
    v_writelane_b32 v10, s80, 3
    s_mov_b32 s80, 0x4950000
    s_mov_b32 s81, 0x8b60000
    s_cmp_ge_u32 s79, 4
    s_cmov_b32 s80, 0xc96
    s_cmov_b32 s81, 0xcb70000
    s_lshr_b64 s[80:81], s[80:81], s82
    v_writelane_b32 v10, s80, 4
    s_mov_b32 s80, 0x560000
    s_mov_b32 s81, 0x0
    s_cmp_ge_u32 s79, 4
    s_cmov_b32 s80, 0x37
    s_cmov_b32 s81, 0x0
    s_lshr_b64 s[80:81], s[80:81], s82
    v_writelane_b32 v10, s80, 5
    v_and_b32 v10, 0xffff, v10
L_tag:
    ds_read_b32 v5, v3 offset:140
    ds_read_b64 v[16:17], v3 offset:152
    s_waitcnt lgkmcnt(0)
    v_readfirstlane_b32 s69, v5
    s_cmp_eq_u32 s69, 0
    s_cbranch_scc1 L_tag
    v_readfirstlane_b32 s86, v16
    v_readfirstlane_b32 s87, v17
    s_bfm_b64 s[84:85], s92, 0
    s_bcnt1_i32_b64 s70, s[86:87]
    s_and_b64 s[84:85], s[84:85], s[86:87]
    s_bcnt1_i32_b64 s71, s[84:85]
    s_mov_b32 s73, s71
L_round:
    s_min_u32 s80, s71, 63
    v_readlane_b32 s97, v10, s80
    s_lshl_b32 s80, s71, 2
    v_mov_b32 v4, s80
    s_cmp_eq_u32 s97, 0
    s_cbranch_scc1 L_last
L_poll:
    ds_read_b32 v5, v4 offset:0
    s_waitcnt lgkmcnt(0)
    v_readfirstlane_b32 s80, v5
    s_cmp_eq_u32 s80, 0
    s_cbranch_scc1 L_poll
    s_add_u32 s95, s69, s71
    s_add_u32 s95, s95, 1
    s_and_b32 s80, s71, 1
    s_lshl_b32 s80, s80, 19
    s_add_u32 s80, s80, 2097152
    s_lshl_b32 s77, s2, 11
    s_add_u32 s77, s77, s80
    s_lshl_b32 s75, s96, 16
    s_add_u32 s75, s75, s80
L_all:
    v_mov_b32 v16, s95
    s_mov_b64 exec, s[86:87]
    buffer_load_dword v16, v28, s[52:55], s75 offen offset:1024 sc0 sc1
    s_mov_b64 exec, -1
    s_waitcnt vmcnt(0)
    v_cmp_ne_u32 vcc, s95, v16
    s_cmp_lg_u64 vcc, 0
    s_cbranch_scc1 L_all
    s_mov_b32 s74, 0
    s_mov_b64 s[84:85], s[86:87]
L_merge:
    v_mov_b32 v7, 0xf149f2ca
    v_mov_b32 v8, 0
    v_mov_b32 v12, 0
    v_mov_b32 v13, 0
    v_mov_b32 v14, 0
L_chunk:
    v_mov_b32 v48, 0
    v_mov_b32 v49, 0
    v_mov_b32 v50, 0
    v_mov_b32 v51, v9
    v_mov_b32 v52, 0
    v_mov_b32 v53, 0
    v_mov_b32 v54, 0
    v_mov_b32 v55, v9
    v_mov_b32 v56, 0
    v_mov_b32 v57, 0
    v_mov_b32 v58, 0
    v_mov_b32 v59, v9
    v_mov_b32 v60, 0
    v_mov_b32 v61, 0
    v_mov_b32 v62, 0
    v_mov_b32 v63, v9
    v_mov_b32 v64, 0
    v_mov_b32 v65, 0
    v_mov_b32 v66, 0
    v_mov_b32 v67, v9
    v_mov_b32 v68, 0
    v_mov_b32 v69, 0
    v_mov_b32 v70, 0
    v_mov_b32 v71, v9
    v_mov_b32 v72, 0
    v_mov_b32 v73, 0
    v_mov_b32 v74, 0
    v_mov_b32 v75, v9
    v_mov_b32 v76, 0
    v_mov_b32 v77, 0
    v_mov_b32 v78, 0
    v_mov_b32 v79, v9
    v_mov_b32 v80, 0
    v_mov_b32 v81, 0
    v_mov_b32 v82, 0
    v_mov_b32 v83, v9
    v_mov_b32 v84, 0
    v_mov_b32 v85, 0
    v_mov_b32 v86, 0
    v_mov_b32 v87, v9
    v_mov_b32 v88, 0
    v_mov_b32 v89, 0
    v_mov_b32 v90, 0
    v_mov_b32 v91, v9
    v_mov_b32 v92, 0
    v_mov_b32 v93, 0
    v_mov_b32 v94, 0
    v_mov_b32 v95, v9
    v_mov_b32 v96, 0
    v_mov_b32 v97, 0
    v_mov_b32 v98, 0
    v_mov_b32 v99, v9
    v_mov_b32 v100, 0
    v_mov_b32 v101, 0
    v_mov_b32 v102, 0
    v_mov_b32 v103, v9
    v_mov_b32 v104, 0
    v_mov_b32 v105, 0
    v_mov_b32 v106, 0
    v_mov_b32 v107, v9
    v_mov_b32 v108, 0
    v_mov_b32 v109, 0
    v_mov_b32 v110, 0
    v_mov_b32 v111, v9
    v_mov_b32 v112, 0
    v_mov_b32 v113, 0
    v_mov_b32 v114, 0
    v_mov_b32 v115, v9
    v_mov_b32 v116, 0
    v_mov_b32 v117, 0
    v_mov_b32 v118, 0
    v_mov_b32 v119, v9
    v_mov_b32 v120, 0
    v_mov_b32 v121, 0
    v_mov_b32 v122, 0
    v_mov_b32 v123, v9
    v_mov_b32 v124, 0
    v_mov_b32 v125, 0
    v_mov_b32 v126, 0
    v_mov_b32 v127, v9
    v_mov_b32 v128, 0
    v_mov_b32 v129, 0
    v_mov_b32 v130, 0
    v_mov_b32 v131, v9
    v_mov_b32 v132, 0
    v_mov_b32 v133, 0
    v_mov_b32 v134, 0
    v_mov_b32 v135, v9
    v_mov_b32 v136, 0
    v_mov_b32 v137, 0
    v_mov_b32 v138, 0
    v_mov_b32 v139, v9
    v_mov_b32 v140, 0
    v_mov_b32 v141, 0
    v_mov_b32 v142, 0
    v_mov_b32 v143, v9
    v_mov_b32 v144, 0
    v_mov_b32 v145, 0
    v_mov_b32 v146, 0
    v_mov_b32 v147, v9
    v_mov_b32 v148, 0
    v_mov_b32 v149, 0
    v_mov_b32 v150, 0
    v_mov_b32 v151, v9
    v_mov_b32 v152, 0
    v_mov_b32 v153, 0
    v_mov_b32 v154, 0
    v_mov_b32 v155, v9
    v_mov_b32 v156, 0
    v_mov_b32 v157, 0
    v_mov_b32 v158, 0
    s_branch L_x1
L_w1:
    s_branch L_w2
L_x1:
    v_mov_b32 v159, v9
    v_mov_b32 v160, 0
    v_mov_b32 v161, 0
    v_mov_b32 v162, 0
    v_mov_b32 v163, v9
    v_mov_b32 v164, 0
    v_mov_b32 v165, 0
    v_mov_b32 v166, 0
    v_mov_b32 v167, v9
    v_mov_b32 v168, 0
    v_mov_b32 v169, 0
    v_mov_b32 v170, 0
    v_mov_b32 v171, v9
    v_mov_b32 v172, 0
    v_mov_b32 v173, 0
    v_mov_b32 v174, 0
    v_mov_b32 v175, v9
    s_ff1_i32_b64 s80, s[84:85]
    s_bitset0_b64 s[84:85], s80
    s_lshl_b32 s81, s80, 11
    s_add_u32 s81, s81, s75
    s_cmp_ge_i32 s80, 0
    s_cselect_b64 exec, -1, 0
    buffer_load_dwordx4 v[48:51], v1, s[52:55], s81 offen sc0 sc1
    s_ff1_i32_b64 s80, s[84:85]
    s_bitset0_b64 s[84:85], s80
    s_lshl_b32 s81, s80, 11
    s_add_u32 s81, s81, s75
    s_cmp_ge_i32 s80, 0
    s_cselect_b64 exec, -1, 0
    buffer_load_dwordx4 v[52:55], v1, s[52:55], s81 offen sc0 sc1
    s_ff1_i32_b64 s80, s[84:85]
    s_bitset0_b64 s[84:85], s80
    s_lshl_b32 s81, s80, 11
    s_add_u32 s81, s81, s75
    s_cmp_ge_i32 s80, 0
    s_cselect_b64 exec, -1, 0
    buffer_load_dwordx4 v[56:59], v1, s[52:55], s81 offen sc0 sc1
    s_ff1_i32_b64 s80, s[84:85]
    s_bitset0_b64 s[84:85], s80
    s_lshl_b32 s81, s80, 11
    s_add_u32 s81, s81, s75
    s_cmp_ge_i32 s80, 0
    s_cselect_b64 exec, -1, 0
    buffer_load_dwordx4 v[60:63], v1, s[52:55], s81 offen sc0 sc1
    s_ff1_i32_b64 s80, s[84:85]
    s_bitset0_b64 s[84:85], s80
    s_lshl_b32 s81, s80, 11
    s_add_u32 s81, s81, s75
    s_cmp_ge_i32 s80, 0
    s_cselect_b64 exec, -1, 0
    buffer_load_dwordx4 v[64:67], v1, s[52:55], s81 offen sc0 sc1
    s_ff1_i32_b64 s80, s[84:85]
    s_bitset0_b64 s[84:85], s80
    s_lshl_b32 s81, s80, 11
    s_add_u32 s81, s81, s75
    s_cmp_ge_i32 s80, 0
    s_cselect_b64 exec, -1, 0
    buffer_load_dwordx4 v[68:71], v1, s[52:55], s81 offen sc0 sc1
    s_ff1_i32_b64 s80, s[84:85]
    s_bitset0_b64 s[84:85], s80
    s_lshl_b32 s81, s80, 11
    s_add_u32 s81, s81, s75
    s_cmp_ge_i32 s80, 0
    s_cselect_b64 exec, -1, 0
    buffer_load_dwordx4 v[72:75], v1, s[52:55], s81 offen sc0 sc1
    s_ff1_i32_b64 s80, s[84:85]
    s_bitset0_b64 s[84:85], s80
    s_lshl_b32 s81, s80, 11
    s_add_u32 s81, s81, s75
    s_cmp_ge_i32 s80, 0
    s_cselect_b64 exec, -1, 0
    buffer_load_dwordx4 v[76:79], v1, s[52:55], s81 offen sc0 sc1
    s_ff1_i32_b64 s80, s[84:85]
    s_bitset0_b64 s[84:85], s80
    s_lshl_b32 s81, s80, 11
    s_add_u32 s81, s81, s75
    s_cmp_ge_i32 s80, 0
    s_cbranch_scc0 L_got
    s_cselect_b64 exec, -1, 0
    buffer_load_dwordx4 v[80:83], v1, s[52:55], s81 offen sc0 sc1
    s_ff1_i32_b64 s80, s[84:85]
    s_bitset0_b64 s[84:85], s80
    s_lshl_b32 s81, s80, 11
    s_add_u32 s81, s81, s75
    s_cmp_ge_i32 s80, 0
    s_cselect_b64 exec, -1, 0
    buffer_load_dwordx4 v[84:87], v1, s[52:55], s81 offen sc0 sc1
    s_ff1_i32_b64 s80, s[84:85]
    s_bitset0_b64 s[84:85], s80
    s_lshl_b32 s81, s80, 11
    s_add_u32 s81, s81, s75
    s_cmp_ge_i32 s80, 0
    s_cselect_b64 exec, -1, 0
    buffer_load_dwordx4 v[88:91], v1, s[52:55], s81 offen sc0 sc1
    s_ff1_i32_b64 s80, s[84:85]
    s_bitset0_b64 s[84:85], s80
    s_lshl_b32 s81, s80, 11
    s_add_u32 s81, s81, s75
    s_cmp_ge_i32 s80, 0
    s_cselect_b64 exec, -1, 0
    buffer_load_dwordx4 v[92:95], v1, s[52:55], s81 offen sc0 sc1
    s_ff1_i32_b64 s80, s[84:85]
    s_bitset0_b64 s[84:85], s80
    s_lshl_b32 s81, s80, 11
    s_add_u32 s81, s81, s75
    s_cmp_ge_i32 s80, 0
    s_cselect_b64 exec, -1, 0
    buffer_load_dwordx4 v[96:99], v1, s[52:55], s81 offen sc0 sc1
    s_ff1_i32_b64 s80, s[84:85]
    s_bitset0_b64 s[84:85], s80
    s_lshl_b32 s81, s80, 11
    s_add_u32 s81, s81, s75
    s_cmp_ge_i32 s80, 0
    s_cselect_b64 exec, -1, 0
    buffer_load_dwordx4 v[100:103], v1, s[52:55], s81 offen sc0 sc1
    s_ff1_i32_b64 s80, s[84:85]
    s_bitset0_b64 s[84:85], s80
    s_lshl_b32 s81, s80, 11
    s_add_u32 s81, s81, s75
    s_cmp_ge_i32 s80, 0
    s_cselect_b64 exec, -1, 0
    buffer_load_dwordx4 v[104:107], v1, s[52:55], s81 offen sc0 sc1
    s_ff1_i32_b64 s80, s[84:85]
    s_bitset0_b64 s[84:85], s80
    s_lshl_b32 s81, s80, 11
    s_add_u32 s81, s81, s75
    s_cmp_ge_i32 s80, 0
    s_cselect_b64 exec, -1, 0
    buffer_load_dwordx4 v[108:111], v1, s[52:55], s81 offen sc0 sc1
    s_ff1_i32_b64 s80, s[84:85]
    s_bitset0_b64 s[84:85], s80
    s_lshl_b32 s81, s80, 11
    s_add_u32 s81, s81, s75
    s_cmp_ge_i32 s80, 0
    s_cbranch_scc0 L_got
    s_cselect_b64 exec, -1, 0
    buffer_load_dwordx4 v[112:115], v1, s[52:55], s81 offen sc0 sc1
    s_ff1_i32_b64 s80, s[84:85]
    s_bitset0_b64 s[84:85], s80
    s_lshl_b32 s81, s80, 11
    s_add_u32 s81, s81, s75
    s_cmp_ge_i32 s80, 0
    s_cselect_b64 exec, -1, 0
    buffer_load_dwordx4 v[116:119], v1, s[52:55], s81 offen sc0 sc1
    s_ff1_i32_b64 s80, s[84:85]
    s_bitset0_b64 s[84:85], s80
    s_lshl_b32 s81, s80, 11
    s_add_u32 s81, s81, s75
    s_cmp_ge_i32 s80, 0
    s_cselect_b64 exec, -1, 0
    buffer_load_dwordx4 v[120:123], v1, s[52:55], s81 offen sc0 sc1
    s_ff1_i32_b64 s80, s[84:85]
    s_bitset0_b64 s[84:85], s80
    s_lshl_b32 s81, s80, 11
    s_add_u32 s81, s81, s75
    s_cmp_ge_i32 s80, 0
    s_cselect_b64 exec, -1, 0
    buffer_load_dwordx4 v[124:127], v1, s[52:55], s81 offen sc0 sc1
    s_ff1_i32_b64 s80, s[84:85]
    s_bitset0_b64 s[84:85], s80
    s_lshl_b32 s81, s80, 11
    s_add_u32 s81, s81, s75
    s_cmp_ge_i32 s80, 0
    s_cselect_b64 exec, -1, 0
    buffer_load_dwordx4 v[128:131], v1, s[52:55], s81 offen sc0 sc1
    s_ff1_i32_b64 s80, s[84:85]
    s_bitset0_b64 s[84:85], s80
    s_lshl_b32 s81, s80, 11
    s_add_u32 s81, s81, s75
    s_cmp_ge_i32 s80, 0
    s_cselect_b64 exec, -1, 0
    buffer_load_dwordx4 v[132:135], v1, s[52:55], s81 offen sc0 sc1
    s_ff1_i32_b64 s80, s[84:85]
    s_bitset0_b64 s[84:85], s80
    s_lshl_b32 s81, s80, 11
    s_add_u32 s81, s81, s75
    s_cmp_ge_i32 s80, 0
    s_cselect_b64 exec, -1, 0
    buffer_load_dwordx4 v[136:139], v1, s[52:55], s81 offen sc0 sc1
    s_ff1_i32_b64 s80, s[84:85]
    s_bitset0_b64 s[84:85], s80
    s_lshl_b32 s81, s80, 11
    s_add_u32 s81, s81, s75
    s_cmp_ge_i32 s80, 0
    s_cselect_b64 exec, -1, 0
    buffer_load_dwordx4 v[140:143], v1, s[52:55], s81 offen sc0 sc1
    s_ff1_i32_b64 s80, s[84:85]
    s_bitset0_b64 s[84:85], s80
    s_lshl_b32 s81, s80, 11
    s_add_u32 s81, s81, s75
    s_cmp_ge_i32 s80, 0
    s_cbranch_scc0 L_got
    s_cselect_b64 exec, -1, 0
    buffer_load_dwordx4 v[144:147], v1, s[52:55], s81 offen sc0 sc1
    s_ff1_i32_b64 s80, s[84:85]
    s_bitset0_b64 s[84:85], s80
    s_lshl_b32 s81, s80, 11
    s_add_u32 s81, s81, s75
    s_cmp_ge_i32 s80, 0
    s_cselect_b64 exec, -1, 0
    buffer_load_dwordx4 v[148:151], v1, s[52:55], s81 offen sc0 sc1
    s_ff1_i32_b64 s80, s[84:85]
    s_bitset0_b64 s[84:85], s80
    s_lshl_b32 s81, s80, 11
    s_add_u32 s81, s81, s75
    s_cmp_ge_i32 s80, 0
    s_cselect_b64 exec, -1, 0
    buffer_load_dwordx4 v[152:155], v1, s[52:55], s81 offen sc0 sc1
    s_ff1_i32_b64 s80, s[84:85]
    s_bitset0_b64 s[84:85], s80
    s_lshl_b32 s81, s80, 11
    s_add_u32 s81, s81, s75
    s_cmp_ge_i32 s80, 0
    s_cselect_b64 exec, -1, 0
    buffer_load_dwordx4 v[156:159], v1, s[52:55], s81 offen sc0 sc1
    s_ff1_i32_b64 s80, s[84:85]
    s_bitset0_b64 s[84:85], s80
    s_lshl_b32 s81, s80, 11
    s_add_u32 s81, s81, s75
    s_cmp_ge_i32 s80, 0
    s_cselect_b64 exec, -1, 0
    buffer_load_dwordx4 v[160:163], v1, s[52:55], s81 offen sc0 sc1
    s_ff1_i32_b64 s80, s[84:85]
    s_bitset0_b64 s[84:85], s80
    s_lshl_b32 s81, s80, 11
    s_add_u32 s81, s81, s75
    s_cmp_ge_i32 s80, 0
    s_cselect_b64 exec, -1, 0
    buffer_load_dwordx4 v[164:167], v1, s[52:55], s81 offen sc0 sc1
    s_ff1_i32_b64 s80, s[84:85]
    s_bitset0_b64 s[84:85], s80
    s_lshl_b32 s81, s80, 11
    s_add_u32 s81, s81, s75
    s_cmp_ge_i32 s80, 0
    s_cselect_b64 exec, -1, 0
    buffer_load_dwordx4 v[168:171], v1, s[52:55], s81 offen sc0 sc1
    s_ff1_i32_b64 s80, s[84:85]
    s_bitset0_b64 s[84:85], s80
    s_lshl_b32 s81, s80, 11
    s_add_u32 s81, s81, s75
    s_cmp_ge_i32 s80, 0
    s_cselect_b64 exec, -1, 0
    buffer_load_dwordx4 v[172:175], v1, s[52:55], s81 offen sc0 sc1
L_got:
    s_mov_b64 exec, -1
    s_waitcnt vmcnt(0)
    v_max_f32 v5, v51, v55
    v_max3_f32 v5, v5, v59, v63
    v_max3_f32 v5, v5, v67, v71
    v_max3_f32 v5, v5, v75, v79
    v_max3_f32 v5, v5, v83, v87
    v_max3_f32 v5, v5, v91, v95
    v_max3_f32 v5, v5, v99, v103
    v_max3_f32 v5, v5, v107, v111
    v_max3_f32 v5, v5, v115, v119
    v_max3_f32 v5, v5, v123, v127
    v_max3_f32 v5, v5, v131, v135
    v_max3_f32 v5, v5, v139, v143
    v_max3_f32 v5, v5, v147, v151
    v_max3_f32 v5, v5, v155, v159
    v_max3_f32 v5, v5, v163, v167
    v_max3_f32 v5, v5, v171, v175
    s_nop 1
    v_max_f32_dpp v6, v5, v7 quad_perm:[0,0,2,2] row_mask:0xf bank_mask:0xf
    v_sub_f32 v5, v7, v6
    v_exp_f32 v5, v5
    v_mov_b32 v7, v6
    v_mul_f32 v8, v8, v5
    v_mul_f32 v12, v12, v5
    v_mul_f32 v13, v13, v5
    v_mul_f32 v14, v14, v5
    v_sub_f32_dpp v20, v51, v6 quad_perm:[0,0,2,2] row_mask:0xf bank_mask:0xf
    v_sub_f32_dpp v21, v55, v6 quad_perm:[0,0,2,2] row_mask:0xf bank_mask:0xf
    v_sub_f32_dpp v22, v59, v6 quad_perm:[0,0,2,2] row_mask:0xf bank_mask:0xf
    v_sub_f32_dpp v23, v63, v6 quad_perm:[0,0,2,2] row_mask:0xf bank_mask:0xf
    v_sub_f32_dpp v24, v67, v6 quad_perm:[0,0,2,2] row_mask:0xf bank_mask:0xf
    v_sub_f32_dpp v25, v71, v6 quad_perm:[0,0,2,2] row_mask:0xf bank_mask:0xf
    v_sub_f32_dpp v26, v75, v6 quad_perm:[0,0,2,2] row_mask:0xf bank_mask:0xf
    v_sub_f32_dpp v27, v79, v6 quad_perm:[0,0,2,2] row_mask:0xf bank_mask:0xf
    v_exp_f32 v20, v20
    v_exp_f32 v21, v21
    v_exp_f32 v22, v22
    v_exp_f32 v23, v23
    v_exp_f32 v24, v24
    v_exp_f32 v25, v25
    v_exp_f32 v26, v26
    v_exp_f32 v27, v27
    s_nop 0
    v_fmac_f32 v12, v20, v48
    v_fmac_f32 v13, v20, v49
    v_fmac_f32 v14, v20, v50
    v_fmac_f32 v8, v20, v51
    v_fmac_f32 v12, v21, v52
    v_fmac_f32 v13, v21, v53
    v_fmac_f32 v14, v21, v54
    v_fmac_f32 v8, v21, v55
    v_fmac_f32 v12, v22, v56
    v_fmac_f32 v13, v22, v57
    v_fmac_f32 v14, v22, v58
    v_fmac_f32 v8, v22, v59
    v_fmac_f32 v12, v23, v60
    v_fmac_f32 v13, v23, v61
    v_fmac_f32 v14, v23, v62
    v_fmac_f32 v8, v23, v63
    v_fmac_f32 v12, v24, v64
    v_fmac_f32 v13, v24, v65
    v_fmac_f32 v14, v24, v66
    v_fmac_f32 v8, v24, v67
    v_fmac_f32 v12, v25, v68
    v_fmac_f32 v13, v25, v69
    v_fmac_f32 v14, v25, v70
    v_fmac_f32 v8, v25, v71
    v_fmac_f32 v12, v26, v72
    v_fmac_f32 v13, v26, v73
    v_fmac_f32 v14, v26, v74
    v_fmac_f32 v8, v26, v75
    v_fmac_f32 v12, v27, v76
    v_fmac_f32 v13, v27, v77
    v_fmac_f32 v14, v27, v78
    v_fmac_f32 v8, v27, v79
    v_sub_f32_dpp v20, v83, v6 quad_perm:[0,0,2,2] row_mask:0xf bank_mask:0xf
    v_sub_f32_dpp v21, v87, v6 quad_perm:[0,0,2,2] row_mask:0xf bank_mask:0xf
    v_sub_f32_dpp v22, v91, v6 quad_perm:[0,0,2,2] row_mask:0xf bank_mask:0xf
    v_sub_f32_dpp v23, v95, v6 quad_perm:[0,0,2,2] row_mask:0xf bank_mask:0xf
    v_sub_f32_dpp v24, v99, v6 quad_perm:[0,0,2,2] row_mask:0xf bank_mask:0xf
    v_sub_f32_dpp v25, v103, v6 quad_perm:[0,0,2,2] row_mask:0xf bank_mask:0xf
    v_sub_f32_dpp v26, v107, v6 quad_perm:[0,0,2,2] row_mask:0xf bank_mask:0xf
    v_sub_f32_dpp v27, v111, v6 quad_perm:[0,0,2,2] row_mask:0xf bank_mask:0xf
    v_exp_f32 v20, v20
    v_exp_f32 v21, v21
    v_exp_f32 v22, v22
    v_exp_f32 v23, v23
    v_exp_f32 v24, v24
    v_exp_f32 v25, v25
    v_exp_f32 v26, v26
    v_exp_f32 v27, v27
    s_nop 0
    v_fmac_f32 v12, v20, v80
    v_fmac_f32 v13, v20, v81
    v_fmac_f32 v14, v20, v82
    v_fmac_f32 v8, v20, v83
    v_fmac_f32 v12, v21, v84
    v_fmac_f32 v13, v21, v85
    v_fmac_f32 v14, v21, v86
    v_fmac_f32 v8, v21, v87
    v_fmac_f32 v12, v22, v88
    v_fmac_f32 v13, v22, v89
    v_fmac_f32 v14, v22, v90
    v_fmac_f32 v8, v22, v91
    v_fmac_f32 v12, v23, v92
    v_fmac_f32 v13, v23, v93
    v_fmac_f32 v14, v23, v94
    v_fmac_f32 v8, v23, v95
    v_fmac_f32 v12, v24, v96
    v_fmac_f32 v13, v24, v97
    v_fmac_f32 v14, v24, v98
    v_fmac_f32 v8, v24, v99
    v_fmac_f32 v12, v25, v100
    v_fmac_f32 v13, v25, v101
    v_fmac_f32 v14, v25, v102
    v_fmac_f32 v8, v25, v103
    v_fmac_f32 v12, v26, v104
    v_fmac_f32 v13, v26, v105
    v_fmac_f32 v14, v26, v106
    v_fmac_f32 v8, v26, v107
    v_fmac_f32 v12, v27, v108
    v_fmac_f32 v13, v27, v109
    v_fmac_f32 v14, v27, v110
    v_fmac_f32 v8, v27, v111
    v_sub_f32_dpp v20, v115, v6 quad_perm:[0,0,2,2] row_mask:0xf bank_mask:0xf
    v_sub_f32_dpp v21, v119, v6 quad_perm:[0,0,2,2] row_mask:0xf bank_mask:0xf
    v_sub_f32_dpp v22, v123, v6 quad_perm:[0,0,2,2] row_mask:0xf bank_mask:0xf
    v_sub_f32_dpp v23, v127, v6 quad_perm:[0,0,2,2] row_mask:0xf bank_mask:0xf
    v_sub_f32_dpp v24, v131, v6 quad_perm:[0,0,2,2] row_mask:0xf bank_mask:0xf
    v_sub_f32_dpp v25, v135, v6 quad_perm:[0,0,2,2] row_mask:0xf bank_mask:0xf
    v_sub_f32_dpp v26, v139, v6 quad_perm:[0,0,2,2] row_mask:0xf bank_mask:0xf
    v_sub_f32_dpp v27, v143, v6 quad_perm:[0,0,2,2] row_mask:0xf bank_mask:0xf
    v_exp_f32 v20, v20
    v_exp_f32 v21, v21
    v_exp_f32 v22, v22
    v_exp_f32 v23, v23
    v_exp_f32 v24, v24
    v_exp_f32 v25, v25
    v_exp_f32 v26, v26
    v_exp_f32 v27, v27
    s_nop 0
    v_fmac_f32 v12, v20, v112
    v_fmac_f32 v13, v20, v113
    v_fmac_f32 v14, v20, v114
    v_fmac_f32 v8, v20, v115
    v_fmac_f32 v12, v21, v116
    v_fmac_f32 v13, v21, v117
    v_fmac_f32 v14, v21, v118
    v_fmac_f32 v8, v21, v119
    v_fmac_f32 v12, v22, v120
    v_fmac_f32 v13, v22, v121
    v_fmac_f32 v14, v22, v122
    v_fmac_f32 v8, v22, v123
    v_fmac_f32 v12, v23, v124
    v_fmac_f32 v13, v23, v125
    v_fmac_f32 v14, v23, v126
    v_fmac_f32 v8, v23, v127
    v_fmac_f32 v12, v24, v128
    v_fmac_f32 v13, v24, v129
    v_fmac_f32 v14, v24, v130
    v_fmac_f32 v8, v24, v131
    v_fmac_f32 v12, v25, v132
    v_fmac_f32 v13, v25, v133
    v_fmac_f32 v14, v25, v134
    v_fmac_f32 v8, v25, v135
    v_fmac_f32 v12, v26, v136
    v_fmac_f32 v13, v26, v137
    v_fmac_f32 v14, v26, v138
    v_fmac_f32 v8, v26, v139
    v_fmac_f32 v12, v27, v140
    v_fmac_f32 v13, v27, v141
    v_fmac_f32 v14, v27, v142
    v_fmac_f32 v8, v27, v143
    v_sub_f32_dpp v20, v147, v6 quad_perm:[0,0,2,2] row_mask:0xf bank_mask:0xf
    v_sub_f32_dpp v21, v151, v6 quad_perm:[0,0,2,2] row_mask:0xf bank_mask:0xf
    v_sub_f32_dpp v22, v155, v6 quad_perm:[0,0,2,2] row_mask:0xf bank_mask:0xf
    v_sub_f32_dpp v23, v159, v6 quad_perm:[0,0,2,2] row_mask:0xf bank_mask:0xf
    v_sub_f32_dpp v24, v163, v6 quad_perm:[0,0,2,2] row_mask:0xf bank_mask:0xf
    v_sub_f32_dpp v25, v167, v6 quad_perm:[0,0,2,2] row_mask:0xf bank_mask:0xf
    v_sub_f32_dpp v26, v171, v6 quad_perm:[0,0,2,2] row_mask:0xf bank_mask:0xf
    v_sub_f32_dpp v27, v175, v6 quad_perm:[0,0,2,2] row_mask:0xf bank_mask:0xf
    v_exp_f32 v20, v20
    v_exp_f32 v21, v21
    v_exp_f32 v22, v22
    v_exp_f32 v23, v23
    v_exp_f32 v24, v24
    v_exp_f32 v25, v25
    v_exp_f32 v26, v26
    v_exp_f32 v27, v27
    s_nop 0
    v_fmac_f32 v12, v20, v144
    v_fmac_f32 v13, v20, v145
    v_fmac_f32 v14, v20, v146
    v_fmac_f32 v8, v20, v147
    v_fmac_f32 v12, v21, v148
    v_fmac_f32 v13, v21, v149
    v_fmac_f32 v14, v21, v150
    v_fmac_f32 v8, v21, v151
    v_fmac_f32 v12, v22, v152
    v_fmac_f32 v13, v22, v153
    v_fmac_f32 v14, v22, v154
    v_fmac_f32 v8, v22, v155
    v_fmac_f32 v12, v23, v156
    v_fmac_f32 v13, v23, v157
    v_fmac_f32 v14, v23, v158
    v_fmac_f32 v8, v23, v159
    v_fmac_f32 v12, v24, v160
    v_fmac_f32 v13, v24, v161
    v_fmac_f32 v14, v24, v162
    v_fmac_f32 v8, v24, v163
    v_fmac_f32 v12, v25, v164
    v_fmac_f32 v13, v25, v165
    v_fmac_f32 v14, v25, v166
    v_fmac_f32 v8, v25, v167
    v_fmac_f32 v12, v26, v168
    v_fmac_f32 v13, v26, v169
    v_fmac_f32 v14, v26, v170
    v_fmac_f32 v8, v26, v171
    v_fmac_f32 v12, v27, v172
    v_fmac_f32 v13, v27, v173
    v_fmac_f32 v14, v27, v174
    v_fmac_f32 v8, v27, v175
    s_cmp_lg_u64 s[84:85], 0
    s_cbranch_scc1 L_chunk
    s_cmp_lg_u32 s74, 0
    s_cbranch_scc1 L_fin
    v_cndmask_b32 v15, v7, v8, s[66:67]
    v_mov_b32 v5, s95
    s_and_b32 s79, s97, 31
    s_lshr_b32 s80, s97, 10
    s_lshl_b32 s80, s80, 3
    s_and_b32 s83, s72, 7
    s_add_u32 s80, s80, s83
    s_bfm_b64 s[88:89], 1, s80
    s_bfe_u32 s83, s97, 0x50005
    s_mul_i32 s83, s83, s70
    s_cmp_lg_u32 s83, 512
    s_cbranch_scc1 L_rec
    s_mov_b64 exec, 1
    buffer_store_dword v5, v3, s[52:55], s77 offen offset:1028
    s_mov_b64 exec, -1
    s_branch L_fin
L_rec:
    s_lshl_b32 s83, s83, 16
    s_or_b32 s89, s89, s83
    v_mov_b32 v16, s88
    v_mov_b32 v17, s89
    s_lshl_b32 s75, s79, 17
    s_add_u32 s75, s75, 4194304
    s_lshl_b32 s80, s80, 11
    s_add_u32 s80, s80, s75
    buffer_store_dwordx4 v[12:15], v1, s[52:55], s80 offen sc0 sc1
    s_mov_b64 exec, 1
    buffer_store_dword v5, v3, s[52:55], s77 offen offset:1028
    s_lshl_b32 s80, s79, 8
    s_add_u32 s80, s80, 23076864
    s_waitcnt vmcnt(0)
    buffer_atomic_add_x2 v[16:17], v3, s[52:55], s80 offen sc0 sc1
    s_waitcnt vmcnt(0)
    s_mov_b64 exec, -1
    v_readfirstlane_b32 s84, v16
    v_readfirstlane_b32 s85, v17
    s_add_u32 s84, s84, s88
    s_add_u32 s85, s85, s89
    s_lshr_b32 s80, s85, 16
    s_cmp_lg_u32 s80, 512
    s_cbranch_scc1 L_next
    s_mov_b32 s74, 1
    s_and_b32 s85, s85, 0xffff
    s_branch L_merge
L_fin:
    s_nop 1
    v_mov_b32_dpp v5, v8 quad_perm:[1,1,3,3] row_mask:0xf bank_mask:0xf
    v_rcp_f32 v5, v5
    s_mul_i32 s80, s79, 384
    v_mul_f32 v12, v12, v5
    v_mul_f32 v13, v13, v5
    v_mul_f32 v14, v14, v5
    v_cvt_pk_bf16_f32 v12, v12, v12
    v_cvt_pk_bf16_f32 v13, v13, v13
    v_cvt_pk_bf16_f32 v14, v14, v14
    buffer_store_short v12, v11, s[56:59], s80 offen offset:0
    buffer_store_short v13, v11, s[56:59], s80 offen offset:128
    buffer_store_short v14, v11, s[56:59], s80 offen offset:256
L_next:
    s_add_u32 s71, s71, s70
    s_branch L_round
L_last:
    s_lshl_b32 s75, s96, 9
    s_add_u32 s75, s75, 1572864
    v_lshrrev_b32 v6, 1, v0
    v_lshlrev_b32 v28, 4, v6
L_inf:
    buffer_load_dwordx4 v[48:51], v28, s[52:55], s75 offen sc0 sc1
    s_waitcnt vmcnt(0)
    v_cmp_ne_u32 vcc, s69, v49
    s_cmp_lg_u64 vcc, 0
    s_cbranch_scc1 L_inf
    v_mov_b32 v7, v50
    s_nop 1
    v_max_f32_dpp v7, v7, v7 row_ror:8 row_mask:0xf bank_mask:0xf
    s_nop 1
    v_max_f32_dpp v7, v7, v7 row_ror:4 row_mask:0xf bank_mask:0xf
    s_nop 1
    v_max_f32_dpp v7, v7, v7 row_ror:2 row_mask:0xf bank_mask:0xf
    s_nop 1
    v_max_f32_dpp v7, v7, v7 row_ror:1 row_mask:0xf bank_mask:0xf
    v_mov_b32 v5, v7
    s_nop 1
    v_permlane32_swap_b32 v7, v5
    s_nop 1
    v_max_f32 v7, v7, v5
    v_mov_b32 v5, v7
    s_nop 1
    v_permlane16_swap_b32 v7, v5
    s_nop 1
    v_max_f32 v7, v7, v5
    v_sub_f32 v20, v50, v7
    v_exp_f32 v20, v20
    s_nop 0
    v_mul_f32 v8, v20, v51
    s_nop 1
    v_add_f32_dpp v8, v8, v8 row_ror:8 row_mask:0xf bank_mask:0xf
    s_nop 1
    v_add_f32_dpp v8, v8, v8 row_ror:4 row_mask:0xf bank_mask:0xf
    s_nop 1
    v_add_f32_dpp v8, v8, v8 row_ror:2 row_mask:0xf bank_mask:0xf
    s_nop 1
    v_add_f32_dpp v8, v8, v8 row_ror:1 row_mask:0xf bank_mask:0xf
    v_mov_b32 v5, v8
    s_nop 1
    v_permlane32_swap_b32 v8, v5
    s_nop 1
    v_add_f32 v8, v8, v5
    v_mov_b32 v5, v8
    s_nop 1
    v_permlane16_swap_b32 v8, v5
    s_nop 1
    v_add_f32 v8, v8, v5
    v_rcp_f32 v8, v8
    v_and_b32 v5, 1, v0
    v_mul_f32 v8, 2.0, v8
    v_mul_f32 v20, v20, v8
    v_lshlrev_b32 v28, 11, v6
    v_lshl_add_u32 v28, v5, 4, v28
    s_lshl_b32 s75, s96, 16
    s_lshl_b32 s80, s92, 5
    s_add_u32 s75, s75, s80
    v_mov_b32 v51, 0
    v_mov_b32 v55, 0
    v_mov_b32 v59, 0
    v_mov_b32 v63, 0
    v_mov_b32 v12, 0
    v_mov_b32 v13, 0
    v_mov_b32 v14, 0
    v_bfe_u32 v6, v0, 4, 1
    v_lshrrev_b32 v11, 5, v0
    v_lshl_add_u32 v11, v6, 1, v11
    v_lshlrev_b32 v11, 7, v11
    v_lshl_add_u32 v11, v5, 3, v11
    s_and_b32 s80, s92, 7
    s_lshl_b32 s80, s80, 4
    s_lshr_b32 s81, s92, 3
    s_lshl_b32 s81, s81, 1
    s_add_u32 s80, s80, s81
    s_add_u32 s79, s96, 24
    s_mul_i32 s78, s79, 384
    s_add_u32 s78, s78, s80
    s_mov_b64 s[24:25], -1
    s_mov_b32 s32, 0x00030003
    s_mov_b32 s33, 0x00000003
L_dt:
    ds_read_b32 v5, v3 offset:144
    s_waitcnt lgkmcnt(0)
    v_readfirstlane_b32 s80, v5
    s_cmp_eq_u32 s80, 0
    s_cbranch_scc1 L_dt
L_pa:
    buffer_load_dwordx4 v[48:51], v28, s[52:55], s75 offen offset:0 sc0 sc1
    s_waitcnt vmcnt(0)
    v_cmpx_eq_u32 vcc, s69, v51
    v_fmac_f32 v12, v20, v48
    v_fmac_f32 v13, v20, v49
    v_fmac_f32 v14, v20, v50
    s_andn2_b64 s[24:25], s[24:25], vcc
    s_mov_b64 exec, s[24:25]
    s_bcnt1_i32_b64 s80, s[24:25]
    s_cmp_gt_u32 s80, 0
    s_cbranch_scc1 L_pa
L_pd:
    s_mov_b64 exec, -1
    v_mov_b32 v15, v14
    v_permlane32_swap_b32 v12, v13
    s_nop 0
    v_permlane32_swap_b32 v14, v15
    v_add_f32 v12, v12, v13
    v_add_f32 v14, v14, v15
    s_nop 1
    v_permlane16_swap_b32 v12, v14
    v_add_f32 v12, v12, v14
    s_nop 1
    v_add_f32_dpp v12, v12, v12 row_ror:8 row_mask:0xf bank_mask:0xf
    s_nop 1
    v_add_f32_dpp v12, v12, v12 row_ror:4 row_mask:0xf bank_mask:0xf
    s_nop 1
    v_add_f32_dpp v12, v12, v12 row_ror:2 row_mask:0xf bank_mask:0xf
    s_mov_b64 exec, s[32:33]
    v_cvt_pk_bf16_f32 v12, v12, v12
    buffer_store_short v12, v11, s[56:59], s78 offen
L_end:
    s_endpgm
L_ticket:
    v_lshlrev_b32 v1, 2, v0
    v_mov_b32 v2, 0
    v_lshlrev_b32 v4, 4, v0
    v_mov_b32 v8, -1
    v_mov_b32 v9, -1
    v_mov_b32 v10, -1
    v_mov_b32 v11, -1
    ds_write_b128 v4, v[8:11] offset:256
    ds_write_b128 v4, v[8:11] offset:1280
    ds_write_b128 v4, v[8:11] offset:2304
    s_memrealtime s[80:81]
    s_waitcnt lgkmcnt(0)
    s_barrier
    s_mov_b32 s52, s22
    s_and_b32 s53, s23, 0xffff
    s_mov_b32 s54, 25165824
    s_mov_b32 s55, 0x00020000
    s_mov_b32 s60, s20
    s_and_b32 s61, s21, 0xffff
    s_mov_b32 s62, 256
    s_mov_b32 s63, 0x00020000
    s_max_u32 s69, s80, 1
    s_cmp_lg_u32 s2, 0
    s_cbranch_scc1 L_kd
    v_lshlrev_b32 v5, 8, v0
    s_mov_b32 s80, 23068672
    v_mov_b32 v3, 0
    buffer_store_dwordx2 v[2:3], v5, s[52:55], s80 offen sc0 sc1
    v_mov_b32 v3, s69
    s_mov_b64 exec, 1
    s_waitcnt vmcnt(0)
    buffer_store_dword v3, v2, s[60:63], 0 offen sc0 sc1
    s_mov_b64 exec, -1
L_kd:
    ds_read_b32 v3, v2 offset:128
    s_waitcnt lgkmcnt(0)
    v_readfirstlane_b32 s80, v3
    s_cmp_eq_u32 s80, 0
    s_cbranch_scc1 L_kd
    ds_read_b128 v[24:27], v4 offset:16128
    ds_read_b128 v[28:31], v4 offset:17152
    ds_read_b128 v[32:35], v4 offset:18176
    ds_read_b128 v[36:39], v4 offset:19200
    s_waitcnt lgkmcnt(0)
    v_max_f32 v18, v24, v25
    v_max3_f32 v18, v18, v26, v27
    v_max3_f32 v18, v18, v28, v29
    v_max3_f32 v18, v18, v30, v31
    v_max3_f32 v18, v18, v32, v33
    v_max3_f32 v18, v18, v34, v35
    v_max3_f32 v18, v18, v36, v37
    v_max3_f32 v18, v18, v38, v39
    s_nop 1
    v_max_f32_dpp v18, v18, v18 row_ror:8 row_mask:0xf bank_mask:0xf
    s_nop 1
    v_max_f32_dpp v18, v18, v18 row_ror:4 row_mask:0xf bank_mask:0xf
    s_nop 1
    v_max_f32_dpp v18, v18, v18 row_ror:2 row_mask:0xf bank_mask:0xf
    s_nop 1
    v_max_f32_dpp v18, v18, v18 row_ror:1 row_mask:0xf bank_mask:0xf
    v_mov_b32 v3, v18
    s_nop 1
    v_permlane32_swap_b32 v18, v3
    s_nop 1
    v_max_f32 v18, v18, v3
    v_mov_b32 v3, v18
    s_nop 1
    v_permlane16_swap_b32 v18, v3
    s_nop 1
    v_max_f32 v18, v18, v3
    v_sub_f32 v24, v24, v18
    v_sub_f32 v25, v25, v18
    v_sub_f32 v26, v26, v18
    v_sub_f32 v27, v27, v18
    v_sub_f32 v28, v28, v18
    v_sub_f32 v29, v29, v18
    v_sub_f32 v30, v30, v18
    v_sub_f32 v31, v31, v18
    v_sub_f32 v32, v32, v18
    v_sub_f32 v33, v33, v18
    v_sub_f32 v34, v34, v18
    v_sub_f32 v35, v35, v18
    v_sub_f32 v36, v36, v18
    v_sub_f32 v37, v37, v18
    v_sub_f32 v38, v38, v18
    v_sub_f32 v39, v39, v18
    v_exp_f32 v24, v24
    v_exp_f32 v25, v25
    v_exp_f32 v26, v26
    v_exp_f32 v27, v27
    v_exp_f32 v28, v28
    v_exp_f32 v29, v29
    v_exp_f32 v30, v30
    v_exp_f32 v31, v31
    v_exp_f32 v32, v32
    v_exp_f32 v33, v33
    v_exp_f32 v34, v34
    v_exp_f32 v35, v35
    v_exp_f32 v36, v36
    v_exp_f32 v37, v37
    v_exp_f32 v38, v38
    v_exp_f32 v39, v39
    ds_write_b32 v2, v18 offset:160
    v_add_f32 v19, v24, v25
    v_add_f32 v19, v19, v26
    v_add_f32 v19, v19, v27
    v_add_f32 v19, v19, v28
    v_add_f32 v19, v19, v29
    v_add_f32 v19, v19, v30
    v_add_f32 v19, v19, v31
    v_add_f32 v19, v19, v32
    v_add_f32 v19, v19, v33
    v_add_f32 v19, v19, v34
    v_add_f32 v19, v19, v35
    v_add_f32 v19, v19, v36
    v_add_f32 v19, v19, v37
    v_add_f32 v19, v19, v38
    v_add_f32 v19, v19, v39
    s_nop 1
    v_add_f32_dpp v19, v19, v19 row_ror:8 row_mask:0xf bank_mask:0xf
    s_nop 1
    v_add_f32_dpp v19, v19, v19 row_ror:4 row_mask:0xf bank_mask:0xf
    s_nop 1
    v_add_f32_dpp v19, v19, v19 row_ror:2 row_mask:0xf bank_mask:0xf
    s_nop 1
    v_add_f32_dpp v19, v19, v19 row_ror:1 row_mask:0xf bank_mask:0xf
    v_mov_b32 v3, v19
    s_nop 1
    v_permlane32_swap_b32 v19, v3
    s_nop 1
    v_add_f32 v19, v19, v3
    v_mov_b32 v3, v19
    s_nop 1
    v_permlane16_swap_b32 v19, v3
    s_nop 1
    v_add_f32 v19, v19, v3
    s_lshl_b32 s80, s2, 11
    s_add_u32 s80, s80, 18874368
    s_waitcnt lgkmcnt(0)
    s_mov_b64 exec, -1
L_tg:
    buffer_load_dword v3, v2, s[60:63], 0 offen sc0 sc1
    s_waitcnt vmcnt(0)
    v_readfirstlane_b32 s69, v3
    s_cmp_eq_u32 s69, 0
    s_cbranch_scc1 L_tg
    s_getreg_b32 s81, hwreg(HW_REG_XCC_ID)
    s_and_b32 s81, s81, 15
    v_mov_b32 v16, s81
    v_mov_b32 v17, s69
    s_lshl_b32 s80, s2, 11
    s_mov_b64 exec, 1
    s_lshl_b32 s82, s2, 4
    s_add_u32 s82, s82, 1572864
    buffer_store_dwordx4 v[16:19], v2, s[52:55], s82 offen sc0 sc1
    v_mov_b32 v12, s69
    v_mov_b32 v13, s69
    s_add_u32 s82, s80, 2097152
    buffer_store_dwordx2 v[12:13], v2, s[52:55], s82 offen offset:1024
    s_add_u32 s82, s80, 2621440
    buffer_store_dwordx2 v[12:13], v2, s[52:55], s82 offen offset:1024
    s_mov_b64 exec, -1
    s_mov_b32 s73, s81
    s_lshl_b32 s80, s79, 2
    s_lshr_b32 s74, 0x54465464, s80
    s_and_b32 s74, s74, 15
    s_mov_b32 s75, 0
    s_mov_b32 s95, s69
    s_lshl_b32 s77, s2, 11
    s_lshl_b32 s94, s79, 16
    s_mov_b32 s76, 2097152
    v_mov_b32 v19, 0
    v_lshlrev_b32 v20, 11, v0
    v_mov_b32 v21, v4
L_fl:
    ds_read_b32 v3, v19
    s_waitcnt lgkmcnt(0)
    v_readfirstlane_b32 s80, v3
    s_cmp_eq_u32 s80, 0
    s_cbranch_scc1 L_fl
    ds_read_b128 v[24:27], v21 offset:20480
    ds_read_b128 v[28:31], v21 offset:21504
    ds_read_b128 v[32:35], v21 offset:22528
    ds_read_b128 v[36:39], v21 offset:23552
    s_waitcnt lgkmcnt(0)
    s_nop 0
    v_add_f32_dpp v37, v37, v37 row_ror:8 row_mask:0xf bank_mask:0xf
    v_add_f32_dpp v38, v38, v38 row_ror:8 row_mask:0xf bank_mask:0xf
    s_nop 0
    v_add_f32_dpp v37, v37, v37 row_ror:4 row_mask:0xf bank_mask:0xf
    v_add_f32_dpp v38, v38, v38 row_ror:4 row_mask:0xf bank_mask:0xf
    s_nop 0
    v_add_f32_dpp v37, v37, v37 row_ror:2 row_mask:0xf bank_mask:0xf
    v_add_f32_dpp v38, v38, v38 row_ror:2 row_mask:0xf bank_mask:0xf
    s_nop 0
    v_add_f32_dpp v37, v37, v37 row_ror:1 row_mask:0xf bank_mask:0xf
    v_add_f32_dpp v38, v38, v38 row_ror:1 row_mask:0xf bank_mask:0xf
    v_mov_b32 v40, v36
    v_mov_b32 v41, v36
    s_branch L_x2
L_w2:
    s_branch L_walked
L_x2:
    s_nop 1
    v_permlane32_swap_b32 v40, v41
    s_nop 1
    v_max_f32 v40, v40, v41
    v_mov_b32 v41, v40
    s_nop 1
    v_permlane16_swap_b32 v40, v41
    s_nop 1
    v_max_f32 v40, v40, v41
    v_sub_f32 v41, v36, v40
    v_exp_f32 v41, v41
    v_mov_b32 v48, v40
    v_mul_f32 v37, v37, v41
    v_mul_f32 v38, v38, v41
    v_mul_f32 v41, 0x58000000, v41
    v_fma_f32 v24, v24, v41, -v38
    v_fma_f32 v25, v25, v41, -v38
    v_fma_f32 v26, v26, v41, -v38
    v_fma_f32 v27, v27, v41, -v38
    v_fma_f32 v28, v28, v41, -v38
    v_fma_f32 v29, v29, v41, -v38
    v_fma_f32 v30, v30, v41, -v38
    v_fma_f32 v31, v31, v41, -v38
    v_fma_f32 v32, v32, v41, -v38
    v_fma_f32 v33, v33, v41, -v38
    v_fma_f32 v34, v34, v41, -v38
    v_fma_f32 v35, v35, v41, -v38
    v_mov_b32 v40, v37
    s_nop 1
    v_permlane32_swap_b32 v37, v40
    v_permlane32_swap_b32 v24, v26
    v_permlane32_swap_b32 v25, v27
    v_permlane32_swap_b32 v28, v30
    v_permlane32_swap_b32 v29, v31
    v_permlane32_swap_b32 v32, v34
    v_permlane32_swap_b32 v33, v35
    s_nop 1
    v_add_f32 v37, v37, v40
    v_add_f32 v24, v24, v26
    v_add_f32 v25, v25, v27
    v_add_f32 v28, v28, v30
    v_add_f32 v29, v29, v31
    v_add_f32 v32, v32, v34
    v_add_f32 v33, v33, v35
    v_mov_b32 v40, v37
    s_nop 1
    v_permlane16_swap_b32 v37, v40
    v_permlane16_swap_b32 v24, v25
    v_permlane16_swap_b32 v28, v29
    v_permlane16_swap_b32 v32, v33
    s_nop 1
    v_add_f32 v49, v37, v40
    v_add_f32 v44, v24, v25
    v_add_f32 v45, v28, v29
    v_add_f32 v46, v32, v33
    v_mov_b32 v8, v44
    v_mov_b32 v9, v45
    v_mov_b32 v10, v46
    v_cndmask_b32 v11, v48, v49, s[66:67]
    s_cmp_eq_u32 s75, 1
    s_cbranch_scc1 L_dep
    s_cmp_lg_u32 s75, 0
    s_cbranch_scc1 L_guard
    s_lshr_b32 s82, s3, 5
    s_lshl_b32 s83, s79, 9
    s_add_u32 s83, s83, 1572864
    s_bfm_b64 exec, 32, 0
L_reg:
    buffer_load_dwordx2 v[12:13], v4, s[52:55], s83 offen sc0 sc1
    s_waitcnt vmcnt(0)
    v_cmp_ne_u32 vcc, s69, v13
    s_cmp_lg_u64 vcc, 0
    s_cbranch_scc1 L_reg
    v_cmp_eq_u32 s[86:87], s73, v12
    s_nop 1
    v_mov_b32 v14, s86
    v_mov_b32 v15, s87
    ds_write_b64 v2, v[14:15] offset:152
    s_waitcnt lgkmcnt(0)
    ds_write_b32 v2, v13 offset:140
    s_mov_b64 exec, -1
    s_branch L_dep
L_guard:
    s_sub_u32 s80, s95, 1
    s_add_u32 s81, s94, s76
L_guard2:
    v_mov_b32 v12, s69
    s_mov_b64 exec, s[86:87]
    buffer_load_dword v12, v20, s[52:55], s81 offen offset:1028 sc0 sc1
    s_mov_b64 exec, -1
    s_waitcnt vmcnt(0)
    v_cmp_eq_u32 vcc, s80, v12
    s_cmp_eq_u64 vcc, 0
    s_cbranch_scc1 L_guard2
L_dep:
    s_add_u32 s75, s75, 1
    s_add_u32 s95, s95, 1
    s_add_u32 s80, s77, s76
    v_mov_b32 v3, s95
    s_waitcnt lgkmcnt(0)
    buffer_store_dwordx4 v[8:11], v4, s[52:55], s80 offen
    s_mov_b64 exec, 1
    s_waitcnt vmcnt(0)
    buffer_store_dword v3, v2, s[52:55], s80 offen offset:1024
    s_mov_b64 exec, -1
    s_xor_b32 s76, s76, 0x80000
    v_add_u32 v21, 4096, v21
    v_add_u32 v19, 4, v19
    s_cmp_lt_u32 s75, s74
    s_cbranch_scc1 L_fl
    s_endpgm
L_ctl:
    s_memtime s[48:49]
    s_memrealtime s[50:51]
    s_mov_b32 s56, 8
    s_mov_b32 s57, -1
    s_mov_b32 s58, 0
    s_mov_b32 s92, 1
    s_mov_b32 s59, 8
    v_lshlrev_b32 v1, 2, v0
    v_mov_b32 v2, 0
    ds_write_b32 v1, v2 offset:3328
    s_and_b32 s70, s2, 31
    s_lshl_b32 s70, s70, 2
    s_mov_b32 s71, 1
    v_mov_b32 v7, s2
    v_and_b32 v10, 15, v0
    v_lshrrev_b32 v8, 5, v7
    v_lshl_add_u32 v10, v8, 4, v10
    v_lshrrev_b32 v9, 4, v0
    v_lshl_add_u32 v10, v9, 7, v10
    s_lshl_b32 s82, s79, 3
    s_mov_b32 s80, 0xeff4fa00
    s_mov_b32 s81, 0xdbe0e5ea
    s_lshr_b64 s[80:81], s[80:81], s82
    s_sext_i32_i8 s80, s80
    s_mov_b32 exec_lo, 0x0
    s_mov_b32 exec_hi, 0x3ff
    v_add_u32 v10, s80, v10
    s_mov_b32 s80, 0xeff43d4c
    s_mov_b32 s81, 0xdbe0e5ea
    s_lshr_b64 s[80:81], s[80:81], s82
    s_sext_i32_i8 s80, s80
    s_mov_b32 exec_lo, 0x0
    s_mov_b32 exec_hi, 0x400
    v_add_u32 v10, s80, v10
    s_mov_b32 s80, 0x2c37424d
    s_mov_b32 s81, 0xb1621
    s_lshr_b64 s[80:81], s[80:81], s82
    s_sext_i32_i8 s80, s80
    s_mov_b32 exec_lo, 0x0
    s_mov_b32 exec_hi, 0xf800
    v_add_u32 v10, s80, v10
    s_mov_b64 exec, -1
    v_mul_u32_u24 v30, 1572864, v10
    v_and_b32 v9, 3, v7
    v_lshl_add_u32 v8, v10, 2, v9
    v_bfe_u32 v9, v7, 2, 3
    v_lshl_add_u32 v8, v8, 3, v9
    v_mul_u32_u24 v9, 384, v8
    v_lshlrev_b32 v8, 7, v8
    s_waitcnt lgkmcnt(0)
    s_mov_b32 s32, s10
    s_and_b32 s33, s11, 0xffff
    s_mov_b32 s34, 6291456
    s_mov_b32 s35, 0x00020000
    buffer_load_dword v10, v9, s[32:35], 0 offen offset:0
    buffer_load_dword v11, v9, s[32:35], 0 offen offset:128
    buffer_load_dword v12, v9, s[32:35], 0 offen offset:256
    s_mov_b32 s36, s12
    s_and_b32 s37, s13, 0xffff
    s_mov_b32 s38, 6291456
    s_mov_b32 s39, 0x00020000
    buffer_load_dword v13, v9, s[36:39], 0 offen offset:0
    buffer_load_dword v14, v9, s[36:39], 0 offen offset:128
    buffer_load_dword v15, v9, s[36:39], 0 offen offset:256
    s_mov_b32 s40, s14
    s_and_b32 s41, s15, 0xffff
    s_mov_b32 s42, 2097152
    s_mov_b32 s43, 0x00020000
    buffer_load_dword v16, v8, s[40:43], 0 offen offset:0
    s_mov_b32 s44, s16
    s_and_b32 s45, s17, 0xffff
    s_mov_b32 s46, 2097152
    s_mov_b32 s47, 0x00020000
    buffer_load_dword v17, v8, s[44:47], 0 offen offset:0
    s_mov_b32 s52, s22
    s_and_b32 s53, s23, 0xffff
    s_mov_b32 s54, 25165824
    s_mov_b32 s55, 0x00020000
    v_lshlrev_b32 v7, 7, v0
    s_lshl_b32 s80, s2, 11
    s_add_u32 s81, s80, 2097152
    s_add_u32 s82, s80, 2621440
    s_mov_b64 exec, 0x1ff
    buffer_load_dword v18, v7, s[52:55], s81 offen
    buffer_load_dword v19, v7, s[52:55], s82 offen
    s_mov_b64 exec, -1
    s_barrier
    s_mov_b32 s60, s20
    s_and_b32 s61, s21, 0xffff
    s_mov_b32 s62, 256
    s_mov_b32 s63, 0x00020000
    s_mov_b32 s52, s22
    s_and_b32 s53, s23, 0xffff
    s_mov_b32 s54, 25165824
    s_mov_b32 s55, 0x00020000
    s_getreg_b32 s76, hwreg(HW_REG_XCC_ID)
    s_and_b32 s76, s76, 15
    s_lshr_b32 s70, s70, 1
    s_and_b32 s75, s2, 31
    s_cmp_eq_u32 s75, 0
    s_cselect_b32 s75, 32, s75
    s_mul_i32 s77, s75, 32
    s_mul_i32 s83, s75, 16
    s_add_u32 s83, s83, 768
    s_min_u32 s77, s77, s83
    v_lshlrev_b32 v1, 1, v0
    v_lshlrev_b32 v7, 7, v0
    s_mov_b32 s24, s6
    s_and_b32 s25, s7, 0xffff
    s_mov_b32 s26, 805306368
    s_mov_b32 s27, 0x00020000
    s_mov_b32 s28, s8
    s_and_b32 s29, s9, 0xffff
    s_mov_b32 s30, 805306368
    s_mov_b32 s31, 0x00020000
    s_and_b32 s88, s2, 31
    s_lshl_b32 s89, s88, 4
    s_sub_i32 s89, s89, 63
    s_mov_b32 s90, 1572800
L_c:
    ds_read_b32 v3, v2 offset:3328
    ds_read_b32 v4, v2 offset:144
    s_mov_b64 exec, 1
    s_waitcnt lgkmcnt(0)
    v_add_u32 v3, 1, v3
    buffer_store_short v3, v2, s[60:63], s70 offen offset:128
    s_bfm_b64 exec, 33, 0
    buffer_load_ushort v5, v1, s[60:63], 0 offen offset:128 sc1
    v_readfirstlane_b32 s72, v3
    v_readfirstlane_b32 s81, v4
    s_add_u32 s80, s71, s72
    s_mov_b32 s71, s72
    s_mov_b64 exec, 0xffffffff
    s_waitcnt vmcnt(0)
    v_cmp_ne_u32 vcc, 0, v5
    v_lshlrev_b32 v6, 1, v5
    v_readlane_b32 s86, v5, 32
    v_cmp_le_u32 s[82:83], s80, v6
    s_bcnt1_i32_b64 s73, vcc
    s_cmp_eq_u32 s86, 0
    s_cselect_b32 s86, 1024, s86
    s_bcnt1_i32_b64 s74, s[82:83]
    s_sub_i32 s86, s86, 1003
    s_cmp_ge_u32 s72, 1024
    s_cselect_b32 s80, 1, 0
    s_add_i32 s86, s86, s80
    s_cmp_ge_u32 s72, 1920
    s_cselect_b32 s80, 2, 0
    s_add_i32 s86, s86, s80
    s_cmp_ge_u32 s72, 1024
    s_cselect_b32 s80, s58, s57
    s_add_i32 s86, s86, s80
    s_mul_i32 s80, s73, s86
    s_lshl_b32 s74, s74, 5
    s_cmp_lt_i32 s74, s80
    s_cselect_b32 s86, 1, 0
    s_lshl_b32 s82, s73, 5
    s_add_u32 s74, s74, s82
    s_cmp_lt_i32 s74, s80
    s_cselect_b32 s86, 2, s86
    s_cmp_ge_u32 s72, 1024
    s_cselect_b32 s80, s59, s92
    s_cmp_eq_u32 s86, 2
    s_cselect_b32 s80, 20, s80
    s_cmp_eq_u32 s86, 0
    s_cselect_b32 s86, 0, s80
    v_mov_b32 v6, s86
    ds_write_b32 v2, v6 offset:148
    s_cmp_lt_u32 s72, s56
    s_cbranch_scc1 L_nad
    s_memtime s[64:65]
    s_memrealtime s[66:67]
    s_add_u32 s56, s56, 64
    s_waitcnt lgkmcnt(0)
    s_sub_u32 s68, s64, s48
    s_sub_u32 s69, s66, s50
    s_mov_b32 s48, s64
    s_mov_b32 s50, s66
    v_cvt_f32_u32 v25, s69
    v_cvt_f32_u32 v24, s68
    v_rcp_f32 v25, v25
    s_nop 1
    v_mul_f32 v24, v24, v25
    v_add_f32 v26, 0xc19cdfda, v24
    v_mul_f32 v26, 0x405c28f6, v26
    v_rndne_f32 v26, v26
    v_cvt_i32_f32 v26, v26
    v_med3_i32 v26, v26, 1, 17
    v_add_f32 v27, 0xc1b73333, v24
    v_mul_f32 v27, 0x41200000, v27
    v_rndne_f32 v27, v27
    v_cvt_i32_f32 v27, v27
    v_med3_i32 v27, v27, 1, 17
    v_add_f32 v25, 0xc1b5999a, v24
    v_readfirstlane_b32 s92, v27
    v_readfirstlane_b32 s68, v24
    v_mul_f32 v25, 0x40600000, v25
    v_rndne_f32 v25, v25
    v_cvt_i32_f32 v25, v25
    s_cmp_ge_u32 s68, 0x00000000
    s_mov_b32 s69, 0x41ac0000
    s_cselect_b32 s69, 0x41ba6666, s69
    v_readfirstlane_b32 s59, v26
    v_readfirstlane_b32 s57, v25
    v_subrev_f32 v24, s69, v24
    v_mul_f32 v24, 0x00000000, v24
    v_rndne_f32 v24, v24
    v_cvt_i32_f32 v24, v24
    s_max_i32 s57, s57, -10
    s_min_i32 s57, s57, 1
    v_readfirstlane_b32 s58, v24
    s_max_i32 s58, s58, 0
    s_min_i32 s58, s58, 0
L_nad:
    s_cmp_lt_i32 s72, s89
    s_cbranch_scc1 L_ntp
    v_readlane_b32 s87, v30, s88
    s_min_u32 s87, s87, 803733504
    s_cmp_ge_u32 s88, 64
    s_cbranch_scc1 L_tpv
    s_load_dword s90, s[6:7], s87
    s_add_u32 s87, s87, 1572800
    s_load_dword s91, s[6:7], s87
    s_branch L_tpd
L_tpv:
    s_load_dword s90, s[8:9], s87
    s_add_u32 s87, s87, 1572800
    s_load_dword s91, s[8:9], s87
L_tpd:
    s_add_u32 s88, s88, 32
    s_add_i32 s89, s89, 512
    s_cmp_ge_u32 s88, 128
    s_cselect_b32 s89, 0x7fffffff, s89
    s_mov_b64 exec, 0xffffffff
L_ntp:
    s_cmp_lt_u32 s72, s77
    s_cbranch_scc1 L_cn
    s_memrealtime s[84:85]
    s_lshl_b32 s86, s75, 11
    s_add_u32 s75, s75, 32
    s_mul_i32 s77, s75, 32
    s_mul_i32 s83, s75, 16
    s_add_u32 s83, s83, 768
    s_min_u32 s77, s77, s83
    s_cmp_lg_u32 s73, 32
    s_cbranch_scc1 L_cn
    v_add_u32_dpp v5, v5, v5 row_ror:8 row_mask:0xf bank_mask:0xf
    s_nop 1
    v_add_u32_dpp v5, v5, v5 row_ror:4 row_mask:0xf bank_mask:0xf
    s_nop 1
    v_add_u32_dpp v5, v5, v5 row_ror:2 row_mask:0xf bank_mask:0xf
    s_nop 1
    v_add_u32_dpp v5, v5, v5 row_ror:1 row_mask:0xf bank_mask:0xf
    s_nop 1
    v_readlane_b32 s74, v5, 0
    v_readlane_b32 s73, v5, 16
    s_add_u32 s86, s86, 3143680
    s_lshl_b32 s80, s76, 7
    s_add_u32 s80, s80, s86
    s_add_u32 s74, s74, s73
    s_lshl_b32 s74, s74, 2
    s_waitcnt lgkmcnt(0)
    s_mul_i32 s73, s84, 13
    s_sub_u32 s74, s74, s73
    v_mov_b32 v8, s74
    v_mov_b32 v9, s84
    s_mov_b64 exec, 1
    buffer_store_dwordx2 v[8:9], v2, s[52:55], s80 offen offset:2048 sc0 sc1
    s_load_dwordx2 s[32:33], s[22:23], s86 offset:0 glc
    s_load_dwordx2 s[34:35], s[22:23], s86 offset:128 glc
    s_load_dwordx2 s[36:37], s[22:23], s86 offset:256 glc
    s_load_dwordx2 s[38:39], s[22:23], s86 offset:384 glc
    s_load_dwordx2 s[40:41], s[22:23], s86 offset:512 glc
    s_load_dwordx2 s[42:43], s[22:23], s86 offset:640 glc
    s_load_dwordx2 s[44:45], s[22:23], s86 offset:768 glc
    s_load_dwordx2 s[46:47], s[22:23], s86 offset:896 glc
    s_mov_b64 exec, 0xffff
    v_mov_b32 v23, 0
    s_waitcnt lgkmcnt(0)
    v_writelane_b32 v22, s32, 0
    v_writelane_b32 v23, s33, 0
    v_writelane_b32 v22, s34, 1
    v_writelane_b32 v23, s35, 1
    v_writelane_b32 v22, s36, 2
    v_writelane_b32 v23, s37, 2
    v_writelane_b32 v22, s38, 3
    v_writelane_b32 v23, s39, 3
    v_writelane_b32 v22, s40, 4
    v_writelane_b32 v23, s41, 4
    v_writelane_b32 v22, s42, 5
    v_writelane_b32 v23, s43, 5
    v_writelane_b32 v22, s44, 6
    v_writelane_b32 v23, s45, 6
    v_writelane_b32 v22, s46, 7
    v_writelane_b32 v23, s47, 7
    v_sub_u32 v9, s84, v23
    v_cmp_gt_u32 vcc, 0x1000, v9
    v_sub_u32 v8, s74, v22
    s_and_b32 vcc_lo, vcc_lo, 255
    s_bitset0_b32 vcc_lo, s76
    v_cndmask_b32 v8, 0, v8, vcc
    s_nop 1
    v_add_u32_dpp v8, v8, v8 row_ror:8 row_mask:0xf bank_mask:0xf
    s_nop 1
    v_add_u32_dpp v8, v8, v8 row_ror:4 row_mask:0xf bank_mask:0xf
    s_nop 1
    v_add_u32_dpp v8, v8, v8 row_ror:2 row_mask:0xf bank_mask:0xf
    s_nop 1
    v_add_u32_dpp v8, v8, v8 row_ror:1 row_mask:0xf bank_mask:0xf
    s_nop 1
    v_ashrrev_i32 v8, 9, v8
    v_max_i32 v8, -5, v8
    v_min_i32 v8, 40, v8
    v_add_u32 v8, 0x400, v8
    s_mov_b64 exec, 1
    buffer_store_short v8, v2, s[60:63], 0 offen offset:192
L_cn:
    s_cmp_eq_u32 s81, 0
    s_cbranch_scc1 L_c
    s_endpgm
.section .rodata,"a"
.p2align 6
.amdhsa_kernel standalone__kv_cache_quant_int4_int2_kv_with_per_channel_or_per_token_scales__decode_kernel
  .amdhsa_next_free_vgpr 246
  .amdhsa_next_free_sgpr 102
  .amdhsa_accum_offset 248
  .amdhsa_float_denorm_mode_32 3
  .amdhsa_group_segment_fixed_size 0
  .amdhsa_kernarg_size 80
  .amdhsa_user_sgpr_count 2
  .amdhsa_user_sgpr_kernarg_segment_ptr 1
  .amdhsa_system_sgpr_workgroup_id_x 1
.end_amdhsa_kernel
```

```asm
; @launch grid=(256,1,1) block=(256,1,1) lds=98304
.amdgcn_target "amdgcn-amd-amdhsa--gfx950"
.text
.globl standalone__kv_cache_quant_int4_int2_kv_with_per_channel_or_per_token_scales__decode_kernel
.p2align 12
.type standalone__kv_cache_quant_int4_int2_kv_with_per_channel_or_per_token_scales__decode_kernel,@function
standalone__kv_cache_quant_int4_int2_kv_with_per_channel_or_per_token_scales__decode_kernel:
    s_cmp_ge_u32 s2, 256
    s_cbranch_scc1 L_end
    s_load_dwordx16 s[4:19], s[0:1], 0
    s_load_dwordx4 s[20:23], s[0:1], 64
    s_and_b32 s80, s2, 7
    s_lshr_b32 s2, s2, 3
    s_lshl_b32 s80, s80, 5
    s_or_b32 s2, s2, s80
    s_mov_b32 s3, s2
    v_lshrrev_b32 v229, 6, v0
    v_and_b32 v0, 63, v0
    v_readfirstlane_b32 s68, v229
    s_lshr_b32 s79, s2, 5
    s_and_b32 s92, s2, 31
    s_mov_b32 s66, 0xaaaaaaaa
    s_mov_b32 s67, 0xaaaaaaaa
    s_cmp_eq_u32 s68, 1
    s_cbranch_scc1 L_service
    s_cmp_eq_u32 s68, 2
    s_cbranch_scc1 L_ticket
    s_cmp_eq_u32 s68, 3
    s_cbranch_scc1 L_ctl
    s_mov_b64 vcc, 0
    s_setprio 1
    v_and_b32 v235, 15, v0
    v_lshrrev_b32 v234, 4, v0
    v_mul_u32_u24 v1, 768, v234
    v_lshl_add_u32 v1, v235, 4, v1
    v_lshlrev_b32 v2, 3, v235
    v_bfrev_b32 v231, v235
    v_lshrrev_b32 v231, 28, v231
    v_and_b32 v232, 3, v231
    v_lshl_add_u32 v3, v232, 2, v234
    v_lshlrev_b32 v3, 1, v3
    v_lshrrev_b32 v231, 2, v231
    v_lshl_add_u32 v3, v231, 10, v3
    v_lshlrev_b32 v239, 2, v0
    v_add_u32 v240, 3840, v239
    v_add_u32 v239, 3584, v239
    v_lshlrev_b32 v241, 4, v0
    v_mov_b32 v242, 0
    v_mov_b32 v243, 1
    v_lshlrev_b32 v224, 2, v0
    v_mov_b32 v225, 1
    v_mov_b32 v226, 260
    s_mul_i32 s58, s79, 0
    s_and_b32 s94, s92, 448
    s_add_u32 s94, s94, s58
    s_add_u32 s94, s94, 512
    s_add_u32 s58, s58, s92
    s_and_b32 s58, s58, 511
    s_lshr_b32 s59, s3, 5
    s_lshl_b32 s69, s79, 9
    s_add_u32 s59, s59, 24
    s_lshl_b32 s59, s59, 9
    s_mov_b32 s64, 0xcccccccc
    s_mov_b32 s65, 0xcccccccc
    s_mov_b32 s60, 0x6fd53b95
    s_mov_b32 s62, 0x80000001
    s_mov_b32 s61, 0x6fd53b95
    s_mov_b32 s63, 0x80000001
    s_and_b32 s80, s92, 3
    s_cmp_eq_u32 s80, 1
    s_mov_b32 s81, 0x11119143
    s_cselect_b32 s81, 0x11659143, s81
    s_cmp_eq_u32 s80, 0
    s_cselect_b32 s81, 0x80659143, s81
    s_andn2_b32 s82, s92, 3
    s_lshr_b32 s81, s81, s82
    s_and_b32 s81, s81, 15
    s_lshl_b32 m0, s81, 1
    s_lshl_b32 s80, s80, 21
    s_max_u32 s80, s80, 64
    s_sub_u32 s80, s80, 64
    s_mul_i32 s82, s79, 25165824
    s_cmp_eq_u32 s81, 1
    s_cselect_b32 s82, s82, 0
    s_add_u32 s80, s80, s82
    v_mov_b32 v236, s80
    s_waitcnt lgkmcnt(0)
    s_movrels_b64 s[84:85], s[4:5]
    global_load_dword v236, v236, s[84:85]
    s_mov_b32 s24, s6
    s_and_b32 s25, s7, 0xffff
    s_mov_b32 s26, 805306368
    s_mov_b32 s27, 0x00020000
    s_mov_b32 s48, s4
    s_and_b32 s49, s5, 0xffff
    s_mov_b32 s50, 12288
    s_mov_b32 s51, 0x00020000
    s_mov_b32 s32, s10
    s_and_b32 s33, s11, 0xffff
    s_mov_b32 s34, 6291456
    s_mov_b32 s35, 0x00020000
    s_mov_b32 s36, s12
    s_and_b32 s37, s13, 0xffff
    s_mov_b32 s38, 6291456
    s_mov_b32 s39, 0x00020000
    s_add_u32 s70, s69, s92
    s_mov_b32 s91, 1
    s_lshr_b32 s74, s70, 9
    s_mul_i32 s74, s74, 384
    buffer_load_dwordx2 v[192:193], v2, s[48:51], s74 offen offset:0
    buffer_load_dwordx2 v[194:195], v2, s[48:51], s74 offen offset:128
    buffer_load_dwordx2 v[196:197], v2, s[48:51], s74 offen offset:256
    s_and_b32 s80, s70, 31
    s_sub_u32 s72, s70, s80
    s_lshr_b32 s80, s80, 2
    s_add_u32 s72, s72, s80
    s_mul_i32 s72, s72, 384
    buffer_load_dwordx2 v[132:133], v2, s[32:35], s72 offen offset:0
    buffer_load_dwordx2 v[134:135], v2, s[32:35], s72 offen offset:128
    buffer_load_dwordx2 v[136:137], v2, s[32:35], s72 offen offset:256
    buffer_load_dwordx2 v[138:139], v2, s[36:39], s72 offen offset:0
    buffer_load_dwordx2 v[140:141], v2, s[36:39], s72 offen offset:128
    buffer_load_dwordx2 v[142:143], v2, s[36:39], s72 offen offset:256
    s_mul_i32 s71, s70, 49152
    s_and_b32 s80, s70, 31
    s_mul_i32 s80, s80, 36864
    s_sub_u32 s71, s71, s80
    buffer_load_dwordx4 v[4:7], v1, s[24:27], s71 offen offset:0 nt
    buffer_load_dwordx4 v[8:11], v1, s[24:27], s71 offen offset:256 nt
    buffer_load_dwordx4 v[12:15], v1, s[24:27], s71 offen offset:512 nt
    s_add_u32 s71, s71, 3072
    buffer_load_dwordx4 v[16:19], v1, s[24:27], s71 offen offset:0 nt
    s_add_u32 s72, s72, 3072
    buffer_load_dwordx2 v[156:157], v2, s[32:35], s72 offen offset:0
    buffer_load_dwordx2 v[158:159], v2, s[32:35], s72 offen offset:128
    buffer_load_dwordx2 v[160:161], v2, s[32:35], s72 offen offset:256
    buffer_load_dwordx2 v[162:163], v2, s[36:39], s72 offen offset:0
    buffer_load_dwordx2 v[164:165], v2, s[36:39], s72 offen offset:128
    buffer_load_dwordx2 v[166:167], v2, s[36:39], s72 offen offset:256
    buffer_load_dwordx4 v[20:23], v1, s[24:27], s71 offen offset:256 nt
    buffer_load_dwordx4 v[24:27], v1, s[24:27], s71 offen offset:512 nt
    s_add_u32 s71, s71, 3072
    buffer_load_dwordx4 v[28:31], v1, s[24:27], s71 offen offset:0 nt
    buffer_load_dwordx4 v[32:35], v1, s[24:27], s71 offen offset:256 nt
    buffer_load_dwordx4 v[36:39], v1, s[24:27], s71 offen offset:512 nt
    s_add_u32 s71, s71, 3072
    buffer_load_dwordx4 v[40:43], v1, s[24:27], s71 offen offset:0 nt
    buffer_load_dwordx4 v[44:47], v1, s[24:27], s71 offen offset:256 nt
    buffer_load_dwordx4 v[48:51], v1, s[24:27], s71 offen offset:512 nt
    s_add_u32 s71, s71, 384000
    buffer_load_dwordx4 v[52:55], v1, s[24:27], s71 offen offset:0 nt
    buffer_load_dwordx4 v[56:59], v1, s[24:27], s71 offen offset:256 nt
    buffer_load_dwordx4 v[60:63], v1, s[24:27], s71 offen offset:512 nt
    s_add_u32 s71, s71, 3072
    buffer_load_dwordx4 v[64:67], v1, s[24:27], s71 offen offset:0 nt
    s_add_u32 s72, s72, 3072
    buffer_load_dwordx2 v[168:169], v2, s[32:35], s72 offen offset:0
    buffer_load_dwordx2 v[170:171], v2, s[32:35], s72 offen offset:128
    buffer_load_dwordx2 v[172:173], v2, s[32:35], s72 offen offset:256
    buffer_load_dwordx2 v[174:175], v2, s[36:39], s72 offen offset:0
    buffer_load_dwordx2 v[176:177], v2, s[36:39], s72 offen offset:128
    buffer_load_dwordx2 v[178:179], v2, s[36:39], s72 offen offset:256
    buffer_load_dwordx4 v[68:71], v1, s[24:27], s71 offen offset:256 nt
    buffer_load_dwordx4 v[72:75], v1, s[24:27], s71 offen offset:512 nt
    s_add_u32 s71, s71, 3072
    buffer_load_dwordx4 v[76:79], v1, s[24:27], s71 offen offset:0 nt
    buffer_load_dwordx4 v[80:83], v1, s[24:27], s71 offen offset:256 nt
    buffer_load_dwordx4 v[84:87], v1, s[24:27], s71 offen offset:512 nt
    s_add_u32 s71, s71, 3072
    buffer_load_dwordx4 v[88:91], v1, s[24:27], s71 offen offset:0 nt
    buffer_load_dwordx4 v[92:95], v1, s[24:27], s71 offen offset:256 nt
    buffer_load_dwordx4 v[96:99], v1, s[24:27], s71 offen offset:512 nt
    s_mov_b32 s28, s8
    s_and_b32 s29, s9, 0xffff
    s_mov_b32 s30, 805306368
    s_mov_b32 s31, 0x00020000
    s_mov_b32 s40, s14
    s_and_b32 s41, s15, 0xffff
    s_mov_b32 s42, 2097152
    s_mov_b32 s43, 0x00020000
    s_mov_b32 s44, s16
    s_and_b32 s45, s17, 0xffff
    s_mov_b32 s46, 2097152
    s_mov_b32 s47, 0x00020000
    s_mov_b32 s52, s22
    s_and_b32 s53, s23, 0xffff
    s_mov_b32 s54, 25165824
    s_mov_b32 s55, 0x00020000
    v_mov_b32 v229, s2
    v_and_b32 v231, 15, v0
    v_lshrrev_b32 v230, 5, v229
    v_lshl_add_u32 v231, v230, 4, v231
    v_lshrrev_b32 v232, 4, v0
    v_lshl_add_u32 v231, v232, 7, v231
    s_lshl_b32 s82, s79, 3
    s_mov_b32 s80, 0xeff4fa00
    s_mov_b32 s81, 0xdbe0e5ea
    s_lshr_b64 s[80:81], s[80:81], s82
    s_sext_i32_i8 s80, s80
    s_mov_b32 exec_lo, 0x0
    s_mov_b32 exec_hi, 0x3ff
    v_add_u32 v231, s80, v231
    s_mov_b32 s80, 0xeff43d4c
    s_mov_b32 s81, 0xdbe0e5ea
    s_lshr_b64 s[80:81], s[80:81], s82
    s_sext_i32_i8 s80, s80
    s_mov_b32 exec_lo, 0x0
    s_mov_b32 exec_hi, 0x400
    v_add_u32 v231, s80, v231
    s_mov_b32 s80, 0x2c37424d
    s_mov_b32 s81, 0xb1621
    s_lshr_b64 s[80:81], s[80:81], s82
    s_sext_i32_i8 s80, s80
    s_mov_b32 exec_lo, 0x0
    s_mov_b32 exec_hi, 0xf800
    v_add_u32 v231, s80, v231
    s_mov_b64 exec, -1
    v_and_b32 v229, 31, v229
    v_lshl_add_u32 v245, v231, 5, v229
    s_mov_b32 s4, 0x10000
    s_mov_b32 s5, 0x10401
    s_cmp_eq_u32 s79, 1
    s_cselect_b32 s4, 0x10000, s4
    s_cselect_b32 s5, 0x14441, s5
    s_cmp_eq_u32 s79, 2
    s_cselect_b32 s4, 0x10000, s4
    s_cselect_b32 s5, 0x10801, s5
    s_cmp_eq_u32 s79, 3
    s_cselect_b32 s4, 0x10000, s4
    s_cselect_b32 s5, 0x10803, s5
    s_cmp_eq_u32 s79, 4
    s_cselect_b32 s4, 0x10000, s4
    s_cselect_b32 s5, 0x18841, s5
    s_cmp_eq_u32 s79, 5
    s_cselect_b32 s4, 0x10000, s4
    s_cselect_b32 s5, 0x10801, s5
    s_cmp_eq_u32 s79, 6
    s_cselect_b32 s4, 0x10000, s4
    s_cselect_b32 s5, 0x10801, s5
    s_cmp_eq_u32 s79, 7
    s_cselect_b32 s4, 0x10000, s4
    s_cselect_b32 s5, 0x10821, s5
    s_mov_b32 s7, 0xf149f2ca
    s_mov_b32 s77, 0xf149f2ca
    v_lshlrev_b32 v225, 4, v0
    v_mov_b32 v100, 0
    v_mov_b32 v101, 0
    v_mov_b32 v102, 0
    v_mov_b32 v103, 0
    s_lshl_b32 s78, s3, 11
    s_mov_b64 s[88:89], 0
    v_mov_b32 v216, 0xf149f2ca
    v_mov_b32 v217, 0
    v_mov_b32 v218, 0
    v_mov_b32 v204, 0
    v_mov_b32 v205, 0
    v_mov_b32 v206, 0
    v_mov_b32 v207, 0
    v_mov_b32 v208, 0
    v_mov_b32 v209, 0
    v_mov_b32 v210, 0
    v_mov_b32 v211, 0
    v_mov_b32 v212, 0
    v_mov_b32 v213, 0
    v_mov_b32 v214, 0
    v_mov_b32 v215, 0
    s_barrier
    s_waitcnt vmcnt(36)
    v_lshlrev_b32 v108, 16, v192
    v_and_b32 v109, 0xffff0000, v192
    v_pk_mul_f32 v[108:109], v[108:109], s[60:61]
    v_lshlrev_b32 v110, 16, v193
    v_and_b32 v111, 0xffff0000, v193
    v_pk_mul_f32 v[110:111], v[110:111], s[60:61]
    v_lshlrev_b32 v112, 16, v194
    v_and_b32 v113, 0xffff0000, v194
    v_pk_mul_f32 v[112:113], v[112:113], s[60:61]
    v_lshlrev_b32 v114, 16, v195
    v_and_b32 v115, 0xffff0000, v195
    v_pk_mul_f32 v[114:115], v[114:115], s[60:61]
    v_lshlrev_b32 v116, 16, v196
    v_and_b32 v117, 0xffff0000, v196
    v_pk_mul_f32 v[116:117], v[116:117], s[60:61]
    v_lshlrev_b32 v118, 16, v197
    v_and_b32 v119, 0xffff0000, v197
    v_pk_mul_f32 v[118:119], v[118:119], s[60:61]
    v_lshlrev_b32 v234, 16, v132
    v_and_b32 v235, 0xffff0000, v132
    v_pk_mul_f32 v[120:121], v[234:235], v[108:109]
    v_lshlrev_b32 v234, 16, v138
    v_and_b32 v235, 0xffff0000, v138
    v_pk_mul_f32 v[200:201], v[120:121], v[234:235]
    v_lshlrev_b32 v234, 16, v133
    v_and_b32 v235, 0xffff0000, v133
    v_pk_mul_f32 v[122:123], v[234:235], v[110:111]
    v_lshlrev_b32 v234, 16, v139
    v_and_b32 v235, 0xffff0000, v139
    v_pk_fma_f32 v[200:201], v[122:123], v[234:235], v[200:201]
    v_lshlrev_b32 v234, 16, v134
    v_and_b32 v235, 0xffff0000, v134
    v_pk_mul_f32 v[124:125], v[234:235], v[112:113]
    v_lshlrev_b32 v234, 16, v140
    v_and_b32 v235, 0xffff0000, v140
    v_pk_fma_f32 v[200:201], v[124:125], v[234:235], v[200:201]
    v_lshlrev_b32 v234, 16, v135
    v_and_b32 v235, 0xffff0000, v135
    v_pk_mul_f32 v[126:127], v[234:235], v[114:115]
    v_lshlrev_b32 v234, 16, v141
    v_and_b32 v235, 0xffff0000, v141
    v_pk_fma_f32 v[200:201], v[126:127], v[234:235], v[200:201]
    v_lshlrev_b32 v234, 16, v136
    v_and_b32 v235, 0xffff0000, v136
    v_pk_mul_f32 v[128:129], v[234:235], v[116:117]
    v_lshlrev_b32 v234, 16, v142
    v_and_b32 v235, 0xffff0000, v142
    v_pk_fma_f32 v[200:201], v[128:129], v[234:235], v[200:201]
    v_lshlrev_b32 v234, 16, v137
    v_and_b32 v235, 0xffff0000, v137
    v_pk_mul_f32 v[130:131], v[234:235], v[118:119]
    v_lshlrev_b32 v234, 16, v143
    v_and_b32 v235, 0xffff0000, v143
    v_pk_fma_f32 v[200:201], v[130:131], v[234:235], v[200:201]
    v_pk_mul_f32 v[200:201], v[200:201], s[62:63]
    s_mov_b32 s76, 63
L_loop0:
    s_waitcnt vmcnt(35)
    v_pk_fma_f32 v[198:199], v[120:121], v[4:5], v[200:201]
    v_pk_fma_f32 v[198:199], v[122:123], v[6:7], v[198:199]
    ds_read_b32 v244, v243 offset:147
    s_add_u32 s71, s71, 384000
    s_cbranch_vccnz L_th24_0
L_tb24_0:
    buffer_load_dwordx4 v[4:7], v1, s[24:27], s71 offen offset:0 nt
    v_add_f32_dpp v229, v228, v228 row_ror:8 row_mask:0xf bank_mask:0xc
    s_waitcnt vmcnt(35)
    v_pk_fma_f32 v[198:199], v[124:125], v[8:9], v[198:199]
    v_pk_fma_f32 v[198:199], v[126:127], v[10:11], v[198:199]
    buffer_load_dwordx4 v[8:11], v1, s[24:27], s71 offen offset:256 nt
    v_add_f32_dpp v230, v229, v229 row_shr:4 row_mask:0xf bank_mask:0xa
    s_waitcnt vmcnt(35)
    v_pk_fma_f32 v[198:199], v[128:129], v[12:13], v[198:199]
    v_pk_fma_f32 v[198:199], v[130:131], v[14:15], v[198:199]
    s_waitcnt lgkmcnt(0)
    v_cmp_lt_u32 vcc, v0, v244
    ds_add_u32 v224, v243 offset:3328
    buffer_load_dwordx4 v[12:15], v1, s[24:27], s71 offen offset:512 nt
    v_add_f32_dpp v232, v230, v230 quad_perm:[2,3,0,1] row_mask:0xf bank_mask:0xf
    v_add_f32 v228, v198, v199
    s_waitcnt vmcnt(35)
    v_pk_fma_f32 v[198:199], v[120:121], v[16:17], v[200:201]
    v_pk_fma_f32 v[198:199], v[122:123], v[18:19], v[198:199]
    s_add_u32 s71, s71, 3072
    s_cbranch_vccnz L_th27_0
L_tb27_0:
    buffer_load_dwordx4 v[16:19], v1, s[24:27], s71 offen offset:0 nt
    v_cndmask_b32 v232, v231, v232, s[64:65]
    v_add_f32_dpp v229, v228, v228 row_ror:8 row_mask:0xf bank_mask:0x3
    s_waitcnt vmcnt(29)
    v_pk_fma_f32 v[198:199], v[124:125], v[20:21], v[198:199]
    v_pk_fma_f32 v[198:199], v[126:127], v[22:23], v[198:199]
    s_add_u32 s72, s72, 3072
    buffer_load_dwordx2 v[180:181], v2, s[32:35], s72 offen offset:0
    buffer_load_dwordx2 v[182:183], v2, s[32:35], s72 offen offset:128
    buffer_load_dwordx2 v[184:185], v2, s[32:35], s72 offen offset:256
    buffer_load_dwordx2 v[186:187], v2, s[36:39], s72 offen offset:0
    buffer_load_dwordx2 v[188:189], v2, s[36:39], s72 offen offset:128
    buffer_load_dwordx2 v[190:191], v2, s[36:39], s72 offen offset:256
    buffer_load_dwordx4 v[20:23], v1, s[24:27], s71 offen offset:256 nt
    v_add_f32_dpp v231, v232, v232 quad_perm:[1,0,3,2] row_mask:0xf bank_mask:0xf
    v_lshlrev_b32 v234, 16, v156
    v_and_b32 v235, 0xffff0000, v156
    v_pk_mul_f32 v[144:145], v[234:235], v[108:109]
    v_lshlrev_b32 v234, 16, v162
    v_and_b32 v235, 0xffff0000, v162
    s_waitcnt vmcnt(35)
    v_pk_fma_f32 v[198:199], v[128:129], v[24:25], v[198:199]
    v_pk_fma_f32 v[198:199], v[130:131], v[26:27], v[198:199]
    ds_add_u32 v224, v243 offset:3328
    buffer_load_dwordx4 v[24:27], v1, s[24:27], s71 offen offset:512 nt
    v_cndmask_b32 v233, v233, v231, s[66:67]
    v_mul_f32 v233, 0x58000000, v233
    ds_write_b32 v239, v233
    v_add_u32 v239, 256, v239
    v_add_f32 v228, v198, v199
    v_pk_mul_f32 v[202:203], v[144:145], v[234:235]
    v_lshlrev_b32 v234, 16, v157
    v_and_b32 v235, 0xffff0000, v157
    v_pk_mul_f32 v[146:147], v[234:235], v[110:111]
    v_lshlrev_b32 v234, 16, v163
    s_waitcnt vmcnt(35)
    v_pk_fma_f32 v[198:199], v[120:121], v[28:29], v[200:201]
    v_pk_fma_f32 v[198:199], v[122:123], v[30:31], v[198:199]
    s_add_u32 s71, s71, 3072
    s_cbranch_vccnz L_th30_0
L_tb30_0:
    buffer_load_dwordx4 v[28:31], v1, s[24:27], s71 offen offset:0 nt
    v_add_f32_dpp v229, v228, v228 row_ror:8 row_mask:0xf bank_mask:0xc
    v_and_b32 v235, 0xffff0000, v163
    v_pk_fma_f32 v[202:203], v[146:147], v[234:235], v[202:203]
    v_lshlrev_b32 v234, 16, v158
    v_and_b32 v235, 0xffff0000, v158
    v_pk_mul_f32 v[148:149], v[234:235], v[112:113]
    s_waitcnt vmcnt(35)
    v_pk_fma_f32 v[198:199], v[124:125], v[32:33], v[198:199]
    v_pk_fma_f32 v[198:199], v[126:127], v[34:35], v[198:199]
    buffer_load_dwordx4 v[32:35], v1, s[24:27], s71 offen offset:256 nt
    v_add_f32_dpp v230, v229, v229 row_shl:4 row_mask:0xf bank_mask:0x5
    v_lshlrev_b32 v234, 16, v164
    v_and_b32 v235, 0xffff0000, v164
    v_pk_fma_f32 v[202:203], v[148:149], v[234:235], v[202:203]
    v_lshlrev_b32 v234, 16, v159
    v_and_b32 v235, 0xffff0000, v159
    s_waitcnt vmcnt(35)
    v_pk_fma_f32 v[198:199], v[128:129], v[36:37], v[198:199]
    v_pk_fma_f32 v[198:199], v[130:131], v[38:39], v[198:199]
    ds_add_u32 v224, v243 offset:3328
    buffer_load_dwordx4 v[36:39], v1, s[24:27], s71 offen offset:512 nt
    v_add_f32 v228, v198, v199
    v_pk_mul_f32 v[150:151], v[234:235], v[114:115]
    v_lshlrev_b32 v234, 16, v165
    v_and_b32 v235, 0xffff0000, v165
    v_pk_fma_f32 v[202:203], v[150:151], v[234:235], v[202:203]
    v_lshlrev_b32 v234, 16, v160
    s_waitcnt vmcnt(35)
    v_pk_fma_f32 v[198:199], v[120:121], v[40:41], v[200:201]
    v_pk_fma_f32 v[198:199], v[122:123], v[42:43], v[198:199]
    s_add_u32 s71, s71, 3072
    s_cbranch_vccnz L_th33_0
L_tb33_0:
    buffer_load_dwordx4 v[40:43], v1, s[24:27], s71 offen offset:0 nt
    v_add_f32_dpp v229, v228, v228 row_ror:8 row_mask:0xf bank_mask:0x3
    v_and_b32 v235, 0xffff0000, v160
    v_pk_mul_f32 v[152:153], v[234:235], v[116:117]
    v_lshlrev_b32 v234, 16, v166
    v_and_b32 v235, 0xffff0000, v166
    v_pk_fma_f32 v[202:203], v[152:153], v[234:235], v[202:203]
    s_waitcnt vmcnt(35)
    v_pk_fma_f32 v[198:199], v[124:125], v[44:45], v[198:199]
    v_pk_fma_f32 v[198:199], v[126:127], v[46:47], v[198:199]
    buffer_load_dwordx4 v[44:47], v1, s[24:27], s71 offen offset:256 nt
    v_lshlrev_b32 v234, 16, v161
    v_and_b32 v235, 0xffff0000, v161
    v_pk_mul_f32 v[154:155], v[234:235], v[118:119]
    v_lshlrev_b32 v234, 16, v167
    v_and_b32 v235, 0xffff0000, v167
    s_waitcnt vmcnt(35)
    v_pk_fma_f32 v[198:199], v[128:129], v[48:49], v[198:199]
    v_pk_fma_f32 v[198:199], v[130:131], v[50:51], v[198:199]
    ds_add_u32 v224, v243 offset:3328
    buffer_load_dwordx4 v[48:51], v1, s[24:27], s71 offen offset:512 nt
    v_add_f32 v228, v198, v199
    v_pk_fma_f32 v[202:203], v[154:155], v[234:235], v[202:203]
    v_pk_mul_f32 v[202:203], v[202:203], s[62:63]
    s_waitcnt vmcnt(35)
    v_pk_fma_f32 v[198:199], v[144:145], v[52:53], v[202:203]
    v_pk_fma_f32 v[198:199], v[146:147], v[54:55], v[198:199]
    ds_read_b32 v244, v243 offset:147
    v_readlane_b32 s70, v245, s91
    s_add_u32 s91, s91, 1
    s_lshr_b32 s74, s70, 9
    s_mul_i32 s74, s74, 384
    buffer_load_dwordx2 v[192:193], v2, s[48:51], s74 offen offset:0
    buffer_load_dwordx2 v[194:195], v2, s[48:51], s74 offen offset:128
    buffer_load_dwordx2 v[196:197], v2, s[48:51], s74 offen offset:256
    s_add_u32 s71, s71, 384000
    s_cbranch_vccnz L_th36_0
L_tb36_0:
    buffer_load_dwordx4 v[52:55], v1, s[24:27], s71 offen offset:0 nt
    v_add_f32_dpp v229, v228, v228 row_ror:8 row_mask:0xf bank_mask:0xc
    s_waitcnt vmcnt(38)
    v_pk_fma_f32 v[198:199], v[148:149], v[56:57], v[198:199]
    v_pk_fma_f32 v[198:199], v[150:151], v[58:59], v[198:199]
    buffer_load_dwordx4 v[56:59], v1, s[24:27], s71 offen offset:256 nt
    v_add_f32_dpp v230, v229, v229 row_shr:4 row_mask:0xf bank_mask:0xa
    s_waitcnt vmcnt(38)
    v_pk_fma_f32 v[198:199], v[152:153], v[60:61], v[198:199]
    v_pk_fma_f32 v[198:199], v[154:155], v[62:63], v[198:199]
    s_waitcnt lgkmcnt(0)
    v_cmp_lt_u32 vcc, v0, v244
    ds_add_u32 v224, v243 offset:3328
    buffer_load_dwordx4 v[60:63], v1, s[24:27], s71 offen offset:512 nt
    v_add_f32_dpp v231, v230, v230 quad_perm:[2,3,0,1] row_mask:0xf bank_mask:0xf
    v_add_f32 v228, v198, v199
    s_waitcnt vmcnt(38)
    v_pk_fma_f32 v[198:199], v[144:145], v[64:65], v[202:203]
    v_pk_fma_f32 v[198:199], v[146:147], v[66:67], v[198:199]
    s_add_u32 s71, s71, 3072
    s_cbranch_vccnz L_th39_0
L_tb39_0:
    buffer_load_dwordx4 v[64:67], v1, s[24:27], s71 offen offset:0 nt
    v_add_f32_dpp v229, v228, v228 row_ror:8 row_mask:0xf bank_mask:0x3
    s_waitcnt vmcnt(32)
    v_pk_fma_f32 v[198:199], v[148:149], v[68:69], v[198:199]
    v_pk_fma_f32 v[198:199], v[150:151], v[70:71], v[198:199]
    s_and_b32 s80, s70, 31
    s_sub_u32 s72, s70, s80
    s_lshr_b32 s80, s80, 2
    s_add_u32 s72, s72, s80
    s_mul_i32 s72, s72, 384
    buffer_load_dwordx2 v[132:133], v2, s[32:35], s72 offen offset:0
    buffer_load_dwordx2 v[134:135], v2, s[32:35], s72 offen offset:128
    buffer_load_dwordx2 v[136:137], v2, s[32:35], s72 offen offset:256
    buffer_load_dwordx2 v[138:139], v2, s[36:39], s72 offen offset:0
    buffer_load_dwordx2 v[140:141], v2, s[36:39], s72 offen offset:128
    buffer_load_dwordx2 v[142:143], v2, s[36:39], s72 offen offset:256
    buffer_load_dwordx4 v[68:71], v1, s[24:27], s71 offen offset:256 nt
    v_lshlrev_b32 v234, 16, v168
    v_and_b32 v235, 0xffff0000, v168
    v_pk_mul_f32 v[120:121], v[234:235], v[108:109]
    v_lshlrev_b32 v234, 16, v174
    v_and_b32 v235, 0xffff0000, v174
    s_waitcnt vmcnt(38)
    v_pk_fma_f32 v[198:199], v[152:153], v[72:73], v[198:199]
    v_pk_fma_f32 v[198:199], v[154:155], v[74:75], v[198:199]
    ds_add_u32 v224, v243 offset:3328
    buffer_load_dwordx4 v[72:75], v1, s[24:27], s71 offen offset:512 nt
    v_add_f32 v228, v198, v199
    v_pk_mul_f32 v[200:201], v[120:121], v[234:235]
    v_lshlrev_b32 v234, 16, v169
    v_and_b32 v235, 0xffff0000, v169
    v_pk_mul_f32 v[122:123], v[234:235], v[110:111]
    v_lshlrev_b32 v234, 16, v175
    s_waitcnt vmcnt(38)
    v_pk_fma_f32 v[198:199], v[144:145], v[76:77], v[202:203]
    v_pk_fma_f32 v[198:199], v[146:147], v[78:79], v[198:199]
    s_add_u32 s71, s71, 3072
    s_cbranch_vccnz L_th42_0
L_tb42_0:
    buffer_load_dwordx4 v[76:79], v1, s[24:27], s71 offen offset:0 nt
    v_add_f32_dpp v229, v228, v228 row_ror:8 row_mask:0xf bank_mask:0xc
    v_and_b32 v235, 0xffff0000, v175
    v_pk_fma_f32 v[200:201], v[122:123], v[234:235], v[200:201]
    v_lshlrev_b32 v234, 16, v170
    v_and_b32 v235, 0xffff0000, v170
    v_pk_mul_f32 v[124:125], v[234:235], v[112:113]
    s_waitcnt vmcnt(38)
    v_pk_fma_f32 v[198:199], v[148:149], v[80:81], v[198:199]
    v_pk_fma_f32 v[198:199], v[150:151], v[82:83], v[198:199]
    buffer_load_dwordx4 v[80:83], v1, s[24:27], s71 offen offset:256 nt
    v_add_f32_dpp v230, v229, v229 row_shl:4 row_mask:0xf bank_mask:0x5
    v_lshlrev_b32 v234, 16, v176
    v_and_b32 v235, 0xffff0000, v176
    v_pk_fma_f32 v[200:201], v[124:125], v[234:235], v[200:201]
    v_lshlrev_b32 v234, 16, v171
    v_and_b32 v235, 0xffff0000, v171
    s_waitcnt vmcnt(38)
    v_pk_fma_f32 v[198:199], v[152:153], v[84:85], v[198:199]
    v_pk_fma_f32 v[198:199], v[154:155], v[86:87], v[198:199]
    ds_add_u32 v224, v243 offset:3328
    buffer_load_dwordx4 v[84:87], v1, s[24:27], s71 offen offset:512 nt
    v_add_f32 v228, v198, v199
    v_pk_mul_f32 v[126:127], v[234:235], v[114:115]
    v_lshlrev_b32 v234, 16, v177
    v_and_b32 v235, 0xffff0000, v177
    v_pk_fma_f32 v[200:201], v[126:127], v[234:235], v[200:201]
    v_lshlrev_b32 v234, 16, v172
    s_waitcnt vmcnt(38)
    v_pk_fma_f32 v[198:199], v[144:145], v[88:89], v[202:203]
    v_pk_fma_f32 v[198:199], v[146:147], v[90:91], v[198:199]
    s_add_u32 s71, s71, 3072
    s_cbranch_vccnz L_th45_0
L_tb45_0:
    buffer_load_dwordx4 v[88:91], v1, s[24:27], s71 offen offset:0 nt
    v_add_f32_dpp v229, v228, v228 row_ror:8 row_mask:0xf bank_mask:0x3
    v_and_b32 v235, 0xffff0000, v172
    v_pk_mul_f32 v[128:129], v[234:235], v[116:117]
    v_lshlrev_b32 v234, 16, v178
    v_and_b32 v235, 0xffff0000, v178
    v_pk_fma_f32 v[200:201], v[128:129], v[234:235], v[200:201]
    s_waitcnt vmcnt(38)
    v_pk_fma_f32 v[198:199], v[148:149], v[92:93], v[198:199]
    v_pk_fma_f32 v[198:199], v[150:151], v[94:95], v[198:199]
    buffer_load_dwordx4 v[92:95], v1, s[24:27], s71 offen offset:256 nt
    v_lshlrev_b32 v234, 16, v173
    v_and_b32 v235, 0xffff0000, v173
    v_pk_mul_f32 v[130:131], v[234:235], v[118:119]
    v_lshlrev_b32 v234, 16, v179
    v_and_b32 v235, 0xffff0000, v179
    s_waitcnt vmcnt(38)
    v_pk_fma_f32 v[198:199], v[152:153], v[96:97], v[198:199]
    v_pk_fma_f32 v[198:199], v[154:155], v[98:99], v[198:199]
    ds_add_u32 v224, v243 offset:3328
    buffer_load_dwordx4 v[96:99], v1, s[24:27], s71 offen offset:512 nt
    v_add_f32 v228, v198, v199
    v_pk_fma_f32 v[200:201], v[130:131], v[234:235], v[200:201]
    v_pk_mul_f32 v[200:201], v[200:201], s[62:63]
    s_waitcnt vmcnt(38)
    v_pk_fma_f32 v[198:199], v[120:121], v[4:5], v[200:201]
    v_pk_fma_f32 v[198:199], v[122:123], v[6:7], v[198:199]
    ds_read_b32 v244, v243 offset:147
    s_mul_i32 s71, s70, 49152
    s_and_b32 s80, s70, 31
    s_mul_i32 s80, s80, 36864
    s_sub_u32 s71, s71, s80
    s_cbranch_vccnz L_th0_0
L_tb0_0:
    buffer_load_dwordx4 v[4:7], v1, s[24:27], s71 offen offset:0 nt
    v_add_f32_dpp v229, v228, v228 row_ror:8 row_mask:0xf bank_mask:0xc
    s_waitcnt vmcnt(38)
    v_pk_fma_f32 v[198:199], v[124:125], v[8:9], v[198:199]
    v_pk_fma_f32 v[198:199], v[126:127], v[10:11], v[198:199]
    buffer_load_dwordx4 v[8:11], v1, s[24:27], s71 offen offset:256 nt
    v_add_f32_dpp v230, v229, v229 row_shr:4 row_mask:0xf bank_mask:0xa
    s_waitcnt vmcnt(38)
    v_pk_fma_f32 v[198:199], v[128:129], v[12:13], v[198:199]
    v_pk_fma_f32 v[198:199], v[130:131], v[14:15], v[198:199]
    s_waitcnt lgkmcnt(0)
    v_cmp_lt_u32 vcc, v0, v244
    ds_add_u32 v224, v243 offset:3328
    buffer_load_dwordx4 v[12:15], v1, s[24:27], s71 offen offset:512 nt
    v_add_f32_dpp v232, v230, v230 quad_perm:[2,3,0,1] row_mask:0xf bank_mask:0xf
    v_add_f32 v228, v198, v199
    s_waitcnt vmcnt(38)
    v_pk_fma_f32 v[198:199], v[120:121], v[16:17], v[200:201]
    v_pk_fma_f32 v[198:199], v[122:123], v[18:19], v[198:199]
    s_add_u32 s71, s71, 3072
    s_cbranch_vccnz L_th3_0
L_tb3_0:
    buffer_load_dwordx4 v[16:19], v1, s[24:27], s71 offen offset:0 nt
    v_cndmask_b32 v232, v231, v232, s[64:65]
    v_add_f32_dpp v229, v228, v228 row_ror:8 row_mask:0xf bank_mask:0x3
    s_waitcnt vmcnt(32)
    v_pk_fma_f32 v[198:199], v[124:125], v[20:21], v[198:199]
    v_pk_fma_f32 v[198:199], v[126:127], v[22:23], v[198:199]
    s_add_u32 s72, s72, 3072
    buffer_load_dwordx2 v[156:157], v2, s[32:35], s72 offen offset:0
    buffer_load_dwordx2 v[158:159], v2, s[32:35], s72 offen offset:128
    buffer_load_dwordx2 v[160:161], v2, s[32:35], s72 offen offset:256
    buffer_load_dwordx2 v[162:163], v2, s[36:39], s72 offen offset:0
    buffer_load_dwordx2 v[164:165], v2, s[36:39], s72 offen offset:128
    buffer_load_dwordx2 v[166:167], v2, s[36:39], s72 offen offset:256
    buffer_load_dwordx4 v[20:23], v1, s[24:27], s71 offen offset:256 nt
    v_add_f32_dpp v233, v232, v232 quad_perm:[1,0,3,2] row_mask:0xf bank_mask:0xf
    v_lshlrev_b32 v234, 16, v180
    v_and_b32 v235, 0xffff0000, v180
    v_pk_mul_f32 v[144:145], v[234:235], v[108:109]
    v_lshlrev_b32 v234, 16, v186
    v_and_b32 v235, 0xffff0000, v186
    s_waitcnt vmcnt(38)
    v_pk_fma_f32 v[198:199], v[128:129], v[24:25], v[198:199]
    v_pk_fma_f32 v[198:199], v[130:131], v[26:27], v[198:199]
    ds_add_u32 v224, v243 offset:3328
    buffer_load_dwordx4 v[24:27], v1, s[24:27], s71 offen offset:512 nt
    v_add_f32 v228, v198, v199
    v_pk_mul_f32 v[202:203], v[144:145], v[234:235]
    s_branch L_x0
L_w0:
    s_branch L_w1
L_x0:
    v_lshlrev_b32 v234, 16, v181
    v_and_b32 v235, 0xffff0000, v181
    v_pk_mul_f32 v[146:147], v[234:235], v[110:111]
    v_lshlrev_b32 v234, 16, v187
    s_waitcnt vmcnt(38)
    v_pk_fma_f32 v[198:199], v[120:121], v[28:29], v[200:201]
    v_pk_fma_f32 v[198:199], v[122:123], v[30:31], v[198:199]
    s_add_u32 s71, s71, 3072
    s_cbranch_vccnz L_th6_0
L_tb6_0:
    buffer_load_dwordx4 v[28:31], v1, s[24:27], s71 offen offset:0 nt
    v_add_f32_dpp v229, v228, v228 row_ror:8 row_mask:0xf bank_mask:0xc
    v_and_b32 v235, 0xffff0000, v187
    v_pk_fma_f32 v[202:203], v[146:147], v[234:235], v[202:203]
    v_lshlrev_b32 v234, 16, v182
    v_and_b32 v235, 0xffff0000, v182
    v_pk_mul_f32 v[148:149], v[234:235], v[112:113]
    s_waitcnt vmcnt(38)
    v_pk_fma_f32 v[198:199], v[124:125], v[32:33], v[198:199]
    v_pk_fma_f32 v[198:199], v[126:127], v[34:35], v[198:199]
    buffer_load_dwordx4 v[32:35], v1, s[24:27], s71 offen offset:256 nt
    v_add_f32_dpp v230, v229, v229 row_shl:4 row_mask:0xf bank_mask:0x5
    v_lshlrev_b32 v234, 16, v188
    v_and_b32 v235, 0xffff0000, v188
    v_pk_fma_f32 v[202:203], v[148:149], v[234:235], v[202:203]
    v_lshlrev_b32 v234, 16, v183
    v_and_b32 v235, 0xffff0000, v183
    s_waitcnt vmcnt(38)
    v_pk_fma_f32 v[198:199], v[128:129], v[36:37], v[198:199]
    v_pk_fma_f32 v[198:199], v[130:131], v[38:39], v[198:199]
    ds_add_u32 v224, v243 offset:3328
    buffer_load_dwordx4 v[36:39], v1, s[24:27], s71 offen offset:512 nt
    v_add_f32 v228, v198, v199
    v_pk_mul_f32 v[150:151], v[234:235], v[114:115]
    v_lshlrev_b32 v234, 16, v189
    v_and_b32 v235, 0xffff0000, v189
    v_pk_fma_f32 v[202:203], v[150:151], v[234:235], v[202:203]
    v_lshlrev_b32 v234, 16, v184
    s_waitcnt vmcnt(38)
    v_pk_fma_f32 v[198:199], v[120:121], v[40:41], v[200:201]
    v_pk_fma_f32 v[198:199], v[122:123], v[42:43], v[198:199]
    s_add_u32 s71, s71, 3072
    s_cbranch_vccnz L_th9_0
L_tb9_0:
    buffer_load_dwordx4 v[40:43], v1, s[24:27], s71 offen offset:0 nt
    v_add_f32_dpp v229, v228, v228 row_ror:8 row_mask:0xf bank_mask:0x3
    v_and_b32 v235, 0xffff0000, v184
    v_pk_mul_f32 v[152:153], v[234:235], v[116:117]
    v_lshlrev_b32 v234, 16, v190
    v_and_b32 v235, 0xffff0000, v190
    v_pk_fma_f32 v[202:203], v[152:153], v[234:235], v[202:203]
    s_waitcnt vmcnt(38)
    v_pk_fma_f32 v[198:199], v[124:125], v[44:45], v[198:199]
    v_pk_fma_f32 v[198:199], v[126:127], v[46:47], v[198:199]
    buffer_load_dwordx4 v[44:47], v1, s[24:27], s71 offen offset:256 nt
    v_lshlrev_b32 v234, 16, v185
    v_and_b32 v235, 0xffff0000, v185
    v_pk_mul_f32 v[154:155], v[234:235], v[118:119]
    v_lshlrev_b32 v234, 16, v191
    v_and_b32 v235, 0xffff0000, v191
    s_waitcnt vmcnt(38)
    v_pk_fma_f32 v[198:199], v[128:129], v[48:49], v[198:199]
    v_pk_fma_f32 v[198:199], v[130:131], v[50:51], v[198:199]
    ds_add_u32 v224, v243 offset:3328
    buffer_load_dwordx4 v[48:51], v1, s[24:27], s71 offen offset:512 nt
    v_add_f32 v228, v198, v199
    v_pk_fma_f32 v[202:203], v[154:155], v[234:235], v[202:203]
    v_pk_mul_f32 v[202:203], v[202:203], s[62:63]
    s_waitcnt vmcnt(35)
    v_pk_fma_f32 v[198:199], v[144:145], v[52:53], v[202:203]
    v_pk_fma_f32 v[198:199], v[146:147], v[54:55], v[198:199]
    ds_read_b32 v244, v243 offset:147
    s_add_u32 s71, s71, 384000
    s_cbranch_vccnz L_th12_0
L_tb12_0:
    buffer_load_dwordx4 v[52:55], v1, s[24:27], s71 offen offset:0 nt
    v_add_f32_dpp v229, v228, v228 row_ror:8 row_mask:0xf bank_mask:0xc
    v_lshlrev_b32 v108, 16, v192
    v_and_b32 v109, 0xffff0000, v192
    v_pk_mul_f32 v[108:109], v[108:109], s[60:61]
    v_lshlrev_b32 v110, 16, v193
    v_and_b32 v111, 0xffff0000, v193
    s_waitcnt vmcnt(35)
    v_pk_fma_f32 v[198:199], v[148:149], v[56:57], v[198:199]
    v_pk_fma_f32 v[198:199], v[150:151], v[58:59], v[198:199]
    buffer_load_dwordx4 v[56:59], v1, s[24:27], s71 offen offset:256 nt
    v_add_f32_dpp v230, v229, v229 row_shr:4 row_mask:0xf bank_mask:0xa
    v_pk_mul_f32 v[110:111], v[110:111], s[60:61]
    v_lshlrev_b32 v112, 16, v194
    v_and_b32 v113, 0xffff0000, v194
    v_pk_mul_f32 v[112:113], v[112:113], s[60:61]
    v_lshlrev_b32 v114, 16, v195
    s_waitcnt vmcnt(35)
    v_pk_fma_f32 v[198:199], v[152:153], v[60:61], v[198:199]
    v_pk_fma_f32 v[198:199], v[154:155], v[62:63], v[198:199]
    s_waitcnt lgkmcnt(0)
    v_cmp_lt_u32 vcc, v0, v244
    ds_add_u32 v224, v243 offset:3328
    buffer_load_dwordx4 v[60:63], v1, s[24:27], s71 offen offset:512 nt
    v_add_f32_dpp v231, v230, v230 quad_perm:[2,3,0,1] row_mask:0xf bank_mask:0xf
    v_add_f32 v228, v198, v199
    v_and_b32 v115, 0xffff0000, v195
    v_pk_mul_f32 v[114:115], v[114:115], s[60:61]
    v_lshlrev_b32 v116, 16, v196
    v_and_b32 v117, 0xffff0000, v196
    v_pk_mul_f32 v[116:117], v[116:117], s[60:61]
    s_waitcnt vmcnt(35)
    v_pk_fma_f32 v[198:199], v[144:145], v[64:65], v[202:203]
    v_pk_fma_f32 v[198:199], v[146:147], v[66:67], v[198:199]
    s_add_u32 s71, s71, 3072
    s_cbranch_vccnz L_th15_0
L_tb15_0:
    buffer_load_dwordx4 v[64:67], v1, s[24:27], s71 offen offset:0 nt
    v_add_f32_dpp v229, v228, v228 row_ror:8 row_mask:0xf bank_mask:0x3
    v_lshlrev_b32 v118, 16, v197
    v_and_b32 v119, 0xffff0000, v197
    v_pk_mul_f32 v[118:119], v[118:119], s[60:61]
    s_waitcnt vmcnt(29)
    v_pk_fma_f32 v[198:199], v[148:149], v[68:69], v[198:199]
    v_pk_fma_f32 v[198:199], v[150:151], v[70:71], v[198:199]
    s_add_u32 s72, s72, 3072
    buffer_load_dwordx2 v[168:169], v2, s[32:35], s72 offen offset:0
    buffer_load_dwordx2 v[170:171], v2, s[32:35], s72 offen offset:128
    buffer_load_dwordx2 v[172:173], v2, s[32:35], s72 offen offset:256
    buffer_load_dwordx2 v[174:175], v2, s[36:39], s72 offen offset:0
    buffer_load_dwordx2 v[176:177], v2, s[36:39], s72 offen offset:128
    buffer_load_dwordx2 v[178:179], v2, s[36:39], s72 offen offset:256
    buffer_load_dwordx4 v[68:71], v1, s[24:27], s71 offen offset:256 nt
    v_lshlrev_b32 v234, 16, v132
    v_and_b32 v235, 0xffff0000, v132
    v_pk_mul_f32 v[120:121], v[234:235], v[108:109]
    v_lshlrev_b32 v234, 16, v138
    v_and_b32 v235, 0xffff0000, v138
    s_waitcnt vmcnt(35)
    v_pk_fma_f32 v[198:199], v[152:153], v[72:73], v[198:199]
    v_pk_fma_f32 v[198:199], v[154:155], v[74:75], v[198:199]
    ds_add_u32 v224, v243 offset:3328
    buffer_load_dwordx4 v[72:75], v1, s[24:27], s71 offen offset:512 nt
    v_add_f32 v228, v198, v199
    v_pk_mul_f32 v[200:201], v[120:121], v[234:235]
    v_lshlrev_b32 v234, 16, v133
    v_and_b32 v235, 0xffff0000, v133
    v_pk_mul_f32 v[122:123], v[234:235], v[110:111]
    v_lshlrev_b32 v234, 16, v139
    s_waitcnt vmcnt(35)
    v_pk_fma_f32 v[198:199], v[144:145], v[76:77], v[202:203]
    v_pk_fma_f32 v[198:199], v[146:147], v[78:79], v[198:199]
    s_add_u32 s71, s71, 3072
    s_cbranch_vccnz L_th18_0
L_tb18_0:
    buffer_load_dwordx4 v[76:79], v1, s[24:27], s71 offen offset:0 nt
    v_add_f32_dpp v229, v228, v228 row_ror:8 row_mask:0xf bank_mask:0xc
    v_and_b32 v235, 0xffff0000, v139
    v_pk_fma_f32 v[200:201], v[122:123], v[234:235], v[200:201]
    v_lshlrev_b32 v234, 16, v134
    v_and_b32 v235, 0xffff0000, v134
    v_pk_mul_f32 v[124:125], v[234:235], v[112:113]
    s_waitcnt vmcnt(35)
    v_pk_fma_f32 v[198:199], v[148:149], v[80:81], v[198:199]
    v_pk_fma_f32 v[198:199], v[150:151], v[82:83], v[198:199]
    buffer_load_dwordx4 v[80:83], v1, s[24:27], s71 offen offset:256 nt
    v_add_f32_dpp v230, v229, v229 row_shl:4 row_mask:0xf bank_mask:0x5
    v_lshlrev_b32 v234, 16, v140
    v_and_b32 v235, 0xffff0000, v140
    v_pk_fma_f32 v[200:201], v[124:125], v[234:235], v[200:201]
    v_lshlrev_b32 v234, 16, v135
    v_and_b32 v235, 0xffff0000, v135
    s_waitcnt vmcnt(35)
    v_pk_fma_f32 v[198:199], v[152:153], v[84:85], v[198:199]
    v_pk_fma_f32 v[198:199], v[154:155], v[86:87], v[198:199]
    ds_add_u32 v224, v243 offset:3328
    buffer_load_dwordx4 v[84:87], v1, s[24:27], s71 offen offset:512 nt
    v_add_f32 v228, v198, v199
    v_pk_mul_f32 v[126:127], v[234:235], v[114:115]
    v_lshlrev_b32 v234, 16, v141
    v_and_b32 v235, 0xffff0000, v141
    v_pk_fma_f32 v[200:201], v[126:127], v[234:235], v[200:201]
    v_lshlrev_b32 v234, 16, v136
    s_waitcnt vmcnt(35)
    v_pk_fma_f32 v[198:199], v[144:145], v[88:89], v[202:203]
    v_pk_fma_f32 v[198:199], v[146:147], v[90:91], v[198:199]
    s_add_u32 s71, s71, 3072
    s_cbranch_vccnz L_th21_0
L_tb21_0:
    buffer_load_dwordx4 v[88:91], v1, s[24:27], s71 offen offset:0 nt
    v_add_f32_dpp v229, v228, v228 row_ror:8 row_mask:0xf bank_mask:0x3
    v_and_b32 v235, 0xffff0000, v136
    v_pk_mul_f32 v[128:129], v[234:235], v[116:117]
    v_lshlrev_b32 v234, 16, v142
    v_and_b32 v235, 0xffff0000, v142
    v_pk_fma_f32 v[200:201], v[128:129], v[234:235], v[200:201]
    s_waitcnt vmcnt(35)
    v_pk_fma_f32 v[198:199], v[148:149], v[92:93], v[198:199]
    v_pk_fma_f32 v[198:199], v[150:151], v[94:95], v[198:199]
    buffer_load_dwordx4 v[92:95], v1, s[24:27], s71 offen offset:256 nt
    v_lshlrev_b32 v234, 16, v137
    v_and_b32 v235, 0xffff0000, v137
    v_pk_mul_f32 v[130:131], v[234:235], v[118:119]
    v_lshlrev_b32 v234, 16, v143
    v_and_b32 v235, 0xffff0000, v143
    s_waitcnt vmcnt(35)
    v_pk_fma_f32 v[198:199], v[152:153], v[96:97], v[198:199]
    v_pk_fma_f32 v[198:199], v[154:155], v[98:99], v[198:199]
    ds_add_u32 v224, v243 offset:3328
    buffer_load_dwordx4 v[96:99], v1, s[24:27], s71 offen offset:512 nt
    v_add_f32 v228, v198, v199
    v_pk_fma_f32 v[200:201], v[130:131], v[234:235], v[200:201]
    v_pk_mul_f32 v[200:201], v[200:201], s[62:63]
    s_sub_u32 s76, s76, 1
    s_cmp_lg_u32 s76, 0
    s_cbranch_scc1 L_loop0
L_h0:
    s_cbranch_execz L_h1
    s_waitcnt vmcnt(35)
    v_pk_fma_f32 v[198:199], v[120:121], v[4:5], v[200:201]
L_h1:
    s_cbranch_execz L_h2
    v_pk_fma_f32 v[198:199], v[122:123], v[6:7], v[198:199]
    ds_read_b32 v244, v243 offset:147
    s_add_u32 s71, s71, 384000
    s_cbranch_vccnz L_th24_1
L_tb24_1:
    buffer_load_dwordx4 v[4:7], v1, s[24:27], s71 offen offset:0 nt
    v_add_f32_dpp v229, v228, v228 row_ror:8 row_mask:0xf bank_mask:0xc
    s_waitcnt vmcnt(35)
    v_pk_fma_f32 v[198:199], v[124:125], v[8:9], v[198:199]
    v_pk_fma_f32 v[198:199], v[126:127], v[10:11], v[198:199]
    buffer_load_dwordx4 v[8:11], v1, s[24:27], s71 offen offset:256 nt
    v_add_f32_dpp v230, v229, v229 row_shr:4 row_mask:0xf bank_mask:0xa
    s_waitcnt vmcnt(35)
    v_pk_fma_f32 v[198:199], v[128:129], v[12:13], v[198:199]
    v_pk_fma_f32 v[198:199], v[130:131], v[14:15], v[198:199]
    s_waitcnt lgkmcnt(0)
    v_cmp_lt_u32 vcc, v0, v244
    ds_add_u32 v224, v243 offset:3328
    buffer_load_dwordx4 v[12:15], v1, s[24:27], s71 offen offset:512 nt
L_h2:
    s_cbranch_execz L_h3
    v_add_f32_dpp v232, v230, v230 quad_perm:[2,3,0,1] row_mask:0xf bank_mask:0xf
    v_add_f32 v228, v198, v199
    s_waitcnt vmcnt(35)
    v_pk_fma_f32 v[198:199], v[120:121], v[16:17], v[200:201]
    v_pk_fma_f32 v[198:199], v[122:123], v[18:19], v[198:199]
    s_add_u32 s71, s71, 3072
    s_cbranch_vccnz L_th27_1
L_tb27_1:
    buffer_load_dwordx4 v[16:19], v1, s[24:27], s71 offen offset:0 nt
    v_cndmask_b32 v232, v231, v232, s[64:65]
    v_add_f32_dpp v229, v228, v228 row_ror:8 row_mask:0xf bank_mask:0x3
    s_waitcnt vmcnt(29)
    v_pk_fma_f32 v[198:199], v[124:125], v[20:21], v[198:199]
    v_pk_fma_f32 v[198:199], v[126:127], v[22:23], v[198:199]
    s_add_u32 s72, s72, 3072
    buffer_load_dwordx2 v[180:181], v2, s[32:35], s72 offen offset:0
    buffer_load_dwordx2 v[182:183], v2, s[32:35], s72 offen offset:128
    buffer_load_dwordx2 v[184:185], v2, s[32:35], s72 offen offset:256
    buffer_load_dwordx2 v[186:187], v2, s[36:39], s72 offen offset:0
L_h3:
    s_cbranch_execz L_h4
    buffer_load_dwordx2 v[188:189], v2, s[36:39], s72 offen offset:128
    buffer_load_dwordx2 v[190:191], v2, s[36:39], s72 offen offset:256
    buffer_load_dwordx4 v[20:23], v1, s[24:27], s71 offen offset:256 nt
    v_add_f32_dpp v231, v232, v232 quad_perm:[1,0,3,2] row_mask:0xf bank_mask:0xf
    v_lshlrev_b32 v234, 16, v156
    v_and_b32 v235, 0xffff0000, v156
    v_pk_mul_f32 v[144:145], v[234:235], v[108:109]
    v_lshlrev_b32 v234, 16, v162
    v_and_b32 v235, 0xffff0000, v162
    s_waitcnt vmcnt(35)
    v_pk_fma_f32 v[198:199], v[128:129], v[24:25], v[198:199]
    v_pk_fma_f32 v[198:199], v[130:131], v[26:27], v[198:199]
    ds_add_u32 v224, v243 offset:3328
    buffer_load_dwordx4 v[24:27], v1, s[24:27], s71 offen offset:512 nt
    v_cndmask_b32 v233, v233, v231, s[66:67]
    v_mul_f32 v233, 0x58000000, v233
    ds_write_b32 v239, v233
L_h4:
    s_cbranch_execz L_h5
    v_add_u32 v239, 256, v239
    v_add_f32 v228, v198, v199
    v_pk_mul_f32 v[202:203], v[144:145], v[234:235]
    v_lshlrev_b32 v234, 16, v157
    v_and_b32 v235, 0xffff0000, v157
    v_pk_mul_f32 v[146:147], v[234:235], v[110:111]
    v_lshlrev_b32 v234, 16, v163
    s_waitcnt vmcnt(35)
    v_pk_fma_f32 v[198:199], v[120:121], v[28:29], v[200:201]
    v_pk_fma_f32 v[198:199], v[122:123], v[30:31], v[198:199]
    s_add_u32 s71, s71, 3072
    s_cbranch_vccnz L_th30_1
L_tb30_1:
    buffer_load_dwordx4 v[28:31], v1, s[24:27], s71 offen offset:0 nt
    v_add_f32_dpp v229, v228, v228 row_ror:8 row_mask:0xf bank_mask:0xc
    v_and_b32 v235, 0xffff0000, v163
    v_pk_fma_f32 v[202:203], v[146:147], v[234:235], v[202:203]
    v_lshlrev_b32 v234, 16, v158
    v_and_b32 v235, 0xffff0000, v158
L_h5:
    s_cbranch_execz L_h6
    v_pk_mul_f32 v[148:149], v[234:235], v[112:113]
    s_waitcnt vmcnt(35)
    v_pk_fma_f32 v[198:199], v[124:125], v[32:33], v[198:199]
    v_pk_fma_f32 v[198:199], v[126:127], v[34:35], v[198:199]
    buffer_load_dwordx4 v[32:35], v1, s[24:27], s71 offen offset:256 nt
    v_add_f32_dpp v230, v229, v229 row_shl:4 row_mask:0xf bank_mask:0x5
    v_lshlrev_b32 v234, 16, v164
    v_and_b32 v235, 0xffff0000, v164
    v_pk_fma_f32 v[202:203], v[148:149], v[234:235], v[202:203]
    v_lshlrev_b32 v234, 16, v159
    v_and_b32 v235, 0xffff0000, v159
    s_waitcnt vmcnt(35)
    v_pk_fma_f32 v[198:199], v[128:129], v[36:37], v[198:199]
    v_pk_fma_f32 v[198:199], v[130:131], v[38:39], v[198:199]
    ds_add_u32 v224, v243 offset:3328
    buffer_load_dwordx4 v[36:39], v1, s[24:27], s71 offen offset:512 nt
    v_add_f32 v228, v198, v199
    v_pk_mul_f32 v[150:151], v[234:235], v[114:115]
L_h6:
    s_cbranch_execz L_h7
    v_lshlrev_b32 v234, 16, v165
    v_and_b32 v235, 0xffff0000, v165
    v_pk_fma_f32 v[202:203], v[150:151], v[234:235], v[202:203]
    v_lshlrev_b32 v234, 16, v160
    s_waitcnt vmcnt(35)
    v_pk_fma_f32 v[198:199], v[120:121], v[40:41], v[200:201]
    v_pk_fma_f32 v[198:199], v[122:123], v[42:43], v[198:199]
    s_add_u32 s71, s71, 3072
    s_cbranch_vccnz L_th33_1
L_tb33_1:
    buffer_load_dwordx4 v[40:43], v1, s[24:27], s71 offen offset:0 nt
    v_add_f32_dpp v229, v228, v228 row_ror:8 row_mask:0xf bank_mask:0x3
    v_and_b32 v235, 0xffff0000, v160
    v_pk_mul_f32 v[152:153], v[234:235], v[116:117]
    v_lshlrev_b32 v234, 16, v166
    v_and_b32 v235, 0xffff0000, v166
    v_pk_fma_f32 v[202:203], v[152:153], v[234:235], v[202:203]
    s_waitcnt vmcnt(35)
    v_pk_fma_f32 v[198:199], v[124:125], v[44:45], v[198:199]
    v_pk_fma_f32 v[198:199], v[126:127], v[46:47], v[198:199]
L_h7:
    s_cbranch_execz L_h8
    buffer_load_dwordx4 v[44:47], v1, s[24:27], s71 offen offset:256 nt
    v_lshlrev_b32 v234, 16, v161
    v_and_b32 v235, 0xffff0000, v161
    v_pk_mul_f32 v[154:155], v[234:235], v[118:119]
    v_lshlrev_b32 v234, 16, v167
    v_and_b32 v235, 0xffff0000, v167
    s_waitcnt vmcnt(35)
    v_pk_fma_f32 v[198:199], v[128:129], v[48:49], v[198:199]
    v_pk_fma_f32 v[198:199], v[130:131], v[50:51], v[198:199]
    ds_add_u32 v224, v243 offset:3328
    buffer_load_dwordx4 v[48:51], v1, s[24:27], s71 offen offset:512 nt
    v_add_f32 v228, v198, v199
    v_pk_fma_f32 v[202:203], v[154:155], v[234:235], v[202:203]
    v_pk_mul_f32 v[202:203], v[202:203], s[62:63]
    s_waitcnt vmcnt(35)
    v_pk_fma_f32 v[198:199], v[144:145], v[52:53], v[202:203]
    v_pk_fma_f32 v[198:199], v[146:147], v[54:55], v[198:199]
    ds_read_b32 v244, v243 offset:147
L_h8:
    s_cbranch_execz L_h9
    s_mov_b32 s91, 0
    v_readlane_b32 s70, v245, s91
    s_add_u32 s91, s91, 1
    s_and_b32 s80, s70, 31
    s_mul_i32 s80, s80, 96
    s_lshl_b32 s73, s70, 7
    s_sub_u32 s73, s73, s80
    buffer_load_ushort v220, v3, s[40:43], s73 offen
    buffer_load_ushort v221, v3, s[44:47], s73 offen
    s_add_u32 s71, s71, 384000
    s_cbranch_vccnz L_th36_1
L_tb36_1:
    buffer_load_dwordx4 v[52:55], v1, s[24:27], s71 offen offset:0 nt
    v_add_f32_dpp v229, v228, v228 row_ror:8 row_mask:0xf bank_mask:0xc
    s_waitcnt vmcnt(37)
    v_pk_fma_f32 v[198:199], v[148:149], v[56:57], v[198:199]
    v_pk_fma_f32 v[198:199], v[150:151], v[58:59], v[198:199]
    buffer_load_dwordx4 v[56:59], v1, s[24:27], s71 offen offset:256 nt
    v_add_f32_dpp v230, v229, v229 row_shr:4 row_mask:0xf bank_mask:0xa
    s_waitcnt vmcnt(37)
L_h9:
    s_cbranch_execz L_h10
    v_pk_fma_f32 v[198:199], v[152:153], v[60:61], v[198:199]
    v_pk_fma_f32 v[198:199], v[154:155], v[62:63], v[198:199]
    s_waitcnt lgkmcnt(0)
    v_cmp_lt_u32 vcc, v0, v244
    ds_add_u32 v224, v243 offset:3328
    buffer_load_dwordx4 v[60:63], v1, s[24:27], s71 offen offset:512 nt
    v_add_f32_dpp v231, v230, v230 quad_perm:[2,3,0,1] row_mask:0xf bank_mask:0xf
    v_add_f32 v228, v198, v199
    s_waitcnt vmcnt(37)
    v_pk_fma_f32 v[198:199], v[144:145], v[64:65], v[202:203]
    v_pk_fma_f32 v[198:199], v[146:147], v[66:67], v[198:199]
    s_add_u32 s71, s71, 3072
    s_cbranch_vccnz L_th39_1
L_tb39_1:
    buffer_load_dwordx4 v[64:67], v1, s[24:27], s71 offen offset:0 nt
    v_add_f32_dpp v229, v228, v228 row_ror:8 row_mask:0xf bank_mask:0x3
    s_waitcnt vmcnt(31)
    v_pk_fma_f32 v[198:199], v[148:149], v[68:69], v[198:199]
    v_pk_fma_f32 v[198:199], v[150:151], v[70:71], v[198:199]
    buffer_load_dwordx4 v[68:71], v1, s[24:27], s71 offen offset:256 nt
L_h10:
    s_cbranch_execz L_h11
    v_lshlrev_b32 v234, 16, v168
    v_and_b32 v235, 0xffff0000, v168
    v_pk_mul_f32 v[120:121], v[234:235], v[108:109]
    v_lshlrev_b32 v234, 16, v174
    v_and_b32 v235, 0xffff0000, v174
    s_waitcnt vmcnt(31)
    v_pk_fma_f32 v[198:199], v[152:153], v[72:73], v[198:199]
    v_pk_fma_f32 v[198:199], v[154:155], v[74:75], v[198:199]
    ds_add_u32 v224, v243 offset:3328
    buffer_load_dwordx4 v[72:75], v1, s[24:27], s71 offen offset:512 nt
    v_add_f32 v228, v198, v199
    v_pk_mul_f32 v[200:201], v[120:121], v[234:235]
    v_lshlrev_b32 v234, 16, v169
    v_and_b32 v235, 0xffff0000, v169
    v_pk_mul_f32 v[122:123], v[234:235], v[110:111]
    v_lshlrev_b32 v234, 16, v175
    s_waitcnt vmcnt(31)
    v_pk_fma_f32 v[198:199], v[144:145], v[76:77], v[202:203]
    v_pk_fma_f32 v[198:199], v[146:147], v[78:79], v[198:199]
L_h11:
    s_cbranch_execz L_h12
    s_add_u32 s71, s71, 3072
    s_cbranch_vccnz L_th42_1
L_tb42_1:
    buffer_load_dwordx4 v[76:79], v1, s[24:27], s71 offen offset:0 nt
    v_add_f32_dpp v229, v228, v228 row_ror:8 row_mask:0xf bank_mask:0xc
    v_and_b32 v235, 0xffff0000, v175
    v_pk_fma_f32 v[200:201], v[122:123], v[234:235], v[200:201]
    v_lshlrev_b32 v234, 16, v170
    v_and_b32 v235, 0xffff0000, v170
    v_pk_mul_f32 v[124:125], v[234:235], v[112:113]
    s_waitcnt vmcnt(31)
    v_pk_fma_f32 v[198:199], v[148:149], v[80:81], v[198:199]
    v_pk_fma_f32 v[198:199], v[150:151], v[82:83], v[198:199]
    buffer_load_dwordx4 v[80:83], v1, s[24:27], s71 offen offset:256 nt
    v_add_f32_dpp v230, v229, v229 row_shl:4 row_mask:0xf bank_mask:0x5
    v_lshlrev_b32 v234, 16, v176
    v_and_b32 v235, 0xffff0000, v176
    v_pk_fma_f32 v[200:201], v[124:125], v[234:235], v[200:201]
L_h12:
    s_cbranch_execz L_h13
    v_lshlrev_b32 v234, 16, v171
    v_and_b32 v235, 0xffff0000, v171
    s_waitcnt vmcnt(31)
    v_pk_fma_f32 v[198:199], v[152:153], v[84:85], v[198:199]
    v_pk_fma_f32 v[198:199], v[154:155], v[86:87], v[198:199]
    ds_add_u32 v224, v243 offset:3328
    buffer_load_dwordx4 v[84:87], v1, s[24:27], s71 offen offset:512 nt
    v_add_f32 v228, v198, v199
    v_pk_mul_f32 v[126:127], v[234:235], v[114:115]
    v_lshlrev_b32 v234, 16, v177
    v_and_b32 v235, 0xffff0000, v177
    v_pk_fma_f32 v[200:201], v[126:127], v[234:235], v[200:201]
    v_lshlrev_b32 v234, 16, v172
    s_waitcnt vmcnt(31)
    v_pk_fma_f32 v[198:199], v[144:145], v[88:89], v[202:203]
    v_pk_fma_f32 v[198:199], v[146:147], v[90:91], v[198:199]
    s_add_u32 s71, s71, 3072
    s_cbranch_vccnz L_th45_1
L_tb45_1:
    buffer_load_dwordx4 v[88:91], v1, s[24:27], s71 offen offset:0 nt
L_h13:
    s_cbranch_execz L_h14
    v_add_f32_dpp v229, v228, v228 row_ror:8 row_mask:0xf bank_mask:0x3
    v_and_b32 v235, 0xffff0000, v172
    v_pk_mul_f32 v[128:129], v[234:235], v[116:117]
    v_lshlrev_b32 v234, 16, v178
    v_and_b32 v235, 0xffff0000, v178
    v_pk_fma_f32 v[200:201], v[128:129], v[234:235], v[200:201]
    s_waitcnt vmcnt(31)
    v_pk_fma_f32 v[198:199], v[148:149], v[92:93], v[198:199]
    v_pk_fma_f32 v[198:199], v[150:151], v[94:95], v[198:199]
    buffer_load_dwordx4 v[92:95], v1, s[24:27], s71 offen offset:256 nt
    v_lshlrev_b32 v234, 16, v173
    v_and_b32 v235, 0xffff0000, v173
    v_pk_mul_f32 v[130:131], v[234:235], v[118:119]
    v_lshlrev_b32 v234, 16, v179
    v_and_b32 v235, 0xffff0000, v179
    s_waitcnt vmcnt(31)
    v_pk_fma_f32 v[198:199], v[152:153], v[96:97], v[198:199]
    v_pk_fma_f32 v[198:199], v[154:155], v[98:99], v[198:199]
L_h14:
    s_cbranch_execz L_h15
    ds_add_u32 v224, v243 offset:3328
    buffer_load_dwordx4 v[96:99], v1, s[24:27], s71 offen offset:512 nt
    v_add_f32 v228, v198, v199
    v_pk_fma_f32 v[200:201], v[130:131], v[234:235], v[200:201]
    v_pk_mul_f32 v[200:201], v[200:201], s[62:63]
    s_waitcnt vmcnt(31)
    v_pk_fma_f32 v[198:199], v[120:121], v[4:5], v[200:201]
    v_pk_fma_f32 v[198:199], v[122:123], v[6:7], v[198:199]
    ds_read_b32 v244, v243 offset:147
    s_mul_i32 s71, s70, 49152
    s_and_b32 s80, s70, 31
    s_mul_i32 s80, s80, 36864
    s_sub_u32 s71, s71, s80
    s_cbranch_vccnz L_th0_1
L_tb0_1:
    buffer_load_dwordx4 v[4:7], v1, s[28:31], s71 offen offset:0 nt
    v_add_f32_dpp v229, v228, v228 row_ror:8 row_mask:0xf bank_mask:0xc
    s_waitcnt vmcnt(31)
    v_pk_fma_f32 v[198:199], v[124:125], v[8:9], v[198:199]
    v_pk_fma_f32 v[198:199], v[126:127], v[10:11], v[198:199]
L_h15:
    s_cbranch_execz L_h16
    buffer_load_dwordx4 v[8:11], v1, s[28:31], s71 offen offset:256 nt
    v_add_f32_dpp v230, v229, v229 row_shr:4 row_mask:0xf bank_mask:0xa
    s_waitcnt vmcnt(31)
    v_pk_fma_f32 v[198:199], v[128:129], v[12:13], v[198:199]
    v_pk_fma_f32 v[198:199], v[130:131], v[14:15], v[198:199]
    s_waitcnt lgkmcnt(0)
    v_cmp_lt_u32 vcc, v0, v244
    ds_add_u32 v224, v243 offset:3328
    buffer_load_dwordx4 v[12:15], v1, s[28:31], s71 offen offset:512 nt
    v_add_f32_dpp v232, v230, v230 quad_perm:[2,3,0,1] row_mask:0xf bank_mask:0xf
    v_add_f32 v228, v198, v199
    s_waitcnt vmcnt(31)
    v_pk_fma_f32 v[198:199], v[120:121], v[16:17], v[200:201]
    v_pk_fma_f32 v[198:199], v[122:123], v[18:19], v[198:199]
    s_add_u32 s71, s71, 3072
    s_cbranch_vccnz L_th3_1
L_tb3_1:
    buffer_load_dwordx4 v[16:19], v1, s[28:31], s71 offen offset:0 nt
    v_cndmask_b32 v232, v231, v232, s[64:65]
L_h16:
    s_cbranch_execz L_h17
    v_add_f32_dpp v229, v228, v228 row_ror:8 row_mask:0xf bank_mask:0x3
    s_waitcnt vmcnt(25)
    v_pk_fma_f32 v[198:199], v[124:125], v[20:21], v[198:199]
    v_pk_fma_f32 v[198:199], v[126:127], v[22:23], v[198:199]
    buffer_load_dwordx4 v[20:23], v1, s[28:31], s71 offen offset:256 nt
    v_add_f32_dpp v233, v232, v232 quad_perm:[1,0,3,2] row_mask:0xf bank_mask:0xf
    v_lshlrev_b32 v234, 16, v180
    v_and_b32 v235, 0xffff0000, v180
    v_pk_mul_f32 v[144:145], v[234:235], v[108:109]
    v_lshlrev_b32 v234, 16, v186
    v_and_b32 v235, 0xffff0000, v186
    s_waitcnt vmcnt(25)
    v_pk_fma_f32 v[198:199], v[128:129], v[24:25], v[198:199]
    v_pk_fma_f32 v[198:199], v[130:131], v[26:27], v[198:199]
    ds_add_u32 v224, v243 offset:3328
    buffer_load_dwordx4 v[24:27], v1, s[28:31], s71 offen offset:512 nt
    v_add_f32 v228, v198, v199
    v_pk_mul_f32 v[202:203], v[144:145], v[234:235]
L_h17:
    s_cbranch_execz L_h18
    v_lshlrev_b32 v234, 16, v181
    v_and_b32 v235, 0xffff0000, v181
    v_pk_mul_f32 v[146:147], v[234:235], v[110:111]
    v_lshlrev_b32 v234, 16, v187
    s_waitcnt vmcnt(25)
    v_pk_fma_f32 v[198:199], v[120:121], v[28:29], v[200:201]
    v_pk_fma_f32 v[198:199], v[122:123], v[30:31], v[198:199]
    s_add_u32 s71, s71, 3072
    s_cbranch_vccnz L_th6_1
L_tb6_1:
    buffer_load_dwordx4 v[28:31], v1, s[28:31], s71 offen offset:0 nt
    v_add_f32_dpp v229, v228, v228 row_ror:8 row_mask:0xf bank_mask:0xc
    v_and_b32 v235, 0xffff0000, v187
    v_pk_fma_f32 v[202:203], v[146:147], v[234:235], v[202:203]
    v_lshlrev_b32 v234, 16, v182
    v_and_b32 v235, 0xffff0000, v182
    v_pk_mul_f32 v[148:149], v[234:235], v[112:113]
    s_waitcnt vmcnt(25)
    v_pk_fma_f32 v[198:199], v[124:125], v[32:33], v[198:199]
    v_pk_fma_f32 v[198:199], v[126:127], v[34:35], v[198:199]
L_h18:
    s_cbranch_execz L_h19
    buffer_load_dwordx4 v[32:35], v1, s[28:31], s71 offen offset:256 nt
    v_add_f32_dpp v230, v229, v229 row_shl:4 row_mask:0xf bank_mask:0x5
    v_lshlrev_b32 v234, 16, v188
    v_and_b32 v235, 0xffff0000, v188
    v_pk_fma_f32 v[202:203], v[148:149], v[234:235], v[202:203]
    v_lshlrev_b32 v234, 16, v183
    v_and_b32 v235, 0xffff0000, v183
    s_waitcnt vmcnt(25)
    v_pk_fma_f32 v[198:199], v[128:129], v[36:37], v[198:199]
    v_pk_fma_f32 v[198:199], v[130:131], v[38:39], v[198:199]
    ds_add_u32 v224, v243 offset:3328
    buffer_load_dwordx4 v[36:39], v1, s[28:31], s71 offen offset:512 nt
    v_add_f32 v228, v198, v199
    v_pk_mul_f32 v[150:151], v[234:235], v[114:115]
    v_lshlrev_b32 v234, 16, v189
    v_and_b32 v235, 0xffff0000, v189
    v_pk_fma_f32 v[202:203], v[150:151], v[234:235], v[202:203]
    v_lshlrev_b32 v234, 16, v184
L_h19:
    s_cbranch_execz L_h20
    s_waitcnt vmcnt(25)
    v_pk_fma_f32 v[198:199], v[120:121], v[40:41], v[200:201]
    v_pk_fma_f32 v[198:199], v[122:123], v[42:43], v[198:199]
    s_add_u32 s71, s71, 3072
    s_cbranch_vccnz L_th9_1
L_tb9_1:
    buffer_load_dwordx4 v[40:43], v1, s[28:31], s71 offen offset:0 nt
    v_add_f32_dpp v229, v228, v228 row_ror:8 row_mask:0xf bank_mask:0x3
    v_and_b32 v235, 0xffff0000, v184
    v_pk_mul_f32 v[152:153], v[234:235], v[116:117]
    v_lshlrev_b32 v234, 16, v190
    v_and_b32 v235, 0xffff0000, v190
    v_pk_fma_f32 v[202:203], v[152:153], v[234:235], v[202:203]
    s_waitcnt vmcnt(25)
    v_pk_fma_f32 v[198:199], v[124:125], v[44:45], v[198:199]
    v_pk_fma_f32 v[198:199], v[126:127], v[46:47], v[198:199]
    buffer_load_dwordx4 v[44:47], v1, s[28:31], s71 offen offset:256 nt
    v_lshlrev_b32 v234, 16, v185
    v_and_b32 v235, 0xffff0000, v185
L_h20:
    s_cbranch_execz L_h21
    v_pk_mul_f32 v[154:155], v[234:235], v[118:119]
    v_lshlrev_b32 v234, 16, v191
    v_and_b32 v235, 0xffff0000, v191
    s_waitcnt vmcnt(25)
    v_pk_fma_f32 v[198:199], v[128:129], v[48:49], v[198:199]
    v_pk_fma_f32 v[198:199], v[130:131], v[50:51], v[198:199]
    ds_add_u32 v224, v243 offset:3328
    buffer_load_dwordx4 v[48:51], v1, s[28:31], s71 offen offset:512 nt
    v_add_f32 v228, v198, v199
    v_pk_fma_f32 v[202:203], v[154:155], v[234:235], v[202:203]
    v_pk_mul_f32 v[202:203], v[202:203], s[62:63]
    s_waitcnt vmcnt(23)
    v_pk_fma_f32 v[198:199], v[144:145], v[52:53], v[202:203]
    v_pk_fma_f32 v[198:199], v[146:147], v[54:55], v[198:199]
    ds_read_b32 v244, v243 offset:147
    s_add_u32 s71, s71, 384000
    s_cbranch_vccnz L_th12_1
L_tb12_1:
    buffer_load_dwordx4 v[52:55], v1, s[28:31], s71 offen offset:0 nt
L_h21:
    s_cbranch_execz L_h22
    v_add_f32_dpp v229, v228, v228 row_ror:8 row_mask:0xf bank_mask:0xc
    s_waitcnt vmcnt(23)
    v_pk_fma_f32 v[198:199], v[148:149], v[56:57], v[198:199]
    v_pk_fma_f32 v[198:199], v[150:151], v[58:59], v[198:199]
    buffer_load_dwordx4 v[56:59], v1, s[28:31], s71 offen offset:256 nt
    v_add_f32_dpp v230, v229, v229 row_shr:4 row_mask:0xf bank_mask:0xa
    s_waitcnt vmcnt(23)
    v_pk_fma_f32 v[198:199], v[152:153], v[60:61], v[198:199]
    v_pk_fma_f32 v[198:199], v[154:155], v[62:63], v[198:199]
    s_waitcnt lgkmcnt(0)
    v_cmp_lt_u32 vcc, v0, v244
    ds_add_u32 v224, v243 offset:3328
    buffer_load_dwordx4 v[60:63], v1, s[28:31], s71 offen offset:512 nt
    v_add_f32_dpp v231, v230, v230 quad_perm:[2,3,0,1] row_mask:0xf bank_mask:0xf
    v_add_f32 v228, v198, v199
    s_waitcnt vmcnt(23)
    v_pk_fma_f32 v[198:199], v[144:145], v[64:65], v[202:203]
    v_pk_fma_f32 v[198:199], v[146:147], v[66:67], v[198:199]
    s_add_u32 s71, s71, 3072
L_h22:
    s_cbranch_execz L_h23
    s_cbranch_vccnz L_th15_1
L_tb15_1:
    buffer_load_dwordx4 v[64:67], v1, s[28:31], s71 offen offset:0 nt
    v_add_f32_dpp v229, v228, v228 row_ror:8 row_mask:0xf bank_mask:0x3
    s_waitcnt vmcnt(23)
    v_pk_fma_f32 v[198:199], v[148:149], v[68:69], v[198:199]
    v_pk_fma_f32 v[198:199], v[150:151], v[70:71], v[198:199]
    buffer_load_dwordx4 v[68:71], v1, s[28:31], s71 offen offset:256 nt
    s_waitcnt vmcnt(23)
    v_pk_fma_f32 v[198:199], v[152:153], v[72:73], v[198:199]
    v_pk_fma_f32 v[198:199], v[154:155], v[74:75], v[198:199]
    ds_add_u32 v224, v243 offset:3328
    buffer_load_dwordx4 v[72:75], v1, s[28:31], s71 offen offset:512 nt
    v_add_f32 v228, v198, v199
    s_waitcnt vmcnt(23)
    v_pk_fma_f32 v[198:199], v[144:145], v[76:77], v[202:203]
    v_pk_fma_f32 v[198:199], v[146:147], v[78:79], v[198:199]
    s_add_u32 s71, s71, 3072
    s_cbranch_vccnz L_th18_1
L_tb18_1:
L_h23:
    s_cbranch_execz L_h24
    buffer_load_dwordx4 v[76:79], v1, s[28:31], s71 offen offset:0 nt
    v_add_f32_dpp v229, v228, v228 row_ror:8 row_mask:0xf bank_mask:0xc
    s_waitcnt vmcnt(23)
    v_pk_fma_f32 v[198:199], v[148:149], v[80:81], v[198:199]
    v_pk_fma_f32 v[198:199], v[150:151], v[82:83], v[198:199]
    buffer_load_dwordx4 v[80:83], v1, s[28:31], s71 offen offset:256 nt
    v_add_f32_dpp v230, v229, v229 row_shl:4 row_mask:0xf bank_mask:0x5
    s_waitcnt vmcnt(23)
    v_pk_fma_f32 v[198:199], v[152:153], v[84:85], v[198:199]
    v_pk_fma_f32 v[198:199], v[154:155], v[86:87], v[198:199]
    ds_add_u32 v224, v243 offset:3328
    buffer_load_dwordx4 v[84:87], v1, s[28:31], s71 offen offset:512 nt
    v_add_f32 v228, v198, v199
    s_waitcnt vmcnt(23)
    v_pk_fma_f32 v[198:199], v[144:145], v[88:89], v[202:203]
    v_pk_fma_f32 v[198:199], v[146:147], v[90:91], v[198:199]
    s_add_u32 s71, s71, 3072
    s_cbranch_vccnz L_th21_1
L_tb21_1:
L_h24:
    s_cbranch_execz L_h25
    buffer_load_dwordx4 v[88:91], v1, s[28:31], s71 offen offset:0 nt
    v_add_f32_dpp v229, v228, v228 row_ror:8 row_mask:0xf bank_mask:0x3
    s_waitcnt vmcnt(23)
    v_pk_fma_f32 v[198:199], v[148:149], v[92:93], v[198:199]
    v_pk_fma_f32 v[198:199], v[150:151], v[94:95], v[198:199]
    buffer_load_dwordx4 v[92:95], v1, s[28:31], s71 offen offset:256 nt
    s_waitcnt vmcnt(23)
    v_pk_fma_f32 v[198:199], v[152:153], v[96:97], v[198:199]
    v_pk_fma_f32 v[198:199], v[154:155], v[98:99], v[198:199]
    ds_add_u32 v224, v243 offset:3328
    buffer_load_dwordx4 v[96:99], v1, s[28:31], s71 offen offset:512 nt
    v_add_f32 v228, v198, v199
    s_nop 1
    v_add_f32_dpp v229, v228, v228 row_ror:8 row_mask:0xf bank_mask:0xc
    s_nop 1
    v_add_f32_dpp v230, v229, v229 row_shr:4 row_mask:0xf bank_mask:0xa
    s_nop 1
    v_add_f32_dpp v232, v230, v230 quad_perm:[2,3,0,1] row_mask:0xf bank_mask:0xf
    s_nop 1
L_h25:
    s_cbranch_execz L_h26
    v_cndmask_b32 v232, v231, v232, s[64:65]
    s_nop 1
    v_add_f32_dpp v231, v232, v232 quad_perm:[1,0,3,2] row_mask:0xf bank_mask:0xf
    s_nop 1
    v_cndmask_b32 v233, v233, v231, s[66:67]
    v_mul_f32 v233, 0x58000000, v233
    ds_write_b32 v239, v233
    v_add_u32 v239, 256, v239
    s_mov_b64 exec, 1
    ds_add_u32 v243, v243 offset:127
    s_mov_b64 exec, -1
    ds_read_b32 v223, v240
    v_add_u32 v240, 256, v240
    v_lshlrev_b32 v220, 16, v220
    v_lshlrev_b32 v221, 16, v221
    s_waitcnt lgkmcnt(0)
    v_max_f32_dpp v234, v223, v223 row_ror:8 row_mask:0xf bank_mask:0xf
    s_nop 1
    v_max_f32_dpp v234, v234, v234 row_ror:4 row_mask:0xf bank_mask:0xf
    s_nop 1
L_h26:
    s_cbranch_execz L_h27
    v_max_f32_dpp v234, v234, v234 row_ror:2 row_mask:0xf bank_mask:0xf
    s_nop 1
    v_max_f32_dpp v234, v234, v234 row_ror:1 row_mask:0xf bank_mask:0xf
    v_mov_b32 v228, v216
    v_max3_f32 v234, v234, v228, s77
    v_sub_f32 v235, v228, v234
    v_sub_f32 v229, v223, v234
    v_exp_f32 v235, v235
    v_exp_f32 v229, v229
    s_nop 0
    v_mul_f32 v222, v229, v220
    v_mul_f32 v230, v222, v221
    v_mul_f32 v238, 0x71800000, v222
    s_nop 0
    s_mov_b32 s76, 63
L_loop1:
    v_mov_b32_dpp v236, v238 row_newbcast:0 row_mask:0xf bank_mask:0xf
    s_waitcnt vmcnt(23)
    v_pk_fma_f32 v[204:205], v[236:237], v[4:5], v[204:205] op_sel_hi:[0,1,1]
    v_pk_fma_f32 v[206:207], v[236:237], v[6:7], v[206:207] op_sel_hi:[0,1,1]
    ds_read_b32 v244, v243 offset:147
    s_add_u32 s71, s71, 384000
    s_cbranch_vccnz L_th24_2
L_tb24_2:
L_h27:
    s_cbranch_execz L_h28
    buffer_load_dwordx4 v[4:7], v1, s[28:31], s71 offen offset:0 nt
    s_bitcmp0_b32 s4, 0
    s_cbranch_scc1 L_nofl2
    s_mov_b64 exec, 1
    ds_add_u32 v242, v243
    s_mov_b64 exec, -1
    v_add_u32 v241, 4096, v241
    v_add_u32 v242, 4, v242
L_nofl2:
    s_waitcnt vmcnt(23)
    v_pk_fma_f32 v[208:209], v[236:237], v[8:9], v[208:209] op_sel_hi:[0,1,1]
    v_pk_fma_f32 v[210:211], v[236:237], v[10:11], v[210:211] op_sel_hi:[0,1,1]
    buffer_load_dwordx4 v[8:11], v1, s[28:31], s71 offen offset:256 nt
    v_pk_mul_f32 v[212:213], v[212:213], v[234:235] op_sel:[0,1] op_sel_hi:[1,1]
    v_pk_mul_f32 v[214:215], v[214:215], v[234:235] op_sel:[0,1] op_sel_hi:[1,1]
    v_mov_b32 v216, v234
    s_waitcnt vmcnt(23)
    v_pk_fma_f32 v[212:213], v[236:237], v[12:13], v[212:213] op_sel_hi:[0,1,1]
    v_pk_fma_f32 v[214:215], v[236:237], v[14:15], v[214:215] op_sel_hi:[0,1,1]
    s_nop 2
    s_waitcnt lgkmcnt(0)
    v_cmp_lt_u32 vcc, v0, v244
L_h28:
    s_cbranch_execz L_h29
    ds_add_u32 v224, v243 offset:3328
    buffer_load_dwordx4 v[12:15], v1, s[28:31], s71 offen offset:512 nt
    v_fma_f32 v217, v217, v235, v229
    v_mov_b32_dpp v236, v238 row_newbcast:8 row_mask:0xf bank_mask:0xf
    s_waitcnt vmcnt(23)
    v_pk_fma_f32 v[204:205], v[236:237], v[16:17], v[204:205] op_sel_hi:[0,1,1]
    v_pk_fma_f32 v[206:207], v[236:237], v[18:19], v[206:207] op_sel_hi:[0,1,1]
    s_add_u32 s71, s71, 3072
    s_cbranch_vccnz L_th27_2
L_tb27_2:
    buffer_load_dwordx4 v[16:19], v1, s[28:31], s71 offen offset:0 nt
    v_fma_f32 v218, v218, v235, v230
    s_waitcnt vmcnt(23)
    v_pk_fma_f32 v[208:209], v[236:237], v[20:21], v[208:209] op_sel_hi:[0,1,1]
    v_pk_fma_f32 v[210:211], v[236:237], v[22:23], v[210:211] op_sel_hi:[0,1,1]
    s_nop 2
    buffer_load_dwordx4 v[20:23], v1, s[28:31], s71 offen offset:256 nt
    ds_read_b32 v223, v240
    v_add_u32 v240, 256, v240
L_h29:
    s_cbranch_execz L_h30
    s_waitcnt vmcnt(23)
    v_pk_fma_f32 v[212:213], v[236:237], v[24:25], v[212:213] op_sel_hi:[0,1,1]
    v_pk_fma_f32 v[214:215], v[236:237], v[26:27], v[214:215] op_sel_hi:[0,1,1]
    ds_add_u32 v224, v243 offset:3328
    buffer_load_dwordx4 v[24:27], v1, s[28:31], s71 offen offset:512 nt
    v_mov_b32_dpp v236, v238 row_newbcast:4 row_mask:0xf bank_mask:0xf
    s_waitcnt vmcnt(23)
    v_pk_fma_f32 v[204:205], v[236:237], v[28:29], v[204:205] op_sel_hi:[0,1,1]
    v_pk_fma_f32 v[206:207], v[236:237], v[30:31], v[206:207] op_sel_hi:[0,1,1]
    s_nop 2
    s_add_u32 s71, s71, 3072
    s_cbranch_vccnz L_th30_2
L_tb30_2:
    buffer_load_dwordx4 v[28:31], v1, s[28:31], s71 offen offset:0 nt
    ds_write_b128 v241, v[216:219] offset:23552
    s_waitcnt vmcnt(23)
    v_pk_fma_f32 v[208:209], v[236:237], v[32:33], v[208:209] op_sel_hi:[0,1,1]
    v_pk_fma_f32 v[210:211], v[236:237], v[34:35], v[210:211] op_sel_hi:[0,1,1]
    s_nop 2
L_h30:
    s_cbranch_execz L_h31
    buffer_load_dwordx4 v[32:35], v1, s[28:31], s71 offen offset:256 nt
    s_waitcnt vmcnt(23)
    v_pk_fma_f32 v[212:213], v[236:237], v[36:37], v[212:213] op_sel_hi:[0,1,1]
    v_pk_fma_f32 v[214:215], v[236:237], v[38:39], v[214:215] op_sel_hi:[0,1,1]
    ds_add_u32 v224, v243 offset:3328
    buffer_load_dwordx4 v[36:39], v1, s[28:31], s71 offen offset:512 nt
    v_mov_b32_dpp v236, v238 row_newbcast:12 row_mask:0xf bank_mask:0xf
    s_waitcnt vmcnt(23)
    v_pk_fma_f32 v[204:205], v[236:237], v[40:41], v[204:205] op_sel_hi:[0,1,1]
    v_pk_fma_f32 v[206:207], v[236:237], v[42:43], v[206:207] op_sel_hi:[0,1,1]
    s_nop 2
    s_add_u32 s71, s71, 3072
    s_cbranch_vccnz L_th33_2
L_tb33_2:
    buffer_load_dwordx4 v[40:43], v1, s[28:31], s71 offen offset:0 nt
    s_waitcnt vmcnt(23)
    v_pk_fma_f32 v[208:209], v[236:237], v[44:45], v[208:209] op_sel_hi:[0,1,1]
    v_pk_fma_f32 v[210:211], v[236:237], v[46:47], v[210:211] op_sel_hi:[0,1,1]
    s_nop 2
    buffer_load_dwordx4 v[44:47], v1, s[28:31], s71 offen offset:256 nt
L_h31:
    s_cbranch_execz L_h32
    s_waitcnt vmcnt(23)
    v_pk_fma_f32 v[212:213], v[236:237], v[48:49], v[212:213] op_sel_hi:[0,1,1]
    v_pk_fma_f32 v[214:215], v[236:237], v[50:51], v[214:215] op_sel_hi:[0,1,1]
    ds_add_u32 v224, v243 offset:3328
    buffer_load_dwordx4 v[48:51], v1, s[28:31], s71 offen offset:512 nt
    v_mov_b32_dpp v236, v238 row_newbcast:2 row_mask:0xf bank_mask:0xf
    s_waitcnt vmcnt(23)
    v_pk_fma_f32 v[204:205], v[236:237], v[52:53], v[204:205] op_sel_hi:[0,1,1]
    v_pk_fma_f32 v[206:207], v[236:237], v[54:55], v[206:207] op_sel_hi:[0,1,1]
    s_nop 2
    ds_read_b32 v244, v243 offset:147
    v_readlane_b32 s70, v245, s91
    s_add_u32 s91, s91, 1
    s_and_b32 s80, s70, 31
    s_mul_i32 s80, s80, 96
    s_lshl_b32 s73, s70, 7
    s_sub_u32 s73, s73, s80
    buffer_load_ushort v220, v3, s[40:43], s73 offen
    buffer_load_ushort v221, v3, s[44:47], s73 offen
L_h32:
    s_cbranch_execz L_h33
    s_add_u32 s71, s71, 384000
    s_cbranch_vccnz L_th36_2
L_tb36_2:
    buffer_load_dwordx4 v[52:55], v1, s[28:31], s71 offen offset:0 nt
    s_waitcnt vmcnt(25)
    v_pk_fma_f32 v[208:209], v[236:237], v[56:57], v[208:209] op_sel_hi:[0,1,1]
    v_pk_fma_f32 v[210:211], v[236:237], v[58:59], v[210:211] op_sel_hi:[0,1,1]
    buffer_load_dwordx4 v[56:59], v1, s[28:31], s71 offen offset:256 nt
    s_waitcnt vmcnt(25)
    v_pk_fma_f32 v[212:213], v[236:237], v[60:61], v[212:213] op_sel_hi:[0,1,1]
    v_pk_fma_f32 v[214:215], v[236:237], v[62:63], v[214:215] op_sel_hi:[0,1,1]
    s_nop 2
    s_waitcnt lgkmcnt(0)
    v_cmp_lt_u32 vcc, v0, v244
    ds_add_u32 v224, v243 offset:3328
    buffer_load_dwordx4 v[60:63], v1, s[28:31], s71 offen offset:512 nt
    v_mov_b32_dpp v236, v238 row_newbcast:10 row_mask:0xf bank_mask:0xf
    s_waitcnt vmcnt(25)
    v_pk_fma_f32 v[204:205], v[236:237], v[64:65], v[204:205] op_sel_hi:[0,1,1]
    v_pk_fma_f32 v[206:207], v[236:237], v[66:67], v[206:207] op_sel_hi:[0,1,1]
L_h33:
    s_cbranch_execz L_h34
    s_add_u32 s71, s71, 3072
    s_cbranch_vccnz L_th39_2
L_tb39_2:
    buffer_load_dwordx4 v[64:67], v1, s[28:31], s71 offen offset:0 nt
    s_waitcnt vmcnt(25)
    v_pk_fma_f32 v[208:209], v[236:237], v[68:69], v[208:209] op_sel_hi:[0,1,1]
    v_pk_fma_f32 v[210:211], v[236:237], v[70:71], v[210:211] op_sel_hi:[0,1,1]
    s_nop 2
    buffer_load_dwordx4 v[68:71], v1, s[28:31], s71 offen offset:256 nt
    s_waitcnt vmcnt(25)
    v_pk_fma_f32 v[212:213], v[236:237], v[72:73], v[212:213] op_sel_hi:[0,1,1]
    v_pk_fma_f32 v[214:215], v[236:237], v[74:75], v[214:215] op_sel_hi:[0,1,1]
    s_nop 2
    ds_add_u32 v224, v243 offset:3328
    buffer_load_dwordx4 v[72:75], v1, s[28:31], s71 offen offset:512 nt
    v_mov_b32_dpp v236, v238 row_newbcast:6 row_mask:0xf bank_mask:0xf
    s_waitcnt vmcnt(25)
    v_pk_fma_f32 v[204:205], v[236:237], v[76:77], v[204:205] op_sel_hi:[0,1,1]
    v_pk_fma_f32 v[206:207], v[236:237], v[78:79], v[206:207] op_sel_hi:[0,1,1]
L_h34:
    s_cbranch_execz L_h35
    s_add_u32 s71, s71, 3072
    s_cbranch_vccnz L_th42_2
L_tb42_2:
    buffer_load_dwordx4 v[76:79], v1, s[28:31], s71 offen offset:0 nt
    s_waitcnt vmcnt(25)
    v_pk_fma_f32 v[208:209], v[236:237], v[80:81], v[208:209] op_sel_hi:[0,1,1]
    v_pk_fma_f32 v[210:211], v[236:237], v[82:83], v[210:211] op_sel_hi:[0,1,1]
    s_nop 2
    buffer_load_dwordx4 v[80:83], v1, s[28:31], s71 offen offset:256 nt
    s_waitcnt vmcnt(25)
    v_pk_fma_f32 v[212:213], v[236:237], v[84:85], v[212:213] op_sel_hi:[0,1,1]
    v_pk_fma_f32 v[214:215], v[236:237], v[86:87], v[214:215] op_sel_hi:[0,1,1]
    s_nop 2
    ds_add_u32 v224, v243 offset:3328
    buffer_load_dwordx4 v[84:87], v1, s[28:31], s71 offen offset:512 nt
    v_mov_b32_dpp v236, v238 row_newbcast:14 row_mask:0xf bank_mask:0xf
    s_waitcnt vmcnt(25)
    v_pk_fma_f32 v[204:205], v[236:237], v[88:89], v[204:205] op_sel_hi:[0,1,1]
    v_pk_fma_f32 v[206:207], v[236:237], v[90:91], v[206:207] op_sel_hi:[0,1,1]
    s_nop 2
L_h35:
    s_cbranch_execz L_h36
    s_add_u32 s71, s71, 3072
    s_cbranch_vccnz L_th45_2
L_tb45_2:
    buffer_load_dwordx4 v[88:91], v1, s[28:31], s71 offen offset:0 nt
    s_waitcnt vmcnt(25)
    v_pk_fma_f32 v[208:209], v[236:237], v[92:93], v[208:209] op_sel_hi:[0,1,1]
    v_pk_fma_f32 v[210:211], v[236:237], v[94:95], v[210:211] op_sel_hi:[0,1,1]
    buffer_load_dwordx4 v[92:95], v1, s[28:31], s71 offen offset:256 nt
    s_cmp_eq_u32 s76, 16
    s_cbranch_scc1 L_getm2
L_gotm2:
    s_waitcnt vmcnt(25)
    v_pk_fma_f32 v[212:213], v[236:237], v[96:97], v[212:213] op_sel_hi:[0,1,1]
    v_pk_fma_f32 v[214:215], v[236:237], v[98:99], v[214:215] op_sel_hi:[0,1,1]
    s_nop 2
    ds_add_u32 v224, v243 offset:3328
    buffer_load_dwordx4 v[96:99], v1, s[28:31], s71 offen offset:512 nt
    v_mov_b32_dpp v236, v238 row_newbcast:1 row_mask:0xf bank_mask:0xf
    s_waitcnt vmcnt(25)
    v_pk_fma_f32 v[204:205], v[236:237], v[4:5], v[204:205] op_sel_hi:[0,1,1]
    v_pk_fma_f32 v[206:207], v[236:237], v[6:7], v[206:207] op_sel_hi:[0,1,1]
L_h36:
    s_cbranch_execz L_h37
    ds_read_b32 v244, v243 offset:147
    s_mul_i32 s71, s70, 49152
    s_and_b32 s80, s70, 31
    s_mul_i32 s80, s80, 36864
    s_sub_u32 s71, s71, s80
    s_cbranch_vccnz L_th0_2
L_tb0_2:
    buffer_load_dwordx4 v[4:7], v1, s[28:31], s71 offen offset:0 nt
    s_waitcnt vmcnt(25)
    v_pk_fma_f32 v[208:209], v[236:237], v[8:9], v[208:209] op_sel_hi:[0,1,1]
    v_pk_fma_f32 v[210:211], v[236:237], v[10:11], v[210:211] op_sel_hi:[0,1,1]
    s_nop 2
    buffer_load_dwordx4 v[8:11], v1, s[28:31], s71 offen offset:256 nt
    s_waitcnt vmcnt(25)
    v_pk_fma_f32 v[212:213], v[236:237], v[12:13], v[212:213] op_sel_hi:[0,1,1]
    v_pk_fma_f32 v[214:215], v[236:237], v[14:15], v[214:215] op_sel_hi:[0,1,1]
    s_nop 2
    s_waitcnt lgkmcnt(0)
    v_cmp_lt_u32 vcc, v0, v244
    ds_add_u32 v224, v243 offset:3328
    buffer_load_dwordx4 v[12:15], v1, s[28:31], s71 offen offset:512 nt
L_h37:
    s_cbranch_execz L_h38
    v_max_f32_dpp v234, v223, v223 row_ror:8 row_mask:0xf bank_mask:0xf
    v_mov_b32_dpp v236, v238 row_newbcast:9 row_mask:0xf bank_mask:0xf
    s_waitcnt vmcnt(25)
    v_pk_fma_f32 v[204:205], v[236:237], v[16:17], v[204:205] op_sel_hi:[0,1,1]
    v_pk_fma_f32 v[206:207], v[236:237], v[18:19], v[206:207] op_sel_hi:[0,1,1]
    s_add_u32 s71, s71, 3072
    s_cbranch_vccnz L_th3_2
L_tb3_2:
    buffer_load_dwordx4 v[16:19], v1, s[28:31], s71 offen offset:0 nt
    v_max_f32_dpp v234, v234, v234 row_ror:4 row_mask:0xf bank_mask:0xf
    s_waitcnt vmcnt(25)
    v_pk_fma_f32 v[208:209], v[236:237], v[20:21], v[208:209] op_sel_hi:[0,1,1]
    v_pk_fma_f32 v[210:211], v[236:237], v[22:23], v[210:211] op_sel_hi:[0,1,1]
    s_nop 2
    buffer_load_dwordx4 v[20:23], v1, s[28:31], s71 offen offset:256 nt
    v_max_f32_dpp v234, v234, v234 row_ror:2 row_mask:0xf bank_mask:0xf
    s_waitcnt vmcnt(25)
    v_pk_fma_f32 v[212:213], v[236:237], v[24:25], v[212:213] op_sel_hi:[0,1,1]
    v_pk_fma_f32 v[214:215], v[236:237], v[26:27], v[214:215] op_sel_hi:[0,1,1]
L_h38:
    s_cbranch_execz L_h39
    ds_add_u32 v224, v243 offset:3328
    buffer_load_dwordx4 v[24:27], v1, s[28:31], s71 offen offset:512 nt
    v_max_f32_dpp v234, v234, v234 row_ror:1 row_mask:0xf bank_mask:0xf
    v_mov_b32_dpp v236, v238 row_newbcast:5 row_mask:0xf bank_mask:0xf
    s_waitcnt vmcnt(25)
    v_pk_fma_f32 v[204:205], v[236:237], v[28:29], v[204:205] op_sel_hi:[0,1,1]
    v_pk_fma_f32 v[206:207], v[236:237], v[30:31], v[206:207] op_sel_hi:[0,1,1]
    s_nop 2
    s_add_u32 s71, s71, 3072
    s_cbranch_vccnz L_th6_2
L_tb6_2:
    buffer_load_dwordx4 v[28:31], v1, s[28:31], s71 offen offset:0 nt
    s_lshr_b64 s[4:5], s[4:5], 1
    s_bitcmp1_b32 s4, 0
    s_cselect_b32 s6, s7, 0x7f7fffff
    v_min_f32 v228, s6, v216
    s_waitcnt vmcnt(25)
    v_pk_fma_f32 v[208:209], v[236:237], v[32:33], v[208:209] op_sel_hi:[0,1,1]
    v_pk_fma_f32 v[210:211], v[236:237], v[34:35], v[210:211] op_sel_hi:[0,1,1]
    s_nop 2
    buffer_load_dwordx4 v[32:35], v1, s[28:31], s71 offen offset:256 nt
L_h39:
    s_cbranch_execz L_h40
    v_max3_f32 v234, v234, v228, s77
    s_waitcnt vmcnt(25)
    v_pk_fma_f32 v[212:213], v[236:237], v[36:37], v[212:213] op_sel_hi:[0,1,1]
    v_pk_fma_f32 v[214:215], v[236:237], v[38:39], v[214:215] op_sel_hi:[0,1,1]
    ds_add_u32 v224, v243 offset:3328
    buffer_load_dwordx4 v[36:39], v1, s[28:31], s71 offen offset:512 nt
    v_sub_f32 v235, v228, v234
    v_sub_f32 v229, v223, v234
    v_mov_b32_dpp v236, v238 row_newbcast:13 row_mask:0xf bank_mask:0xf
    s_waitcnt vmcnt(25)
    v_pk_fma_f32 v[204:205], v[236:237], v[40:41], v[204:205] op_sel_hi:[0,1,1]
    v_pk_fma_f32 v[206:207], v[236:237], v[42:43], v[206:207] op_sel_hi:[0,1,1]
    s_nop 2
    s_add_u32 s71, s71, 3072
    s_cbranch_vccnz L_th9_2
L_tb9_2:
    buffer_load_dwordx4 v[40:43], v1, s[28:31], s71 offen offset:0 nt
    v_exp_f32 v235, v235
    s_waitcnt vmcnt(25)
    v_pk_fma_f32 v[208:209], v[236:237], v[44:45], v[208:209] op_sel_hi:[0,1,1]
L_h40:
    s_cbranch_execz L_h41
    v_pk_fma_f32 v[210:211], v[236:237], v[46:47], v[210:211] op_sel_hi:[0,1,1]
    buffer_load_dwordx4 v[44:47], v1, s[28:31], s71 offen offset:256 nt
    v_exp_f32 v229, v229
    s_waitcnt vmcnt(25)
    v_pk_fma_f32 v[212:213], v[236:237], v[48:49], v[212:213] op_sel_hi:[0,1,1]
    v_pk_fma_f32 v[214:215], v[236:237], v[50:51], v[214:215] op_sel_hi:[0,1,1]
    s_nop 2
    ds_add_u32 v224, v243 offset:3328
    buffer_load_dwordx4 v[48:51], v1, s[28:31], s71 offen offset:512 nt
    v_mov_b32_dpp v236, v238 row_newbcast:3 row_mask:0xf bank_mask:0xf
    s_waitcnt vmcnt(23)
    v_pk_fma_f32 v[204:205], v[236:237], v[52:53], v[204:205] op_sel_hi:[0,1,1]
    v_pk_fma_f32 v[206:207], v[236:237], v[54:55], v[206:207] op_sel_hi:[0,1,1]
    s_nop 2
    ds_read_b32 v244, v243 offset:147
    s_add_u32 s71, s71, 384000
    s_cbranch_vccnz L_th12_2
L_tb12_2:
    buffer_load_dwordx4 v[52:55], v1, s[28:31], s71 offen offset:0 nt
    v_lshlrev_b32 v220, 16, v220
L_h41:
    s_cbranch_execz L_h42
    s_waitcnt vmcnt(23)
    v_pk_fma_f32 v[208:209], v[236:237], v[56:57], v[208:209] op_sel_hi:[0,1,1]
    v_pk_fma_f32 v[210:211], v[236:237], v[58:59], v[210:211] op_sel_hi:[0,1,1]
    buffer_load_dwordx4 v[56:59], v1, s[28:31], s71 offen offset:256 nt
    v_lshlrev_b32 v221, 16, v221
    s_waitcnt vmcnt(23)
    v_pk_fma_f32 v[212:213], v[236:237], v[60:61], v[212:213] op_sel_hi:[0,1,1]
    v_pk_fma_f32 v[214:215], v[236:237], v[62:63], v[214:215] op_sel_hi:[0,1,1]
    s_nop 2
    s_waitcnt lgkmcnt(0)
    v_cmp_lt_u32 vcc, v0, v244
    ds_add_u32 v224, v243 offset:3328
    buffer_load_dwordx4 v[60:63], v1, s[28:31], s71 offen offset:512 nt
    v_mov_b32_dpp v236, v238 row_newbcast:11 row_mask:0xf bank_mask:0xf
    s_waitcnt vmcnt(23)
    v_pk_fma_f32 v[204:205], v[236:237], v[64:65], v[204:205] op_sel_hi:[0,1,1]
    v_pk_fma_f32 v[206:207], v[236:237], v[66:67], v[206:207] op_sel_hi:[0,1,1]
    s_nop 2
    s_add_u32 s71, s71, 3072
    s_cbranch_vccnz L_th15_2
L_tb15_2:
L_h42:
    s_cbranch_execz L_h43
    buffer_load_dwordx4 v[64:67], v1, s[28:31], s71 offen offset:0 nt
    v_mul_f32 v222, v229, v220
    s_waitcnt vmcnt(23)
    v_pk_fma_f32 v[208:209], v[236:237], v[68:69], v[208:209] op_sel_hi:[0,1,1]
    v_pk_fma_f32 v[210:211], v[236:237], v[70:71], v[210:211] op_sel_hi:[0,1,1]
    buffer_load_dwordx4 v[68:71], v1, s[28:31], s71 offen offset:256 nt
    v_mul_f32 v230, v222, v221
    s_waitcnt vmcnt(23)
    v_pk_fma_f32 v[212:213], v[236:237], v[72:73], v[212:213] op_sel_hi:[0,1,1]
    v_pk_fma_f32 v[214:215], v[236:237], v[74:75], v[214:215] op_sel_hi:[0,1,1]
    s_nop 2
    ds_add_u32 v224, v243 offset:3328
    buffer_load_dwordx4 v[72:75], v1, s[28:31], s71 offen offset:512 nt
    v_mov_b32_dpp v236, v238 row_newbcast:7 row_mask:0xf bank_mask:0xf
    s_waitcnt vmcnt(23)
    v_pk_fma_f32 v[204:205], v[236:237], v[76:77], v[204:205] op_sel_hi:[0,1,1]
    v_pk_fma_f32 v[206:207], v[236:237], v[78:79], v[206:207] op_sel_hi:[0,1,1]
    s_nop 2
    s_add_u32 s71, s71, 3072
L_h43:
    s_cbranch_execz L_h44
    s_cbranch_vccnz L_th18_2
L_tb18_2:
    buffer_load_dwordx4 v[76:79], v1, s[28:31], s71 offen offset:0 nt
    s_waitcnt vmcnt(23)
    v_pk_fma_f32 v[208:209], v[236:237], v[80:81], v[208:209] op_sel_hi:[0,1,1]
    v_pk_fma_f32 v[210:211], v[236:237], v[82:83], v[210:211] op_sel_hi:[0,1,1]
    buffer_load_dwordx4 v[80:83], v1, s[28:31], s71 offen offset:256 nt
    s_waitcnt vmcnt(23)
    v_pk_fma_f32 v[212:213], v[236:237], v[84:85], v[212:213] op_sel_hi:[0,1,1]
    v_pk_fma_f32 v[214:215], v[236:237], v[86:87], v[214:215] op_sel_hi:[0,1,1]
    s_nop 2
    ds_add_u32 v224, v243 offset:3328
    buffer_load_dwordx4 v[84:87], v1, s[28:31], s71 offen offset:512 nt
    v_mov_b32_dpp v236, v238 row_newbcast:15 row_mask:0xf bank_mask:0xf
    s_waitcnt vmcnt(23)
    v_pk_fma_f32 v[204:205], v[236:237], v[88:89], v[204:205] op_sel_hi:[0,1,1]
    v_pk_fma_f32 v[206:207], v[236:237], v[90:91], v[206:207] op_sel_hi:[0,1,1]
    s_nop 2
    s_add_u32 s71, s71, 3072
    s_cbranch_vccnz L_th21_2
L_tb21_2:
L_h44:
    s_cbranch_execz L_h45
    buffer_load_dwordx4 v[88:91], v1, s[28:31], s71 offen offset:0 nt
    ds_write_b128 v241, v[204:207] offset:20480
    v_mul_f32 v238, 0x71800000, v222
    s_waitcnt vmcnt(23)
    v_pk_fma_f32 v[208:209], v[236:237], v[92:93], v[208:209] op_sel_hi:[0,1,1]
    v_pk_fma_f32 v[210:211], v[236:237], v[94:95], v[210:211] op_sel_hi:[0,1,1]
    buffer_load_dwordx4 v[92:95], v1, s[28:31], s71 offen offset:256 nt
    ds_write_b128 v241, v[208:211] offset:21504
    v_pk_mul_f32 v[204:205], v[204:205], v[234:235] op_sel:[0,1] op_sel_hi:[1,1]
    v_pk_mul_f32 v[206:207], v[206:207], v[234:235] op_sel:[0,1] op_sel_hi:[1,1]
    s_waitcnt vmcnt(23)
    v_pk_fma_f32 v[212:213], v[236:237], v[96:97], v[212:213] op_sel_hi:[0,1,1]
    v_pk_fma_f32 v[214:215], v[236:237], v[98:99], v[214:215] op_sel_hi:[0,1,1]
    s_nop 2
    ds_add_u32 v224, v243 offset:3328
    buffer_load_dwordx4 v[96:99], v1, s[28:31], s71 offen offset:512 nt
    ds_write_b128 v241, v[212:215] offset:22528
L_h45:
    s_cbranch_execz L_h46
    v_pk_mul_f32 v[208:209], v[208:209], v[234:235] op_sel:[0,1] op_sel_hi:[1,1]
    v_pk_mul_f32 v[210:211], v[210:211], v[234:235] op_sel:[0,1] op_sel_hi:[1,1]
    s_sub_u32 s76, s76, 1
    s_cmp_lg_u32 s76, 0
    s_cbranch_scc1 L_loop1
    v_mov_b32_dpp v236, v238 row_newbcast:0 row_mask:0xf bank_mask:0xf
    s_waitcnt vmcnt(23)
    v_pk_fma_f32 v[204:205], v[236:237], v[4:5], v[204:205] op_sel_hi:[0,1,1]
    v_pk_fma_f32 v[206:207], v[236:237], v[6:7], v[206:207] op_sel_hi:[0,1,1]
    ds_read_b32 v244, v243 offset:147
    s_add_u32 s71, s71, 384000
    s_cbranch_vccnz L_th24_3
L_tb24_3:
    buffer_load_dwordx4 v[4:7], v1, s[28:31], s71 offen offset:0 nt
    s_bitcmp0_b32 s4, 0
    s_cbranch_scc1 L_nofl3
    s_mov_b64 exec, 1
    ds_add_u32 v242, v243
    s_mov_b64 exec, -1
    v_add_u32 v241, 4096, v241
    v_add_u32 v242, 4, v242
L_nofl3:
    s_waitcnt vmcnt(23)
L_h46:
    s_cbranch_execz L_h47
    v_pk_fma_f32 v[208:209], v[236:237], v[8:9], v[208:209] op_sel_hi:[0,1,1]
    v_pk_fma_f32 v[210:211], v[236:237], v[10:11], v[210:211] op_sel_hi:[0,1,1]
    buffer_load_dwordx4 v[8:11], v1, s[28:31], s71 offen offset:256 nt
    v_pk_mul_f32 v[212:213], v[212:213], v[234:235] op_sel:[0,1] op_sel_hi:[1,1]
    v_pk_mul_f32 v[214:215], v[214:215], v[234:235] op_sel:[0,1] op_sel_hi:[1,1]
    v_mov_b32 v216, v234
    s_waitcnt vmcnt(23)
    v_pk_fma_f32 v[212:213], v[236:237], v[12:13], v[212:213] op_sel_hi:[0,1,1]
    v_pk_fma_f32 v[214:215], v[236:237], v[14:15], v[214:215] op_sel_hi:[0,1,1]
    s_nop 2
    s_waitcnt lgkmcnt(0)
    v_cmp_lt_u32 vcc, v0, v244
    ds_add_u32 v224, v243 offset:3328
    buffer_load_dwordx4 v[12:15], v1, s[28:31], s71 offen offset:512 nt
    v_fma_f32 v217, v217, v235, v229
    v_mov_b32_dpp v236, v238 row_newbcast:8 row_mask:0xf bank_mask:0xf
    s_waitcnt vmcnt(23)
    v_pk_fma_f32 v[204:205], v[236:237], v[16:17], v[204:205] op_sel_hi:[0,1,1]
    v_pk_fma_f32 v[206:207], v[236:237], v[18:19], v[206:207] op_sel_hi:[0,1,1]
L_h47:
    s_cbranch_execz L_h48
    s_add_u32 s71, s71, 3072
    s_cbranch_vccnz L_th27_3
L_tb27_3:
    buffer_load_dwordx4 v[16:19], v1, s[28:31], s71 offen offset:0 nt
    v_fma_f32 v218, v218, v235, v230
    s_waitcnt vmcnt(23)
    v_pk_fma_f32 v[208:209], v[236:237], v[20:21], v[208:209] op_sel_hi:[0,1,1]
    v_pk_fma_f32 v[210:211], v[236:237], v[22:23], v[210:211] op_sel_hi:[0,1,1]
    s_nop 2
    buffer_load_dwordx4 v[20:23], v1, s[28:31], s71 offen offset:256 nt
    s_mov_b64 exec, s[88:89]
    buffer_store_dwordx4 v[100:103], v225, s[52:55], s78 offen offset:0
    s_mov_b64 exec, -1
    s_waitcnt vmcnt(23)
    v_pk_fma_f32 v[212:213], v[236:237], v[24:25], v[212:213] op_sel_hi:[0,1,1]
    v_pk_fma_f32 v[214:215], v[236:237], v[26:27], v[214:215] op_sel_hi:[0,1,1]
    s_nop 2
    ds_add_u32 v224, v243 offset:3328
    buffer_load_dwordx4 v[24:27], v1, s[28:31], s71 offen offset:512 nt
    v_add_f32_dpp v218, v218, v218 row_ror:8 row_mask:0xf bank_mask:0xf
L_h48:
    s_cbranch_execz L_h49
    v_mov_b32_dpp v236, v238 row_newbcast:4 row_mask:0xf bank_mask:0xf
    s_waitcnt vmcnt(23)
    v_pk_fma_f32 v[204:205], v[236:237], v[28:29], v[204:205] op_sel_hi:[0,1,1]
    v_pk_fma_f32 v[206:207], v[236:237], v[30:31], v[206:207] op_sel_hi:[0,1,1]
    s_add_u32 s71, s71, 3072
    s_cbranch_vccnz L_th30_3
L_tb30_3:
    buffer_load_dwordx4 v[28:31], v1, s[28:31], s71 offen offset:0 nt
    v_add_f32_dpp v218, v218, v218 row_ror:4 row_mask:0xf bank_mask:0xf
    s_waitcnt vmcnt(23)
    v_pk_fma_f32 v[208:209], v[236:237], v[32:33], v[208:209] op_sel_hi:[0,1,1]
    v_pk_fma_f32 v[210:211], v[236:237], v[34:35], v[210:211] op_sel_hi:[0,1,1]
    s_nop 2
    buffer_load_dwordx4 v[32:35], v1, s[28:31], s71 offen offset:256 nt
    v_add_f32_dpp v218, v218, v218 row_ror:2 row_mask:0xf bank_mask:0xf
    s_waitcnt vmcnt(23)
    v_pk_fma_f32 v[212:213], v[236:237], v[36:37], v[212:213] op_sel_hi:[0,1,1]
    v_pk_fma_f32 v[214:215], v[236:237], v[38:39], v[214:215] op_sel_hi:[0,1,1]
    s_nop 2
L_h49:
    s_cbranch_execz L_h50
    ds_add_u32 v224, v243 offset:3328
    buffer_load_dwordx4 v[36:39], v1, s[28:31], s71 offen offset:512 nt
    v_add_f32_dpp v218, v218, v218 row_ror:1 row_mask:0xf bank_mask:0xf
    v_mov_b32_dpp v236, v238 row_newbcast:12 row_mask:0xf bank_mask:0xf
    s_waitcnt vmcnt(23)
    v_pk_fma_f32 v[204:205], v[236:237], v[40:41], v[204:205] op_sel_hi:[0,1,1]
    v_pk_fma_f32 v[206:207], v[236:237], v[42:43], v[206:207] op_sel_hi:[0,1,1]
    s_add_u32 s71, s71, 3072
    s_cbranch_vccnz L_th33_3
L_tb33_3:
    buffer_load_dwordx4 v[40:43], v1, s[28:31], s71 offen offset:0 nt
    v_mov_b32 v234, v218
    s_waitcnt vmcnt(23)
    v_pk_fma_f32 v[208:209], v[236:237], v[44:45], v[208:209] op_sel_hi:[0,1,1]
    v_pk_fma_f32 v[210:211], v[236:237], v[46:47], v[210:211] op_sel_hi:[0,1,1]
    s_nop 2
    buffer_load_dwordx4 v[44:47], v1, s[28:31], s71 offen offset:256 nt
    v_permlane32_swap_b32 v218, v234
    s_waitcnt vmcnt(23)
    v_pk_fma_f32 v[212:213], v[236:237], v[48:49], v[212:213] op_sel_hi:[0,1,1]
L_h50:
    s_cbranch_execz L_h51
    v_pk_fma_f32 v[214:215], v[236:237], v[50:51], v[214:215] op_sel_hi:[0,1,1]
    ds_add_u32 v224, v243 offset:3328
    buffer_load_dwordx4 v[48:51], v1, s[28:31], s71 offen offset:512 nt
    v_add_f32 v218, v218, v234
    v_mov_b32_dpp v236, v238 row_newbcast:2 row_mask:0xf bank_mask:0xf
    s_waitcnt vmcnt(23)
    v_pk_fma_f32 v[204:205], v[236:237], v[52:53], v[204:205] op_sel_hi:[0,1,1]
    v_pk_fma_f32 v[206:207], v[236:237], v[54:55], v[206:207] op_sel_hi:[0,1,1]
    s_nop 2
    ds_read_b32 v244, v243 offset:147
    s_add_u32 s71, s71, 384000
    s_cbranch_vccnz L_th36_3
L_tb36_3:
    buffer_load_dwordx4 v[52:55], v1, s[28:31], s71 offen offset:0 nt
    v_mov_b32 v234, v218
    s_waitcnt vmcnt(23)
    v_pk_fma_f32 v[208:209], v[236:237], v[56:57], v[208:209] op_sel_hi:[0,1,1]
    v_pk_fma_f32 v[210:211], v[236:237], v[58:59], v[210:211] op_sel_hi:[0,1,1]
    s_nop 2
    buffer_load_dwordx4 v[56:59], v1, s[28:31], s71 offen offset:256 nt
L_h51:
    s_cbranch_execz L_h52
    v_permlane16_swap_b32 v218, v234
    s_waitcnt vmcnt(23)
    v_pk_fma_f32 v[212:213], v[236:237], v[60:61], v[212:213] op_sel_hi:[0,1,1]
    v_pk_fma_f32 v[214:215], v[236:237], v[62:63], v[214:215] op_sel_hi:[0,1,1]
    s_waitcnt lgkmcnt(0)
    v_cmp_lt_u32 vcc, v0, v244
    ds_add_u32 v224, v243 offset:3328
    buffer_load_dwordx4 v[60:63], v1, s[28:31], s71 offen offset:512 nt
    v_add_f32 v218, v218, v234
    v_mov_b32_dpp v236, v238 row_newbcast:10 row_mask:0xf bank_mask:0xf
    s_waitcnt vmcnt(23)
    v_pk_fma_f32 v[204:205], v[236:237], v[64:65], v[204:205] op_sel_hi:[0,1,1]
    v_pk_fma_f32 v[206:207], v[236:237], v[66:67], v[206:207] op_sel_hi:[0,1,1]
    s_nop 2
    s_add_u32 s71, s71, 3072
    s_cbranch_vccnz L_th39_3
L_tb39_3:
    buffer_load_dwordx4 v[64:67], v1, s[28:31], s71 offen offset:0 nt
    v_mov_b32 v103, s93
    v_lshlrev_b32 v235, 4, v0
    s_lshl_b32 s78, s3, 11
    s_mov_b32 s6, 0x58000000
L_h52:
    s_cbranch_execz L_h53
    s_waitcnt vmcnt(23)
    v_pk_fma_f32 v[208:209], v[236:237], v[68:69], v[208:209] op_sel_hi:[0,1,1]
    v_pk_fma_f32 v[210:211], v[236:237], v[70:71], v[210:211] op_sel_hi:[0,1,1]
    buffer_load_dwordx4 v[68:71], v1, s[28:31], s71 offen offset:256 nt
    s_waitcnt vmcnt(23)
    v_pk_fma_f32 v[212:213], v[236:237], v[72:73], v[212:213] op_sel_hi:[0,1,1]
    v_pk_fma_f32 v[214:215], v[236:237], v[74:75], v[214:215] op_sel_hi:[0,1,1]
    s_nop 2
    ds_add_u32 v224, v243 offset:3328
    buffer_load_dwordx4 v[72:75], v1, s[28:31], s71 offen offset:512 nt
    v_mov_b32_dpp v236, v238 row_newbcast:6 row_mask:0xf bank_mask:0xf
    s_waitcnt vmcnt(23)
    v_pk_fma_f32 v[204:205], v[236:237], v[76:77], v[204:205] op_sel_hi:[0,1,1]
    v_pk_fma_f32 v[206:207], v[236:237], v[78:79], v[206:207] op_sel_hi:[0,1,1]
    s_nop 2
    s_add_u32 s71, s71, 3072
    s_cbranch_vccnz L_th42_3
L_tb42_3:
    buffer_load_dwordx4 v[76:79], v1, s[28:31], s71 offen offset:0 nt
    s_waitcnt vmcnt(23)
L_h53:
    s_cbranch_execz L_h54
    v_pk_fma_f32 v[208:209], v[236:237], v[80:81], v[208:209] op_sel_hi:[0,1,1]
    v_pk_fma_f32 v[210:211], v[236:237], v[82:83], v[210:211] op_sel_hi:[0,1,1]
    buffer_load_dwordx4 v[80:83], v1, s[28:31], s71 offen offset:256 nt
    s_waitcnt vmcnt(23)
    v_pk_fma_f32 v[212:213], v[236:237], v[84:85], v[212:213] op_sel_hi:[0,1,1]
    v_pk_fma_f32 v[214:215], v[236:237], v[86:87], v[214:215] op_sel_hi:[0,1,1]
    s_nop 2
    ds_add_u32 v224, v243 offset:3328
    buffer_load_dwordx4 v[84:87], v1, s[28:31], s71 offen offset:512 nt
    v_mov_b32_dpp v236, v238 row_newbcast:14 row_mask:0xf bank_mask:0xf
    s_waitcnt vmcnt(23)
    v_pk_fma_f32 v[204:205], v[236:237], v[88:89], v[204:205] op_sel_hi:[0,1,1]
    v_pk_fma_f32 v[206:207], v[236:237], v[90:91], v[206:207] op_sel_hi:[0,1,1]
    s_nop 2
    s_add_u32 s71, s71, 3072
    s_cbranch_vccnz L_th45_3
L_tb45_3:
    buffer_load_dwordx4 v[88:91], v1, s[28:31], s71 offen offset:0 nt
    s_waitcnt vmcnt(23)
    v_pk_fma_f32 v[208:209], v[236:237], v[92:93], v[208:209] op_sel_hi:[0,1,1]
L_h54:
    s_cbranch_execz L_h55
    v_pk_fma_f32 v[210:211], v[236:237], v[94:95], v[210:211] op_sel_hi:[0,1,1]
    buffer_load_dwordx4 v[92:95], v1, s[28:31], s71 offen offset:256 nt
    s_waitcnt vmcnt(23)
    v_pk_fma_f32 v[212:213], v[236:237], v[96:97], v[212:213] op_sel_hi:[0,1,1]
    v_pk_fma_f32 v[214:215], v[236:237], v[98:99], v[214:215] op_sel_hi:[0,1,1]
    s_nop 2
    ds_add_u32 v224, v243 offset:3328
    buffer_load_dwordx4 v[96:99], v1, s[28:31], s71 offen offset:512 nt
    ds_write_b32 v243, v243 offset:143
    v_mov_b32_dpp v236, v238 row_newbcast:1 row_mask:0xf bank_mask:0xf
    s_waitcnt vmcnt(23)
    v_pk_fma_f32 v[204:205], v[236:237], v[4:5], v[204:205] op_sel_hi:[0,1,1]
    v_pk_fma_f32 v[206:207], v[236:237], v[6:7], v[206:207] op_sel_hi:[0,1,1]
    s_waitcnt vmcnt(22)
    v_pk_fma_f32 v[208:209], v[236:237], v[8:9], v[208:209] op_sel_hi:[0,1,1]
    v_pk_fma_f32 v[210:211], v[236:237], v[10:11], v[210:211] op_sel_hi:[0,1,1]
    s_waitcnt vmcnt(21)
    v_pk_fma_f32 v[212:213], v[236:237], v[12:13], v[212:213] op_sel_hi:[0,1,1]
L_h55:
    s_cbranch_execz L_h56
    v_pk_fma_f32 v[214:215], v[236:237], v[14:15], v[214:215] op_sel_hi:[0,1,1]
    v_mov_b32_dpp v236, v238 row_newbcast:9 row_mask:0xf bank_mask:0xf
    s_waitcnt vmcnt(20)
    v_pk_fma_f32 v[204:205], v[236:237], v[16:17], v[204:205] op_sel_hi:[0,1,1]
    v_pk_fma_f32 v[206:207], v[236:237], v[18:19], v[206:207] op_sel_hi:[0,1,1]
    s_waitcnt vmcnt(19)
    v_pk_fma_f32 v[208:209], v[236:237], v[20:21], v[208:209] op_sel_hi:[0,1,1]
    v_pk_fma_f32 v[210:211], v[236:237], v[22:23], v[210:211] op_sel_hi:[0,1,1]
    s_waitcnt vmcnt(18)
    v_pk_fma_f32 v[212:213], v[236:237], v[24:25], v[212:213] op_sel_hi:[0,1,1]
    v_pk_fma_f32 v[214:215], v[236:237], v[26:27], v[214:215] op_sel_hi:[0,1,1]
    v_mov_b32_dpp v236, v238 row_newbcast:5 row_mask:0xf bank_mask:0xf
    s_waitcnt vmcnt(17)
    v_pk_fma_f32 v[204:205], v[236:237], v[28:29], v[204:205] op_sel_hi:[0,1,1]
    v_pk_fma_f32 v[206:207], v[236:237], v[30:31], v[206:207] op_sel_hi:[0,1,1]
    s_waitcnt vmcnt(16)
    v_pk_fma_f32 v[208:209], v[236:237], v[32:33], v[208:209] op_sel_hi:[0,1,1]
    v_pk_fma_f32 v[210:211], v[236:237], v[34:35], v[210:211] op_sel_hi:[0,1,1]
L_h56:
    s_cbranch_execz L_h57
    s_waitcnt vmcnt(15)
    v_pk_fma_f32 v[212:213], v[236:237], v[36:37], v[212:213] op_sel_hi:[0,1,1]
    v_pk_fma_f32 v[214:215], v[236:237], v[38:39], v[214:215] op_sel_hi:[0,1,1]
    v_mov_b32_dpp v236, v238 row_newbcast:13 row_mask:0xf bank_mask:0xf
    s_waitcnt vmcnt(14)
    v_pk_fma_f32 v[204:205], v[236:237], v[40:41], v[204:205] op_sel_hi:[0,1,1]
    v_pk_fma_f32 v[206:207], v[236:237], v[42:43], v[206:207] op_sel_hi:[0,1,1]
    s_waitcnt vmcnt(13)
    v_pk_fma_f32 v[208:209], v[236:237], v[44:45], v[208:209] op_sel_hi:[0,1,1]
    v_pk_fma_f32 v[210:211], v[236:237], v[46:47], v[210:211] op_sel_hi:[0,1,1]
    s_waitcnt vmcnt(12)
    v_pk_fma_f32 v[212:213], v[236:237], v[48:49], v[212:213] op_sel_hi:[0,1,1]
    v_pk_fma_f32 v[214:215], v[236:237], v[50:51], v[214:215] op_sel_hi:[0,1,1]
    v_mov_b32_dpp v236, v238 row_newbcast:3 row_mask:0xf bank_mask:0xf
    s_waitcnt vmcnt(11)
    v_pk_fma_f32 v[204:205], v[236:237], v[52:53], v[204:205] op_sel_hi:[0,1,1]
    v_pk_fma_f32 v[206:207], v[236:237], v[54:55], v[206:207] op_sel_hi:[0,1,1]
    s_waitcnt vmcnt(10)
L_h57:
    s_cbranch_execz L_h58
    v_pk_fma_f32 v[208:209], v[236:237], v[56:57], v[208:209] op_sel_hi:[0,1,1]
    v_pk_fma_f32 v[210:211], v[236:237], v[58:59], v[210:211] op_sel_hi:[0,1,1]
    s_waitcnt vmcnt(9)
    v_pk_fma_f32 v[212:213], v[236:237], v[60:61], v[212:213] op_sel_hi:[0,1,1]
    v_pk_fma_f32 v[214:215], v[236:237], v[62:63], v[214:215] op_sel_hi:[0,1,1]
    v_mov_b32_dpp v236, v238 row_newbcast:11 row_mask:0xf bank_mask:0xf
    s_waitcnt vmcnt(8)
    v_pk_fma_f32 v[204:205], v[236:237], v[64:65], v[204:205] op_sel_hi:[0,1,1]
    v_pk_fma_f32 v[206:207], v[236:237], v[66:67], v[206:207] op_sel_hi:[0,1,1]
    s_waitcnt vmcnt(7)
    v_pk_fma_f32 v[208:209], v[236:237], v[68:69], v[208:209] op_sel_hi:[0,1,1]
    v_pk_fma_f32 v[210:211], v[236:237], v[70:71], v[210:211] op_sel_hi:[0,1,1]
    s_waitcnt vmcnt(6)
    v_pk_fma_f32 v[212:213], v[236:237], v[72:73], v[212:213] op_sel_hi:[0,1,1]
    v_pk_fma_f32 v[214:215], v[236:237], v[74:75], v[214:215] op_sel_hi:[0,1,1]
    v_mov_b32_dpp v236, v238 row_newbcast:7 row_mask:0xf bank_mask:0xf
    s_waitcnt vmcnt(5)
    v_pk_fma_f32 v[204:205], v[236:237], v[76:77], v[204:205] op_sel_hi:[0,1,1]
L_h58:
    s_cbranch_execz L_h59
    v_pk_fma_f32 v[206:207], v[236:237], v[78:79], v[206:207] op_sel_hi:[0,1,1]
    s_waitcnt vmcnt(4)
    v_pk_fma_f32 v[208:209], v[236:237], v[80:81], v[208:209] op_sel_hi:[0,1,1]
    v_pk_fma_f32 v[210:211], v[236:237], v[82:83], v[210:211] op_sel_hi:[0,1,1]
    s_waitcnt vmcnt(3)
    v_pk_fma_f32 v[212:213], v[236:237], v[84:85], v[212:213] op_sel_hi:[0,1,1]
    v_pk_fma_f32 v[214:215], v[236:237], v[86:87], v[214:215] op_sel_hi:[0,1,1]
    v_mov_b32_dpp v236, v238 row_newbcast:15 row_mask:0xf bank_mask:0xf
    s_waitcnt vmcnt(2)
    v_pk_fma_f32 v[204:205], v[236:237], v[88:89], v[204:205] op_sel_hi:[0,1,1]
    v_pk_fma_f32 v[206:207], v[236:237], v[90:91], v[206:207] op_sel_hi:[0,1,1]
    s_waitcnt vmcnt(1)
    v_pk_fma_f32 v[208:209], v[236:237], v[92:93], v[208:209] op_sel_hi:[0,1,1]
    v_pk_fma_f32 v[210:211], v[236:237], v[94:95], v[210:211] op_sel_hi:[0,1,1]
    v_permlane32_swap_b32 v204, v206
    v_permlane32_swap_b32 v205, v207
    v_add_f32 v204, v204, v206
    v_add_f32 v205, v205, v207
    v_permlane32_swap_b32 v208, v210
    v_permlane32_swap_b32 v209, v211
    v_add_f32 v208, v208, v210
L_h59:
    s_cbranch_execz L_h60
    v_add_f32 v209, v209, v211
    v_permlane16_swap_b32 v204, v205
    v_add_f32 v204, v204, v205
    v_fma_f32 v100, v204, s6, -v218
    v_permlane16_swap_b32 v208, v209
    v_add_f32 v208, v208, v209
    v_fma_f32 v101, v208, s6, -v218
    s_waitcnt vmcnt(0)
    v_pk_fma_f32 v[212:213], v[236:237], v[96:97], v[212:213] op_sel_hi:[0,1,1]
    v_pk_fma_f32 v[214:215], v[236:237], v[98:99], v[214:215] op_sel_hi:[0,1,1]
    s_nop 1
    v_permlane32_swap_b32 v212, v214
    v_permlane32_swap_b32 v213, v215
    v_add_f32 v212, v212, v214
    v_add_f32 v213, v213, v215
    s_nop 1
    v_permlane16_swap_b32 v212, v213
    v_add_f32 v212, v212, v213
    v_fma_f32 v102, v212, s6, -v218
    s_mov_b64 exec, s[88:89]
    buffer_store_dwordx4 v[100:103], v225, s[52:55], s78 offen offset:0
    s_not_b64 exec, exec
    buffer_store_dwordx4 v[100:103], v225, s[52:55], s78 offen offset:0 sc0 sc1
    s_mov_b64 exec, -1
L_final:
L_h60:
    s_cbranch_execz L_h61
    s_endpgm
L_th24_0:
    s_waitcnt vmcnt(33)
    s_bitcmp0_b32 vcc_lo, 2
    s_cbranch_scc1 L_tb24_0
    s_bitcmp0_b32 vcc_lo, 19
    s_cbranch_scc1 L_tb24_0
    s_waitcnt vmcnt(23)
    s_branch L_tb24_0
L_th27_0:
    s_waitcnt vmcnt(27)
    s_bitcmp0_b32 vcc_lo, 10
    s_cbranch_scc1 L_tb27_0
    s_bitcmp0_b32 vcc_lo, 19
    s_cbranch_scc1 L_tb27_0
    s_waitcnt vmcnt(23)
    s_branch L_tb27_0
L_th30_0:
    s_waitcnt vmcnt(33)
    s_bitcmp0_b32 vcc_lo, 6
    s_cbranch_scc1 L_tb30_0
    s_bitcmp0_b32 vcc_lo, 19
    s_cbranch_scc1 L_tb30_0
    s_waitcnt vmcnt(29)
    s_branch L_tb30_0
L_th33_0:
    s_waitcnt vmcnt(33)
    s_bitcmp0_b32 vcc_lo, 14
    s_cbranch_scc1 L_tb33_0
    s_bitcmp0_b32 vcc_lo, 19
    s_cbranch_scc1 L_tb33_0
    s_waitcnt vmcnt(29)
    s_branch L_tb33_0
L_th36_0:
    s_waitcnt vmcnt(36)
    s_bitcmp0_b32 vcc_lo, 4
L_h61:
    s_cbranch_execz L_h62
    s_cbranch_scc1 L_tb36_0
    s_bitcmp0_b32 vcc_lo, 19
    s_cbranch_scc1 L_tb36_0
    s_waitcnt vmcnt(26)
    s_branch L_tb36_0
L_th39_0:
    s_waitcnt vmcnt(30)
    s_bitcmp0_b32 vcc_lo, 12
    s_cbranch_scc1 L_tb39_0
    s_bitcmp0_b32 vcc_lo, 19
    s_cbranch_scc1 L_tb39_0
    s_waitcnt vmcnt(26)
    s_branch L_tb39_0
L_th42_0:
    s_waitcnt vmcnt(36)
    s_bitcmp0_b32 vcc_lo, 8
    s_cbranch_scc1 L_tb42_0
    s_bitcmp0_b32 vcc_lo, 19
    s_cbranch_scc1 L_tb42_0
    s_waitcnt vmcnt(32)
    s_branch L_tb42_0
L_th45_0:
    s_waitcnt vmcnt(36)
    s_bitcmp0_b32 vcc_lo, 16
    s_cbranch_scc1 L_tb45_0
    s_bitcmp0_b32 vcc_lo, 19
    s_cbranch_scc1 L_tb45_0
    s_waitcnt vmcnt(32)
    s_branch L_tb45_0
L_th0_0:
    s_waitcnt vmcnt(36)
    s_bitcmp0_b32 vcc_lo, 1
    s_cbranch_scc1 L_tb0_0
    s_bitcmp0_b32 vcc_lo, 19
    s_cbranch_scc1 L_tb0_0
L_h62:
    s_cbranch_execz L_h63
    s_waitcnt vmcnt(26)
    s_branch L_tb0_0
L_th3_0:
    s_waitcnt vmcnt(30)
    s_bitcmp0_b32 vcc_lo, 9
    s_cbranch_scc1 L_tb3_0
    s_bitcmp0_b32 vcc_lo, 19
    s_cbranch_scc1 L_tb3_0
    s_waitcnt vmcnt(26)
    s_branch L_tb3_0
L_th6_0:
    s_waitcnt vmcnt(36)
    s_bitcmp0_b32 vcc_lo, 5
    s_cbranch_scc1 L_tb6_0
    s_bitcmp0_b32 vcc_lo, 19
    s_cbranch_scc1 L_tb6_0
    s_waitcnt vmcnt(29)
    s_branch L_tb6_0
L_th9_0:
    s_waitcnt vmcnt(36)
    s_bitcmp0_b32 vcc_lo, 13
    s_cbranch_scc1 L_tb9_0
    s_bitcmp0_b32 vcc_lo, 19
    s_cbranch_scc1 L_tb9_0
    s_waitcnt vmcnt(29)
    s_branch L_tb9_0
L_th12_0:
    s_waitcnt vmcnt(33)
    s_bitcmp0_b32 vcc_lo, 3
    s_cbranch_scc1 L_tb12_0
    s_bitcmp0_b32 vcc_lo, 19
    s_cbranch_scc1 L_tb12_0
    s_waitcnt vmcnt(23)
    s_branch L_tb12_0
L_th15_0:
    s_waitcnt vmcnt(27)
L_h63:
    s_cbranch_execz L_h64
    s_bitcmp0_b32 vcc_lo, 11
    s_cbranch_scc1 L_tb15_0
    s_bitcmp0_b32 vcc_lo, 19
    s_cbranch_scc1 L_tb15_0
    s_waitcnt vmcnt(23)
    s_branch L_tb15_0
L_th18_0:
    s_waitcnt vmcnt(33)
    s_bitcmp0_b32 vcc_lo, 7
    s_cbranch_scc1 L_tb18_0
    s_bitcmp0_b32 vcc_lo, 19
    s_cbranch_scc1 L_tb18_0
    s_waitcnt vmcnt(29)
    s_branch L_tb18_0
L_th21_0:
    s_waitcnt vmcnt(33)
    s_bitcmp0_b32 vcc_lo, 15
    s_cbranch_scc1 L_tb21_0
    s_bitcmp0_b32 vcc_lo, 19
    s_cbranch_scc1 L_tb21_0
    s_waitcnt vmcnt(29)
    s_branch L_tb21_0
L_th24_1:
    s_waitcnt vmcnt(33)
    s_bitcmp0_b32 vcc_lo, 2
    s_cbranch_scc1 L_tb24_1
    s_bitcmp0_b32 vcc_lo, 19
    s_cbranch_scc1 L_tb24_1
    s_waitcnt vmcnt(23)
    s_branch L_tb24_1
L_th27_1:
    s_waitcnt vmcnt(27)
    s_bitcmp0_b32 vcc_lo, 10
    s_cbranch_scc1 L_tb27_1
    s_bitcmp0_b32 vcc_lo, 19
L_h64:
    s_cbranch_execz L_h65
    s_cbranch_scc1 L_tb27_1
    s_waitcnt vmcnt(23)
    s_branch L_tb27_1
L_th30_1:
    s_waitcnt vmcnt(33)
    s_bitcmp0_b32 vcc_lo, 6
    s_cbranch_scc1 L_tb30_1
    s_bitcmp0_b32 vcc_lo, 19
    s_cbranch_scc1 L_tb30_1
    s_waitcnt vmcnt(29)
    s_branch L_tb30_1
L_th33_1:
    s_waitcnt vmcnt(33)
    s_bitcmp0_b32 vcc_lo, 14
    s_cbranch_scc1 L_tb33_1
    s_bitcmp0_b32 vcc_lo, 19
    s_cbranch_scc1 L_tb33_1
    s_waitcnt vmcnt(29)
    s_branch L_tb33_1
L_th36_1:
    s_waitcnt vmcnt(35)
    s_bitcmp0_b32 vcc_lo, 4
    s_cbranch_scc1 L_tb36_1
    s_bitcmp0_b32 vcc_lo, 19
    s_cbranch_scc1 L_tb36_1
    s_waitcnt vmcnt(25)
    s_branch L_tb36_1
L_th39_1:
    s_waitcnt vmcnt(29)
    s_bitcmp0_b32 vcc_lo, 12
    s_cbranch_scc1 L_tb39_1
    s_bitcmp0_b32 vcc_lo, 19
    s_cbranch_scc1 L_tb39_1
    s_waitcnt vmcnt(25)
    s_branch L_tb39_1
L_h65:
    s_branch L_h66
L_th42_1:
    s_waitcnt vmcnt(29)
    s_bitcmp0_b32 vcc_lo, 8
    s_cbranch_scc1 L_tb42_1
    s_bitcmp0_b32 vcc_lo, 19
    s_cbranch_scc1 L_tb42_1
    s_waitcnt vmcnt(25)
    s_branch L_tb42_1
L_th45_1:
    s_waitcnt vmcnt(29)
    s_bitcmp0_b32 vcc_lo, 16
    s_cbranch_scc1 L_tb45_1
    s_bitcmp0_b32 vcc_lo, 19
    s_cbranch_scc1 L_tb45_1
    s_waitcnt vmcnt(25)
    s_branch L_tb45_1
L_th0_1:
    s_waitcnt vmcnt(29)
    s_bitcmp0_b32 vcc_lo, 1
    s_cbranch_scc1 L_tb0_1
    s_bitcmp0_b32 vcc_lo, 19
    s_cbranch_scc1 L_tb0_1
    s_waitcnt vmcnt(19)
    s_branch L_tb0_1
L_th3_1:
    s_waitcnt vmcnt(23)
    s_bitcmp0_b32 vcc_lo, 9
    s_cbranch_scc1 L_tb3_1
    s_bitcmp0_b32 vcc_lo, 19
    s_cbranch_scc1 L_tb3_1
    s_waitcnt vmcnt(19)
    s_branch L_tb3_1
L_th6_1:
    s_waitcnt vmcnt(23)
    s_bitcmp0_b32 vcc_lo, 5
    s_cbranch_scc1 L_tb6_1
L_h66:
    s_cbranch_execz L_h67
    s_bitcmp0_b32 vcc_lo, 19
    s_cbranch_scc1 L_tb6_1
    s_waitcnt vmcnt(17)
    s_branch L_tb6_1
L_th9_1:
    s_waitcnt vmcnt(23)
    s_bitcmp0_b32 vcc_lo, 13
    s_cbranch_scc1 L_tb9_1
    s_bitcmp0_b32 vcc_lo, 19
    s_cbranch_scc1 L_tb9_1
    s_waitcnt vmcnt(17)
    s_branch L_tb9_1
L_th12_1:
    s_waitcnt vmcnt(21)
    s_bitcmp0_b32 vcc_lo, 3
    s_cbranch_scc1 L_tb12_1
    s_bitcmp0_b32 vcc_lo, 19
    s_cbranch_scc1 L_tb12_1
    s_waitcnt vmcnt(17)
    s_branch L_tb12_1
L_th15_1:
    s_waitcnt vmcnt(21)
    s_bitcmp0_b32 vcc_lo, 11
    s_cbranch_scc1 L_tb15_1
    s_bitcmp0_b32 vcc_lo, 19
    s_cbranch_scc1 L_tb15_1
    s_waitcnt vmcnt(17)
    s_branch L_tb15_1
L_th18_1:
    s_waitcnt vmcnt(21)
    s_bitcmp0_b32 vcc_lo, 7
    s_cbranch_scc1 L_tb18_1
    s_bitcmp0_b32 vcc_lo, 19
    s_cbranch_scc1 L_tb18_1
    s_waitcnt vmcnt(17)
L_h67:
    s_cbranch_execz L_h68
    s_branch L_tb18_1
L_th21_1:
    s_waitcnt vmcnt(21)
    s_bitcmp0_b32 vcc_lo, 15
    s_cbranch_scc1 L_tb21_1
    s_bitcmp0_b32 vcc_lo, 19
    s_cbranch_scc1 L_tb21_1
    s_waitcnt vmcnt(17)
    s_branch L_tb21_1
L_th24_2:
    s_bitcmp1_b32 vcc_lo, 2
    s_cbranch_scc1 L_tx24_2
    s_waitcnt vmcnt(22)
    s_branch L_tb24_2
L_tx24_2:
    s_nop 7
    s_waitcnt vmcnt(22)
    s_bitcmp0_b32 vcc_lo, 19
    s_cbranch_scc1 L_tb24_2
    s_waitcnt vmcnt(17)
    s_branch L_tb24_2
L_th27_2:
    s_bitcmp1_b32 vcc_lo, 10
    s_cbranch_scc1 L_tx27_2
    s_waitcnt vmcnt(22)
    s_branch L_tb27_2
L_tx27_2:
    s_nop 7
    s_waitcnt vmcnt(22)
    s_bitcmp0_b32 vcc_lo, 19
    s_cbranch_scc1 L_tb27_2
    s_waitcnt vmcnt(17)
    s_branch L_tb27_2
L_th30_2:
    s_bitcmp1_b32 vcc_lo, 6
    s_cbranch_scc1 L_tx30_2
    s_waitcnt vmcnt(22)
L_h68:
    s_cbranch_execz L_h69
    s_branch L_tb30_2
L_tx30_2:
    s_nop 7
    s_waitcnt vmcnt(22)
    s_bitcmp0_b32 vcc_lo, 19
    s_cbranch_scc1 L_tb30_2
    s_waitcnt vmcnt(17)
    s_branch L_tb30_2
L_th33_2:
    s_bitcmp1_b32 vcc_lo, 14
    s_cbranch_scc1 L_tx33_2
    s_waitcnt vmcnt(22)
    s_branch L_tb33_2
L_tx33_2:
    s_nop 7
    s_waitcnt vmcnt(22)
    s_bitcmp0_b32 vcc_lo, 19
    s_cbranch_scc1 L_tb33_2
    s_waitcnt vmcnt(17)
    s_branch L_tb33_2
L_th36_2:
    s_bitcmp1_b32 vcc_lo, 4
    s_cbranch_scc1 L_tx36_2
    s_waitcnt vmcnt(24)
    s_branch L_tb36_2
L_tx36_2:
    s_nop 7
    s_waitcnt vmcnt(24)
    s_bitcmp0_b32 vcc_lo, 19
    s_cbranch_scc1 L_tb36_2
    s_waitcnt vmcnt(19)
    s_branch L_tb36_2
L_th39_2:
    s_bitcmp1_b32 vcc_lo, 12
    s_cbranch_scc1 L_tx39_2
    s_waitcnt vmcnt(24)
    s_branch L_tb39_2
L_h69:
    s_branch L_h70
L_tx39_2:
    s_nop 7
    s_waitcnt vmcnt(24)
    s_bitcmp0_b32 vcc_lo, 19
    s_cbranch_scc1 L_tb39_2
    s_waitcnt vmcnt(19)
    s_branch L_tb39_2
L_th42_2:
    s_bitcmp1_b32 vcc_lo, 8
    s_cbranch_scc1 L_tx42_2
    s_waitcnt vmcnt(24)
    s_branch L_tb42_2
L_tx42_2:
    s_nop 7
    s_waitcnt vmcnt(24)
    s_bitcmp0_b32 vcc_lo, 19
    s_cbranch_scc1 L_tb42_2
    s_waitcnt vmcnt(19)
    s_branch L_tb42_2
L_th45_2:
    s_bitcmp1_b32 vcc_lo, 16
    s_cbranch_scc1 L_tx45_2
    s_waitcnt vmcnt(24)
    s_branch L_tb45_2
L_tx45_2:
    s_nop 7
    s_waitcnt vmcnt(24)
    s_bitcmp0_b32 vcc_lo, 19
    s_cbranch_scc1 L_tb45_2
    s_waitcnt vmcnt(19)
    s_branch L_tb45_2
L_getm2:
    ds_read_b32 v227, v243 offset:139
    ds_read_b32 v226, v243 offset:159
    s_waitcnt lgkmcnt(0)
L_h70:
    s_cbranch_execz L_h71
    v_readfirstlane_b32 s93, v227
    v_readfirstlane_b32 s77, v226
    s_cmp_eq_u32 s93, 0
    s_cbranch_scc1 L_getm2
    ds_read_b32 v226, v243 offset:151
    s_waitcnt lgkmcnt(0)
    v_readfirstlane_b32 s88, v226
    s_cmp_eq_u32 s88, -1
    s_cselect_b64 s[88:89], -1, 0
    s_branch L_gotm2
L_th0_2:
    s_bitcmp1_b32 vcc_lo, 1
    s_cbranch_scc1 L_tx0_2
    s_waitcnt vmcnt(24)
    s_branch L_tb0_2
L_tx0_2:
    s_nop 7
    s_waitcnt vmcnt(24)
    s_bitcmp0_b32 vcc_lo, 19
    s_cbranch_scc1 L_tb0_2
    s_waitcnt vmcnt(19)
    s_branch L_tb0_2
L_th3_2:
    s_bitcmp1_b32 vcc_lo, 9
    s_cbranch_scc1 L_tx3_2
    s_waitcnt vmcnt(24)
    s_branch L_tb3_2
L_tx3_2:
    s_nop 7
    s_waitcnt vmcnt(24)
    s_bitcmp0_b32 vcc_lo, 19
    s_cbranch_scc1 L_tb3_2
    s_waitcnt vmcnt(19)
    s_branch L_tb3_2
L_h71:
    s_branch L_h72
L_th6_2:
    s_bitcmp1_b32 vcc_lo, 5
    s_cbranch_scc1 L_tx6_2
    s_waitcnt vmcnt(24)
    s_branch L_tb6_2
L_tx6_2:
    s_nop 7
    s_waitcnt vmcnt(24)
    s_bitcmp0_b32 vcc_lo, 19
    s_cbranch_scc1 L_tb6_2
    s_waitcnt vmcnt(17)
    s_branch L_tb6_2
L_th9_2:
    s_bitcmp1_b32 vcc_lo, 13
    s_cbranch_scc1 L_tx9_2
    s_waitcnt vmcnt(24)
    s_branch L_tb9_2
L_tx9_2:
    s_nop 7
    s_waitcnt vmcnt(24)
    s_bitcmp0_b32 vcc_lo, 19
    s_cbranch_scc1 L_tb9_2
    s_waitcnt vmcnt(17)
    s_branch L_tb9_2
L_th12_2:
    s_bitcmp1_b32 vcc_lo, 3
    s_cbranch_scc1 L_tx12_2
    s_waitcnt vmcnt(22)
    s_branch L_tb12_2
L_tx12_2:
    s_nop 7
    s_waitcnt vmcnt(22)
    s_bitcmp0_b32 vcc_lo, 19
    s_cbranch_scc1 L_tb12_2
    s_waitcnt vmcnt(17)
    s_branch L_tb12_2
L_th15_2:
    s_bitcmp1_b32 vcc_lo, 11
L_h72:
    s_cbranch_execz L_h73
    s_cbranch_scc1 L_tx15_2
    s_waitcnt vmcnt(22)
    s_branch L_tb15_2
L_tx15_2:
    s_nop 7
    s_waitcnt vmcnt(22)
    s_bitcmp0_b32 vcc_lo, 19
    s_cbranch_scc1 L_tb15_2
    s_waitcnt vmcnt(17)
    s_branch L_tb15_2
L_th18_2:
    s_bitcmp1_b32 vcc_lo, 7
    s_cbranch_scc1 L_tx18_2
    s_waitcnt vmcnt(22)
    s_branch L_tb18_2
L_tx18_2:
    s_nop 7
    s_waitcnt vmcnt(22)
    s_bitcmp0_b32 vcc_lo, 19
    s_cbranch_scc1 L_tb18_2
    s_waitcnt vmcnt(17)
    s_branch L_tb18_2
L_th21_2:
    s_bitcmp1_b32 vcc_lo, 15
    s_cbranch_scc1 L_tx21_2
    s_waitcnt vmcnt(22)
    s_branch L_tb21_2
L_tx21_2:
    s_nop 7
    s_waitcnt vmcnt(22)
    s_bitcmp0_b32 vcc_lo, 19
    s_cbranch_scc1 L_tb21_2
    s_waitcnt vmcnt(17)
    s_branch L_tb21_2
L_th24_3:
    s_bitcmp1_b32 vcc_lo, 2
    s_cbranch_scc1 L_tx24_3
L_h73:
    s_cbranch_execz L_h74
    s_waitcnt vmcnt(22)
    s_branch L_tb24_3
L_tx24_3:
    s_nop 7
    s_waitcnt vmcnt(22)
    s_bitcmp0_b32 vcc_lo, 19
    s_cbranch_scc1 L_tb24_3
    s_waitcnt vmcnt(17)
    s_branch L_tb24_3
L_th27_3:
    s_bitcmp1_b32 vcc_lo, 10
    s_cbranch_scc1 L_tx27_3
    s_waitcnt vmcnt(22)
    s_branch L_tb27_3
L_tx27_3:
    s_nop 7
    s_waitcnt vmcnt(22)
    s_bitcmp0_b32 vcc_lo, 19
    s_cbranch_scc1 L_tb27_3
    s_waitcnt vmcnt(17)
    s_branch L_tb27_3
L_th30_3:
    s_bitcmp1_b32 vcc_lo, 6
    s_cbranch_scc1 L_tx30_3
    s_waitcnt vmcnt(22)
    s_branch L_tb30_3
L_tx30_3:
    s_nop 7
    s_waitcnt vmcnt(22)
    s_bitcmp0_b32 vcc_lo, 19
    s_cbranch_scc1 L_tb30_3
    s_waitcnt vmcnt(17)
    s_branch L_tb30_3
L_th33_3:
    s_bitcmp1_b32 vcc_lo, 14
    s_cbranch_scc1 L_tx33_3
    s_waitcnt vmcnt(22)
L_h74:
    s_cbranch_execz L_h75
    s_branch L_tb33_3
L_tx33_3:
    s_nop 7
    s_waitcnt vmcnt(22)
    s_bitcmp0_b32 vcc_lo, 19
    s_cbranch_scc1 L_tb33_3
    s_waitcnt vmcnt(17)
    s_branch L_tb33_3
L_th36_3:
    s_bitcmp1_b32 vcc_lo, 4
    s_cbranch_scc1 L_tx36_3
    s_waitcnt vmcnt(22)
    s_branch L_tb36_3
L_tx36_3:
    s_nop 7
    s_waitcnt vmcnt(22)
    s_bitcmp0_b32 vcc_lo, 19
    s_cbranch_scc1 L_tb36_3
    s_waitcnt vmcnt(17)
    s_branch L_tb36_3
L_th39_3:
    s_bitcmp1_b32 vcc_lo, 12
    s_cbranch_scc1 L_tx39_3
    s_waitcnt vmcnt(22)
    s_branch L_tb39_3
L_tx39_3:
    s_nop 7
    s_waitcnt vmcnt(22)
    s_bitcmp0_b32 vcc_lo, 19
    s_cbranch_scc1 L_tb39_3
    s_waitcnt vmcnt(17)
    s_branch L_tb39_3
L_th42_3:
    s_bitcmp1_b32 vcc_lo, 8
    s_cbranch_scc1 L_tx42_3
    s_waitcnt vmcnt(22)
    s_branch L_tb42_3
L_h75:
    s_branch L_hopped
L_tx42_3:
    s_nop 7
    s_waitcnt vmcnt(22)
    s_bitcmp0_b32 vcc_lo, 19
    s_cbranch_scc1 L_tb42_3
    s_waitcnt vmcnt(17)
    s_branch L_tb42_3
L_th45_3:
    s_bitcmp1_b32 vcc_lo, 16
    s_cbranch_scc1 L_tx45_3
    s_waitcnt vmcnt(22)
    s_branch L_tb45_3
L_tx45_3:
    s_nop 7
    s_waitcnt vmcnt(22)
    s_bitcmp0_b32 vcc_lo, 19
    s_cbranch_scc1 L_tb45_3
    s_waitcnt vmcnt(17)
    s_branch L_tb45_3
L_service:
    v_lshlrev_b32 v5, 2, v0
    v_mov_b32 v3, 0
    ds_write_b32 v5, v3 offset:0
    v_lshlrev_b32 v1, 4, v0
    v_lshlrev_b32 v28, 11, v0
    v_mov_b32 v9, 0xf149f2ca
    v_cndmask_b32 v9, v9, v3, s[66:67]
    v_and_b32 v5, 15, v0
    v_lshrrev_b32 v6, 4, v0
    v_lshl_add_u32 v11, v5, 2, v6
    v_lshlrev_b32 v11, 1, v11
    s_getreg_b32 s72, hwreg(HW_REG_XCC_ID)
    s_and_b32 s72, s72, 15
    s_waitcnt lgkmcnt(0)
    s_barrier
    s_branch L_w0
L_walked:
    s_mov_b32 s24, s6
    s_and_b32 s25, s7, 0xffff
    s_mov_b32 s26, 805306368
    s_mov_b32 s27, 0x00020000
    s_mov_b32 s28, s8
    s_and_b32 s29, s9, 0xffff
    s_mov_b32 s30, 805306368
    s_mov_b32 s31, 0x00020000
    s_mov_b32 s32, s10
    s_and_b32 s33, s11, 0xffff
    s_mov_b32 s34, 6291456
    s_mov_b32 s35, 0x00020000
    s_mov_b32 s36, s12
    s_and_b32 s37, s13, 0xffff
    s_mov_b32 s38, 6291456
    s_mov_b32 s39, 0x00020000
    s_mov_b32 s40, s14
    s_and_b32 s41, s15, 0xffff
    s_mov_b32 s42, 2097152
    s_mov_b32 s43, 0x00020000
    s_mov_b32 s44, s16
    s_and_b32 s45, s17, 0xffff
    s_mov_b32 s46, 2097152
    s_mov_b32 s47, 0x00020000
    s_mov_b32 s48, s4
    s_and_b32 s49, s5, 0xffff
    s_mov_b32 s50, 12288
    s_mov_b32 s51, 0x00020000
    s_mov_b32 s52, s22
    s_and_b32 s53, s23, 0xffff
    s_mov_b32 s54, 25165824
    s_mov_b32 s55, 0x00020000
    s_mov_b64 exec, 0
    s_branch L_h0
L_hopped:
    s_mov_b64 exec, -1
    s_mov_b32 s52, s22
    s_and_b32 s53, s23, 0xffff
    s_mov_b32 s54, 25165824
    s_mov_b32 s55, 0x00020000
    s_mov_b32 s56, s18
    s_and_b32 s57, s19, 0xffff
    s_mov_b32 s58, 12288
    s_mov_b32 s59, 0x00020000
    s_mov_b32 s96, s79
    s_and_b32 s82, s79, 3
    s_lshl_b32 s82, s82, 4
    v_mov_b32 v10, 0
    s_mov_b32 s80, 0x2010200
    s_mov_b32 s81, 0x2030202
    s_cmp_ge_u32 s79, 4
    s_cmov_b32 s80, 0x2050204
    s_cmov_b32 s81, 0x2070206
    s_lshr_b64 s[80:81], s[80:81], s82
    v_writelane_b32 v10, s80, 0
    s_mov_b32 s80, 0x2090208
    s_mov_b32 s81, 0x20b020a
    s_cmp_ge_u32 s79, 4
    s_cmov_b32 s80, 0x20d020c
    s_cmov_b32 s81, 0x20f020e
    s_lshr_b64 s[80:81], s[80:81], s82
    v_writelane_b32 v10, s80, 1
    s_mov_b32 s80, 0x4d00150
    s_mov_b32 s81, 0x8310571
    s_cmp_ge_u32 s79, 4
    s_cmov_b32 s80, 0x57304d2
    s_cmov_b32 s81, 0x4b40174
    s_lshr_b64 s[80:81], s[80:81], s82
    v_writelane_b32 v10, s80, 2
    s_mov_b32 s80, 0x9100d5
    s_mov_b32 s81, 0x15204b6
    s_cmp_ge_u32 s79, 4
    s_cmov_b32 s80, 0x4b700b3
    s_cmov_b32 s81, 0x8d508b7
    s_lshr_b64 s[80:81], s[80:81], s82
    v_writelane_b32 v10, s80, 3
    s_mov_b32 s80, 0x4950000
    s_mov_b32 s81, 0x8b60000
    s_cmp_ge_u32 s79, 4
    s_cmov_b32 s80, 0xc96
    s_cmov_b32 s81, 0xcb70000
    s_lshr_b64 s[80:81], s[80:81], s82
    v_writelane_b32 v10, s80, 4
    s_mov_b32 s80, 0x560000
    s_mov_b32 s81, 0x0
    s_cmp_ge_u32 s79, 4
    s_cmov_b32 s80, 0x37
    s_cmov_b32 s81, 0x0
    s_lshr_b64 s[80:81], s[80:81], s82
    v_writelane_b32 v10, s80, 5
    v_and_b32 v10, 0xffff, v10
L_tag:
    ds_read_b32 v5, v3 offset:140
    ds_read_b64 v[16:17], v3 offset:152
    s_waitcnt lgkmcnt(0)
    v_readfirstlane_b32 s69, v5
    s_cmp_eq_u32 s69, 0
    s_cbranch_scc1 L_tag
    v_readfirstlane_b32 s86, v16
    v_readfirstlane_b32 s87, v17
    s_bfm_b64 s[84:85], s92, 0
    s_bcnt1_i32_b64 s70, s[86:87]
    s_and_b64 s[84:85], s[84:85], s[86:87]
    s_bcnt1_i32_b64 s71, s[84:85]
    s_mov_b32 s73, s71
L_round:
    s_min_u32 s80, s71, 63
    v_readlane_b32 s97, v10, s80
    s_lshl_b32 s80, s71, 2
    v_mov_b32 v4, s80
    s_cmp_eq_u32 s97, 0
    s_cbranch_scc1 L_last
L_poll:
    ds_read_b32 v5, v4 offset:0
    s_waitcnt lgkmcnt(0)
    v_readfirstlane_b32 s80, v5
    s_cmp_eq_u32 s80, 0
    s_cbranch_scc1 L_poll
    s_add_u32 s95, s69, s71
    s_add_u32 s95, s95, 1
    s_and_b32 s80, s71, 1
    s_lshl_b32 s80, s80, 19
    s_add_u32 s80, s80, 2097152
    s_lshl_b32 s77, s2, 11
    s_add_u32 s77, s77, s80
    s_lshl_b32 s75, s96, 16
    s_add_u32 s75, s75, s80
L_all:
    v_mov_b32 v16, s95
    s_mov_b64 exec, s[86:87]
    buffer_load_dword v16, v28, s[52:55], s75 offen offset:1024 sc0 sc1
    s_mov_b64 exec, -1
    s_waitcnt vmcnt(0)
    v_cmp_ne_u32 vcc, s95, v16
    s_cmp_lg_u64 vcc, 0
    s_cbranch_scc1 L_all
    s_mov_b32 s74, 0
    s_mov_b64 s[84:85], s[86:87]
L_merge:
    v_mov_b32 v7, 0xf149f2ca
    v_mov_b32 v8, 0
    v_mov_b32 v12, 0
    v_mov_b32 v13, 0
    v_mov_b32 v14, 0
L_chunk:
    v_mov_b32 v48, 0
    v_mov_b32 v49, 0
    v_mov_b32 v50, 0
    v_mov_b32 v51, v9
    v_mov_b32 v52, 0
    v_mov_b32 v53, 0
    v_mov_b32 v54, 0
    v_mov_b32 v55, v9
    v_mov_b32 v56, 0
    v_mov_b32 v57, 0
    v_mov_b32 v58, 0
    v_mov_b32 v59, v9
    v_mov_b32 v60, 0
    v_mov_b32 v61, 0
    v_mov_b32 v62, 0
    v_mov_b32 v63, v9
    v_mov_b32 v64, 0
    v_mov_b32 v65, 0
    v_mov_b32 v66, 0
    v_mov_b32 v67, v9
    v_mov_b32 v68, 0
    v_mov_b32 v69, 0
    v_mov_b32 v70, 0
    v_mov_b32 v71, v9
    v_mov_b32 v72, 0
    v_mov_b32 v73, 0
    v_mov_b32 v74, 0
    v_mov_b32 v75, v9
    v_mov_b32 v76, 0
    v_mov_b32 v77, 0
    v_mov_b32 v78, 0
    v_mov_b32 v79, v9
    v_mov_b32 v80, 0
    v_mov_b32 v81, 0
    v_mov_b32 v82, 0
    v_mov_b32 v83, v9
    v_mov_b32 v84, 0
    v_mov_b32 v85, 0
    v_mov_b32 v86, 0
    v_mov_b32 v87, v9
    v_mov_b32 v88, 0
    v_mov_b32 v89, 0
    v_mov_b32 v90, 0
    v_mov_b32 v91, v9
    v_mov_b32 v92, 0
    v_mov_b32 v93, 0
    v_mov_b32 v94, 0
    v_mov_b32 v95, v9
    v_mov_b32 v96, 0
    v_mov_b32 v97, 0
    v_mov_b32 v98, 0
    v_mov_b32 v99, v9
    v_mov_b32 v100, 0
    v_mov_b32 v101, 0
    v_mov_b32 v102, 0
    v_mov_b32 v103, v9
    v_mov_b32 v104, 0
    v_mov_b32 v105, 0
    v_mov_b32 v106, 0
    v_mov_b32 v107, v9
    v_mov_b32 v108, 0
    v_mov_b32 v109, 0
    v_mov_b32 v110, 0
    v_mov_b32 v111, v9
    v_mov_b32 v112, 0
    v_mov_b32 v113, 0
    v_mov_b32 v114, 0
    v_mov_b32 v115, v9
    v_mov_b32 v116, 0
    v_mov_b32 v117, 0
    v_mov_b32 v118, 0
    v_mov_b32 v119, v9
    v_mov_b32 v120, 0
    v_mov_b32 v121, 0
    v_mov_b32 v122, 0
    v_mov_b32 v123, v9
    v_mov_b32 v124, 0
    v_mov_b32 v125, 0
    v_mov_b32 v126, 0
    v_mov_b32 v127, v9
    v_mov_b32 v128, 0
    v_mov_b32 v129, 0
    v_mov_b32 v130, 0
    v_mov_b32 v131, v9
    v_mov_b32 v132, 0
    v_mov_b32 v133, 0
    v_mov_b32 v134, 0
    v_mov_b32 v135, v9
    v_mov_b32 v136, 0
    v_mov_b32 v137, 0
    v_mov_b32 v138, 0
    v_mov_b32 v139, v9
    v_mov_b32 v140, 0
    v_mov_b32 v141, 0
    v_mov_b32 v142, 0
    v_mov_b32 v143, v9
    v_mov_b32 v144, 0
    v_mov_b32 v145, 0
    v_mov_b32 v146, 0
    v_mov_b32 v147, v9
    v_mov_b32 v148, 0
    v_mov_b32 v149, 0
    v_mov_b32 v150, 0
    v_mov_b32 v151, v9
    v_mov_b32 v152, 0
    v_mov_b32 v153, 0
    v_mov_b32 v154, 0
    v_mov_b32 v155, v9
    v_mov_b32 v156, 0
    v_mov_b32 v157, 0
    v_mov_b32 v158, 0
    s_branch L_x1
L_w1:
    s_branch L_w2
L_x1:
    v_mov_b32 v159, v9
    v_mov_b32 v160, 0
    v_mov_b32 v161, 0
    v_mov_b32 v162, 0
    v_mov_b32 v163, v9
    v_mov_b32 v164, 0
    v_mov_b32 v165, 0
    v_mov_b32 v166, 0
    v_mov_b32 v167, v9
    v_mov_b32 v168, 0
    v_mov_b32 v169, 0
    v_mov_b32 v170, 0
    v_mov_b32 v171, v9
    v_mov_b32 v172, 0
    v_mov_b32 v173, 0
    v_mov_b32 v174, 0
    v_mov_b32 v175, v9
    s_ff1_i32_b64 s80, s[84:85]
    s_bitset0_b64 s[84:85], s80
    s_lshl_b32 s81, s80, 11
    s_add_u32 s81, s81, s75
    s_cmp_ge_i32 s80, 0
    s_cselect_b64 exec, -1, 0
    buffer_load_dwordx4 v[48:51], v1, s[52:55], s81 offen sc0 sc1
    s_ff1_i32_b64 s80, s[84:85]
    s_bitset0_b64 s[84:85], s80
    s_lshl_b32 s81, s80, 11
    s_add_u32 s81, s81, s75
    s_cmp_ge_i32 s80, 0
    s_cselect_b64 exec, -1, 0
    buffer_load_dwordx4 v[52:55], v1, s[52:55], s81 offen sc0 sc1
    s_ff1_i32_b64 s80, s[84:85]
    s_bitset0_b64 s[84:85], s80
    s_lshl_b32 s81, s80, 11
    s_add_u32 s81, s81, s75
    s_cmp_ge_i32 s80, 0
    s_cselect_b64 exec, -1, 0
    buffer_load_dwordx4 v[56:59], v1, s[52:55], s81 offen sc0 sc1
    s_ff1_i32_b64 s80, s[84:85]
    s_bitset0_b64 s[84:85], s80
    s_lshl_b32 s81, s80, 11
    s_add_u32 s81, s81, s75
    s_cmp_ge_i32 s80, 0
    s_cselect_b64 exec, -1, 0
    buffer_load_dwordx4 v[60:63], v1, s[52:55], s81 offen sc0 sc1
    s_ff1_i32_b64 s80, s[84:85]
    s_bitset0_b64 s[84:85], s80
    s_lshl_b32 s81, s80, 11
    s_add_u32 s81, s81, s75
    s_cmp_ge_i32 s80, 0
    s_cselect_b64 exec, -1, 0
    buffer_load_dwordx4 v[64:67], v1, s[52:55], s81 offen sc0 sc1
    s_ff1_i32_b64 s80, s[84:85]
    s_bitset0_b64 s[84:85], s80
    s_lshl_b32 s81, s80, 11
    s_add_u32 s81, s81, s75
    s_cmp_ge_i32 s80, 0
    s_cselect_b64 exec, -1, 0
    buffer_load_dwordx4 v[68:71], v1, s[52:55], s81 offen sc0 sc1
    s_ff1_i32_b64 s80, s[84:85]
    s_bitset0_b64 s[84:85], s80
    s_lshl_b32 s81, s80, 11
    s_add_u32 s81, s81, s75
    s_cmp_ge_i32 s80, 0
    s_cselect_b64 exec, -1, 0
    buffer_load_dwordx4 v[72:75], v1, s[52:55], s81 offen sc0 sc1
    s_ff1_i32_b64 s80, s[84:85]
    s_bitset0_b64 s[84:85], s80
    s_lshl_b32 s81, s80, 11
    s_add_u32 s81, s81, s75
    s_cmp_ge_i32 s80, 0
    s_cselect_b64 exec, -1, 0
    buffer_load_dwordx4 v[76:79], v1, s[52:55], s81 offen sc0 sc1
    s_ff1_i32_b64 s80, s[84:85]
    s_bitset0_b64 s[84:85], s80
    s_lshl_b32 s81, s80, 11
    s_add_u32 s81, s81, s75
    s_cmp_ge_i32 s80, 0
    s_cbranch_scc0 L_got
    s_cselect_b64 exec, -1, 0
    buffer_load_dwordx4 v[80:83], v1, s[52:55], s81 offen sc0 sc1
    s_ff1_i32_b64 s80, s[84:85]
    s_bitset0_b64 s[84:85], s80
    s_lshl_b32 s81, s80, 11
    s_add_u32 s81, s81, s75
    s_cmp_ge_i32 s80, 0
    s_cselect_b64 exec, -1, 0
    buffer_load_dwordx4 v[84:87], v1, s[52:55], s81 offen sc0 sc1
    s_ff1_i32_b64 s80, s[84:85]
    s_bitset0_b64 s[84:85], s80
    s_lshl_b32 s81, s80, 11
    s_add_u32 s81, s81, s75
    s_cmp_ge_i32 s80, 0
    s_cselect_b64 exec, -1, 0
    buffer_load_dwordx4 v[88:91], v1, s[52:55], s81 offen sc0 sc1
    s_ff1_i32_b64 s80, s[84:85]
    s_bitset0_b64 s[84:85], s80
    s_lshl_b32 s81, s80, 11
    s_add_u32 s81, s81, s75
    s_cmp_ge_i32 s80, 0
    s_cselect_b64 exec, -1, 0
    buffer_load_dwordx4 v[92:95], v1, s[52:55], s81 offen sc0 sc1
    s_ff1_i32_b64 s80, s[84:85]
    s_bitset0_b64 s[84:85], s80
    s_lshl_b32 s81, s80, 11
    s_add_u32 s81, s81, s75
    s_cmp_ge_i32 s80, 0
    s_cselect_b64 exec, -1, 0
    buffer_load_dwordx4 v[96:99], v1, s[52:55], s81 offen sc0 sc1
    s_ff1_i32_b64 s80, s[84:85]
    s_bitset0_b64 s[84:85], s80
    s_lshl_b32 s81, s80, 11
    s_add_u32 s81, s81, s75
    s_cmp_ge_i32 s80, 0
    s_cselect_b64 exec, -1, 0
    buffer_load_dwordx4 v[100:103], v1, s[52:55], s81 offen sc0 sc1
    s_ff1_i32_b64 s80, s[84:85]
    s_bitset0_b64 s[84:85], s80
    s_lshl_b32 s81, s80, 11
    s_add_u32 s81, s81, s75
    s_cmp_ge_i32 s80, 0
    s_cselect_b64 exec, -1, 0
    buffer_load_dwordx4 v[104:107], v1, s[52:55], s81 offen sc0 sc1
    s_ff1_i32_b64 s80, s[84:85]
    s_bitset0_b64 s[84:85], s80
    s_lshl_b32 s81, s80, 11
    s_add_u32 s81, s81, s75
    s_cmp_ge_i32 s80, 0
    s_cselect_b64 exec, -1, 0
    buffer_load_dwordx4 v[108:111], v1, s[52:55], s81 offen sc0 sc1
    s_ff1_i32_b64 s80, s[84:85]
    s_bitset0_b64 s[84:85], s80
    s_lshl_b32 s81, s80, 11
    s_add_u32 s81, s81, s75
    s_cmp_ge_i32 s80, 0
    s_cbranch_scc0 L_got
    s_cselect_b64 exec, -1, 0
    buffer_load_dwordx4 v[112:115], v1, s[52:55], s81 offen sc0 sc1
    s_ff1_i32_b64 s80, s[84:85]
    s_bitset0_b64 s[84:85], s80
    s_lshl_b32 s81, s80, 11
    s_add_u32 s81, s81, s75
    s_cmp_ge_i32 s80, 0
    s_cselect_b64 exec, -1, 0
    buffer_load_dwordx4 v[116:119], v1, s[52:55], s81 offen sc0 sc1
    s_ff1_i32_b64 s80, s[84:85]
    s_bitset0_b64 s[84:85], s80
    s_lshl_b32 s81, s80, 11
    s_add_u32 s81, s81, s75
    s_cmp_ge_i32 s80, 0
    s_cselect_b64 exec, -1, 0
    buffer_load_dwordx4 v[120:123], v1, s[52:55], s81 offen sc0 sc1
    s_ff1_i32_b64 s80, s[84:85]
    s_bitset0_b64 s[84:85], s80
    s_lshl_b32 s81, s80, 11
    s_add_u32 s81, s81, s75
    s_cmp_ge_i32 s80, 0
    s_cselect_b64 exec, -1, 0
    buffer_load_dwordx4 v[124:127], v1, s[52:55], s81 offen sc0 sc1
    s_ff1_i32_b64 s80, s[84:85]
    s_bitset0_b64 s[84:85], s80
    s_lshl_b32 s81, s80, 11
    s_add_u32 s81, s81, s75
    s_cmp_ge_i32 s80, 0
    s_cselect_b64 exec, -1, 0
    buffer_load_dwordx4 v[128:131], v1, s[52:55], s81 offen sc0 sc1
    s_ff1_i32_b64 s80, s[84:85]
    s_bitset0_b64 s[84:85], s80
    s_lshl_b32 s81, s80, 11
    s_add_u32 s81, s81, s75
    s_cmp_ge_i32 s80, 0
    s_cselect_b64 exec, -1, 0
    buffer_load_dwordx4 v[132:135], v1, s[52:55], s81 offen sc0 sc1
    s_ff1_i32_b64 s80, s[84:85]
    s_bitset0_b64 s[84:85], s80
    s_lshl_b32 s81, s80, 11
    s_add_u32 s81, s81, s75
    s_cmp_ge_i32 s80, 0
    s_cselect_b64 exec, -1, 0
    buffer_load_dwordx4 v[136:139], v1, s[52:55], s81 offen sc0 sc1
    s_ff1_i32_b64 s80, s[84:85]
    s_bitset0_b64 s[84:85], s80
    s_lshl_b32 s81, s80, 11
    s_add_u32 s81, s81, s75
    s_cmp_ge_i32 s80, 0
    s_cselect_b64 exec, -1, 0
    buffer_load_dwordx4 v[140:143], v1, s[52:55], s81 offen sc0 sc1
    s_ff1_i32_b64 s80, s[84:85]
    s_bitset0_b64 s[84:85], s80
    s_lshl_b32 s81, s80, 11
    s_add_u32 s81, s81, s75
    s_cmp_ge_i32 s80, 0
    s_cbranch_scc0 L_got
    s_cselect_b64 exec, -1, 0
    buffer_load_dwordx4 v[144:147], v1, s[52:55], s81 offen sc0 sc1
    s_ff1_i32_b64 s80, s[84:85]
    s_bitset0_b64 s[84:85], s80
    s_lshl_b32 s81, s80, 11
    s_add_u32 s81, s81, s75
    s_cmp_ge_i32 s80, 0
    s_cselect_b64 exec, -1, 0
    buffer_load_dwordx4 v[148:151], v1, s[52:55], s81 offen sc0 sc1
    s_ff1_i32_b64 s80, s[84:85]
    s_bitset0_b64 s[84:85], s80
    s_lshl_b32 s81, s80, 11
    s_add_u32 s81, s81, s75
    s_cmp_ge_i32 s80, 0
    s_cselect_b64 exec, -1, 0
    buffer_load_dwordx4 v[152:155], v1, s[52:55], s81 offen sc0 sc1
    s_ff1_i32_b64 s80, s[84:85]
    s_bitset0_b64 s[84:85], s80
    s_lshl_b32 s81, s80, 11
    s_add_u32 s81, s81, s75
    s_cmp_ge_i32 s80, 0
    s_cselect_b64 exec, -1, 0
    buffer_load_dwordx4 v[156:159], v1, s[52:55], s81 offen sc0 sc1
    s_ff1_i32_b64 s80, s[84:85]
    s_bitset0_b64 s[84:85], s80
    s_lshl_b32 s81, s80, 11
    s_add_u32 s81, s81, s75
    s_cmp_ge_i32 s80, 0
    s_cselect_b64 exec, -1, 0
    buffer_load_dwordx4 v[160:163], v1, s[52:55], s81 offen sc0 sc1
    s_ff1_i32_b64 s80, s[84:85]
    s_bitset0_b64 s[84:85], s80
    s_lshl_b32 s81, s80, 11
    s_add_u32 s81, s81, s75
    s_cmp_ge_i32 s80, 0
    s_cselect_b64 exec, -1, 0
    buffer_load_dwordx4 v[164:167], v1, s[52:55], s81 offen sc0 sc1
    s_ff1_i32_b64 s80, s[84:85]
    s_bitset0_b64 s[84:85], s80
    s_lshl_b32 s81, s80, 11
    s_add_u32 s81, s81, s75
    s_cmp_ge_i32 s80, 0
    s_cselect_b64 exec, -1, 0
    buffer_load_dwordx4 v[168:171], v1, s[52:55], s81 offen sc0 sc1
    s_ff1_i32_b64 s80, s[84:85]
    s_bitset0_b64 s[84:85], s80
    s_lshl_b32 s81, s80, 11
    s_add_u32 s81, s81, s75
    s_cmp_ge_i32 s80, 0
    s_cselect_b64 exec, -1, 0
    buffer_load_dwordx4 v[172:175], v1, s[52:55], s81 offen sc0 sc1
L_got:
    s_mov_b64 exec, -1
    s_waitcnt vmcnt(0)
    v_max_f32 v5, v51, v55
    v_max3_f32 v5, v5, v59, v63
    v_max3_f32 v5, v5, v67, v71
    v_max3_f32 v5, v5, v75, v79
    v_max3_f32 v5, v5, v83, v87
    v_max3_f32 v5, v5, v91, v95
    v_max3_f32 v5, v5, v99, v103
    v_max3_f32 v5, v5, v107, v111
    v_max3_f32 v5, v5, v115, v119
    v_max3_f32 v5, v5, v123, v127
    v_max3_f32 v5, v5, v131, v135
    v_max3_f32 v5, v5, v139, v143
    v_max3_f32 v5, v5, v147, v151
    v_max3_f32 v5, v5, v155, v159
    v_max3_f32 v5, v5, v163, v167
    v_max3_f32 v5, v5, v171, v175
    s_nop 1
    v_max_f32_dpp v6, v5, v7 quad_perm:[0,0,2,2] row_mask:0xf bank_mask:0xf
    v_sub_f32 v5, v7, v6
    v_exp_f32 v5, v5
    v_mov_b32 v7, v6
    v_mul_f32 v8, v8, v5
    v_mul_f32 v12, v12, v5
    v_mul_f32 v13, v13, v5
    v_mul_f32 v14, v14, v5
    v_sub_f32_dpp v20, v51, v6 quad_perm:[0,0,2,2] row_mask:0xf bank_mask:0xf
    v_sub_f32_dpp v21, v55, v6 quad_perm:[0,0,2,2] row_mask:0xf bank_mask:0xf
    v_sub_f32_dpp v22, v59, v6 quad_perm:[0,0,2,2] row_mask:0xf bank_mask:0xf
    v_sub_f32_dpp v23, v63, v6 quad_perm:[0,0,2,2] row_mask:0xf bank_mask:0xf
    v_sub_f32_dpp v24, v67, v6 quad_perm:[0,0,2,2] row_mask:0xf bank_mask:0xf
    v_sub_f32_dpp v25, v71, v6 quad_perm:[0,0,2,2] row_mask:0xf bank_mask:0xf
    v_sub_f32_dpp v26, v75, v6 quad_perm:[0,0,2,2] row_mask:0xf bank_mask:0xf
    v_sub_f32_dpp v27, v79, v6 quad_perm:[0,0,2,2] row_mask:0xf bank_mask:0xf
    v_exp_f32 v20, v20
    v_exp_f32 v21, v21
    v_exp_f32 v22, v22
    v_exp_f32 v23, v23
    v_exp_f32 v24, v24
    v_exp_f32 v25, v25
    v_exp_f32 v26, v26
    v_exp_f32 v27, v27
    s_nop 0
    v_fmac_f32 v12, v20, v48
    v_fmac_f32 v13, v20, v49
    v_fmac_f32 v14, v20, v50
    v_fmac_f32 v8, v20, v51
    v_fmac_f32 v12, v21, v52
    v_fmac_f32 v13, v21, v53
    v_fmac_f32 v14, v21, v54
    v_fmac_f32 v8, v21, v55
    v_fmac_f32 v12, v22, v56
    v_fmac_f32 v13, v22, v57
    v_fmac_f32 v14, v22, v58
    v_fmac_f32 v8, v22, v59
    v_fmac_f32 v12, v23, v60
    v_fmac_f32 v13, v23, v61
    v_fmac_f32 v14, v23, v62
    v_fmac_f32 v8, v23, v63
    v_fmac_f32 v12, v24, v64
    v_fmac_f32 v13, v24, v65
    v_fmac_f32 v14, v24, v66
    v_fmac_f32 v8, v24, v67
    v_fmac_f32 v12, v25, v68
    v_fmac_f32 v13, v25, v69
    v_fmac_f32 v14, v25, v70
    v_fmac_f32 v8, v25, v71
    v_fmac_f32 v12, v26, v72
    v_fmac_f32 v13, v26, v73
    v_fmac_f32 v14, v26, v74
    v_fmac_f32 v8, v26, v75
    v_fmac_f32 v12, v27, v76
    v_fmac_f32 v13, v27, v77
    v_fmac_f32 v14, v27, v78
    v_fmac_f32 v8, v27, v79
    v_sub_f32_dpp v20, v83, v6 quad_perm:[0,0,2,2] row_mask:0xf bank_mask:0xf
    v_sub_f32_dpp v21, v87, v6 quad_perm:[0,0,2,2] row_mask:0xf bank_mask:0xf
    v_sub_f32_dpp v22, v91, v6 quad_perm:[0,0,2,2] row_mask:0xf bank_mask:0xf
    v_sub_f32_dpp v23, v95, v6 quad_perm:[0,0,2,2] row_mask:0xf bank_mask:0xf
    v_sub_f32_dpp v24, v99, v6 quad_perm:[0,0,2,2] row_mask:0xf bank_mask:0xf
    v_sub_f32_dpp v25, v103, v6 quad_perm:[0,0,2,2] row_mask:0xf bank_mask:0xf
    v_sub_f32_dpp v26, v107, v6 quad_perm:[0,0,2,2] row_mask:0xf bank_mask:0xf
    v_sub_f32_dpp v27, v111, v6 quad_perm:[0,0,2,2] row_mask:0xf bank_mask:0xf
    v_exp_f32 v20, v20
    v_exp_f32 v21, v21
    v_exp_f32 v22, v22
    v_exp_f32 v23, v23
    v_exp_f32 v24, v24
    v_exp_f32 v25, v25
    v_exp_f32 v26, v26
    v_exp_f32 v27, v27
    s_nop 0
    v_fmac_f32 v12, v20, v80
    v_fmac_f32 v13, v20, v81
    v_fmac_f32 v14, v20, v82
    v_fmac_f32 v8, v20, v83
    v_fmac_f32 v12, v21, v84
    v_fmac_f32 v13, v21, v85
    v_fmac_f32 v14, v21, v86
    v_fmac_f32 v8, v21, v87
    v_fmac_f32 v12, v22, v88
    v_fmac_f32 v13, v22, v89
    v_fmac_f32 v14, v22, v90
    v_fmac_f32 v8, v22, v91
    v_fmac_f32 v12, v23, v92
    v_fmac_f32 v13, v23, v93
    v_fmac_f32 v14, v23, v94
    v_fmac_f32 v8, v23, v95
    v_fmac_f32 v12, v24, v96
    v_fmac_f32 v13, v24, v97
    v_fmac_f32 v14, v24, v98
    v_fmac_f32 v8, v24, v99
    v_fmac_f32 v12, v25, v100
    v_fmac_f32 v13, v25, v101
    v_fmac_f32 v14, v25, v102
    v_fmac_f32 v8, v25, v103
    v_fmac_f32 v12, v26, v104
    v_fmac_f32 v13, v26, v105
    v_fmac_f32 v14, v26, v106
    v_fmac_f32 v8, v26, v107
    v_fmac_f32 v12, v27, v108
    v_fmac_f32 v13, v27, v109
    v_fmac_f32 v14, v27, v110
    v_fmac_f32 v8, v27, v111
    v_sub_f32_dpp v20, v115, v6 quad_perm:[0,0,2,2] row_mask:0xf bank_mask:0xf
    v_sub_f32_dpp v21, v119, v6 quad_perm:[0,0,2,2] row_mask:0xf bank_mask:0xf
    v_sub_f32_dpp v22, v123, v6 quad_perm:[0,0,2,2] row_mask:0xf bank_mask:0xf
    v_sub_f32_dpp v23, v127, v6 quad_perm:[0,0,2,2] row_mask:0xf bank_mask:0xf
    v_sub_f32_dpp v24, v131, v6 quad_perm:[0,0,2,2] row_mask:0xf bank_mask:0xf
    v_sub_f32_dpp v25, v135, v6 quad_perm:[0,0,2,2] row_mask:0xf bank_mask:0xf
    v_sub_f32_dpp v26, v139, v6 quad_perm:[0,0,2,2] row_mask:0xf bank_mask:0xf
    v_sub_f32_dpp v27, v143, v6 quad_perm:[0,0,2,2] row_mask:0xf bank_mask:0xf
    v_exp_f32 v20, v20
    v_exp_f32 v21, v21
    v_exp_f32 v22, v22
    v_exp_f32 v23, v23
    v_exp_f32 v24, v24
    v_exp_f32 v25, v25
    v_exp_f32 v26, v26
    v_exp_f32 v27, v27
    s_nop 0
    v_fmac_f32 v12, v20, v112
    v_fmac_f32 v13, v20, v113
    v_fmac_f32 v14, v20, v114
    v_fmac_f32 v8, v20, v115
    v_fmac_f32 v12, v21, v116
    v_fmac_f32 v13, v21, v117
    v_fmac_f32 v14, v21, v118
    v_fmac_f32 v8, v21, v119
    v_fmac_f32 v12, v22, v120
    v_fmac_f32 v13, v22, v121
    v_fmac_f32 v14, v22, v122
    v_fmac_f32 v8, v22, v123
    v_fmac_f32 v12, v23, v124
    v_fmac_f32 v13, v23, v125
    v_fmac_f32 v14, v23, v126
    v_fmac_f32 v8, v23, v127
    v_fmac_f32 v12, v24, v128
    v_fmac_f32 v13, v24, v129
    v_fmac_f32 v14, v24, v130
    v_fmac_f32 v8, v24, v131
    v_fmac_f32 v12, v25, v132
    v_fmac_f32 v13, v25, v133
    v_fmac_f32 v14, v25, v134
    v_fmac_f32 v8, v25, v135
    v_fmac_f32 v12, v26, v136
    v_fmac_f32 v13, v26, v137
    v_fmac_f32 v14, v26, v138
    v_fmac_f32 v8, v26, v139
    v_fmac_f32 v12, v27, v140
    v_fmac_f32 v13, v27, v141
    v_fmac_f32 v14, v27, v142
    v_fmac_f32 v8, v27, v143
    v_sub_f32_dpp v20, v147, v6 quad_perm:[0,0,2,2] row_mask:0xf bank_mask:0xf
    v_sub_f32_dpp v21, v151, v6 quad_perm:[0,0,2,2] row_mask:0xf bank_mask:0xf
    v_sub_f32_dpp v22, v155, v6 quad_perm:[0,0,2,2] row_mask:0xf bank_mask:0xf
    v_sub_f32_dpp v23, v159, v6 quad_perm:[0,0,2,2] row_mask:0xf bank_mask:0xf
    v_sub_f32_dpp v24, v163, v6 quad_perm:[0,0,2,2] row_mask:0xf bank_mask:0xf
    v_sub_f32_dpp v25, v167, v6 quad_perm:[0,0,2,2] row_mask:0xf bank_mask:0xf
    v_sub_f32_dpp v26, v171, v6 quad_perm:[0,0,2,2] row_mask:0xf bank_mask:0xf
    v_sub_f32_dpp v27, v175, v6 quad_perm:[0,0,2,2] row_mask:0xf bank_mask:0xf
    v_exp_f32 v20, v20
    v_exp_f32 v21, v21
    v_exp_f32 v22, v22
    v_exp_f32 v23, v23
    v_exp_f32 v24, v24
    v_exp_f32 v25, v25
    v_exp_f32 v26, v26
    v_exp_f32 v27, v27
    s_nop 0
    v_fmac_f32 v12, v20, v144
    v_fmac_f32 v13, v20, v145
    v_fmac_f32 v14, v20, v146
    v_fmac_f32 v8, v20, v147
    v_fmac_f32 v12, v21, v148
    v_fmac_f32 v13, v21, v149
    v_fmac_f32 v14, v21, v150
    v_fmac_f32 v8, v21, v151
    v_fmac_f32 v12, v22, v152
    v_fmac_f32 v13, v22, v153
    v_fmac_f32 v14, v22, v154
    v_fmac_f32 v8, v22, v155
    v_fmac_f32 v12, v23, v156
    v_fmac_f32 v13, v23, v157
    v_fmac_f32 v14, v23, v158
    v_fmac_f32 v8, v23, v159
    v_fmac_f32 v12, v24, v160
    v_fmac_f32 v13, v24, v161
    v_fmac_f32 v14, v24, v162
    v_fmac_f32 v8, v24, v163
    v_fmac_f32 v12, v25, v164
    v_fmac_f32 v13, v25, v165
    v_fmac_f32 v14, v25, v166
    v_fmac_f32 v8, v25, v167
    v_fmac_f32 v12, v26, v168
    v_fmac_f32 v13, v26, v169
    v_fmac_f32 v14, v26, v170
    v_fmac_f32 v8, v26, v171
    v_fmac_f32 v12, v27, v172
    v_fmac_f32 v13, v27, v173
    v_fmac_f32 v14, v27, v174
    v_fmac_f32 v8, v27, v175
    s_cmp_lg_u64 s[84:85], 0
    s_cbranch_scc1 L_chunk
    s_cmp_lg_u32 s74, 0
    s_cbranch_scc1 L_fin
    v_cndmask_b32 v15, v7, v8, s[66:67]
    v_mov_b32 v5, s95
    s_and_b32 s79, s97, 31
    s_lshr_b32 s80, s97, 10
    s_lshl_b32 s80, s80, 3
    s_and_b32 s83, s72, 7
    s_add_u32 s80, s80, s83
    s_bfm_b64 s[88:89], 1, s80
    s_bfe_u32 s83, s97, 0x50005
    s_mul_i32 s83, s83, s70
    s_cmp_lg_u32 s83, 512
    s_cbranch_scc1 L_rec
    s_mov_b64 exec, 1
    buffer_store_dword v5, v3, s[52:55], s77 offen offset:1028
    s_mov_b64 exec, -1
    s_branch L_fin
L_rec:
    s_lshl_b32 s83, s83, 16
    s_or_b32 s89, s89, s83
    v_mov_b32 v16, s88
    v_mov_b32 v17, s89
    s_lshl_b32 s75, s79, 17
    s_add_u32 s75, s75, 4194304
    s_lshl_b32 s80, s80, 11
    s_add_u32 s80, s80, s75
    buffer_store_dwordx4 v[12:15], v1, s[52:55], s80 offen sc0 sc1
    s_mov_b64 exec, 1
    buffer_store_dword v5, v3, s[52:55], s77 offen offset:1028
    s_lshl_b32 s80, s79, 8
    s_add_u32 s80, s80, 23076864
    s_waitcnt vmcnt(0)
    buffer_atomic_add_x2 v[16:17], v3, s[52:55], s80 offen sc0 sc1
    s_waitcnt vmcnt(0)
    s_mov_b64 exec, -1
    v_readfirstlane_b32 s84, v16
    v_readfirstlane_b32 s85, v17
    s_add_u32 s84, s84, s88
    s_add_u32 s85, s85, s89
    s_lshr_b32 s80, s85, 16
    s_cmp_lg_u32 s80, 512
    s_cbranch_scc1 L_next
    s_mov_b32 s74, 1
    s_and_b32 s85, s85, 0xffff
    s_branch L_merge
L_fin:
    s_nop 1
    v_mov_b32_dpp v5, v8 quad_perm:[1,1,3,3] row_mask:0xf bank_mask:0xf
    v_rcp_f32 v5, v5
    s_mul_i32 s80, s79, 384
    v_mul_f32 v12, v12, v5
    v_mul_f32 v13, v13, v5
    v_mul_f32 v14, v14, v5
    v_cvt_pk_bf16_f32 v12, v12, v12
    v_cvt_pk_bf16_f32 v13, v13, v13
    v_cvt_pk_bf16_f32 v14, v14, v14
    buffer_store_short v12, v11, s[56:59], s80 offen offset:0
    buffer_store_short v13, v11, s[56:59], s80 offen offset:128
    buffer_store_short v14, v11, s[56:59], s80 offen offset:256
L_next:
    s_add_u32 s71, s71, s70
    s_branch L_round
L_last:
    s_lshl_b32 s75, s96, 9
    s_add_u32 s75, s75, 1572864
    v_lshrrev_b32 v6, 1, v0
    v_lshlrev_b32 v28, 4, v6
L_inf:
    buffer_load_dwordx4 v[48:51], v28, s[52:55], s75 offen sc0 sc1
    s_waitcnt vmcnt(0)
    v_cmp_ne_u32 vcc, s69, v49
    s_cmp_lg_u64 vcc, 0
    s_cbranch_scc1 L_inf
    v_mov_b32 v7, v50
    s_nop 1
    v_max_f32_dpp v7, v7, v7 row_ror:8 row_mask:0xf bank_mask:0xf
    s_nop 1
    v_max_f32_dpp v7, v7, v7 row_ror:4 row_mask:0xf bank_mask:0xf
    s_nop 1
    v_max_f32_dpp v7, v7, v7 row_ror:2 row_mask:0xf bank_mask:0xf
    s_nop 1
    v_max_f32_dpp v7, v7, v7 row_ror:1 row_mask:0xf bank_mask:0xf
    v_mov_b32 v5, v7
    s_nop 1
    v_permlane32_swap_b32 v7, v5
    s_nop 1
    v_max_f32 v7, v7, v5
    v_mov_b32 v5, v7
    s_nop 1
    v_permlane16_swap_b32 v7, v5
    s_nop 1
    v_max_f32 v7, v7, v5
    v_sub_f32 v20, v50, v7
    v_exp_f32 v20, v20
    s_nop 0
    v_mul_f32 v8, v20, v51
    s_nop 1
    v_add_f32_dpp v8, v8, v8 row_ror:8 row_mask:0xf bank_mask:0xf
    s_nop 1
    v_add_f32_dpp v8, v8, v8 row_ror:4 row_mask:0xf bank_mask:0xf
    s_nop 1
    v_add_f32_dpp v8, v8, v8 row_ror:2 row_mask:0xf bank_mask:0xf
    s_nop 1
    v_add_f32_dpp v8, v8, v8 row_ror:1 row_mask:0xf bank_mask:0xf
    v_mov_b32 v5, v8
    s_nop 1
    v_permlane32_swap_b32 v8, v5
    s_nop 1
    v_add_f32 v8, v8, v5
    v_mov_b32 v5, v8
    s_nop 1
    v_permlane16_swap_b32 v8, v5
    s_nop 1
    v_add_f32 v8, v8, v5
    v_rcp_f32 v8, v8
    v_and_b32 v5, 1, v0
    v_mul_f32 v8, 2.0, v8
    v_mul_f32 v20, v20, v8
    v_lshlrev_b32 v28, 11, v6
    v_lshl_add_u32 v28, v5, 4, v28
    s_lshl_b32 s75, s96, 16
    s_lshl_b32 s80, s92, 5
    s_add_u32 s75, s75, s80
    v_mov_b32 v51, 0
    v_mov_b32 v55, 0
    v_mov_b32 v59, 0
    v_mov_b32 v63, 0
    v_mov_b32 v12, 0
    v_mov_b32 v13, 0
    v_mov_b32 v14, 0
    v_bfe_u32 v6, v0, 4, 1
    v_lshrrev_b32 v11, 5, v0
    v_lshl_add_u32 v11, v6, 1, v11
    v_lshlrev_b32 v11, 7, v11
    v_lshl_add_u32 v11, v5, 3, v11
    s_and_b32 s80, s92, 7
    s_lshl_b32 s80, s80, 4
    s_lshr_b32 s81, s92, 3
    s_lshl_b32 s81, s81, 1
    s_add_u32 s80, s80, s81
    s_add_u32 s79, s96, 24
    s_mul_i32 s78, s79, 384
    s_add_u32 s78, s78, s80
    s_mov_b64 s[24:25], -1
    s_mov_b32 s32, 0x00030003
    s_mov_b32 s33, 0x00000003
L_dt:
    ds_read_b32 v5, v3 offset:144
    s_waitcnt lgkmcnt(0)
    v_readfirstlane_b32 s80, v5
    s_cmp_eq_u32 s80, 0
    s_cbranch_scc1 L_dt
L_pa:
    buffer_load_dwordx4 v[48:51], v28, s[52:55], s75 offen offset:0 sc0 sc1
    s_waitcnt vmcnt(0)
    v_cmpx_eq_u32 vcc, s69, v51
    v_fmac_f32 v12, v20, v48
    v_fmac_f32 v13, v20, v49
    v_fmac_f32 v14, v20, v50
    s_andn2_b64 s[24:25], s[24:25], vcc
    s_mov_b64 exec, s[24:25]
    s_bcnt1_i32_b64 s80, s[24:25]
    s_cmp_gt_u32 s80, 0
    s_cbranch_scc1 L_pa
L_pd:
    s_mov_b64 exec, -1
    v_mov_b32 v15, v14
    v_permlane32_swap_b32 v12, v13
    s_nop 0
    v_permlane32_swap_b32 v14, v15
    v_add_f32 v12, v12, v13
    v_add_f32 v14, v14, v15
    s_nop 1
    v_permlane16_swap_b32 v12, v14
    v_add_f32 v12, v12, v14
    s_nop 1
    v_add_f32_dpp v12, v12, v12 row_ror:8 row_mask:0xf bank_mask:0xf
    s_nop 1
    v_add_f32_dpp v12, v12, v12 row_ror:4 row_mask:0xf bank_mask:0xf
    s_nop 1
    v_add_f32_dpp v12, v12, v12 row_ror:2 row_mask:0xf bank_mask:0xf
    s_mov_b64 exec, s[32:33]
    v_cvt_pk_bf16_f32 v12, v12, v12
    buffer_store_short v12, v11, s[56:59], s78 offen
L_end:
    s_endpgm
L_ticket:
    v_lshlrev_b32 v1, 2, v0
    v_mov_b32 v2, 0
    v_lshlrev_b32 v4, 4, v0
    v_mov_b32 v8, -1
    v_mov_b32 v9, -1
    v_mov_b32 v10, -1
    v_mov_b32 v11, -1
    ds_write_b128 v4, v[8:11] offset:256
    ds_write_b128 v4, v[8:11] offset:1280
    ds_write_b128 v4, v[8:11] offset:2304
    s_memrealtime s[80:81]
    s_waitcnt lgkmcnt(0)
    s_barrier
    s_mov_b32 s52, s22
    s_and_b32 s53, s23, 0xffff
    s_mov_b32 s54, 25165824
    s_mov_b32 s55, 0x00020000
    s_mov_b32 s60, s20
    s_and_b32 s61, s21, 0xffff
    s_mov_b32 s62, 256
    s_mov_b32 s63, 0x00020000
    s_max_u32 s69, s80, 1
    s_cmp_lg_u32 s2, 0
    s_cbranch_scc1 L_kd
    v_lshlrev_b32 v5, 8, v0
    s_mov_b32 s80, 23068672
    v_mov_b32 v3, 0
    buffer_store_dwordx2 v[2:3], v5, s[52:55], s80 offen sc0 sc1
    v_mov_b32 v3, s69
    s_mov_b64 exec, 1
    s_waitcnt vmcnt(0)
    buffer_store_dword v3, v2, s[60:63], 0 offen sc0 sc1
    s_mov_b64 exec, -1
L_kd:
    ds_read_b32 v3, v2 offset:128
    s_waitcnt lgkmcnt(0)
    v_readfirstlane_b32 s80, v3
    s_cmp_eq_u32 s80, 0
    s_cbranch_scc1 L_kd
    ds_read_b128 v[24:27], v4 offset:16128
    ds_read_b128 v[28:31], v4 offset:17152
    ds_read_b128 v[32:35], v4 offset:18176
    ds_read_b128 v[36:39], v4 offset:19200
    s_waitcnt lgkmcnt(0)
    v_max_f32 v18, v24, v25
    v_max3_f32 v18, v18, v26, v27
    v_max3_f32 v18, v18, v28, v29
    v_max3_f32 v18, v18, v30, v31
    v_max3_f32 v18, v18, v32, v33
    v_max3_f32 v18, v18, v34, v35
    v_max3_f32 v18, v18, v36, v37
    v_max3_f32 v18, v18, v38, v39
    s_nop 1
    v_max_f32_dpp v18, v18, v18 row_ror:8 row_mask:0xf bank_mask:0xf
    s_nop 1
    v_max_f32_dpp v18, v18, v18 row_ror:4 row_mask:0xf bank_mask:0xf
    s_nop 1
    v_max_f32_dpp v18, v18, v18 row_ror:2 row_mask:0xf bank_mask:0xf
    s_nop 1
    v_max_f32_dpp v18, v18, v18 row_ror:1 row_mask:0xf bank_mask:0xf
    v_mov_b32 v3, v18
    s_nop 1
    v_permlane32_swap_b32 v18, v3
    s_nop 1
    v_max_f32 v18, v18, v3
    v_mov_b32 v3, v18
    s_nop 1
    v_permlane16_swap_b32 v18, v3
    s_nop 1
    v_max_f32 v18, v18, v3
    v_sub_f32 v24, v24, v18
    v_sub_f32 v25, v25, v18
    v_sub_f32 v26, v26, v18
    v_sub_f32 v27, v27, v18
    v_sub_f32 v28, v28, v18
    v_sub_f32 v29, v29, v18
    v_sub_f32 v30, v30, v18
    v_sub_f32 v31, v31, v18
    v_sub_f32 v32, v32, v18
    v_sub_f32 v33, v33, v18
    v_sub_f32 v34, v34, v18
    v_sub_f32 v35, v35, v18
    v_sub_f32 v36, v36, v18
    v_sub_f32 v37, v37, v18
    v_sub_f32 v38, v38, v18
    v_sub_f32 v39, v39, v18
    v_exp_f32 v24, v24
    v_exp_f32 v25, v25
    v_exp_f32 v26, v26
    v_exp_f32 v27, v27
    v_exp_f32 v28, v28
    v_exp_f32 v29, v29
    v_exp_f32 v30, v30
    v_exp_f32 v31, v31
    v_exp_f32 v32, v32
    v_exp_f32 v33, v33
    v_exp_f32 v34, v34
    v_exp_f32 v35, v35
    v_exp_f32 v36, v36
    v_exp_f32 v37, v37
    v_exp_f32 v38, v38
    v_exp_f32 v39, v39
    ds_write_b32 v2, v18 offset:160
    v_add_f32 v19, v24, v25
    v_add_f32 v19, v19, v26
    v_add_f32 v19, v19, v27
    v_add_f32 v19, v19, v28
    v_add_f32 v19, v19, v29
    v_add_f32 v19, v19, v30
    v_add_f32 v19, v19, v31
    v_add_f32 v19, v19, v32
    v_add_f32 v19, v19, v33
    v_add_f32 v19, v19, v34
    v_add_f32 v19, v19, v35
    v_add_f32 v19, v19, v36
    v_add_f32 v19, v19, v37
    v_add_f32 v19, v19, v38
    v_add_f32 v19, v19, v39
    s_nop 1
    v_add_f32_dpp v19, v19, v19 row_ror:8 row_mask:0xf bank_mask:0xf
    s_nop 1
    v_add_f32_dpp v19, v19, v19 row_ror:4 row_mask:0xf bank_mask:0xf
    s_nop 1
    v_add_f32_dpp v19, v19, v19 row_ror:2 row_mask:0xf bank_mask:0xf
    s_nop 1
    v_add_f32_dpp v19, v19, v19 row_ror:1 row_mask:0xf bank_mask:0xf
    v_mov_b32 v3, v19
    s_nop 1
    v_permlane32_swap_b32 v19, v3
    s_nop 1
    v_add_f32 v19, v19, v3
    v_mov_b32 v3, v19
    s_nop 1
    v_permlane16_swap_b32 v19, v3
    s_nop 1
    v_add_f32 v19, v19, v3
    s_lshl_b32 s80, s2, 11
    s_add_u32 s80, s80, 18874368
    s_waitcnt lgkmcnt(0)
    s_mov_b64 exec, -1
L_tg:
    buffer_load_dword v3, v2, s[60:63], 0 offen sc0 sc1
    s_waitcnt vmcnt(0)
    v_readfirstlane_b32 s69, v3
    s_cmp_eq_u32 s69, 0
    s_cbranch_scc1 L_tg
    s_getreg_b32 s81, hwreg(HW_REG_XCC_ID)
    s_and_b32 s81, s81, 15
    v_mov_b32 v16, s81
    v_mov_b32 v17, s69
    s_lshl_b32 s80, s2, 11
    s_mov_b64 exec, 1
    s_lshl_b32 s82, s2, 4
    s_add_u32 s82, s82, 1572864
    buffer_store_dwordx4 v[16:19], v2, s[52:55], s82 offen sc0 sc1
    v_mov_b32 v12, s69
    v_mov_b32 v13, s69
    s_add_u32 s82, s80, 2097152
    buffer_store_dwordx2 v[12:13], v2, s[52:55], s82 offen offset:1024
    s_add_u32 s82, s80, 2621440
    buffer_store_dwordx2 v[12:13], v2, s[52:55], s82 offen offset:1024
    s_mov_b64 exec, -1
    s_mov_b32 s73, s81
    s_lshl_b32 s80, s79, 2
    s_lshr_b32 s74, 0x54465464, s80
    s_and_b32 s74, s74, 15
    s_mov_b32 s75, 0
    s_mov_b32 s95, s69
    s_lshl_b32 s77, s2, 11
    s_lshl_b32 s94, s79, 16
    s_mov_b32 s76, 2097152
    v_mov_b32 v19, 0
    v_lshlrev_b32 v20, 11, v0
    v_mov_b32 v21, v4
L_fl:
    ds_read_b32 v3, v19
    s_waitcnt lgkmcnt(0)
    v_readfirstlane_b32 s80, v3
    s_cmp_eq_u32 s80, 0
    s_cbranch_scc1 L_fl
    ds_read_b128 v[24:27], v21 offset:20480
    ds_read_b128 v[28:31], v21 offset:21504
    ds_read_b128 v[32:35], v21 offset:22528
    ds_read_b128 v[36:39], v21 offset:23552
    s_waitcnt lgkmcnt(0)
    s_nop 0
    v_add_f32_dpp v37, v37, v37 row_ror:8 row_mask:0xf bank_mask:0xf
    v_add_f32_dpp v38, v38, v38 row_ror:8 row_mask:0xf bank_mask:0xf
    s_nop 0
    v_add_f32_dpp v37, v37, v37 row_ror:4 row_mask:0xf bank_mask:0xf
    v_add_f32_dpp v38, v38, v38 row_ror:4 row_mask:0xf bank_mask:0xf
    s_nop 0
    v_add_f32_dpp v37, v37, v37 row_ror:2 row_mask:0xf bank_mask:0xf
    v_add_f32_dpp v38, v38, v38 row_ror:2 row_mask:0xf bank_mask:0xf
    s_nop 0
    v_add_f32_dpp v37, v37, v37 row_ror:1 row_mask:0xf bank_mask:0xf
    v_add_f32_dpp v38, v38, v38 row_ror:1 row_mask:0xf bank_mask:0xf
    v_mov_b32 v40, v36
    v_mov_b32 v41, v36
    s_branch L_x2
L_w2:
    s_branch L_walked
L_x2:
    s_nop 1
    v_permlane32_swap_b32 v40, v41
    s_nop 1
    v_max_f32 v40, v40, v41
    v_mov_b32 v41, v40
    s_nop 1
    v_permlane16_swap_b32 v40, v41
    s_nop 1
    v_max_f32 v40, v40, v41
    v_sub_f32 v41, v36, v40
    v_exp_f32 v41, v41
    v_mov_b32 v48, v40
    v_mul_f32 v37, v37, v41
    v_mul_f32 v38, v38, v41
    v_mul_f32 v41, 0x58000000, v41
    v_fma_f32 v24, v24, v41, -v38
    v_fma_f32 v25, v25, v41, -v38
    v_fma_f32 v26, v26, v41, -v38
    v_fma_f32 v27, v27, v41, -v38
    v_fma_f32 v28, v28, v41, -v38
    v_fma_f32 v29, v29, v41, -v38
    v_fma_f32 v30, v30, v41, -v38
    v_fma_f32 v31, v31, v41, -v38
    v_fma_f32 v32, v32, v41, -v38
    v_fma_f32 v33, v33, v41, -v38
    v_fma_f32 v34, v34, v41, -v38
    v_fma_f32 v35, v35, v41, -v38
    v_mov_b32 v40, v37
    s_nop 1
    v_permlane32_swap_b32 v37, v40
    v_permlane32_swap_b32 v24, v26
    v_permlane32_swap_b32 v25, v27
    v_permlane32_swap_b32 v28, v30
    v_permlane32_swap_b32 v29, v31
    v_permlane32_swap_b32 v32, v34
    v_permlane32_swap_b32 v33, v35
    s_nop 1
    v_add_f32 v37, v37, v40
    v_add_f32 v24, v24, v26
    v_add_f32 v25, v25, v27
    v_add_f32 v28, v28, v30
    v_add_f32 v29, v29, v31
    v_add_f32 v32, v32, v34
    v_add_f32 v33, v33, v35
    v_mov_b32 v40, v37
    s_nop 1
    v_permlane16_swap_b32 v37, v40
    v_permlane16_swap_b32 v24, v25
    v_permlane16_swap_b32 v28, v29
    v_permlane16_swap_b32 v32, v33
    s_nop 1
    v_add_f32 v49, v37, v40
    v_add_f32 v44, v24, v25
    v_add_f32 v45, v28, v29
    v_add_f32 v46, v32, v33
    v_mov_b32 v8, v44
    v_mov_b32 v9, v45
    v_mov_b32 v10, v46
    v_cndmask_b32 v11, v48, v49, s[66:67]
    s_cmp_eq_u32 s75, 1
    s_cbranch_scc1 L_dep
    s_cmp_lg_u32 s75, 0
    s_cbranch_scc1 L_guard
    s_lshr_b32 s82, s3, 5
    s_lshl_b32 s83, s79, 9
    s_add_u32 s83, s83, 1572864
    s_bfm_b64 exec, 32, 0
L_reg:
    buffer_load_dwordx2 v[12:13], v4, s[52:55], s83 offen sc0 sc1
    s_waitcnt vmcnt(0)
    v_cmp_ne_u32 vcc, s69, v13
    s_cmp_lg_u64 vcc, 0
    s_cbranch_scc1 L_reg
    v_cmp_eq_u32 s[86:87], s73, v12
    s_nop 1
    v_mov_b32 v14, s86
    v_mov_b32 v15, s87
    ds_write_b64 v2, v[14:15] offset:152
    s_waitcnt lgkmcnt(0)
    ds_write_b32 v2, v13 offset:140
    s_mov_b64 exec, -1
    s_branch L_dep
L_guard:
    s_sub_u32 s80, s95, 1
    s_add_u32 s81, s94, s76
L_guard2:
    v_mov_b32 v12, s69
    s_mov_b64 exec, s[86:87]
    buffer_load_dword v12, v20, s[52:55], s81 offen offset:1028 sc0 sc1
    s_mov_b64 exec, -1
    s_waitcnt vmcnt(0)
    v_cmp_eq_u32 vcc, s80, v12
    s_cmp_eq_u64 vcc, 0
    s_cbranch_scc1 L_guard2
L_dep:
    s_add_u32 s75, s75, 1
    s_add_u32 s95, s95, 1
    s_add_u32 s80, s77, s76
    v_mov_b32 v3, s95
    s_waitcnt lgkmcnt(0)
    buffer_store_dwordx4 v[8:11], v4, s[52:55], s80 offen
    s_mov_b64 exec, 1
    s_waitcnt vmcnt(0)
    buffer_store_dword v3, v2, s[52:55], s80 offen offset:1024
    s_mov_b64 exec, -1
    s_xor_b32 s76, s76, 0x80000
    v_add_u32 v21, 4096, v21
    v_add_u32 v19, 4, v19
    s_cmp_lt_u32 s75, s74
    s_cbranch_scc1 L_fl
    s_endpgm
L_ctl:
    s_memtime s[48:49]
    s_memrealtime s[50:51]
    s_mov_b32 s56, 8
    s_mov_b32 s57, -1
    s_mov_b32 s58, 0
    s_mov_b32 s92, 1
    s_mov_b32 s59, 8
    v_lshlrev_b32 v1, 2, v0
    v_mov_b32 v2, 0
    ds_write_b32 v1, v2 offset:3328
    s_and_b32 s70, s2, 31
    s_lshl_b32 s70, s70, 2
    s_mov_b32 s71, 1
    v_mov_b32 v7, s2
    v_and_b32 v10, 15, v0
    v_lshrrev_b32 v8, 5, v7
    v_lshl_add_u32 v10, v8, 4, v10
    v_lshrrev_b32 v9, 4, v0
    v_lshl_add_u32 v10, v9, 7, v10
    s_lshl_b32 s82, s79, 3
    s_mov_b32 s80, 0xeff4fa00
    s_mov_b32 s81, 0xdbe0e5ea
    s_lshr_b64 s[80:81], s[80:81], s82
    s_sext_i32_i8 s80, s80
    s_mov_b32 exec_lo, 0x0
    s_mov_b32 exec_hi, 0x3ff
    v_add_u32 v10, s80, v10
    s_mov_b32 s80, 0xeff43d4c
    s_mov_b32 s81, 0xdbe0e5ea
    s_lshr_b64 s[80:81], s[80:81], s82
    s_sext_i32_i8 s80, s80
    s_mov_b32 exec_lo, 0x0
    s_mov_b32 exec_hi, 0x400
    v_add_u32 v10, s80, v10
    s_mov_b32 s80, 0x2c37424d
    s_mov_b32 s81, 0xb1621
    s_lshr_b64 s[80:81], s[80:81], s82
    s_sext_i32_i8 s80, s80
    s_mov_b32 exec_lo, 0x0
    s_mov_b32 exec_hi, 0xf800
    v_add_u32 v10, s80, v10
    s_mov_b64 exec, -1
    v_mul_u32_u24 v30, 1572864, v10
    v_and_b32 v9, 3, v7
    v_lshl_add_u32 v8, v10, 2, v9
    v_bfe_u32 v9, v7, 2, 3
    v_lshl_add_u32 v8, v8, 3, v9
    v_mul_u32_u24 v9, 384, v8
    v_lshlrev_b32 v8, 7, v8
    s_waitcnt lgkmcnt(0)
    s_mov_b32 s32, s10
    s_and_b32 s33, s11, 0xffff
    s_mov_b32 s34, 6291456
    s_mov_b32 s35, 0x00020000
    buffer_load_dword v10, v9, s[32:35], 0 offen offset:0
    buffer_load_dword v11, v9, s[32:35], 0 offen offset:128
    buffer_load_dword v12, v9, s[32:35], 0 offen offset:256
    s_mov_b32 s36, s12
    s_and_b32 s37, s13, 0xffff
    s_mov_b32 s38, 6291456
    s_mov_b32 s39, 0x00020000
    buffer_load_dword v13, v9, s[36:39], 0 offen offset:0
    buffer_load_dword v14, v9, s[36:39], 0 offen offset:128
    buffer_load_dword v15, v9, s[36:39], 0 offen offset:256
    s_mov_b32 s40, s14
    s_and_b32 s41, s15, 0xffff
    s_mov_b32 s42, 2097152
    s_mov_b32 s43, 0x00020000
    buffer_load_dword v16, v8, s[40:43], 0 offen offset:0
    s_mov_b32 s44, s16
    s_and_b32 s45, s17, 0xffff
    s_mov_b32 s46, 2097152
    s_mov_b32 s47, 0x00020000
    buffer_load_dword v17, v8, s[44:47], 0 offen offset:0
    s_mov_b32 s52, s22
    s_and_b32 s53, s23, 0xffff
    s_mov_b32 s54, 25165824
    s_mov_b32 s55, 0x00020000
    v_lshlrev_b32 v7, 7, v0
    s_lshl_b32 s80, s2, 11
    s_add_u32 s81, s80, 2097152
    s_add_u32 s82, s80, 2621440
    s_mov_b64 exec, 0x1ff
    buffer_load_dword v18, v7, s[52:55], s81 offen
    buffer_load_dword v19, v7, s[52:55], s82 offen
    s_mov_b64 exec, -1
    s_barrier
    s_mov_b32 s60, s20
    s_and_b32 s61, s21, 0xffff
    s_mov_b32 s62, 256
    s_mov_b32 s63, 0x00020000
    s_mov_b32 s52, s22
    s_and_b32 s53, s23, 0xffff
    s_mov_b32 s54, 25165824
    s_mov_b32 s55, 0x00020000
    s_getreg_b32 s76, hwreg(HW_REG_XCC_ID)
    s_and_b32 s76, s76, 15
    s_lshr_b32 s70, s70, 1
    s_and_b32 s75, s2, 31
    s_cmp_eq_u32 s75, 0
    s_cselect_b32 s75, 32, s75
    s_mul_i32 s77, s75, 32
    s_mul_i32 s83, s75, 16
    s_add_u32 s83, s83, 768
    s_min_u32 s77, s77, s83
    v_lshlrev_b32 v1, 1, v0
    v_lshlrev_b32 v7, 7, v0
    s_mov_b32 s24, s6
    s_and_b32 s25, s7, 0xffff
    s_mov_b32 s26, 805306368
    s_mov_b32 s27, 0x00020000
    s_mov_b32 s28, s8
    s_and_b32 s29, s9, 0xffff
    s_mov_b32 s30, 805306368
    s_mov_b32 s31, 0x00020000
    s_and_b32 s88, s2, 31
    s_lshl_b32 s89, s88, 4
    s_sub_i32 s89, s89, 63
    s_mov_b32 s90, 1572800
L_c:
    ds_read_b32 v3, v2 offset:3328
    ds_read_b32 v4, v2 offset:144
    s_mov_b64 exec, 1
    s_waitcnt lgkmcnt(0)
    v_add_u32 v3, 1, v3
    buffer_store_short v3, v2, s[60:63], s70 offen offset:128
    s_bfm_b64 exec, 33, 0
    buffer_load_ushort v5, v1, s[60:63], 0 offen offset:128 sc1
    v_readfirstlane_b32 s72, v3
    v_readfirstlane_b32 s81, v4
    s_add_u32 s80, s71, s72
    s_mov_b32 s71, s72
    s_mov_b64 exec, 0xffffffff
    s_waitcnt vmcnt(0)
    v_cmp_ne_u32 vcc, 0, v5
    v_lshlrev_b32 v6, 1, v5
    v_readlane_b32 s86, v5, 32
    v_cmp_le_u32 s[82:83], s80, v6
    s_bcnt1_i32_b64 s73, vcc
    s_cmp_eq_u32 s86, 0
    s_cselect_b32 s86, 1024, s86
    s_bcnt1_i32_b64 s74, s[82:83]
    s_sub_i32 s86, s86, 1003
    s_cmp_ge_u32 s72, 1024
    s_cselect_b32 s80, 1, 0
    s_add_i32 s86, s86, s80
    s_cmp_ge_u32 s72, 1920
    s_cselect_b32 s80, 2, 0
    s_add_i32 s86, s86, s80
    s_cmp_ge_u32 s72, 1024
    s_cselect_b32 s80, s58, s57
    s_add_i32 s86, s86, s80
    s_mul_i32 s80, s73, s86
    s_lshl_b32 s74, s74, 5
    s_cmp_lt_i32 s74, s80
    s_cselect_b32 s86, 1, 0
    s_lshl_b32 s82, s73, 5
    s_add_u32 s74, s74, s82
    s_cmp_lt_i32 s74, s80
    s_cselect_b32 s86, 2, s86
    s_cmp_ge_u32 s72, 1024
    s_cselect_b32 s80, s59, s92
    s_cmp_eq_u32 s86, 2
    s_cselect_b32 s80, 20, s80
    s_cmp_eq_u32 s86, 0
    s_cselect_b32 s86, 0, s80
    v_mov_b32 v6, s86
    ds_write_b32 v2, v6 offset:148
    s_cmp_lt_u32 s72, s56
    s_cbranch_scc1 L_nad
    s_memtime s[64:65]
    s_memrealtime s[66:67]
    s_add_u32 s56, s72, 64
    s_waitcnt lgkmcnt(0)
    s_sub_u32 s68, s64, s48
    s_sub_u32 s69, s66, s50
    s_mov_b32 s48, s64
    s_mov_b32 s50, s66
    v_cvt_f32_u32 v25, s69
    v_cvt_f32_u32 v24, s68
    v_rcp_f32 v25, v25
    s_nop 1
    v_mul_f32 v24, v24, v25
    v_add_f32 v26, 0xc19cdfda, v24
    v_mul_f32 v26, 0x405c28f6, v26
    v_rndne_f32 v26, v26
    v_cvt_i32_f32 v26, v26
    v_med3_i32 v26, v26, 1, 17
    v_add_f32 v27, 0xc1b73333, v24
    v_mul_f32 v27, 0x41200000, v27
    v_rndne_f32 v27, v27
    v_cvt_i32_f32 v27, v27
    v_med3_i32 v27, v27, 1, 17
    v_add_f32 v25, 0xc1b5999a, v24
    v_readfirstlane_b32 s92, v27
    v_readfirstlane_b32 s68, v24
    v_mul_f32 v25, 0x40600000, v25
    v_rndne_f32 v25, v25
    v_cvt_i32_f32 v25, v25
    s_cmp_ge_u32 s68, 0x00000000
    s_mov_b32 s69, 0x00000000
    s_cselect_b32 s69, 0x41a0cccd, s69
    v_readfirstlane_b32 s59, v26
    v_readfirstlane_b32 s57, v25
    v_subrev_f32 v24, s69, v24
    v_mul_f32 v24, 0x40800000, v24
    v_rndne_f32 v24, v24
    v_cvt_i32_f32 v24, v24
    s_max_i32 s57, s57, -13
    s_min_i32 s57, s57, 1
    v_readfirstlane_b32 s58, v24
    s_max_i32 s58, s58, -10
    s_min_i32 s58, s58, 0
L_nad:
    s_cmp_lt_i32 s72, s89
    s_cbranch_scc1 L_ntp
    v_readlane_b32 s87, v30, s88
    s_min_u32 s87, s87, 803733504
    s_cmp_ge_u32 s88, 64
    s_cbranch_scc1 L_tpv
    s_load_dword s90, s[6:7], s87
    s_add_u32 s87, s87, 1572800
    s_load_dword s91, s[6:7], s87
    s_branch L_tpd
L_tpv:
    s_load_dword s90, s[8:9], s87
    s_add_u32 s87, s87, 1572800
    s_load_dword s91, s[8:9], s87
L_tpd:
    s_add_u32 s88, s88, 32
    s_add_i32 s89, s89, 512
    s_cmp_ge_u32 s88, 128
    s_cselect_b32 s89, 0x7fffffff, s89
    s_mov_b64 exec, 0xffffffff
L_ntp:
    s_cmp_lt_u32 s72, s77
    s_cbranch_scc1 L_cn
    s_memrealtime s[84:85]
    s_lshl_b32 s86, s75, 11
    s_add_u32 s75, s75, 32
    s_mul_i32 s77, s75, 32
    s_mul_i32 s83, s75, 16
    s_add_u32 s83, s83, 768
    s_min_u32 s77, s77, s83
    s_cmp_lg_u32 s73, 32
    s_cbranch_scc1 L_cn
    v_add_u32_dpp v5, v5, v5 row_ror:8 row_mask:0xf bank_mask:0xf
    s_nop 1
    v_add_u32_dpp v5, v5, v5 row_ror:4 row_mask:0xf bank_mask:0xf
    s_nop 1
    v_add_u32_dpp v5, v5, v5 row_ror:2 row_mask:0xf bank_mask:0xf
    s_nop 1
    v_add_u32_dpp v5, v5, v5 row_ror:1 row_mask:0xf bank_mask:0xf
    s_nop 1
    v_readlane_b32 s74, v5, 0
    v_readlane_b32 s73, v5, 16
    s_add_u32 s86, s86, 3143680
    s_lshl_b32 s80, s76, 7
    s_add_u32 s80, s80, s86
    s_add_u32 s74, s74, s73
    s_lshl_b32 s74, s74, 2
    s_waitcnt lgkmcnt(0)
    s_mul_i32 s73, s84, 13
    s_sub_u32 s74, s74, s73
    v_mov_b32 v8, s74
    v_mov_b32 v9, s84
    s_mov_b64 exec, 1
    buffer_store_dwordx2 v[8:9], v2, s[52:55], s80 offen offset:2048 sc0 sc1
    s_load_dwordx2 s[32:33], s[22:23], s86 offset:0 glc
    s_load_dwordx2 s[34:35], s[22:23], s86 offset:128 glc
    s_load_dwordx2 s[36:37], s[22:23], s86 offset:256 glc
    s_load_dwordx2 s[38:39], s[22:23], s86 offset:384 glc
    s_load_dwordx2 s[40:41], s[22:23], s86 offset:512 glc
    s_load_dwordx2 s[42:43], s[22:23], s86 offset:640 glc
    s_load_dwordx2 s[44:45], s[22:23], s86 offset:768 glc
    s_load_dwordx2 s[46:47], s[22:23], s86 offset:896 glc
    s_mov_b64 exec, 0xffff
    v_mov_b32 v23, 0
    s_waitcnt lgkmcnt(0)
    v_writelane_b32 v22, s32, 0
    v_writelane_b32 v23, s33, 0
    v_writelane_b32 v22, s34, 1
    v_writelane_b32 v23, s35, 1
    v_writelane_b32 v22, s36, 2
    v_writelane_b32 v23, s37, 2
    v_writelane_b32 v22, s38, 3
    v_writelane_b32 v23, s39, 3
    v_writelane_b32 v22, s40, 4
    v_writelane_b32 v23, s41, 4
    v_writelane_b32 v22, s42, 5
    v_writelane_b32 v23, s43, 5
    v_writelane_b32 v22, s44, 6
    v_writelane_b32 v23, s45, 6
    v_writelane_b32 v22, s46, 7
    v_writelane_b32 v23, s47, 7
    v_sub_u32 v9, s84, v23
    v_cmp_gt_u32 vcc, 0x1000, v9
    v_sub_u32 v8, s74, v22
    s_and_b32 vcc_lo, vcc_lo, 255
    s_bitset0_b32 vcc_lo, s76
    v_cndmask_b32 v8, 0, v8, vcc
    s_nop 1
    v_add_u32_dpp v8, v8, v8 row_ror:8 row_mask:0xf bank_mask:0xf
    s_nop 1
    v_add_u32_dpp v8, v8, v8 row_ror:4 row_mask:0xf bank_mask:0xf
    s_nop 1
    v_add_u32_dpp v8, v8, v8 row_ror:2 row_mask:0xf bank_mask:0xf
    s_nop 1
    v_add_u32_dpp v8, v8, v8 row_ror:1 row_mask:0xf bank_mask:0xf
    s_nop 1
    v_ashrrev_i32 v8, 9, v8
    v_max_i32 v8, -5, v8
    v_min_i32 v8, 40, v8
    v_add_u32 v8, 0x400, v8
    s_mov_b64 exec, 1
    buffer_store_short v8, v2, s[60:63], 0 offen offset:192
L_cn:
    s_cmp_eq_u32 s81, 0
    s_cbranch_scc1 L_c
    s_endpgm
.section .rodata,"a"
.p2align 6
.amdhsa_kernel standalone__kv_cache_quant_int4_int2_kv_with_per_channel_or_per_token_scales__decode_kernel
  .amdhsa_next_free_vgpr 246
  .amdhsa_next_free_sgpr 102
  .amdhsa_accum_offset 248
  .amdhsa_float_denorm_mode_32 3
  .amdhsa_group_segment_fixed_size 0
  .amdhsa_kernarg_size 80
  .amdhsa_user_sgpr_count 2
  .amdhsa_user_sgpr_kernarg_segment_ptr 1
  .amdhsa_system_sgpr_workgroup_id_x 1
.end_amdhsa_kernel
```

```asm
; @launch grid=(256,1,1) block=(256,1,1) lds=98304
.amdgcn_target "amdgcn-amd-amdhsa--gfx950"
.text
.globl standalone__kv_cache_quant_int4_int2_kv_with_per_channel_or_per_token_scales__decode_kernel
.p2align 12
.type standalone__kv_cache_quant_int4_int2_kv_with_per_channel_or_per_token_scales__decode_kernel,@function
standalone__kv_cache_quant_int4_int2_kv_with_per_channel_or_per_token_scales__decode_kernel:
    s_cmp_ge_u32 s2, 256
    s_cbranch_scc1 L_end
    s_load_dwordx16 s[4:19], s[0:1], 0
    s_load_dwordx4 s[20:23], s[0:1], 64
    s_and_b32 s80, s2, 7
    s_lshr_b32 s2, s2, 3
    s_lshl_b32 s80, s80, 5
    s_or_b32 s2, s2, s80
    s_mov_b32 s3, s2
    v_lshrrev_b32 v229, 6, v0
    v_and_b32 v0, 63, v0
    v_readfirstlane_b32 s68, v229
    s_lshr_b32 s79, s2, 5
    s_and_b32 s92, s2, 31
    s_mov_b32 s66, 0xaaaaaaaa
    s_mov_b32 s67, 0xaaaaaaaa
    s_cmp_eq_u32 s68, 1
    s_cbranch_scc1 L_service
    s_cmp_eq_u32 s68, 2
    s_cbranch_scc1 L_ticket
    s_cmp_eq_u32 s68, 3
    s_cbranch_scc1 L_ctl
    s_mov_b64 vcc, 0
    s_setprio 1
    v_and_b32 v235, 15, v0
    v_lshrrev_b32 v234, 4, v0
    v_mul_u32_u24 v1, 768, v234
    v_lshl_add_u32 v1, v235, 4, v1
    v_lshlrev_b32 v2, 3, v235
    v_bfrev_b32 v231, v235
    v_lshrrev_b32 v231, 28, v231
    v_and_b32 v232, 3, v231
    v_lshl_add_u32 v3, v232, 2, v234
    v_lshlrev_b32 v3, 1, v3
    v_lshrrev_b32 v231, 2, v231
    v_lshl_add_u32 v3, v231, 10, v3
    v_lshlrev_b32 v239, 2, v0
    v_add_u32 v240, 3840, v239
    v_add_u32 v239, 3584, v239
    v_lshlrev_b32 v241, 4, v0
    v_mov_b32 v242, 0
    v_mov_b32 v243, 1
    v_lshlrev_b32 v224, 2, v0
    v_mov_b32 v225, 1
    v_mov_b32 v226, 260
    s_mul_i32 s58, s79, 0
    s_and_b32 s94, s92, 448
    s_add_u32 s94, s94, s58
    s_add_u32 s94, s94, 512
    s_add_u32 s58, s58, s92
    s_and_b32 s58, s58, 511
    s_lshr_b32 s59, s3, 5
    s_lshl_b32 s69, s79, 9
    s_add_u32 s59, s59, 24
    s_lshl_b32 s59, s59, 9
    s_mov_b32 s64, 0xcccccccc
    s_mov_b32 s65, 0xcccccccc
    s_mov_b32 s60, 0x6fd53b95
    s_mov_b32 s62, 0x80000001
    s_mov_b32 s61, 0x6fd53b95
    s_mov_b32 s63, 0x80000001
    s_and_b32 s80, s92, 3
    s_cmp_eq_u32 s80, 1
    s_mov_b32 s81, 0x11119143
    s_cselect_b32 s81, 0x11659143, s81
    s_cmp_eq_u32 s80, 0
    s_cselect_b32 s81, 0x80659143, s81
    s_andn2_b32 s82, s92, 3
    s_lshr_b32 s81, s81, s82
    s_and_b32 s81, s81, 15
    s_lshl_b32 m0, s81, 1
    s_lshl_b32 s80, s80, 21
    s_max_u32 s80, s80, 64
    s_sub_u32 s80, s80, 64
    s_mul_i32 s82, s79, 25165824
    s_cmp_eq_u32 s81, 1
    s_cselect_b32 s82, s82, 0
    s_add_u32 s80, s80, s82
    v_mov_b32 v236, s80
    s_waitcnt lgkmcnt(0)
    s_movrels_b64 s[84:85], s[4:5]
    global_load_dword v236, v236, s[84:85]
    s_mov_b32 s24, s6
    s_and_b32 s25, s7, 0xffff
    s_mov_b32 s26, 805306368
    s_mov_b32 s27, 0x00020000
    s_mov_b32 s48, s4
    s_and_b32 s49, s5, 0xffff
    s_mov_b32 s50, 12288
    s_mov_b32 s51, 0x00020000
    s_mov_b32 s32, s10
    s_and_b32 s33, s11, 0xffff
    s_mov_b32 s34, 6291456
    s_mov_b32 s35, 0x00020000
    s_mov_b32 s36, s12
    s_and_b32 s37, s13, 0xffff
    s_mov_b32 s38, 6291456
    s_mov_b32 s39, 0x00020000
    s_add_u32 s70, s69, s92
    s_mov_b32 s91, 1
    s_lshr_b32 s74, s70, 9
    s_mul_i32 s74, s74, 384
    buffer_load_dwordx2 v[192:193], v2, s[48:51], s74 offen offset:0
    buffer_load_dwordx2 v[194:195], v2, s[48:51], s74 offen offset:128
    buffer_load_dwordx2 v[196:197], v2, s[48:51], s74 offen offset:256
    s_and_b32 s80, s70, 31
    s_sub_u32 s72, s70, s80
    s_lshr_b32 s80, s80, 2
    s_add_u32 s72, s72, s80
    s_mul_i32 s72, s72, 384
    buffer_load_dwordx2 v[132:133], v2, s[32:35], s72 offen offset:0
    buffer_load_dwordx2 v[134:135], v2, s[32:35], s72 offen offset:128
    buffer_load_dwordx2 v[136:137], v2, s[32:35], s72 offen offset:256
    buffer_load_dwordx2 v[138:139], v2, s[36:39], s72 offen offset:0
    buffer_load_dwordx2 v[140:141], v2, s[36:39], s72 offen offset:128
    buffer_load_dwordx2 v[142:143], v2, s[36:39], s72 offen offset:256
    s_mul_i32 s71, s70, 49152
    s_and_b32 s80, s70, 31
    s_mul_i32 s80, s80, 36864
    s_sub_u32 s71, s71, s80
    buffer_load_dwordx4 v[4:7], v1, s[24:27], s71 offen offset:0 nt
    buffer_load_dwordx4 v[8:11], v1, s[24:27], s71 offen offset:256 nt
    buffer_load_dwordx4 v[12:15], v1, s[24:27], s71 offen offset:512 nt
    s_add_u32 s71, s71, 3072
    buffer_load_dwordx4 v[16:19], v1, s[24:27], s71 offen offset:0 nt
    s_add_u32 s72, s72, 3072
    buffer_load_dwordx2 v[156:157], v2, s[32:35], s72 offen offset:0
    buffer_load_dwordx2 v[158:159], v2, s[32:35], s72 offen offset:128
    buffer_load_dwordx2 v[160:161], v2, s[32:35], s72 offen offset:256
    buffer_load_dwordx2 v[162:163], v2, s[36:39], s72 offen offset:0
    buffer_load_dwordx2 v[164:165], v2, s[36:39], s72 offen offset:128
    buffer_load_dwordx2 v[166:167], v2, s[36:39], s72 offen offset:256
    buffer_load_dwordx4 v[20:23], v1, s[24:27], s71 offen offset:256 nt
    buffer_load_dwordx4 v[24:27], v1, s[24:27], s71 offen offset:512 nt
    s_add_u32 s71, s71, 3072
    buffer_load_dwordx4 v[28:31], v1, s[24:27], s71 offen offset:0 nt
    buffer_load_dwordx4 v[32:35], v1, s[24:27], s71 offen offset:256 nt
    buffer_load_dwordx4 v[36:39], v1, s[24:27], s71 offen offset:512 nt
    s_add_u32 s71, s71, 3072
    buffer_load_dwordx4 v[40:43], v1, s[24:27], s71 offen offset:0 nt
    buffer_load_dwordx4 v[44:47], v1, s[24:27], s71 offen offset:256 nt
    buffer_load_dwordx4 v[48:51], v1, s[24:27], s71 offen offset:512 nt
    s_add_u32 s71, s71, 384000
    buffer_load_dwordx4 v[52:55], v1, s[24:27], s71 offen offset:0 nt
    buffer_load_dwordx4 v[56:59], v1, s[24:27], s71 offen offset:256 nt
    buffer_load_dwordx4 v[60:63], v1, s[24:27], s71 offen offset:512 nt
    s_add_u32 s71, s71, 3072
    buffer_load_dwordx4 v[64:67], v1, s[24:27], s71 offen offset:0 nt
    s_add_u32 s72, s72, 3072
    buffer_load_dwordx2 v[168:169], v2, s[32:35], s72 offen offset:0
    buffer_load_dwordx2 v[170:171], v2, s[32:35], s72 offen offset:128
    buffer_load_dwordx2 v[172:173], v2, s[32:35], s72 offen offset:256
    buffer_load_dwordx2 v[174:175], v2, s[36:39], s72 offen offset:0
    buffer_load_dwordx2 v[176:177], v2, s[36:39], s72 offen offset:128
    buffer_load_dwordx2 v[178:179], v2, s[36:39], s72 offen offset:256
    buffer_load_dwordx4 v[68:71], v1, s[24:27], s71 offen offset:256 nt
    buffer_load_dwordx4 v[72:75], v1, s[24:27], s71 offen offset:512 nt
    s_add_u32 s71, s71, 3072
    buffer_load_dwordx4 v[76:79], v1, s[24:27], s71 offen offset:0 nt
    buffer_load_dwordx4 v[80:83], v1, s[24:27], s71 offen offset:256 nt
    buffer_load_dwordx4 v[84:87], v1, s[24:27], s71 offen offset:512 nt
    s_add_u32 s71, s71, 3072
    buffer_load_dwordx4 v[88:91], v1, s[24:27], s71 offen offset:0 nt
    buffer_load_dwordx4 v[92:95], v1, s[24:27], s71 offen offset:256 nt
    buffer_load_dwordx4 v[96:99], v1, s[24:27], s71 offen offset:512 nt
    s_mov_b32 s28, s8
    s_and_b32 s29, s9, 0xffff
    s_mov_b32 s30, 805306368
    s_mov_b32 s31, 0x00020000
    s_mov_b32 s40, s14
    s_and_b32 s41, s15, 0xffff
    s_mov_b32 s42, 2097152
    s_mov_b32 s43, 0x00020000
    s_mov_b32 s44, s16
    s_and_b32 s45, s17, 0xffff
    s_mov_b32 s46, 2097152
    s_mov_b32 s47, 0x00020000
    s_mov_b32 s52, s22
    s_and_b32 s53, s23, 0xffff
    s_mov_b32 s54, 25165824
    s_mov_b32 s55, 0x00020000
    v_mov_b32 v229, s2
    v_and_b32 v231, 15, v0
    v_lshrrev_b32 v230, 5, v229
    v_lshl_add_u32 v231, v230, 4, v231
    v_lshrrev_b32 v232, 4, v0
    v_lshl_add_u32 v231, v232, 7, v231
    s_lshl_b32 s82, s79, 3
    s_mov_b32 s80, 0xeff4fa00
    s_mov_b32 s81, 0xdbe0e5ea
    s_lshr_b64 s[80:81], s[80:81], s82
    s_sext_i32_i8 s80, s80
    s_mov_b32 exec_lo, 0x0
    s_mov_b32 exec_hi, 0x3ff
    v_add_u32 v231, s80, v231
    s_mov_b32 s80, 0xeff43d4c
    s_mov_b32 s81, 0xdbe0e5ea
    s_lshr_b64 s[80:81], s[80:81], s82
    s_sext_i32_i8 s80, s80
    s_mov_b32 exec_lo, 0x0
    s_mov_b32 exec_hi, 0x400
    v_add_u32 v231, s80, v231
    s_mov_b32 s80, 0x2c37424d
    s_mov_b32 s81, 0xb1621
    s_lshr_b64 s[80:81], s[80:81], s82
    s_sext_i32_i8 s80, s80
    s_mov_b32 exec_lo, 0x0
    s_mov_b32 exec_hi, 0xf800
    v_add_u32 v231, s80, v231
    s_mov_b64 exec, -1
    v_and_b32 v229, 31, v229
    v_lshl_add_u32 v245, v231, 5, v229
    s_mov_b32 s4, 0x10000
    s_mov_b32 s5, 0x10401
    s_cmp_eq_u32 s79, 1
    s_cselect_b32 s4, 0x10000, s4
    s_cselect_b32 s5, 0x14441, s5
    s_cmp_eq_u32 s79, 2
    s_cselect_b32 s4, 0x10000, s4
    s_cselect_b32 s5, 0x10801, s5
    s_cmp_eq_u32 s79, 3
    s_cselect_b32 s4, 0x10000, s4
    s_cselect_b32 s5, 0x10803, s5
    s_cmp_eq_u32 s79, 4
    s_cselect_b32 s4, 0x10000, s4
    s_cselect_b32 s5, 0x18841, s5
    s_cmp_eq_u32 s79, 5
    s_cselect_b32 s4, 0x10000, s4
    s_cselect_b32 s5, 0x10801, s5
    s_cmp_eq_u32 s79, 6
    s_cselect_b32 s4, 0x10000, s4
    s_cselect_b32 s5, 0x10801, s5
    s_cmp_eq_u32 s79, 7
    s_cselect_b32 s4, 0x10000, s4
    s_cselect_b32 s5, 0x10821, s5
    s_mov_b32 s7, 0xf149f2ca
    s_mov_b32 s77, 0xf149f2ca
    v_lshlrev_b32 v225, 4, v0
    v_mov_b32 v100, 0
    v_mov_b32 v101, 0
    v_mov_b32 v102, 0
    v_mov_b32 v103, 0
    s_lshl_b32 s78, s3, 12
    s_mov_b64 s[88:89], 0
    v_mov_b32 v216, 0xf149f2ca
    v_mov_b32 v217, 0
    v_mov_b32 v218, 0
    v_mov_b32 v204, 0
    v_mov_b32 v205, 0
    v_mov_b32 v206, 0
    v_mov_b32 v207, 0
    v_mov_b32 v208, 0
    v_mov_b32 v209, 0
    v_mov_b32 v210, 0
    v_mov_b32 v211, 0
    v_mov_b32 v212, 0
    v_mov_b32 v213, 0
    v_mov_b32 v214, 0
    v_mov_b32 v215, 0
    s_barrier
    s_waitcnt vmcnt(36)
    v_lshlrev_b32 v108, 16, v192
    v_and_b32 v109, 0xffff0000, v192
    v_pk_mul_f32 v[108:109], v[108:109], s[60:61]
    v_lshlrev_b32 v110, 16, v193
    v_and_b32 v111, 0xffff0000, v193
    v_pk_mul_f32 v[110:111], v[110:111], s[60:61]
    v_lshlrev_b32 v112, 16, v194
    v_and_b32 v113, 0xffff0000, v194
    v_pk_mul_f32 v[112:113], v[112:113], s[60:61]
    v_lshlrev_b32 v114, 16, v195
    v_and_b32 v115, 0xffff0000, v195
    v_pk_mul_f32 v[114:115], v[114:115], s[60:61]
    v_lshlrev_b32 v116, 16, v196
    v_and_b32 v117, 0xffff0000, v196
    v_pk_mul_f32 v[116:117], v[116:117], s[60:61]
    v_lshlrev_b32 v118, 16, v197
    v_and_b32 v119, 0xffff0000, v197
    v_pk_mul_f32 v[118:119], v[118:119], s[60:61]
    v_lshlrev_b32 v234, 16, v132
    v_and_b32 v235, 0xffff0000, v132
    v_pk_mul_f32 v[120:121], v[234:235], v[108:109]
    v_lshlrev_b32 v234, 16, v138
    v_and_b32 v235, 0xffff0000, v138
    v_pk_mul_f32 v[200:201], v[120:121], v[234:235]
    v_lshlrev_b32 v234, 16, v133
    v_and_b32 v235, 0xffff0000, v133
    v_pk_mul_f32 v[122:123], v[234:235], v[110:111]
    v_lshlrev_b32 v234, 16, v139
    v_and_b32 v235, 0xffff0000, v139
    v_pk_fma_f32 v[200:201], v[122:123], v[234:235], v[200:201]
    v_lshlrev_b32 v234, 16, v134
    v_and_b32 v235, 0xffff0000, v134
    v_pk_mul_f32 v[124:125], v[234:235], v[112:113]
    v_lshlrev_b32 v234, 16, v140
    v_and_b32 v235, 0xffff0000, v140
    v_pk_fma_f32 v[200:201], v[124:125], v[234:235], v[200:201]
    v_lshlrev_b32 v234, 16, v135
    v_and_b32 v235, 0xffff0000, v135
    v_pk_mul_f32 v[126:127], v[234:235], v[114:115]
    v_lshlrev_b32 v234, 16, v141
    v_and_b32 v235, 0xffff0000, v141
    v_pk_fma_f32 v[200:201], v[126:127], v[234:235], v[200:201]
    v_lshlrev_b32 v234, 16, v136
    v_and_b32 v235, 0xffff0000, v136
    v_pk_mul_f32 v[128:129], v[234:235], v[116:117]
    v_lshlrev_b32 v234, 16, v142
    v_and_b32 v235, 0xffff0000, v142
    v_pk_fma_f32 v[200:201], v[128:129], v[234:235], v[200:201]
    v_lshlrev_b32 v234, 16, v137
    v_and_b32 v235, 0xffff0000, v137
    v_pk_mul_f32 v[130:131], v[234:235], v[118:119]
    v_lshlrev_b32 v234, 16, v143
    v_and_b32 v235, 0xffff0000, v143
    v_pk_fma_f32 v[200:201], v[130:131], v[234:235], v[200:201]
    v_pk_mul_f32 v[200:201], v[200:201], s[62:63]
    s_mov_b32 s76, 63
L_loop0:
    s_waitcnt vmcnt(35)
    v_pk_fma_f32 v[198:199], v[120:121], v[4:5], v[200:201]
    v_pk_fma_f32 v[198:199], v[122:123], v[6:7], v[198:199]
    ds_read_b32 v244, v243 offset:147
    s_add_u32 s71, s71, 384000
    s_cbranch_vccnz L_th24_0
L_tb24_0:
    buffer_load_dwordx4 v[4:7], v1, s[24:27], s71 offen offset:0 nt
    v_add_f32_dpp v229, v228, v228 row_ror:8 row_mask:0xf bank_mask:0xc
    s_waitcnt vmcnt(35)
    v_pk_fma_f32 v[198:199], v[124:125], v[8:9], v[198:199]
    v_pk_fma_f32 v[198:199], v[126:127], v[10:11], v[198:199]
    buffer_load_dwordx4 v[8:11], v1, s[24:27], s71 offen offset:256 nt
    v_add_f32_dpp v230, v229, v229 row_shr:4 row_mask:0xf bank_mask:0xa
    s_waitcnt vmcnt(35)
    v_pk_fma_f32 v[198:199], v[128:129], v[12:13], v[198:199]
    v_pk_fma_f32 v[198:199], v[130:131], v[14:15], v[198:199]
    s_waitcnt lgkmcnt(0)
    v_cmp_lt_u32 vcc, v0, v244
    ds_add_u32 v224, v243 offset:3328
    buffer_load_dwordx4 v[12:15], v1, s[24:27], s71 offen offset:512 nt
    v_add_f32_dpp v232, v230, v230 quad_perm:[2,3,0,1] row_mask:0xf bank_mask:0xf
    v_add_f32 v228, v198, v199
    s_waitcnt vmcnt(35)
    v_pk_fma_f32 v[198:199], v[120:121], v[16:17], v[200:201]
    v_pk_fma_f32 v[198:199], v[122:123], v[18:19], v[198:199]
    s_add_u32 s71, s71, 3072
    s_cbranch_vccnz L_th27_0
L_tb27_0:
    buffer_load_dwordx4 v[16:19], v1, s[24:27], s71 offen offset:0 nt
    v_cndmask_b32 v232, v231, v232, s[64:65]
    v_add_f32_dpp v229, v228, v228 row_ror:8 row_mask:0xf bank_mask:0x3
    s_waitcnt vmcnt(29)
    v_pk_fma_f32 v[198:199], v[124:125], v[20:21], v[198:199]
    v_pk_fma_f32 v[198:199], v[126:127], v[22:23], v[198:199]
    s_add_u32 s72, s72, 3072
    buffer_load_dwordx2 v[180:181], v2, s[32:35], s72 offen offset:0
    buffer_load_dwordx2 v[182:183], v2, s[32:35], s72 offen offset:128
    buffer_load_dwordx2 v[184:185], v2, s[32:35], s72 offen offset:256
    buffer_load_dwordx2 v[186:187], v2, s[36:39], s72 offen offset:0
    buffer_load_dwordx2 v[188:189], v2, s[36:39], s72 offen offset:128
    buffer_load_dwordx2 v[190:191], v2, s[36:39], s72 offen offset:256
    buffer_load_dwordx4 v[20:23], v1, s[24:27], s71 offen offset:256 nt
    v_add_f32_dpp v231, v232, v232 quad_perm:[1,0,3,2] row_mask:0xf bank_mask:0xf
    v_lshlrev_b32 v234, 16, v156
    v_and_b32 v235, 0xffff0000, v156
    v_pk_mul_f32 v[144:145], v[234:235], v[108:109]
    v_lshlrev_b32 v234, 16, v162
    v_and_b32 v235, 0xffff0000, v162
    s_waitcnt vmcnt(35)
    v_pk_fma_f32 v[198:199], v[128:129], v[24:25], v[198:199]
    v_pk_fma_f32 v[198:199], v[130:131], v[26:27], v[198:199]
    ds_add_u32 v224, v243 offset:3328
    buffer_load_dwordx4 v[24:27], v1, s[24:27], s71 offen offset:512 nt
    v_cndmask_b32 v233, v233, v231, s[66:67]
    v_mul_f32 v233, 0x58000000, v233
    ds_write_b32 v239, v233
    v_add_u32 v239, 256, v239
    v_add_f32 v228, v198, v199
    v_pk_mul_f32 v[202:203], v[144:145], v[234:235]
    v_lshlrev_b32 v234, 16, v157
    v_and_b32 v235, 0xffff0000, v157
    v_pk_mul_f32 v[146:147], v[234:235], v[110:111]
    v_lshlrev_b32 v234, 16, v163
    s_waitcnt vmcnt(35)
    v_pk_fma_f32 v[198:199], v[120:121], v[28:29], v[200:201]
    v_pk_fma_f32 v[198:199], v[122:123], v[30:31], v[198:199]
    s_add_u32 s71, s71, 3072
    s_cbranch_vccnz L_th30_0
L_tb30_0:
    buffer_load_dwordx4 v[28:31], v1, s[24:27], s71 offen offset:0 nt
    v_add_f32_dpp v229, v228, v228 row_ror:8 row_mask:0xf bank_mask:0xc
    v_and_b32 v235, 0xffff0000, v163
    v_pk_fma_f32 v[202:203], v[146:147], v[234:235], v[202:203]
    v_lshlrev_b32 v234, 16, v158
    v_and_b32 v235, 0xffff0000, v158
    v_pk_mul_f32 v[148:149], v[234:235], v[112:113]
    s_waitcnt vmcnt(35)
    v_pk_fma_f32 v[198:199], v[124:125], v[32:33], v[198:199]
    v_pk_fma_f32 v[198:199], v[126:127], v[34:35], v[198:199]
    buffer_load_dwordx4 v[32:35], v1, s[24:27], s71 offen offset:256 nt
    v_add_f32_dpp v230, v229, v229 row_shl:4 row_mask:0xf bank_mask:0x5
    v_lshlrev_b32 v234, 16, v164
    v_and_b32 v235, 0xffff0000, v164
    v_pk_fma_f32 v[202:203], v[148:149], v[234:235], v[202:203]
    v_lshlrev_b32 v234, 16, v159
    v_and_b32 v235, 0xffff0000, v159
    s_waitcnt vmcnt(35)
    v_pk_fma_f32 v[198:199], v[128:129], v[36:37], v[198:199]
    v_pk_fma_f32 v[198:199], v[130:131], v[38:39], v[198:199]
    ds_add_u32 v224, v243 offset:3328
    buffer_load_dwordx4 v[36:39], v1, s[24:27], s71 offen offset:512 nt
    v_add_f32 v228, v198, v199
    v_pk_mul_f32 v[150:151], v[234:235], v[114:115]
    v_lshlrev_b32 v234, 16, v165
    v_and_b32 v235, 0xffff0000, v165
    v_pk_fma_f32 v[202:203], v[150:151], v[234:235], v[202:203]
    v_lshlrev_b32 v234, 16, v160
    s_waitcnt vmcnt(35)
    v_pk_fma_f32 v[198:199], v[120:121], v[40:41], v[200:201]
    v_pk_fma_f32 v[198:199], v[122:123], v[42:43], v[198:199]
    s_add_u32 s71, s71, 3072
    s_cbranch_vccnz L_th33_0
L_tb33_0:
    buffer_load_dwordx4 v[40:43], v1, s[24:27], s71 offen offset:0 nt
    v_add_f32_dpp v229, v228, v228 row_ror:8 row_mask:0xf bank_mask:0x3
    v_and_b32 v235, 0xffff0000, v160
    v_pk_mul_f32 v[152:153], v[234:235], v[116:117]
    v_lshlrev_b32 v234, 16, v166
    v_and_b32 v235, 0xffff0000, v166
    v_pk_fma_f32 v[202:203], v[152:153], v[234:235], v[202:203]
    s_waitcnt vmcnt(35)
    v_pk_fma_f32 v[198:199], v[124:125], v[44:45], v[198:199]
    v_pk_fma_f32 v[198:199], v[126:127], v[46:47], v[198:199]
    buffer_load_dwordx4 v[44:47], v1, s[24:27], s71 offen offset:256 nt
    v_lshlrev_b32 v234, 16, v161
    v_and_b32 v235, 0xffff0000, v161
    v_pk_mul_f32 v[154:155], v[234:235], v[118:119]
    v_lshlrev_b32 v234, 16, v167
    v_and_b32 v235, 0xffff0000, v167
    s_waitcnt vmcnt(35)
    v_pk_fma_f32 v[198:199], v[128:129], v[48:49], v[198:199]
    v_pk_fma_f32 v[198:199], v[130:131], v[50:51], v[198:199]
    ds_add_u32 v224, v243 offset:3328
    buffer_load_dwordx4 v[48:51], v1, s[24:27], s71 offen offset:512 nt
    v_add_f32 v228, v198, v199
    v_pk_fma_f32 v[202:203], v[154:155], v[234:235], v[202:203]
    v_pk_mul_f32 v[202:203], v[202:203], s[62:63]
    s_waitcnt vmcnt(35)
    v_pk_fma_f32 v[198:199], v[144:145], v[52:53], v[202:203]
    v_pk_fma_f32 v[198:199], v[146:147], v[54:55], v[198:199]
    ds_read_b32 v244, v243 offset:147
    v_readlane_b32 s70, v245, s91
    s_add_u32 s91, s91, 1
    s_lshr_b32 s74, s70, 9
    s_mul_i32 s74, s74, 384
    buffer_load_dwordx2 v[192:193], v2, s[48:51], s74 offen offset:0
    buffer_load_dwordx2 v[194:195], v2, s[48:51], s74 offen offset:128
    buffer_load_dwordx2 v[196:197], v2, s[48:51], s74 offen offset:256
    s_add_u32 s71, s71, 384000
    s_cbranch_vccnz L_th36_0
L_tb36_0:
    buffer_load_dwordx4 v[52:55], v1, s[24:27], s71 offen offset:0 nt
    v_add_f32_dpp v229, v228, v228 row_ror:8 row_mask:0xf bank_mask:0xc
    s_waitcnt vmcnt(38)
    v_pk_fma_f32 v[198:199], v[148:149], v[56:57], v[198:199]
    v_pk_fma_f32 v[198:199], v[150:151], v[58:59], v[198:199]
    buffer_load_dwordx4 v[56:59], v1, s[24:27], s71 offen offset:256 nt
    v_add_f32_dpp v230, v229, v229 row_shr:4 row_mask:0xf bank_mask:0xa
    s_waitcnt vmcnt(38)
    v_pk_fma_f32 v[198:199], v[152:153], v[60:61], v[198:199]
    v_pk_fma_f32 v[198:199], v[154:155], v[62:63], v[198:199]
    s_waitcnt lgkmcnt(0)
    v_cmp_lt_u32 vcc, v0, v244
    ds_add_u32 v224, v243 offset:3328
    buffer_load_dwordx4 v[60:63], v1, s[24:27], s71 offen offset:512 nt
    v_add_f32_dpp v231, v230, v230 quad_perm:[2,3,0,1] row_mask:0xf bank_mask:0xf
    v_add_f32 v228, v198, v199
    s_waitcnt vmcnt(38)
    v_pk_fma_f32 v[198:199], v[144:145], v[64:65], v[202:203]
    v_pk_fma_f32 v[198:199], v[146:147], v[66:67], v[198:199]
    s_add_u32 s71, s71, 3072
    s_cbranch_vccnz L_th39_0
L_tb39_0:
    buffer_load_dwordx4 v[64:67], v1, s[24:27], s71 offen offset:0 nt
    v_add_f32_dpp v229, v228, v228 row_ror:8 row_mask:0xf bank_mask:0x3
    s_waitcnt vmcnt(32)
    v_pk_fma_f32 v[198:199], v[148:149], v[68:69], v[198:199]
    v_pk_fma_f32 v[198:199], v[150:151], v[70:71], v[198:199]
    s_and_b32 s80, s70, 31
    s_sub_u32 s72, s70, s80
    s_lshr_b32 s80, s80, 2
    s_add_u32 s72, s72, s80
    s_mul_i32 s72, s72, 384
    buffer_load_dwordx2 v[132:133], v2, s[32:35], s72 offen offset:0
    buffer_load_dwordx2 v[134:135], v2, s[32:35], s72 offen offset:128
    buffer_load_dwordx2 v[136:137], v2, s[32:35], s72 offen offset:256
    buffer_load_dwordx2 v[138:139], v2, s[36:39], s72 offen offset:0
    buffer_load_dwordx2 v[140:141], v2, s[36:39], s72 offen offset:128
    buffer_load_dwordx2 v[142:143], v2, s[36:39], s72 offen offset:256
    buffer_load_dwordx4 v[68:71], v1, s[24:27], s71 offen offset:256 nt
    v_lshlrev_b32 v234, 16, v168
    v_and_b32 v235, 0xffff0000, v168
    v_pk_mul_f32 v[120:121], v[234:235], v[108:109]
    v_lshlrev_b32 v234, 16, v174
    v_and_b32 v235, 0xffff0000, v174
    s_waitcnt vmcnt(38)
    v_pk_fma_f32 v[198:199], v[152:153], v[72:73], v[198:199]
    v_pk_fma_f32 v[198:199], v[154:155], v[74:75], v[198:199]
    ds_add_u32 v224, v243 offset:3328
    buffer_load_dwordx4 v[72:75], v1, s[24:27], s71 offen offset:512 nt
    v_add_f32 v228, v198, v199
    v_pk_mul_f32 v[200:201], v[120:121], v[234:235]
    v_lshlrev_b32 v234, 16, v169
    v_and_b32 v235, 0xffff0000, v169
    v_pk_mul_f32 v[122:123], v[234:235], v[110:111]
    v_lshlrev_b32 v234, 16, v175
    s_waitcnt vmcnt(38)
    v_pk_fma_f32 v[198:199], v[144:145], v[76:77], v[202:203]
    v_pk_fma_f32 v[198:199], v[146:147], v[78:79], v[198:199]
    s_add_u32 s71, s71, 3072
    s_cbranch_vccnz L_th42_0
L_tb42_0:
    buffer_load_dwordx4 v[76:79], v1, s[24:27], s71 offen offset:0 nt
    v_add_f32_dpp v229, v228, v228 row_ror:8 row_mask:0xf bank_mask:0xc
    v_and_b32 v235, 0xffff0000, v175
    v_pk_fma_f32 v[200:201], v[122:123], v[234:235], v[200:201]
    v_lshlrev_b32 v234, 16, v170
    v_and_b32 v235, 0xffff0000, v170
    v_pk_mul_f32 v[124:125], v[234:235], v[112:113]
    s_waitcnt vmcnt(38)
    v_pk_fma_f32 v[198:199], v[148:149], v[80:81], v[198:199]
    v_pk_fma_f32 v[198:199], v[150:151], v[82:83], v[198:199]
    buffer_load_dwordx4 v[80:83], v1, s[24:27], s71 offen offset:256 nt
    v_add_f32_dpp v230, v229, v229 row_shl:4 row_mask:0xf bank_mask:0x5
    v_lshlrev_b32 v234, 16, v176
    v_and_b32 v235, 0xffff0000, v176
    v_pk_fma_f32 v[200:201], v[124:125], v[234:235], v[200:201]
    v_lshlrev_b32 v234, 16, v171
    v_and_b32 v235, 0xffff0000, v171
    s_waitcnt vmcnt(38)
    v_pk_fma_f32 v[198:199], v[152:153], v[84:85], v[198:199]
    v_pk_fma_f32 v[198:199], v[154:155], v[86:87], v[198:199]
    ds_add_u32 v224, v243 offset:3328
    buffer_load_dwordx4 v[84:87], v1, s[24:27], s71 offen offset:512 nt
    v_add_f32 v228, v198, v199
    v_pk_mul_f32 v[126:127], v[234:235], v[114:115]
    v_lshlrev_b32 v234, 16, v177
    v_and_b32 v235, 0xffff0000, v177
    v_pk_fma_f32 v[200:201], v[126:127], v[234:235], v[200:201]
    v_lshlrev_b32 v234, 16, v172
    s_waitcnt vmcnt(38)
    v_pk_fma_f32 v[198:199], v[144:145], v[88:89], v[202:203]
    v_pk_fma_f32 v[198:199], v[146:147], v[90:91], v[198:199]
    s_add_u32 s71, s71, 3072
    s_cbranch_vccnz L_th45_0
L_tb45_0:
    buffer_load_dwordx4 v[88:91], v1, s[24:27], s71 offen offset:0 nt
    v_add_f32_dpp v229, v228, v228 row_ror:8 row_mask:0xf bank_mask:0x3
    v_and_b32 v235, 0xffff0000, v172
    v_pk_mul_f32 v[128:129], v[234:235], v[116:117]
    v_lshlrev_b32 v234, 16, v178
    v_and_b32 v235, 0xffff0000, v178
    v_pk_fma_f32 v[200:201], v[128:129], v[234:235], v[200:201]
    s_waitcnt vmcnt(38)
    v_pk_fma_f32 v[198:199], v[148:149], v[92:93], v[198:199]
    v_pk_fma_f32 v[198:199], v[150:151], v[94:95], v[198:199]
    buffer_load_dwordx4 v[92:95], v1, s[24:27], s71 offen offset:256 nt
    v_lshlrev_b32 v234, 16, v173
    v_and_b32 v235, 0xffff0000, v173
    v_pk_mul_f32 v[130:131], v[234:235], v[118:119]
    v_lshlrev_b32 v234, 16, v179
    v_and_b32 v235, 0xffff0000, v179
    s_waitcnt vmcnt(38)
    v_pk_fma_f32 v[198:199], v[152:153], v[96:97], v[198:199]
    v_pk_fma_f32 v[198:199], v[154:155], v[98:99], v[198:199]
    ds_add_u32 v224, v243 offset:3328
    buffer_load_dwordx4 v[96:99], v1, s[24:27], s71 offen offset:512 nt
    v_add_f32 v228, v198, v199
    v_pk_fma_f32 v[200:201], v[130:131], v[234:235], v[200:201]
    v_pk_mul_f32 v[200:201], v[200:201], s[62:63]
    s_waitcnt vmcnt(38)
    v_pk_fma_f32 v[198:199], v[120:121], v[4:5], v[200:201]
    v_pk_fma_f32 v[198:199], v[122:123], v[6:7], v[198:199]
    ds_read_b32 v244, v243 offset:147
    s_mul_i32 s71, s70, 49152
    s_and_b32 s80, s70, 31
    s_mul_i32 s80, s80, 36864
    s_sub_u32 s71, s71, s80
    s_cbranch_vccnz L_th0_0
L_tb0_0:
    buffer_load_dwordx4 v[4:7], v1, s[24:27], s71 offen offset:0 nt
    v_add_f32_dpp v229, v228, v228 row_ror:8 row_mask:0xf bank_mask:0xc
    s_waitcnt vmcnt(38)
    v_pk_fma_f32 v[198:199], v[124:125], v[8:9], v[198:199]
    v_pk_fma_f32 v[198:199], v[126:127], v[10:11], v[198:199]
    buffer_load_dwordx4 v[8:11], v1, s[24:27], s71 offen offset:256 nt
    v_add_f32_dpp v230, v229, v229 row_shr:4 row_mask:0xf bank_mask:0xa
    s_waitcnt vmcnt(38)
    v_pk_fma_f32 v[198:199], v[128:129], v[12:13], v[198:199]
    v_pk_fma_f32 v[198:199], v[130:131], v[14:15], v[198:199]
    s_waitcnt lgkmcnt(0)
    v_cmp_lt_u32 vcc, v0, v244
    ds_add_u32 v224, v243 offset:3328
    buffer_load_dwordx4 v[12:15], v1, s[24:27], s71 offen offset:512 nt
    v_add_f32_dpp v232, v230, v230 quad_perm:[2,3,0,1] row_mask:0xf bank_mask:0xf
    v_add_f32 v228, v198, v199
    s_waitcnt vmcnt(38)
    v_pk_fma_f32 v[198:199], v[120:121], v[16:17], v[200:201]
    v_pk_fma_f32 v[198:199], v[122:123], v[18:19], v[198:199]
    s_add_u32 s71, s71, 3072
    s_cbranch_vccnz L_th3_0
L_tb3_0:
    buffer_load_dwordx4 v[16:19], v1, s[24:27], s71 offen offset:0 nt
    v_cndmask_b32 v232, v231, v232, s[64:65]
    v_add_f32_dpp v229, v228, v228 row_ror:8 row_mask:0xf bank_mask:0x3
    s_waitcnt vmcnt(32)
    v_pk_fma_f32 v[198:199], v[124:125], v[20:21], v[198:199]
    v_pk_fma_f32 v[198:199], v[126:127], v[22:23], v[198:199]
    s_add_u32 s72, s72, 3072
    buffer_load_dwordx2 v[156:157], v2, s[32:35], s72 offen offset:0
    buffer_load_dwordx2 v[158:159], v2, s[32:35], s72 offen offset:128
    buffer_load_dwordx2 v[160:161], v2, s[32:35], s72 offen offset:256
    buffer_load_dwordx2 v[162:163], v2, s[36:39], s72 offen offset:0
    buffer_load_dwordx2 v[164:165], v2, s[36:39], s72 offen offset:128
    buffer_load_dwordx2 v[166:167], v2, s[36:39], s72 offen offset:256
    buffer_load_dwordx4 v[20:23], v1, s[24:27], s71 offen offset:256 nt
    v_add_f32_dpp v233, v232, v232 quad_perm:[1,0,3,2] row_mask:0xf bank_mask:0xf
    v_lshlrev_b32 v234, 16, v180
    v_and_b32 v235, 0xffff0000, v180
    v_pk_mul_f32 v[144:145], v[234:235], v[108:109]
    v_lshlrev_b32 v234, 16, v186
    v_and_b32 v235, 0xffff0000, v186
    s_waitcnt vmcnt(38)
    v_pk_fma_f32 v[198:199], v[128:129], v[24:25], v[198:199]
    v_pk_fma_f32 v[198:199], v[130:131], v[26:27], v[198:199]
    ds_add_u32 v224, v243 offset:3328
    buffer_load_dwordx4 v[24:27], v1, s[24:27], s71 offen offset:512 nt
    v_add_f32 v228, v198, v199
    v_pk_mul_f32 v[202:203], v[144:145], v[234:235]
    s_branch L_x0
L_w0:
    s_branch L_w1
L_x0:
    v_lshlrev_b32 v234, 16, v181
    v_and_b32 v235, 0xffff0000, v181
    v_pk_mul_f32 v[146:147], v[234:235], v[110:111]
    v_lshlrev_b32 v234, 16, v187
    s_waitcnt vmcnt(38)
    v_pk_fma_f32 v[198:199], v[120:121], v[28:29], v[200:201]
    v_pk_fma_f32 v[198:199], v[122:123], v[30:31], v[198:199]
    s_add_u32 s71, s71, 3072
    s_cbranch_vccnz L_th6_0
L_tb6_0:
    buffer_load_dwordx4 v[28:31], v1, s[24:27], s71 offen offset:0 nt
    v_add_f32_dpp v229, v228, v228 row_ror:8 row_mask:0xf bank_mask:0xc
    v_and_b32 v235, 0xffff0000, v187
    v_pk_fma_f32 v[202:203], v[146:147], v[234:235], v[202:203]
    v_lshlrev_b32 v234, 16, v182
    v_and_b32 v235, 0xffff0000, v182
    v_pk_mul_f32 v[148:149], v[234:235], v[112:113]
    s_waitcnt vmcnt(38)
    v_pk_fma_f32 v[198:199], v[124:125], v[32:33], v[198:199]
    v_pk_fma_f32 v[198:199], v[126:127], v[34:35], v[198:199]
    buffer_load_dwordx4 v[32:35], v1, s[24:27], s71 offen offset:256 nt
    v_add_f32_dpp v230, v229, v229 row_shl:4 row_mask:0xf bank_mask:0x5
    v_lshlrev_b32 v234, 16, v188
    v_and_b32 v235, 0xffff0000, v188
    v_pk_fma_f32 v[202:203], v[148:149], v[234:235], v[202:203]
    v_lshlrev_b32 v234, 16, v183
    v_and_b32 v235, 0xffff0000, v183
    s_waitcnt vmcnt(38)
    v_pk_fma_f32 v[198:199], v[128:129], v[36:37], v[198:199]
    v_pk_fma_f32 v[198:199], v[130:131], v[38:39], v[198:199]
    ds_add_u32 v224, v243 offset:3328
    buffer_load_dwordx4 v[36:39], v1, s[24:27], s71 offen offset:512 nt
    v_add_f32 v228, v198, v199
    v_pk_mul_f32 v[150:151], v[234:235], v[114:115]
    v_lshlrev_b32 v234, 16, v189
    v_and_b32 v235, 0xffff0000, v189
    v_pk_fma_f32 v[202:203], v[150:151], v[234:235], v[202:203]
    v_lshlrev_b32 v234, 16, v184
    s_waitcnt vmcnt(38)
    v_pk_fma_f32 v[198:199], v[120:121], v[40:41], v[200:201]
    v_pk_fma_f32 v[198:199], v[122:123], v[42:43], v[198:199]
    s_add_u32 s71, s71, 3072
    s_cbranch_vccnz L_th9_0
L_tb9_0:
    buffer_load_dwordx4 v[40:43], v1, s[24:27], s71 offen offset:0 nt
    v_add_f32_dpp v229, v228, v228 row_ror:8 row_mask:0xf bank_mask:0x3
    v_and_b32 v235, 0xffff0000, v184
    v_pk_mul_f32 v[152:153], v[234:235], v[116:117]
    v_lshlrev_b32 v234, 16, v190
    v_and_b32 v235, 0xffff0000, v190
    v_pk_fma_f32 v[202:203], v[152:153], v[234:235], v[202:203]
    s_waitcnt vmcnt(38)
    v_pk_fma_f32 v[198:199], v[124:125], v[44:45], v[198:199]
    v_pk_fma_f32 v[198:199], v[126:127], v[46:47], v[198:199]
    buffer_load_dwordx4 v[44:47], v1, s[24:27], s71 offen offset:256 nt
    v_lshlrev_b32 v234, 16, v185
    v_and_b32 v235, 0xffff0000, v185
    v_pk_mul_f32 v[154:155], v[234:235], v[118:119]
    v_lshlrev_b32 v234, 16, v191
    v_and_b32 v235, 0xffff0000, v191
    s_waitcnt vmcnt(38)
    v_pk_fma_f32 v[198:199], v[128:129], v[48:49], v[198:199]
    v_pk_fma_f32 v[198:199], v[130:131], v[50:51], v[198:199]
    ds_add_u32 v224, v243 offset:3328
    buffer_load_dwordx4 v[48:51], v1, s[24:27], s71 offen offset:512 nt
    v_add_f32 v228, v198, v199
    v_pk_fma_f32 v[202:203], v[154:155], v[234:235], v[202:203]
    v_pk_mul_f32 v[202:203], v[202:203], s[62:63]
    s_waitcnt vmcnt(35)
    v_pk_fma_f32 v[198:199], v[144:145], v[52:53], v[202:203]
    v_pk_fma_f32 v[198:199], v[146:147], v[54:55], v[198:199]
    ds_read_b32 v244, v243 offset:147
    s_add_u32 s71, s71, 384000
    s_cbranch_vccnz L_th12_0
L_tb12_0:
    buffer_load_dwordx4 v[52:55], v1, s[24:27], s71 offen offset:0 nt
    v_add_f32_dpp v229, v228, v228 row_ror:8 row_mask:0xf bank_mask:0xc
    v_lshlrev_b32 v108, 16, v192
    v_and_b32 v109, 0xffff0000, v192
    v_pk_mul_f32 v[108:109], v[108:109], s[60:61]
    v_lshlrev_b32 v110, 16, v193
    v_and_b32 v111, 0xffff0000, v193
    s_waitcnt vmcnt(35)
    v_pk_fma_f32 v[198:199], v[148:149], v[56:57], v[198:199]
    v_pk_fma_f32 v[198:199], v[150:151], v[58:59], v[198:199]
    buffer_load_dwordx4 v[56:59], v1, s[24:27], s71 offen offset:256 nt
    v_add_f32_dpp v230, v229, v229 row_shr:4 row_mask:0xf bank_mask:0xa
    v_pk_mul_f32 v[110:111], v[110:111], s[60:61]
    v_lshlrev_b32 v112, 16, v194
    v_and_b32 v113, 0xffff0000, v194
    v_pk_mul_f32 v[112:113], v[112:113], s[60:61]
    v_lshlrev_b32 v114, 16, v195
    s_waitcnt vmcnt(35)
    v_pk_fma_f32 v[198:199], v[152:153], v[60:61], v[198:199]
    v_pk_fma_f32 v[198:199], v[154:155], v[62:63], v[198:199]
    s_waitcnt lgkmcnt(0)
    v_cmp_lt_u32 vcc, v0, v244
    ds_add_u32 v224, v243 offset:3328
    buffer_load_dwordx4 v[60:63], v1, s[24:27], s71 offen offset:512 nt
    v_add_f32_dpp v231, v230, v230 quad_perm:[2,3,0,1] row_mask:0xf bank_mask:0xf
    v_add_f32 v228, v198, v199
    v_and_b32 v115, 0xffff0000, v195
    v_pk_mul_f32 v[114:115], v[114:115], s[60:61]
    v_lshlrev_b32 v116, 16, v196
    v_and_b32 v117, 0xffff0000, v196
    v_pk_mul_f32 v[116:117], v[116:117], s[60:61]
    s_waitcnt vmcnt(35)
    v_pk_fma_f32 v[198:199], v[144:145], v[64:65], v[202:203]
    v_pk_fma_f32 v[198:199], v[146:147], v[66:67], v[198:199]
    s_add_u32 s71, s71, 3072
    s_cbranch_vccnz L_th15_0
L_tb15_0:
    buffer_load_dwordx4 v[64:67], v1, s[24:27], s71 offen offset:0 nt
    v_add_f32_dpp v229, v228, v228 row_ror:8 row_mask:0xf bank_mask:0x3
    v_lshlrev_b32 v118, 16, v197
    v_and_b32 v119, 0xffff0000, v197
    v_pk_mul_f32 v[118:119], v[118:119], s[60:61]
    s_waitcnt vmcnt(29)
    v_pk_fma_f32 v[198:199], v[148:149], v[68:69], v[198:199]
    v_pk_fma_f32 v[198:199], v[150:151], v[70:71], v[198:199]
    s_add_u32 s72, s72, 3072
    buffer_load_dwordx2 v[168:169], v2, s[32:35], s72 offen offset:0
    buffer_load_dwordx2 v[170:171], v2, s[32:35], s72 offen offset:128
    buffer_load_dwordx2 v[172:173], v2, s[32:35], s72 offen offset:256
    buffer_load_dwordx2 v[174:175], v2, s[36:39], s72 offen offset:0
    buffer_load_dwordx2 v[176:177], v2, s[36:39], s72 offen offset:128
    buffer_load_dwordx2 v[178:179], v2, s[36:39], s72 offen offset:256
    buffer_load_dwordx4 v[68:71], v1, s[24:27], s71 offen offset:256 nt
    v_lshlrev_b32 v234, 16, v132
    v_and_b32 v235, 0xffff0000, v132
    v_pk_mul_f32 v[120:121], v[234:235], v[108:109]
    v_lshlrev_b32 v234, 16, v138
    v_and_b32 v235, 0xffff0000, v138
    s_waitcnt vmcnt(35)
    v_pk_fma_f32 v[198:199], v[152:153], v[72:73], v[198:199]
    v_pk_fma_f32 v[198:199], v[154:155], v[74:75], v[198:199]
    ds_add_u32 v224, v243 offset:3328
    buffer_load_dwordx4 v[72:75], v1, s[24:27], s71 offen offset:512 nt
    v_add_f32 v228, v198, v199
    v_pk_mul_f32 v[200:201], v[120:121], v[234:235]
    v_lshlrev_b32 v234, 16, v133
    v_and_b32 v235, 0xffff0000, v133
    v_pk_mul_f32 v[122:123], v[234:235], v[110:111]
    v_lshlrev_b32 v234, 16, v139
    s_waitcnt vmcnt(35)
    v_pk_fma_f32 v[198:199], v[144:145], v[76:77], v[202:203]
    v_pk_fma_f32 v[198:199], v[146:147], v[78:79], v[198:199]
    s_add_u32 s71, s71, 3072
    s_cbranch_vccnz L_th18_0
L_tb18_0:
    buffer_load_dwordx4 v[76:79], v1, s[24:27], s71 offen offset:0 nt
    v_add_f32_dpp v229, v228, v228 row_ror:8 row_mask:0xf bank_mask:0xc
    v_and_b32 v235, 0xffff0000, v139
    v_pk_fma_f32 v[200:201], v[122:123], v[234:235], v[200:201]
    v_lshlrev_b32 v234, 16, v134
    v_and_b32 v235, 0xffff0000, v134
    v_pk_mul_f32 v[124:125], v[234:235], v[112:113]
    s_waitcnt vmcnt(35)
    v_pk_fma_f32 v[198:199], v[148:149], v[80:81], v[198:199]
    v_pk_fma_f32 v[198:199], v[150:151], v[82:83], v[198:199]
    buffer_load_dwordx4 v[80:83], v1, s[24:27], s71 offen offset:256 nt
    v_add_f32_dpp v230, v229, v229 row_shl:4 row_mask:0xf bank_mask:0x5
    v_lshlrev_b32 v234, 16, v140
    v_and_b32 v235, 0xffff0000, v140
    v_pk_fma_f32 v[200:201], v[124:125], v[234:235], v[200:201]
    v_lshlrev_b32 v234, 16, v135
    v_and_b32 v235, 0xffff0000, v135
    s_waitcnt vmcnt(35)
    v_pk_fma_f32 v[198:199], v[152:153], v[84:85], v[198:199]
    v_pk_fma_f32 v[198:199], v[154:155], v[86:87], v[198:199]
    ds_add_u32 v224, v243 offset:3328
    buffer_load_dwordx4 v[84:87], v1, s[24:27], s71 offen offset:512 nt
    v_add_f32 v228, v198, v199
    v_pk_mul_f32 v[126:127], v[234:235], v[114:115]
    v_lshlrev_b32 v234, 16, v141
    v_and_b32 v235, 0xffff0000, v141
    v_pk_fma_f32 v[200:201], v[126:127], v[234:235], v[200:201]
    v_lshlrev_b32 v234, 16, v136
    s_waitcnt vmcnt(35)
    v_pk_fma_f32 v[198:199], v[144:145], v[88:89], v[202:203]
    v_pk_fma_f32 v[198:199], v[146:147], v[90:91], v[198:199]
    s_add_u32 s71, s71, 3072
    s_cbranch_vccnz L_th21_0
L_tb21_0:
    buffer_load_dwordx4 v[88:91], v1, s[24:27], s71 offen offset:0 nt
    v_add_f32_dpp v229, v228, v228 row_ror:8 row_mask:0xf bank_mask:0x3
    v_and_b32 v235, 0xffff0000, v136
    v_pk_mul_f32 v[128:129], v[234:235], v[116:117]
    v_lshlrev_b32 v234, 16, v142
    v_and_b32 v235, 0xffff0000, v142
    v_pk_fma_f32 v[200:201], v[128:129], v[234:235], v[200:201]
    s_waitcnt vmcnt(35)
    v_pk_fma_f32 v[198:199], v[148:149], v[92:93], v[198:199]
    v_pk_fma_f32 v[198:199], v[150:151], v[94:95], v[198:199]
    buffer_load_dwordx4 v[92:95], v1, s[24:27], s71 offen offset:256 nt
    v_lshlrev_b32 v234, 16, v137
    v_and_b32 v235, 0xffff0000, v137
    v_pk_mul_f32 v[130:131], v[234:235], v[118:119]
    v_lshlrev_b32 v234, 16, v143
    v_and_b32 v235, 0xffff0000, v143
    s_waitcnt vmcnt(35)
    v_pk_fma_f32 v[198:199], v[152:153], v[96:97], v[198:199]
    v_pk_fma_f32 v[198:199], v[154:155], v[98:99], v[198:199]
    ds_add_u32 v224, v243 offset:3328
    buffer_load_dwordx4 v[96:99], v1, s[24:27], s71 offen offset:512 nt
    v_add_f32 v228, v198, v199
    v_pk_fma_f32 v[200:201], v[130:131], v[234:235], v[200:201]
    v_pk_mul_f32 v[200:201], v[200:201], s[62:63]
    s_sub_u32 s76, s76, 1
    s_cmp_lg_u32 s76, 0
    s_cbranch_scc1 L_loop0
L_h0:
    s_cbranch_execz L_h1
    s_waitcnt vmcnt(35)
    v_pk_fma_f32 v[198:199], v[120:121], v[4:5], v[200:201]
L_h1:
    s_cbranch_execz L_h2
    v_pk_fma_f32 v[198:199], v[122:123], v[6:7], v[198:199]
    ds_read_b32 v244, v243 offset:147
    s_add_u32 s71, s71, 384000
    s_cbranch_vccnz L_th24_1
L_tb24_1:
    buffer_load_dwordx4 v[4:7], v1, s[24:27], s71 offen offset:0 nt
    v_add_f32_dpp v229, v228, v228 row_ror:8 row_mask:0xf bank_mask:0xc
    s_waitcnt vmcnt(35)
    v_pk_fma_f32 v[198:199], v[124:125], v[8:9], v[198:199]
    v_pk_fma_f32 v[198:199], v[126:127], v[10:11], v[198:199]
    buffer_load_dwordx4 v[8:11], v1, s[24:27], s71 offen offset:256 nt
    v_add_f32_dpp v230, v229, v229 row_shr:4 row_mask:0xf bank_mask:0xa
    s_waitcnt vmcnt(35)
    v_pk_fma_f32 v[198:199], v[128:129], v[12:13], v[198:199]
    v_pk_fma_f32 v[198:199], v[130:131], v[14:15], v[198:199]
    s_waitcnt lgkmcnt(0)
    v_cmp_lt_u32 vcc, v0, v244
    ds_add_u32 v224, v243 offset:3328
    buffer_load_dwordx4 v[12:15], v1, s[24:27], s71 offen offset:512 nt
L_h2:
    s_cbranch_execz L_h3
    v_add_f32_dpp v232, v230, v230 quad_perm:[2,3,0,1] row_mask:0xf bank_mask:0xf
    v_add_f32 v228, v198, v199
    s_waitcnt vmcnt(35)
    v_pk_fma_f32 v[198:199], v[120:121], v[16:17], v[200:201]
    v_pk_fma_f32 v[198:199], v[122:123], v[18:19], v[198:199]
    s_add_u32 s71, s71, 3072
    s_cbranch_vccnz L_th27_1
L_tb27_1:
    buffer_load_dwordx4 v[16:19], v1, s[24:27], s71 offen offset:0 nt
    v_cndmask_b32 v232, v231, v232, s[64:65]
    v_add_f32_dpp v229, v228, v228 row_ror:8 row_mask:0xf bank_mask:0x3
    s_waitcnt vmcnt(29)
    v_pk_fma_f32 v[198:199], v[124:125], v[20:21], v[198:199]
    v_pk_fma_f32 v[198:199], v[126:127], v[22:23], v[198:199]
    s_add_u32 s72, s72, 3072
    buffer_load_dwordx2 v[180:181], v2, s[32:35], s72 offen offset:0
    buffer_load_dwordx2 v[182:183], v2, s[32:35], s72 offen offset:128
    buffer_load_dwordx2 v[184:185], v2, s[32:35], s72 offen offset:256
    buffer_load_dwordx2 v[186:187], v2, s[36:39], s72 offen offset:0
L_h3:
    s_cbranch_execz L_h4
    buffer_load_dwordx2 v[188:189], v2, s[36:39], s72 offen offset:128
    buffer_load_dwordx2 v[190:191], v2, s[36:39], s72 offen offset:256
    buffer_load_dwordx4 v[20:23], v1, s[24:27], s71 offen offset:256 nt
    v_add_f32_dpp v231, v232, v232 quad_perm:[1,0,3,2] row_mask:0xf bank_mask:0xf
    v_lshlrev_b32 v234, 16, v156
    v_and_b32 v235, 0xffff0000, v156
    v_pk_mul_f32 v[144:145], v[234:235], v[108:109]
    v_lshlrev_b32 v234, 16, v162
    v_and_b32 v235, 0xffff0000, v162
    s_waitcnt vmcnt(35)
    v_pk_fma_f32 v[198:199], v[128:129], v[24:25], v[198:199]
    v_pk_fma_f32 v[198:199], v[130:131], v[26:27], v[198:199]
    ds_add_u32 v224, v243 offset:3328
    buffer_load_dwordx4 v[24:27], v1, s[24:27], s71 offen offset:512 nt
    v_cndmask_b32 v233, v233, v231, s[66:67]
    v_mul_f32 v233, 0x58000000, v233
    ds_write_b32 v239, v233
L_h4:
    s_cbranch_execz L_h5
    v_add_u32 v239, 256, v239
    v_add_f32 v228, v198, v199
    v_pk_mul_f32 v[202:203], v[144:145], v[234:235]
    v_lshlrev_b32 v234, 16, v157
    v_and_b32 v235, 0xffff0000, v157
    v_pk_mul_f32 v[146:147], v[234:235], v[110:111]
    v_lshlrev_b32 v234, 16, v163
    s_waitcnt vmcnt(35)
    v_pk_fma_f32 v[198:199], v[120:121], v[28:29], v[200:201]
    v_pk_fma_f32 v[198:199], v[122:123], v[30:31], v[198:199]
    s_add_u32 s71, s71, 3072
    s_cbranch_vccnz L_th30_1
L_tb30_1:
    buffer_load_dwordx4 v[28:31], v1, s[24:27], s71 offen offset:0 nt
    v_add_f32_dpp v229, v228, v228 row_ror:8 row_mask:0xf bank_mask:0xc
    v_and_b32 v235, 0xffff0000, v163
    v_pk_fma_f32 v[202:203], v[146:147], v[234:235], v[202:203]
    v_lshlrev_b32 v234, 16, v158
    v_and_b32 v235, 0xffff0000, v158
L_h5:
    s_cbranch_execz L_h6
    v_pk_mul_f32 v[148:149], v[234:235], v[112:113]
    s_waitcnt vmcnt(35)
    v_pk_fma_f32 v[198:199], v[124:125], v[32:33], v[198:199]
    v_pk_fma_f32 v[198:199], v[126:127], v[34:35], v[198:199]
    buffer_load_dwordx4 v[32:35], v1, s[24:27], s71 offen offset:256 nt
    v_add_f32_dpp v230, v229, v229 row_shl:4 row_mask:0xf bank_mask:0x5
    v_lshlrev_b32 v234, 16, v164
    v_and_b32 v235, 0xffff0000, v164
    v_pk_fma_f32 v[202:203], v[148:149], v[234:235], v[202:203]
    v_lshlrev_b32 v234, 16, v159
    v_and_b32 v235, 0xffff0000, v159
    s_waitcnt vmcnt(35)
    v_pk_fma_f32 v[198:199], v[128:129], v[36:37], v[198:199]
    v_pk_fma_f32 v[198:199], v[130:131], v[38:39], v[198:199]
    ds_add_u32 v224, v243 offset:3328
    buffer_load_dwordx4 v[36:39], v1, s[24:27], s71 offen offset:512 nt
    v_add_f32 v228, v198, v199
    v_pk_mul_f32 v[150:151], v[234:235], v[114:115]
L_h6:
    s_cbranch_execz L_h7
    v_lshlrev_b32 v234, 16, v165
    v_and_b32 v235, 0xffff0000, v165
    v_pk_fma_f32 v[202:203], v[150:151], v[234:235], v[202:203]
    v_lshlrev_b32 v234, 16, v160
    s_waitcnt vmcnt(35)
    v_pk_fma_f32 v[198:199], v[120:121], v[40:41], v[200:201]
    v_pk_fma_f32 v[198:199], v[122:123], v[42:43], v[198:199]
    s_add_u32 s71, s71, 3072
    s_cbranch_vccnz L_th33_1
L_tb33_1:
    buffer_load_dwordx4 v[40:43], v1, s[24:27], s71 offen offset:0 nt
    v_add_f32_dpp v229, v228, v228 row_ror:8 row_mask:0xf bank_mask:0x3
    v_and_b32 v235, 0xffff0000, v160
    v_pk_mul_f32 v[152:153], v[234:235], v[116:117]
    v_lshlrev_b32 v234, 16, v166
    v_and_b32 v235, 0xffff0000, v166
    v_pk_fma_f32 v[202:203], v[152:153], v[234:235], v[202:203]
    s_waitcnt vmcnt(35)
    v_pk_fma_f32 v[198:199], v[124:125], v[44:45], v[198:199]
    v_pk_fma_f32 v[198:199], v[126:127], v[46:47], v[198:199]
L_h7:
    s_cbranch_execz L_h8
    buffer_load_dwordx4 v[44:47], v1, s[24:27], s71 offen offset:256 nt
    v_lshlrev_b32 v234, 16, v161
    v_and_b32 v235, 0xffff0000, v161
    v_pk_mul_f32 v[154:155], v[234:235], v[118:119]
    v_lshlrev_b32 v234, 16, v167
    v_and_b32 v235, 0xffff0000, v167
    s_waitcnt vmcnt(35)
    v_pk_fma_f32 v[198:199], v[128:129], v[48:49], v[198:199]
    v_pk_fma_f32 v[198:199], v[130:131], v[50:51], v[198:199]
    ds_add_u32 v224, v243 offset:3328
    buffer_load_dwordx4 v[48:51], v1, s[24:27], s71 offen offset:512 nt
    v_add_f32 v228, v198, v199
    v_pk_fma_f32 v[202:203], v[154:155], v[234:235], v[202:203]
    v_pk_mul_f32 v[202:203], v[202:203], s[62:63]
    s_waitcnt vmcnt(35)
    v_pk_fma_f32 v[198:199], v[144:145], v[52:53], v[202:203]
    v_pk_fma_f32 v[198:199], v[146:147], v[54:55], v[198:199]
    ds_read_b32 v244, v243 offset:147
L_h8:
    s_cbranch_execz L_h9
    s_mov_b32 s91, 0
    v_readlane_b32 s70, v245, s91
    s_add_u32 s91, s91, 1
    s_and_b32 s80, s70, 31
    s_mul_i32 s80, s80, 96
    s_lshl_b32 s73, s70, 7
    s_sub_u32 s73, s73, s80
    buffer_load_ushort v220, v3, s[40:43], s73 offen
    buffer_load_ushort v221, v3, s[44:47], s73 offen
    s_add_u32 s71, s71, 384000
    s_cbranch_vccnz L_th36_1
L_tb36_1:
    buffer_load_dwordx4 v[52:55], v1, s[24:27], s71 offen offset:0 nt
    v_add_f32_dpp v229, v228, v228 row_ror:8 row_mask:0xf bank_mask:0xc
    s_waitcnt vmcnt(37)
    v_pk_fma_f32 v[198:199], v[148:149], v[56:57], v[198:199]
    v_pk_fma_f32 v[198:199], v[150:151], v[58:59], v[198:199]
    buffer_load_dwordx4 v[56:59], v1, s[24:27], s71 offen offset:256 nt
    v_add_f32_dpp v230, v229, v229 row_shr:4 row_mask:0xf bank_mask:0xa
    s_waitcnt vmcnt(37)
L_h9:
    s_cbranch_execz L_h10
    v_pk_fma_f32 v[198:199], v[152:153], v[60:61], v[198:199]
    v_pk_fma_f32 v[198:199], v[154:155], v[62:63], v[198:199]
    s_waitcnt lgkmcnt(0)
    v_cmp_lt_u32 vcc, v0, v244
    ds_add_u32 v224, v243 offset:3328
    buffer_load_dwordx4 v[60:63], v1, s[24:27], s71 offen offset:512 nt
    v_add_f32_dpp v231, v230, v230 quad_perm:[2,3,0,1] row_mask:0xf bank_mask:0xf
    v_add_f32 v228, v198, v199
    s_waitcnt vmcnt(37)
    v_pk_fma_f32 v[198:199], v[144:145], v[64:65], v[202:203]
    v_pk_fma_f32 v[198:199], v[146:147], v[66:67], v[198:199]
    s_add_u32 s71, s71, 3072
    s_cbranch_vccnz L_th39_1
L_tb39_1:
    buffer_load_dwordx4 v[64:67], v1, s[24:27], s71 offen offset:0 nt
    v_add_f32_dpp v229, v228, v228 row_ror:8 row_mask:0xf bank_mask:0x3
    s_waitcnt vmcnt(31)
    v_pk_fma_f32 v[198:199], v[148:149], v[68:69], v[198:199]
    v_pk_fma_f32 v[198:199], v[150:151], v[70:71], v[198:199]
    buffer_load_dwordx4 v[68:71], v1, s[24:27], s71 offen offset:256 nt
L_h10:
    s_cbranch_execz L_h11
    v_lshlrev_b32 v234, 16, v168
    v_and_b32 v235, 0xffff0000, v168
    v_pk_mul_f32 v[120:121], v[234:235], v[108:109]
    v_lshlrev_b32 v234, 16, v174
    v_and_b32 v235, 0xffff0000, v174
    s_waitcnt vmcnt(31)
    v_pk_fma_f32 v[198:199], v[152:153], v[72:73], v[198:199]
    v_pk_fma_f32 v[198:199], v[154:155], v[74:75], v[198:199]
    ds_add_u32 v224, v243 offset:3328
    buffer_load_dwordx4 v[72:75], v1, s[24:27], s71 offen offset:512 nt
    v_add_f32 v228, v198, v199
    v_pk_mul_f32 v[200:201], v[120:121], v[234:235]
    v_lshlrev_b32 v234, 16, v169
    v_and_b32 v235, 0xffff0000, v169
    v_pk_mul_f32 v[122:123], v[234:235], v[110:111]
    v_lshlrev_b32 v234, 16, v175
    s_waitcnt vmcnt(31)
    v_pk_fma_f32 v[198:199], v[144:145], v[76:77], v[202:203]
    v_pk_fma_f32 v[198:199], v[146:147], v[78:79], v[198:199]
L_h11:
    s_cbranch_execz L_h12
    s_add_u32 s71, s71, 3072
    s_cbranch_vccnz L_th42_1
L_tb42_1:
    buffer_load_dwordx4 v[76:79], v1, s[24:27], s71 offen offset:0 nt
    v_add_f32_dpp v229, v228, v228 row_ror:8 row_mask:0xf bank_mask:0xc
    v_and_b32 v235, 0xffff0000, v175
    v_pk_fma_f32 v[200:201], v[122:123], v[234:235], v[200:201]
    v_lshlrev_b32 v234, 16, v170
    v_and_b32 v235, 0xffff0000, v170
    v_pk_mul_f32 v[124:125], v[234:235], v[112:113]
    s_waitcnt vmcnt(31)
    v_pk_fma_f32 v[198:199], v[148:149], v[80:81], v[198:199]
    v_pk_fma_f32 v[198:199], v[150:151], v[82:83], v[198:199]
    buffer_load_dwordx4 v[80:83], v1, s[24:27], s71 offen offset:256 nt
    v_add_f32_dpp v230, v229, v229 row_shl:4 row_mask:0xf bank_mask:0x5
    v_lshlrev_b32 v234, 16, v176
    v_and_b32 v235, 0xffff0000, v176
    v_pk_fma_f32 v[200:201], v[124:125], v[234:235], v[200:201]
L_h12:
    s_cbranch_execz L_h13
    v_lshlrev_b32 v234, 16, v171
    v_and_b32 v235, 0xffff0000, v171
    s_waitcnt vmcnt(31)
    v_pk_fma_f32 v[198:199], v[152:153], v[84:85], v[198:199]
    v_pk_fma_f32 v[198:199], v[154:155], v[86:87], v[198:199]
    ds_add_u32 v224, v243 offset:3328
    buffer_load_dwordx4 v[84:87], v1, s[24:27], s71 offen offset:512 nt
    v_add_f32 v228, v198, v199
    v_pk_mul_f32 v[126:127], v[234:235], v[114:115]
    v_lshlrev_b32 v234, 16, v177
    v_and_b32 v235, 0xffff0000, v177
    v_pk_fma_f32 v[200:201], v[126:127], v[234:235], v[200:201]
    v_lshlrev_b32 v234, 16, v172
    s_waitcnt vmcnt(31)
    v_pk_fma_f32 v[198:199], v[144:145], v[88:89], v[202:203]
    v_pk_fma_f32 v[198:199], v[146:147], v[90:91], v[198:199]
    s_add_u32 s71, s71, 3072
    s_cbranch_vccnz L_th45_1
L_tb45_1:
    buffer_load_dwordx4 v[88:91], v1, s[24:27], s71 offen offset:0 nt
L_h13:
    s_cbranch_execz L_h14
    v_add_f32_dpp v229, v228, v228 row_ror:8 row_mask:0xf bank_mask:0x3
    v_and_b32 v235, 0xffff0000, v172
    v_pk_mul_f32 v[128:129], v[234:235], v[116:117]
    v_lshlrev_b32 v234, 16, v178
    v_and_b32 v235, 0xffff0000, v178
    v_pk_fma_f32 v[200:201], v[128:129], v[234:235], v[200:201]
    s_waitcnt vmcnt(31)
    v_pk_fma_f32 v[198:199], v[148:149], v[92:93], v[198:199]
    v_pk_fma_f32 v[198:199], v[150:151], v[94:95], v[198:199]
    buffer_load_dwordx4 v[92:95], v1, s[24:27], s71 offen offset:256 nt
    v_lshlrev_b32 v234, 16, v173
    v_and_b32 v235, 0xffff0000, v173
    v_pk_mul_f32 v[130:131], v[234:235], v[118:119]
    v_lshlrev_b32 v234, 16, v179
    v_and_b32 v235, 0xffff0000, v179
    s_waitcnt vmcnt(31)
    v_pk_fma_f32 v[198:199], v[152:153], v[96:97], v[198:199]
    v_pk_fma_f32 v[198:199], v[154:155], v[98:99], v[198:199]
L_h14:
    s_cbranch_execz L_h15
    ds_add_u32 v224, v243 offset:3328
    buffer_load_dwordx4 v[96:99], v1, s[24:27], s71 offen offset:512 nt
    v_add_f32 v228, v198, v199
    v_pk_fma_f32 v[200:201], v[130:131], v[234:235], v[200:201]
    v_pk_mul_f32 v[200:201], v[200:201], s[62:63]
    s_waitcnt vmcnt(31)
    v_pk_fma_f32 v[198:199], v[120:121], v[4:5], v[200:201]
    v_pk_fma_f32 v[198:199], v[122:123], v[6:7], v[198:199]
    ds_read_b32 v244, v243 offset:147
    s_mul_i32 s71, s70, 49152
    s_and_b32 s80, s70, 31
    s_mul_i32 s80, s80, 36864
    s_sub_u32 s71, s71, s80
    s_cbranch_vccnz L_th0_1
L_tb0_1:
    buffer_load_dwordx4 v[4:7], v1, s[28:31], s71 offen offset:0 nt
    v_add_f32_dpp v229, v228, v228 row_ror:8 row_mask:0xf bank_mask:0xc
    s_waitcnt vmcnt(31)
    v_pk_fma_f32 v[198:199], v[124:125], v[8:9], v[198:199]
    v_pk_fma_f32 v[198:199], v[126:127], v[10:11], v[198:199]
L_h15:
    s_cbranch_execz L_h16
    buffer_load_dwordx4 v[8:11], v1, s[28:31], s71 offen offset:256 nt
    v_add_f32_dpp v230, v229, v229 row_shr:4 row_mask:0xf bank_mask:0xa
    s_waitcnt vmcnt(31)
    v_pk_fma_f32 v[198:199], v[128:129], v[12:13], v[198:199]
    v_pk_fma_f32 v[198:199], v[130:131], v[14:15], v[198:199]
    s_waitcnt lgkmcnt(0)
    v_cmp_lt_u32 vcc, v0, v244
    ds_add_u32 v224, v243 offset:3328
    buffer_load_dwordx4 v[12:15], v1, s[28:31], s71 offen offset:512 nt
    v_add_f32_dpp v232, v230, v230 quad_perm:[2,3,0,1] row_mask:0xf bank_mask:0xf
    v_add_f32 v228, v198, v199
    s_waitcnt vmcnt(31)
    v_pk_fma_f32 v[198:199], v[120:121], v[16:17], v[200:201]
    v_pk_fma_f32 v[198:199], v[122:123], v[18:19], v[198:199]
    s_add_u32 s71, s71, 3072
    s_cbranch_vccnz L_th3_1
L_tb3_1:
    buffer_load_dwordx4 v[16:19], v1, s[28:31], s71 offen offset:0 nt
    v_cndmask_b32 v232, v231, v232, s[64:65]
L_h16:
    s_cbranch_execz L_h17
    v_add_f32_dpp v229, v228, v228 row_ror:8 row_mask:0xf bank_mask:0x3
    s_waitcnt vmcnt(25)
    v_pk_fma_f32 v[198:199], v[124:125], v[20:21], v[198:199]
    v_pk_fma_f32 v[198:199], v[126:127], v[22:23], v[198:199]
    buffer_load_dwordx4 v[20:23], v1, s[28:31], s71 offen offset:256 nt
    v_add_f32_dpp v233, v232, v232 quad_perm:[1,0,3,2] row_mask:0xf bank_mask:0xf
    v_lshlrev_b32 v234, 16, v180
    v_and_b32 v235, 0xffff0000, v180
    v_pk_mul_f32 v[144:145], v[234:235], v[108:109]
    v_lshlrev_b32 v234, 16, v186
    v_and_b32 v235, 0xffff0000, v186
    s_waitcnt vmcnt(25)
    v_pk_fma_f32 v[198:199], v[128:129], v[24:25], v[198:199]
    v_pk_fma_f32 v[198:199], v[130:131], v[26:27], v[198:199]
    ds_add_u32 v224, v243 offset:3328
    buffer_load_dwordx4 v[24:27], v1, s[28:31], s71 offen offset:512 nt
    v_add_f32 v228, v198, v199
    v_pk_mul_f32 v[202:203], v[144:145], v[234:235]
L_h17:
    s_cbranch_execz L_h18
    v_lshlrev_b32 v234, 16, v181
    v_and_b32 v235, 0xffff0000, v181
    v_pk_mul_f32 v[146:147], v[234:235], v[110:111]
    v_lshlrev_b32 v234, 16, v187
    s_waitcnt vmcnt(25)
    v_pk_fma_f32 v[198:199], v[120:121], v[28:29], v[200:201]
    v_pk_fma_f32 v[198:199], v[122:123], v[30:31], v[198:199]
    s_add_u32 s71, s71, 3072
    s_cbranch_vccnz L_th6_1
L_tb6_1:
    buffer_load_dwordx4 v[28:31], v1, s[28:31], s71 offen offset:0 nt
    v_add_f32_dpp v229, v228, v228 row_ror:8 row_mask:0xf bank_mask:0xc
    v_and_b32 v235, 0xffff0000, v187
    v_pk_fma_f32 v[202:203], v[146:147], v[234:235], v[202:203]
    v_lshlrev_b32 v234, 16, v182
    v_and_b32 v235, 0xffff0000, v182
    v_pk_mul_f32 v[148:149], v[234:235], v[112:113]
    s_waitcnt vmcnt(25)
    v_pk_fma_f32 v[198:199], v[124:125], v[32:33], v[198:199]
    v_pk_fma_f32 v[198:199], v[126:127], v[34:35], v[198:199]
L_h18:
    s_cbranch_execz L_h19
    buffer_load_dwordx4 v[32:35], v1, s[28:31], s71 offen offset:256 nt
    v_add_f32_dpp v230, v229, v229 row_shl:4 row_mask:0xf bank_mask:0x5
    v_lshlrev_b32 v234, 16, v188
    v_and_b32 v235, 0xffff0000, v188
    v_pk_fma_f32 v[202:203], v[148:149], v[234:235], v[202:203]
    v_lshlrev_b32 v234, 16, v183
    v_and_b32 v235, 0xffff0000, v183
    s_waitcnt vmcnt(25)
    v_pk_fma_f32 v[198:199], v[128:129], v[36:37], v[198:199]
    v_pk_fma_f32 v[198:199], v[130:131], v[38:39], v[198:199]
    ds_add_u32 v224, v243 offset:3328
    buffer_load_dwordx4 v[36:39], v1, s[28:31], s71 offen offset:512 nt
    v_add_f32 v228, v198, v199
    v_pk_mul_f32 v[150:151], v[234:235], v[114:115]
    v_lshlrev_b32 v234, 16, v189
    v_and_b32 v235, 0xffff0000, v189
    v_pk_fma_f32 v[202:203], v[150:151], v[234:235], v[202:203]
    v_lshlrev_b32 v234, 16, v184
L_h19:
    s_cbranch_execz L_h20
    s_waitcnt vmcnt(25)
    v_pk_fma_f32 v[198:199], v[120:121], v[40:41], v[200:201]
    v_pk_fma_f32 v[198:199], v[122:123], v[42:43], v[198:199]
    s_add_u32 s71, s71, 3072
    s_cbranch_vccnz L_th9_1
L_tb9_1:
    buffer_load_dwordx4 v[40:43], v1, s[28:31], s71 offen offset:0 nt
    v_add_f32_dpp v229, v228, v228 row_ror:8 row_mask:0xf bank_mask:0x3
    v_and_b32 v235, 0xffff0000, v184
    v_pk_mul_f32 v[152:153], v[234:235], v[116:117]
    v_lshlrev_b32 v234, 16, v190
    v_and_b32 v235, 0xffff0000, v190
    v_pk_fma_f32 v[202:203], v[152:153], v[234:235], v[202:203]
    s_waitcnt vmcnt(25)
    v_pk_fma_f32 v[198:199], v[124:125], v[44:45], v[198:199]
    v_pk_fma_f32 v[198:199], v[126:127], v[46:47], v[198:199]
    buffer_load_dwordx4 v[44:47], v1, s[28:31], s71 offen offset:256 nt
    v_lshlrev_b32 v234, 16, v185
    v_and_b32 v235, 0xffff0000, v185
L_h20:
    s_cbranch_execz L_h21
    v_pk_mul_f32 v[154:155], v[234:235], v[118:119]
    v_lshlrev_b32 v234, 16, v191
    v_and_b32 v235, 0xffff0000, v191
    s_waitcnt vmcnt(25)
    v_pk_fma_f32 v[198:199], v[128:129], v[48:49], v[198:199]
    v_pk_fma_f32 v[198:199], v[130:131], v[50:51], v[198:199]
    ds_add_u32 v224, v243 offset:3328
    buffer_load_dwordx4 v[48:51], v1, s[28:31], s71 offen offset:512 nt
    v_add_f32 v228, v198, v199
    v_pk_fma_f32 v[202:203], v[154:155], v[234:235], v[202:203]
    v_pk_mul_f32 v[202:203], v[202:203], s[62:63]
    s_waitcnt vmcnt(23)
    v_pk_fma_f32 v[198:199], v[144:145], v[52:53], v[202:203]
    v_pk_fma_f32 v[198:199], v[146:147], v[54:55], v[198:199]
    ds_read_b32 v244, v243 offset:147
    s_add_u32 s71, s71, 384000
    s_cbranch_vccnz L_th12_1
L_tb12_1:
    buffer_load_dwordx4 v[52:55], v1, s[28:31], s71 offen offset:0 nt
L_h21:
    s_cbranch_execz L_h22
    v_add_f32_dpp v229, v228, v228 row_ror:8 row_mask:0xf bank_mask:0xc
    s_waitcnt vmcnt(23)
    v_pk_fma_f32 v[198:199], v[148:149], v[56:57], v[198:199]
    v_pk_fma_f32 v[198:199], v[150:151], v[58:59], v[198:199]
    buffer_load_dwordx4 v[56:59], v1, s[28:31], s71 offen offset:256 nt
    v_add_f32_dpp v230, v229, v229 row_shr:4 row_mask:0xf bank_mask:0xa
    s_waitcnt vmcnt(23)
    v_pk_fma_f32 v[198:199], v[152:153], v[60:61], v[198:199]
    v_pk_fma_f32 v[198:199], v[154:155], v[62:63], v[198:199]
    s_waitcnt lgkmcnt(0)
    v_cmp_lt_u32 vcc, v0, v244
    ds_add_u32 v224, v243 offset:3328
    buffer_load_dwordx4 v[60:63], v1, s[28:31], s71 offen offset:512 nt
    v_add_f32_dpp v231, v230, v230 quad_perm:[2,3,0,1] row_mask:0xf bank_mask:0xf
    v_add_f32 v228, v198, v199
    s_waitcnt vmcnt(23)
    v_pk_fma_f32 v[198:199], v[144:145], v[64:65], v[202:203]
    v_pk_fma_f32 v[198:199], v[146:147], v[66:67], v[198:199]
    s_add_u32 s71, s71, 3072
L_h22:
    s_cbranch_execz L_h23
    s_cbranch_vccnz L_th15_1
L_tb15_1:
    buffer_load_dwordx4 v[64:67], v1, s[28:31], s71 offen offset:0 nt
    v_add_f32_dpp v229, v228, v228 row_ror:8 row_mask:0xf bank_mask:0x3
    s_waitcnt vmcnt(23)
    v_pk_fma_f32 v[198:199], v[148:149], v[68:69], v[198:199]
    v_pk_fma_f32 v[198:199], v[150:151], v[70:71], v[198:199]
    buffer_load_dwordx4 v[68:71], v1, s[28:31], s71 offen offset:256 nt
    s_waitcnt vmcnt(23)
    v_pk_fma_f32 v[198:199], v[152:153], v[72:73], v[198:199]
    v_pk_fma_f32 v[198:199], v[154:155], v[74:75], v[198:199]
    ds_add_u32 v224, v243 offset:3328
    buffer_load_dwordx4 v[72:75], v1, s[28:31], s71 offen offset:512 nt
    v_add_f32 v228, v198, v199
    s_waitcnt vmcnt(23)
    v_pk_fma_f32 v[198:199], v[144:145], v[76:77], v[202:203]
    v_pk_fma_f32 v[198:199], v[146:147], v[78:79], v[198:199]
    s_add_u32 s71, s71, 3072
    s_cbranch_vccnz L_th18_1
L_tb18_1:
L_h23:
    s_cbranch_execz L_h24
    buffer_load_dwordx4 v[76:79], v1, s[28:31], s71 offen offset:0 nt
    v_add_f32_dpp v229, v228, v228 row_ror:8 row_mask:0xf bank_mask:0xc
    s_waitcnt vmcnt(23)
    v_pk_fma_f32 v[198:199], v[148:149], v[80:81], v[198:199]
    v_pk_fma_f32 v[198:199], v[150:151], v[82:83], v[198:199]
    buffer_load_dwordx4 v[80:83], v1, s[28:31], s71 offen offset:256 nt
    v_add_f32_dpp v230, v229, v229 row_shl:4 row_mask:0xf bank_mask:0x5
    s_waitcnt vmcnt(23)
    v_pk_fma_f32 v[198:199], v[152:153], v[84:85], v[198:199]
    v_pk_fma_f32 v[198:199], v[154:155], v[86:87], v[198:199]
    ds_add_u32 v224, v243 offset:3328
    buffer_load_dwordx4 v[84:87], v1, s[28:31], s71 offen offset:512 nt
    v_add_f32 v228, v198, v199
    s_waitcnt vmcnt(23)
    v_pk_fma_f32 v[198:199], v[144:145], v[88:89], v[202:203]
    v_pk_fma_f32 v[198:199], v[146:147], v[90:91], v[198:199]
    s_add_u32 s71, s71, 3072
    s_cbranch_vccnz L_th21_1
L_tb21_1:
L_h24:
    s_cbranch_execz L_h25
    buffer_load_dwordx4 v[88:91], v1, s[28:31], s71 offen offset:0 nt
    v_add_f32_dpp v229, v228, v228 row_ror:8 row_mask:0xf bank_mask:0x3
    s_waitcnt vmcnt(23)
    v_pk_fma_f32 v[198:199], v[148:149], v[92:93], v[198:199]
    v_pk_fma_f32 v[198:199], v[150:151], v[94:95], v[198:199]
    buffer_load_dwordx4 v[92:95], v1, s[28:31], s71 offen offset:256 nt
    s_waitcnt vmcnt(23)
    v_pk_fma_f32 v[198:199], v[152:153], v[96:97], v[198:199]
    v_pk_fma_f32 v[198:199], v[154:155], v[98:99], v[198:199]
    ds_add_u32 v224, v243 offset:3328
    buffer_load_dwordx4 v[96:99], v1, s[28:31], s71 offen offset:512 nt
    v_add_f32 v228, v198, v199
    s_nop 1
    v_add_f32_dpp v229, v228, v228 row_ror:8 row_mask:0xf bank_mask:0xc
    s_nop 1
    v_add_f32_dpp v230, v229, v229 row_shr:4 row_mask:0xf bank_mask:0xa
    s_nop 1
    v_add_f32_dpp v232, v230, v230 quad_perm:[2,3,0,1] row_mask:0xf bank_mask:0xf
    s_nop 1
L_h25:
    s_cbranch_execz L_h26
    v_cndmask_b32 v232, v231, v232, s[64:65]
    s_nop 1
    v_add_f32_dpp v231, v232, v232 quad_perm:[1,0,3,2] row_mask:0xf bank_mask:0xf
    s_nop 1
    v_cndmask_b32 v233, v233, v231, s[66:67]
    v_mul_f32 v233, 0x58000000, v233
    ds_write_b32 v239, v233
    v_add_u32 v239, 256, v239
    s_mov_b64 exec, 1
    ds_add_u32 v243, v243 offset:127
    s_mov_b64 exec, -1
    ds_read_b32 v223, v240
    v_add_u32 v240, 256, v240
    v_lshlrev_b32 v220, 16, v220
    v_lshlrev_b32 v221, 16, v221
    s_waitcnt lgkmcnt(0)
    v_max_f32_dpp v234, v223, v223 row_ror:8 row_mask:0xf bank_mask:0xf
    s_nop 1
    v_max_f32_dpp v234, v234, v234 row_ror:4 row_mask:0xf bank_mask:0xf
    s_nop 1
L_h26:
    s_cbranch_execz L_h27
    v_max_f32_dpp v234, v234, v234 row_ror:2 row_mask:0xf bank_mask:0xf
    s_nop 1
    v_max_f32_dpp v234, v234, v234 row_ror:1 row_mask:0xf bank_mask:0xf
    v_mov_b32 v228, v216
    v_max3_f32 v234, v234, v228, s77
    v_sub_f32 v235, v228, v234
    v_sub_f32 v229, v223, v234
    v_exp_f32 v235, v235
    v_exp_f32 v229, v229
    s_nop 0
    v_mul_f32 v222, v229, v220
    v_mul_f32 v230, v222, v221
    v_mul_f32 v238, 0x71800000, v222
    s_nop 0
    s_mov_b32 s76, 63
L_loop1:
    v_mov_b32_dpp v236, v238 row_newbcast:0 row_mask:0xf bank_mask:0xf
    s_waitcnt vmcnt(23)
    v_pk_fma_f32 v[204:205], v[236:237], v[4:5], v[204:205] op_sel_hi:[0,1,1]
    v_pk_fma_f32 v[206:207], v[236:237], v[6:7], v[206:207] op_sel_hi:[0,1,1]
    ds_read_b32 v244, v243 offset:147
    s_add_u32 s71, s71, 384000
    s_cbranch_vccnz L_th24_2
L_tb24_2:
L_h27:
    s_cbranch_execz L_h28
    buffer_load_dwordx4 v[4:7], v1, s[28:31], s71 offen offset:0 nt
    s_bitcmp0_b32 s4, 0
    s_cbranch_scc1 L_nofl2
    s_mov_b64 exec, 1
    ds_add_u32 v242, v243
    s_mov_b64 exec, -1
    v_add_u32 v241, 4096, v241
    v_add_u32 v242, 4, v242
L_nofl2:
    s_waitcnt vmcnt(23)
    v_pk_fma_f32 v[208:209], v[236:237], v[8:9], v[208:209] op_sel_hi:[0,1,1]
    v_pk_fma_f32 v[210:211], v[236:237], v[10:11], v[210:211] op_sel_hi:[0,1,1]
    buffer_load_dwordx4 v[8:11], v1, s[28:31], s71 offen offset:256 nt
    v_pk_mul_f32 v[212:213], v[212:213], v[234:235] op_sel:[0,1] op_sel_hi:[1,1]
    v_pk_mul_f32 v[214:215], v[214:215], v[234:235] op_sel:[0,1] op_sel_hi:[1,1]
    v_mov_b32 v216, v234
    s_waitcnt vmcnt(23)
    v_pk_fma_f32 v[212:213], v[236:237], v[12:13], v[212:213] op_sel_hi:[0,1,1]
    v_pk_fma_f32 v[214:215], v[236:237], v[14:15], v[214:215] op_sel_hi:[0,1,1]
    s_nop 2
    s_waitcnt lgkmcnt(0)
    v_cmp_lt_u32 vcc, v0, v244
L_h28:
    s_cbranch_execz L_h29
    ds_add_u32 v224, v243 offset:3328
    buffer_load_dwordx4 v[12:15], v1, s[28:31], s71 offen offset:512 nt
    v_fma_f32 v217, v217, v235, v229
    v_mov_b32_dpp v236, v238 row_newbcast:8 row_mask:0xf bank_mask:0xf
    s_waitcnt vmcnt(23)
    v_pk_fma_f32 v[204:205], v[236:237], v[16:17], v[204:205] op_sel_hi:[0,1,1]
    v_pk_fma_f32 v[206:207], v[236:237], v[18:19], v[206:207] op_sel_hi:[0,1,1]
    s_add_u32 s71, s71, 3072
    s_cbranch_vccnz L_th27_2
L_tb27_2:
    buffer_load_dwordx4 v[16:19], v1, s[28:31], s71 offen offset:0 nt
    v_fma_f32 v218, v218, v235, v230
    s_waitcnt vmcnt(23)
    v_pk_fma_f32 v[208:209], v[236:237], v[20:21], v[208:209] op_sel_hi:[0,1,1]
    v_pk_fma_f32 v[210:211], v[236:237], v[22:23], v[210:211] op_sel_hi:[0,1,1]
    s_nop 2
    buffer_load_dwordx4 v[20:23], v1, s[28:31], s71 offen offset:256 nt
    ds_read_b32 v223, v240
    v_add_u32 v240, 256, v240
L_h29:
    s_cbranch_execz L_h30
    s_waitcnt vmcnt(23)
    v_pk_fma_f32 v[212:213], v[236:237], v[24:25], v[212:213] op_sel_hi:[0,1,1]
    v_pk_fma_f32 v[214:215], v[236:237], v[26:27], v[214:215] op_sel_hi:[0,1,1]
    ds_add_u32 v224, v243 offset:3328
    buffer_load_dwordx4 v[24:27], v1, s[28:31], s71 offen offset:512 nt
    v_mov_b32_dpp v236, v238 row_newbcast:4 row_mask:0xf bank_mask:0xf
    s_waitcnt vmcnt(23)
    v_pk_fma_f32 v[204:205], v[236:237], v[28:29], v[204:205] op_sel_hi:[0,1,1]
    v_pk_fma_f32 v[206:207], v[236:237], v[30:31], v[206:207] op_sel_hi:[0,1,1]
    s_nop 2
    s_add_u32 s71, s71, 3072
    s_cbranch_vccnz L_th30_2
L_tb30_2:
    buffer_load_dwordx4 v[28:31], v1, s[28:31], s71 offen offset:0 nt
    ds_write_b128 v241, v[216:219] offset:23552
    s_waitcnt vmcnt(23)
    v_pk_fma_f32 v[208:209], v[236:237], v[32:33], v[208:209] op_sel_hi:[0,1,1]
    v_pk_fma_f32 v[210:211], v[236:237], v[34:35], v[210:211] op_sel_hi:[0,1,1]
    s_nop 2
L_h30:
    s_cbranch_execz L_h31
    buffer_load_dwordx4 v[32:35], v1, s[28:31], s71 offen offset:256 nt
    s_waitcnt vmcnt(23)
    v_pk_fma_f32 v[212:213], v[236:237], v[36:37], v[212:213] op_sel_hi:[0,1,1]
    v_pk_fma_f32 v[214:215], v[236:237], v[38:39], v[214:215] op_sel_hi:[0,1,1]
    ds_add_u32 v224, v243 offset:3328
    buffer_load_dwordx4 v[36:39], v1, s[28:31], s71 offen offset:512 nt
    v_mov_b32_dpp v236, v238 row_newbcast:12 row_mask:0xf bank_mask:0xf
    s_waitcnt vmcnt(23)
    v_pk_fma_f32 v[204:205], v[236:237], v[40:41], v[204:205] op_sel_hi:[0,1,1]
    v_pk_fma_f32 v[206:207], v[236:237], v[42:43], v[206:207] op_sel_hi:[0,1,1]
    s_nop 2
    s_add_u32 s71, s71, 3072
    s_cbranch_vccnz L_th33_2
L_tb33_2:
    buffer_load_dwordx4 v[40:43], v1, s[28:31], s71 offen offset:0 nt
    s_waitcnt vmcnt(23)
    v_pk_fma_f32 v[208:209], v[236:237], v[44:45], v[208:209] op_sel_hi:[0,1,1]
    v_pk_fma_f32 v[210:211], v[236:237], v[46:47], v[210:211] op_sel_hi:[0,1,1]
    s_nop 2
    buffer_load_dwordx4 v[44:47], v1, s[28:31], s71 offen offset:256 nt
L_h31:
    s_cbranch_execz L_h32
    s_waitcnt vmcnt(23)
    v_pk_fma_f32 v[212:213], v[236:237], v[48:49], v[212:213] op_sel_hi:[0,1,1]
    v_pk_fma_f32 v[214:215], v[236:237], v[50:51], v[214:215] op_sel_hi:[0,1,1]
    ds_add_u32 v224, v243 offset:3328
    buffer_load_dwordx4 v[48:51], v1, s[28:31], s71 offen offset:512 nt
    v_mov_b32_dpp v236, v238 row_newbcast:2 row_mask:0xf bank_mask:0xf
    s_waitcnt vmcnt(23)
    v_pk_fma_f32 v[204:205], v[236:237], v[52:53], v[204:205] op_sel_hi:[0,1,1]
    v_pk_fma_f32 v[206:207], v[236:237], v[54:55], v[206:207] op_sel_hi:[0,1,1]
    s_nop 2
    ds_read_b32 v244, v243 offset:147
    v_readlane_b32 s70, v245, s91
    s_add_u32 s91, s91, 1
    s_and_b32 s80, s70, 31
    s_mul_i32 s80, s80, 96
    s_lshl_b32 s73, s70, 7
    s_sub_u32 s73, s73, s80
    buffer_load_ushort v220, v3, s[40:43], s73 offen
    buffer_load_ushort v221, v3, s[44:47], s73 offen
L_h32:
    s_cbranch_execz L_h33
    s_add_u32 s71, s71, 384000
    s_cbranch_vccnz L_th36_2
L_tb36_2:
    buffer_load_dwordx4 v[52:55], v1, s[28:31], s71 offen offset:0 nt
    s_waitcnt vmcnt(25)
    v_pk_fma_f32 v[208:209], v[236:237], v[56:57], v[208:209] op_sel_hi:[0,1,1]
    v_pk_fma_f32 v[210:211], v[236:237], v[58:59], v[210:211] op_sel_hi:[0,1,1]
    buffer_load_dwordx4 v[56:59], v1, s[28:31], s71 offen offset:256 nt
    s_waitcnt vmcnt(25)
    v_pk_fma_f32 v[212:213], v[236:237], v[60:61], v[212:213] op_sel_hi:[0,1,1]
    v_pk_fma_f32 v[214:215], v[236:237], v[62:63], v[214:215] op_sel_hi:[0,1,1]
    s_nop 2
    s_waitcnt lgkmcnt(0)
    v_cmp_lt_u32 vcc, v0, v244
    ds_add_u32 v224, v243 offset:3328
    buffer_load_dwordx4 v[60:63], v1, s[28:31], s71 offen offset:512 nt
    v_mov_b32_dpp v236, v238 row_newbcast:10 row_mask:0xf bank_mask:0xf
    s_waitcnt vmcnt(25)
    v_pk_fma_f32 v[204:205], v[236:237], v[64:65], v[204:205] op_sel_hi:[0,1,1]
    v_pk_fma_f32 v[206:207], v[236:237], v[66:67], v[206:207] op_sel_hi:[0,1,1]
L_h33:
    s_cbranch_execz L_h34
    s_add_u32 s71, s71, 3072
    s_cbranch_vccnz L_th39_2
L_tb39_2:
    buffer_load_dwordx4 v[64:67], v1, s[28:31], s71 offen offset:0 nt
    s_waitcnt vmcnt(25)
    v_pk_fma_f32 v[208:209], v[236:237], v[68:69], v[208:209] op_sel_hi:[0,1,1]
    v_pk_fma_f32 v[210:211], v[236:237], v[70:71], v[210:211] op_sel_hi:[0,1,1]
    s_nop 2
    buffer_load_dwordx4 v[68:71], v1, s[28:31], s71 offen offset:256 nt
    s_waitcnt vmcnt(25)
    v_pk_fma_f32 v[212:213], v[236:237], v[72:73], v[212:213] op_sel_hi:[0,1,1]
    v_pk_fma_f32 v[214:215], v[236:237], v[74:75], v[214:215] op_sel_hi:[0,1,1]
    s_nop 2
    ds_add_u32 v224, v243 offset:3328
    buffer_load_dwordx4 v[72:75], v1, s[28:31], s71 offen offset:512 nt
    v_mov_b32_dpp v236, v238 row_newbcast:6 row_mask:0xf bank_mask:0xf
    s_waitcnt vmcnt(25)
    v_pk_fma_f32 v[204:205], v[236:237], v[76:77], v[204:205] op_sel_hi:[0,1,1]
    v_pk_fma_f32 v[206:207], v[236:237], v[78:79], v[206:207] op_sel_hi:[0,1,1]
L_h34:
    s_cbranch_execz L_h35
    s_add_u32 s71, s71, 3072
    s_cbranch_vccnz L_th42_2
L_tb42_2:
    buffer_load_dwordx4 v[76:79], v1, s[28:31], s71 offen offset:0 nt
    s_waitcnt vmcnt(25)
    v_pk_fma_f32 v[208:209], v[236:237], v[80:81], v[208:209] op_sel_hi:[0,1,1]
    v_pk_fma_f32 v[210:211], v[236:237], v[82:83], v[210:211] op_sel_hi:[0,1,1]
    s_nop 2
    buffer_load_dwordx4 v[80:83], v1, s[28:31], s71 offen offset:256 nt
    s_waitcnt vmcnt(25)
    v_pk_fma_f32 v[212:213], v[236:237], v[84:85], v[212:213] op_sel_hi:[0,1,1]
    v_pk_fma_f32 v[214:215], v[236:237], v[86:87], v[214:215] op_sel_hi:[0,1,1]
    s_nop 2
    ds_add_u32 v224, v243 offset:3328
    buffer_load_dwordx4 v[84:87], v1, s[28:31], s71 offen offset:512 nt
    v_mov_b32_dpp v236, v238 row_newbcast:14 row_mask:0xf bank_mask:0xf
    s_waitcnt vmcnt(25)
    v_pk_fma_f32 v[204:205], v[236:237], v[88:89], v[204:205] op_sel_hi:[0,1,1]
    v_pk_fma_f32 v[206:207], v[236:237], v[90:91], v[206:207] op_sel_hi:[0,1,1]
    s_nop 2
L_h35:
    s_cbranch_execz L_h36
    s_add_u32 s71, s71, 3072
    s_cbranch_vccnz L_th45_2
L_tb45_2:
    buffer_load_dwordx4 v[88:91], v1, s[28:31], s71 offen offset:0 nt
    s_waitcnt vmcnt(25)
    v_pk_fma_f32 v[208:209], v[236:237], v[92:93], v[208:209] op_sel_hi:[0,1,1]
    v_pk_fma_f32 v[210:211], v[236:237], v[94:95], v[210:211] op_sel_hi:[0,1,1]
    buffer_load_dwordx4 v[92:95], v1, s[28:31], s71 offen offset:256 nt
    s_cmp_eq_u32 s76, 16
    s_cbranch_scc1 L_getm2
L_gotm2:
    s_waitcnt vmcnt(25)
    v_pk_fma_f32 v[212:213], v[236:237], v[96:97], v[212:213] op_sel_hi:[0,1,1]
    v_pk_fma_f32 v[214:215], v[236:237], v[98:99], v[214:215] op_sel_hi:[0,1,1]
    s_nop 2
    ds_add_u32 v224, v243 offset:3328
    buffer_load_dwordx4 v[96:99], v1, s[28:31], s71 offen offset:512 nt
    v_mov_b32_dpp v236, v238 row_newbcast:1 row_mask:0xf bank_mask:0xf
    s_waitcnt vmcnt(25)
    v_pk_fma_f32 v[204:205], v[236:237], v[4:5], v[204:205] op_sel_hi:[0,1,1]
    v_pk_fma_f32 v[206:207], v[236:237], v[6:7], v[206:207] op_sel_hi:[0,1,1]
L_h36:
    s_cbranch_execz L_h37
    ds_read_b32 v244, v243 offset:147
    s_mul_i32 s71, s70, 49152
    s_and_b32 s80, s70, 31
    s_mul_i32 s80, s80, 36864
    s_sub_u32 s71, s71, s80
    s_cbranch_vccnz L_th0_2
L_tb0_2:
    buffer_load_dwordx4 v[4:7], v1, s[28:31], s71 offen offset:0 nt
    s_waitcnt vmcnt(25)
    v_pk_fma_f32 v[208:209], v[236:237], v[8:9], v[208:209] op_sel_hi:[0,1,1]
    v_pk_fma_f32 v[210:211], v[236:237], v[10:11], v[210:211] op_sel_hi:[0,1,1]
    s_nop 2
    buffer_load_dwordx4 v[8:11], v1, s[28:31], s71 offen offset:256 nt
    s_waitcnt vmcnt(25)
    v_pk_fma_f32 v[212:213], v[236:237], v[12:13], v[212:213] op_sel_hi:[0,1,1]
    v_pk_fma_f32 v[214:215], v[236:237], v[14:15], v[214:215] op_sel_hi:[0,1,1]
    s_nop 2
    s_waitcnt lgkmcnt(0)
    v_cmp_lt_u32 vcc, v0, v244
    ds_add_u32 v224, v243 offset:3328
    buffer_load_dwordx4 v[12:15], v1, s[28:31], s71 offen offset:512 nt
L_h37:
    s_cbranch_execz L_h38
    v_max_f32_dpp v234, v223, v223 row_ror:8 row_mask:0xf bank_mask:0xf
    v_mov_b32_dpp v236, v238 row_newbcast:9 row_mask:0xf bank_mask:0xf
    s_waitcnt vmcnt(25)
    v_pk_fma_f32 v[204:205], v[236:237], v[16:17], v[204:205] op_sel_hi:[0,1,1]
    v_pk_fma_f32 v[206:207], v[236:237], v[18:19], v[206:207] op_sel_hi:[0,1,1]
    s_add_u32 s71, s71, 3072
    s_cbranch_vccnz L_th3_2
L_tb3_2:
    buffer_load_dwordx4 v[16:19], v1, s[28:31], s71 offen offset:0 nt
    v_max_f32_dpp v234, v234, v234 row_ror:4 row_mask:0xf bank_mask:0xf
    s_waitcnt vmcnt(25)
    v_pk_fma_f32 v[208:209], v[236:237], v[20:21], v[208:209] op_sel_hi:[0,1,1]
    v_pk_fma_f32 v[210:211], v[236:237], v[22:23], v[210:211] op_sel_hi:[0,1,1]
    s_nop 2
    buffer_load_dwordx4 v[20:23], v1, s[28:31], s71 offen offset:256 nt
    v_max_f32_dpp v234, v234, v234 row_ror:2 row_mask:0xf bank_mask:0xf
    s_waitcnt vmcnt(25)
    v_pk_fma_f32 v[212:213], v[236:237], v[24:25], v[212:213] op_sel_hi:[0,1,1]
    v_pk_fma_f32 v[214:215], v[236:237], v[26:27], v[214:215] op_sel_hi:[0,1,1]
L_h38:
    s_cbranch_execz L_h39
    ds_add_u32 v224, v243 offset:3328
    buffer_load_dwordx4 v[24:27], v1, s[28:31], s71 offen offset:512 nt
    v_max_f32_dpp v234, v234, v234 row_ror:1 row_mask:0xf bank_mask:0xf
    v_mov_b32_dpp v236, v238 row_newbcast:5 row_mask:0xf bank_mask:0xf
    s_waitcnt vmcnt(25)
    v_pk_fma_f32 v[204:205], v[236:237], v[28:29], v[204:205] op_sel_hi:[0,1,1]
    v_pk_fma_f32 v[206:207], v[236:237], v[30:31], v[206:207] op_sel_hi:[0,1,1]
    s_nop 2
    s_add_u32 s71, s71, 3072
    s_cbranch_vccnz L_th6_2
L_tb6_2:
    buffer_load_dwordx4 v[28:31], v1, s[28:31], s71 offen offset:0 nt
    s_lshr_b64 s[4:5], s[4:5], 1
    s_bitcmp1_b32 s4, 0
    s_cselect_b32 s6, s7, 0x7f7fffff
    v_min_f32 v228, s6, v216
    s_waitcnt vmcnt(25)
    v_pk_fma_f32 v[208:209], v[236:237], v[32:33], v[208:209] op_sel_hi:[0,1,1]
    v_pk_fma_f32 v[210:211], v[236:237], v[34:35], v[210:211] op_sel_hi:[0,1,1]
    s_nop 2
    buffer_load_dwordx4 v[32:35], v1, s[28:31], s71 offen offset:256 nt
L_h39:
    s_cbranch_execz L_h40
    v_max3_f32 v234, v234, v228, s77
    s_waitcnt vmcnt(25)
    v_pk_fma_f32 v[212:213], v[236:237], v[36:37], v[212:213] op_sel_hi:[0,1,1]
    v_pk_fma_f32 v[214:215], v[236:237], v[38:39], v[214:215] op_sel_hi:[0,1,1]
    ds_add_u32 v224, v243 offset:3328
    buffer_load_dwordx4 v[36:39], v1, s[28:31], s71 offen offset:512 nt
    v_sub_f32 v235, v228, v234
    v_sub_f32 v229, v223, v234
    v_mov_b32_dpp v236, v238 row_newbcast:13 row_mask:0xf bank_mask:0xf
    s_waitcnt vmcnt(25)
    v_pk_fma_f32 v[204:205], v[236:237], v[40:41], v[204:205] op_sel_hi:[0,1,1]
    v_pk_fma_f32 v[206:207], v[236:237], v[42:43], v[206:207] op_sel_hi:[0,1,1]
    s_nop 2
    s_add_u32 s71, s71, 3072
    s_cbranch_vccnz L_th9_2
L_tb9_2:
    buffer_load_dwordx4 v[40:43], v1, s[28:31], s71 offen offset:0 nt
    v_exp_f32 v235, v235
    s_waitcnt vmcnt(25)
    v_pk_fma_f32 v[208:209], v[236:237], v[44:45], v[208:209] op_sel_hi:[0,1,1]
L_h40:
    s_cbranch_execz L_h41
    v_pk_fma_f32 v[210:211], v[236:237], v[46:47], v[210:211] op_sel_hi:[0,1,1]
    buffer_load_dwordx4 v[44:47], v1, s[28:31], s71 offen offset:256 nt
    v_exp_f32 v229, v229
    s_waitcnt vmcnt(25)
    v_pk_fma_f32 v[212:213], v[236:237], v[48:49], v[212:213] op_sel_hi:[0,1,1]
    v_pk_fma_f32 v[214:215], v[236:237], v[50:51], v[214:215] op_sel_hi:[0,1,1]
    s_nop 2
    ds_add_u32 v224, v243 offset:3328
    buffer_load_dwordx4 v[48:51], v1, s[28:31], s71 offen offset:512 nt
    v_mov_b32_dpp v236, v238 row_newbcast:3 row_mask:0xf bank_mask:0xf
    s_waitcnt vmcnt(23)
    v_pk_fma_f32 v[204:205], v[236:237], v[52:53], v[204:205] op_sel_hi:[0,1,1]
    v_pk_fma_f32 v[206:207], v[236:237], v[54:55], v[206:207] op_sel_hi:[0,1,1]
    s_nop 2
    ds_read_b32 v244, v243 offset:147
    s_add_u32 s71, s71, 384000
    s_cbranch_vccnz L_th12_2
L_tb12_2:
    buffer_load_dwordx4 v[52:55], v1, s[28:31], s71 offen offset:0 nt
    v_lshlrev_b32 v220, 16, v220
L_h41:
    s_cbranch_execz L_h42
    s_waitcnt vmcnt(23)
    v_pk_fma_f32 v[208:209], v[236:237], v[56:57], v[208:209] op_sel_hi:[0,1,1]
    v_pk_fma_f32 v[210:211], v[236:237], v[58:59], v[210:211] op_sel_hi:[0,1,1]
    buffer_load_dwordx4 v[56:59], v1, s[28:31], s71 offen offset:256 nt
    v_lshlrev_b32 v221, 16, v221
    s_waitcnt vmcnt(23)
    v_pk_fma_f32 v[212:213], v[236:237], v[60:61], v[212:213] op_sel_hi:[0,1,1]
    v_pk_fma_f32 v[214:215], v[236:237], v[62:63], v[214:215] op_sel_hi:[0,1,1]
    s_nop 2
    s_waitcnt lgkmcnt(0)
    v_cmp_lt_u32 vcc, v0, v244
    ds_add_u32 v224, v243 offset:3328
    buffer_load_dwordx4 v[60:63], v1, s[28:31], s71 offen offset:512 nt
    v_mov_b32_dpp v236, v238 row_newbcast:11 row_mask:0xf bank_mask:0xf
    s_waitcnt vmcnt(23)
    v_pk_fma_f32 v[204:205], v[236:237], v[64:65], v[204:205] op_sel_hi:[0,1,1]
    v_pk_fma_f32 v[206:207], v[236:237], v[66:67], v[206:207] op_sel_hi:[0,1,1]
    s_nop 2
    s_add_u32 s71, s71, 3072
    s_cbranch_vccnz L_th15_2
L_tb15_2:
L_h42:
    s_cbranch_execz L_h43
    buffer_load_dwordx4 v[64:67], v1, s[28:31], s71 offen offset:0 nt
    v_mul_f32 v222, v229, v220
    s_waitcnt vmcnt(23)
    v_pk_fma_f32 v[208:209], v[236:237], v[68:69], v[208:209] op_sel_hi:[0,1,1]
    v_pk_fma_f32 v[210:211], v[236:237], v[70:71], v[210:211] op_sel_hi:[0,1,1]
    buffer_load_dwordx4 v[68:71], v1, s[28:31], s71 offen offset:256 nt
    v_mul_f32 v230, v222, v221
    s_waitcnt vmcnt(23)
    v_pk_fma_f32 v[212:213], v[236:237], v[72:73], v[212:213] op_sel_hi:[0,1,1]
    v_pk_fma_f32 v[214:215], v[236:237], v[74:75], v[214:215] op_sel_hi:[0,1,1]
    s_nop 2
    ds_add_u32 v224, v243 offset:3328
    buffer_load_dwordx4 v[72:75], v1, s[28:31], s71 offen offset:512 nt
    v_mov_b32_dpp v236, v238 row_newbcast:7 row_mask:0xf bank_mask:0xf
    s_waitcnt vmcnt(23)
    v_pk_fma_f32 v[204:205], v[236:237], v[76:77], v[204:205] op_sel_hi:[0,1,1]
    v_pk_fma_f32 v[206:207], v[236:237], v[78:79], v[206:207] op_sel_hi:[0,1,1]
    s_nop 2
    s_add_u32 s71, s71, 3072
L_h43:
    s_cbranch_execz L_h44
    s_cbranch_vccnz L_th18_2
L_tb18_2:
    buffer_load_dwordx4 v[76:79], v1, s[28:31], s71 offen offset:0 nt
    s_waitcnt vmcnt(23)
    v_pk_fma_f32 v[208:209], v[236:237], v[80:81], v[208:209] op_sel_hi:[0,1,1]
    v_pk_fma_f32 v[210:211], v[236:237], v[82:83], v[210:211] op_sel_hi:[0,1,1]
    buffer_load_dwordx4 v[80:83], v1, s[28:31], s71 offen offset:256 nt
    s_waitcnt vmcnt(23)
    v_pk_fma_f32 v[212:213], v[236:237], v[84:85], v[212:213] op_sel_hi:[0,1,1]
    v_pk_fma_f32 v[214:215], v[236:237], v[86:87], v[214:215] op_sel_hi:[0,1,1]
    s_nop 2
    ds_add_u32 v224, v243 offset:3328
    buffer_load_dwordx4 v[84:87], v1, s[28:31], s71 offen offset:512 nt
    v_mov_b32_dpp v236, v238 row_newbcast:15 row_mask:0xf bank_mask:0xf
    s_waitcnt vmcnt(23)
    v_pk_fma_f32 v[204:205], v[236:237], v[88:89], v[204:205] op_sel_hi:[0,1,1]
    v_pk_fma_f32 v[206:207], v[236:237], v[90:91], v[206:207] op_sel_hi:[0,1,1]
    s_nop 2
    s_add_u32 s71, s71, 3072
    s_cbranch_vccnz L_th21_2
L_tb21_2:
L_h44:
    s_cbranch_execz L_h45
    buffer_load_dwordx4 v[88:91], v1, s[28:31], s71 offen offset:0 nt
    ds_write_b128 v241, v[204:207] offset:20480
    v_mul_f32 v238, 0x71800000, v222
    s_waitcnt vmcnt(23)
    v_pk_fma_f32 v[208:209], v[236:237], v[92:93], v[208:209] op_sel_hi:[0,1,1]
    v_pk_fma_f32 v[210:211], v[236:237], v[94:95], v[210:211] op_sel_hi:[0,1,1]
    buffer_load_dwordx4 v[92:95], v1, s[28:31], s71 offen offset:256 nt
    ds_write_b128 v241, v[208:211] offset:21504
    v_pk_mul_f32 v[204:205], v[204:205], v[234:235] op_sel:[0,1] op_sel_hi:[1,1]
    v_pk_mul_f32 v[206:207], v[206:207], v[234:235] op_sel:[0,1] op_sel_hi:[1,1]
    s_waitcnt vmcnt(23)
    v_pk_fma_f32 v[212:213], v[236:237], v[96:97], v[212:213] op_sel_hi:[0,1,1]
    v_pk_fma_f32 v[214:215], v[236:237], v[98:99], v[214:215] op_sel_hi:[0,1,1]
    s_nop 2
    ds_add_u32 v224, v243 offset:3328
    buffer_load_dwordx4 v[96:99], v1, s[28:31], s71 offen offset:512 nt
    ds_write_b128 v241, v[212:215] offset:22528
L_h45:
    s_cbranch_execz L_h46
    v_pk_mul_f32 v[208:209], v[208:209], v[234:235] op_sel:[0,1] op_sel_hi:[1,1]
    v_pk_mul_f32 v[210:211], v[210:211], v[234:235] op_sel:[0,1] op_sel_hi:[1,1]
    s_sub_u32 s76, s76, 1
    s_cmp_lg_u32 s76, 0
    s_cbranch_scc1 L_loop1
    v_mov_b32_dpp v236, v238 row_newbcast:0 row_mask:0xf bank_mask:0xf
    s_waitcnt vmcnt(23)
    v_pk_fma_f32 v[204:205], v[236:237], v[4:5], v[204:205] op_sel_hi:[0,1,1]
    v_pk_fma_f32 v[206:207], v[236:237], v[6:7], v[206:207] op_sel_hi:[0,1,1]
    ds_read_b32 v244, v243 offset:147
    s_add_u32 s71, s71, 384000
    s_cbranch_vccnz L_th24_3
L_tb24_3:
    buffer_load_dwordx4 v[4:7], v1, s[28:31], s71 offen offset:0 nt
    s_bitcmp0_b32 s4, 0
    s_cbranch_scc1 L_nofl3
    s_mov_b64 exec, 1
    ds_add_u32 v242, v243
    s_mov_b64 exec, -1
    v_add_u32 v241, 4096, v241
    v_add_u32 v242, 4, v242
L_nofl3:
    s_waitcnt vmcnt(23)
L_h46:
    s_cbranch_execz L_h47
    v_pk_fma_f32 v[208:209], v[236:237], v[8:9], v[208:209] op_sel_hi:[0,1,1]
    v_pk_fma_f32 v[210:211], v[236:237], v[10:11], v[210:211] op_sel_hi:[0,1,1]
    buffer_load_dwordx4 v[8:11], v1, s[28:31], s71 offen offset:256 nt
    v_pk_mul_f32 v[212:213], v[212:213], v[234:235] op_sel:[0,1] op_sel_hi:[1,1]
    v_pk_mul_f32 v[214:215], v[214:215], v[234:235] op_sel:[0,1] op_sel_hi:[1,1]
    v_mov_b32 v216, v234
    s_waitcnt vmcnt(23)
    v_pk_fma_f32 v[212:213], v[236:237], v[12:13], v[212:213] op_sel_hi:[0,1,1]
    v_pk_fma_f32 v[214:215], v[236:237], v[14:15], v[214:215] op_sel_hi:[0,1,1]
    s_nop 2
    s_waitcnt lgkmcnt(0)
    v_cmp_lt_u32 vcc, v0, v244
    ds_add_u32 v224, v243 offset:3328
    buffer_load_dwordx4 v[12:15], v1, s[28:31], s71 offen offset:512 nt
    v_fma_f32 v217, v217, v235, v229
    v_mov_b32_dpp v236, v238 row_newbcast:8 row_mask:0xf bank_mask:0xf
    s_waitcnt vmcnt(23)
    v_pk_fma_f32 v[204:205], v[236:237], v[16:17], v[204:205] op_sel_hi:[0,1,1]
    v_pk_fma_f32 v[206:207], v[236:237], v[18:19], v[206:207] op_sel_hi:[0,1,1]
L_h47:
    s_cbranch_execz L_h48
    s_add_u32 s71, s71, 3072
    s_cbranch_vccnz L_th27_3
L_tb27_3:
    buffer_load_dwordx4 v[16:19], v1, s[28:31], s71 offen offset:0 nt
    v_fma_f32 v218, v218, v235, v230
    s_waitcnt vmcnt(23)
    v_pk_fma_f32 v[208:209], v[236:237], v[20:21], v[208:209] op_sel_hi:[0,1,1]
    v_pk_fma_f32 v[210:211], v[236:237], v[22:23], v[210:211] op_sel_hi:[0,1,1]
    s_nop 2
    buffer_load_dwordx4 v[20:23], v1, s[28:31], s71 offen offset:256 nt
    ds_read_b32 v226, v243 offset:131
    s_waitcnt vmcnt(23)
    v_pk_fma_f32 v[212:213], v[236:237], v[24:25], v[212:213] op_sel_hi:[0,1,1]
    v_pk_fma_f32 v[214:215], v[236:237], v[26:27], v[214:215] op_sel_hi:[0,1,1]
    s_nop 2
    ds_add_u32 v224, v243 offset:3328
    buffer_load_dwordx4 v[24:27], v1, s[28:31], s71 offen offset:512 nt
    v_add_f32_dpp v218, v218, v218 row_ror:8 row_mask:0xf bank_mask:0xf
    v_mov_b32_dpp v236, v238 row_newbcast:4 row_mask:0xf bank_mask:0xf
L_h48:
    s_cbranch_execz L_h49
    s_waitcnt vmcnt(23)
    v_pk_fma_f32 v[204:205], v[236:237], v[28:29], v[204:205] op_sel_hi:[0,1,1]
    v_pk_fma_f32 v[206:207], v[236:237], v[30:31], v[206:207] op_sel_hi:[0,1,1]
    s_add_u32 s71, s71, 3072
    s_cbranch_vccnz L_th30_3
L_tb30_3:
    buffer_load_dwordx4 v[28:31], v1, s[28:31], s71 offen offset:0 nt
    v_add_f32_dpp v218, v218, v218 row_ror:4 row_mask:0xf bank_mask:0xf
    s_waitcnt vmcnt(23)
    v_pk_fma_f32 v[208:209], v[236:237], v[32:33], v[208:209] op_sel_hi:[0,1,1]
    v_pk_fma_f32 v[210:211], v[236:237], v[34:35], v[210:211] op_sel_hi:[0,1,1]
    s_nop 2
    buffer_load_dwordx4 v[32:35], v1, s[28:31], s71 offen offset:256 nt
    v_add_f32_dpp v218, v218, v218 row_ror:2 row_mask:0xf bank_mask:0xf
    s_waitcnt lgkmcnt(0)
    v_readfirstlane_b32 s6, v226
    s_cmp_eq_u32 s6, 0
    s_cbranch_scc1 L_rl3
L_rlb3:
    s_mov_b64 exec, s[88:89]
    buffer_store_dwordx4 v[100:103], v225, s[52:55], s78 offen offset:0
    s_mov_b64 exec, -1
L_h49:
    s_cbranch_execz L_h50
    s_waitcnt vmcnt(23)
    v_pk_fma_f32 v[212:213], v[236:237], v[36:37], v[212:213] op_sel_hi:[0,1,1]
    v_pk_fma_f32 v[214:215], v[236:237], v[38:39], v[214:215] op_sel_hi:[0,1,1]
    ds_add_u32 v224, v243 offset:3328
    buffer_load_dwordx4 v[36:39], v1, s[28:31], s71 offen offset:512 nt
    v_add_f32_dpp v218, v218, v218 row_ror:1 row_mask:0xf bank_mask:0xf
    v_mov_b32_dpp v236, v238 row_newbcast:12 row_mask:0xf bank_mask:0xf
    s_waitcnt vmcnt(23)
    v_pk_fma_f32 v[204:205], v[236:237], v[40:41], v[204:205] op_sel_hi:[0,1,1]
    v_pk_fma_f32 v[206:207], v[236:237], v[42:43], v[206:207] op_sel_hi:[0,1,1]
    s_nop 2
    s_add_u32 s71, s71, 3072
    s_cbranch_vccnz L_th33_3
L_tb33_3:
    buffer_load_dwordx4 v[40:43], v1, s[28:31], s71 offen offset:0 nt
    v_mov_b32 v234, v218
    s_waitcnt vmcnt(23)
    v_pk_fma_f32 v[208:209], v[236:237], v[44:45], v[208:209] op_sel_hi:[0,1,1]
    v_pk_fma_f32 v[210:211], v[236:237], v[46:47], v[210:211] op_sel_hi:[0,1,1]
    s_nop 2
L_h50:
    s_cbranch_execz L_h51
    buffer_load_dwordx4 v[44:47], v1, s[28:31], s71 offen offset:256 nt
    v_permlane32_swap_b32 v218, v234
    s_waitcnt vmcnt(23)
    v_pk_fma_f32 v[212:213], v[236:237], v[48:49], v[212:213] op_sel_hi:[0,1,1]
    v_pk_fma_f32 v[214:215], v[236:237], v[50:51], v[214:215] op_sel_hi:[0,1,1]
    ds_add_u32 v224, v243 offset:3328
    buffer_load_dwordx4 v[48:51], v1, s[28:31], s71 offen offset:512 nt
    v_add_f32 v218, v218, v234
    v_mov_b32_dpp v236, v238 row_newbcast:2 row_mask:0xf bank_mask:0xf
    s_waitcnt vmcnt(23)
    v_pk_fma_f32 v[204:205], v[236:237], v[52:53], v[204:205] op_sel_hi:[0,1,1]
    v_pk_fma_f32 v[206:207], v[236:237], v[54:55], v[206:207] op_sel_hi:[0,1,1]
    s_nop 2
    ds_read_b32 v244, v243 offset:147
    s_add_u32 s71, s71, 384000
    s_cbranch_vccnz L_th36_3
L_tb36_3:
    buffer_load_dwordx4 v[52:55], v1, s[28:31], s71 offen offset:0 nt
    v_mov_b32 v234, v218
    s_waitcnt vmcnt(23)
    v_pk_fma_f32 v[208:209], v[236:237], v[56:57], v[208:209] op_sel_hi:[0,1,1]
L_h51:
    s_cbranch_execz L_h52
    v_pk_fma_f32 v[210:211], v[236:237], v[58:59], v[210:211] op_sel_hi:[0,1,1]
    buffer_load_dwordx4 v[56:59], v1, s[28:31], s71 offen offset:256 nt
    v_permlane16_swap_b32 v218, v234
    s_waitcnt vmcnt(23)
    v_pk_fma_f32 v[212:213], v[236:237], v[60:61], v[212:213] op_sel_hi:[0,1,1]
    v_pk_fma_f32 v[214:215], v[236:237], v[62:63], v[214:215] op_sel_hi:[0,1,1]
    s_nop 2
    s_waitcnt lgkmcnt(0)
    v_cmp_lt_u32 vcc, v0, v244
    ds_add_u32 v224, v243 offset:3328
    buffer_load_dwordx4 v[60:63], v1, s[28:31], s71 offen offset:512 nt
    v_add_f32 v218, v218, v234
    v_mov_b32_dpp v236, v238 row_newbcast:10 row_mask:0xf bank_mask:0xf
    s_waitcnt vmcnt(23)
    v_pk_fma_f32 v[204:205], v[236:237], v[64:65], v[204:205] op_sel_hi:[0,1,1]
    v_pk_fma_f32 v[206:207], v[236:237], v[66:67], v[206:207] op_sel_hi:[0,1,1]
    s_nop 2
    s_add_u32 s71, s71, 3072
    s_cbranch_vccnz L_th39_3
L_tb39_3:
    buffer_load_dwordx4 v[64:67], v1, s[28:31], s71 offen offset:0 nt
L_h52:
    s_cbranch_execz L_h53
    v_mov_b32 v103, s93
    v_lshlrev_b32 v235, 4, v0
    s_lshl_b32 s78, s3, 12
    s_mov_b32 s6, 0x58000000
    s_waitcnt vmcnt(23)
    v_pk_fma_f32 v[208:209], v[236:237], v[68:69], v[208:209] op_sel_hi:[0,1,1]
    v_pk_fma_f32 v[210:211], v[236:237], v[70:71], v[210:211] op_sel_hi:[0,1,1]
    buffer_load_dwordx4 v[68:71], v1, s[28:31], s71 offen offset:256 nt
    s_waitcnt vmcnt(23)
    v_pk_fma_f32 v[212:213], v[236:237], v[72:73], v[212:213] op_sel_hi:[0,1,1]
    v_pk_fma_f32 v[214:215], v[236:237], v[74:75], v[214:215] op_sel_hi:[0,1,1]
    s_nop 2
    ds_add_u32 v224, v243 offset:3328
    buffer_load_dwordx4 v[72:75], v1, s[28:31], s71 offen offset:512 nt
    v_mov_b32_dpp v236, v238 row_newbcast:6 row_mask:0xf bank_mask:0xf
    s_waitcnt vmcnt(23)
    v_pk_fma_f32 v[204:205], v[236:237], v[76:77], v[204:205] op_sel_hi:[0,1,1]
    v_pk_fma_f32 v[206:207], v[236:237], v[78:79], v[206:207] op_sel_hi:[0,1,1]
    s_nop 2
L_h53:
    s_cbranch_execz L_h54
    s_add_u32 s71, s71, 3072
    s_cbranch_vccnz L_th42_3
L_tb42_3:
    buffer_load_dwordx4 v[76:79], v1, s[28:31], s71 offen offset:0 nt
    s_waitcnt vmcnt(23)
    v_pk_fma_f32 v[208:209], v[236:237], v[80:81], v[208:209] op_sel_hi:[0,1,1]
    v_pk_fma_f32 v[210:211], v[236:237], v[82:83], v[210:211] op_sel_hi:[0,1,1]
    buffer_load_dwordx4 v[80:83], v1, s[28:31], s71 offen offset:256 nt
    s_waitcnt vmcnt(23)
    v_pk_fma_f32 v[212:213], v[236:237], v[84:85], v[212:213] op_sel_hi:[0,1,1]
    v_pk_fma_f32 v[214:215], v[236:237], v[86:87], v[214:215] op_sel_hi:[0,1,1]
    s_nop 2
    ds_add_u32 v224, v243 offset:3328
    buffer_load_dwordx4 v[84:87], v1, s[28:31], s71 offen offset:512 nt
    v_mov_b32_dpp v236, v238 row_newbcast:14 row_mask:0xf bank_mask:0xf
    s_waitcnt vmcnt(23)
    v_pk_fma_f32 v[204:205], v[236:237], v[88:89], v[204:205] op_sel_hi:[0,1,1]
    v_pk_fma_f32 v[206:207], v[236:237], v[90:91], v[206:207] op_sel_hi:[0,1,1]
    s_nop 2
    s_add_u32 s71, s71, 3072
L_h54:
    s_cbranch_execz L_h55
    s_cbranch_vccnz L_th45_3
L_tb45_3:
    buffer_load_dwordx4 v[88:91], v1, s[28:31], s71 offen offset:0 nt
    s_waitcnt vmcnt(23)
    v_pk_fma_f32 v[208:209], v[236:237], v[92:93], v[208:209] op_sel_hi:[0,1,1]
    v_pk_fma_f32 v[210:211], v[236:237], v[94:95], v[210:211] op_sel_hi:[0,1,1]
    buffer_load_dwordx4 v[92:95], v1, s[28:31], s71 offen offset:256 nt
    s_waitcnt vmcnt(23)
    v_pk_fma_f32 v[212:213], v[236:237], v[96:97], v[212:213] op_sel_hi:[0,1,1]
    v_pk_fma_f32 v[214:215], v[236:237], v[98:99], v[214:215] op_sel_hi:[0,1,1]
    s_nop 2
    ds_add_u32 v224, v243 offset:3328
    buffer_load_dwordx4 v[96:99], v1, s[28:31], s71 offen offset:512 nt
    ds_write_b32 v243, v243 offset:143
    v_mov_b32_dpp v236, v238 row_newbcast:1 row_mask:0xf bank_mask:0xf
    s_waitcnt vmcnt(23)
    v_pk_fma_f32 v[204:205], v[236:237], v[4:5], v[204:205] op_sel_hi:[0,1,1]
    v_pk_fma_f32 v[206:207], v[236:237], v[6:7], v[206:207] op_sel_hi:[0,1,1]
    s_waitcnt vmcnt(22)
L_h55:
    s_cbranch_execz L_h56
    v_pk_fma_f32 v[208:209], v[236:237], v[8:9], v[208:209] op_sel_hi:[0,1,1]
    v_pk_fma_f32 v[210:211], v[236:237], v[10:11], v[210:211] op_sel_hi:[0,1,1]
    s_waitcnt vmcnt(21)
    v_pk_fma_f32 v[212:213], v[236:237], v[12:13], v[212:213] op_sel_hi:[0,1,1]
    v_pk_fma_f32 v[214:215], v[236:237], v[14:15], v[214:215] op_sel_hi:[0,1,1]
    v_mov_b32_dpp v236, v238 row_newbcast:9 row_mask:0xf bank_mask:0xf
    s_waitcnt vmcnt(20)
    v_pk_fma_f32 v[204:205], v[236:237], v[16:17], v[204:205] op_sel_hi:[0,1,1]
    v_pk_fma_f32 v[206:207], v[236:237], v[18:19], v[206:207] op_sel_hi:[0,1,1]
    s_waitcnt vmcnt(19)
    v_pk_fma_f32 v[208:209], v[236:237], v[20:21], v[208:209] op_sel_hi:[0,1,1]
    v_pk_fma_f32 v[210:211], v[236:237], v[22:23], v[210:211] op_sel_hi:[0,1,1]
    s_waitcnt vmcnt(18)
    v_pk_fma_f32 v[212:213], v[236:237], v[24:25], v[212:213] op_sel_hi:[0,1,1]
    v_pk_fma_f32 v[214:215], v[236:237], v[26:27], v[214:215] op_sel_hi:[0,1,1]
    v_mov_b32_dpp v236, v238 row_newbcast:5 row_mask:0xf bank_mask:0xf
    s_waitcnt vmcnt(17)
    v_pk_fma_f32 v[204:205], v[236:237], v[28:29], v[204:205] op_sel_hi:[0,1,1]
L_h56:
    s_cbranch_execz L_h57
    v_pk_fma_f32 v[206:207], v[236:237], v[30:31], v[206:207] op_sel_hi:[0,1,1]
    s_waitcnt vmcnt(16)
    v_pk_fma_f32 v[208:209], v[236:237], v[32:33], v[208:209] op_sel_hi:[0,1,1]
    v_pk_fma_f32 v[210:211], v[236:237], v[34:35], v[210:211] op_sel_hi:[0,1,1]
    s_waitcnt vmcnt(15)
    v_pk_fma_f32 v[212:213], v[236:237], v[36:37], v[212:213] op_sel_hi:[0,1,1]
    v_pk_fma_f32 v[214:215], v[236:237], v[38:39], v[214:215] op_sel_hi:[0,1,1]
    v_mov_b32_dpp v236, v238 row_newbcast:13 row_mask:0xf bank_mask:0xf
    s_waitcnt vmcnt(14)
    v_pk_fma_f32 v[204:205], v[236:237], v[40:41], v[204:205] op_sel_hi:[0,1,1]
    v_pk_fma_f32 v[206:207], v[236:237], v[42:43], v[206:207] op_sel_hi:[0,1,1]
    s_waitcnt vmcnt(13)
    v_pk_fma_f32 v[208:209], v[236:237], v[44:45], v[208:209] op_sel_hi:[0,1,1]
    v_pk_fma_f32 v[210:211], v[236:237], v[46:47], v[210:211] op_sel_hi:[0,1,1]
    s_waitcnt vmcnt(12)
    v_pk_fma_f32 v[212:213], v[236:237], v[48:49], v[212:213] op_sel_hi:[0,1,1]
    v_pk_fma_f32 v[214:215], v[236:237], v[50:51], v[214:215] op_sel_hi:[0,1,1]
    v_mov_b32_dpp v236, v238 row_newbcast:3 row_mask:0xf bank_mask:0xf
L_h57:
    s_cbranch_execz L_h58
    s_waitcnt vmcnt(11)
    v_pk_fma_f32 v[204:205], v[236:237], v[52:53], v[204:205] op_sel_hi:[0,1,1]
    v_pk_fma_f32 v[206:207], v[236:237], v[54:55], v[206:207] op_sel_hi:[0,1,1]
    s_waitcnt vmcnt(10)
    v_pk_fma_f32 v[208:209], v[236:237], v[56:57], v[208:209] op_sel_hi:[0,1,1]
    v_pk_fma_f32 v[210:211], v[236:237], v[58:59], v[210:211] op_sel_hi:[0,1,1]
    s_waitcnt vmcnt(9)
    v_pk_fma_f32 v[212:213], v[236:237], v[60:61], v[212:213] op_sel_hi:[0,1,1]
    v_pk_fma_f32 v[214:215], v[236:237], v[62:63], v[214:215] op_sel_hi:[0,1,1]
    v_mov_b32_dpp v236, v238 row_newbcast:11 row_mask:0xf bank_mask:0xf
    s_waitcnt vmcnt(8)
    v_pk_fma_f32 v[204:205], v[236:237], v[64:65], v[204:205] op_sel_hi:[0,1,1]
    v_pk_fma_f32 v[206:207], v[236:237], v[66:67], v[206:207] op_sel_hi:[0,1,1]
    s_waitcnt vmcnt(7)
    v_pk_fma_f32 v[208:209], v[236:237], v[68:69], v[208:209] op_sel_hi:[0,1,1]
    v_pk_fma_f32 v[210:211], v[236:237], v[70:71], v[210:211] op_sel_hi:[0,1,1]
    s_waitcnt vmcnt(6)
    v_pk_fma_f32 v[212:213], v[236:237], v[72:73], v[212:213] op_sel_hi:[0,1,1]
    v_pk_fma_f32 v[214:215], v[236:237], v[74:75], v[214:215] op_sel_hi:[0,1,1]
L_h58:
    s_cbranch_execz L_h59
    v_mov_b32_dpp v236, v238 row_newbcast:7 row_mask:0xf bank_mask:0xf
    s_waitcnt vmcnt(5)
    v_pk_fma_f32 v[204:205], v[236:237], v[76:77], v[204:205] op_sel_hi:[0,1,1]
    v_pk_fma_f32 v[206:207], v[236:237], v[78:79], v[206:207] op_sel_hi:[0,1,1]
    s_waitcnt vmcnt(4)
    v_pk_fma_f32 v[208:209], v[236:237], v[80:81], v[208:209] op_sel_hi:[0,1,1]
    v_pk_fma_f32 v[210:211], v[236:237], v[82:83], v[210:211] op_sel_hi:[0,1,1]
    s_waitcnt vmcnt(3)
    v_pk_fma_f32 v[212:213], v[236:237], v[84:85], v[212:213] op_sel_hi:[0,1,1]
    v_pk_fma_f32 v[214:215], v[236:237], v[86:87], v[214:215] op_sel_hi:[0,1,1]
    v_mov_b32_dpp v236, v238 row_newbcast:15 row_mask:0xf bank_mask:0xf
    s_waitcnt vmcnt(2)
    v_pk_fma_f32 v[204:205], v[236:237], v[88:89], v[204:205] op_sel_hi:[0,1,1]
    v_pk_fma_f32 v[206:207], v[236:237], v[90:91], v[206:207] op_sel_hi:[0,1,1]
    s_waitcnt vmcnt(1)
    v_pk_fma_f32 v[208:209], v[236:237], v[92:93], v[208:209] op_sel_hi:[0,1,1]
    v_pk_fma_f32 v[210:211], v[236:237], v[94:95], v[210:211] op_sel_hi:[0,1,1]
    v_permlane32_swap_b32 v204, v206
L_h59:
    s_cbranch_execz L_h60
    v_permlane32_swap_b32 v205, v207
    v_add_f32 v204, v204, v206
    v_add_f32 v205, v205, v207
    v_permlane32_swap_b32 v208, v210
    v_permlane32_swap_b32 v209, v211
    v_add_f32 v208, v208, v210
    v_add_f32 v209, v209, v211
    v_permlane16_swap_b32 v204, v205
    v_add_f32 v204, v204, v205
    v_fma_f32 v100, v204, s6, -v218
    v_permlane16_swap_b32 v208, v209
    v_add_f32 v208, v208, v209
    v_fma_f32 v101, v208, s6, -v218
    s_waitcnt vmcnt(0)
    v_pk_fma_f32 v[212:213], v[236:237], v[96:97], v[212:213] op_sel_hi:[0,1,1]
    v_pk_fma_f32 v[214:215], v[236:237], v[98:99], v[214:215] op_sel_hi:[0,1,1]
    s_nop 1
    v_permlane32_swap_b32 v212, v214
    v_permlane32_swap_b32 v213, v215
    v_add_f32 v212, v212, v214
    v_add_f32 v213, v213, v215
    s_nop 1
    v_permlane16_swap_b32 v212, v213
    v_add_f32 v212, v212, v213
    v_fma_f32 v102, v212, s6, -v218
    s_mov_b64 exec, s[88:89]
    buffer_store_dwordx4 v[100:103], v225, s[52:55], s78 offen offset:0
    s_not_b64 exec, exec
    buffer_store_dwordx4 v[100:103], v225, s[52:55], s78 offen offset:0 sc0 sc1
    s_mov_b64 exec, -1
L_final:
L_h60:
    s_cbranch_execz L_h61
    s_endpgm
L_th24_0:
    s_waitcnt vmcnt(33)
    s_bitcmp0_b32 vcc_lo, 2
    s_cbranch_scc1 L_tb24_0
    s_bitcmp0_b32 vcc_lo, 19
    s_cbranch_scc1 L_tb24_0
    s_waitcnt vmcnt(23)
    s_branch L_tb24_0
L_th27_0:
    s_waitcnt vmcnt(27)
    s_bitcmp0_b32 vcc_lo, 10
    s_cbranch_scc1 L_tb27_0
    s_bitcmp0_b32 vcc_lo, 19
    s_cbranch_scc1 L_tb27_0
    s_waitcnt vmcnt(23)
    s_branch L_tb27_0
L_th30_0:
    s_waitcnt vmcnt(33)
    s_bitcmp0_b32 vcc_lo, 6
    s_cbranch_scc1 L_tb30_0
    s_bitcmp0_b32 vcc_lo, 19
    s_cbranch_scc1 L_tb30_0
    s_waitcnt vmcnt(29)
    s_branch L_tb30_0
L_th33_0:
    s_waitcnt vmcnt(33)
    s_bitcmp0_b32 vcc_lo, 14
    s_cbranch_scc1 L_tb33_0
L_h61:
    s_cbranch_execz L_h62
    s_bitcmp0_b32 vcc_lo, 19
    s_cbranch_scc1 L_tb33_0
    s_waitcnt vmcnt(29)
    s_branch L_tb33_0
L_th36_0:
    s_waitcnt vmcnt(36)
    s_bitcmp0_b32 vcc_lo, 4
    s_cbranch_scc1 L_tb36_0
    s_bitcmp0_b32 vcc_lo, 19
    s_cbranch_scc1 L_tb36_0
    s_waitcnt vmcnt(26)
    s_branch L_tb36_0
L_th39_0:
    s_waitcnt vmcnt(30)
    s_bitcmp0_b32 vcc_lo, 12
    s_cbranch_scc1 L_tb39_0
    s_bitcmp0_b32 vcc_lo, 19
    s_cbranch_scc1 L_tb39_0
    s_waitcnt vmcnt(26)
    s_branch L_tb39_0
L_th42_0:
    s_waitcnt vmcnt(36)
    s_bitcmp0_b32 vcc_lo, 8
    s_cbranch_scc1 L_tb42_0
    s_bitcmp0_b32 vcc_lo, 19
    s_cbranch_scc1 L_tb42_0
    s_waitcnt vmcnt(32)
    s_branch L_tb42_0
L_th45_0:
    s_waitcnt vmcnt(36)
    s_bitcmp0_b32 vcc_lo, 16
    s_cbranch_scc1 L_tb45_0
    s_bitcmp0_b32 vcc_lo, 19
    s_cbranch_scc1 L_tb45_0
    s_waitcnt vmcnt(32)
L_h62:
    s_cbranch_execz L_h63
    s_branch L_tb45_0
L_th0_0:
    s_waitcnt vmcnt(36)
    s_bitcmp0_b32 vcc_lo, 1
    s_cbranch_scc1 L_tb0_0
    s_bitcmp0_b32 vcc_lo, 19
    s_cbranch_scc1 L_tb0_0
    s_waitcnt vmcnt(26)
    s_branch L_tb0_0
L_th3_0:
    s_waitcnt vmcnt(30)
    s_bitcmp0_b32 vcc_lo, 9
    s_cbranch_scc1 L_tb3_0
    s_bitcmp0_b32 vcc_lo, 19
    s_cbranch_scc1 L_tb3_0
    s_waitcnt vmcnt(26)
    s_branch L_tb3_0
L_th6_0:
    s_waitcnt vmcnt(36)
    s_bitcmp0_b32 vcc_lo, 5
    s_cbranch_scc1 L_tb6_0
    s_bitcmp0_b32 vcc_lo, 19
    s_cbranch_scc1 L_tb6_0
    s_waitcnt vmcnt(29)
    s_branch L_tb6_0
L_th9_0:
    s_waitcnt vmcnt(36)
    s_bitcmp0_b32 vcc_lo, 13
    s_cbranch_scc1 L_tb9_0
    s_bitcmp0_b32 vcc_lo, 19
    s_cbranch_scc1 L_tb9_0
    s_waitcnt vmcnt(29)
    s_branch L_tb9_0
L_th12_0:
    s_waitcnt vmcnt(33)
    s_bitcmp0_b32 vcc_lo, 3
L_h63:
    s_cbranch_execz L_h64
    s_cbranch_scc1 L_tb12_0
    s_bitcmp0_b32 vcc_lo, 19
    s_cbranch_scc1 L_tb12_0
    s_waitcnt vmcnt(23)
    s_branch L_tb12_0
L_th15_0:
    s_waitcnt vmcnt(27)
    s_bitcmp0_b32 vcc_lo, 11
    s_cbranch_scc1 L_tb15_0
    s_bitcmp0_b32 vcc_lo, 19
    s_cbranch_scc1 L_tb15_0
    s_waitcnt vmcnt(23)
    s_branch L_tb15_0
L_th18_0:
    s_waitcnt vmcnt(33)
    s_bitcmp0_b32 vcc_lo, 7
    s_cbranch_scc1 L_tb18_0
    s_bitcmp0_b32 vcc_lo, 19
    s_cbranch_scc1 L_tb18_0
    s_waitcnt vmcnt(29)
    s_branch L_tb18_0
L_th21_0:
    s_waitcnt vmcnt(33)
    s_bitcmp0_b32 vcc_lo, 15
    s_cbranch_scc1 L_tb21_0
    s_bitcmp0_b32 vcc_lo, 19
    s_cbranch_scc1 L_tb21_0
    s_waitcnt vmcnt(29)
    s_branch L_tb21_0
L_th24_1:
    s_waitcnt vmcnt(33)
    s_bitcmp0_b32 vcc_lo, 2
    s_cbranch_scc1 L_tb24_1
    s_bitcmp0_b32 vcc_lo, 19
    s_cbranch_scc1 L_tb24_1
L_h64:
    s_cbranch_execz L_h65
    s_waitcnt vmcnt(23)
    s_branch L_tb24_1
L_th27_1:
    s_waitcnt vmcnt(27)
    s_bitcmp0_b32 vcc_lo, 10
    s_cbranch_scc1 L_tb27_1
    s_bitcmp0_b32 vcc_lo, 19
    s_cbranch_scc1 L_tb27_1
    s_waitcnt vmcnt(23)
    s_branch L_tb27_1
L_th30_1:
    s_waitcnt vmcnt(33)
    s_bitcmp0_b32 vcc_lo, 6
    s_cbranch_scc1 L_tb30_1
    s_bitcmp0_b32 vcc_lo, 19
    s_cbranch_scc1 L_tb30_1
    s_waitcnt vmcnt(29)
    s_branch L_tb30_1
L_th33_1:
    s_waitcnt vmcnt(33)
    s_bitcmp0_b32 vcc_lo, 14
    s_cbranch_scc1 L_tb33_1
    s_bitcmp0_b32 vcc_lo, 19
    s_cbranch_scc1 L_tb33_1
    s_waitcnt vmcnt(29)
    s_branch L_tb33_1
L_th36_1:
    s_waitcnt vmcnt(35)
    s_bitcmp0_b32 vcc_lo, 4
    s_cbranch_scc1 L_tb36_1
    s_bitcmp0_b32 vcc_lo, 19
    s_cbranch_scc1 L_tb36_1
    s_waitcnt vmcnt(25)
    s_branch L_tb36_1
L_th39_1:
    s_waitcnt vmcnt(29)
L_h65:
    s_cbranch_execz L_h66
    s_bitcmp0_b32 vcc_lo, 12
    s_cbranch_scc1 L_tb39_1
    s_bitcmp0_b32 vcc_lo, 19
    s_cbranch_scc1 L_tb39_1
    s_waitcnt vmcnt(25)
    s_branch L_tb39_1
L_th42_1:
    s_waitcnt vmcnt(29)
    s_bitcmp0_b32 vcc_lo, 8
    s_cbranch_scc1 L_tb42_1
    s_bitcmp0_b32 vcc_lo, 19
    s_cbranch_scc1 L_tb42_1
    s_waitcnt vmcnt(25)
    s_branch L_tb42_1
L_th45_1:
    s_waitcnt vmcnt(29)
    s_bitcmp0_b32 vcc_lo, 16
    s_cbranch_scc1 L_tb45_1
    s_bitcmp0_b32 vcc_lo, 19
    s_cbranch_scc1 L_tb45_1
    s_waitcnt vmcnt(25)
    s_branch L_tb45_1
L_th0_1:
    s_waitcnt vmcnt(29)
    s_bitcmp0_b32 vcc_lo, 1
    s_cbranch_scc1 L_tb0_1
    s_bitcmp0_b32 vcc_lo, 19
    s_cbranch_scc1 L_tb0_1
    s_waitcnt vmcnt(19)
    s_branch L_tb0_1
L_th3_1:
    s_waitcnt vmcnt(23)
    s_bitcmp0_b32 vcc_lo, 9
    s_cbranch_scc1 L_tb3_1
    s_bitcmp0_b32 vcc_lo, 19
L_h66:
    s_cbranch_execz L_h67
    s_cbranch_scc1 L_tb3_1
    s_waitcnt vmcnt(19)
    s_branch L_tb3_1
L_th6_1:
    s_waitcnt vmcnt(23)
    s_bitcmp0_b32 vcc_lo, 5
    s_cbranch_scc1 L_tb6_1
    s_bitcmp0_b32 vcc_lo, 19
    s_cbranch_scc1 L_tb6_1
    s_waitcnt vmcnt(17)
    s_branch L_tb6_1
L_th9_1:
    s_waitcnt vmcnt(23)
    s_bitcmp0_b32 vcc_lo, 13
    s_cbranch_scc1 L_tb9_1
    s_bitcmp0_b32 vcc_lo, 19
    s_cbranch_scc1 L_tb9_1
    s_waitcnt vmcnt(17)
    s_branch L_tb9_1
L_th12_1:
    s_waitcnt vmcnt(21)
    s_bitcmp0_b32 vcc_lo, 3
    s_cbranch_scc1 L_tb12_1
    s_bitcmp0_b32 vcc_lo, 19
    s_cbranch_scc1 L_tb12_1
    s_waitcnt vmcnt(17)
    s_branch L_tb12_1
L_th15_1:
    s_waitcnt vmcnt(21)
    s_bitcmp0_b32 vcc_lo, 11
    s_cbranch_scc1 L_tb15_1
    s_bitcmp0_b32 vcc_lo, 19
    s_cbranch_scc1 L_tb15_1
    s_waitcnt vmcnt(17)
    s_branch L_tb15_1
L_h67:
    s_branch L_h68
L_th18_1:
    s_waitcnt vmcnt(21)
    s_bitcmp0_b32 vcc_lo, 7
    s_cbranch_scc1 L_tb18_1
    s_bitcmp0_b32 vcc_lo, 19
    s_cbranch_scc1 L_tb18_1
    s_waitcnt vmcnt(17)
    s_branch L_tb18_1
L_th21_1:
    s_waitcnt vmcnt(21)
    s_bitcmp0_b32 vcc_lo, 15
    s_cbranch_scc1 L_tb21_1
    s_bitcmp0_b32 vcc_lo, 19
    s_cbranch_scc1 L_tb21_1
    s_waitcnt vmcnt(17)
    s_branch L_tb21_1
L_th24_2:
    s_bitcmp1_b32 vcc_lo, 2
    s_cbranch_scc1 L_tx24_2
    s_waitcnt vmcnt(22)
    s_branch L_tb24_2
L_tx24_2:
    s_nop 7
    s_waitcnt vmcnt(22)
    s_bitcmp0_b32 vcc_lo, 19
    s_cbranch_scc1 L_tb24_2
    s_waitcnt vmcnt(17)
    s_branch L_tb24_2
L_th27_2:
    s_bitcmp1_b32 vcc_lo, 10
    s_cbranch_scc1 L_tx27_2
    s_waitcnt vmcnt(22)
    s_branch L_tb27_2
L_tx27_2:
    s_nop 7
    s_waitcnt vmcnt(22)
    s_bitcmp0_b32 vcc_lo, 19
L_h68:
    s_cbranch_execz L_h69
    s_cbranch_scc1 L_tb27_2
    s_waitcnt vmcnt(17)
    s_branch L_tb27_2
L_th30_2:
    s_bitcmp1_b32 vcc_lo, 6
    s_cbranch_scc1 L_tx30_2
    s_waitcnt vmcnt(22)
    s_branch L_tb30_2
L_tx30_2:
    s_nop 7
    s_waitcnt vmcnt(22)
    s_bitcmp0_b32 vcc_lo, 19
    s_cbranch_scc1 L_tb30_2
    s_waitcnt vmcnt(17)
    s_branch L_tb30_2
L_th33_2:
    s_bitcmp1_b32 vcc_lo, 14
    s_cbranch_scc1 L_tx33_2
    s_waitcnt vmcnt(22)
    s_branch L_tb33_2
L_tx33_2:
    s_nop 7
    s_waitcnt vmcnt(22)
    s_bitcmp0_b32 vcc_lo, 19
    s_cbranch_scc1 L_tb33_2
    s_waitcnt vmcnt(17)
    s_branch L_tb33_2
L_th36_2:
    s_bitcmp1_b32 vcc_lo, 4
    s_cbranch_scc1 L_tx36_2
    s_waitcnt vmcnt(24)
    s_branch L_tb36_2
L_tx36_2:
    s_nop 7
    s_waitcnt vmcnt(24)
    s_bitcmp0_b32 vcc_lo, 19
    s_cbranch_scc1 L_tb36_2
L_h69:
    s_cbranch_execz L_h70
    s_waitcnt vmcnt(19)
    s_branch L_tb36_2
L_th39_2:
    s_bitcmp1_b32 vcc_lo, 12
    s_cbranch_scc1 L_tx39_2
    s_waitcnt vmcnt(24)
    s_branch L_tb39_2
L_tx39_2:
    s_nop 7
    s_waitcnt vmcnt(24)
    s_bitcmp0_b32 vcc_lo, 19
    s_cbranch_scc1 L_tb39_2
    s_waitcnt vmcnt(19)
    s_branch L_tb39_2
L_th42_2:
    s_bitcmp1_b32 vcc_lo, 8
    s_cbranch_scc1 L_tx42_2
    s_waitcnt vmcnt(24)
    s_branch L_tb42_2
L_tx42_2:
    s_nop 7
    s_waitcnt vmcnt(24)
    s_bitcmp0_b32 vcc_lo, 19
    s_cbranch_scc1 L_tb42_2
    s_waitcnt vmcnt(19)
    s_branch L_tb42_2
L_th45_2:
    s_bitcmp1_b32 vcc_lo, 16
    s_cbranch_scc1 L_tx45_2
    s_waitcnt vmcnt(24)
    s_branch L_tb45_2
L_tx45_2:
    s_nop 7
    s_waitcnt vmcnt(24)
    s_bitcmp0_b32 vcc_lo, 19
    s_cbranch_scc1 L_tb45_2
    s_waitcnt vmcnt(19)
L_h70:
    s_cbranch_execz L_h71
    s_branch L_tb45_2
L_getm2:
    ds_read_b32 v227, v243 offset:139
    ds_read_b32 v226, v243 offset:159
    s_waitcnt lgkmcnt(0)
    v_readfirstlane_b32 s93, v227
    v_readfirstlane_b32 s77, v226
    s_cmp_eq_u32 s93, 0
    s_cbranch_scc1 L_getm2
    ds_read_b32 v226, v243 offset:151
    s_waitcnt lgkmcnt(0)
    v_readfirstlane_b32 s88, v226
    s_cmp_eq_u32 s88, -1
    s_cselect_b64 s[88:89], -1, 0
    s_branch L_gotm2
L_th0_2:
    s_bitcmp1_b32 vcc_lo, 1
    s_cbranch_scc1 L_tx0_2
    s_waitcnt vmcnt(24)
    s_branch L_tb0_2
L_tx0_2:
    s_nop 7
    s_waitcnt vmcnt(24)
    s_bitcmp0_b32 vcc_lo, 19
    s_cbranch_scc1 L_tb0_2
    s_waitcnt vmcnt(19)
    s_branch L_tb0_2
L_th3_2:
    s_bitcmp1_b32 vcc_lo, 9
    s_cbranch_scc1 L_tx3_2
    s_waitcnt vmcnt(24)
    s_branch L_tb3_2
L_h71:
    s_branch L_h72
L_tx3_2:
    s_nop 7
    s_waitcnt vmcnt(24)
    s_bitcmp0_b32 vcc_lo, 19
    s_cbranch_scc1 L_tb3_2
    s_waitcnt vmcnt(19)
    s_branch L_tb3_2
L_th6_2:
    s_bitcmp1_b32 vcc_lo, 5
    s_cbranch_scc1 L_tx6_2
    s_waitcnt vmcnt(24)
    s_branch L_tb6_2
L_tx6_2:
    s_nop 7
    s_waitcnt vmcnt(24)
    s_bitcmp0_b32 vcc_lo, 19
    s_cbranch_scc1 L_tb6_2
    s_waitcnt vmcnt(17)
    s_branch L_tb6_2
L_th9_2:
    s_bitcmp1_b32 vcc_lo, 13
    s_cbranch_scc1 L_tx9_2
    s_waitcnt vmcnt(24)
    s_branch L_tb9_2
L_tx9_2:
    s_nop 7
    s_waitcnt vmcnt(24)
    s_bitcmp0_b32 vcc_lo, 19
    s_cbranch_scc1 L_tb9_2
    s_waitcnt vmcnt(17)
    s_branch L_tb9_2
L_th12_2:
    s_bitcmp1_b32 vcc_lo, 3
    s_cbranch_scc1 L_tx12_2
    s_waitcnt vmcnt(22)
    s_branch L_tb12_2
L_tx12_2:
    s_nop 7
L_h72:
    s_cbranch_execz L_h73
    s_waitcnt vmcnt(22)
    s_bitcmp0_b32 vcc_lo, 19
    s_cbranch_scc1 L_tb12_2
    s_waitcnt vmcnt(17)
    s_branch L_tb12_2
L_th15_2:
    s_bitcmp1_b32 vcc_lo, 11
    s_cbranch_scc1 L_tx15_2
    s_waitcnt vmcnt(22)
    s_branch L_tb15_2
L_tx15_2:
    s_nop 7
    s_waitcnt vmcnt(22)
    s_bitcmp0_b32 vcc_lo, 19
    s_cbranch_scc1 L_tb15_2
    s_waitcnt vmcnt(17)
    s_branch L_tb15_2
L_th18_2:
    s_bitcmp1_b32 vcc_lo, 7
    s_cbranch_scc1 L_tx18_2
    s_waitcnt vmcnt(22)
    s_branch L_tb18_2
L_tx18_2:
    s_nop 7
    s_waitcnt vmcnt(22)
    s_bitcmp0_b32 vcc_lo, 19
    s_cbranch_scc1 L_tb18_2
    s_waitcnt vmcnt(17)
    s_branch L_tb18_2
L_th21_2:
    s_bitcmp1_b32 vcc_lo, 15
    s_cbranch_scc1 L_tx21_2
    s_waitcnt vmcnt(22)
    s_branch L_tb21_2
L_tx21_2:
    s_nop 7
    s_waitcnt vmcnt(22)
L_h73:
    s_cbranch_execz L_h74
    s_bitcmp0_b32 vcc_lo, 19
    s_cbranch_scc1 L_tb21_2
    s_waitcnt vmcnt(17)
    s_branch L_tb21_2
L_th24_3:
    s_bitcmp1_b32 vcc_lo, 2
    s_cbranch_scc1 L_tx24_3
    s_waitcnt vmcnt(22)
    s_branch L_tb24_3
L_tx24_3:
    s_nop 7
    s_waitcnt vmcnt(22)
    s_bitcmp0_b32 vcc_lo, 19
    s_cbranch_scc1 L_tb24_3
    s_waitcnt vmcnt(17)
    s_branch L_tb24_3
L_th27_3:
    s_bitcmp1_b32 vcc_lo, 10
    s_cbranch_scc1 L_tx27_3
    s_waitcnt vmcnt(22)
    s_branch L_tb27_3
L_tx27_3:
    s_nop 7
    s_waitcnt vmcnt(22)
    s_bitcmp0_b32 vcc_lo, 19
    s_cbranch_scc1 L_tb27_3
    s_waitcnt vmcnt(17)
    s_branch L_tb27_3
L_th30_3:
    s_bitcmp1_b32 vcc_lo, 6
    s_cbranch_scc1 L_tx30_3
    s_waitcnt vmcnt(22)
    s_branch L_tb30_3
L_tx30_3:
    s_nop 7
    s_waitcnt vmcnt(22)
    s_bitcmp0_b32 vcc_lo, 19
L_h74:
    s_cbranch_execz L_h75
    s_cbranch_scc1 L_tb30_3
    s_waitcnt vmcnt(17)
    s_branch L_tb30_3
L_rl3:
    ds_read_b32 v226, v243 offset:131
    s_waitcnt lgkmcnt(0)
    v_readfirstlane_b32 s6, v226
    s_cmp_eq_u32 s6, 0
    s_cbranch_scc1 L_rl3
    s_branch L_rlb3
L_th33_3:
    s_bitcmp1_b32 vcc_lo, 14
    s_cbranch_scc1 L_tx33_3
    s_waitcnt vmcnt(22)
    s_branch L_tb33_3
L_tx33_3:
    s_nop 7
    s_waitcnt vmcnt(22)
    s_bitcmp0_b32 vcc_lo, 19
    s_cbranch_scc1 L_tb33_3
    s_waitcnt vmcnt(17)
    s_branch L_tb33_3
L_th36_3:
    s_bitcmp1_b32 vcc_lo, 4
    s_cbranch_scc1 L_tx36_3
    s_waitcnt vmcnt(22)
    s_branch L_tb36_3
L_tx36_3:
    s_nop 7
    s_waitcnt vmcnt(22)
    s_bitcmp0_b32 vcc_lo, 19
    s_cbranch_scc1 L_tb36_3
    s_waitcnt vmcnt(17)
    s_branch L_tb36_3
L_th39_3:
    s_bitcmp1_b32 vcc_lo, 12
L_h75:
    s_cbranch_execz L_hopped
    s_cbranch_scc1 L_tx39_3
    s_waitcnt vmcnt(22)
    s_branch L_tb39_3
L_tx39_3:
    s_nop 7
    s_waitcnt vmcnt(22)
    s_bitcmp0_b32 vcc_lo, 19
    s_cbranch_scc1 L_tb39_3
    s_waitcnt vmcnt(17)
    s_branch L_tb39_3
L_th42_3:
    s_bitcmp1_b32 vcc_lo, 8
    s_cbranch_scc1 L_tx42_3
    s_waitcnt vmcnt(22)
    s_branch L_tb42_3
L_tx42_3:
    s_nop 7
    s_waitcnt vmcnt(22)
    s_bitcmp0_b32 vcc_lo, 19
    s_cbranch_scc1 L_tb42_3
    s_waitcnt vmcnt(17)
    s_branch L_tb42_3
L_th45_3:
    s_bitcmp1_b32 vcc_lo, 16
    s_cbranch_scc1 L_tx45_3
    s_waitcnt vmcnt(22)
    s_branch L_tb45_3
L_tx45_3:
    s_nop 7
    s_waitcnt vmcnt(22)
    s_bitcmp0_b32 vcc_lo, 19
    s_cbranch_scc1 L_tb45_3
    s_waitcnt vmcnt(17)
    s_branch L_tb45_3
L_service:
    v_lshlrev_b32 v5, 2, v0
    v_mov_b32 v3, 0
    ds_write_b32 v5, v3 offset:0
    v_lshlrev_b32 v1, 4, v0
    v_lshlrev_b32 v28, 12, v0
    v_mov_b32 v9, 0xf149f2ca
    v_cndmask_b32 v9, v9, v3, s[66:67]
    v_and_b32 v5, 15, v0
    v_lshrrev_b32 v6, 4, v0
    v_lshl_add_u32 v11, v5, 2, v6
    v_lshlrev_b32 v11, 1, v11
    s_getreg_b32 s72, hwreg(HW_REG_XCC_ID)
    s_and_b32 s72, s72, 15
    s_waitcnt lgkmcnt(0)
    s_barrier
    s_branch L_w0
L_walked:
    s_mov_b32 s24, s6
    s_and_b32 s25, s7, 0xffff
    s_mov_b32 s26, 805306368
    s_mov_b32 s27, 0x00020000
    s_mov_b32 s28, s8
    s_and_b32 s29, s9, 0xffff
    s_mov_b32 s30, 805306368
    s_mov_b32 s31, 0x00020000
    s_mov_b32 s32, s10
    s_and_b32 s33, s11, 0xffff
    s_mov_b32 s34, 6291456
    s_mov_b32 s35, 0x00020000
    s_mov_b32 s36, s12
    s_and_b32 s37, s13, 0xffff
    s_mov_b32 s38, 6291456
    s_mov_b32 s39, 0x00020000
    s_mov_b32 s40, s14
    s_and_b32 s41, s15, 0xffff
    s_mov_b32 s42, 2097152
    s_mov_b32 s43, 0x00020000
    s_mov_b32 s44, s16
    s_and_b32 s45, s17, 0xffff
    s_mov_b32 s46, 2097152
    s_mov_b32 s47, 0x00020000
    s_mov_b32 s48, s4
    s_and_b32 s49, s5, 0xffff
    s_mov_b32 s50, 12288
    s_mov_b32 s51, 0x00020000
    s_mov_b32 s52, s22
    s_and_b32 s53, s23, 0xffff
    s_mov_b32 s54, 25165824
    s_mov_b32 s55, 0x00020000
    s_mov_b64 exec, 0
    s_branch L_h0
L_hopped:
    s_mov_b64 exec, -1
    s_mov_b32 s52, s22
    s_and_b32 s53, s23, 0xffff
    s_mov_b32 s54, 25165824
    s_mov_b32 s55, 0x00020000
    s_mov_b32 s56, s18
    s_and_b32 s57, s19, 0xffff
    s_mov_b32 s58, 12288
    s_mov_b32 s59, 0x00020000
    s_mov_b32 s96, s79
    s_and_b32 s82, s79, 3
    s_lshl_b32 s82, s82, 4
    v_mov_b32 v10, 0
    s_mov_b32 s80, 0x2010200
    s_mov_b32 s81, 0x2030202
    s_cmp_ge_u32 s79, 4
    s_cmov_b32 s80, 0x2050204
    s_cmov_b32 s81, 0x2070206
    s_lshr_b64 s[80:81], s[80:81], s82
    v_writelane_b32 v10, s80, 0
    s_mov_b32 s80, 0x2090208
    s_mov_b32 s81, 0x20b020a
    s_cmp_ge_u32 s79, 4
    s_cmov_b32 s80, 0x20d020c
    s_cmov_b32 s81, 0x20f020e
    s_lshr_b64 s[80:81], s[80:81], s82
    v_writelane_b32 v10, s80, 1
    s_mov_b32 s80, 0x4d00150
    s_mov_b32 s81, 0x8310571
    s_cmp_ge_u32 s79, 4
    s_cmov_b32 s80, 0x57304d2
    s_cmov_b32 s81, 0x4b40174
    s_lshr_b64 s[80:81], s[80:81], s82
    v_writelane_b32 v10, s80, 2
    s_mov_b32 s80, 0x9100d5
    s_mov_b32 s81, 0x15204b6
    s_cmp_ge_u32 s79, 4
    s_cmov_b32 s80, 0x4b700b3
    s_cmov_b32 s81, 0x8d508b7
    s_lshr_b64 s[80:81], s[80:81], s82
    v_writelane_b32 v10, s80, 3
    s_mov_b32 s80, 0x4950000
    s_mov_b32 s81, 0x8b60000
    s_cmp_ge_u32 s79, 4
    s_cmov_b32 s80, 0xc96
    s_cmov_b32 s81, 0xcb70000
    s_lshr_b64 s[80:81], s[80:81], s82
    v_writelane_b32 v10, s80, 4
    s_mov_b32 s80, 0x560000
    s_mov_b32 s81, 0x0
    s_cmp_ge_u32 s79, 4
    s_cmov_b32 s80, 0x37
    s_cmov_b32 s81, 0x0
    s_lshr_b64 s[80:81], s[80:81], s82
    v_writelane_b32 v10, s80, 5
    v_and_b32 v10, 0xffff, v10
L_tag:
    ds_read_b32 v5, v3 offset:140
    ds_read_b64 v[16:17], v3 offset:152
    s_waitcnt lgkmcnt(0)
    v_readfirstlane_b32 s69, v5
    s_cmp_eq_u32 s69, 0
    s_cbranch_scc1 L_tag
    v_readfirstlane_b32 s86, v16
    v_readfirstlane_b32 s87, v17
    s_bfm_b64 s[84:85], s92, 0
    s_bcnt1_i32_b64 s70, s[86:87]
    s_and_b64 s[84:85], s[84:85], s[86:87]
    s_bcnt1_i32_b64 s71, s[84:85]
    s_mov_b32 s73, s71
L_round:
    s_min_u32 s80, s71, 63
    v_readlane_b32 s97, v10, s80
    s_lshl_b32 s80, s71, 2
    v_mov_b32 v4, s80
    s_cmp_eq_u32 s97, 0
    s_cbranch_scc1 L_last
L_poll:
    ds_read_b32 v5, v4 offset:0
    s_waitcnt lgkmcnt(0)
    v_readfirstlane_b32 s80, v5
    s_cmp_eq_u32 s80, 0
    s_cbranch_scc1 L_poll
    s_add_u32 s95, s69, s71
    s_add_u32 s95, s95, 1
    s_and_b32 s80, s71, 1
    s_mul_i32 s80, s80, 0
    s_xor_b32 s80, s80, 0
    s_lshl_b32 s77, s2, 12
    s_add_u32 s77, s77, s80
    s_lshl_b32 s75, s96, 17
    s_add_u32 s75, s75, s80
    s_and_b32 s77, s2, 31
    s_lshl3_add_u32 s77, s77, s75
    v_lshlrev_b32 v6, 3, v0
L_all:
    v_mov_b32 v16, s95
    s_mov_b64 exec, s[86:87]
    buffer_load_dword v16, v6, s[52:55], s75 offen offset:1024 sc0 sc1
    s_mov_b64 exec, -1
    s_waitcnt vmcnt(0)
    v_cmp_ne_u32 vcc, s95, v16
    s_cmp_lg_u64 vcc, 0
    s_cbranch_scc1 L_all
    s_mov_b32 s74, 12
    s_mov_b64 s[84:85], s[86:87]
L_merge:
    v_mov_b32 v7, 0xf149f2ca
    v_mov_b32 v8, 0
    v_mov_b32 v12, 0
    v_mov_b32 v13, 0
    v_mov_b32 v14, 0
L_chunk:
    v_mov_b32 v48, 0
    v_mov_b32 v49, 0
    v_mov_b32 v50, 0
    v_mov_b32 v51, v9
    v_mov_b32 v52, 0
    v_mov_b32 v53, 0
    v_mov_b32 v54, 0
    v_mov_b32 v55, v9
    v_mov_b32 v56, 0
    v_mov_b32 v57, 0
    v_mov_b32 v58, 0
    v_mov_b32 v59, v9
    v_mov_b32 v60, 0
    v_mov_b32 v61, 0
    v_mov_b32 v62, 0
    v_mov_b32 v63, v9
    v_mov_b32 v64, 0
    v_mov_b32 v65, 0
    v_mov_b32 v66, 0
    v_mov_b32 v67, v9
    v_mov_b32 v68, 0
    v_mov_b32 v69, 0
    v_mov_b32 v70, 0
    v_mov_b32 v71, v9
    v_mov_b32 v72, 0
    v_mov_b32 v73, 0
    v_mov_b32 v74, 0
    v_mov_b32 v75, v9
    v_mov_b32 v76, 0
    v_mov_b32 v77, 0
    v_mov_b32 v78, 0
    v_mov_b32 v79, v9
    v_mov_b32 v80, 0
    v_mov_b32 v81, 0
    v_mov_b32 v82, 0
    v_mov_b32 v83, v9
    v_mov_b32 v84, 0
    v_mov_b32 v85, 0
    v_mov_b32 v86, 0
    v_mov_b32 v87, v9
    v_mov_b32 v88, 0
    v_mov_b32 v89, 0
    v_mov_b32 v90, 0
    v_mov_b32 v91, v9
    v_mov_b32 v92, 0
    v_mov_b32 v93, 0
    v_mov_b32 v94, 0
    v_mov_b32 v95, v9
    v_mov_b32 v96, 0
    v_mov_b32 v97, 0
    v_mov_b32 v98, 0
    v_mov_b32 v99, v9
    v_mov_b32 v100, 0
    v_mov_b32 v101, 0
    v_mov_b32 v102, 0
    v_mov_b32 v103, v9
    v_mov_b32 v104, 0
    v_mov_b32 v105, 0
    v_mov_b32 v106, 0
    v_mov_b32 v107, v9
    v_mov_b32 v108, 0
    v_mov_b32 v109, 0
    v_mov_b32 v110, 0
    v_mov_b32 v111, v9
    v_mov_b32 v112, 0
    v_mov_b32 v113, 0
    v_mov_b32 v114, 0
    v_mov_b32 v115, v9
    v_mov_b32 v116, 0
    v_mov_b32 v117, 0
    v_mov_b32 v118, 0
    v_mov_b32 v119, v9
    v_mov_b32 v120, 0
    v_mov_b32 v121, 0
    v_mov_b32 v122, 0
    v_mov_b32 v123, v9
    v_mov_b32 v124, 0
    v_mov_b32 v125, 0
    v_mov_b32 v126, 0
    v_mov_b32 v127, v9
    v_mov_b32 v128, 0
    v_mov_b32 v129, 0
    v_mov_b32 v130, 0
    v_mov_b32 v131, v9
    v_mov_b32 v132, 0
    v_mov_b32 v133, 0
    v_mov_b32 v134, 0
    v_mov_b32 v135, v9
    v_mov_b32 v136, 0
    v_mov_b32 v137, 0
    v_mov_b32 v138, 0
    v_mov_b32 v139, v9
    v_mov_b32 v140, 0
    v_mov_b32 v141, 0
    v_mov_b32 v142, 0
    v_mov_b32 v143, v9
    s_branch L_x1
L_w1:
    s_branch L_w2
L_x1:
    v_mov_b32 v144, 0
    v_mov_b32 v145, 0
    v_mov_b32 v146, 0
    v_mov_b32 v147, v9
    v_mov_b32 v148, 0
    v_mov_b32 v149, 0
    v_mov_b32 v150, 0
    v_mov_b32 v151, v9
    v_mov_b32 v152, 0
    v_mov_b32 v153, 0
    v_mov_b32 v154, 0
    v_mov_b32 v155, v9
    v_mov_b32 v156, 0
    v_mov_b32 v157, 0
    v_mov_b32 v158, 0
    v_mov_b32 v159, v9
    v_mov_b32 v160, 0
    v_mov_b32 v161, 0
    v_mov_b32 v162, 0
    v_mov_b32 v163, v9
    v_mov_b32 v164, 0
    v_mov_b32 v165, 0
    v_mov_b32 v166, 0
    v_mov_b32 v167, v9
    v_mov_b32 v168, 0
    v_mov_b32 v169, 0
    v_mov_b32 v170, 0
    v_mov_b32 v171, v9
    v_mov_b32 v172, 0
    v_mov_b32 v173, 0
    v_mov_b32 v174, 0
    v_mov_b32 v175, v9
    s_ff1_i32_b64 s80, s[84:85]
    s_bitset0_b64 s[84:85], s80
    s_lshl_b32 s81, s80, s74
    s_add_u32 s81, s81, s75
    s_cmp_ge_i32 s80, 0
    s_cselect_b64 exec, -1, 0
    buffer_load_dwordx4 v[48:51], v1, s[52:55], s81 offen sc0 sc1
    s_ff1_i32_b64 s80, s[84:85]
    s_bitset0_b64 s[84:85], s80
    s_lshl_b32 s81, s80, s74
    s_add_u32 s81, s81, s75
    s_cmp_ge_i32 s80, 0
    s_cselect_b64 exec, -1, 0
    buffer_load_dwordx4 v[52:55], v1, s[52:55], s81 offen sc0 sc1
    s_ff1_i32_b64 s80, s[84:85]
    s_bitset0_b64 s[84:85], s80
    s_lshl_b32 s81, s80, s74
    s_add_u32 s81, s81, s75
    s_cmp_ge_i32 s80, 0
    s_cselect_b64 exec, -1, 0
    buffer_load_dwordx4 v[56:59], v1, s[52:55], s81 offen sc0 sc1
    s_ff1_i32_b64 s80, s[84:85]
    s_bitset0_b64 s[84:85], s80
    s_lshl_b32 s81, s80, s74
    s_add_u32 s81, s81, s75
    s_cmp_ge_i32 s80, 0
    s_cselect_b64 exec, -1, 0
    buffer_load_dwordx4 v[60:63], v1, s[52:55], s81 offen sc0 sc1
    s_ff1_i32_b64 s80, s[84:85]
    s_bitset0_b64 s[84:85], s80
    s_lshl_b32 s81, s80, s74
    s_add_u32 s81, s81, s75
    s_cmp_ge_i32 s80, 0
    s_cselect_b64 exec, -1, 0
    buffer_load_dwordx4 v[64:67], v1, s[52:55], s81 offen sc0 sc1
    s_ff1_i32_b64 s80, s[84:85]
    s_bitset0_b64 s[84:85], s80
    s_lshl_b32 s81, s80, s74
    s_add_u32 s81, s81, s75
    s_cmp_ge_i32 s80, 0
    s_cselect_b64 exec, -1, 0
    buffer_load_dwordx4 v[68:71], v1, s[52:55], s81 offen sc0 sc1
    s_ff1_i32_b64 s80, s[84:85]
    s_bitset0_b64 s[84:85], s80
    s_lshl_b32 s81, s80, s74
    s_add_u32 s81, s81, s75
    s_cmp_ge_i32 s80, 0
    s_cselect_b64 exec, -1, 0
    buffer_load_dwordx4 v[72:75], v1, s[52:55], s81 offen sc0 sc1
    s_ff1_i32_b64 s80, s[84:85]
    s_bitset0_b64 s[84:85], s80
    s_lshl_b32 s81, s80, s74
    s_add_u32 s81, s81, s75
    s_cmp_ge_i32 s80, 0
    s_cselect_b64 exec, -1, 0
    buffer_load_dwordx4 v[76:79], v1, s[52:55], s81 offen sc0 sc1
    s_ff1_i32_b64 s80, s[84:85]
    s_bitset0_b64 s[84:85], s80
    s_lshl_b32 s81, s80, s74
    s_add_u32 s81, s81, s75
    s_cmp_ge_i32 s80, 0
    s_cbranch_scc0 L_got
    s_cselect_b64 exec, -1, 0
    buffer_load_dwordx4 v[80:83], v1, s[52:55], s81 offen sc0 sc1
    s_ff1_i32_b64 s80, s[84:85]
    s_bitset0_b64 s[84:85], s80
    s_lshl_b32 s81, s80, s74
    s_add_u32 s81, s81, s75
    s_cmp_ge_i32 s80, 0
    s_cselect_b64 exec, -1, 0
    buffer_load_dwordx4 v[84:87], v1, s[52:55], s81 offen sc0 sc1
    s_ff1_i32_b64 s80, s[84:85]
    s_bitset0_b64 s[84:85], s80
    s_lshl_b32 s81, s80, s74
    s_add_u32 s81, s81, s75
    s_cmp_ge_i32 s80, 0
    s_cselect_b64 exec, -1, 0
    buffer_load_dwordx4 v[88:91], v1, s[52:55], s81 offen sc0 sc1
    s_ff1_i32_b64 s80, s[84:85]
    s_bitset0_b64 s[84:85], s80
    s_lshl_b32 s81, s80, s74
    s_add_u32 s81, s81, s75
    s_cmp_ge_i32 s80, 0
    s_cselect_b64 exec, -1, 0
    buffer_load_dwordx4 v[92:95], v1, s[52:55], s81 offen sc0 sc1
    s_ff1_i32_b64 s80, s[84:85]
    s_bitset0_b64 s[84:85], s80
    s_lshl_b32 s81, s80, s74
    s_add_u32 s81, s81, s75
    s_cmp_ge_i32 s80, 0
    s_cselect_b64 exec, -1, 0
    buffer_load_dwordx4 v[96:99], v1, s[52:55], s81 offen sc0 sc1
    s_ff1_i32_b64 s80, s[84:85]
    s_bitset0_b64 s[84:85], s80
    s_lshl_b32 s81, s80, s74
    s_add_u32 s81, s81, s75
    s_cmp_ge_i32 s80, 0
    s_cselect_b64 exec, -1, 0
    buffer_load_dwordx4 v[100:103], v1, s[52:55], s81 offen sc0 sc1
    s_ff1_i32_b64 s80, s[84:85]
    s_bitset0_b64 s[84:85], s80
    s_lshl_b32 s81, s80, s74
    s_add_u32 s81, s81, s75
    s_cmp_ge_i32 s80, 0
    s_cselect_b64 exec, -1, 0
    buffer_load_dwordx4 v[104:107], v1, s[52:55], s81 offen sc0 sc1
    s_ff1_i32_b64 s80, s[84:85]
    s_bitset0_b64 s[84:85], s80
    s_lshl_b32 s81, s80, s74
    s_add_u32 s81, s81, s75
    s_cmp_ge_i32 s80, 0
    s_cselect_b64 exec, -1, 0
    buffer_load_dwordx4 v[108:111], v1, s[52:55], s81 offen sc0 sc1
    s_ff1_i32_b64 s80, s[84:85]
    s_bitset0_b64 s[84:85], s80
    s_lshl_b32 s81, s80, s74
    s_add_u32 s81, s81, s75
    s_cmp_ge_i32 s80, 0
    s_cbranch_scc0 L_got
    s_cselect_b64 exec, -1, 0
    buffer_load_dwordx4 v[112:115], v1, s[52:55], s81 offen sc0 sc1
    s_ff1_i32_b64 s80, s[84:85]
    s_bitset0_b64 s[84:85], s80
    s_lshl_b32 s81, s80, s74
    s_add_u32 s81, s81, s75
    s_cmp_ge_i32 s80, 0
    s_cselect_b64 exec, -1, 0
    buffer_load_dwordx4 v[116:119], v1, s[52:55], s81 offen sc0 sc1
    s_ff1_i32_b64 s80, s[84:85]
    s_bitset0_b64 s[84:85], s80
    s_lshl_b32 s81, s80, s74
    s_add_u32 s81, s81, s75
    s_cmp_ge_i32 s80, 0
    s_cselect_b64 exec, -1, 0
    buffer_load_dwordx4 v[120:123], v1, s[52:55], s81 offen sc0 sc1
    s_ff1_i32_b64 s80, s[84:85]
    s_bitset0_b64 s[84:85], s80
    s_lshl_b32 s81, s80, s74
    s_add_u32 s81, s81, s75
    s_cmp_ge_i32 s80, 0
    s_cselect_b64 exec, -1, 0
    buffer_load_dwordx4 v[124:127], v1, s[52:55], s81 offen sc0 sc1
    s_ff1_i32_b64 s80, s[84:85]
    s_bitset0_b64 s[84:85], s80
    s_lshl_b32 s81, s80, s74
    s_add_u32 s81, s81, s75
    s_cmp_ge_i32 s80, 0
    s_cselect_b64 exec, -1, 0
    buffer_load_dwordx4 v[128:131], v1, s[52:55], s81 offen sc0 sc1
    s_ff1_i32_b64 s80, s[84:85]
    s_bitset0_b64 s[84:85], s80
    s_lshl_b32 s81, s80, s74
    s_add_u32 s81, s81, s75
    s_cmp_ge_i32 s80, 0
    s_cselect_b64 exec, -1, 0
    buffer_load_dwordx4 v[132:135], v1, s[52:55], s81 offen sc0 sc1
    s_ff1_i32_b64 s80, s[84:85]
    s_bitset0_b64 s[84:85], s80
    s_lshl_b32 s81, s80, s74
    s_add_u32 s81, s81, s75
    s_cmp_ge_i32 s80, 0
    s_cselect_b64 exec, -1, 0
    buffer_load_dwordx4 v[136:139], v1, s[52:55], s81 offen sc0 sc1
    s_ff1_i32_b64 s80, s[84:85]
    s_bitset0_b64 s[84:85], s80
    s_lshl_b32 s81, s80, s74
    s_add_u32 s81, s81, s75
    s_cmp_ge_i32 s80, 0
    s_cselect_b64 exec, -1, 0
    buffer_load_dwordx4 v[140:143], v1, s[52:55], s81 offen sc0 sc1
    s_ff1_i32_b64 s80, s[84:85]
    s_bitset0_b64 s[84:85], s80
    s_lshl_b32 s81, s80, s74
    s_add_u32 s81, s81, s75
    s_cmp_ge_i32 s80, 0
    s_cbranch_scc0 L_got
    s_cselect_b64 exec, -1, 0
    buffer_load_dwordx4 v[144:147], v1, s[52:55], s81 offen sc0 sc1
    s_ff1_i32_b64 s80, s[84:85]
    s_bitset0_b64 s[84:85], s80
    s_lshl_b32 s81, s80, s74
    s_add_u32 s81, s81, s75
    s_cmp_ge_i32 s80, 0
    s_cselect_b64 exec, -1, 0
    buffer_load_dwordx4 v[148:151], v1, s[52:55], s81 offen sc0 sc1
    s_ff1_i32_b64 s80, s[84:85]
    s_bitset0_b64 s[84:85], s80
    s_lshl_b32 s81, s80, s74
    s_add_u32 s81, s81, s75
    s_cmp_ge_i32 s80, 0
    s_cselect_b64 exec, -1, 0
    buffer_load_dwordx4 v[152:155], v1, s[52:55], s81 offen sc0 sc1
    s_ff1_i32_b64 s80, s[84:85]
    s_bitset0_b64 s[84:85], s80
    s_lshl_b32 s81, s80, s74
    s_add_u32 s81, s81, s75
    s_cmp_ge_i32 s80, 0
    s_cselect_b64 exec, -1, 0
    buffer_load_dwordx4 v[156:159], v1, s[52:55], s81 offen sc0 sc1
    s_ff1_i32_b64 s80, s[84:85]
    s_bitset0_b64 s[84:85], s80
    s_lshl_b32 s81, s80, s74
    s_add_u32 s81, s81, s75
    s_cmp_ge_i32 s80, 0
    s_cselect_b64 exec, -1, 0
    buffer_load_dwordx4 v[160:163], v1, s[52:55], s81 offen sc0 sc1
    s_ff1_i32_b64 s80, s[84:85]
    s_bitset0_b64 s[84:85], s80
    s_lshl_b32 s81, s80, s74
    s_add_u32 s81, s81, s75
    s_cmp_ge_i32 s80, 0
    s_cselect_b64 exec, -1, 0
    buffer_load_dwordx4 v[164:167], v1, s[52:55], s81 offen sc0 sc1
    s_ff1_i32_b64 s80, s[84:85]
    s_bitset0_b64 s[84:85], s80
    s_lshl_b32 s81, s80, s74
    s_add_u32 s81, s81, s75
    s_cmp_ge_i32 s80, 0
    s_cselect_b64 exec, -1, 0
    buffer_load_dwordx4 v[168:171], v1, s[52:55], s81 offen sc0 sc1
    s_ff1_i32_b64 s80, s[84:85]
    s_bitset0_b64 s[84:85], s80
    s_lshl_b32 s81, s80, s74
    s_add_u32 s81, s81, s75
    s_cmp_ge_i32 s80, 0
    s_cselect_b64 exec, -1, 0
    buffer_load_dwordx4 v[172:175], v1, s[52:55], s81 offen sc0 sc1
L_got:
    s_mov_b64 exec, -1
    s_waitcnt vmcnt(0)
    v_max_f32 v5, v51, v55
    v_max3_f32 v5, v5, v59, v63
    v_max3_f32 v5, v5, v67, v71
    v_max3_f32 v5, v5, v75, v79
    v_max3_f32 v5, v5, v83, v87
    v_max3_f32 v5, v5, v91, v95
    v_max3_f32 v5, v5, v99, v103
    v_max3_f32 v5, v5, v107, v111
    v_max3_f32 v5, v5, v115, v119
    v_max3_f32 v5, v5, v123, v127
    v_max3_f32 v5, v5, v131, v135
    v_max3_f32 v5, v5, v139, v143
    v_max3_f32 v5, v5, v147, v151
    v_max3_f32 v5, v5, v155, v159
    v_max3_f32 v5, v5, v163, v167
    v_max3_f32 v5, v5, v171, v175
    s_nop 1
    v_max_f32_dpp v6, v5, v7 quad_perm:[0,0,2,2] row_mask:0xf bank_mask:0xf
    v_sub_f32 v5, v7, v6
    v_exp_f32 v5, v5
    v_mov_b32 v7, v6
    v_mul_f32 v8, v8, v5
    v_mul_f32 v12, v12, v5
    v_mul_f32 v13, v13, v5
    v_mul_f32 v14, v14, v5
    v_sub_f32_dpp v20, v51, v6 quad_perm:[0,0,2,2] row_mask:0xf bank_mask:0xf
    v_sub_f32_dpp v21, v55, v6 quad_perm:[0,0,2,2] row_mask:0xf bank_mask:0xf
    v_sub_f32_dpp v22, v59, v6 quad_perm:[0,0,2,2] row_mask:0xf bank_mask:0xf
    v_sub_f32_dpp v23, v63, v6 quad_perm:[0,0,2,2] row_mask:0xf bank_mask:0xf
    v_sub_f32_dpp v24, v67, v6 quad_perm:[0,0,2,2] row_mask:0xf bank_mask:0xf
    v_sub_f32_dpp v25, v71, v6 quad_perm:[0,0,2,2] row_mask:0xf bank_mask:0xf
    v_sub_f32_dpp v26, v75, v6 quad_perm:[0,0,2,2] row_mask:0xf bank_mask:0xf
    v_sub_f32_dpp v27, v79, v6 quad_perm:[0,0,2,2] row_mask:0xf bank_mask:0xf
    v_exp_f32 v20, v20
    v_exp_f32 v21, v21
    v_exp_f32 v22, v22
    v_exp_f32 v23, v23
    v_exp_f32 v24, v24
    v_exp_f32 v25, v25
    v_exp_f32 v26, v26
    v_exp_f32 v27, v27
    s_nop 0
    v_fmac_f32 v12, v20, v48
    v_fmac_f32 v13, v20, v49
    v_fmac_f32 v14, v20, v50
    v_fmac_f32 v8, v20, v51
    v_fmac_f32 v12, v21, v52
    v_fmac_f32 v13, v21, v53
    v_fmac_f32 v14, v21, v54
    v_fmac_f32 v8, v21, v55
    v_fmac_f32 v12, v22, v56
    v_fmac_f32 v13, v22, v57
    v_fmac_f32 v14, v22, v58
    v_fmac_f32 v8, v22, v59
    v_fmac_f32 v12, v23, v60
    v_fmac_f32 v13, v23, v61
    v_fmac_f32 v14, v23, v62
    v_fmac_f32 v8, v23, v63
    v_fmac_f32 v12, v24, v64
    v_fmac_f32 v13, v24, v65
    v_fmac_f32 v14, v24, v66
    v_fmac_f32 v8, v24, v67
    v_fmac_f32 v12, v25, v68
    v_fmac_f32 v13, v25, v69
    v_fmac_f32 v14, v25, v70
    v_fmac_f32 v8, v25, v71
    v_fmac_f32 v12, v26, v72
    v_fmac_f32 v13, v26, v73
    v_fmac_f32 v14, v26, v74
    v_fmac_f32 v8, v26, v75
    v_fmac_f32 v12, v27, v76
    v_fmac_f32 v13, v27, v77
    v_fmac_f32 v14, v27, v78
    v_fmac_f32 v8, v27, v79
    v_sub_f32_dpp v20, v83, v6 quad_perm:[0,0,2,2] row_mask:0xf bank_mask:0xf
    v_sub_f32_dpp v21, v87, v6 quad_perm:[0,0,2,2] row_mask:0xf bank_mask:0xf
    v_sub_f32_dpp v22, v91, v6 quad_perm:[0,0,2,2] row_mask:0xf bank_mask:0xf
    v_sub_f32_dpp v23, v95, v6 quad_perm:[0,0,2,2] row_mask:0xf bank_mask:0xf
    v_sub_f32_dpp v24, v99, v6 quad_perm:[0,0,2,2] row_mask:0xf bank_mask:0xf
    v_sub_f32_dpp v25, v103, v6 quad_perm:[0,0,2,2] row_mask:0xf bank_mask:0xf
    v_sub_f32_dpp v26, v107, v6 quad_perm:[0,0,2,2] row_mask:0xf bank_mask:0xf
    v_sub_f32_dpp v27, v111, v6 quad_perm:[0,0,2,2] row_mask:0xf bank_mask:0xf
    v_exp_f32 v20, v20
    v_exp_f32 v21, v21
    v_exp_f32 v22, v22
    v_exp_f32 v23, v23
    v_exp_f32 v24, v24
    v_exp_f32 v25, v25
    v_exp_f32 v26, v26
    v_exp_f32 v27, v27
    s_nop 0
    v_fmac_f32 v12, v20, v80
    v_fmac_f32 v13, v20, v81
    v_fmac_f32 v14, v20, v82
    v_fmac_f32 v8, v20, v83
    v_fmac_f32 v12, v21, v84
    v_fmac_f32 v13, v21, v85
    v_fmac_f32 v14, v21, v86
    v_fmac_f32 v8, v21, v87
    v_fmac_f32 v12, v22, v88
    v_fmac_f32 v13, v22, v89
    v_fmac_f32 v14, v22, v90
    v_fmac_f32 v8, v22, v91
    v_fmac_f32 v12, v23, v92
    v_fmac_f32 v13, v23, v93
    v_fmac_f32 v14, v23, v94
    v_fmac_f32 v8, v23, v95
    v_fmac_f32 v12, v24, v96
    v_fmac_f32 v13, v24, v97
    v_fmac_f32 v14, v24, v98
    v_fmac_f32 v8, v24, v99
    v_fmac_f32 v12, v25, v100
    v_fmac_f32 v13, v25, v101
    v_fmac_f32 v14, v25, v102
    v_fmac_f32 v8, v25, v103
    v_fmac_f32 v12, v26, v104
    v_fmac_f32 v13, v26, v105
    v_fmac_f32 v14, v26, v106
    v_fmac_f32 v8, v26, v107
    v_fmac_f32 v12, v27, v108
    v_fmac_f32 v13, v27, v109
    v_fmac_f32 v14, v27, v110
    v_fmac_f32 v8, v27, v111
    v_sub_f32_dpp v20, v115, v6 quad_perm:[0,0,2,2] row_mask:0xf bank_mask:0xf
    v_sub_f32_dpp v21, v119, v6 quad_perm:[0,0,2,2] row_mask:0xf bank_mask:0xf
    v_sub_f32_dpp v22, v123, v6 quad_perm:[0,0,2,2] row_mask:0xf bank_mask:0xf
    v_sub_f32_dpp v23, v127, v6 quad_perm:[0,0,2,2] row_mask:0xf bank_mask:0xf
    v_sub_f32_dpp v24, v131, v6 quad_perm:[0,0,2,2] row_mask:0xf bank_mask:0xf
    v_sub_f32_dpp v25, v135, v6 quad_perm:[0,0,2,2] row_mask:0xf bank_mask:0xf
    v_sub_f32_dpp v26, v139, v6 quad_perm:[0,0,2,2] row_mask:0xf bank_mask:0xf
    v_sub_f32_dpp v27, v143, v6 quad_perm:[0,0,2,2] row_mask:0xf bank_mask:0xf
    v_exp_f32 v20, v20
    v_exp_f32 v21, v21
    v_exp_f32 v22, v22
    v_exp_f32 v23, v23
    v_exp_f32 v24, v24
    v_exp_f32 v25, v25
    v_exp_f32 v26, v26
    v_exp_f32 v27, v27
    s_nop 0
    v_fmac_f32 v12, v20, v112
    v_fmac_f32 v13, v20, v113
    v_fmac_f32 v14, v20, v114
    v_fmac_f32 v8, v20, v115
    v_fmac_f32 v12, v21, v116
    v_fmac_f32 v13, v21, v117
    v_fmac_f32 v14, v21, v118
    v_fmac_f32 v8, v21, v119
    v_fmac_f32 v12, v22, v120
    v_fmac_f32 v13, v22, v121
    v_fmac_f32 v14, v22, v122
    v_fmac_f32 v8, v22, v123
    v_fmac_f32 v12, v23, v124
    v_fmac_f32 v13, v23, v125
    v_fmac_f32 v14, v23, v126
    v_fmac_f32 v8, v23, v127
    v_fmac_f32 v12, v24, v128
    v_fmac_f32 v13, v24, v129
    v_fmac_f32 v14, v24, v130
    v_fmac_f32 v8, v24, v131
    v_fmac_f32 v12, v25, v132
    v_fmac_f32 v13, v25, v133
    v_fmac_f32 v14, v25, v134
    v_fmac_f32 v8, v25, v135
    v_fmac_f32 v12, v26, v136
    v_fmac_f32 v13, v26, v137
    v_fmac_f32 v14, v26, v138
    v_fmac_f32 v8, v26, v139
    v_fmac_f32 v12, v27, v140
    v_fmac_f32 v13, v27, v141
    v_fmac_f32 v14, v27, v142
    v_fmac_f32 v8, v27, v143
    v_sub_f32_dpp v20, v147, v6 quad_perm:[0,0,2,2] row_mask:0xf bank_mask:0xf
    v_sub_f32_dpp v21, v151, v6 quad_perm:[0,0,2,2] row_mask:0xf bank_mask:0xf
    v_sub_f32_dpp v22, v155, v6 quad_perm:[0,0,2,2] row_mask:0xf bank_mask:0xf
    v_sub_f32_dpp v23, v159, v6 quad_perm:[0,0,2,2] row_mask:0xf bank_mask:0xf
    v_sub_f32_dpp v24, v163, v6 quad_perm:[0,0,2,2] row_mask:0xf bank_mask:0xf
    v_sub_f32_dpp v25, v167, v6 quad_perm:[0,0,2,2] row_mask:0xf bank_mask:0xf
    v_sub_f32_dpp v26, v171, v6 quad_perm:[0,0,2,2] row_mask:0xf bank_mask:0xf
    v_sub_f32_dpp v27, v175, v6 quad_perm:[0,0,2,2] row_mask:0xf bank_mask:0xf
    v_exp_f32 v20, v20
    v_exp_f32 v21, v21
    v_exp_f32 v22, v22
    v_exp_f32 v23, v23
    v_exp_f32 v24, v24
    v_exp_f32 v25, v25
    v_exp_f32 v26, v26
    v_exp_f32 v27, v27
    s_nop 0
    v_fmac_f32 v12, v20, v144
    v_fmac_f32 v13, v20, v145
    v_fmac_f32 v14, v20, v146
    v_fmac_f32 v8, v20, v147
    v_fmac_f32 v12, v21, v148
    v_fmac_f32 v13, v21, v149
    v_fmac_f32 v14, v21, v150
    v_fmac_f32 v8, v21, v151
    v_fmac_f32 v12, v22, v152
    v_fmac_f32 v13, v22, v153
    v_fmac_f32 v14, v22, v154
    v_fmac_f32 v8, v22, v155
    v_fmac_f32 v12, v23, v156
    v_fmac_f32 v13, v23, v157
    v_fmac_f32 v14, v23, v158
    v_fmac_f32 v8, v23, v159
    v_fmac_f32 v12, v24, v160
    v_fmac_f32 v13, v24, v161
    v_fmac_f32 v14, v24, v162
    v_fmac_f32 v8, v24, v163
    v_fmac_f32 v12, v25, v164
    v_fmac_f32 v13, v25, v165
    v_fmac_f32 v14, v25, v166
    v_fmac_f32 v8, v25, v167
    v_fmac_f32 v12, v26, v168
    v_fmac_f32 v13, v26, v169
    v_fmac_f32 v14, v26, v170
    v_fmac_f32 v8, v26, v171
    v_fmac_f32 v12, v27, v172
    v_fmac_f32 v13, v27, v173
    v_fmac_f32 v14, v27, v174
    v_fmac_f32 v8, v27, v175
    s_cmp_lg_u64 s[84:85], 0
    s_cbranch_scc1 L_chunk
    s_cmp_lg_u32 s74, 12
    s_cbranch_scc1 L_fin
    v_cndmask_b32 v15, v7, v8, s[66:67]
    v_mov_b32 v5, s95
    s_and_b32 s79, s97, 31
    s_lshr_b32 s80, s97, 10
    s_lshl_b32 s80, s80, 3
    s_and_b32 s83, s72, 7
    s_add_u32 s80, s80, s83
    s_bfm_b64 s[88:89], 1, s80
    s_bfe_u32 s83, s97, 0x50005
    s_mul_i32 s83, s83, s70
    s_cmp_lg_u32 s83, 512
    s_cbranch_scc1 L_rec
    s_mov_b64 exec, 1
    buffer_store_dword v5, v3, s[52:55], s77 offen offset:1028
    s_mov_b64 exec, -1
    s_branch L_fin
L_rec:
    s_lshl_b32 s83, s83, 16
    s_or_b32 s89, s89, s83
    v_mov_b32 v16, s88
    v_mov_b32 v17, s89
    s_lshl_b32 s75, s79, 17
    s_add_u32 s75, s75, 4194304
    s_lshl_b32 s80, s80, 11
    s_add_u32 s80, s80, s75
    buffer_store_dwordx4 v[12:15], v1, s[52:55], s80 offen sc0 sc1
    s_mov_b64 exec, 1
    buffer_store_dword v5, v3, s[52:55], s77 offen offset:1028
    s_lshl_b32 s80, s79, 8
    s_add_u32 s80, s80, 23076864
    s_waitcnt vmcnt(0)
    buffer_atomic_add_x2 v[16:17], v3, s[52:55], s80 offen sc0 sc1
    s_waitcnt vmcnt(0)
    s_mov_b64 exec, -1
    v_readfirstlane_b32 s84, v16
    v_readfirstlane_b32 s85, v17
    s_add_u32 s84, s84, s88
    s_add_u32 s85, s85, s89
    s_lshr_b32 s80, s85, 16
    s_cmp_lg_u32 s80, 512
    s_cbranch_scc1 L_next
    s_mov_b32 s74, 11
    s_and_b32 s85, s85, 0xffff
    s_branch L_merge
L_fin:
    s_nop 1
    v_mov_b32_dpp v5, v8 quad_perm:[1,1,3,3] row_mask:0xf bank_mask:0xf
    v_rcp_f32 v5, v5
    s_mul_i32 s80, s79, 384
    v_mul_f32 v12, v12, v5
    v_mul_f32 v13, v13, v5
    v_mul_f32 v14, v14, v5
    v_cvt_pk_bf16_f32 v12, v12, v12
    v_cvt_pk_bf16_f32 v13, v13, v13
    v_cvt_pk_bf16_f32 v14, v14, v14
    buffer_store_short v12, v11, s[56:59], s80 offen offset:0
    buffer_store_short v13, v11, s[56:59], s80 offen offset:128
    buffer_store_short v14, v11, s[56:59], s80 offen offset:256
L_next:
    s_add_u32 s71, s71, s70
    s_branch L_round
L_last:
    s_lshl_b32 s75, s96, 9
    s_add_u32 s75, s75, 1572864
    v_lshrrev_b32 v6, 1, v0
    v_lshlrev_b32 v28, 4, v6
L_inf:
    buffer_load_dwordx4 v[48:51], v28, s[52:55], s75 offen sc0 sc1
    s_waitcnt vmcnt(0)
    v_cmp_ne_u32 vcc, s69, v49
    s_cmp_lg_u64 vcc, 0
    s_cbranch_scc1 L_inf
    v_mov_b32 v7, v50
    s_nop 1
    v_max_f32_dpp v7, v7, v7 row_ror:8 row_mask:0xf bank_mask:0xf
    s_nop 1
    v_max_f32_dpp v7, v7, v7 row_ror:4 row_mask:0xf bank_mask:0xf
    s_nop 1
    v_max_f32_dpp v7, v7, v7 row_ror:2 row_mask:0xf bank_mask:0xf
    s_nop 1
    v_max_f32_dpp v7, v7, v7 row_ror:1 row_mask:0xf bank_mask:0xf
    v_mov_b32 v5, v7
    s_nop 1
    v_permlane32_swap_b32 v7, v5
    s_nop 1
    v_max_f32 v7, v7, v5
    v_mov_b32 v5, v7
    s_nop 1
    v_permlane16_swap_b32 v7, v5
    s_nop 1
    v_max_f32 v7, v7, v5
    v_sub_f32 v20, v50, v7
    v_exp_f32 v20, v20
    s_nop 0
    v_mul_f32 v8, v20, v51
    s_nop 1
    v_add_f32_dpp v8, v8, v8 row_ror:8 row_mask:0xf bank_mask:0xf
    s_nop 1
    v_add_f32_dpp v8, v8, v8 row_ror:4 row_mask:0xf bank_mask:0xf
    s_nop 1
    v_add_f32_dpp v8, v8, v8 row_ror:2 row_mask:0xf bank_mask:0xf
    s_nop 1
    v_add_f32_dpp v8, v8, v8 row_ror:1 row_mask:0xf bank_mask:0xf
    v_mov_b32 v5, v8
    s_nop 1
    v_permlane32_swap_b32 v8, v5
    s_nop 1
    v_add_f32 v8, v8, v5
    v_mov_b32 v5, v8
    s_nop 1
    v_permlane16_swap_b32 v8, v5
    s_nop 1
    v_add_f32 v8, v8, v5
    v_rcp_f32 v8, v8
    v_and_b32 v5, 1, v0
    v_mul_f32 v8, 2.0, v8
    v_mul_f32 v20, v20, v8
    v_lshlrev_b32 v28, 12, v6
    v_lshl_add_u32 v28, v5, 4, v28
    s_lshl_b32 s75, s96, 17
    s_lshl_b32 s80, s92, 5
    s_add_u32 s75, s75, s80
    v_mov_b32 v51, 0
    v_mov_b32 v55, 0
    v_mov_b32 v59, 0
    v_mov_b32 v63, 0
    v_mov_b32 v12, 0
    v_mov_b32 v13, 0
    v_mov_b32 v14, 0
    v_bfe_u32 v6, v0, 4, 1
    v_lshrrev_b32 v11, 5, v0
    v_lshl_add_u32 v11, v6, 1, v11
    v_lshlrev_b32 v11, 7, v11
    v_lshl_add_u32 v11, v5, 3, v11
    s_and_b32 s80, s92, 7
    s_lshl_b32 s80, s80, 4
    s_lshr_b32 s81, s92, 3
    s_lshl_b32 s81, s81, 1
    s_add_u32 s80, s80, s81
    s_add_u32 s79, s96, 24
    s_mul_i32 s78, s79, 384
    s_add_u32 s78, s78, s80
    s_mov_b64 s[24:25], -1
    s_mov_b32 s32, 0x00030003
    s_mov_b32 s33, 0x00000003
L_dt:
    ds_read_b32 v5, v3 offset:144
    s_waitcnt lgkmcnt(0)
    v_readfirstlane_b32 s80, v5
    s_cmp_eq_u32 s80, 0
    s_cbranch_scc1 L_dt
L_pa:
    buffer_load_dwordx4 v[48:51], v28, s[52:55], s75 offen offset:0 sc0 sc1
    s_waitcnt vmcnt(0)
    v_cmpx_eq_u32 vcc, s69, v51
    v_fmac_f32 v12, v20, v48
    v_fmac_f32 v13, v20, v49
    v_fmac_f32 v14, v20, v50
    s_andn2_b64 s[24:25], s[24:25], vcc
    s_mov_b64 exec, s[24:25]
    s_bcnt1_i32_b64 s80, s[24:25]
    s_cmp_gt_u32 s80, 0
    s_cbranch_scc1 L_pa
L_pd:
    s_mov_b64 exec, -1
    v_mov_b32 v15, v14
    v_permlane32_swap_b32 v12, v13
    s_nop 0
    v_permlane32_swap_b32 v14, v15
    v_add_f32 v12, v12, v13
    v_add_f32 v14, v14, v15
    s_nop 1
    v_permlane16_swap_b32 v12, v14
    v_add_f32 v12, v12, v14
    s_nop 1
    v_add_f32_dpp v12, v12, v12 row_ror:8 row_mask:0xf bank_mask:0xf
    s_nop 1
    v_add_f32_dpp v12, v12, v12 row_ror:4 row_mask:0xf bank_mask:0xf
    s_nop 1
    v_add_f32_dpp v12, v12, v12 row_ror:2 row_mask:0xf bank_mask:0xf
    s_mov_b64 exec, s[32:33]
    v_cvt_pk_bf16_f32 v12, v12, v12
    buffer_store_short v12, v11, s[56:59], s78 offen
L_end:
    s_endpgm
L_ticket:
    v_lshlrev_b32 v1, 2, v0
    v_mov_b32 v2, 0
    v_lshlrev_b32 v4, 4, v0
    v_mov_b32 v8, -1
    v_mov_b32 v9, -1
    v_mov_b32 v10, -1
    v_mov_b32 v11, -1
    ds_write_b128 v4, v[8:11] offset:256
    ds_write_b128 v4, v[8:11] offset:1280
    ds_write_b128 v4, v[8:11] offset:2304
    s_memrealtime s[80:81]
    s_waitcnt lgkmcnt(0)
    s_barrier
    s_mov_b32 s52, s22
    s_and_b32 s53, s23, 0xffff
    s_mov_b32 s54, 25165824
    s_mov_b32 s55, 0x00020000
    s_mov_b32 s60, s20
    s_and_b32 s61, s21, 0xffff
    s_mov_b32 s62, 256
    s_mov_b32 s63, 0x00020000
    s_max_u32 s69, s80, 1
    s_cmp_lg_u32 s2, 0
    s_cbranch_scc1 L_kd
    v_lshlrev_b32 v5, 8, v0
    s_mov_b32 s80, 23068672
    v_mov_b32 v3, 0
    buffer_store_dwordx2 v[2:3], v5, s[52:55], s80 offen sc0 sc1
    v_mov_b32 v3, s69
    s_mov_b64 exec, 1
    s_waitcnt vmcnt(0)
    buffer_store_dword v3, v2, s[60:63], 0 offen sc0 sc1
    s_mov_b64 exec, -1
L_kd:
    ds_read_b32 v3, v2 offset:128
    s_waitcnt lgkmcnt(0)
    v_readfirstlane_b32 s80, v3
    s_cmp_eq_u32 s80, 0
    s_cbranch_scc1 L_kd
    ds_read_b128 v[24:27], v4 offset:16128
    ds_read_b128 v[28:31], v4 offset:17152
    ds_read_b128 v[32:35], v4 offset:18176
    ds_read_b128 v[36:39], v4 offset:19200
    s_waitcnt lgkmcnt(0)
    v_max_f32 v18, v24, v25
    v_max3_f32 v18, v18, v26, v27
    v_max3_f32 v18, v18, v28, v29
    v_max3_f32 v18, v18, v30, v31
    v_max3_f32 v18, v18, v32, v33
    v_max3_f32 v18, v18, v34, v35
    v_max3_f32 v18, v18, v36, v37
    v_max3_f32 v18, v18, v38, v39
    s_nop 1
    v_max_f32_dpp v18, v18, v18 row_ror:8 row_mask:0xf bank_mask:0xf
    s_nop 1
    v_max_f32_dpp v18, v18, v18 row_ror:4 row_mask:0xf bank_mask:0xf
    s_nop 1
    v_max_f32_dpp v18, v18, v18 row_ror:2 row_mask:0xf bank_mask:0xf
    s_nop 1
    v_max_f32_dpp v18, v18, v18 row_ror:1 row_mask:0xf bank_mask:0xf
    v_mov_b32 v3, v18
    s_nop 1
    v_permlane32_swap_b32 v18, v3
    s_nop 1
    v_max_f32 v18, v18, v3
    v_mov_b32 v3, v18
    s_nop 1
    v_permlane16_swap_b32 v18, v3
    s_nop 1
    v_max_f32 v18, v18, v3
    v_sub_f32 v24, v24, v18
    v_sub_f32 v25, v25, v18
    v_sub_f32 v26, v26, v18
    v_sub_f32 v27, v27, v18
    v_sub_f32 v28, v28, v18
    v_sub_f32 v29, v29, v18
    v_sub_f32 v30, v30, v18
    v_sub_f32 v31, v31, v18
    v_sub_f32 v32, v32, v18
    v_sub_f32 v33, v33, v18
    v_sub_f32 v34, v34, v18
    v_sub_f32 v35, v35, v18
    v_sub_f32 v36, v36, v18
    v_sub_f32 v37, v37, v18
    v_sub_f32 v38, v38, v18
    v_sub_f32 v39, v39, v18
    v_exp_f32 v24, v24
    v_exp_f32 v25, v25
    v_exp_f32 v26, v26
    v_exp_f32 v27, v27
    v_exp_f32 v28, v28
    v_exp_f32 v29, v29
    v_exp_f32 v30, v30
    v_exp_f32 v31, v31
    v_exp_f32 v32, v32
    v_exp_f32 v33, v33
    v_exp_f32 v34, v34
    v_exp_f32 v35, v35
    v_exp_f32 v36, v36
    v_exp_f32 v37, v37
    v_exp_f32 v38, v38
    v_exp_f32 v39, v39
    ds_write_b32 v2, v18 offset:160
    v_add_f32 v19, v24, v25
    v_add_f32 v19, v19, v26
    v_add_f32 v19, v19, v27
    v_add_f32 v19, v19, v28
    v_add_f32 v19, v19, v29
    v_add_f32 v19, v19, v30
    v_add_f32 v19, v19, v31
    v_add_f32 v19, v19, v32
    v_add_f32 v19, v19, v33
    v_add_f32 v19, v19, v34
    v_add_f32 v19, v19, v35
    v_add_f32 v19, v19, v36
    v_add_f32 v19, v19, v37
    v_add_f32 v19, v19, v38
    v_add_f32 v19, v19, v39
    s_nop 1
    v_add_f32_dpp v19, v19, v19 row_ror:8 row_mask:0xf bank_mask:0xf
    s_nop 1
    v_add_f32_dpp v19, v19, v19 row_ror:4 row_mask:0xf bank_mask:0xf
    s_nop 1
    v_add_f32_dpp v19, v19, v19 row_ror:2 row_mask:0xf bank_mask:0xf
    s_nop 1
    v_add_f32_dpp v19, v19, v19 row_ror:1 row_mask:0xf bank_mask:0xf
    v_mov_b32 v3, v19
    s_nop 1
    v_permlane32_swap_b32 v19, v3
    s_nop 1
    v_add_f32 v19, v19, v3
    v_mov_b32 v3, v19
    s_nop 1
    v_permlane16_swap_b32 v19, v3
    s_nop 1
    v_add_f32 v19, v19, v3
    s_lshl_b32 s80, s2, 11
    s_add_u32 s80, s80, 18874368
    s_waitcnt lgkmcnt(0)
    s_mov_b64 exec, -1
L_tg:
    buffer_load_dword v3, v2, s[60:63], 0 offen sc0 sc1
    s_waitcnt vmcnt(0)
    v_readfirstlane_b32 s69, v3
    s_cmp_eq_u32 s69, 0
    s_cbranch_scc1 L_tg
    s_getreg_b32 s81, hwreg(HW_REG_XCC_ID)
    s_and_b32 s81, s81, 15
    v_mov_b32 v16, s81
    v_mov_b32 v17, s69
    s_lshl_b32 s80, s2, 12
    s_mov_b64 exec, 1
    s_lshl_b32 s82, s2, 4
    s_add_u32 s82, s82, 1572864
    buffer_store_dwordx4 v[16:19], v2, s[52:55], s82 offen sc0 sc1
    v_mov_b32 v12, s69
    v_mov_b32 v13, s69
    s_and_b32 s24, s2, 31
    s_lshl_b32 s80, s79, 17
    s_lshl3_add_u32 s24, s24, s80
    s_mov_b32 s80, s24
    s_add_u32 s82, s80, 0
    buffer_store_dwordx2 v[12:13], v2, s[52:55], s82 offen offset:1024
    s_mov_b64 exec, -1
    s_mov_b32 s73, s81
    s_lshl_b32 s80, s79, 2
    s_lshr_b32 s74, 0x54465464, s80
    s_and_b32 s74, s74, 15
    s_mov_b32 s75, 0
    s_mov_b32 s95, s69
    s_lshl_b32 s77, s2, 12
    s_lshl_b32 s94, s79, 17
    s_mov_b32 s76, 0
    v_mov_b32 v19, 0
    v_lshlrev_b32 v20, 3, v0
    v_mov_b32 v21, v4
L_fl:
    ds_read_b32 v3, v19
    s_waitcnt lgkmcnt(0)
    v_readfirstlane_b32 s80, v3
    s_cmp_eq_u32 s80, 0
    s_cbranch_scc1 L_fl
    ds_read_b128 v[24:27], v21 offset:20480
    ds_read_b128 v[28:31], v21 offset:21504
    ds_read_b128 v[32:35], v21 offset:22528
    ds_read_b128 v[36:39], v21 offset:23552
    s_waitcnt lgkmcnt(0)
    s_nop 0
    v_add_f32_dpp v37, v37, v37 row_ror:8 row_mask:0xf bank_mask:0xf
    v_add_f32_dpp v38, v38, v38 row_ror:8 row_mask:0xf bank_mask:0xf
    s_nop 0
    v_add_f32_dpp v37, v37, v37 row_ror:4 row_mask:0xf bank_mask:0xf
    v_add_f32_dpp v38, v38, v38 row_ror:4 row_mask:0xf bank_mask:0xf
    s_branch L_x2
L_w2:
    s_branch L_walked
L_x2:
    s_nop 0
    v_add_f32_dpp v37, v37, v37 row_ror:2 row_mask:0xf bank_mask:0xf
    v_add_f32_dpp v38, v38, v38 row_ror:2 row_mask:0xf bank_mask:0xf
    s_nop 0
    v_add_f32_dpp v37, v37, v37 row_ror:1 row_mask:0xf bank_mask:0xf
    v_add_f32_dpp v38, v38, v38 row_ror:1 row_mask:0xf bank_mask:0xf
    v_mov_b32 v40, v36
    v_mov_b32 v41, v36
    s_nop 1
    v_permlane32_swap_b32 v40, v41
    s_nop 1
    v_max_f32 v40, v40, v41
    v_mov_b32 v41, v40
    s_nop 1
    v_permlane16_swap_b32 v40, v41
    s_nop 1
    v_max_f32 v40, v40, v41
    v_sub_f32 v41, v36, v40
    v_exp_f32 v41, v41
    v_mov_b32 v48, v40
    v_mul_f32 v37, v37, v41
    v_mul_f32 v38, v38, v41
    v_mul_f32 v41, 0x58000000, v41
    v_fma_f32 v24, v24, v41, -v38
    v_fma_f32 v25, v25, v41, -v38
    v_fma_f32 v26, v26, v41, -v38
    v_fma_f32 v27, v27, v41, -v38
    v_fma_f32 v28, v28, v41, -v38
    v_fma_f32 v29, v29, v41, -v38
    v_fma_f32 v30, v30, v41, -v38
    v_fma_f32 v31, v31, v41, -v38
    v_fma_f32 v32, v32, v41, -v38
    v_fma_f32 v33, v33, v41, -v38
    v_fma_f32 v34, v34, v41, -v38
    v_fma_f32 v35, v35, v41, -v38
    v_mov_b32 v40, v37
    s_nop 1
    v_permlane32_swap_b32 v37, v40
    v_permlane32_swap_b32 v24, v26
    v_permlane32_swap_b32 v25, v27
    v_permlane32_swap_b32 v28, v30
    v_permlane32_swap_b32 v29, v31
    v_permlane32_swap_b32 v32, v34
    v_permlane32_swap_b32 v33, v35
    s_nop 1
    v_add_f32 v37, v37, v40
    v_add_f32 v24, v24, v26
    v_add_f32 v25, v25, v27
    v_add_f32 v28, v28, v30
    v_add_f32 v29, v29, v31
    v_add_f32 v32, v32, v34
    v_add_f32 v33, v33, v35
    v_mov_b32 v40, v37
    s_nop 1
    v_permlane16_swap_b32 v37, v40
    v_permlane16_swap_b32 v24, v25
    v_permlane16_swap_b32 v28, v29
    v_permlane16_swap_b32 v32, v33
    s_nop 1
    v_add_f32 v49, v37, v40
    v_add_f32 v44, v24, v25
    v_add_f32 v45, v28, v29
    v_add_f32 v46, v32, v33
    v_mov_b32 v8, v44
    v_mov_b32 v9, v45
    v_mov_b32 v10, v46
    v_cndmask_b32 v11, v48, v49, s[66:67]
    s_cmp_lg_u32 s75, 0
    s_cbranch_scc1 L_guard
    s_lshr_b32 s82, s3, 5
    s_lshl_b32 s83, s79, 9
    s_add_u32 s83, s83, 1572864
    s_bfm_b64 exec, 32, 0
L_reg:
    buffer_load_dwordx2 v[12:13], v4, s[52:55], s83 offen sc0 sc1
    s_waitcnt vmcnt(0)
    v_cmp_ne_u32 vcc, s69, v13
    s_cmp_lg_u64 vcc, 0
    s_cbranch_scc1 L_reg
    v_cmp_eq_u32 s[86:87], s73, v12
    s_nop 1
    v_mov_b32 v14, s86
    v_mov_b32 v15, s87
    ds_write_b64 v2, v[14:15] offset:152
    s_waitcnt lgkmcnt(0)
    ds_write_b32 v2, v13 offset:140
    s_mov_b64 exec, -1
    s_branch L_dep
L_guard:
    s_sub_u32 s80, s95, 0
    s_add_u32 s81, s94, s76
L_guard2:
    v_mov_b32 v12, s69
    s_mov_b64 exec, s[86:87]
    buffer_load_dword v12, v20, s[52:55], s81 offen offset:1028 sc0 sc1
    s_mov_b64 exec, -1
    s_waitcnt vmcnt(0)
    v_cmp_eq_u32 vcc, s80, v12
    s_cmp_eq_u64 vcc, 0
    s_cbranch_scc1 L_guard2
L_dep:
    s_add_u32 s75, s75, 1
    s_add_u32 s95, s95, 1
    s_add_u32 s80, s77, s76
    v_mov_b32 v3, s95
    s_waitcnt lgkmcnt(0)
    buffer_store_dwordx4 v[8:11], v4, s[52:55], s80 offen
    s_mov_b64 exec, 1
    s_add_u32 s80, s24, s76
    s_waitcnt vmcnt(0)
    buffer_store_dword v3, v2, s[52:55], s80 offen offset:1024
    s_mov_b64 exec, -1
    s_xor_b32 s76, s76, 0
    v_add_u32 v21, 4096, v21
    v_add_u32 v19, 4, v19
    s_cmp_lt_u32 s75, s74
    s_cbranch_scc1 L_fl
L_g3:
    ds_read_b32 v3, v2 offset:3328
    s_waitcnt lgkmcnt(0)
    v_readfirstlane_b32 s80, v3
    s_cmp_lt_u32 s80, 1920
    s_cbranch_scc1 L_g3
L_g4:
    v_mov_b32 v12, s69
    s_mov_b64 exec, s[86:87]
    buffer_load_dword v12, v20, s[52:55], s94 offen offset:1028 sc0 sc1
    s_mov_b64 exec, -1
    s_waitcnt vmcnt(0)
    v_cmp_eq_u32 vcc, s95, v12
    s_cmp_eq_u64 vcc, 0
    s_cbranch_scc1 L_g4
    v_mov_b32 v8, 0
    v_mov_b32 v9, 0
    v_mov_b32 v10, 0
    v_mov_b32 v11, 0
    v_mov_b32 v3, 1
    buffer_store_dwordx4 v[8:11], v4, s[52:55], s77 offen
    s_waitcnt vmcnt(0)
    ds_write_b32 v2, v3 offset:132
    s_waitcnt lgkmcnt(0)
    s_endpgm
L_ctl:
    s_memtime s[48:49]
    s_memrealtime s[50:51]
    s_mov_b32 s56, 8
    s_mov_b32 s57, -1
    s_mov_b32 s58, 0
    s_mov_b32 s92, 1
    s_mov_b32 s59, 8
    v_lshlrev_b32 v1, 2, v0
    v_mov_b32 v2, 0
    ds_write_b32 v1, v2 offset:3328
    s_and_b32 s70, s2, 31
    s_lshl_b32 s70, s70, 2
    s_mov_b32 s71, 1
    v_mov_b32 v7, s2
    v_and_b32 v10, 15, v0
    v_lshrrev_b32 v8, 5, v7
    v_lshl_add_u32 v10, v8, 4, v10
    v_lshrrev_b32 v9, 4, v0
    v_lshl_add_u32 v10, v9, 7, v10
    s_lshl_b32 s82, s79, 3
    s_mov_b32 s80, 0xeff4fa00
    s_mov_b32 s81, 0xdbe0e5ea
    s_lshr_b64 s[80:81], s[80:81], s82
    s_sext_i32_i8 s80, s80
    s_mov_b32 exec_lo, 0x0
    s_mov_b32 exec_hi, 0x3ff
    v_add_u32 v10, s80, v10
    s_mov_b32 s80, 0xeff43d4c
    s_mov_b32 s81, 0xdbe0e5ea
    s_lshr_b64 s[80:81], s[80:81], s82
    s_sext_i32_i8 s80, s80
    s_mov_b32 exec_lo, 0x0
    s_mov_b32 exec_hi, 0x400
    v_add_u32 v10, s80, v10
    s_mov_b32 s80, 0x2c37424d
    s_mov_b32 s81, 0xb1621
    s_lshr_b64 s[80:81], s[80:81], s82
    s_sext_i32_i8 s80, s80
    s_mov_b32 exec_lo, 0x0
    s_mov_b32 exec_hi, 0xf800
    v_add_u32 v10, s80, v10
    s_mov_b64 exec, -1
    v_mul_u32_u24 v30, 1572864, v10
    v_and_b32 v9, 3, v7
    v_lshl_add_u32 v8, v10, 2, v9
    v_bfe_u32 v9, v7, 2, 3
    v_lshl_add_u32 v8, v8, 3, v9
    v_mul_u32_u24 v9, 384, v8
    v_lshlrev_b32 v8, 7, v8
    s_waitcnt lgkmcnt(0)
    s_mov_b32 s32, s10
    s_and_b32 s33, s11, 0xffff
    s_mov_b32 s34, 6291456
    s_mov_b32 s35, 0x00020000
    buffer_load_dword v10, v9, s[32:35], 0 offen offset:0
    buffer_load_dword v11, v9, s[32:35], 0 offen offset:128
    buffer_load_dword v12, v9, s[32:35], 0 offen offset:256
    s_mov_b32 s36, s12
    s_and_b32 s37, s13, 0xffff
    s_mov_b32 s38, 6291456
    s_mov_b32 s39, 0x00020000
    buffer_load_dword v13, v9, s[36:39], 0 offen offset:0
    buffer_load_dword v14, v9, s[36:39], 0 offen offset:128
    buffer_load_dword v15, v9, s[36:39], 0 offen offset:256
    s_mov_b32 s40, s14
    s_and_b32 s41, s15, 0xffff
    s_mov_b32 s42, 2097152
    s_mov_b32 s43, 0x00020000
    buffer_load_dword v16, v8, s[40:43], 0 offen offset:0
    s_mov_b32 s44, s16
    s_and_b32 s45, s17, 0xffff
    s_mov_b32 s46, 2097152
    s_mov_b32 s47, 0x00020000
    buffer_load_dword v17, v8, s[44:47], 0 offen offset:0
    s_mov_b32 s52, s22
    s_and_b32 s53, s23, 0xffff
    s_mov_b32 s54, 25165824
    s_mov_b32 s55, 0x00020000
    v_lshlrev_b32 v7, 7, v0
    s_lshl_b32 s80, s2, 12
    s_add_u32 s81, s80, 0
    s_add_u32 s82, s80, 0
    s_mov_b64 exec, 0x1ff
    s_and_b32 s83, s2, 31
    s_movk_i32 s83, 0x3ff
    s_cselect_b32 exec_lo, 0xff, s83
    buffer_load_dword v18, v7, s[52:55], s81 offen
    s_mov_b64 exec, -1
    s_barrier
    s_mov_b32 s60, s20
    s_and_b32 s61, s21, 0xffff
    s_mov_b32 s62, 256
    s_mov_b32 s63, 0x00020000
    s_mov_b32 s52, s22
    s_and_b32 s53, s23, 0xffff
    s_mov_b32 s54, 25165824
    s_mov_b32 s55, 0x00020000
    s_getreg_b32 s76, hwreg(HW_REG_XCC_ID)
    s_and_b32 s76, s76, 15
    s_lshr_b32 s70, s70, 1
    s_and_b32 s75, s2, 31
    s_cmp_eq_u32 s75, 0
    s_cselect_b32 s75, 32, s75
    s_mul_i32 s77, s75, 32
    s_mul_i32 s83, s75, 16
    s_add_u32 s83, s83, 768
    s_min_u32 s77, s77, s83
    v_lshlrev_b32 v1, 1, v0
    v_lshlrev_b32 v7, 7, v0
    s_mov_b32 s24, s6
    s_and_b32 s25, s7, 0xffff
    s_mov_b32 s26, 805306368
    s_mov_b32 s27, 0x00020000
    s_mov_b32 s28, s8
    s_and_b32 s29, s9, 0xffff
    s_mov_b32 s30, 805306368
    s_mov_b32 s31, 0x00020000
    s_and_b32 s88, s2, 31
    s_lshl_b32 s89, s88, 4
    s_sub_i32 s89, s89, 63
    s_mov_b32 s90, 1572800
L_c:
    ds_read_b32 v3, v2 offset:3328
    ds_read_b32 v4, v2 offset:144
    s_mov_b64 exec, 1
    s_waitcnt lgkmcnt(0)
    v_add_u32 v3, 1, v3
    buffer_store_short v3, v2, s[60:63], s70 offen offset:128
    s_bfm_b64 exec, 33, 0
    buffer_load_ushort v5, v1, s[60:63], 0 offen offset:128 sc1
    v_readfirstlane_b32 s72, v3
    v_readfirstlane_b32 s81, v4
    s_add_u32 s80, s71, s72
    s_mov_b32 s71, s72
    s_mov_b64 exec, 0xffffffff
    s_waitcnt vmcnt(0)
    v_cmp_ne_u32 vcc, 0, v5
    v_lshlrev_b32 v6, 1, v5
    v_readlane_b32 s86, v5, 32
    v_cmp_le_u32 s[82:83], s80, v6
    s_bcnt1_i32_b64 s73, vcc
    s_cmp_eq_u32 s86, 0
    s_cselect_b32 s86, 1024, s86
    s_bcnt1_i32_b64 s74, s[82:83]
    s_sub_i32 s86, s86, 1003
    s_cmp_ge_u32 s72, 1024
    s_cselect_b32 s80, 1, 0
    s_add_i32 s86, s86, s80
    s_cmp_ge_u32 s72, 1920
    s_cselect_b32 s80, 2, 0
    s_add_i32 s86, s86, s80
    s_cmp_ge_u32 s72, 1024
    s_cselect_b32 s80, s58, s57
    s_add_i32 s86, s86, s80
    s_mul_i32 s80, s73, s86
    s_lshl_b32 s74, s74, 5
    s_cmp_lt_i32 s74, s80
    s_cselect_b32 s86, 1, 0
    s_lshl_b32 s82, s73, 5
    s_add_u32 s74, s74, s82
    s_cmp_lt_i32 s74, s80
    s_cselect_b32 s86, 2, s86
    s_cmp_ge_u32 s72, 1024
    s_cselect_b32 s80, s59, s92
    s_cmp_eq_u32 s86, 2
    s_cselect_b32 s80, 20, s80
    s_cmp_eq_u32 s86, 0
    s_cselect_b32 s86, 0, s80
    v_mov_b32 v6, s86
    ds_write_b32 v2, v6 offset:148
    s_cmp_lt_u32 s72, s56
    s_cbranch_scc1 L_nad
    s_memtime s[64:65]
    s_memrealtime s[66:67]
    s_add_u32 s56, s72, 64
    s_waitcnt lgkmcnt(0)
    s_sub_u32 s68, s64, s48
    s_sub_u32 s69, s66, s50
    s_mov_b32 s48, s64
    s_mov_b32 s50, s66
    v_cvt_f32_u32 v25, s69
    v_cvt_f32_u32 v24, s68
    v_rcp_f32 v25, v25
    s_nop 1
    v_mul_f32 v24, v24, v25
    v_add_f32 v26, 0xc19cdfda, v24
    v_mul_f32 v26, 0x405c28f6, v26
    v_rndne_f32 v26, v26
    v_cvt_i32_f32 v26, v26
    v_med3_i32 v26, v26, 1, 17
    v_add_f32 v27, 0xc1b73333, v24
    v_mul_f32 v27, 0x41200000, v27
    v_rndne_f32 v27, v27
    v_cvt_i32_f32 v27, v27
    v_med3_i32 v27, v27, 1, 17
    v_add_f32 v25, 0xc1b5999a, v24
    v_readfirstlane_b32 s92, v27
    v_readfirstlane_b32 s68, v24
    v_mul_f32 v25, 0x40600000, v25
    v_rndne_f32 v25, v25
    v_cvt_i32_f32 v25, v25
    s_cmp_ge_u32 s68, 0x00000000
    s_mov_b32 s69, 0x00000000
    s_cselect_b32 s69, 0x41a0cccd, s69
    v_readfirstlane_b32 s59, v26
    v_readfirstlane_b32 s57, v25
    v_subrev_f32 v24, s69, v24
    v_mul_f32 v24, 0x40800000, v24
    v_rndne_f32 v24, v24
    v_cvt_i32_f32 v24, v24
    s_max_i32 s57, s57, -13
    s_min_i32 s57, s57, 1
    v_readfirstlane_b32 s58, v24
    s_max_i32 s58, s58, -10
    s_min_i32 s58, s58, 0
L_nad:
    s_cmp_lt_i32 s72, s89
    s_cbranch_scc1 L_ntp
    v_readlane_b32 s87, v30, s88
    s_min_u32 s87, s87, 803733504
    s_cmp_ge_u32 s88, 64
    s_cbranch_scc1 L_tpv
    s_load_dword s90, s[6:7], s87
    s_add_u32 s87, s87, 1572800
    s_load_dword s91, s[6:7], s87
    s_branch L_tpd
L_tpv:
    s_load_dword s90, s[8:9], s87
    s_add_u32 s87, s87, 1572800
    s_load_dword s91, s[8:9], s87
L_tpd:
    s_add_u32 s88, s88, 32
    s_add_i32 s89, s89, 512
    s_cmp_ge_u32 s88, 128
    s_cselect_b32 s89, 0x7fffffff, s89
    s_mov_b64 exec, 0xffffffff
L_ntp:
    s_cmp_lt_u32 s72, s77
    s_cbranch_scc1 L_cn
    s_memrealtime s[84:85]
    s_lshl_b32 s86, s75, 11
    s_add_u32 s75, s75, 32
    s_mul_i32 s77, s75, 32
    s_mul_i32 s83, s75, 16
    s_add_u32 s83, s83, 768
    s_min_u32 s77, s77, s83
    s_cmp_lg_u32 s73, 32
    s_cbranch_scc1 L_cn
    v_add_u32_dpp v5, v5, v5 row_ror:8 row_mask:0xf bank_mask:0xf
    s_nop 1
    v_add_u32_dpp v5, v5, v5 row_ror:4 row_mask:0xf bank_mask:0xf
    s_nop 1
    v_add_u32_dpp v5, v5, v5 row_ror:2 row_mask:0xf bank_mask:0xf
    s_nop 1
    v_add_u32_dpp v5, v5, v5 row_ror:1 row_mask:0xf bank_mask:0xf
    s_nop 1
    v_readlane_b32 s74, v5, 0
    v_readlane_b32 s73, v5, 16
    s_add_u32 s86, s86, 1112064
    s_lshl_b32 s80, s76, 7
    s_add_u32 s80, s80, s86
    s_add_u32 s74, s74, s73
    s_lshl_b32 s74, s74, 2
    s_waitcnt lgkmcnt(0)
    s_mul_i32 s73, s84, 13
    s_sub_u32 s74, s74, s73
    v_mov_b32 v8, s74
    v_mov_b32 v9, s84
    s_mov_b64 exec, 1
    buffer_store_dwordx2 v[8:9], v2, s[52:55], s80 offen offset:2048 sc0 sc1
    s_load_dwordx2 s[32:33], s[22:23], s86 offset:0 glc
    s_load_dwordx2 s[34:35], s[22:23], s86 offset:128 glc
    s_load_dwordx2 s[36:37], s[22:23], s86 offset:256 glc
    s_load_dwordx2 s[38:39], s[22:23], s86 offset:384 glc
    s_load_dwordx2 s[40:41], s[22:23], s86 offset:512 glc
    s_load_dwordx2 s[42:43], s[22:23], s86 offset:640 glc
    s_load_dwordx2 s[44:45], s[22:23], s86 offset:768 glc
    s_load_dwordx2 s[46:47], s[22:23], s86 offset:896 glc
    s_mov_b64 exec, 0xffff
    v_mov_b32 v23, 0
    s_waitcnt lgkmcnt(0)
    v_writelane_b32 v22, s32, 0
    v_writelane_b32 v23, s33, 0
    v_writelane_b32 v22, s34, 1
    v_writelane_b32 v23, s35, 1
    v_writelane_b32 v22, s36, 2
    v_writelane_b32 v23, s37, 2
    v_writelane_b32 v22, s38, 3
    v_writelane_b32 v23, s39, 3
    v_writelane_b32 v22, s40, 4
    v_writelane_b32 v23, s41, 4
    v_writelane_b32 v22, s42, 5
    v_writelane_b32 v23, s43, 5
    v_writelane_b32 v22, s44, 6
    v_writelane_b32 v23, s45, 6
    v_writelane_b32 v22, s46, 7
    v_writelane_b32 v23, s47, 7
    v_sub_u32 v9, s84, v23
    v_cmp_gt_u32 vcc, 0x1000, v9
    v_sub_u32 v8, s74, v22
    s_and_b32 vcc_lo, vcc_lo, 255
    s_bitset0_b32 vcc_lo, s76
    v_cndmask_b32 v8, 0, v8, vcc
    s_nop 1
    v_add_u32_dpp v8, v8, v8 row_ror:8 row_mask:0xf bank_mask:0xf
    s_nop 1
    v_add_u32_dpp v8, v8, v8 row_ror:4 row_mask:0xf bank_mask:0xf
    s_nop 1
    v_add_u32_dpp v8, v8, v8 row_ror:2 row_mask:0xf bank_mask:0xf
    s_nop 1
    v_add_u32_dpp v8, v8, v8 row_ror:1 row_mask:0xf bank_mask:0xf
    s_nop 1
    v_ashrrev_i32 v8, 9, v8
    v_max_i32 v8, -5, v8
    v_min_i32 v8, 40, v8
    v_add_u32 v8, 0x400, v8
    s_mov_b64 exec, 1
    buffer_store_short v8, v2, s[60:63], 0 offen offset:192
L_cn:
    s_cmp_eq_u32 s81, 0
    s_cbranch_scc1 L_c
    s_endpgm
.section .rodata,"a"
.p2align 6
.amdhsa_kernel standalone__kv_cache_quant_int4_int2_kv_with_per_channel_or_per_token_scales__decode_kernel
  .amdhsa_next_free_vgpr 246
  .amdhsa_next_free_sgpr 102
  .amdhsa_accum_offset 248
  .amdhsa_float_denorm_mode_32 3
  .amdhsa_group_segment_fixed_size 0
  .amdhsa_kernarg_size 80
  .amdhsa_user_sgpr_count 2
  .amdhsa_user_sgpr_kernarg_segment_ptr 1
  .amdhsa_system_sgpr_workgroup_id_x 1
.end_amdhsa_kernel
```
